```python
import torch

def _softmax(x, axis=-1):
    return torch.softmax(x, dim=axis)
def _gelu(x):
    return torch.nn.functional.gelu(x, approximate="tanh")
def _silu(x):
    return torch.nn.functional.silu(x)
def _sigmoid(x):
    return torch.sigmoid(x)
def _layernorm(x, axis=-1, eps=1e-5):
    m = x.mean(dim=axis, keepdim=True)
    v = x.var(dim=axis, keepdim=True, unbiased=False)
    return (x - m) / torch.sqrt(v + eps)
def _scatter_add(tgt, idx, src, axis=0):
    return tgt.clone().index_add_(axis, idx, src)
def _segment_sum(src, seg, n):
    out = torch.zeros((n,) + src.shape[1:], dtype=src.dtype)
    return out.index_add_(0, seg, src)
def _pad(x, pw):
    flat = tuple(v for pair in reversed(pw) for v in pair)
    return torch.nn.functional.pad(x, flat)

kernel_name = 'recurrent_scan__compressed_kv_cla__geglu_ffn__prompt'

def setup_inputs():

    _w = (lambda a: (lambda t: t.to(torch.bfloat16) if t.is_floating_point() else t)(torch.as_tensor(a)))
    def _A_setup():
        B, H, Sq, Sk, D, M = 1, 32, 2048, 2048, 128, 640
        Dc = 4 * D
        return {
            "x": _w((lambda *s: torch.randn(*s, dtype=torch.bfloat16) * 0.05)(B, Sq, M)),
            "c_kv": _w((lambda *s: torch.randn(*s, dtype=torch.bfloat16) * 0.2)(B, Sk, Dc)),
            "w_q": _w((lambda *s: torch.randn(*s, dtype=torch.bfloat16) * 3.2)(M, H, D) * (M ** -0.5)),
            "w_uk": _w((lambda *s: torch.randn(*s, dtype=torch.bfloat16) * 3.2)(Dc, H, D) * (Dc ** -0.5)),
            "w_uv": _w((lambda *s: torch.randn(*s, dtype=torch.bfloat16) * 0.2)(Dc, H, D) * (Dc ** -0.5)),
            "w_o": _w((lambda *s: torch.randn(*s, dtype=torch.bfloat16) * 0.2)(H, D, M) * ((H * D) ** -0.5)),
        }
    _A_in = _A_setup()

    def _B_setup():
        B, S, D, F = 1, 2048, 640, 1728
        return {
            "x": _w((lambda *s: torch.randn(*s, dtype=torch.bfloat16) * 0.05)(B, S, D)),
            "w_gate": _w((lambda *s: torch.randn(*s, dtype=torch.bfloat16) * 0.1)(D, F)),
            "w_up": _w((lambda *s: torch.randn(*s, dtype=torch.bfloat16) * 0.1)(D, F)),
            "w_down": _w((lambda *s: torch.randn(*s, dtype=torch.bfloat16) * 0.1)(F, D)),
        }
    _B_in = _B_setup()

    return {
        "A_x": _A_in["x"],
        "A_c_kv": _A_in["c_kv"],
        "A_w_q": _A_in["w_q"],
        "A_w_uk": _A_in["w_uk"],
        "A_w_uv": _A_in["w_uv"],
        "A_w_o": _A_in["w_o"],
        "B_x": _B_in["x"],
        "B_w_gate": _B_in["w_gate"],
        "B_w_up": _B_in["w_up"],
        "B_w_down": _B_in["w_down"],
    }

def reference(A_x, A_c_kv, A_w_q, A_w_uk, A_w_uv, A_w_o, B_x, B_w_gate, B_w_up, B_w_down):
    def _A_ref(x, c_kv, w_q, w_uk, w_uv, w_o):
        B, Sq, M = x.shape[0], x.shape[1], x.shape[2]
        Sk = c_kv.shape[1]
        H, D = w_q.shape[1], w_q.shape[2]
        q = torch.einsum("bqm,mhd->bhqd", x, w_q)
        k = torch.einsum("bkc,chd->bhkd", c_kv, w_uk)
        v = torch.einsum("bkc,chd->bhkd", c_kv, w_uv)
        scores = torch.einsum("bhqd,bhkd->bhqk", q, k) * (D ** -0.5)
        off = Sk - Sq
        qi = torch.arange(Sq)[:, None]
        kj = torch.arange(Sk)[None, :]
        cmask = kj <= (qi + off)
        scores = torch.where(cmask[None, None], scores, -1e9)
        p = _softmax(scores, axis=-1)
        ctx = torch.einsum("bhqk,bhkd->bhqd", p, v)
        return torch.einsum("bhqd,hdm->bqm", ctx, w_o)

    def _B_ref(x, w_gate, w_up, w_down):
        return (_gelu(x @ w_gate) * (x @ w_up)) @ w_down

    x = A_x
    xn = _layernorm(x, axis=-1)
    s = _A_ref(xn, A_c_kv, A_w_q, A_w_uk, A_w_uv, A_w_o)
    g = _silu(_B_ref(xn, B_w_gate, B_w_up, B_w_down))
    return x + s * g
```

```asm
; @launch grid=(256,1,1) block=(256,1,1) lds=163840
.amdgcn_target "amdgcn-amd-amdhsa--gfx950"
.text
.globl recurrent_scan__compressed_kv_cla__geglu_ffn__prompt_kernel
.p2align 8
.type recurrent_scan__compressed_kv_cla__geglu_ffn__prompt_kernel,@function
recurrent_scan__compressed_kv_cla__geglu_ffn__prompt_kernel:
    s_cmp_lt_u32 s2, 256
    s_cbranch_scc1 K_go
    s_endpgm
K_go:
    s_lshr_b32 s3, s2, 5
    s_xor_b32 s3, s3, s2
    s_and_b32 s3, s3, 1
    s_mul_i32 s3, s3, 33
    s_xor_b32 s2, s2, s3
    s_load_dwordx16 s[4:19], s[0:1], 0
    s_load_dwordx8 s[20:27], s[0:1], 64
    s_load_dwordx2 s[28:29], s[0:1], 96
    s_getpc_b64 s[52:53]
K_pc:
    s_mov_b32 s54, K_end-K_pc
    s_mov_b32 s55, 0x00020000
    s_bfe_u32 s35, s2, 0x20003
    s_lshl_b32 s33, s35, 15
    v_lshlrev_b32 v34, 7, v0
    buffer_load_dword v63, v34, s[52:55], s33 offen
    v_and_b32 v1, 63, v0
    v_lshrrev_b32 v35, 6, v0
    s_nop 0
    v_readfirstlane_b32 s30, v35
    s_and_b32 s33, s2, 7
    s_lshl_b32 s31, s33, 2
    s_add_u32 s31, s31, s35
    s_lshr_b32 s32, s2, 5
    s_sub_u32 s3, s31, s33
    s_sub_u32 s33, s33, s32
    s_and_b32 s33, s33, 7
    s_add_u32 s33, s33, 24
    s_cmp_eq_u32 s35, 3
    s_cselect_b32 s3, s33, s3
    s_and_b32 s94, s30, 1
    s_lshr_b32 s95, s30, 1
    s_lshl_b32 s92, s30, 13
    v_lshrrev_b32 v34, 3, v1
    v_lshrrev_b32 v35, 4, v1
    v_and_b32 v36, 7, v1
    v_xor_b32 v36, v36, v35
    v_lshlrev_b32 v36, 4, v36
    s_lshl_b32 s33, s30, 16
    v_lshl_add_u32 v8, v34, 10, v36
    v_add_u32 v8, s33, v8
    v_xor_b32 v9, 64, v8
    v_add_u32 v9, 7168, v9
    v_add_u32 v10, 14336, v8
    v_add_u32 v11, 14336, v9
    v_and_b32 v36, 15, v1
    v_lshlrev_b32 v34, 1, v35
    v_xor_b32 v36, v36, v34
    v_lshlrev_b32 v36, 4, v36
    v_lshl_add_u32 v12, v35, 13, v36
    s_lshl_b32 s33, s94, 18
    v_add_u32 v12, s33, v12
    v_add_u32 v13, 31744, v12
    v_xor_b32 v14, 128, v12
    v_add_u32 v14, 63488, v14
    v_add_u32 v15, 31744, v14
    v_and_b32 v34, 15, v1
    v_lshrrev_b32 v36, 1, v34
    v_xor_b32 v36, v36, v35
    v_lshlrev_b32 v34, 7, v34
    v_lshl_add_u32 v34, v36, 4, v34
    s_lshl_b32 s33, s94, 14
    v_add_u32 v16, s33, v34
    v_xor_b32 v17, 64, v16
    v_bfe_u32 v34, v1, 2, 2
    v_lshl_add_u32 v36, v35, 3, v34
    v_lshlrev_b32 v36, 8, v36
    v_and_b32 v37, 3, v1
    v_lshl_add_u32 v36, v37, 3, v36
    v_and_b32 v35, 1, v35
    v_lshl_add_u32 v34, v35, 2, v34
    v_lshl_add_u32 v36, v34, 5, v36
    s_lshl_b32 s33, s95, 7
    s_add_u32 s33, s33, 65536
    v_xor_b32 v18, s33, v36
    v_xor_b32 v19, 32, v18
    v_xor_b32 v20, 64, v18
    v_xor_b32 v21, 96, v18
    v_lshrrev_b32 v34, 5, v0
    v_and_b32 v35, 31, v0
    v_lshlrev_b32 v35, 3, v35
    v_mul_u32_u24 v36, 1280, v34
    v_add_u32 v32, v36, v35
    v_lshl_add_u32 v36, v34, 4, v32
    v_add_u32 v57, 131072, v36
    v_and_b32 v61, 0xf8, v0
    v_or_b32 v61, 2, v61
    v_max_u32 v61, v61, v0
    v_lshlrev_b32 v61, 7, v61
    v_bfe_u32 v34, v0, 1, 6
    v_and_b32 v35, 1, v0
    v_lshlrev_b32 v35, 7, v35
    v_lshl_add_u32 v62, v34, 13, v35
    v_and_b32 v34, 7, v0
    v_lshrrev_b32 v35, 3, v0
    v_mul_u32_u24 v36, 1296, v34
    v_lshl_add_u32 v36, v35, 4, v36
    v_add_u32 v58, 131072, v36
    v_lshlrev_b32 v34, 4, v34
    v_lshl_add_u32 v59, v35, 8, v34
    v_lshlrev_b32 v0, 2, v0
    v_lshlrev_b32 v2, 4, v1
    v_add_u32 v4, 4096, v2
    s_lshl_b32 s33, s32, 18
    s_lshl_b32 s34, s31, 8
    s_sub_u32 s42, 4194304, s34
    s_mov_b32 s43, 0x00020000
    s_mov_b32 s38, 262144
    s_mov_b32 s39, 0x00020000
    s_mul_i32 s96, s2, 10240
    s_cmp_eq_u32 s95, 0
    s_waitcnt lgkmcnt(0)
    s_cselect_b32 s40, s10, s12
    s_cselect_b32 s41, s11, s13
    s_add_u32 s36, s6, s33
    s_addc_u32 s37, s7, 0
    s_add_u32 s40, s40, s34
    s_addc_u32 s41, s41, 0
    s_add_u32 m0, s92, 0
    s_mov_b32 s94, 0
    buffer_load_dwordx4 v8, s[36:39], s94 offen offset:0 lds
    buffer_load_dwordx4 v9, s[36:39], s94 offen offset:1024 lds
    buffer_load_dwordx4 v10, s[36:39], s94 offen offset:2048 lds
    buffer_load_dwordx4 v11, s[36:39], s94 offen offset:3072 lds
    s_add_u32 m0, s92, 65536
    s_mov_b32 s95, 0
    buffer_load_dwordx4 v12, s[40:43], s95 offen offset:0 lds
    buffer_load_dwordx4 v13, s[40:43], s95 offen offset:1024 lds
    buffer_load_dwordx4 v14, s[40:43], s95 offen offset:2048 lds
    buffer_load_dwordx4 v15, s[40:43], s95 offen offset:3072 lds
    s_add_u32 m0, s92, 4096
    s_mov_b32 s94, 32768
    buffer_load_dwordx4 v8, s[36:39], s94 offen offset:0 lds
    buffer_load_dwordx4 v9, s[36:39], s94 offen offset:1024 lds
    buffer_load_dwordx4 v10, s[36:39], s94 offen offset:2048 lds
    buffer_load_dwordx4 v11, s[36:39], s94 offen offset:3072 lds
    s_add_u32 m0, s92, 69632
    s_mov_b32 s95, 131072
    buffer_load_dwordx4 v12, s[40:43], s95 offen offset:0 lds
    buffer_load_dwordx4 v13, s[40:43], s95 offen offset:1024 lds
    buffer_load_dwordx4 v14, s[40:43], s95 offen offset:2048 lds
    buffer_load_dwordx4 v15, s[40:43], s95 offen offset:3072 lds
    s_add_u32 s48, s4, s96
    s_addc_u32 s49, s5, 0
    s_mov_b32 s50, 10240
    s_mov_b32 s51, 0x00020000
    buffer_load_dwordx2 v[22:23], v32, s[48:51], 0 offen offset:0
    buffer_load_dwordx2 v[24:25], v32, s[48:51], 0 offen offset:256
    buffer_load_dwordx2 v[26:27], v32, s[48:51], 0 offen offset:512
    buffer_load_dwordx2 v[28:29], v32, s[48:51], 0 offen offset:768
    buffer_load_dwordx2 v[30:31], v32, s[48:51], 0 offen offset:1024
    s_lshl_b32 s33, s2, 7
    s_add_u32 s33, s33, 100663296
    s_add_u32 s76, s28, s33
    s_addc_u32 s77, s29, 0
    s_mov_b32 s78, 4
    s_mov_b32 s79, 0x00020000
    s_cmp_eq_u32 s2, 0
    s_cselect_b32 s33, 32768, 0
    s_cselect_b32 s82, 4, 0
    s_add_u32 s88, s28, 100663296
    s_addc_u32 s89, s29, 0
    s_mov_b32 s90, s33
    s_mov_b32 s91, 0x00020000
    v_mov_b32 v5, 0
    v_lshlrev_b32 v6, 5, v0
    buffer_store_dword v5, v6, s[88:91], 0 offen sc1
    s_add_u32 m0, s92, 32768
    s_mov_b32 s94, 128
    buffer_load_dwordx4 v8, s[36:39], s94 offen offset:0 lds
    buffer_load_dwordx4 v9, s[36:39], s94 offen offset:1024 lds
    buffer_load_dwordx4 v10, s[36:39], s94 offen offset:2048 lds
    buffer_load_dwordx4 v11, s[36:39], s94 offen offset:3072 lds
    s_add_u32 m0, s92, 98304
    s_mov_b32 s95, 524288
    buffer_load_dwordx4 v12, s[40:43], s95 offen offset:0 lds
    buffer_load_dwordx4 v13, s[40:43], s95 offen offset:1024 lds
    buffer_load_dwordx4 v14, s[40:43], s95 offen offset:2048 lds
    buffer_load_dwordx4 v15, s[40:43], s95 offen offset:3072 lds
    s_mov_b64 s[80:81], s[26:27]
    s_mov_b32 s83, 0x00020000
    s_mov_b32 s90, 32768
    s_lshr_b32 s33, s2, 1
    s_mul_i32 s33, s33, 20480
    s_and_b32 s34, s2, 1
    s_lshl_b32 s34, s34, 7
    s_add_u32 s33, s33, s34
    s_add_u32 s33, s33, 37748736
    s_add_u32 s48, s28, s33
    s_addc_u32 s49, s29, 0
    s_mov_b32 s50, 20352
    s_mov_b32 s51, 0x00020000
    s_mul_i32 s33, s31, 1082368
    s_mul_i32 s34, s32, 135168
    s_add_u32 s33, s33, s34
    s_add_u32 s44, s28, s33
    s_addc_u32 s45, s29, 0
    s_mov_b32 s46, 135168
    s_mov_b32 s47, 0x00020000
    s_lshl_b32 s33, s31, 8
    s_sub_u32 s34, 5242880, s33
    s_add_u32 s60, s8, s33
    s_addc_u32 s61, s9, 0
    s_mov_b32 s62, s34
    s_mov_b32 s63, 0x00020000
    s_lshl_b32 s33, s3, 7
    s_sub_u32 s34, 2211840, s33
    s_add_u32 s35, s34, 2048
    s_cmp_lt_u32 s3, 27
    s_cselect_b32 s33, s33, 0
    s_cselect_b32 s34, s34, 0
    s_cselect_b32 s35, s35, 0
    s_add_u32 s64, s18, s33
    s_addc_u32 s65, s19, 0
    s_mov_b32 s66, s34
    s_mov_b32 s67, 0x00020000
    s_add_u32 s68, s20, s33
    s_addc_u32 s69, s21, 0
    s_mov_b32 s70, s35
    s_mov_b32 s71, 0x00020000
    s_sub_u32 s68, s68, 2048
    s_subb_u32 s69, s69, 0
    s_add_u32 s72, s28, 37748736
    s_addc_u32 s73, s29, 0
    s_mov_b32 s74, 2621440
    s_mov_b32 s75, 0x00020000
    s_lshl_b32 s33, s32, 3
    s_add_u32 s56, s33, s30
    s_sub_u32 s59, 127, s56
    s_sub_u32 s57, s33, s30
    s_add_u32 s57, s57, 7
    s_sub_u32 s58, 127, s57
    s_mul_i32 s84, s56, 20480
    s_mul_i32 s56, s56, 188416
    s_mul_i32 s85, s57, 20480
    s_mul_i32 s57, s57, 188416
    s_mul_i32 s86, s58, 20480
    s_mul_i32 s58, s58, 188416
    s_mul_i32 s87, s59, 20480
    s_mul_i32 s59, s59, 188416
    s_lshl_b32 s93, s30, 12
    s_sub_u32 s0, s3, 27
    s_cselect_b32 s0, 0x800, s0
    s_lshl3_add_u32 s0, s0, s32
    s_mul_i32 s1, s30, 1310720
    s_lshl_b32 s35, s0, 15
    s_add_u32 s1, s1, s35
    s_lshl2_add_u32 s0, s0, s30
    s_lshl_b32 s0, s0, 14
    s_add_u32 s8, s14, 0
    s_addc_u32 s9, s15, 0
    s_mov_b32 s10, 5242880
    s_mov_b32 s11, 0x00020000
    s_add_u32 s16, s22, 0
    s_addc_u32 s17, s23, 0
    s_mov_b32 s18, 2211840
    s_mov_b32 s19, 0x00020000
    s_add_u32 s12, s28, 67108864
    s_addc_u32 s13, s29, 0
    s_mov_b32 s14, 16777216
    s_mov_b32 s15, 0x00020000
    s_add_u32 s20, s28, 41943040
    s_addc_u32 s21, s29, 0
    s_mov_b32 s22, 24117248
    s_mov_b32 s23, 0x00020000
    s_and_b32 s33, s31, 7
    s_min_u32 s33, s33, 4
    s_lshl_b32 s33, s33, 8
    s_bitcmp1_b32 s31, 3
    s_cselect_b32 s34, s85, s84
    s_cselect_b32 s35, s87, s86
    s_bitcmp1_b32 s31, 4
    s_cselect_b32 s34, s35, s34
    s_add_u32 s33, s33, s34
    s_add_u32 s4, s4, s33
    s_addc_u32 s5, s5, 0
    s_mov_b32 s6, 19456
    s_mov_b32 s7, 0x00020000
    s_add_u32 s24, s24, s33
    s_addc_u32 s25, s25, 0
    s_mov_b32 s26, 19456
    s_mov_b32 s27, 0x00020000
    s_lshl_b32 s33, s31, 12
    s_add_u32 s33, s33, 41943040
    s_add_u32 s52, s28, s33
    s_addc_u32 s53, s29, 0
    s_mov_b32 s54, 23932928
    s_mov_b32 s55, 0x00020000
    s_waitcnt vmcnt(14)
    s_barrier
    ds_read_b64_tr_b16 a[64:65], v18 offset:16384
    ds_read_b64_tr_b16 a[66:67], v18 offset:17408
    ds_read_b128 a[0:3], v16 offset:0
    ds_read_b64_tr_b16 a[68:69], v19 offset:16384
    ds_read_b64_tr_b16 a[70:71], v19 offset:17408
    ds_read_b128 a[4:7], v16 offset:2048
    ds_read_b128 a[8:11], v16 offset:4096
    ds_read_b128 a[12:15], v16 offset:6144
    ds_read_b128 a[16:19], v16 offset:8192
    ds_read_b128 a[20:23], v16 offset:10240
    ds_read_b128 a[24:27], v16 offset:12288
    ds_read_b128 a[28:31], v16 offset:14336
    s_waitcnt lgkmcnt(9)
    v_mfma_f32_16x16x32_bf16 a[96:99], a[0:3], a[64:67], 0
    s_waitcnt lgkmcnt(7)
    ds_read_b64_tr_b16 a[72:73], v20 offset:16384
    ds_read_b64_tr_b16 a[74:75], v20 offset:17408
    v_mfma_f32_16x16x32_bf16 a[128:131], a[0:3], a[68:71], 0
    s_waitcnt lgkmcnt(8)
    ds_read_b64_tr_b16 a[76:77], v21 offset:16384
    ds_read_b64_tr_b16 a[78:79], v21 offset:17408
    v_mfma_f32_16x16x32_bf16 a[132:135], a[4:7], a[68:71], 0
    s_add_u32 m0, s92, 36864
    v_mfma_f32_16x16x32_bf16 a[100:103], a[4:7], a[64:67], 0
    s_mov_b32 s94, 32896
    s_waitcnt lgkmcnt(9)
    v_mfma_f32_16x16x32_bf16 a[104:107], a[8:11], a[64:67], 0
    ds_read_b128 a[32:35], v17 offset:0
    ds_read_b128 a[36:39], v17 offset:2048
    v_mfma_f32_16x16x32_bf16 a[136:139], a[8:11], a[68:71], 0
    s_waitcnt lgkmcnt(10)
    buffer_load_dwordx4 v8, s[36:39], s94 offen offset:0 lds
    v_mfma_f32_16x16x32_bf16 a[140:143], a[12:15], a[68:71], 0
    v_mfma_f32_16x16x32_bf16 a[108:111], a[12:15], a[64:67], 0
    s_waitcnt lgkmcnt(4)
    v_mfma_f32_16x16x32_bf16 a[112:115], a[16:19], a[64:67], 0
    buffer_load_dwordx4 v9, s[36:39], s94 offen offset:1024 lds
    v_mfma_f32_16x16x32_bf16 a[144:147], a[16:19], a[68:71], 0
    v_mfma_f32_16x16x32_bf16 a[148:151], a[20:23], a[68:71], 0
    s_waitcnt vmcnt(15)
    v_lshlrev_b32 v34, 16, v22
    v_and_b32 v35, 0xffff0000, v22
    v_mfma_f32_16x16x32_bf16 a[116:119], a[20:23], a[64:67], 0
    buffer_load_dwordx4 v10, s[36:39], s94 offen offset:2048 lds
    v_mfma_f32_16x16x32_bf16 a[120:123], a[24:27], a[64:67], 0
    ds_read_b128 a[40:43], v17 offset:4096
    ds_read_b128 a[44:47], v17 offset:6144
    v_mfma_f32_16x16x32_bf16 a[152:155], a[24:27], a[68:71], 0
    v_lshlrev_b32 v36, 16, v23
    v_and_b32 v37, 0xffff0000, v23
    v_mfma_f32_16x16x32_bf16 a[156:159], a[28:31], a[68:71], 0
    s_waitcnt lgkmcnt(2)
    buffer_load_dwordx4 v11, s[36:39], s94 offen offset:3072 lds
    v_mfma_f32_16x16x32_bf16 a[124:127], a[28:31], a[64:67], 0
    s_add_u32 m0, s92, 102400
    s_waitcnt vmcnt(16)
    v_lshlrev_b32 v38, 16, v24
    v_and_b32 v39, 0xffff0000, v24
    v_mfma_f32_16x16x32_bf16 v[172:175], a[28:31], a[72:75], 0
    s_mov_b32 s95, 655360
    ds_read_b64_tr_b16 a[64:65], v18 offset:0
    ds_read_b64_tr_b16 a[66:67], v18 offset:1024
    v_mfma_f32_16x16x32_bf16 v[188:191], a[28:31], a[76:79], 0
    ds_read_b64_tr_b16 a[68:69], v19 offset:0
    ds_read_b64_tr_b16 a[70:71], v19 offset:1024
    v_mfma_f32_16x16x32_bf16 v[92:95], a[24:27], a[76:79], 0
    buffer_load_dwordx4 v12, s[40:43], s95 offen offset:0 lds
    v_mfma_f32_16x16x32_bf16 v[76:79], a[24:27], a[72:75], 0
    v_lshlrev_b32 v40, 16, v25
    v_and_b32 v41, 0xffff0000, v25
    v_mfma_f32_16x16x32_bf16 v[168:171], a[20:23], a[72:75], 0
    ds_read_b128 a[48:51], v17 offset:8192
    ds_read_b128 a[52:55], v17 offset:10240
    v_mfma_f32_16x16x32_bf16 v[184:187], a[20:23], a[76:79], 0
    buffer_load_dwordx4 v13, s[40:43], s95 offen offset:1024 lds
    v_mfma_f32_16x16x32_bf16 v[88:91], a[16:19], a[76:79], 0
    s_waitcnt vmcnt(17)
    v_lshlrev_b32 v42, 16, v26
    v_and_b32 v43, 0xffff0000, v26
    v_mfma_f32_16x16x32_bf16 v[72:75], a[16:19], a[72:75], 0
    v_lshlrev_b32 v44, 16, v27
    v_and_b32 v45, 0xffff0000, v27
    v_mfma_f32_16x16x32_bf16 v[164:167], a[12:15], a[72:75], 0
    buffer_load_dwordx4 v14, s[40:43], s95 offen offset:2048 lds
    v_mfma_f32_16x16x32_bf16 v[180:183], a[12:15], a[76:79], 0
    s_waitcnt vmcnt(17)
    v_lshlrev_b32 v46, 16, v28
    v_and_b32 v47, 0xffff0000, v28
    v_mfma_f32_16x16x32_bf16 v[84:87], a[8:11], a[76:79], 0
    v_lshlrev_b32 v48, 16, v29
    v_and_b32 v49, 0xffff0000, v29
    v_mfma_f32_16x16x32_bf16 v[68:71], a[8:11], a[72:75], 0
    buffer_load_dwordx4 v15, s[40:43], s95 offen offset:3072 lds
    v_mfma_f32_16x16x32_bf16 v[160:163], a[4:7], a[72:75], 0
    s_and_b32 s96, s31, 7
    ds_read_b128 a[56:59], v17 offset:12288
    ds_read_b128 a[60:63], v17 offset:14336
    v_mfma_f32_16x16x32_bf16 v[176:179], a[4:7], a[76:79], 0
    s_lshl_b32 s96, s96, 15
    s_waitcnt vmcnt(17)
    v_lshlrev_b32 v50, 16, v30
    v_and_b32 v51, 0xffff0000, v30
    v_mfma_f32_16x16x32_bf16 v[80:83], a[0:3], a[76:79], 0
    s_waitcnt lgkmcnt(2)
    buffer_load_dword v61, v61, s[36:39], s96 offen
    v_mfma_f32_16x16x32_bf16 v[64:67], a[0:3], a[72:75], 0
    s_lshl_b32 s96, s32, 19
    v_lshlrev_b32 v52, 16, v31
    v_and_b32 v53, 0xffff0000, v31
    v_mfma_f32_16x16x32_bf16 v[96:99], a[64:67], a[0:3], 0
    ds_read_b64_tr_b16 a[72:73], v20 offset:0
    ds_read_b64_tr_b16 a[74:75], v20 offset:1024
    v_mfma_f32_16x16x32_bf16 v[192:195], a[68:71], a[0:3], 0
    ds_read_b64_tr_b16 a[76:77], v21 offset:0
    ds_read_b64_tr_b16 a[78:79], v21 offset:1024
    v_mfma_f32_16x16x32_bf16 v[196:199], a[68:71], a[4:7], 0
    s_cmp_lt_u32 s32, 2
    s_cselect_b32 s96, 4194304, s96
    v_add_f32 v54, v34, v35
    v_mfma_f32_16x16x32_bf16 v[100:103], a[64:67], a[4:7], 0
    buffer_load_dword v62, v62, s[40:43], s96 offen
    v_mfma_f32_16x16x32_bf16 v[104:107], a[64:67], a[8:11], 0
    v_add_f32 v54, v54, v36
    v_add_f32 v54, v54, v37
    v_mfma_f32_16x16x32_bf16 v[200:203], a[68:71], a[8:11], 0
    v_add_f32 v54, v54, v38
    v_add_f32 v54, v54, v39
    v_mfma_f32_16x16x32_bf16 v[204:207], a[68:71], a[12:15], 0
    v_add_f32 v54, v54, v40
    v_add_f32 v54, v54, v41
    v_mfma_f32_16x16x32_bf16 v[108:111], a[64:67], a[12:15], 0
    v_add_f32 v54, v54, v42
    v_add_f32 v54, v54, v43
    v_mfma_f32_16x16x32_bf16 v[112:115], a[64:67], a[16:19], 0
    v_add_f32 v54, v54, v44
    v_add_f32 v54, v54, v45
    v_mfma_f32_16x16x32_bf16 v[208:211], a[68:71], a[16:19], 0
    v_add_f32 v54, v54, v46
    v_add_f32 v54, v54, v47
    v_mfma_f32_16x16x32_bf16 v[212:215], a[68:71], a[20:23], 0
    v_add_f32 v54, v54, v48
    v_add_f32 v54, v54, v49
    v_mfma_f32_16x16x32_bf16 v[116:119], a[64:67], a[20:23], 0
    v_add_f32 v54, v54, v50
    v_add_f32 v54, v54, v51
    v_mfma_f32_16x16x32_bf16 v[120:123], a[64:67], a[24:27], 0
    v_add_f32 v54, v54, v52
    v_add_f32 v54, v54, v53
    v_mfma_f32_16x16x32_bf16 v[216:219], a[68:71], a[24:27], 0
    s_nop 0
    v_add_f32_dpp v54, v54, v54 quad_perm:[1,0,3,2] row_mask:0xf bank_mask:0xf
    s_nop 1
    v_add_f32_dpp v54, v54, v54 quad_perm:[2,3,0,1] row_mask:0xf bank_mask:0xf
    v_mfma_f32_16x16x32_bf16 v[220:223], a[68:71], a[28:31], 0
    s_nop 0
    v_add_f32_dpp v54, v54, v54 row_half_mirror row_mask:0xf bank_mask:0xf
    s_nop 1
    v_add_f32_dpp v54, v54, v54 row_mirror row_mask:0xf bank_mask:0xf
    v_mfma_f32_16x16x32_bf16 v[124:127], a[64:67], a[28:31], 0
    s_waitcnt lgkmcnt(0)
    v_mov_b32 v56, v54
    s_nop 1
    v_permlane16_swap_b32 v56, v54
    v_mfma_f32_16x16x32_bf16 v[156:159], a[72:75], a[28:31], 0
    ds_read_b64_tr_b16 a[64:65], v18 offset:24576
    ds_read_b64_tr_b16 a[66:67], v18 offset:25600
    v_mfma_f32_16x16x32_bf16 v[252:255], a[76:79], a[28:31], 0
    ds_read_b64_tr_b16 a[68:69], v19 offset:24576
    ds_read_b64_tr_b16 a[70:71], v19 offset:25600
    v_mfma_f32_16x16x32_bf16 v[248:251], a[76:79], a[24:27], 0
    v_add_f32 v54, v54, v56
    v_mul_f32 v54, 0x3acccccd, v54
    v_mfma_f32_16x16x32_bf16 v[152:155], a[72:75], a[24:27], 0
    v_sub_f32 v56, v34, v54
    v_mul_f32 v55, v56, v56
    v_mfma_f32_16x16x32_bf16 v[148:151], a[72:75], a[20:23], 0
    v_sub_f32 v56, v35, v54
    v_fmac_f32 v55, v56, v56
    v_mfma_f32_16x16x32_bf16 v[244:247], a[76:79], a[20:23], 0
    v_sub_f32 v56, v36, v54
    v_fmac_f32 v55, v56, v56
    v_mfma_f32_16x16x32_bf16 v[240:243], a[76:79], a[16:19], 0
    v_sub_f32 v56, v37, v54
    v_fmac_f32 v55, v56, v56
    v_mfma_f32_16x16x32_bf16 v[144:147], a[72:75], a[16:19], 0
    v_sub_f32 v56, v38, v54
    v_fmac_f32 v55, v56, v56
    v_mfma_f32_16x16x32_bf16 v[140:143], a[72:75], a[12:15], 0
    v_sub_f32 v56, v39, v54
    v_fmac_f32 v55, v56, v56
    v_mfma_f32_16x16x32_bf16 v[236:239], a[76:79], a[12:15], 0
    v_sub_f32 v56, v40, v54
    v_fmac_f32 v55, v56, v56
    v_mfma_f32_16x16x32_bf16 v[232:235], a[76:79], a[8:11], 0
    v_sub_f32 v56, v41, v54
    v_fmac_f32 v55, v56, v56
    v_mfma_f32_16x16x32_bf16 v[136:139], a[72:75], a[8:11], 0
    v_sub_f32 v56, v42, v54
    v_fmac_f32 v55, v56, v56
    v_mfma_f32_16x16x32_bf16 v[132:135], a[72:75], a[4:7], 0
    v_sub_f32 v56, v43, v54
    v_fmac_f32 v55, v56, v56
    v_mfma_f32_16x16x32_bf16 v[228:231], a[76:79], a[4:7], 0
    v_sub_f32 v56, v44, v54
    v_fmac_f32 v55, v56, v56
    v_mfma_f32_16x16x32_bf16 v[224:227], a[76:79], a[0:3], 0
    v_sub_f32 v56, v45, v54
    v_fmac_f32 v55, v56, v56
    v_mfma_f32_16x16x32_bf16 v[128:131], a[72:75], a[0:3], 0
    s_waitcnt lgkmcnt(0)
    v_sub_f32 v56, v46, v54
    v_fmac_f32 v55, v56, v56
    v_mfma_f32_16x16x32_bf16 a[96:99], a[32:35], a[64:67], a[96:99]
    ds_read_b64_tr_b16 a[72:73], v20 offset:24576
    ds_read_b64_tr_b16 a[74:75], v20 offset:25600
    v_mfma_f32_16x16x32_bf16 a[128:131], a[32:35], a[68:71], a[128:131]
    ds_read_b64_tr_b16 a[76:77], v21 offset:24576
    ds_read_b64_tr_b16 a[78:79], v21 offset:25600
    v_mfma_f32_16x16x32_bf16 a[132:135], a[36:39], a[68:71], a[132:135]
    v_sub_f32 v56, v47, v54
    v_fmac_f32 v55, v56, v56
    v_mfma_f32_16x16x32_bf16 a[100:103], a[36:39], a[64:67], a[100:103]
    v_sub_f32 v56, v48, v54
    v_fmac_f32 v55, v56, v56
    v_mfma_f32_16x16x32_bf16 a[104:107], a[40:43], a[64:67], a[104:107]
    v_sub_f32 v56, v49, v54
    v_fmac_f32 v55, v56, v56
    v_mfma_f32_16x16x32_bf16 a[136:139], a[40:43], a[68:71], a[136:139]
    v_sub_f32 v56, v50, v54
    v_fmac_f32 v55, v56, v56
    v_mfma_f32_16x16x32_bf16 a[140:143], a[44:47], a[68:71], a[140:143]
    v_sub_f32 v56, v51, v54
    v_fmac_f32 v55, v56, v56
    v_mfma_f32_16x16x32_bf16 a[108:111], a[44:47], a[64:67], a[108:111]
    v_sub_f32 v56, v52, v54
    v_fmac_f32 v55, v56, v56
    v_mfma_f32_16x16x32_bf16 a[112:115], a[48:51], a[64:67], a[112:115]
    v_sub_f32 v56, v53, v54
    v_fmac_f32 v55, v56, v56
    v_mfma_f32_16x16x32_bf16 a[144:147], a[48:51], a[68:71], a[144:147]
    s_nop 0
    v_add_f32_dpp v55, v55, v55 quad_perm:[1,0,3,2] row_mask:0xf bank_mask:0xf
    s_nop 1
    v_add_f32_dpp v55, v55, v55 quad_perm:[2,3,0,1] row_mask:0xf bank_mask:0xf
    v_mfma_f32_16x16x32_bf16 a[148:151], a[52:55], a[68:71], a[148:151]
    s_nop 0
    v_add_f32_dpp v55, v55, v55 row_half_mirror row_mask:0xf bank_mask:0xf
    s_nop 1
    v_add_f32_dpp v55, v55, v55 row_mirror row_mask:0xf bank_mask:0xf
    v_mfma_f32_16x16x32_bf16 a[116:119], a[52:55], a[64:67], a[116:119]
    v_mov_b32 v56, v55
    s_nop 1
    v_permlane16_swap_b32 v56, v55
    v_mfma_f32_16x16x32_bf16 a[120:123], a[56:59], a[64:67], a[120:123]
    v_add_f32 v55, v55, v56
    v_mul_f32 v55, 0x3acccccd, v55
    v_mfma_f32_16x16x32_bf16 a[152:155], a[56:59], a[68:71], a[152:155]
    v_cvt_pk_bf16_f32 v56, v54, v55
    v_lshlrev_b32 v54, 16, v56
    v_mfma_f32_16x16x32_bf16 a[156:159], a[60:63], a[68:71], a[156:159]
    v_and_b32 v55, 0xffff0000, v56
    v_add_f32 v55, 0x3727c5ac, v55
    v_mfma_f32_16x16x32_bf16 a[124:127], a[60:63], a[64:67], a[124:127]
    s_waitcnt lgkmcnt(0)
    v_cvt_pk_bf16_f32 v55, v55, v55
    v_and_b32 v55, 0xffff0000, v55
    v_mfma_f32_16x16x32_bf16 v[172:175], a[60:63], a[72:75], v[172:175]
    ds_read_b64_tr_b16 a[64:65], v18 offset:8192
    ds_read_b64_tr_b16 a[66:67], v18 offset:9216
    v_mfma_f32_16x16x32_bf16 v[188:191], a[60:63], a[76:79], v[188:191]
    ds_read_b64_tr_b16 a[68:69], v19 offset:8192
    ds_read_b64_tr_b16 a[70:71], v19 offset:9216
    v_mfma_f32_16x16x32_bf16 v[92:95], a[56:59], a[76:79], v[92:95]
    v_sqrt_f32 v55, v55
    v_mfma_f32_16x16x32_bf16 v[76:79], a[56:59], a[72:75], v[76:79]
    v_cvt_pk_bf16_f32 v55, v55, v55
    v_and_b32 v55, 0xffff0000, v55
    v_mfma_f32_16x16x32_bf16 v[168:171], a[52:55], a[72:75], v[168:171]
    v_rcp_f32 v55, v55
    v_mfma_f32_16x16x32_bf16 v[184:187], a[52:55], a[76:79], v[184:187]
    v_sub_f32 v34, v34, v54
    v_sub_f32 v35, v35, v54
    v_mfma_f32_16x16x32_bf16 v[88:91], a[48:51], a[76:79], v[88:91]
    v_cvt_pk_bf16_f32 v56, v34, v35
    v_lshlrev_b32 v34, 16, v56
    v_mfma_f32_16x16x32_bf16 v[72:75], a[48:51], a[72:75], v[72:75]
    v_and_b32 v35, 0xffff0000, v56
    v_mul_f32 v34, v34, v55
    v_mfma_f32_16x16x32_bf16 v[164:167], a[44:47], a[72:75], v[164:167]
    v_mul_f32 v35, v35, v55
    v_cvt_pk_bf16_f32 v22, v34, v35
    v_mfma_f32_16x16x32_bf16 v[180:183], a[44:47], a[76:79], v[180:183]
    v_sub_f32 v36, v36, v54
    v_sub_f32 v37, v37, v54
    v_mfma_f32_16x16x32_bf16 v[84:87], a[40:43], a[76:79], v[84:87]
    v_cvt_pk_bf16_f32 v56, v36, v37
    v_lshlrev_b32 v36, 16, v56
    v_mfma_f32_16x16x32_bf16 v[68:71], a[40:43], a[72:75], v[68:71]
    v_and_b32 v37, 0xffff0000, v56
    v_mul_f32 v36, v36, v55
    v_mfma_f32_16x16x32_bf16 v[160:163], a[36:39], a[72:75], v[160:163]
    v_mul_f32 v37, v37, v55
    v_cvt_pk_bf16_f32 v23, v36, v37
    v_mfma_f32_16x16x32_bf16 v[176:179], a[36:39], a[76:79], v[176:179]
    v_sub_f32 v38, v38, v54
    v_sub_f32 v39, v39, v54
    v_mfma_f32_16x16x32_bf16 v[80:83], a[32:35], a[76:79], v[80:83]
    v_cvt_pk_bf16_f32 v56, v38, v39
    v_lshlrev_b32 v38, 16, v56
    v_mfma_f32_16x16x32_bf16 v[64:67], a[32:35], a[72:75], v[64:67]
    s_waitcnt lgkmcnt(0)
    v_and_b32 v39, 0xffff0000, v56
    v_mul_f32 v38, v38, v55
    v_mfma_f32_16x16x32_bf16 v[96:99], a[64:67], a[32:35], v[96:99]
    ds_read_b64_tr_b16 a[72:73], v20 offset:8192
    ds_read_b64_tr_b16 a[74:75], v20 offset:9216
    v_mfma_f32_16x16x32_bf16 v[192:195], a[68:71], a[32:35], v[192:195]
    ds_read_b64_tr_b16 a[76:77], v21 offset:8192
    ds_read_b64_tr_b16 a[78:79], v21 offset:9216
    v_mfma_f32_16x16x32_bf16 v[196:199], a[68:71], a[36:39], v[196:199]
    v_mul_f32 v39, v39, v55
    v_cvt_pk_bf16_f32 v24, v38, v39
    v_mfma_f32_16x16x32_bf16 v[100:103], a[64:67], a[36:39], v[100:103]
    v_sub_f32 v40, v40, v54
    v_sub_f32 v41, v41, v54
    v_mfma_f32_16x16x32_bf16 v[104:107], a[64:67], a[40:43], v[104:107]
    v_cvt_pk_bf16_f32 v56, v40, v41
    v_lshlrev_b32 v40, 16, v56
    v_mfma_f32_16x16x32_bf16 v[200:203], a[68:71], a[40:43], v[200:203]
    s_waitcnt vmcnt(2) lgkmcnt(0)
    v_and_b32 v41, 0xffff0000, v56
    v_mul_f32 v40, v40, v55
    v_mfma_f32_16x16x32_bf16 v[204:207], a[68:71], a[44:47], v[204:207]
    s_barrier
    v_mul_f32 v41, v41, v55
    v_cvt_pk_bf16_f32 v25, v40, v41
    v_mfma_f32_16x16x32_bf16 v[108:111], a[64:67], a[44:47], v[108:111]
    s_add_u32 m0, s92, 0
    ds_read_b128 a[0:3], v16 offset:32768
    ds_read_b128 a[4:7], v16 offset:34816
    v_mfma_f32_16x16x32_bf16 v[112:115], a[64:67], a[48:51], v[112:115]
    s_mov_b32 s94, 256
    v_mov_b32 v5, 1
    v_sub_f32 v42, v42, v54
    v_mfma_f32_16x16x32_bf16 v[208:211], a[68:71], a[48:51], v[208:211]
    ds_read_b128 a[8:11], v16 offset:36864
    ds_read_b128 a[12:15], v16 offset:38912
    v_mfma_f32_16x16x32_bf16 v[212:215], a[68:71], a[52:55], v[212:215]
    buffer_store_dword v5, v0, s[80:83], 0 offen sc1
    v_mfma_f32_16x16x32_bf16 v[116:119], a[64:67], a[52:55], v[116:119]
    s_mov_b32 s82, 4
    ds_read_b128 a[16:19], v16 offset:40960
    ds_read_b128 a[20:23], v16 offset:43008
    v_mfma_f32_16x16x32_bf16 v[120:123], a[64:67], a[56:59], v[120:123]
    buffer_load_dwordx4 v8, s[36:39], s94 offen offset:0 lds
    v_mfma_f32_16x16x32_bf16 v[216:219], a[68:71], a[56:59], v[216:219]
    ds_read_b128 a[24:27], v16 offset:45056
    ds_read_b128 a[28:31], v16 offset:47104
    v_mfma_f32_16x16x32_bf16 v[220:223], a[68:71], a[60:63], v[220:223]
    v_sub_f32 v43, v43, v54
    v_cvt_pk_bf16_f32 v56, v42, v43
    v_mfma_f32_16x16x32_bf16 v[124:127], a[64:67], a[60:63], v[124:127]
    v_lshlrev_b32 v42, 16, v56
    v_and_b32 v43, 0xffff0000, v56
    v_mfma_f32_16x16x32_bf16 v[156:159], a[72:75], a[60:63], v[156:159]
    ds_read_b64_tr_b16 a[64:65], v18 offset:49152
    ds_read_b64_tr_b16 a[66:67], v18 offset:50176
    v_mfma_f32_16x16x32_bf16 v[252:255], a[76:79], a[60:63], v[252:255]
    ds_read_b64_tr_b16 a[68:69], v19 offset:49152
    ds_read_b64_tr_b16 a[70:71], v19 offset:50176
    v_mfma_f32_16x16x32_bf16 v[248:251], a[76:79], a[56:59], v[248:251]
    buffer_load_dwordx4 v9, s[36:39], s94 offen offset:1024 lds
    v_mfma_f32_16x16x32_bf16 v[152:155], a[72:75], a[56:59], v[152:155]
    v_mul_f32 v42, v42, v55
    v_mul_f32 v43, v43, v55
    v_mfma_f32_16x16x32_bf16 v[148:151], a[72:75], a[52:55], v[148:151]
    v_cvt_pk_bf16_f32 v26, v42, v43
    v_sub_f32 v44, v44, v54
    v_mfma_f32_16x16x32_bf16 v[244:247], a[76:79], a[52:55], v[244:247]
    v_sub_f32 v45, v45, v54
    v_cvt_pk_bf16_f32 v56, v44, v45
    v_mfma_f32_16x16x32_bf16 v[240:243], a[76:79], a[48:51], v[240:243]
    buffer_load_dwordx4 v10, s[36:39], s94 offen offset:2048 lds
    v_mfma_f32_16x16x32_bf16 v[144:147], a[72:75], a[48:51], v[144:147]
    v_lshlrev_b32 v44, 16, v56
    v_and_b32 v45, 0xffff0000, v56
    v_mfma_f32_16x16x32_bf16 v[140:143], a[72:75], a[44:47], v[140:143]
    v_mul_f32 v44, v44, v55
    v_mul_f32 v45, v45, v55
    v_mfma_f32_16x16x32_bf16 v[236:239], a[76:79], a[44:47], v[236:239]
    v_cvt_pk_bf16_f32 v27, v44, v45
    v_sub_f32 v46, v46, v54
    v_mfma_f32_16x16x32_bf16 v[232:235], a[76:79], a[40:43], v[232:235]
    buffer_load_dwordx4 v11, s[36:39], s94 offen offset:3072 lds
    v_mfma_f32_16x16x32_bf16 v[136:139], a[72:75], a[40:43], v[136:139]
    s_add_u32 m0, s92, 65536
    v_sub_f32 v47, v47, v54
    v_cvt_pk_bf16_f32 v56, v46, v47
    v_mfma_f32_16x16x32_bf16 v[132:135], a[72:75], a[36:39], v[132:135]
    s_mov_b32 s95, 1048576
    v_lshlrev_b32 v46, 16, v56
    v_and_b32 v47, 0xffff0000, v56
    v_mfma_f32_16x16x32_bf16 v[228:231], a[76:79], a[36:39], v[228:231]
    v_mul_f32 v46, v46, v55
    v_mul_f32 v47, v47, v55
    v_mfma_f32_16x16x32_bf16 v[224:227], a[76:79], a[32:35], v[224:227]
    buffer_load_dwordx4 v12, s[40:43], s95 offen offset:0 lds
    v_mfma_f32_16x16x32_bf16 v[128:131], a[72:75], a[32:35], v[128:131]
    s_waitcnt lgkmcnt(0)
    v_cvt_pk_bf16_f32 v28, v46, v47
    v_sub_f32 v48, v48, v54
    v_mfma_f32_16x16x32_bf16 a[96:99], a[0:3], a[64:67], a[96:99]
    ds_read_b64_tr_b16 a[72:73], v20 offset:49152
    ds_read_b64_tr_b16 a[74:75], v20 offset:50176
    v_mfma_f32_16x16x32_bf16 a[128:131], a[0:3], a[68:71], a[128:131]
    ds_read_b64_tr_b16 a[76:77], v21 offset:49152
    ds_read_b64_tr_b16 a[78:79], v21 offset:50176
    v_mfma_f32_16x16x32_bf16 a[132:135], a[4:7], a[68:71], a[132:135]
    buffer_load_dwordx4 v13, s[40:43], s95 offen offset:1024 lds
    v_mfma_f32_16x16x32_bf16 a[100:103], a[4:7], a[64:67], a[100:103]
    v_sub_f32 v49, v49, v54
    v_cvt_pk_bf16_f32 v56, v48, v49
    v_mfma_f32_16x16x32_bf16 a[104:107], a[8:11], a[64:67], a[104:107]
    ds_read_b128 a[32:35], v17 offset:32768
    ds_read_b128 a[36:39], v17 offset:34816
    v_mfma_f32_16x16x32_bf16 a[136:139], a[8:11], a[68:71], a[136:139]
    v_lshlrev_b32 v48, 16, v56
    v_and_b32 v49, 0xffff0000, v56
    v_mfma_f32_16x16x32_bf16 a[140:143], a[12:15], a[68:71], a[140:143]
    buffer_load_dwordx4 v14, s[40:43], s95 offen offset:2048 lds
    v_mfma_f32_16x16x32_bf16 a[108:111], a[12:15], a[64:67], a[108:111]
    v_mul_f32 v48, v48, v55
    v_mul_f32 v49, v49, v55
    v_mfma_f32_16x16x32_bf16 a[112:115], a[16:19], a[64:67], a[112:115]
    v_cvt_pk_bf16_f32 v29, v48, v49
    v_sub_f32 v50, v50, v54
    v_mfma_f32_16x16x32_bf16 a[144:147], a[16:19], a[68:71], a[144:147]
    v_sub_f32 v51, v51, v54
    v_cvt_pk_bf16_f32 v56, v50, v51
    v_mfma_f32_16x16x32_bf16 a[148:151], a[20:23], a[68:71], a[148:151]
    buffer_load_dwordx4 v15, s[40:43], s95 offen offset:3072 lds
    v_mfma_f32_16x16x32_bf16 a[116:119], a[20:23], a[64:67], a[116:119]
    s_add_u32 m0, s92, 4096
    v_lshlrev_b32 v50, 16, v56
    v_and_b32 v51, 0xffff0000, v56
    v_mfma_f32_16x16x32_bf16 a[120:123], a[24:27], a[64:67], a[120:123]
    s_mov_b32 s94, 33024
    ds_read_b128 a[40:43], v17 offset:36864
    ds_read_b128 a[44:47], v17 offset:38912
    v_mfma_f32_16x16x32_bf16 a[152:155], a[24:27], a[68:71], a[152:155]
    v_mul_f32 v50, v50, v55
    v_mul_f32 v51, v51, v55
    v_mfma_f32_16x16x32_bf16 a[156:159], a[28:31], a[68:71], a[156:159]
    buffer_load_dwordx4 v8, s[36:39], s94 offen offset:0 lds
    v_mfma_f32_16x16x32_bf16 a[124:127], a[28:31], a[64:67], a[124:127]
    s_waitcnt lgkmcnt(2)
    v_cvt_pk_bf16_f32 v30, v50, v51
    v_sub_f32 v52, v52, v54
    v_mfma_f32_16x16x32_bf16 v[172:175], a[28:31], a[72:75], v[172:175]
    ds_read_b64_tr_b16 a[64:65], v18 offset:32768
    ds_read_b64_tr_b16 a[66:67], v18 offset:33792
    v_mfma_f32_16x16x32_bf16 v[188:191], a[28:31], a[76:79], v[188:191]
    ds_read_b64_tr_b16 a[68:69], v19 offset:32768
    ds_read_b64_tr_b16 a[70:71], v19 offset:33792
    v_mfma_f32_16x16x32_bf16 v[92:95], a[24:27], a[76:79], v[92:95]
    buffer_load_dwordx4 v9, s[36:39], s94 offen offset:1024 lds
    v_mfma_f32_16x16x32_bf16 v[76:79], a[24:27], a[72:75], v[76:79]
    v_sub_f32 v53, v53, v54
    v_cvt_pk_bf16_f32 v56, v52, v53
    v_mfma_f32_16x16x32_bf16 v[168:171], a[20:23], a[72:75], v[168:171]
    ds_read_b128 a[48:51], v17 offset:40960
    ds_read_b128 a[52:55], v17 offset:43008
    v_mfma_f32_16x16x32_bf16 v[184:187], a[20:23], a[76:79], v[184:187]
    v_lshlrev_b32 v52, 16, v56
    v_and_b32 v53, 0xffff0000, v56
    v_mfma_f32_16x16x32_bf16 v[88:91], a[16:19], a[76:79], v[88:91]
    buffer_load_dwordx4 v10, s[36:39], s94 offen offset:2048 lds
    v_mfma_f32_16x16x32_bf16 v[72:75], a[16:19], a[72:75], v[72:75]
    v_mul_f32 v52, v52, v55
    v_mul_f32 v53, v53, v55
    v_mfma_f32_16x16x32_bf16 v[164:167], a[12:15], a[72:75], v[164:167]
    v_cvt_pk_bf16_f32 v31, v52, v53
    v_mfma_f32_16x16x32_bf16 v[180:183], a[12:15], a[76:79], v[180:183]
    ds_write_b64 v57, v[22:23] offset:0
    ds_write_b64 v57, v[24:25] offset:256
    v_mfma_f32_16x16x32_bf16 v[84:87], a[8:11], a[76:79], v[84:87]
    buffer_load_dwordx4 v11, s[36:39], s94 offen offset:3072 lds
    v_mfma_f32_16x16x32_bf16 v[68:71], a[8:11], a[72:75], v[68:71]
    s_add_u32 m0, s92, 69632
    ds_write_b64 v57, v[26:27] offset:512
    ds_write_b64 v57, v[28:29] offset:768
    v_mfma_f32_16x16x32_bf16 v[160:163], a[4:7], a[72:75], v[160:163]
    s_mov_b32 s95, 1179648
    ds_read_b128 a[56:59], v17 offset:45056
    ds_read_b128 a[60:63], v17 offset:47104
    v_mfma_f32_16x16x32_bf16 v[176:179], a[4:7], a[76:79], v[176:179]
    ds_write_b64 v57, v[30:31] offset:1024
    v_mfma_f32_16x16x32_bf16 v[80:83], a[0:3], a[76:79], v[80:83]
    buffer_load_dwordx4 v12, s[40:43], s95 offen offset:0 lds
    v_mfma_f32_16x16x32_bf16 v[64:67], a[0:3], a[72:75], v[64:67]
    s_waitcnt lgkmcnt(7)
    v_mfma_f32_16x16x32_bf16 v[96:99], a[64:67], a[0:3], v[96:99]
    ds_read_b64_tr_b16 a[72:73], v20 offset:32768
    ds_read_b64_tr_b16 a[74:75], v20 offset:33792
    v_mfma_f32_16x16x32_bf16 v[192:195], a[68:71], a[0:3], v[192:195]
    ds_read_b64_tr_b16 a[76:77], v21 offset:32768
    ds_read_b64_tr_b16 a[78:79], v21 offset:33792
    v_mfma_f32_16x16x32_bf16 v[196:199], a[68:71], a[4:7], v[196:199]
    buffer_load_dwordx4 v13, s[40:43], s95 offen offset:1024 lds
    v_mfma_f32_16x16x32_bf16 v[100:103], a[64:67], a[4:7], v[100:103]
    v_mfma_f32_16x16x32_bf16 v[104:107], a[64:67], a[8:11], v[104:107]
    v_mfma_f32_16x16x32_bf16 v[200:203], a[68:71], a[8:11], v[200:203]
    v_mfma_f32_16x16x32_bf16 v[204:207], a[68:71], a[12:15], v[204:207]
    buffer_load_dwordx4 v14, s[40:43], s95 offen offset:2048 lds
    v_mfma_f32_16x16x32_bf16 v[108:111], a[64:67], a[12:15], v[108:111]
    v_mfma_f32_16x16x32_bf16 v[112:115], a[64:67], a[16:19], v[112:115]
    v_mfma_f32_16x16x32_bf16 v[208:211], a[68:71], a[16:19], v[208:211]
    v_mfma_f32_16x16x32_bf16 v[212:215], a[68:71], a[20:23], v[212:215]
    buffer_load_dwordx4 v15, s[40:43], s95 offen offset:3072 lds
    v_mfma_f32_16x16x32_bf16 v[116:119], a[64:67], a[20:23], v[116:119]
    v_mfma_f32_16x16x32_bf16 v[120:123], a[64:67], a[24:27], v[120:123]
    v_mfma_f32_16x16x32_bf16 v[216:219], a[68:71], a[24:27], v[216:219]
    v_mfma_f32_16x16x32_bf16 v[220:223], a[68:71], a[28:31], v[220:223]
    v_mfma_f32_16x16x32_bf16 v[124:127], a[64:67], a[28:31], v[124:127]
    s_waitcnt lgkmcnt(0)
    v_mfma_f32_16x16x32_bf16 v[156:159], a[72:75], a[28:31], v[156:159]
    ds_read_b64_tr_b16 a[64:65], v18 offset:57344
    ds_read_b64_tr_b16 a[66:67], v18 offset:58368
    v_mfma_f32_16x16x32_bf16 v[252:255], a[76:79], a[28:31], v[252:255]
    ds_read_b64_tr_b16 a[68:69], v19 offset:57344
    ds_read_b64_tr_b16 a[70:71], v19 offset:58368
    v_mfma_f32_16x16x32_bf16 v[248:251], a[76:79], a[24:27], v[248:251]
    v_mfma_f32_16x16x32_bf16 v[152:155], a[72:75], a[24:27], v[152:155]
    v_mfma_f32_16x16x32_bf16 v[148:151], a[72:75], a[20:23], v[148:151]
    v_mfma_f32_16x16x32_bf16 v[244:247], a[76:79], a[20:23], v[244:247]
    v_mfma_f32_16x16x32_bf16 v[240:243], a[76:79], a[16:19], v[240:243]
    v_mfma_f32_16x16x32_bf16 v[144:147], a[72:75], a[16:19], v[144:147]
    v_mfma_f32_16x16x32_bf16 v[140:143], a[72:75], a[12:15], v[140:143]
    v_mfma_f32_16x16x32_bf16 v[236:239], a[76:79], a[12:15], v[236:239]
    v_mfma_f32_16x16x32_bf16 v[232:235], a[76:79], a[8:11], v[232:235]
    v_mfma_f32_16x16x32_bf16 v[136:139], a[72:75], a[8:11], v[136:139]
    v_mfma_f32_16x16x32_bf16 v[132:135], a[72:75], a[4:7], v[132:135]
    v_mfma_f32_16x16x32_bf16 v[228:231], a[76:79], a[4:7], v[228:231]
    v_mfma_f32_16x16x32_bf16 v[224:227], a[76:79], a[0:3], v[224:227]
    v_mfma_f32_16x16x32_bf16 v[128:131], a[72:75], a[0:3], v[128:131]
    s_waitcnt lgkmcnt(0)
    v_mfma_f32_16x16x32_bf16 a[96:99], a[32:35], a[64:67], a[96:99]
    ds_read_b64_tr_b16 a[72:73], v20 offset:57344
    ds_read_b64_tr_b16 a[74:75], v20 offset:58368
    v_mfma_f32_16x16x32_bf16 a[128:131], a[32:35], a[68:71], a[128:131]
    ds_read_b64_tr_b16 a[76:77], v21 offset:57344
    ds_read_b64_tr_b16 a[78:79], v21 offset:58368
    v_mfma_f32_16x16x32_bf16 a[132:135], a[36:39], a[68:71], a[132:135]
    v_mfma_f32_16x16x32_bf16 a[100:103], a[36:39], a[64:67], a[100:103]
    v_mfma_f32_16x16x32_bf16 a[104:107], a[40:43], a[64:67], a[104:107]
    v_mfma_f32_16x16x32_bf16 a[136:139], a[40:43], a[68:71], a[136:139]
    v_mfma_f32_16x16x32_bf16 a[140:143], a[44:47], a[68:71], a[140:143]
    v_mfma_f32_16x16x32_bf16 a[108:111], a[44:47], a[64:67], a[108:111]
    v_mfma_f32_16x16x32_bf16 a[112:115], a[48:51], a[64:67], a[112:115]
    v_mfma_f32_16x16x32_bf16 a[144:147], a[48:51], a[68:71], a[144:147]
    v_mfma_f32_16x16x32_bf16 a[148:151], a[52:55], a[68:71], a[148:151]
    v_mfma_f32_16x16x32_bf16 a[116:119], a[52:55], a[64:67], a[116:119]
    v_mfma_f32_16x16x32_bf16 a[120:123], a[56:59], a[64:67], a[120:123]
    v_mfma_f32_16x16x32_bf16 a[152:155], a[56:59], a[68:71], a[152:155]
    v_mfma_f32_16x16x32_bf16 a[156:159], a[60:63], a[68:71], a[156:159]
    v_mfma_f32_16x16x32_bf16 a[124:127], a[60:63], a[64:67], a[124:127]
    s_waitcnt lgkmcnt(0)
    v_mfma_f32_16x16x32_bf16 v[172:175], a[60:63], a[72:75], v[172:175]
    ds_read_b64_tr_b16 a[64:65], v18 offset:40960
    ds_read_b64_tr_b16 a[66:67], v18 offset:41984
    v_mfma_f32_16x16x32_bf16 v[188:191], a[60:63], a[76:79], v[188:191]
    ds_read_b64_tr_b16 a[68:69], v19 offset:40960
    ds_read_b64_tr_b16 a[70:71], v19 offset:41984
    v_mfma_f32_16x16x32_bf16 v[92:95], a[56:59], a[76:79], v[92:95]
    v_mfma_f32_16x16x32_bf16 v[76:79], a[56:59], a[72:75], v[76:79]
    v_mfma_f32_16x16x32_bf16 v[168:171], a[52:55], a[72:75], v[168:171]
    v_mfma_f32_16x16x32_bf16 v[184:187], a[52:55], a[76:79], v[184:187]
    v_mfma_f32_16x16x32_bf16 v[88:91], a[48:51], a[76:79], v[88:91]
    v_mfma_f32_16x16x32_bf16 v[72:75], a[48:51], a[72:75], v[72:75]
    v_mfma_f32_16x16x32_bf16 v[164:167], a[44:47], a[72:75], v[164:167]
    v_mfma_f32_16x16x32_bf16 v[180:183], a[44:47], a[76:79], v[180:183]
    v_mfma_f32_16x16x32_bf16 v[84:87], a[40:43], a[76:79], v[84:87]
    v_mfma_f32_16x16x32_bf16 v[68:71], a[40:43], a[72:75], v[68:71]
    v_mfma_f32_16x16x32_bf16 v[160:163], a[36:39], a[72:75], v[160:163]
    v_mfma_f32_16x16x32_bf16 v[176:179], a[36:39], a[76:79], v[176:179]
    v_mfma_f32_16x16x32_bf16 v[80:83], a[32:35], a[76:79], v[80:83]
    v_mfma_f32_16x16x32_bf16 v[64:67], a[32:35], a[72:75], v[64:67]
    s_waitcnt lgkmcnt(0)
    v_mfma_f32_16x16x32_bf16 v[96:99], a[64:67], a[32:35], v[96:99]
    ds_read_b64_tr_b16 a[72:73], v20 offset:40960
    ds_read_b64_tr_b16 a[74:75], v20 offset:41984
    v_mfma_f32_16x16x32_bf16 v[192:195], a[68:71], a[32:35], v[192:195]
    ds_read_b64_tr_b16 a[76:77], v21 offset:40960
    ds_read_b64_tr_b16 a[78:79], v21 offset:41984
    v_mfma_f32_16x16x32_bf16 v[196:199], a[68:71], a[36:39], v[196:199]
    v_mfma_f32_16x16x32_bf16 v[100:103], a[64:67], a[36:39], v[100:103]
    v_mfma_f32_16x16x32_bf16 v[104:107], a[64:67], a[40:43], v[104:107]
    v_mfma_f32_16x16x32_bf16 v[200:203], a[68:71], a[40:43], v[200:203]
    s_waitcnt vmcnt(0) lgkmcnt(0)
    v_mfma_f32_16x16x32_bf16 v[204:207], a[68:71], a[44:47], v[204:207]
    s_barrier
    v_mfma_f32_16x16x32_bf16 v[108:111], a[64:67], a[44:47], v[108:111]
    s_add_u32 m0, s92, 32768
    ds_read_b128 a[0:3], v16 offset:0
    ds_read_b128 a[4:7], v16 offset:2048
    v_mfma_f32_16x16x32_bf16 v[112:115], a[64:67], a[48:51], v[112:115]
    s_mov_b32 s94, 384
    ds_read_b128 v[34:37], v58 offset:0
    ds_read_b128 v[38:41], v58 offset:512
    v_mfma_f32_16x16x32_bf16 v[208:211], a[68:71], a[48:51], v[208:211]
    ds_read_b128 a[8:11], v16 offset:4096
    ds_read_b128 a[12:15], v16 offset:6144
    v_mfma_f32_16x16x32_bf16 v[212:215], a[68:71], a[52:55], v[212:215]
    ds_read_b128 v[42:45], v58 offset:1024
    v_mfma_f32_16x16x32_bf16 v[116:119], a[64:67], a[52:55], v[116:119]
    ds_read_b128 a[16:19], v16 offset:8192
    ds_read_b128 a[20:23], v16 offset:10240
    v_mfma_f32_16x16x32_bf16 v[120:123], a[64:67], a[56:59], v[120:123]
    buffer_load_dwordx4 v8, s[36:39], s94 offen offset:0 lds
    v_mfma_f32_16x16x32_bf16 v[216:219], a[68:71], a[56:59], v[216:219]
    ds_read_b128 a[24:27], v16 offset:12288
    ds_read_b128 a[28:31], v16 offset:14336
    v_mfma_f32_16x16x32_bf16 v[220:223], a[68:71], a[60:63], v[220:223]
    v_mfma_f32_16x16x32_bf16 v[124:127], a[64:67], a[60:63], v[124:127]
    buffer_load_dwordx4 v9, s[36:39], s94 offen offset:1024 lds
    v_mfma_f32_16x16x32_bf16 v[156:159], a[72:75], a[60:63], v[156:159]
    ds_read_b64_tr_b16 a[64:65], v18 offset:16384
    ds_read_b64_tr_b16 a[66:67], v18 offset:17408
    v_mfma_f32_16x16x32_bf16 v[252:255], a[76:79], a[60:63], v[252:255]
    ds_read_b64_tr_b16 a[68:69], v19 offset:16384
    ds_read_b64_tr_b16 a[70:71], v19 offset:17408
    v_mfma_f32_16x16x32_bf16 v[248:251], a[76:79], a[56:59], v[248:251]
    buffer_load_dwordx4 v10, s[36:39], s94 offen offset:2048 lds
    v_mfma_f32_16x16x32_bf16 v[152:155], a[72:75], a[56:59], v[152:155]
    v_mfma_f32_16x16x32_bf16 v[148:151], a[72:75], a[52:55], v[148:151]
    v_mfma_f32_16x16x32_bf16 v[244:247], a[76:79], a[52:55], v[244:247]
    buffer_load_dwordx4 v11, s[36:39], s94 offen offset:3072 lds
    v_mfma_f32_16x16x32_bf16 v[240:243], a[76:79], a[48:51], v[240:243]
    s_add_u32 m0, s92, 98304
    v_mfma_f32_16x16x32_bf16 v[144:147], a[72:75], a[48:51], v[144:147]
    s_mov_b32 s95, 1572864
    v_mfma_f32_16x16x32_bf16 v[140:143], a[72:75], a[44:47], v[140:143]
    buffer_load_dwordx4 v12, s[40:43], s95 offen offset:0 lds
    v_mfma_f32_16x16x32_bf16 v[236:239], a[76:79], a[44:47], v[236:239]
    v_mfma_f32_16x16x32_bf16 v[232:235], a[76:79], a[40:43], v[232:235]
    v_mfma_f32_16x16x32_bf16 v[136:139], a[72:75], a[40:43], v[136:139]
    buffer_load_dwordx4 v13, s[40:43], s95 offen offset:1024 lds
    v_mfma_f32_16x16x32_bf16 v[132:135], a[72:75], a[36:39], v[132:135]
    v_mfma_f32_16x16x32_bf16 v[228:231], a[76:79], a[36:39], v[228:231]
    v_mfma_f32_16x16x32_bf16 v[224:227], a[76:79], a[32:35], v[224:227]
    buffer_load_dwordx4 v14, s[40:43], s95 offen offset:2048 lds
    v_mfma_f32_16x16x32_bf16 v[128:131], a[72:75], a[32:35], v[128:131]
    s_waitcnt lgkmcnt(0)
    v_mfma_f32_16x16x32_bf16 a[96:99], a[0:3], a[64:67], a[96:99]
    ds_read_b64_tr_b16 a[72:73], v20 offset:16384
    ds_read_b64_tr_b16 a[74:75], v20 offset:17408
    v_mfma_f32_16x16x32_bf16 a[128:131], a[0:3], a[68:71], a[128:131]
    ds_read_b64_tr_b16 a[76:77], v21 offset:16384
    ds_read_b64_tr_b16 a[78:79], v21 offset:17408
    v_mfma_f32_16x16x32_bf16 a[132:135], a[4:7], a[68:71], a[132:135]
    buffer_load_dwordx4 v15, s[40:43], s95 offen offset:3072 lds
    v_mfma_f32_16x16x32_bf16 a[100:103], a[4:7], a[64:67], a[100:103]
    s_add_u32 m0, s92, 36864
    v_lshrrev_b32 v27, 1, v1
    v_min_u32 v26, 9, v27
    v_mfma_f32_16x16x32_bf16 a[104:107], a[8:11], a[64:67], a[104:107]
    s_mov_b32 s94, 33152
    ds_read_b128 a[32:35], v17 offset:0
    ds_read_b128 a[36:39], v17 offset:2048
    v_mfma_f32_16x16x32_bf16 a[136:139], a[8:11], a[68:71], a[136:139]
    buffer_load_dwordx4 v8, s[36:39], s94 offen offset:0 lds
    v_mfma_f32_16x16x32_bf16 a[140:143], a[12:15], a[68:71], a[140:143]
    v_mad_u32_u24 v26, s30, 10, v26
    v_and_b32 v28, 1, v1
    v_mfma_f32_16x16x32_bf16 a[108:111], a[12:15], a[64:67], a[108:111]
    v_lshlrev_b32 v28, 7, v28
    v_lshl_add_u32 v26, v26, 13, v28
    v_mfma_f32_16x16x32_bf16 a[112:115], a[16:19], a[64:67], a[112:115]
    buffer_load_dwordx4 v9, s[36:39], s94 offen offset:1024 lds
    v_mfma_f32_16x16x32_bf16 a[144:147], a[16:19], a[68:71], a[144:147]
    v_min_u32 v27, 19, v27
    v_mad_u32_u24 v27, s30, 20, v27
    v_mfma_f32_16x16x32_bf16 a[148:151], a[20:23], a[68:71], a[148:151]
    v_mul_u32_u24 v27, 3456, v27
    v_mfma_f32_16x16x32_bf16 a[116:119], a[20:23], a[64:67], a[116:119]
    buffer_load_dwordx4 v10, s[36:39], s94 offen offset:2048 lds
    v_mfma_f32_16x16x32_bf16 a[120:123], a[24:27], a[64:67], a[120:123]
    ds_read_b128 a[40:43], v17 offset:4096
    ds_read_b128 a[44:47], v17 offset:6144
    v_mfma_f32_16x16x32_bf16 a[152:155], a[24:27], a[68:71], a[152:155]
    v_mfma_f32_16x16x32_bf16 a[156:159], a[28:31], a[68:71], a[156:159]
    s_waitcnt lgkmcnt(2)
    buffer_load_dwordx4 v11, s[36:39], s94 offen offset:3072 lds
    v_mfma_f32_16x16x32_bf16 a[124:127], a[28:31], a[64:67], a[124:127]
    s_add_u32 m0, s92, 102400
    v_mfma_f32_16x16x32_bf16 v[172:175], a[28:31], a[72:75], v[172:175]
    s_mov_b32 s95, 1703936
    ds_read_b64_tr_b16 a[64:65], v18 offset:0
    ds_read_b64_tr_b16 a[66:67], v18 offset:1024
    v_mfma_f32_16x16x32_bf16 v[188:191], a[28:31], a[76:79], v[188:191]
    ds_read_b64_tr_b16 a[68:69], v19 offset:0
    ds_read_b64_tr_b16 a[70:71], v19 offset:1024
    v_mfma_f32_16x16x32_bf16 v[92:95], a[24:27], a[76:79], v[92:95]
    buffer_load_dwordx4 v12, s[40:43], s95 offen offset:0 lds
    v_mfma_f32_16x16x32_bf16 v[76:79], a[24:27], a[72:75], v[76:79]
    v_mfma_f32_16x16x32_bf16 v[168:171], a[20:23], a[72:75], v[168:171]
    ds_read_b128 a[48:51], v17 offset:8192
    ds_read_b128 a[52:55], v17 offset:10240
    v_mfma_f32_16x16x32_bf16 v[184:187], a[20:23], a[76:79], v[184:187]
    buffer_load_dwordx4 v13, s[40:43], s95 offen offset:1024 lds
    v_mfma_f32_16x16x32_bf16 v[88:91], a[16:19], a[76:79], v[88:91]
    v_mfma_f32_16x16x32_bf16 v[72:75], a[16:19], a[72:75], v[72:75]
    v_mfma_f32_16x16x32_bf16 v[164:167], a[12:15], a[72:75], v[164:167]
    buffer_load_dwordx4 v14, s[40:43], s95 offen offset:2048 lds
    v_mfma_f32_16x16x32_bf16 v[180:183], a[12:15], a[76:79], v[180:183]
    v_mfma_f32_16x16x32_bf16 v[84:87], a[8:11], a[76:79], v[84:87]
    v_mfma_f32_16x16x32_bf16 v[68:71], a[8:11], a[72:75], v[68:71]
    buffer_load_dwordx4 v15, s[40:43], s95 offen offset:3072 lds
    v_mfma_f32_16x16x32_bf16 v[160:163], a[4:7], a[72:75], v[160:163]
    s_movk_i32 s96, 0
    ds_read_b128 a[56:59], v17 offset:12288
    ds_read_b128 a[60:63], v17 offset:14336
    v_mfma_f32_16x16x32_bf16 v[176:179], a[4:7], a[76:79], v[176:179]
    buffer_store_dwordx4 v[34:37], v59, s[48:51], s96 offen sc1
    v_mfma_f32_16x16x32_bf16 v[80:83], a[0:3], a[76:79], v[80:83]
    s_waitcnt lgkmcnt(2)
    v_mfma_f32_16x16x32_bf16 v[64:67], a[0:3], a[72:75], v[64:67]
    s_movk_i32 s96, 8192
    buffer_store_dwordx4 v[38:41], v59, s[48:51], s96 offen sc1
    v_mfma_f32_16x16x32_bf16 v[96:99], a[64:67], a[0:3], v[96:99]
    ds_read_b64_tr_b16 a[72:73], v20 offset:0
    ds_read_b64_tr_b16 a[74:75], v20 offset:1024
    v_mfma_f32_16x16x32_bf16 v[192:195], a[68:71], a[0:3], v[192:195]
    s_movk_i32 s96, 16384
    ds_read_b64_tr_b16 a[76:77], v21 offset:0
    ds_read_b64_tr_b16 a[78:79], v21 offset:1024
    v_mfma_f32_16x16x32_bf16 v[196:199], a[68:71], a[4:7], v[196:199]
    buffer_store_dwordx4 v[42:45], v59, s[48:51], s96 offen sc1
    v_mfma_f32_16x16x32_bf16 v[100:103], a[64:67], a[4:7], v[100:103]
    v_mfma_f32_16x16x32_bf16 v[104:107], a[64:67], a[8:11], v[104:107]
    v_mfma_f32_16x16x32_bf16 v[200:203], a[68:71], a[8:11], v[200:203]
    v_mfma_f32_16x16x32_bf16 v[204:207], a[68:71], a[12:15], v[204:207]
    v_mfma_f32_16x16x32_bf16 v[108:111], a[64:67], a[12:15], v[108:111]
    v_mfma_f32_16x16x32_bf16 v[112:115], a[64:67], a[16:19], v[112:115]
    s_and_b32 s33, s30, 1
    v_mfma_f32_16x16x32_bf16 v[208:211], a[68:71], a[16:19], v[208:211]
    s_lshl_b32 s34, s33, 18
    v_mfma_f32_16x16x32_bf16 v[212:215], a[68:71], a[20:23], v[212:215]
    s_lshl_b32 s35, s30, 17
    v_mfma_f32_16x16x32_bf16 v[116:119], a[64:67], a[20:23], v[116:119]
    s_sub_u32 s34, s35, s34
    v_add_u32 v34, s34, v12
    v_add_u32 v35, s34, v13
    v_mfma_f32_16x16x32_bf16 v[120:123], a[64:67], a[24:27], v[120:123]
    v_add_u32 v36, s34, v14
    v_add_u32 v37, s34, v15
    v_mfma_f32_16x16x32_bf16 v[216:219], a[68:71], a[24:27], v[216:219]
    s_mul_i32 s33, s33, 67584
    v_mfma_f32_16x16x32_bf16 v[220:223], a[68:71], a[28:31], v[220:223]
    s_lshr_b32 s34, s30, 1
    v_mfma_f32_16x16x32_bf16 v[124:127], a[64:67], a[28:31], v[124:127]
    s_lshl_b32 s35, s34, 11
    s_waitcnt lgkmcnt(2)
    v_mfma_f32_16x16x32_bf16 v[156:159], a[72:75], a[28:31], v[156:159]
    s_add_u32 s33, s33, s35
    ds_read_b64_tr_b16 a[64:65], v18 offset:24576
    ds_read_b64_tr_b16 a[66:67], v18 offset:25600
    s_waitcnt lgkmcnt(2)
    v_mfma_f32_16x16x32_bf16 v[252:255], a[76:79], a[28:31], v[252:255]
    ds_read_b64_tr_b16 a[68:69], v19 offset:24576
    ds_read_b64_tr_b16 a[70:71], v19 offset:25600
    v_mfma_f32_16x16x32_bf16 v[248:251], a[76:79], a[24:27], v[248:251]
    v_add_u32 v30, s33, v2
    v_add_u32 v31, s35, v30
    v_mfma_f32_16x16x32_bf16 v[152:155], a[72:75], a[24:27], v[152:155]
    v_add_u32 v31, 17408, v31
    v_mov_b32 v32, v2
    v_mfma_f32_16x16x32_bf16 v[148:151], a[72:75], a[20:23], v[148:151]
    s_lshl_b32 s34, s34, 7
    v_xor_b32 v40, s34, v18
    v_xor_b32 v41, 32, v40
    v_mfma_f32_16x16x32_bf16 v[244:247], a[76:79], a[20:23], v[244:247]
    v_xor_b32 v42, 64, v40
    v_xor_b32 v43, 96, v40
    v_mfma_f32_16x16x32_bf16 v[240:243], a[76:79], a[16:19], v[240:243]
    v_xor_b32 v44, 128, v40
    v_xor_b32 v45, 160, v40
    v_mfma_f32_16x16x32_bf16 v[144:147], a[72:75], a[16:19], v[144:147]
    v_xor_b32 v46, 192, v40
    v_xor_b32 v47, 224, v40
    v_mfma_f32_16x16x32_bf16 v[140:143], a[72:75], a[12:15], v[140:143]
    v_xor_b32 v52, 196608, v40
    v_xor_b32 v53, 196640, v40
    v_mfma_f32_16x16x32_bf16 v[236:239], a[76:79], a[12:15], v[236:239]
    v_xor_b32 v54, 196672, v40
    v_xor_b32 v55, 196704, v40
    v_mfma_f32_16x16x32_bf16 v[232:235], a[76:79], a[8:11], v[232:235]
    v_xor_b32 v56, 196736, v40
    v_xor_b32 v57, 196768, v40
    v_mfma_f32_16x16x32_bf16 v[136:139], a[72:75], a[8:11], v[136:139]
    v_xor_b32 v58, 196800, v40
    v_xor_b32 v59, 196832, v40
    v_mfma_f32_16x16x32_bf16 v[132:135], a[72:75], a[4:7], v[132:135]
    v_bfe_u32 v23, v1, 4, 1
    v_lshlrev_b32 v22, 1, v23
    v_mfma_f32_16x16x32_bf16 v[228:231], a[76:79], a[4:7], v[228:231]
    v_and_b32 v24, 7, v1
    v_xor_b32 v24, v24, v22
    v_mfma_f32_16x16x32_bf16 v[224:227], a[76:79], a[0:3], v[224:227]
    s_waitcnt lgkmcnt(0)
    v_lshlrev_b32 v24, 4, v24
    v_lshrrev_b32 v22, 3, v1
    v_mfma_f32_16x16x32_bf16 v[128:131], a[72:75], a[0:3], v[128:131]
    s_lshl_b32 s33, s30, 4
    v_add_u32 v22, s33, v22
    v_mul_u32_u24 v22, 3456, v22
    v_mfma_f32_16x16x32_bf16 a[96:99], a[32:35], a[64:67], a[96:99]
    ds_read_b64_tr_b16 a[72:73], v20 offset:24576
    ds_read_b64_tr_b16 a[74:75], v20 offset:25600
    v_mfma_f32_16x16x32_bf16 a[128:131], a[32:35], a[68:71], a[128:131]
    ds_read_b64_tr_b16 a[76:77], v21 offset:24576
    ds_read_b64_tr_b16 a[78:79], v21 offset:25600
    v_mfma_f32_16x16x32_bf16 a[132:135], a[36:39], a[68:71], a[132:135]
    v_add_u32 v38, v22, v24
    v_xor_b32 v39, 64, v38
    v_mfma_f32_16x16x32_bf16 a[100:103], a[36:39], a[64:67], a[100:103]
    v_add_u32 v39, 26624, v39
    v_bfe_u32 v22, v1, 2, 2
    v_mfma_f32_16x16x32_bf16 a[104:107], a[40:43], a[64:67], a[104:107]
    v_lshl_add_u32 v24, v23, 3, v22
    v_lshlrev_b32 v24, 7, v24
    v_mfma_f32_16x16x32_bf16 a[136:139], a[40:43], a[68:71], a[136:139]
    v_and_b32 v25, 3, v1
    v_lshl_add_u32 v24, v25, 3, v24
    v_mfma_f32_16x16x32_bf16 a[140:143], a[44:47], a[68:71], a[140:143]
    v_lshrrev_b32 v25, 5, v1
    v_lshl_add_u32 v24, v25, 12, v24
    v_mfma_f32_16x16x32_bf16 a[108:111], a[44:47], a[64:67], a[108:111]
    v_lshrrev_b32 v22, 1, v22
    v_lshl_add_u32 v22, v23, 1, v22
    v_mfma_f32_16x16x32_bf16 a[112:115], a[48:51], a[64:67], a[112:115]
    v_lshl_add_u32 v24, v22, 5, v24
    v_xor_b32 v48, 65536, v24
    v_mfma_f32_16x16x32_bf16 a[144:147], a[48:51], a[68:71], a[144:147]
    v_xor_b32 v60, 131072, v24
    v_xor_b32 v49, 65568, v24
    v_mfma_f32_16x16x32_bf16 a[148:151], a[52:55], a[68:71], a[148:151]
    v_xor_b32 v61, 131104, v24
    v_xor_b32 v50, 65600, v24
    v_mfma_f32_16x16x32_bf16 a[116:119], a[52:55], a[64:67], a[116:119]
    v_xor_b32 v62, 131136, v24
    v_xor_b32 v51, 65632, v24
    v_mfma_f32_16x16x32_bf16 a[120:123], a[56:59], a[64:67], a[120:123]
    v_xor_b32 v63, 131168, v24
    v_and_b32 v22, 15, v1
    v_mfma_f32_16x16x32_bf16 a[152:155], a[56:59], a[68:71], a[152:155]
    v_mul_u32_u24 v23, 240, v23
    v_mfma_f32_16x16x32_bf16 a[156:159], a[60:63], a[68:71], a[156:159]
    s_lshl_b32 s33, s32, 4
    v_xor_b32 v23, s33, v23
    v_add_lshl_u32 v3, v22, v23, 7
    v_mfma_f32_16x16x32_bf16 a[124:127], a[60:63], a[64:67], a[124:127]
    s_waitcnt lgkmcnt(0)
    v_mfma_f32_16x16x32_bf16 v[172:175], a[60:63], a[72:75], v[172:175]
    ds_read_b64_tr_b16 a[64:65], v18 offset:8192
    ds_read_b64_tr_b16 a[66:67], v18 offset:9216
    v_mfma_f32_16x16x32_bf16 v[188:191], a[60:63], a[76:79], v[188:191]
    ds_read_b64_tr_b16 a[68:69], v19 offset:8192
    ds_read_b64_tr_b16 a[70:71], v19 offset:9216
    v_mfma_f32_16x16x32_bf16 v[92:95], a[56:59], a[76:79], v[92:95]
    v_mfma_f32_16x16x32_bf16 v[76:79], a[56:59], a[72:75], v[76:79]
    v_mfma_f32_16x16x32_bf16 v[168:171], a[52:55], a[72:75], v[168:171]
    v_mfma_f32_16x16x32_bf16 v[184:187], a[52:55], a[76:79], v[184:187]
    v_mfma_f32_16x16x32_bf16 v[88:91], a[48:51], a[76:79], v[88:91]
    v_mfma_f32_16x16x32_bf16 v[72:75], a[48:51], a[72:75], v[72:75]
    v_mfma_f32_16x16x32_bf16 v[164:167], a[44:47], a[72:75], v[164:167]
    v_mfma_f32_16x16x32_bf16 v[180:183], a[44:47], a[76:79], v[180:183]
    v_mfma_f32_16x16x32_bf16 v[84:87], a[40:43], a[76:79], v[84:87]
    v_mfma_f32_16x16x32_bf16 v[68:71], a[40:43], a[72:75], v[68:71]
    v_mfma_f32_16x16x32_bf16 v[160:163], a[36:39], a[72:75], v[160:163]
    v_mfma_f32_16x16x32_bf16 v[176:179], a[36:39], a[76:79], v[176:179]
    v_mfma_f32_16x16x32_bf16 v[80:83], a[32:35], a[76:79], v[80:83]
    v_mfma_f32_16x16x32_bf16 v[64:67], a[32:35], a[72:75], v[64:67]
    s_waitcnt lgkmcnt(0)
    v_mfma_f32_16x16x32_bf16 v[96:99], a[64:67], a[32:35], v[96:99]
    ds_read_b64_tr_b16 a[72:73], v20 offset:8192
    ds_read_b64_tr_b16 a[74:75], v20 offset:9216
    v_mfma_f32_16x16x32_bf16 v[192:195], a[68:71], a[32:35], v[192:195]
    ds_read_b64_tr_b16 a[76:77], v21 offset:8192
    ds_read_b64_tr_b16 a[78:79], v21 offset:9216
    v_mfma_f32_16x16x32_bf16 v[196:199], a[68:71], a[36:39], v[196:199]
    v_mfma_f32_16x16x32_bf16 v[100:103], a[64:67], a[36:39], v[100:103]
    v_mfma_f32_16x16x32_bf16 v[104:107], a[64:67], a[40:43], v[104:107]
    v_mfma_f32_16x16x32_bf16 v[200:203], a[68:71], a[40:43], v[200:203]
    s_waitcnt vmcnt(3) lgkmcnt(0)
    v_mfma_f32_16x16x32_bf16 v[204:207], a[68:71], a[44:47], v[204:207]
    s_barrier
    v_mfma_f32_16x16x32_bf16 v[108:111], a[64:67], a[44:47], v[108:111]
    s_add_u32 m0, s92, 0
    ds_read_b128 a[0:3], v16 offset:32768
    ds_read_b128 a[4:7], v16 offset:34816
    v_mfma_f32_16x16x32_bf16 v[112:115], a[64:67], a[48:51], v[112:115]
    s_mov_b32 s94, 512
    v_mfma_f32_16x16x32_bf16 v[208:211], a[68:71], a[48:51], v[208:211]
    ds_read_b128 a[8:11], v16 offset:36864
    ds_read_b128 a[12:15], v16 offset:38912
    v_mfma_f32_16x16x32_bf16 v[212:215], a[68:71], a[52:55], v[212:215]
    buffer_load_dwordx4 v8, s[36:39], s94 offen offset:0 lds
    v_mfma_f32_16x16x32_bf16 v[116:119], a[64:67], a[52:55], v[116:119]
    ds_read_b128 a[16:19], v16 offset:40960
    ds_read_b128 a[20:23], v16 offset:43008
    v_mfma_f32_16x16x32_bf16 v[120:123], a[64:67], a[56:59], v[120:123]
    v_mfma_f32_16x16x32_bf16 v[216:219], a[68:71], a[56:59], v[216:219]
    ds_read_b128 a[24:27], v16 offset:45056
    ds_read_b128 a[28:31], v16 offset:47104
    v_mfma_f32_16x16x32_bf16 v[220:223], a[68:71], a[60:63], v[220:223]
    buffer_load_dwordx4 v9, s[36:39], s94 offen offset:1024 lds
    v_mfma_f32_16x16x32_bf16 v[124:127], a[64:67], a[60:63], v[124:127]
    v_mfma_f32_16x16x32_bf16 v[156:159], a[72:75], a[60:63], v[156:159]
    ds_read_b64_tr_b16 a[64:65], v18 offset:49152
    ds_read_b64_tr_b16 a[66:67], v18 offset:50176
    v_mfma_f32_16x16x32_bf16 v[252:255], a[76:79], a[60:63], v[252:255]
    ds_read_b64_tr_b16 a[68:69], v19 offset:49152
    ds_read_b64_tr_b16 a[70:71], v19 offset:50176
    v_mfma_f32_16x16x32_bf16 v[248:251], a[76:79], a[56:59], v[248:251]
    buffer_load_dwordx4 v10, s[36:39], s94 offen offset:2048 lds
    v_mfma_f32_16x16x32_bf16 v[152:155], a[72:75], a[56:59], v[152:155]
    v_mfma_f32_16x16x32_bf16 v[148:151], a[72:75], a[52:55], v[148:151]
    v_mfma_f32_16x16x32_bf16 v[244:247], a[76:79], a[52:55], v[244:247]
    buffer_load_dwordx4 v11, s[36:39], s94 offen offset:3072 lds
    v_mfma_f32_16x16x32_bf16 v[240:243], a[76:79], a[48:51], v[240:243]
    s_add_u32 m0, s92, 65536
    v_mfma_f32_16x16x32_bf16 v[144:147], a[72:75], a[48:51], v[144:147]
    s_mov_b32 s95, 2097152
    v_mfma_f32_16x16x32_bf16 v[140:143], a[72:75], a[44:47], v[140:143]
    buffer_load_dwordx4 v12, s[40:43], s95 offen offset:0 lds
    v_mfma_f32_16x16x32_bf16 v[236:239], a[76:79], a[44:47], v[236:239]
    v_mfma_f32_16x16x32_bf16 v[232:235], a[76:79], a[40:43], v[232:235]
    v_mfma_f32_16x16x32_bf16 v[136:139], a[72:75], a[40:43], v[136:139]
    buffer_load_dwordx4 v13, s[40:43], s95 offen offset:1024 lds
    v_mfma_f32_16x16x32_bf16 v[132:135], a[72:75], a[36:39], v[132:135]
    v_mfma_f32_16x16x32_bf16 v[228:231], a[76:79], a[36:39], v[228:231]
    v_mfma_f32_16x16x32_bf16 v[224:227], a[76:79], a[32:35], v[224:227]
    buffer_load_dwordx4 v14, s[40:43], s95 offen offset:2048 lds
    v_mfma_f32_16x16x32_bf16 v[128:131], a[72:75], a[32:35], v[128:131]
    s_waitcnt lgkmcnt(0)
    v_mfma_f32_16x16x32_bf16 a[96:99], a[0:3], a[64:67], a[96:99]
    ds_read_b64_tr_b16 a[72:73], v20 offset:49152
    ds_read_b64_tr_b16 a[74:75], v20 offset:50176
    v_mfma_f32_16x16x32_bf16 a[128:131], a[0:3], a[68:71], a[128:131]
    ds_read_b64_tr_b16 a[76:77], v21 offset:49152
    ds_read_b64_tr_b16 a[78:79], v21 offset:50176
    v_mfma_f32_16x16x32_bf16 a[132:135], a[4:7], a[68:71], a[132:135]
    buffer_load_dwordx4 v15, s[40:43], s95 offen offset:3072 lds
    v_mfma_f32_16x16x32_bf16 a[100:103], a[4:7], a[64:67], a[100:103]
    s_add_u32 m0, s92, 4096
    v_mfma_f32_16x16x32_bf16 a[104:107], a[8:11], a[64:67], a[104:107]
    s_mov_b32 s94, 33280
    ds_read_b128 a[32:35], v17 offset:32768
    ds_read_b128 a[36:39], v17 offset:34816
    v_mfma_f32_16x16x32_bf16 a[136:139], a[8:11], a[68:71], a[136:139]
    buffer_load_dwordx4 v8, s[36:39], s94 offen offset:0 lds
    v_mfma_f32_16x16x32_bf16 a[140:143], a[12:15], a[68:71], a[140:143]
    v_mfma_f32_16x16x32_bf16 a[108:111], a[12:15], a[64:67], a[108:111]
    v_mfma_f32_16x16x32_bf16 a[112:115], a[16:19], a[64:67], a[112:115]
    buffer_load_dwordx4 v9, s[36:39], s94 offen offset:1024 lds
    v_mfma_f32_16x16x32_bf16 a[144:147], a[16:19], a[68:71], a[144:147]
    v_mfma_f32_16x16x32_bf16 a[148:151], a[20:23], a[68:71], a[148:151]
    v_mfma_f32_16x16x32_bf16 a[116:119], a[20:23], a[64:67], a[116:119]
    buffer_load_dwordx4 v10, s[36:39], s94 offen offset:2048 lds
    v_mfma_f32_16x16x32_bf16 a[120:123], a[24:27], a[64:67], a[120:123]
    ds_read_b128 a[40:43], v17 offset:36864
    ds_read_b128 a[44:47], v17 offset:38912
    v_mfma_f32_16x16x32_bf16 a[152:155], a[24:27], a[68:71], a[152:155]
    v_mfma_f32_16x16x32_bf16 a[156:159], a[28:31], a[68:71], a[156:159]
    s_waitcnt lgkmcnt(2)
    buffer_load_dwordx4 v11, s[36:39], s94 offen offset:3072 lds
    v_mfma_f32_16x16x32_bf16 a[124:127], a[28:31], a[64:67], a[124:127]
    s_add_u32 m0, s92, 69632
    v_mfma_f32_16x16x32_bf16 v[172:175], a[28:31], a[72:75], v[172:175]
    s_mov_b32 s95, 2228224
    ds_read_b64_tr_b16 a[64:65], v18 offset:32768
    ds_read_b64_tr_b16 a[66:67], v18 offset:33792
    v_mfma_f32_16x16x32_bf16 v[188:191], a[28:31], a[76:79], v[188:191]
    ds_read_b64_tr_b16 a[68:69], v19 offset:32768
    ds_read_b64_tr_b16 a[70:71], v19 offset:33792
    v_mfma_f32_16x16x32_bf16 v[92:95], a[24:27], a[76:79], v[92:95]
    buffer_load_dwordx4 v12, s[40:43], s95 offen offset:0 lds
    v_mfma_f32_16x16x32_bf16 v[76:79], a[24:27], a[72:75], v[76:79]
    v_mfma_f32_16x16x32_bf16 v[168:171], a[20:23], a[72:75], v[168:171]
    ds_read_b128 a[48:51], v17 offset:40960
    ds_read_b128 a[52:55], v17 offset:43008
    v_mfma_f32_16x16x32_bf16 v[184:187], a[20:23], a[76:79], v[184:187]
    buffer_load_dwordx4 v13, s[40:43], s95 offen offset:1024 lds
    v_mfma_f32_16x16x32_bf16 v[88:91], a[16:19], a[76:79], v[88:91]
    v_mfma_f32_16x16x32_bf16 v[72:75], a[16:19], a[72:75], v[72:75]
    v_mfma_f32_16x16x32_bf16 v[164:167], a[12:15], a[72:75], v[164:167]
    buffer_load_dwordx4 v14, s[40:43], s95 offen offset:2048 lds
    v_mfma_f32_16x16x32_bf16 v[180:183], a[12:15], a[76:79], v[180:183]
    v_mfma_f32_16x16x32_bf16 v[84:87], a[8:11], a[76:79], v[84:87]
    v_mfma_f32_16x16x32_bf16 v[68:71], a[8:11], a[72:75], v[68:71]
    buffer_load_dwordx4 v15, s[40:43], s95 offen offset:3072 lds
    v_mfma_f32_16x16x32_bf16 v[160:163], a[4:7], a[72:75], v[160:163]
    s_mul_i32 s96, s32, 327680
    ds_read_b128 a[56:59], v17 offset:45056
    ds_read_b128 a[60:63], v17 offset:47104
    v_mfma_f32_16x16x32_bf16 v[176:179], a[4:7], a[76:79], v[176:179]
    buffer_load_dword v28, v26, s[60:63], s96 offen
    v_mfma_f32_16x16x32_bf16 v[80:83], a[0:3], a[76:79], v[80:83]
    v_mfma_f32_16x16x32_bf16 v[64:67], a[0:3], a[72:75], v[64:67]
    s_waitcnt lgkmcnt(2)
    v_mfma_f32_16x16x32_bf16 v[96:99], a[64:67], a[0:3], v[96:99]
    ds_read_b64_tr_b16 a[72:73], v20 offset:32768
    ds_read_b64_tr_b16 a[74:75], v20 offset:33792
    v_mfma_f32_16x16x32_bf16 v[192:195], a[68:71], a[0:3], v[192:195]
    ds_read_b64_tr_b16 a[76:77], v21 offset:32768
    ds_read_b64_tr_b16 a[78:79], v21 offset:33792
    v_mfma_f32_16x16x32_bf16 v[196:199], a[68:71], a[4:7], v[196:199]
    buffer_load_dword v6, v0, s[80:83], 0 offen sc1
    v_mfma_f32_16x16x32_bf16 v[100:103], a[64:67], a[4:7], v[100:103]
    v_mfma_f32_16x16x32_bf16 v[104:107], a[64:67], a[8:11], v[104:107]
    v_mfma_f32_16x16x32_bf16 v[200:203], a[68:71], a[8:11], v[200:203]
    v_mfma_f32_16x16x32_bf16 v[204:207], a[68:71], a[12:15], v[204:207]
    v_mfma_f32_16x16x32_bf16 v[108:111], a[64:67], a[12:15], v[108:111]
    v_mfma_f32_16x16x32_bf16 v[112:115], a[64:67], a[16:19], v[112:115]
    v_mfma_f32_16x16x32_bf16 v[208:211], a[68:71], a[16:19], v[208:211]
    v_mfma_f32_16x16x32_bf16 v[212:215], a[68:71], a[20:23], v[212:215]
    v_mfma_f32_16x16x32_bf16 v[116:119], a[64:67], a[20:23], v[116:119]
    v_mfma_f32_16x16x32_bf16 v[120:123], a[64:67], a[24:27], v[120:123]
    v_mfma_f32_16x16x32_bf16 v[216:219], a[68:71], a[24:27], v[216:219]
    v_mfma_f32_16x16x32_bf16 v[220:223], a[68:71], a[28:31], v[220:223]
    v_mfma_f32_16x16x32_bf16 v[124:127], a[64:67], a[28:31], v[124:127]
    s_waitcnt lgkmcnt(0)
    v_mfma_f32_16x16x32_bf16 v[156:159], a[72:75], a[28:31], v[156:159]
    ds_read_b64_tr_b16 a[64:65], v18 offset:57344
    ds_read_b64_tr_b16 a[66:67], v18 offset:58368
    v_mfma_f32_16x16x32_bf16 v[252:255], a[76:79], a[28:31], v[252:255]
    ds_read_b64_tr_b16 a[68:69], v19 offset:57344
    ds_read_b64_tr_b16 a[70:71], v19 offset:58368
    v_mfma_f32_16x16x32_bf16 v[248:251], a[76:79], a[24:27], v[248:251]
    v_mfma_f32_16x16x32_bf16 v[152:155], a[72:75], a[24:27], v[152:155]
    v_mfma_f32_16x16x32_bf16 v[148:151], a[72:75], a[20:23], v[148:151]
    v_mfma_f32_16x16x32_bf16 v[244:247], a[76:79], a[20:23], v[244:247]
    v_mfma_f32_16x16x32_bf16 v[240:243], a[76:79], a[16:19], v[240:243]
    v_mfma_f32_16x16x32_bf16 v[144:147], a[72:75], a[16:19], v[144:147]
    v_mfma_f32_16x16x32_bf16 v[140:143], a[72:75], a[12:15], v[140:143]
    v_mfma_f32_16x16x32_bf16 v[236:239], a[76:79], a[12:15], v[236:239]
    v_mfma_f32_16x16x32_bf16 v[232:235], a[76:79], a[8:11], v[232:235]
    v_mfma_f32_16x16x32_bf16 v[136:139], a[72:75], a[8:11], v[136:139]
    v_mfma_f32_16x16x32_bf16 v[132:135], a[72:75], a[4:7], v[132:135]
    v_mfma_f32_16x16x32_bf16 v[228:231], a[76:79], a[4:7], v[228:231]
    v_mfma_f32_16x16x32_bf16 v[224:227], a[76:79], a[0:3], v[224:227]
    v_mfma_f32_16x16x32_bf16 v[128:131], a[72:75], a[0:3], v[128:131]
    s_waitcnt lgkmcnt(0)
    v_mfma_f32_16x16x32_bf16 a[96:99], a[32:35], a[64:67], a[96:99]
    ds_read_b64_tr_b16 a[72:73], v20 offset:57344
    ds_read_b64_tr_b16 a[74:75], v20 offset:58368
    v_mfma_f32_16x16x32_bf16 a[128:131], a[32:35], a[68:71], a[128:131]
    ds_read_b64_tr_b16 a[76:77], v21 offset:57344
    ds_read_b64_tr_b16 a[78:79], v21 offset:58368
    v_mfma_f32_16x16x32_bf16 a[132:135], a[36:39], a[68:71], a[132:135]
    v_mfma_f32_16x16x32_bf16 a[100:103], a[36:39], a[64:67], a[100:103]
    v_mfma_f32_16x16x32_bf16 a[104:107], a[40:43], a[64:67], a[104:107]
    v_mfma_f32_16x16x32_bf16 a[136:139], a[40:43], a[68:71], a[136:139]
    v_mfma_f32_16x16x32_bf16 a[140:143], a[44:47], a[68:71], a[140:143]
    v_mfma_f32_16x16x32_bf16 a[108:111], a[44:47], a[64:67], a[108:111]
    v_mfma_f32_16x16x32_bf16 a[112:115], a[48:51], a[64:67], a[112:115]
    v_mfma_f32_16x16x32_bf16 a[144:147], a[48:51], a[68:71], a[144:147]
    v_mfma_f32_16x16x32_bf16 a[148:151], a[52:55], a[68:71], a[148:151]
    v_mfma_f32_16x16x32_bf16 a[116:119], a[52:55], a[64:67], a[116:119]
    v_mfma_f32_16x16x32_bf16 a[120:123], a[56:59], a[64:67], a[120:123]
    v_mfma_f32_16x16x32_bf16 a[152:155], a[56:59], a[68:71], a[152:155]
    v_mfma_f32_16x16x32_bf16 a[156:159], a[60:63], a[68:71], a[156:159]
    v_mfma_f32_16x16x32_bf16 a[124:127], a[60:63], a[64:67], a[124:127]
    s_waitcnt lgkmcnt(0)
    v_mfma_f32_16x16x32_bf16 v[172:175], a[60:63], a[72:75], v[172:175]
    ds_read_b64_tr_b16 a[64:65], v18 offset:40960
    ds_read_b64_tr_b16 a[66:67], v18 offset:41984
    v_mfma_f32_16x16x32_bf16 v[188:191], a[60:63], a[76:79], v[188:191]
    ds_read_b64_tr_b16 a[68:69], v19 offset:40960
    ds_read_b64_tr_b16 a[70:71], v19 offset:41984
    v_mfma_f32_16x16x32_bf16 v[92:95], a[56:59], a[76:79], v[92:95]
    v_mfma_f32_16x16x32_bf16 v[76:79], a[56:59], a[72:75], v[76:79]
    v_mfma_f32_16x16x32_bf16 v[168:171], a[52:55], a[72:75], v[168:171]
    v_mfma_f32_16x16x32_bf16 v[184:187], a[52:55], a[76:79], v[184:187]
    v_mfma_f32_16x16x32_bf16 v[88:91], a[48:51], a[76:79], v[88:91]
    v_mfma_f32_16x16x32_bf16 v[72:75], a[48:51], a[72:75], v[72:75]
    v_mfma_f32_16x16x32_bf16 v[164:167], a[44:47], a[72:75], v[164:167]
    v_mfma_f32_16x16x32_bf16 v[180:183], a[44:47], a[76:79], v[180:183]
    v_mfma_f32_16x16x32_bf16 v[84:87], a[40:43], a[76:79], v[84:87]
    v_mfma_f32_16x16x32_bf16 v[68:71], a[40:43], a[72:75], v[68:71]
    v_mfma_f32_16x16x32_bf16 v[160:163], a[36:39], a[72:75], v[160:163]
    v_mfma_f32_16x16x32_bf16 v[176:179], a[36:39], a[76:79], v[176:179]
    v_mfma_f32_16x16x32_bf16 v[80:83], a[32:35], a[76:79], v[80:83]
    v_mfma_f32_16x16x32_bf16 v[64:67], a[32:35], a[72:75], v[64:67]
    s_waitcnt lgkmcnt(0)
    v_mfma_f32_16x16x32_bf16 v[96:99], a[64:67], a[32:35], v[96:99]
    ds_read_b64_tr_b16 a[72:73], v20 offset:40960
    ds_read_b64_tr_b16 a[74:75], v20 offset:41984
    v_mfma_f32_16x16x32_bf16 v[192:195], a[68:71], a[32:35], v[192:195]
    ds_read_b64_tr_b16 a[76:77], v21 offset:40960
    ds_read_b64_tr_b16 a[78:79], v21 offset:41984
    v_mfma_f32_16x16x32_bf16 v[196:199], a[68:71], a[36:39], v[196:199]
    v_mfma_f32_16x16x32_bf16 v[100:103], a[64:67], a[36:39], v[100:103]
    v_mfma_f32_16x16x32_bf16 v[104:107], a[64:67], a[40:43], v[104:107]
    v_mfma_f32_16x16x32_bf16 v[200:203], a[68:71], a[40:43], v[200:203]
    s_waitcnt vmcnt(0) lgkmcnt(0)
    v_mfma_f32_16x16x32_bf16 v[204:207], a[68:71], a[44:47], v[204:207]
    s_barrier
    v_mfma_f32_16x16x32_bf16 v[108:111], a[64:67], a[44:47], v[108:111]
    s_add_u32 m0, s92, 32768
    ds_read_b128 a[0:3], v16 offset:0
    ds_read_b128 a[4:7], v16 offset:2048
    v_mfma_f32_16x16x32_bf16 v[112:115], a[64:67], a[48:51], v[112:115]
    s_mov_b32 s94, 640
    v_cmp_eq_u32 vcc, v0, v6
    v_mfma_f32_16x16x32_bf16 v[208:211], a[68:71], a[48:51], v[208:211]
    s_cbranch_vccnz SP_cnt
SR_cnt:
    ds_read_b128 a[8:11], v16 offset:4096
    ds_read_b128 a[12:15], v16 offset:6144
    v_mfma_f32_16x16x32_bf16 v[212:215], a[68:71], a[52:55], v[212:215]
    buffer_store_dword v5, v0, s[76:79], 0 offen sc1
    v_mfma_f32_16x16x32_bf16 v[116:119], a[64:67], a[52:55], v[116:119]
    ds_read_b128 a[16:19], v16 offset:8192
    ds_read_b128 a[20:23], v16 offset:10240
    v_mfma_f32_16x16x32_bf16 v[120:123], a[64:67], a[56:59], v[120:123]
    buffer_load_dwordx4 v8, s[36:39], s94 offen offset:0 lds
    v_mfma_f32_16x16x32_bf16 v[216:219], a[68:71], a[56:59], v[216:219]
    ds_read_b128 a[24:27], v16 offset:12288
    ds_read_b128 a[28:31], v16 offset:14336
    v_mfma_f32_16x16x32_bf16 v[220:223], a[68:71], a[60:63], v[220:223]
    v_mfma_f32_16x16x32_bf16 v[124:127], a[64:67], a[60:63], v[124:127]
    buffer_load_dwordx4 v9, s[36:39], s94 offen offset:1024 lds
    v_mfma_f32_16x16x32_bf16 v[156:159], a[72:75], a[60:63], v[156:159]
    ds_read_b64_tr_b16 a[64:65], v18 offset:16384
    ds_read_b64_tr_b16 a[66:67], v18 offset:17408
    v_mfma_f32_16x16x32_bf16 v[252:255], a[76:79], a[60:63], v[252:255]
    ds_read_b64_tr_b16 a[68:69], v19 offset:16384
    ds_read_b64_tr_b16 a[70:71], v19 offset:17408
    v_mfma_f32_16x16x32_bf16 v[248:251], a[76:79], a[56:59], v[248:251]
    buffer_load_dwordx4 v10, s[36:39], s94 offen offset:2048 lds
    v_mfma_f32_16x16x32_bf16 v[152:155], a[72:75], a[56:59], v[152:155]
    v_mfma_f32_16x16x32_bf16 v[148:151], a[72:75], a[52:55], v[148:151]
    v_mfma_f32_16x16x32_bf16 v[244:247], a[76:79], a[52:55], v[244:247]
    buffer_load_dwordx4 v11, s[36:39], s94 offen offset:3072 lds
    v_mfma_f32_16x16x32_bf16 v[240:243], a[76:79], a[48:51], v[240:243]
    s_add_u32 m0, s92, 98304
    v_mfma_f32_16x16x32_bf16 v[144:147], a[72:75], a[48:51], v[144:147]
    s_mov_b32 s95, 2621440
    v_mfma_f32_16x16x32_bf16 v[140:143], a[72:75], a[44:47], v[140:143]
    buffer_load_dwordx4 v12, s[40:43], s95 offen offset:0 lds
    v_mfma_f32_16x16x32_bf16 v[236:239], a[76:79], a[44:47], v[236:239]
    v_mfma_f32_16x16x32_bf16 v[232:235], a[76:79], a[40:43], v[232:235]
    v_mfma_f32_16x16x32_bf16 v[136:139], a[72:75], a[40:43], v[136:139]
    buffer_load_dwordx4 v13, s[40:43], s95 offen offset:1024 lds
    v_mfma_f32_16x16x32_bf16 v[132:135], a[72:75], a[36:39], v[132:135]
    v_mfma_f32_16x16x32_bf16 v[228:231], a[76:79], a[36:39], v[228:231]
    v_mfma_f32_16x16x32_bf16 v[224:227], a[76:79], a[32:35], v[224:227]
    buffer_load_dwordx4 v14, s[40:43], s95 offen offset:2048 lds
    v_mfma_f32_16x16x32_bf16 v[128:131], a[72:75], a[32:35], v[128:131]
    s_waitcnt lgkmcnt(0)
    v_mfma_f32_16x16x32_bf16 a[96:99], a[0:3], a[64:67], a[96:99]
    ds_read_b64_tr_b16 a[72:73], v20 offset:16384
    ds_read_b64_tr_b16 a[74:75], v20 offset:17408
    v_mfma_f32_16x16x32_bf16 a[128:131], a[0:3], a[68:71], a[128:131]
    ds_read_b64_tr_b16 a[76:77], v21 offset:16384
    ds_read_b64_tr_b16 a[78:79], v21 offset:17408
    v_mfma_f32_16x16x32_bf16 a[132:135], a[4:7], a[68:71], a[132:135]
    buffer_load_dwordx4 v15, s[40:43], s95 offen offset:3072 lds
    v_mfma_f32_16x16x32_bf16 a[100:103], a[4:7], a[64:67], a[100:103]
    s_add_u32 m0, s92, 36864
    v_mfma_f32_16x16x32_bf16 a[104:107], a[8:11], a[64:67], a[104:107]
    s_mov_b32 s94, 33408
    ds_read_b128 a[32:35], v17 offset:0
    ds_read_b128 a[36:39], v17 offset:2048
    v_mfma_f32_16x16x32_bf16 a[136:139], a[8:11], a[68:71], a[136:139]
    buffer_load_dwordx4 v8, s[36:39], s94 offen offset:0 lds
    v_mfma_f32_16x16x32_bf16 a[140:143], a[12:15], a[68:71], a[140:143]
    v_mfma_f32_16x16x32_bf16 a[108:111], a[12:15], a[64:67], a[108:111]
    v_mfma_f32_16x16x32_bf16 a[112:115], a[16:19], a[64:67], a[112:115]
    buffer_load_dwordx4 v9, s[36:39], s94 offen offset:1024 lds
    v_mfma_f32_16x16x32_bf16 a[144:147], a[16:19], a[68:71], a[144:147]
    v_mfma_f32_16x16x32_bf16 a[148:151], a[20:23], a[68:71], a[148:151]
    v_mfma_f32_16x16x32_bf16 a[116:119], a[20:23], a[64:67], a[116:119]
    buffer_load_dwordx4 v10, s[36:39], s94 offen offset:2048 lds
    v_mfma_f32_16x16x32_bf16 a[120:123], a[24:27], a[64:67], a[120:123]
    ds_read_b128 a[40:43], v17 offset:4096
    ds_read_b128 a[44:47], v17 offset:6144
    v_mfma_f32_16x16x32_bf16 a[152:155], a[24:27], a[68:71], a[152:155]
    v_mfma_f32_16x16x32_bf16 a[156:159], a[28:31], a[68:71], a[156:159]
    s_waitcnt lgkmcnt(2)
    buffer_load_dwordx4 v11, s[36:39], s94 offen offset:3072 lds
    v_mfma_f32_16x16x32_bf16 a[124:127], a[28:31], a[64:67], a[124:127]
    s_add_u32 m0, s92, 102400
    v_mfma_f32_16x16x32_bf16 v[172:175], a[28:31], a[72:75], v[172:175]
    s_mov_b32 s95, 2752512
    ds_read_b64_tr_b16 a[64:65], v18 offset:0
    ds_read_b64_tr_b16 a[66:67], v18 offset:1024
    v_mfma_f32_16x16x32_bf16 v[188:191], a[28:31], a[76:79], v[188:191]
    ds_read_b64_tr_b16 a[68:69], v19 offset:0
    ds_read_b64_tr_b16 a[70:71], v19 offset:1024
    v_mfma_f32_16x16x32_bf16 v[92:95], a[24:27], a[76:79], v[92:95]
    buffer_load_dwordx4 v12, s[40:43], s95 offen offset:0 lds
    v_mfma_f32_16x16x32_bf16 v[76:79], a[24:27], a[72:75], v[76:79]
    v_mfma_f32_16x16x32_bf16 v[168:171], a[20:23], a[72:75], v[168:171]
    ds_read_b128 a[48:51], v17 offset:8192
    ds_read_b128 a[52:55], v17 offset:10240
    v_mfma_f32_16x16x32_bf16 v[184:187], a[20:23], a[76:79], v[184:187]
    buffer_load_dwordx4 v13, s[40:43], s95 offen offset:1024 lds
    v_mfma_f32_16x16x32_bf16 v[88:91], a[16:19], a[76:79], v[88:91]
    v_mfma_f32_16x16x32_bf16 v[72:75], a[16:19], a[72:75], v[72:75]
    v_mfma_f32_16x16x32_bf16 v[164:167], a[12:15], a[72:75], v[164:167]
    buffer_load_dwordx4 v14, s[40:43], s95 offen offset:2048 lds
    v_mfma_f32_16x16x32_bf16 v[180:183], a[12:15], a[76:79], v[180:183]
    v_mfma_f32_16x16x32_bf16 v[84:87], a[8:11], a[76:79], v[84:87]
    v_mfma_f32_16x16x32_bf16 v[68:71], a[8:11], a[72:75], v[68:71]
    buffer_load_dwordx4 v15, s[40:43], s95 offen offset:3072 lds
    v_mfma_f32_16x16x32_bf16 v[160:163], a[4:7], a[72:75], v[160:163]
    s_mul_i32 s96, s32, 276480
    ds_read_b128 a[56:59], v17 offset:12288
    ds_read_b128 a[60:63], v17 offset:14336
    v_mfma_f32_16x16x32_bf16 v[176:179], a[4:7], a[76:79], v[176:179]
    buffer_load_dword v33, v27, s[64:67], s96 offen
    v_mfma_f32_16x16x32_bf16 v[80:83], a[0:3], a[76:79], v[80:83]
    s_mul_i32 s96, s32, 276480
    buffer_load_dword v27, v27, s[68:71], s96 offen offset:2048
    v_mfma_f32_16x16x32_bf16 v[64:67], a[0:3], a[72:75], v[64:67]
    s_waitcnt lgkmcnt(2)
    v_mfma_f32_16x16x32_bf16 v[96:99], a[64:67], a[0:3], v[96:99]
    ds_read_b64_tr_b16 a[72:73], v20 offset:0
    ds_read_b64_tr_b16 a[74:75], v20 offset:1024
    v_mfma_f32_16x16x32_bf16 v[192:195], a[68:71], a[0:3], v[192:195]
    ds_read_b64_tr_b16 a[76:77], v21 offset:0
    ds_read_b64_tr_b16 a[78:79], v21 offset:1024
    v_mfma_f32_16x16x32_bf16 v[196:199], a[68:71], a[4:7], v[196:199]
    v_mfma_f32_16x16x32_bf16 v[100:103], a[64:67], a[4:7], v[100:103]
    v_mfma_f32_16x16x32_bf16 v[104:107], a[64:67], a[8:11], v[104:107]
    v_mfma_f32_16x16x32_bf16 v[200:203], a[68:71], a[8:11], v[200:203]
    v_mfma_f32_16x16x32_bf16 v[204:207], a[68:71], a[12:15], v[204:207]
    v_mfma_f32_16x16x32_bf16 v[108:111], a[64:67], a[12:15], v[108:111]
    v_mfma_f32_16x16x32_bf16 v[112:115], a[64:67], a[16:19], v[112:115]
    v_mfma_f32_16x16x32_bf16 v[208:211], a[68:71], a[16:19], v[208:211]
    v_mfma_f32_16x16x32_bf16 v[212:215], a[68:71], a[20:23], v[212:215]
    v_mfma_f32_16x16x32_bf16 v[116:119], a[64:67], a[20:23], v[116:119]
    v_mfma_f32_16x16x32_bf16 v[120:123], a[64:67], a[24:27], v[120:123]
    v_mfma_f32_16x16x32_bf16 v[216:219], a[68:71], a[24:27], v[216:219]
    v_mfma_f32_16x16x32_bf16 v[220:223], a[68:71], a[28:31], v[220:223]
    v_mfma_f32_16x16x32_bf16 v[124:127], a[64:67], a[28:31], v[124:127]
    s_waitcnt lgkmcnt(0)
    v_mfma_f32_16x16x32_bf16 v[156:159], a[72:75], a[28:31], v[156:159]
    ds_read_b64_tr_b16 a[64:65], v18 offset:24576
    ds_read_b64_tr_b16 a[66:67], v18 offset:25600
    v_mfma_f32_16x16x32_bf16 v[252:255], a[76:79], a[28:31], v[252:255]
    ds_read_b64_tr_b16 a[68:69], v19 offset:24576
    ds_read_b64_tr_b16 a[70:71], v19 offset:25600
    v_mfma_f32_16x16x32_bf16 v[248:251], a[76:79], a[24:27], v[248:251]
    v_mfma_f32_16x16x32_bf16 v[152:155], a[72:75], a[24:27], v[152:155]
    v_mfma_f32_16x16x32_bf16 v[148:151], a[72:75], a[20:23], v[148:151]
    v_mfma_f32_16x16x32_bf16 v[244:247], a[76:79], a[20:23], v[244:247]
    v_mfma_f32_16x16x32_bf16 v[240:243], a[76:79], a[16:19], v[240:243]
    v_mfma_f32_16x16x32_bf16 v[144:147], a[72:75], a[16:19], v[144:147]
    v_mfma_f32_16x16x32_bf16 v[140:143], a[72:75], a[12:15], v[140:143]
    v_mfma_f32_16x16x32_bf16 v[236:239], a[76:79], a[12:15], v[236:239]
    v_mfma_f32_16x16x32_bf16 v[232:235], a[76:79], a[8:11], v[232:235]
    v_mfma_f32_16x16x32_bf16 v[136:139], a[72:75], a[8:11], v[136:139]
    v_mfma_f32_16x16x32_bf16 v[132:135], a[72:75], a[4:7], v[132:135]
    v_mfma_f32_16x16x32_bf16 v[228:231], a[76:79], a[4:7], v[228:231]
    v_mfma_f32_16x16x32_bf16 v[224:227], a[76:79], a[0:3], v[224:227]
    v_mfma_f32_16x16x32_bf16 v[128:131], a[72:75], a[0:3], v[128:131]
    s_waitcnt lgkmcnt(0)
    v_mfma_f32_16x16x32_bf16 a[96:99], a[32:35], a[64:67], a[96:99]
    ds_read_b64_tr_b16 a[72:73], v20 offset:24576
    ds_read_b64_tr_b16 a[74:75], v20 offset:25600
    v_mfma_f32_16x16x32_bf16 a[128:131], a[32:35], a[68:71], a[128:131]
    ds_read_b64_tr_b16 a[76:77], v21 offset:24576
    ds_read_b64_tr_b16 a[78:79], v21 offset:25600
    v_mfma_f32_16x16x32_bf16 a[132:135], a[36:39], a[68:71], a[132:135]
    v_mfma_f32_16x16x32_bf16 a[100:103], a[36:39], a[64:67], a[100:103]
    v_mfma_f32_16x16x32_bf16 a[104:107], a[40:43], a[64:67], a[104:107]
    v_mfma_f32_16x16x32_bf16 a[136:139], a[40:43], a[68:71], a[136:139]
    v_mfma_f32_16x16x32_bf16 a[140:143], a[44:47], a[68:71], a[140:143]
    v_mfma_f32_16x16x32_bf16 a[108:111], a[44:47], a[64:67], a[108:111]
    v_mfma_f32_16x16x32_bf16 a[112:115], a[48:51], a[64:67], a[112:115]
    v_mfma_f32_16x16x32_bf16 a[144:147], a[48:51], a[68:71], a[144:147]
    v_mfma_f32_16x16x32_bf16 a[148:151], a[52:55], a[68:71], a[148:151]
    v_mfma_f32_16x16x32_bf16 a[116:119], a[52:55], a[64:67], a[116:119]
    v_mfma_f32_16x16x32_bf16 a[120:123], a[56:59], a[64:67], a[120:123]
    v_mfma_f32_16x16x32_bf16 a[152:155], a[56:59], a[68:71], a[152:155]
    v_mfma_f32_16x16x32_bf16 a[156:159], a[60:63], a[68:71], a[156:159]
    v_mfma_f32_16x16x32_bf16 a[124:127], a[60:63], a[64:67], a[124:127]
    s_waitcnt lgkmcnt(0)
    v_mfma_f32_16x16x32_bf16 v[172:175], a[60:63], a[72:75], v[172:175]
    ds_read_b64_tr_b16 a[64:65], v18 offset:8192
    ds_read_b64_tr_b16 a[66:67], v18 offset:9216
    v_mfma_f32_16x16x32_bf16 v[188:191], a[60:63], a[76:79], v[188:191]
    ds_read_b64_tr_b16 a[68:69], v19 offset:8192
    ds_read_b64_tr_b16 a[70:71], v19 offset:9216
    v_mfma_f32_16x16x32_bf16 v[92:95], a[56:59], a[76:79], v[92:95]
    v_mfma_f32_16x16x32_bf16 v[76:79], a[56:59], a[72:75], v[76:79]
    v_mfma_f32_16x16x32_bf16 v[168:171], a[52:55], a[72:75], v[168:171]
    v_mfma_f32_16x16x32_bf16 v[184:187], a[52:55], a[76:79], v[184:187]
    v_mfma_f32_16x16x32_bf16 v[88:91], a[48:51], a[76:79], v[88:91]
    v_mfma_f32_16x16x32_bf16 v[72:75], a[48:51], a[72:75], v[72:75]
    v_mfma_f32_16x16x32_bf16 v[164:167], a[44:47], a[72:75], v[164:167]
    v_mfma_f32_16x16x32_bf16 v[180:183], a[44:47], a[76:79], v[180:183]
    v_mfma_f32_16x16x32_bf16 v[84:87], a[40:43], a[76:79], v[84:87]
    v_mfma_f32_16x16x32_bf16 v[68:71], a[40:43], a[72:75], v[68:71]
    v_mfma_f32_16x16x32_bf16 v[160:163], a[36:39], a[72:75], v[160:163]
    v_mfma_f32_16x16x32_bf16 v[176:179], a[36:39], a[76:79], v[176:179]
    v_mfma_f32_16x16x32_bf16 v[80:83], a[32:35], a[76:79], v[80:83]
    v_mfma_f32_16x16x32_bf16 v[64:67], a[32:35], a[72:75], v[64:67]
    s_waitcnt lgkmcnt(0)
    v_mfma_f32_16x16x32_bf16 v[96:99], a[64:67], a[32:35], v[96:99]
    ds_read_b64_tr_b16 a[72:73], v20 offset:8192
    ds_read_b64_tr_b16 a[74:75], v20 offset:9216
    v_mfma_f32_16x16x32_bf16 v[192:195], a[68:71], a[32:35], v[192:195]
    ds_read_b64_tr_b16 a[76:77], v21 offset:8192
    ds_read_b64_tr_b16 a[78:79], v21 offset:9216
    v_mfma_f32_16x16x32_bf16 v[196:199], a[68:71], a[36:39], v[196:199]
    v_mfma_f32_16x16x32_bf16 v[100:103], a[64:67], a[36:39], v[100:103]
    v_mfma_f32_16x16x32_bf16 v[104:107], a[64:67], a[40:43], v[104:107]
    v_mfma_f32_16x16x32_bf16 v[200:203], a[68:71], a[40:43], v[200:203]
    s_waitcnt vmcnt(2) lgkmcnt(0)
    v_mfma_f32_16x16x32_bf16 v[204:207], a[68:71], a[44:47], v[204:207]
    s_barrier
    v_mfma_f32_16x16x32_bf16 v[108:111], a[64:67], a[44:47], v[108:111]
    s_add_u32 m0, s92, 0
    ds_read_b128 a[0:3], v16 offset:32768
    ds_read_b128 a[4:7], v16 offset:34816
    v_mfma_f32_16x16x32_bf16 v[112:115], a[64:67], a[48:51], v[112:115]
    s_mov_b32 s94, 768
    v_mfma_f32_16x16x32_bf16 v[208:211], a[68:71], a[48:51], v[208:211]
    ds_read_b128 a[8:11], v16 offset:36864
    ds_read_b128 a[12:15], v16 offset:38912
    v_mfma_f32_16x16x32_bf16 v[212:215], a[68:71], a[52:55], v[212:215]
    buffer_load_dwordx4 v8, s[36:39], s94 offen offset:0 lds
    v_mfma_f32_16x16x32_bf16 v[116:119], a[64:67], a[52:55], v[116:119]
    ds_read_b128 a[16:19], v16 offset:40960
    ds_read_b128 a[20:23], v16 offset:43008
    v_mfma_f32_16x16x32_bf16 v[120:123], a[64:67], a[56:59], v[120:123]
    v_mfma_f32_16x16x32_bf16 v[216:219], a[68:71], a[56:59], v[216:219]
    ds_read_b128 a[24:27], v16 offset:45056
    ds_read_b128 a[28:31], v16 offset:47104
    v_mfma_f32_16x16x32_bf16 v[220:223], a[68:71], a[60:63], v[220:223]
    buffer_load_dwordx4 v9, s[36:39], s94 offen offset:1024 lds
    v_mfma_f32_16x16x32_bf16 v[124:127], a[64:67], a[60:63], v[124:127]
    v_mfma_f32_16x16x32_bf16 v[156:159], a[72:75], a[60:63], v[156:159]
    ds_read_b64_tr_b16 a[64:65], v18 offset:49152
    ds_read_b64_tr_b16 a[66:67], v18 offset:50176
    v_mfma_f32_16x16x32_bf16 v[252:255], a[76:79], a[60:63], v[252:255]
    ds_read_b64_tr_b16 a[68:69], v19 offset:49152
    ds_read_b64_tr_b16 a[70:71], v19 offset:50176
    v_mfma_f32_16x16x32_bf16 v[248:251], a[76:79], a[56:59], v[248:251]
    buffer_load_dwordx4 v10, s[36:39], s94 offen offset:2048 lds
    v_mfma_f32_16x16x32_bf16 v[152:155], a[72:75], a[56:59], v[152:155]
    v_mfma_f32_16x16x32_bf16 v[148:151], a[72:75], a[52:55], v[148:151]
    v_mfma_f32_16x16x32_bf16 v[244:247], a[76:79], a[52:55], v[244:247]
    buffer_load_dwordx4 v11, s[36:39], s94 offen offset:3072 lds
    v_mfma_f32_16x16x32_bf16 v[240:243], a[76:79], a[48:51], v[240:243]
    s_add_u32 m0, s92, 65536
    v_mfma_f32_16x16x32_bf16 v[144:147], a[72:75], a[48:51], v[144:147]
    s_mov_b32 s95, 3145728
    v_mfma_f32_16x16x32_bf16 v[140:143], a[72:75], a[44:47], v[140:143]
    buffer_load_dwordx4 v12, s[40:43], s95 offen offset:0 lds
    v_mfma_f32_16x16x32_bf16 v[236:239], a[76:79], a[44:47], v[236:239]
    v_mfma_f32_16x16x32_bf16 v[232:235], a[76:79], a[40:43], v[232:235]
    v_mfma_f32_16x16x32_bf16 v[136:139], a[72:75], a[40:43], v[136:139]
    buffer_load_dwordx4 v13, s[40:43], s95 offen offset:1024 lds
    v_mfma_f32_16x16x32_bf16 v[132:135], a[72:75], a[36:39], v[132:135]
    v_mfma_f32_16x16x32_bf16 v[228:231], a[76:79], a[36:39], v[228:231]
    v_mfma_f32_16x16x32_bf16 v[224:227], a[76:79], a[32:35], v[224:227]
    buffer_load_dwordx4 v14, s[40:43], s95 offen offset:2048 lds
    v_mfma_f32_16x16x32_bf16 v[128:131], a[72:75], a[32:35], v[128:131]
    s_waitcnt lgkmcnt(0)
    v_mfma_f32_16x16x32_bf16 a[96:99], a[0:3], a[64:67], a[96:99]
    ds_read_b64_tr_b16 a[72:73], v20 offset:49152
    ds_read_b64_tr_b16 a[74:75], v20 offset:50176
    v_mfma_f32_16x16x32_bf16 a[128:131], a[0:3], a[68:71], a[128:131]
    ds_read_b64_tr_b16 a[76:77], v21 offset:49152
    ds_read_b64_tr_b16 a[78:79], v21 offset:50176
    v_mfma_f32_16x16x32_bf16 a[132:135], a[4:7], a[68:71], a[132:135]
    buffer_load_dwordx4 v15, s[40:43], s95 offen offset:3072 lds
    v_mfma_f32_16x16x32_bf16 a[100:103], a[4:7], a[64:67], a[100:103]
    s_add_u32 m0, s92, 4096
    v_mfma_f32_16x16x32_bf16 a[104:107], a[8:11], a[64:67], a[104:107]
    s_mov_b32 s94, 33536
    ds_read_b128 a[32:35], v17 offset:32768
    ds_read_b128 a[36:39], v17 offset:34816
    v_mfma_f32_16x16x32_bf16 a[136:139], a[8:11], a[68:71], a[136:139]
    buffer_load_dwordx4 v8, s[36:39], s94 offen offset:0 lds
    v_mfma_f32_16x16x32_bf16 a[140:143], a[12:15], a[68:71], a[140:143]
    v_mfma_f32_16x16x32_bf16 a[108:111], a[12:15], a[64:67], a[108:111]
    v_mfma_f32_16x16x32_bf16 a[112:115], a[16:19], a[64:67], a[112:115]
    buffer_load_dwordx4 v9, s[36:39], s94 offen offset:1024 lds
    v_mfma_f32_16x16x32_bf16 a[144:147], a[16:19], a[68:71], a[144:147]
    v_mfma_f32_16x16x32_bf16 a[148:151], a[20:23], a[68:71], a[148:151]
    v_mfma_f32_16x16x32_bf16 a[116:119], a[20:23], a[64:67], a[116:119]
    buffer_load_dwordx4 v10, s[36:39], s94 offen offset:2048 lds
    v_mfma_f32_16x16x32_bf16 a[120:123], a[24:27], a[64:67], a[120:123]
    ds_read_b128 a[40:43], v17 offset:36864
    ds_read_b128 a[44:47], v17 offset:38912
    v_mfma_f32_16x16x32_bf16 a[152:155], a[24:27], a[68:71], a[152:155]
    v_mfma_f32_16x16x32_bf16 a[156:159], a[28:31], a[68:71], a[156:159]
    s_waitcnt lgkmcnt(2)
    buffer_load_dwordx4 v11, s[36:39], s94 offen offset:3072 lds
    v_mfma_f32_16x16x32_bf16 a[124:127], a[28:31], a[64:67], a[124:127]
    s_add_u32 m0, s92, 69632
    v_mfma_f32_16x16x32_bf16 v[172:175], a[28:31], a[72:75], v[172:175]
    s_mov_b32 s95, 3276800
    ds_read_b64_tr_b16 a[64:65], v18 offset:32768
    ds_read_b64_tr_b16 a[66:67], v18 offset:33792
    v_mfma_f32_16x16x32_bf16 v[188:191], a[28:31], a[76:79], v[188:191]
    ds_read_b64_tr_b16 a[68:69], v19 offset:32768
    ds_read_b64_tr_b16 a[70:71], v19 offset:33792
    v_mfma_f32_16x16x32_bf16 v[92:95], a[24:27], a[76:79], v[92:95]
    buffer_load_dwordx4 v12, s[40:43], s95 offen offset:0 lds
    v_mfma_f32_16x16x32_bf16 v[76:79], a[24:27], a[72:75], v[76:79]
    v_mfma_f32_16x16x32_bf16 v[168:171], a[20:23], a[72:75], v[168:171]
    ds_read_b128 a[48:51], v17 offset:40960
    ds_read_b128 a[52:55], v17 offset:43008
    v_mfma_f32_16x16x32_bf16 v[184:187], a[20:23], a[76:79], v[184:187]
    buffer_load_dwordx4 v13, s[40:43], s95 offen offset:1024 lds
    v_mfma_f32_16x16x32_bf16 v[88:91], a[16:19], a[76:79], v[88:91]
    v_mfma_f32_16x16x32_bf16 v[72:75], a[16:19], a[72:75], v[72:75]
    v_mfma_f32_16x16x32_bf16 v[164:167], a[12:15], a[72:75], v[164:167]
    buffer_load_dwordx4 v14, s[40:43], s95 offen offset:2048 lds
    v_mfma_f32_16x16x32_bf16 v[180:183], a[12:15], a[76:79], v[180:183]
    v_mfma_f32_16x16x32_bf16 v[84:87], a[8:11], a[76:79], v[84:87]
    v_mfma_f32_16x16x32_bf16 v[68:71], a[8:11], a[72:75], v[68:71]
    buffer_load_dwordx4 v15, s[40:43], s95 offen offset:3072 lds
    v_mfma_f32_16x16x32_bf16 v[160:163], a[4:7], a[72:75], v[160:163]
    s_mul_i32 s96, s32, 327680
    ds_read_b128 a[56:59], v17 offset:45056
    ds_read_b128 a[60:63], v17 offset:47104
    v_mfma_f32_16x16x32_bf16 v[176:179], a[4:7], a[76:79], v[176:179]
    s_add_u32 s96, s96, 2621440
    buffer_load_dword v26, v26, s[60:63], s96 offen
    v_mfma_f32_16x16x32_bf16 v[80:83], a[0:3], a[76:79], v[80:83]
    v_mfma_f32_16x16x32_bf16 v[64:67], a[0:3], a[72:75], v[64:67]
    s_waitcnt lgkmcnt(2)
    v_mfma_f32_16x16x32_bf16 v[96:99], a[64:67], a[0:3], v[96:99]
    ds_read_b64_tr_b16 a[72:73], v20 offset:32768
    ds_read_b64_tr_b16 a[74:75], v20 offset:33792
    v_mfma_f32_16x16x32_bf16 v[192:195], a[68:71], a[0:3], v[192:195]
    ds_read_b64_tr_b16 a[76:77], v21 offset:32768
    ds_read_b64_tr_b16 a[78:79], v21 offset:33792
    v_mfma_f32_16x16x32_bf16 v[196:199], a[68:71], a[4:7], v[196:199]
    v_mfma_f32_16x16x32_bf16 v[100:103], a[64:67], a[4:7], v[100:103]
    v_mfma_f32_16x16x32_bf16 v[104:107], a[64:67], a[8:11], v[104:107]
    v_mfma_f32_16x16x32_bf16 v[200:203], a[68:71], a[8:11], v[200:203]
    v_mfma_f32_16x16x32_bf16 v[204:207], a[68:71], a[12:15], v[204:207]
    v_mfma_f32_16x16x32_bf16 v[108:111], a[64:67], a[12:15], v[108:111]
    v_mfma_f32_16x16x32_bf16 v[112:115], a[64:67], a[16:19], v[112:115]
    v_mfma_f32_16x16x32_bf16 v[208:211], a[68:71], a[16:19], v[208:211]
    v_mfma_f32_16x16x32_bf16 v[212:215], a[68:71], a[20:23], v[212:215]
    v_mfma_f32_16x16x32_bf16 v[116:119], a[64:67], a[20:23], v[116:119]
    v_mfma_f32_16x16x32_bf16 v[120:123], a[64:67], a[24:27], v[120:123]
    v_mfma_f32_16x16x32_bf16 v[216:219], a[68:71], a[24:27], v[216:219]
    v_mfma_f32_16x16x32_bf16 v[220:223], a[68:71], a[28:31], v[220:223]
    v_mfma_f32_16x16x32_bf16 v[124:127], a[64:67], a[28:31], v[124:127]
    s_waitcnt lgkmcnt(0)
    v_mfma_f32_16x16x32_bf16 v[156:159], a[72:75], a[28:31], v[156:159]
    ds_read_b64_tr_b16 a[64:65], v18 offset:57344
    ds_read_b64_tr_b16 a[66:67], v18 offset:58368
    v_mfma_f32_16x16x32_bf16 v[252:255], a[76:79], a[28:31], v[252:255]
    ds_read_b64_tr_b16 a[68:69], v19 offset:57344
    ds_read_b64_tr_b16 a[70:71], v19 offset:58368
    v_mfma_f32_16x16x32_bf16 v[248:251], a[76:79], a[24:27], v[248:251]
    s_add_u32 m0, s93, 131072
    v_mfma_f32_16x16x32_bf16 v[152:155], a[72:75], a[24:27], v[152:155]
    s_mov_b32 s94, 0
    v_mfma_f32_16x16x32_bf16 v[148:151], a[72:75], a[20:23], v[148:151]
    buffer_load_dwordx4 v34, s[60:63], s94 offen offset:0 lds
    v_mfma_f32_16x16x32_bf16 v[244:247], a[76:79], a[20:23], v[244:247]
    v_mfma_f32_16x16x32_bf16 v[240:243], a[76:79], a[16:19], v[240:243]
    v_mfma_f32_16x16x32_bf16 v[144:147], a[72:75], a[16:19], v[144:147]
    v_mfma_f32_16x16x32_bf16 v[140:143], a[72:75], a[12:15], v[140:143]
    v_mfma_f32_16x16x32_bf16 v[236:239], a[76:79], a[12:15], v[236:239]
    buffer_load_dwordx4 v35, s[60:63], s94 offen offset:1024 lds
    v_mfma_f32_16x16x32_bf16 v[232:235], a[76:79], a[8:11], v[232:235]
    v_mfma_f32_16x16x32_bf16 v[136:139], a[72:75], a[8:11], v[136:139]
    v_mfma_f32_16x16x32_bf16 v[132:135], a[72:75], a[4:7], v[132:135]
    v_mfma_f32_16x16x32_bf16 v[228:231], a[76:79], a[4:7], v[228:231]
    v_mfma_f32_16x16x32_bf16 v[224:227], a[76:79], a[0:3], v[224:227]
    buffer_load_dwordx4 v36, s[60:63], s94 offen offset:2048 lds
    v_mfma_f32_16x16x32_bf16 v[128:131], a[72:75], a[0:3], v[128:131]
    s_waitcnt lgkmcnt(0)
    v_mfma_f32_16x16x32_bf16 a[96:99], a[32:35], a[64:67], a[96:99]
    ds_read_b64_tr_b16 a[72:73], v20 offset:57344
    ds_read_b64_tr_b16 a[74:75], v20 offset:58368
    v_mfma_f32_16x16x32_bf16 a[128:131], a[32:35], a[68:71], a[128:131]
    ds_read_b64_tr_b16 a[76:77], v21 offset:57344
    ds_read_b64_tr_b16 a[78:79], v21 offset:58368
    v_mfma_f32_16x16x32_bf16 a[132:135], a[36:39], a[68:71], a[132:135]
    v_mfma_f32_16x16x32_bf16 a[100:103], a[36:39], a[64:67], a[100:103]
    buffer_load_dwordx4 v37, s[60:63], s94 offen offset:3072 lds
    v_mfma_f32_16x16x32_bf16 a[104:107], a[40:43], a[64:67], a[104:107]
    s_add_u32 m0, s93, 147456
    v_mfma_f32_16x16x32_bf16 a[136:139], a[40:43], a[68:71], a[136:139]
    s_mov_b32 s95, 0
    v_mfma_f32_16x16x32_bf16 a[140:143], a[44:47], a[68:71], a[140:143]
    v_mfma_f32_16x16x32_bf16 a[108:111], a[44:47], a[64:67], a[108:111]
    v_mfma_f32_16x16x32_bf16 a[112:115], a[48:51], a[64:67], a[112:115]
    buffer_load_dwordx4 v38, s[64:67], s95 offen offset:0 lds
    v_mfma_f32_16x16x32_bf16 a[144:147], a[48:51], a[68:71], a[144:147]
    v_mfma_f32_16x16x32_bf16 a[148:151], a[52:55], a[68:71], a[148:151]
    v_mfma_f32_16x16x32_bf16 a[116:119], a[52:55], a[64:67], a[116:119]
    v_mfma_f32_16x16x32_bf16 a[120:123], a[56:59], a[64:67], a[120:123]
    v_mfma_f32_16x16x32_bf16 a[152:155], a[56:59], a[68:71], a[152:155]
    buffer_load_dwordx4 v39, s[64:67], s95 offen offset:1024 lds
    v_mfma_f32_16x16x32_bf16 a[156:159], a[60:63], a[68:71], a[156:159]
    v_mfma_f32_16x16x32_bf16 a[124:127], a[60:63], a[64:67], a[124:127]
    s_waitcnt lgkmcnt(0)
    v_mfma_f32_16x16x32_bf16 v[172:175], a[60:63], a[72:75], v[172:175]
    ds_read_b64_tr_b16 a[64:65], v18 offset:40960
    ds_read_b64_tr_b16 a[66:67], v18 offset:41984
    v_mfma_f32_16x16x32_bf16 v[188:191], a[60:63], a[76:79], v[188:191]
    ds_read_b64_tr_b16 a[68:69], v19 offset:40960
    ds_read_b64_tr_b16 a[70:71], v19 offset:41984
    v_mfma_f32_16x16x32_bf16 v[92:95], a[56:59], a[76:79], v[92:95]
    buffer_load_dwordx4 v38, s[68:71], s95 offen offset:2048 lds
    v_mfma_f32_16x16x32_bf16 v[76:79], a[56:59], a[72:75], v[76:79]
    v_mfma_f32_16x16x32_bf16 v[168:171], a[52:55], a[72:75], v[168:171]
    v_mfma_f32_16x16x32_bf16 v[184:187], a[52:55], a[76:79], v[184:187]
    v_mfma_f32_16x16x32_bf16 v[88:91], a[48:51], a[76:79], v[88:91]
    v_mfma_f32_16x16x32_bf16 v[72:75], a[48:51], a[72:75], v[72:75]
    buffer_load_dwordx4 v39, s[68:71], s95 offen offset:3072 lds
    v_mfma_f32_16x16x32_bf16 v[164:167], a[44:47], a[72:75], v[164:167]
    v_mfma_f32_16x16x32_bf16 v[180:183], a[44:47], a[76:79], v[180:183]
    v_mfma_f32_16x16x32_bf16 v[84:87], a[40:43], a[76:79], v[84:87]
    v_mfma_f32_16x16x32_bf16 v[68:71], a[40:43], a[72:75], v[68:71]
    v_mfma_f32_16x16x32_bf16 v[160:163], a[36:39], a[72:75], v[160:163]
    v_mfma_f32_16x16x32_bf16 v[176:179], a[36:39], a[76:79], v[176:179]
    v_mfma_f32_16x16x32_bf16 v[80:83], a[32:35], a[76:79], v[80:83]
    v_mfma_f32_16x16x32_bf16 v[64:67], a[32:35], a[72:75], v[64:67]
    s_waitcnt lgkmcnt(0)
    v_mfma_f32_16x16x32_bf16 v[96:99], a[64:67], a[32:35], v[96:99]
    ds_read_b64_tr_b16 a[72:73], v20 offset:40960
    ds_read_b64_tr_b16 a[74:75], v20 offset:41984
    v_mfma_f32_16x16x32_bf16 v[192:195], a[68:71], a[32:35], v[192:195]
    ds_read_b64_tr_b16 a[76:77], v21 offset:40960
    ds_read_b64_tr_b16 a[78:79], v21 offset:41984
    v_mfma_f32_16x16x32_bf16 v[196:199], a[68:71], a[36:39], v[196:199]
    v_mfma_f32_16x16x32_bf16 v[100:103], a[64:67], a[36:39], v[100:103]
    v_mfma_f32_16x16x32_bf16 v[104:107], a[64:67], a[40:43], v[104:107]
    v_mfma_f32_16x16x32_bf16 v[200:203], a[68:71], a[40:43], v[200:203]
    s_waitcnt vmcnt(9) lgkmcnt(0)
    v_mfma_f32_16x16x32_bf16 v[204:207], a[68:71], a[44:47], v[204:207]
    s_barrier
    v_mfma_f32_16x16x32_bf16 v[108:111], a[64:67], a[44:47], v[108:111]
    s_add_u32 m0, s92, 32768
    ds_read_b128 a[0:3], v16 offset:0
    ds_read_b128 a[4:7], v16 offset:2048
    v_mfma_f32_16x16x32_bf16 v[112:115], a[64:67], a[48:51], v[112:115]
    s_mov_b32 s94, 896
    v_mfma_f32_16x16x32_bf16 v[208:211], a[68:71], a[48:51], v[208:211]
    ds_read_b128 a[8:11], v16 offset:4096
    ds_read_b128 a[12:15], v16 offset:6144
    v_mfma_f32_16x16x32_bf16 v[212:215], a[68:71], a[52:55], v[212:215]
    buffer_load_dwordx4 v8, s[36:39], s94 offen offset:0 lds
    v_mfma_f32_16x16x32_bf16 v[116:119], a[64:67], a[52:55], v[116:119]
    ds_read_b128 a[16:19], v16 offset:8192
    ds_read_b128 a[20:23], v16 offset:10240
    v_mfma_f32_16x16x32_bf16 v[120:123], a[64:67], a[56:59], v[120:123]
    v_mfma_f32_16x16x32_bf16 v[216:219], a[68:71], a[56:59], v[216:219]
    ds_read_b128 a[24:27], v16 offset:12288
    ds_read_b128 a[28:31], v16 offset:14336
    v_mfma_f32_16x16x32_bf16 v[220:223], a[68:71], a[60:63], v[220:223]
    buffer_load_dwordx4 v9, s[36:39], s94 offen offset:1024 lds
    v_mfma_f32_16x16x32_bf16 v[124:127], a[64:67], a[60:63], v[124:127]
    v_mfma_f32_16x16x32_bf16 v[156:159], a[72:75], a[60:63], v[156:159]
    ds_read_b64_tr_b16 a[64:65], v18 offset:16384
    ds_read_b64_tr_b16 a[66:67], v18 offset:17408
    v_mfma_f32_16x16x32_bf16 v[252:255], a[76:79], a[60:63], v[252:255]
    ds_read_b64_tr_b16 a[68:69], v19 offset:16384
    ds_read_b64_tr_b16 a[70:71], v19 offset:17408
    v_mfma_f32_16x16x32_bf16 v[248:251], a[76:79], a[56:59], v[248:251]
    buffer_load_dwordx4 v10, s[36:39], s94 offen offset:2048 lds
    v_mfma_f32_16x16x32_bf16 v[152:155], a[72:75], a[56:59], v[152:155]
    v_mfma_f32_16x16x32_bf16 v[148:151], a[72:75], a[52:55], v[148:151]
    v_mfma_f32_16x16x32_bf16 v[244:247], a[76:79], a[52:55], v[244:247]
    v_mfma_f32_16x16x32_bf16 v[240:243], a[76:79], a[48:51], v[240:243]
    buffer_load_dwordx4 v11, s[36:39], s94 offen offset:3072 lds
    v_mfma_f32_16x16x32_bf16 v[144:147], a[72:75], a[48:51], v[144:147]
    s_add_u32 m0, s92, 98304
    v_mfma_f32_16x16x32_bf16 v[140:143], a[72:75], a[44:47], v[140:143]
    s_mov_b32 s95, 3670016
    v_mfma_f32_16x16x32_bf16 v[236:239], a[76:79], a[44:47], v[236:239]
    v_mfma_f32_16x16x32_bf16 v[232:235], a[76:79], a[40:43], v[232:235]
    buffer_load_dwordx4 v12, s[40:43], s95 offen offset:0 lds
    v_mfma_f32_16x16x32_bf16 v[136:139], a[72:75], a[40:43], v[136:139]
    v_mfma_f32_16x16x32_bf16 v[132:135], a[72:75], a[36:39], v[132:135]
    v_mfma_f32_16x16x32_bf16 v[228:231], a[76:79], a[36:39], v[228:231]
    v_mfma_f32_16x16x32_bf16 v[224:227], a[76:79], a[32:35], v[224:227]
    buffer_load_dwordx4 v13, s[40:43], s95 offen offset:1024 lds
    v_mfma_f32_16x16x32_bf16 v[128:131], a[72:75], a[32:35], v[128:131]
    s_waitcnt lgkmcnt(0)
    v_mfma_f32_16x16x32_bf16 a[96:99], a[0:3], a[64:67], a[96:99]
    ds_read_b64_tr_b16 a[72:73], v20 offset:16384
    ds_read_b64_tr_b16 a[74:75], v20 offset:17408
    v_mfma_f32_16x16x32_bf16 a[128:131], a[0:3], a[68:71], a[128:131]
    ds_read_b64_tr_b16 a[76:77], v21 offset:16384
    ds_read_b64_tr_b16 a[78:79], v21 offset:17408
    v_mfma_f32_16x16x32_bf16 a[132:135], a[4:7], a[68:71], a[132:135]
    buffer_load_dwordx4 v14, s[40:43], s95 offen offset:2048 lds
    v_mfma_f32_16x16x32_bf16 a[100:103], a[4:7], a[64:67], a[100:103]
    v_mfma_f32_16x16x32_bf16 a[104:107], a[8:11], a[64:67], a[104:107]
    ds_read_b128 a[32:35], v17 offset:0
    ds_read_b128 a[36:39], v17 offset:2048
    v_mfma_f32_16x16x32_bf16 a[136:139], a[8:11], a[68:71], a[136:139]
    v_mfma_f32_16x16x32_bf16 a[140:143], a[12:15], a[68:71], a[140:143]
    buffer_load_dwordx4 v15, s[40:43], s95 offen offset:3072 lds
    v_mfma_f32_16x16x32_bf16 a[108:111], a[12:15], a[64:67], a[108:111]
    s_add_u32 m0, s92, 36864
    v_mfma_f32_16x16x32_bf16 a[112:115], a[16:19], a[64:67], a[112:115]
    s_mov_b32 s94, 33664
    v_mfma_f32_16x16x32_bf16 a[144:147], a[16:19], a[68:71], a[144:147]
    v_mfma_f32_16x16x32_bf16 a[148:151], a[20:23], a[68:71], a[148:151]
    buffer_load_dwordx4 v8, s[36:39], s94 offen offset:0 lds
    v_mfma_f32_16x16x32_bf16 a[116:119], a[20:23], a[64:67], a[116:119]
    v_mfma_f32_16x16x32_bf16 a[120:123], a[24:27], a[64:67], a[120:123]
    ds_read_b128 a[40:43], v17 offset:4096
    ds_read_b128 a[44:47], v17 offset:6144
    v_mfma_f32_16x16x32_bf16 a[152:155], a[24:27], a[68:71], a[152:155]
    v_mfma_f32_16x16x32_bf16 a[156:159], a[28:31], a[68:71], a[156:159]
    buffer_load_dwordx4 v9, s[36:39], s94 offen offset:1024 lds
    v_mfma_f32_16x16x32_bf16 a[124:127], a[28:31], a[64:67], a[124:127]
    s_waitcnt lgkmcnt(2)
    v_mfma_f32_16x16x32_bf16 v[172:175], a[28:31], a[72:75], v[172:175]
    ds_read_b64_tr_b16 a[64:65], v18 offset:0
    ds_read_b64_tr_b16 a[66:67], v18 offset:1024
    v_mfma_f32_16x16x32_bf16 v[188:191], a[28:31], a[76:79], v[188:191]
    ds_read_b64_tr_b16 a[68:69], v19 offset:0
    ds_read_b64_tr_b16 a[70:71], v19 offset:1024
    v_mfma_f32_16x16x32_bf16 v[92:95], a[24:27], a[76:79], v[92:95]
    buffer_load_dwordx4 v10, s[36:39], s94 offen offset:2048 lds
    v_mfma_f32_16x16x32_bf16 v[76:79], a[24:27], a[72:75], v[76:79]
    v_mfma_f32_16x16x32_bf16 v[168:171], a[20:23], a[72:75], v[168:171]
    ds_read_b128 a[48:51], v17 offset:8192
    ds_read_b128 a[52:55], v17 offset:10240
    v_mfma_f32_16x16x32_bf16 v[184:187], a[20:23], a[76:79], v[184:187]
    v_mfma_f32_16x16x32_bf16 v[88:91], a[16:19], a[76:79], v[88:91]
    buffer_load_dwordx4 v11, s[36:39], s94 offen offset:3072 lds
    v_mfma_f32_16x16x32_bf16 v[72:75], a[16:19], a[72:75], v[72:75]
    s_add_u32 m0, s92, 102400
    v_mfma_f32_16x16x32_bf16 v[164:167], a[12:15], a[72:75], v[164:167]
    s_mov_b32 s95, 3801088
    v_mfma_f32_16x16x32_bf16 v[180:183], a[12:15], a[76:79], v[180:183]
    v_mfma_f32_16x16x32_bf16 v[84:87], a[8:11], a[76:79], v[84:87]
    buffer_load_dwordx4 v12, s[40:43], s95 offen offset:0 lds
    v_mfma_f32_16x16x32_bf16 v[68:71], a[8:11], a[72:75], v[68:71]
    v_mfma_f32_16x16x32_bf16 v[160:163], a[4:7], a[72:75], v[160:163]
    ds_read_b128 a[56:59], v17 offset:12288
    ds_read_b128 a[60:63], v17 offset:14336
    v_mfma_f32_16x16x32_bf16 v[176:179], a[4:7], a[76:79], v[176:179]
    v_mfma_f32_16x16x32_bf16 v[80:83], a[0:3], a[76:79], v[80:83]
    buffer_load_dwordx4 v13, s[40:43], s95 offen offset:1024 lds
    v_mfma_f32_16x16x32_bf16 v[64:67], a[0:3], a[72:75], v[64:67]
    s_waitcnt lgkmcnt(2)
    v_mfma_f32_16x16x32_bf16 v[96:99], a[64:67], a[0:3], v[96:99]
    ds_read_b64_tr_b16 a[72:73], v20 offset:0
    ds_read_b64_tr_b16 a[74:75], v20 offset:1024
    v_mfma_f32_16x16x32_bf16 v[192:195], a[68:71], a[0:3], v[192:195]
    ds_read_b64_tr_b16 a[76:77], v21 offset:0
    ds_read_b64_tr_b16 a[78:79], v21 offset:1024
    v_mfma_f32_16x16x32_bf16 v[196:199], a[68:71], a[4:7], v[196:199]
    buffer_load_dwordx4 v14, s[40:43], s95 offen offset:2048 lds
    v_mfma_f32_16x16x32_bf16 v[100:103], a[64:67], a[4:7], v[100:103]
    v_mfma_f32_16x16x32_bf16 v[104:107], a[64:67], a[8:11], v[104:107]
    v_mfma_f32_16x16x32_bf16 v[200:203], a[68:71], a[8:11], v[200:203]
    v_mfma_f32_16x16x32_bf16 v[204:207], a[68:71], a[12:15], v[204:207]
    buffer_load_dwordx4 v15, s[40:43], s95 offen offset:3072 lds
    v_mfma_f32_16x16x32_bf16 v[108:111], a[64:67], a[12:15], v[108:111]
    v_mfma_f32_16x16x32_bf16 v[112:115], a[64:67], a[16:19], v[112:115]
    v_mfma_f32_16x16x32_bf16 v[208:211], a[68:71], a[16:19], v[208:211]
    v_mfma_f32_16x16x32_bf16 v[212:215], a[68:71], a[20:23], v[212:215]
    v_mfma_f32_16x16x32_bf16 v[116:119], a[64:67], a[20:23], v[116:119]
    v_mfma_f32_16x16x32_bf16 v[120:123], a[64:67], a[24:27], v[120:123]
    v_mfma_f32_16x16x32_bf16 v[216:219], a[68:71], a[24:27], v[216:219]
    v_mfma_f32_16x16x32_bf16 v[220:223], a[68:71], a[28:31], v[220:223]
    v_mfma_f32_16x16x32_bf16 v[124:127], a[64:67], a[28:31], v[124:127]
    s_waitcnt lgkmcnt(0)
    v_mfma_f32_16x16x32_bf16 v[156:159], a[72:75], a[28:31], v[156:159]
    ds_read_b64_tr_b16 a[64:65], v18 offset:24576
    ds_read_b64_tr_b16 a[66:67], v18 offset:25600
    v_mfma_f32_16x16x32_bf16 v[252:255], a[76:79], a[28:31], v[252:255]
    ds_read_b64_tr_b16 a[68:69], v19 offset:24576
    ds_read_b64_tr_b16 a[70:71], v19 offset:25600
    v_mfma_f32_16x16x32_bf16 v[248:251], a[76:79], a[24:27], v[248:251]
    v_mfma_f32_16x16x32_bf16 v[152:155], a[72:75], a[24:27], v[152:155]
    v_mfma_f32_16x16x32_bf16 v[148:151], a[72:75], a[20:23], v[148:151]
    v_mfma_f32_16x16x32_bf16 v[244:247], a[76:79], a[20:23], v[244:247]
    v_mfma_f32_16x16x32_bf16 v[240:243], a[76:79], a[16:19], v[240:243]
    v_mfma_f32_16x16x32_bf16 v[144:147], a[72:75], a[16:19], v[144:147]
    v_mfma_f32_16x16x32_bf16 v[140:143], a[72:75], a[12:15], v[140:143]
    v_mfma_f32_16x16x32_bf16 v[236:239], a[76:79], a[12:15], v[236:239]
    v_mfma_f32_16x16x32_bf16 v[232:235], a[76:79], a[8:11], v[232:235]
    v_mfma_f32_16x16x32_bf16 v[136:139], a[72:75], a[8:11], v[136:139]
    v_mfma_f32_16x16x32_bf16 v[132:135], a[72:75], a[4:7], v[132:135]
    v_mfma_f32_16x16x32_bf16 v[228:231], a[76:79], a[4:7], v[228:231]
    v_mfma_f32_16x16x32_bf16 v[224:227], a[76:79], a[0:3], v[224:227]
    v_mfma_f32_16x16x32_bf16 v[128:131], a[72:75], a[0:3], v[128:131]
    s_waitcnt lgkmcnt(0)
    v_mfma_f32_16x16x32_bf16 a[96:99], a[32:35], a[64:67], a[96:99]
    ds_read_b64_tr_b16 a[72:73], v20 offset:24576
    ds_read_b64_tr_b16 a[74:75], v20 offset:25600
    v_mfma_f32_16x16x32_bf16 a[128:131], a[32:35], a[68:71], a[128:131]
    ds_read_b64_tr_b16 a[76:77], v21 offset:24576
    ds_read_b64_tr_b16 a[78:79], v21 offset:25600
    v_mfma_f32_16x16x32_bf16 a[132:135], a[36:39], a[68:71], a[132:135]
    v_mfma_f32_16x16x32_bf16 a[100:103], a[36:39], a[64:67], a[100:103]
    v_mfma_f32_16x16x32_bf16 a[104:107], a[40:43], a[64:67], a[104:107]
    v_mfma_f32_16x16x32_bf16 a[136:139], a[40:43], a[68:71], a[136:139]
    v_mfma_f32_16x16x32_bf16 a[140:143], a[44:47], a[68:71], a[140:143]
    v_mfma_f32_16x16x32_bf16 a[108:111], a[44:47], a[64:67], a[108:111]
    v_mfma_f32_16x16x32_bf16 a[112:115], a[48:51], a[64:67], a[112:115]
    v_mfma_f32_16x16x32_bf16 a[144:147], a[48:51], a[68:71], a[144:147]
    v_mfma_f32_16x16x32_bf16 a[148:151], a[52:55], a[68:71], a[148:151]
    v_mfma_f32_16x16x32_bf16 a[116:119], a[52:55], a[64:67], a[116:119]
    v_mfma_f32_16x16x32_bf16 a[120:123], a[56:59], a[64:67], a[120:123]
    v_mfma_f32_16x16x32_bf16 a[152:155], a[56:59], a[68:71], a[152:155]
    v_mfma_f32_16x16x32_bf16 a[156:159], a[60:63], a[68:71], a[156:159]
    v_mfma_f32_16x16x32_bf16 a[124:127], a[60:63], a[64:67], a[124:127]
    s_waitcnt lgkmcnt(0)
    v_mfma_f32_16x16x32_bf16 v[172:175], a[60:63], a[72:75], v[172:175]
    ds_read_b64_tr_b16 a[64:65], v18 offset:8192
    ds_read_b64_tr_b16 a[66:67], v18 offset:9216
    v_mfma_f32_16x16x32_bf16 v[188:191], a[60:63], a[76:79], v[188:191]
    ds_read_b64_tr_b16 a[68:69], v19 offset:8192
    ds_read_b64_tr_b16 a[70:71], v19 offset:9216
    v_mfma_f32_16x16x32_bf16 v[92:95], a[56:59], a[76:79], v[92:95]
    v_mfma_f32_16x16x32_bf16 v[76:79], a[56:59], a[72:75], v[76:79]
    v_mfma_f32_16x16x32_bf16 v[168:171], a[52:55], a[72:75], v[168:171]
    v_mfma_f32_16x16x32_bf16 v[184:187], a[52:55], a[76:79], v[184:187]
    v_mfma_f32_16x16x32_bf16 v[88:91], a[48:51], a[76:79], v[88:91]
    v_mfma_f32_16x16x32_bf16 v[72:75], a[48:51], a[72:75], v[72:75]
    v_mfma_f32_16x16x32_bf16 v[164:167], a[44:47], a[72:75], v[164:167]
    v_mfma_f32_16x16x32_bf16 v[180:183], a[44:47], a[76:79], v[180:183]
    v_mfma_f32_16x16x32_bf16 v[84:87], a[40:43], a[76:79], v[84:87]
    buffer_load_dword v6, v3, s[88:91], 0 offen sc1
    v_mfma_f32_16x16x32_bf16 v[68:71], a[40:43], a[72:75], v[68:71]
    v_mfma_f32_16x16x32_bf16 v[160:163], a[36:39], a[72:75], v[160:163]
    v_mfma_f32_16x16x32_bf16 v[176:179], a[36:39], a[76:79], v[176:179]
    v_mfma_f32_16x16x32_bf16 v[80:83], a[32:35], a[76:79], v[80:83]
    v_mfma_f32_16x16x32_bf16 v[64:67], a[32:35], a[72:75], v[64:67]
    s_waitcnt lgkmcnt(0)
    v_mfma_f32_16x16x32_bf16 v[96:99], a[64:67], a[32:35], v[96:99]
    ds_read_b64_tr_b16 a[72:73], v20 offset:8192
    ds_read_b64_tr_b16 a[74:75], v20 offset:9216
    v_mfma_f32_16x16x32_bf16 v[192:195], a[68:71], a[32:35], v[192:195]
    ds_read_b64_tr_b16 a[76:77], v21 offset:8192
    ds_read_b64_tr_b16 a[78:79], v21 offset:9216
    v_mfma_f32_16x16x32_bf16 v[196:199], a[68:71], a[36:39], v[196:199]
    v_mfma_f32_16x16x32_bf16 v[100:103], a[64:67], a[36:39], v[100:103]
    v_mfma_f32_16x16x32_bf16 v[104:107], a[64:67], a[40:43], v[104:107]
    v_mfma_f32_16x16x32_bf16 v[200:203], a[68:71], a[40:43], v[200:203]
    s_waitcnt vmcnt(1) lgkmcnt(0)
    v_mfma_f32_16x16x32_bf16 v[204:207], a[68:71], a[44:47], v[204:207]
    s_barrier
    v_mfma_f32_16x16x32_bf16 v[108:111], a[64:67], a[44:47], v[108:111]
    ds_read_b128 a[0:3], v16 offset:32768
    ds_read_b128 a[4:7], v16 offset:34816
    v_mfma_f32_16x16x32_bf16 v[112:115], a[64:67], a[48:51], v[112:115]
    s_add_u32 m0, s93, 65536
    v_mfma_f32_16x16x32_bf16 v[208:211], a[68:71], a[48:51], v[208:211]
    s_mov_b32 s94, 524288
    ds_read_b128 a[8:11], v16 offset:36864
    ds_read_b128 a[12:15], v16 offset:38912
    v_mfma_f32_16x16x32_bf16 v[212:215], a[68:71], a[52:55], v[212:215]
    buffer_load_dwordx4 v34, s[60:63], s94 offen offset:0 lds
    v_mfma_f32_16x16x32_bf16 v[116:119], a[64:67], a[52:55], v[116:119]
    ds_read_b128 a[16:19], v16 offset:40960
    ds_read_b128 a[20:23], v16 offset:43008
    v_mfma_f32_16x16x32_bf16 v[120:123], a[64:67], a[56:59], v[120:123]
    v_mfma_f32_16x16x32_bf16 v[216:219], a[68:71], a[56:59], v[216:219]
    ds_read_b128 a[24:27], v16 offset:45056
    ds_read_b128 a[28:31], v16 offset:47104
    v_mfma_f32_16x16x32_bf16 v[220:223], a[68:71], a[60:63], v[220:223]
    buffer_load_dwordx4 v35, s[60:63], s94 offen offset:1024 lds
    v_mfma_f32_16x16x32_bf16 v[124:127], a[64:67], a[60:63], v[124:127]
    v_mfma_f32_16x16x32_bf16 v[156:159], a[72:75], a[60:63], v[156:159]
    ds_read_b64_tr_b16 a[64:65], v18 offset:49152
    ds_read_b64_tr_b16 a[66:67], v18 offset:50176
    v_mfma_f32_16x16x32_bf16 v[252:255], a[76:79], a[60:63], v[252:255]
    ds_read_b64_tr_b16 a[68:69], v19 offset:49152
    ds_read_b64_tr_b16 a[70:71], v19 offset:50176
    v_mfma_f32_16x16x32_bf16 v[248:251], a[76:79], a[56:59], v[248:251]
    buffer_load_dwordx4 v36, s[60:63], s94 offen offset:2048 lds
    v_mfma_f32_16x16x32_bf16 v[152:155], a[72:75], a[56:59], v[152:155]
    v_mfma_f32_16x16x32_bf16 v[148:151], a[72:75], a[52:55], v[148:151]
    v_mfma_f32_16x16x32_bf16 v[244:247], a[76:79], a[52:55], v[244:247]
    buffer_load_dwordx4 v37, s[60:63], s94 offen offset:3072 lds
    v_mfma_f32_16x16x32_bf16 v[240:243], a[76:79], a[48:51], v[240:243]
    s_add_u32 m0, s93, 81920
    v_mfma_f32_16x16x32_bf16 v[144:147], a[72:75], a[48:51], v[144:147]
    s_mov_b32 s95, 221184
    v_mfma_f32_16x16x32_bf16 v[140:143], a[72:75], a[44:47], v[140:143]
    buffer_load_dwordx4 v38, s[64:67], s95 offen offset:0 lds
    v_mfma_f32_16x16x32_bf16 v[236:239], a[76:79], a[44:47], v[236:239]
    v_mfma_f32_16x16x32_bf16 v[232:235], a[76:79], a[40:43], v[232:235]
    v_mfma_f32_16x16x32_bf16 v[136:139], a[72:75], a[40:43], v[136:139]
    buffer_load_dwordx4 v39, s[64:67], s95 offen offset:1024 lds
    v_mfma_f32_16x16x32_bf16 v[132:135], a[72:75], a[36:39], v[132:135]
    v_mfma_f32_16x16x32_bf16 v[228:231], a[76:79], a[36:39], v[228:231]
    v_mfma_f32_16x16x32_bf16 v[224:227], a[76:79], a[32:35], v[224:227]
    buffer_load_dwordx4 v38, s[68:71], s95 offen offset:2048 lds
    v_mfma_f32_16x16x32_bf16 v[128:131], a[72:75], a[32:35], v[128:131]
    s_waitcnt lgkmcnt(0)
    v_mfma_f32_16x16x32_bf16 a[96:99], a[0:3], a[64:67], a[96:99]
    ds_read_b64_tr_b16 a[72:73], v20 offset:49152
    ds_read_b64_tr_b16 a[74:75], v20 offset:50176
    v_mfma_f32_16x16x32_bf16 a[128:131], a[0:3], a[68:71], a[128:131]
    ds_read_b64_tr_b16 a[76:77], v21 offset:49152
    ds_read_b64_tr_b16 a[78:79], v21 offset:50176
    v_mfma_f32_16x16x32_bf16 a[132:135], a[4:7], a[68:71], a[132:135]
    buffer_load_dwordx4 v39, s[68:71], s95 offen offset:3072 lds
    v_mfma_f32_16x16x32_bf16 a[100:103], a[4:7], a[64:67], a[100:103]
    ds_read_b128 a[32:35], v17 offset:32768
    ds_read_b128 a[36:39], v17 offset:34816
    v_mfma_f32_16x16x32_bf16 a[104:107], a[8:11], a[64:67], a[104:107]
    v_mfma_f32_16x16x32_bf16 a[136:139], a[8:11], a[68:71], a[136:139]
    v_mfma_f32_16x16x32_bf16 a[140:143], a[12:15], a[68:71], a[140:143]
    v_mfma_f32_16x16x32_bf16 a[108:111], a[12:15], a[64:67], a[108:111]
    ds_read_b128 a[40:43], v17 offset:36864
    ds_read_b128 a[44:47], v17 offset:38912
    v_mfma_f32_16x16x32_bf16 a[112:115], a[16:19], a[64:67], a[112:115]
    v_mfma_f32_16x16x32_bf16 a[144:147], a[16:19], a[68:71], a[144:147]
    v_mfma_f32_16x16x32_bf16 a[148:151], a[20:23], a[68:71], a[148:151]
    v_mfma_f32_16x16x32_bf16 a[116:119], a[20:23], a[64:67], a[116:119]
    ds_read_b128 a[48:51], v17 offset:40960
    ds_read_b128 a[52:55], v17 offset:43008
    v_mfma_f32_16x16x32_bf16 a[120:123], a[24:27], a[64:67], a[120:123]
    v_mfma_f32_16x16x32_bf16 a[152:155], a[24:27], a[68:71], a[152:155]
    v_mfma_f32_16x16x32_bf16 a[156:159], a[28:31], a[68:71], a[156:159]
    v_mfma_f32_16x16x32_bf16 a[124:127], a[28:31], a[64:67], a[124:127]
    s_waitcnt lgkmcnt(2)
    ds_read_b128 a[56:59], v17 offset:45056
    ds_read_b128 a[60:63], v17 offset:47104
    v_mfma_f32_16x16x32_bf16 v[172:175], a[28:31], a[72:75], v[172:175]
    s_waitcnt vmcnt(8)
    ds_read_b64_tr_b16 a[64:65], v18 offset:57344
    ds_read_b64_tr_b16 a[66:67], v18 offset:58368
    v_mfma_f32_16x16x32_bf16 v[188:191], a[28:31], a[76:79], v[188:191]
    ds_read_b64_tr_b16 a[68:69], v19 offset:57344
    ds_read_b64_tr_b16 a[70:71], v19 offset:58368
    v_mfma_f32_16x16x32_bf16 v[92:95], a[24:27], a[76:79], v[92:95]
    v_cmp_gt_u32 vcc, 1, v6
    v_mfma_f32_16x16x32_bf16 v[76:79], a[24:27], a[72:75], v[76:79]
    s_cbranch_vccnz SP_xn
SR_xn:
    v_mfma_f32_16x16x32_bf16 v[168:171], a[20:23], a[72:75], v[168:171]
    buffer_load_dwordx4 a[160:163], v32, s[72:75], s84 offen offset:0 sc1
    v_mfma_f32_16x16x32_bf16 v[184:187], a[20:23], a[76:79], v[184:187]
    v_mfma_f32_16x16x32_bf16 v[88:91], a[16:19], a[76:79], v[88:91]
    v_mfma_f32_16x16x32_bf16 v[72:75], a[16:19], a[72:75], v[72:75]
    buffer_load_dwordx4 a[164:167], v32, s[72:75], s85 offen offset:0 sc1
    v_mfma_f32_16x16x32_bf16 v[164:167], a[12:15], a[72:75], v[164:167]
    v_mfma_f32_16x16x32_bf16 v[180:183], a[12:15], a[76:79], v[180:183]
    v_mfma_f32_16x16x32_bf16 v[84:87], a[8:11], a[76:79], v[84:87]
    buffer_load_dwordx4 a[168:171], v32, s[72:75], s86 offen offset:0 sc1
    v_mfma_f32_16x16x32_bf16 v[68:71], a[8:11], a[72:75], v[68:71]
    v_mfma_f32_16x16x32_bf16 v[160:163], a[4:7], a[72:75], v[160:163]
    v_mfma_f32_16x16x32_bf16 v[176:179], a[4:7], a[76:79], v[176:179]
    buffer_load_dwordx4 a[172:175], v32, s[72:75], s87 offen offset:0 sc1
    v_mfma_f32_16x16x32_bf16 v[80:83], a[0:3], a[76:79], v[80:83]
    v_mfma_f32_16x16x32_bf16 v[64:67], a[0:3], a[72:75], v[64:67]
    s_waitcnt lgkmcnt(0)
    v_mfma_f32_16x16x32_bf16 a[96:99], a[32:35], a[64:67], a[96:99]
    ds_read_b64_tr_b16 a[72:73], v20 offset:57344
    ds_read_b64_tr_b16 a[74:75], v20 offset:58368
    v_mfma_f32_16x16x32_bf16 a[128:131], a[32:35], a[68:71], a[128:131]
    ds_read_b64_tr_b16 a[76:77], v21 offset:57344
    ds_read_b64_tr_b16 a[78:79], v21 offset:58368
    v_mfma_f32_16x16x32_bf16 a[132:135], a[36:39], a[68:71], a[132:135]
    buffer_load_dwordx4 a[176:179], v32, s[72:75], s84 offen offset:1024 sc1
    v_mfma_f32_16x16x32_bf16 a[100:103], a[36:39], a[64:67], a[100:103]
    v_mfma_f32_16x16x32_bf16 a[104:107], a[40:43], a[64:67], a[104:107]
    v_mfma_f32_16x16x32_bf16 a[136:139], a[40:43], a[68:71], a[136:139]
    buffer_load_dwordx4 a[180:183], v32, s[72:75], s85 offen offset:1024 sc1
    v_mfma_f32_16x16x32_bf16 a[140:143], a[44:47], a[68:71], a[140:143]
    v_mfma_f32_16x16x32_bf16 a[108:111], a[44:47], a[64:67], a[108:111]
    v_accvgpr_read_b32 v8, a128
    v_accvgpr_read_b32 v9, a129
    v_mfma_f32_16x16x32_bf16 a[112:115], a[48:51], a[64:67], a[112:115]
    buffer_load_dwordx4 a[184:187], v32, s[72:75], s86 offen offset:1024 sc1
    v_mfma_f32_16x16x32_bf16 a[144:147], a[48:51], a[68:71], a[144:147]
    v_accvgpr_read_b32 v10, a130
    v_accvgpr_read_b32 v11, a131
    v_mfma_f32_16x16x32_bf16 a[148:151], a[52:55], a[68:71], a[148:151]
    v_accvgpr_read_b32 v12, a132
    v_accvgpr_read_b32 v13, a133
    v_mfma_f32_16x16x32_bf16 a[116:119], a[52:55], a[64:67], a[116:119]
    buffer_load_dwordx4 a[188:191], v32, s[72:75], s87 offen offset:1024 sc1
    v_mfma_f32_16x16x32_bf16 a[120:123], a[56:59], a[64:67], a[120:123]
    v_accvgpr_read_b32 v14, a134
    v_accvgpr_read_b32 v15, a135
    v_mfma_f32_16x16x32_bf16 a[152:155], a[56:59], a[68:71], a[152:155]
    v_cvt_pk_bf16_f32 v8, v8, v9
    v_cvt_pk_bf16_f32 v9, v10, v11
    v_mfma_f32_16x16x32_bf16 a[156:159], a[60:63], a[68:71], a[156:159]
    buffer_load_dwordx4 a[192:195], v32, s[72:75], s84 offen offset:2048 sc1
    v_mfma_f32_16x16x32_bf16 a[124:127], a[60:63], a[64:67], a[124:127]
    s_waitcnt lgkmcnt(0)
    v_cvt_pk_bf16_f32 v10, v12, v13
    v_cvt_pk_bf16_f32 v11, v14, v15
    v_mfma_f32_16x16x32_bf16 v[172:175], a[60:63], a[72:75], v[172:175]
    s_mov_b32 s96, 0
    ds_read_b64_tr_b16 a[64:65], v18 offset:32768
    ds_read_b64_tr_b16 a[66:67], v18 offset:33792
    v_mfma_f32_16x16x32_bf16 v[188:191], a[60:63], a[76:79], v[188:191]
    ds_read_b64_tr_b16 a[68:69], v19 offset:32768
    ds_read_b64_tr_b16 a[70:71], v19 offset:33792
    v_mfma_f32_16x16x32_bf16 v[92:95], a[56:59], a[76:79], v[92:95]
    buffer_load_dwordx4 a[196:199], v32, s[72:75], s85 offen offset:2048 sc1
    v_mfma_f32_16x16x32_bf16 v[76:79], a[56:59], a[72:75], v[76:79]
    buffer_store_dwordx4 v[8:11], v31, s[44:47], s96 offen offset:1024 sc1
    v_mfma_f32_16x16x32_bf16 v[168:171], a[52:55], a[72:75], v[168:171]
    v_accvgpr_read_b32 v22, a96
    v_accvgpr_read_b32 v23, a97
    v_mfma_f32_16x16x32_bf16 v[184:187], a[52:55], a[76:79], v[184:187]
    buffer_load_dwordx4 a[200:203], v32, s[72:75], s86 offen offset:2048 sc1
    v_mfma_f32_16x16x32_bf16 v[88:91], a[48:51], a[76:79], v[88:91]
    v_accvgpr_read_b32 v24, a98
    v_accvgpr_read_b32 v25, a99
    v_mfma_f32_16x16x32_bf16 v[72:75], a[48:51], a[72:75], v[72:75]
    v_accvgpr_read_b32 v26, a100
    v_accvgpr_read_b32 v27, a101
    v_mfma_f32_16x16x32_bf16 v[164:167], a[44:47], a[72:75], v[164:167]
    buffer_load_dwordx4 a[204:207], v32, s[72:75], s87 offen offset:2048 sc1
    v_mfma_f32_16x16x32_bf16 v[180:183], a[44:47], a[76:79], v[180:183]
    v_accvgpr_read_b32 v28, a102
    v_accvgpr_read_b32 v29, a103
    v_mfma_f32_16x16x32_bf16 v[84:87], a[40:43], a[76:79], v[84:87]
    v_cvt_pk_bf16_f32 v22, v22, v23
    v_cvt_pk_bf16_f32 v23, v24, v25
    v_mfma_f32_16x16x32_bf16 v[68:71], a[40:43], a[72:75], v[68:71]
    v_cvt_pk_bf16_f32 v24, v26, v27
    v_cvt_pk_bf16_f32 v25, v28, v29
    v_mfma_f32_16x16x32_bf16 v[160:163], a[36:39], a[72:75], v[160:163]
    s_mov_b32 s96, 0
    buffer_store_dwordx4 v[22:25], v31, s[44:47], s96 offen offset:0 sc1
    v_mfma_f32_16x16x32_bf16 v[176:179], a[36:39], a[76:79], v[176:179]
    v_accvgpr_read_b32 v8, a136
    v_accvgpr_read_b32 v9, a137
    v_mfma_f32_16x16x32_bf16 v[80:83], a[32:35], a[76:79], v[80:83]
    v_accvgpr_read_b32 v10, a138
    v_accvgpr_read_b32 v11, a139
    v_mfma_f32_16x16x32_bf16 v[64:67], a[32:35], a[72:75], v[64:67]
    s_waitcnt lgkmcnt(0)
    v_accvgpr_read_b32 v12, a140
    v_accvgpr_read_b32 v13, a141
    v_mfma_f32_16x16x32_bf16 v[96:99], a[64:67], a[0:3], v[96:99]
    ds_read_b64_tr_b16 a[72:73], v18 offset:40960
    ds_read_b64_tr_b16 a[74:75], v18 offset:41984
    v_mfma_f32_16x16x32_bf16 v[192:195], a[68:71], a[0:3], v[192:195]
    ds_read_b64_tr_b16 a[76:77], v19 offset:40960
    ds_read_b64_tr_b16 a[78:79], v19 offset:41984
    v_mfma_f32_16x16x32_bf16 v[196:199], a[68:71], a[4:7], v[196:199]
    v_accvgpr_read_b32 v14, a142
    v_accvgpr_read_b32 v15, a143
    v_mfma_f32_16x16x32_bf16 v[100:103], a[64:67], a[4:7], v[100:103]
    v_cvt_pk_bf16_f32 v8, v8, v9
    v_cvt_pk_bf16_f32 v9, v10, v11
    v_mfma_f32_16x16x32_bf16 v[104:107], a[64:67], a[8:11], v[104:107]
    v_cvt_pk_bf16_f32 v10, v12, v13
    v_cvt_pk_bf16_f32 v11, v14, v15
    v_mfma_f32_16x16x32_bf16 v[200:203], a[68:71], a[8:11], v[200:203]
    s_mov_b32 s96, 8192
    buffer_store_dwordx4 v[8:11], v31, s[44:47], s96 offen offset:1024 sc1
    v_mfma_f32_16x16x32_bf16 v[204:207], a[68:71], a[12:15], v[204:207]
    v_accvgpr_read_b32 v22, a104
    v_accvgpr_read_b32 v23, a105
    v_mfma_f32_16x16x32_bf16 v[108:111], a[64:67], a[12:15], v[108:111]
    v_accvgpr_read_b32 v24, a106
    v_accvgpr_read_b32 v25, a107
    v_mfma_f32_16x16x32_bf16 v[112:115], a[64:67], a[16:19], v[112:115]
    v_accvgpr_read_b32 v26, a108
    v_accvgpr_read_b32 v27, a109
    v_mfma_f32_16x16x32_bf16 v[208:211], a[68:71], a[16:19], v[208:211]
    v_accvgpr_read_b32 v28, a110
    v_accvgpr_read_b32 v29, a111
    v_mfma_f32_16x16x32_bf16 v[212:215], a[68:71], a[20:23], v[212:215]
    v_cvt_pk_bf16_f32 v22, v22, v23
    v_cvt_pk_bf16_f32 v23, v24, v25
    v_mfma_f32_16x16x32_bf16 v[116:119], a[64:67], a[20:23], v[116:119]
    v_cvt_pk_bf16_f32 v24, v26, v27
    v_cvt_pk_bf16_f32 v25, v28, v29
    v_mfma_f32_16x16x32_bf16 v[120:123], a[64:67], a[24:27], v[120:123]
    s_mov_b32 s96, 8192
    buffer_store_dwordx4 v[22:25], v31, s[44:47], s96 offen offset:0 sc1
    v_mfma_f32_16x16x32_bf16 v[216:219], a[68:71], a[24:27], v[216:219]
    v_accvgpr_read_b32 v8, a144
    v_accvgpr_read_b32 v9, a145
    v_mfma_f32_16x16x32_bf16 v[220:223], a[68:71], a[28:31], v[220:223]
    v_accvgpr_read_b32 v10, a146
    v_accvgpr_read_b32 v11, a147
    v_mfma_f32_16x16x32_bf16 v[124:127], a[64:67], a[28:31], v[124:127]
    s_waitcnt lgkmcnt(0)
    v_accvgpr_read_b32 v12, a148
    v_accvgpr_read_b32 v13, a149
    v_mfma_f32_16x16x32_bf16 v[124:127], a[72:75], a[60:63], v[124:127]
    ds_read_b64_tr_b16 a[64:65], v20 offset:32768
    ds_read_b64_tr_b16 a[66:67], v20 offset:33792
    v_mfma_f32_16x16x32_bf16 v[220:223], a[76:79], a[60:63], v[220:223]
    ds_read_b64_tr_b16 a[68:69], v21 offset:32768
    ds_read_b64_tr_b16 a[70:71], v21 offset:33792
    v_mfma_f32_16x16x32_bf16 v[216:219], a[76:79], a[56:59], v[216:219]
    v_accvgpr_read_b32 v14, a150
    v_accvgpr_read_b32 v15, a151
    v_mfma_f32_16x16x32_bf16 v[120:123], a[72:75], a[56:59], v[120:123]
    v_cvt_pk_bf16_f32 v8, v8, v9
    v_cvt_pk_bf16_f32 v9, v10, v11
    v_mfma_f32_16x16x32_bf16 v[116:119], a[72:75], a[52:55], v[116:119]
    v_cvt_pk_bf16_f32 v10, v12, v13
    v_cvt_pk_bf16_f32 v11, v14, v15
    v_mfma_f32_16x16x32_bf16 v[212:215], a[76:79], a[52:55], v[212:215]
    s_mov_b32 s96, 33792
    buffer_store_dwordx4 v[8:11], v31, s[44:47], s96 offen offset:1024 sc1
    v_mfma_f32_16x16x32_bf16 v[208:211], a[76:79], a[48:51], v[208:211]
    v_accvgpr_read_b32 v22, a112
    v_accvgpr_read_b32 v23, a113
    v_mfma_f32_16x16x32_bf16 v[112:115], a[72:75], a[48:51], v[112:115]
    v_accvgpr_read_b32 v24, a114
    v_accvgpr_read_b32 v25, a115
    v_mfma_f32_16x16x32_bf16 v[108:111], a[72:75], a[44:47], v[108:111]
    v_accvgpr_read_b32 v26, a116
    v_accvgpr_read_b32 v27, a117
    v_mfma_f32_16x16x32_bf16 v[204:207], a[76:79], a[44:47], v[204:207]
    v_accvgpr_read_b32 v28, a118
    v_accvgpr_read_b32 v29, a119
    v_mfma_f32_16x16x32_bf16 v[200:203], a[76:79], a[40:43], v[200:203]
    v_cvt_pk_bf16_f32 v22, v22, v23
    v_cvt_pk_bf16_f32 v23, v24, v25
    v_mfma_f32_16x16x32_bf16 v[104:107], a[72:75], a[40:43], v[104:107]
    v_cvt_pk_bf16_f32 v24, v26, v27
    v_cvt_pk_bf16_f32 v25, v28, v29
    v_mfma_f32_16x16x32_bf16 v[100:103], a[72:75], a[36:39], v[100:103]
    s_mov_b32 s96, 33792
    buffer_store_dwordx4 v[22:25], v31, s[44:47], s96 offen offset:0 sc1
    v_mfma_f32_16x16x32_bf16 v[196:199], a[76:79], a[36:39], v[196:199]
    v_accvgpr_read_b32 v8, a152
    v_accvgpr_read_b32 v9, a153
    v_mfma_f32_16x16x32_bf16 v[192:195], a[76:79], a[32:35], v[192:195]
    v_accvgpr_read_b32 v10, a154
    v_accvgpr_read_b32 v11, a155
    v_mfma_f32_16x16x32_bf16 v[96:99], a[72:75], a[32:35], v[96:99]
    s_waitcnt lgkmcnt(0)
    v_accvgpr_read_b32 v12, a156
    v_accvgpr_read_b32 v13, a157
    v_mfma_f32_16x16x32_bf16 v[128:131], a[64:67], a[0:3], v[128:131]
    ds_read_b64_tr_b16 a[72:73], v20 offset:40960
    ds_read_b64_tr_b16 a[74:75], v20 offset:41984
    v_mfma_f32_16x16x32_bf16 v[224:227], a[68:71], a[0:3], v[224:227]
    ds_read_b64_tr_b16 a[76:77], v21 offset:40960
    ds_read_b64_tr_b16 a[78:79], v21 offset:41984
    v_mfma_f32_16x16x32_bf16 v[228:231], a[68:71], a[4:7], v[228:231]
    v_accvgpr_read_b32 v14, a158
    v_accvgpr_read_b32 v15, a159
    v_mfma_f32_16x16x32_bf16 v[132:135], a[64:67], a[4:7], v[132:135]
    v_cvt_pk_bf16_f32 v8, v8, v9
    v_cvt_pk_bf16_f32 v9, v10, v11
    v_mfma_f32_16x16x32_bf16 v[136:139], a[64:67], a[8:11], v[136:139]
    v_cvt_pk_bf16_f32 v10, v12, v13
    v_cvt_pk_bf16_f32 v11, v14, v15
    v_mfma_f32_16x16x32_bf16 v[232:235], a[68:71], a[8:11], v[232:235]
    s_waitcnt lgkmcnt(0)
    v_cvt_pk_bf16_f32 v92, v92, v93
    v_cvt_pk_bf16_f32 v93, v94, v95
    v_mfma_f32_16x16x32_bf16 v[236:239], a[68:71], a[12:15], v[236:239]
    s_barrier
    v_cvt_pk_bf16_f32 v94, v188, v189
    v_cvt_pk_bf16_f32 v95, v190, v191
    v_mfma_f32_16x16x32_bf16 v[140:143], a[64:67], a[12:15], v[140:143]
    s_mov_b32 s96, 41984
    buffer_store_dwordx4 v[8:11], v31, s[44:47], s96 offen offset:1024 sc1
    v_mfma_f32_16x16x32_bf16 v[144:147], a[64:67], a[16:19], v[144:147]
    ds_read_b64_tr_b16 a[224:225], v52 offset:0
    ds_read_b64_tr_b16 a[226:227], v52 offset:1024
    v_mfma_f32_16x16x32_bf16 v[240:243], a[68:71], a[16:19], v[240:243]
    ds_read_b64_tr_b16 a[228:229], v53 offset:0
    ds_read_b64_tr_b16 a[230:231], v53 offset:1024
    v_mfma_f32_16x16x32_bf16 v[244:247], a[68:71], a[20:23], v[244:247]
    v_accvgpr_read_b32 v22, a120
    v_accvgpr_read_b32 v23, a121
    v_mfma_f32_16x16x32_bf16 v[148:151], a[64:67], a[20:23], v[148:151]
    v_accvgpr_read_b32 v24, a122
    v_accvgpr_read_b32 v25, a123
    v_mfma_f32_16x16x32_bf16 v[152:155], a[64:67], a[24:27], v[152:155]
    v_accvgpr_read_b32 v26, a124
    v_accvgpr_read_b32 v27, a125
    v_mfma_f32_16x16x32_bf16 v[248:251], a[68:71], a[24:27], v[248:251]
    v_accvgpr_read_b32 v28, a126
    v_accvgpr_read_b32 v29, a127
    v_mfma_f32_16x16x32_bf16 v[252:255], a[68:71], a[28:31], v[252:255]
    v_cvt_pk_bf16_f32 v22, v22, v23
    v_cvt_pk_bf16_f32 v23, v24, v25
    v_mfma_f32_16x16x32_bf16 v[156:159], a[64:67], a[28:31], v[156:159]
    v_cvt_pk_bf16_f32 v24, v26, v27
    v_cvt_pk_bf16_f32 v25, v28, v29
    v_mfma_f32_16x16x32_bf16 v[156:159], a[72:75], a[60:63], v[156:159]
    s_mov_b32 s96, 41984
    ds_read_b64_tr_b16 a[232:233], v54 offset:0
    ds_read_b64_tr_b16 a[234:235], v54 offset:1024
    v_mfma_f32_16x16x32_bf16 v[252:255], a[76:79], a[60:63], v[252:255]
    ds_read_b64_tr_b16 a[236:237], v55 offset:0
    ds_read_b64_tr_b16 a[238:239], v55 offset:1024
    v_mfma_f32_16x16x32_bf16 v[248:251], a[76:79], a[56:59], v[248:251]
    buffer_store_dwordx4 v[22:25], v31, s[44:47], s96 offen offset:0 sc1
    v_mfma_f32_16x16x32_bf16 v[152:155], a[72:75], a[56:59], v[152:155]
    v_cvt_pk_bf16_f32 v76, v76, v77
    v_cvt_pk_bf16_f32 v77, v78, v79
    v_mfma_f32_16x16x32_bf16 v[148:151], a[72:75], a[52:55], v[148:151]
    v_cvt_pk_bf16_f32 v78, v172, v173
    v_cvt_pk_bf16_f32 v79, v174, v175
    v_mfma_f32_16x16x32_bf16 v[244:247], a[76:79], a[52:55], v[244:247]
    v_cvt_pk_bf16_f32 v88, v88, v89
    v_cvt_pk_bf16_f32 v89, v90, v91
    v_mfma_f32_16x16x32_bf16 v[240:243], a[76:79], a[48:51], v[240:243]
    v_cvt_pk_bf16_f32 v90, v184, v185
    v_cvt_pk_bf16_f32 v91, v186, v187
    v_mfma_f32_16x16x32_bf16 v[144:147], a[72:75], a[48:51], v[144:147]
    v_cvt_pk_bf16_f32 v72, v72, v73
    v_cvt_pk_bf16_f32 v73, v74, v75
    v_mfma_f32_16x16x32_bf16 v[140:143], a[72:75], a[44:47], v[140:143]
    ds_read_b64_tr_b16 a[240:241], v56 offset:0
    ds_read_b64_tr_b16 a[242:243], v56 offset:1024
    v_mfma_f32_16x16x32_bf16 v[236:239], a[76:79], a[44:47], v[236:239]
    ds_read_b64_tr_b16 a[244:245], v57 offset:0
    ds_read_b64_tr_b16 a[246:247], v57 offset:1024
    v_mfma_f32_16x16x32_bf16 v[232:235], a[76:79], a[40:43], v[232:235]
    v_cvt_pk_bf16_f32 v74, v168, v169
    v_cvt_pk_bf16_f32 v75, v170, v171
    v_mfma_f32_16x16x32_bf16 v[136:139], a[72:75], a[40:43], v[136:139]
    v_cvt_pk_bf16_f32 v84, v84, v85
    v_cvt_pk_bf16_f32 v85, v86, v87
    v_mfma_f32_16x16x32_bf16 v[132:135], a[72:75], a[36:39], v[132:135]
    v_cvt_pk_bf16_f32 v86, v180, v181
    v_cvt_pk_bf16_f32 v87, v182, v183
    v_mfma_f32_16x16x32_bf16 v[228:231], a[76:79], a[36:39], v[228:231]
    v_cvt_pk_bf16_f32 v68, v68, v69
    v_cvt_pk_bf16_f32 v69, v70, v71
    v_mfma_f32_16x16x32_bf16 v[224:227], a[76:79], a[32:35], v[224:227]
    v_cvt_pk_bf16_f32 v70, v164, v165
    v_cvt_pk_bf16_f32 v71, v166, v167
    v_mfma_f32_16x16x32_bf16 v[128:131], a[72:75], a[32:35], v[128:131]
    s_cmp_ge_u32 s3, 27
    s_cbranch_scc1 QG_light
    s_waitcnt vmcnt(19) lgkmcnt(10)
    v_mfma_f32_16x16x32_bf16 a[0:3], a[224:227], a[160:163], 0
    s_waitcnt lgkmcnt(8)
    ds_read_b64_tr_b16 a[248:249], v58 offset:0
    ds_read_b64_tr_b16 a[250:251], v58 offset:1024
    v_mfma_f32_16x16x32_bf16 a[16:19], a[228:231], a[160:163], 0
    s_waitcnt vmcnt(18)
    ds_read_b64_tr_b16 a[252:253], v59 offset:0
    ds_read_b64_tr_b16 a[254:255], v59 offset:1024
    v_mfma_f32_16x16x32_bf16 a[20:23], a[228:231], a[164:167], 0
    s_add_u32 m0, s93, 98304
    v_cvt_pk_bf16_f32 v80, v80, v81
    v_cvt_pk_bf16_f32 v81, v82, v83
    v_mfma_f32_16x16x32_bf16 a[4:7], a[224:227], a[164:167], 0
    s_mov_b32 s94, 1048576
    v_cvt_pk_bf16_f32 v82, v176, v177
    v_cvt_pk_bf16_f32 v83, v178, v179
    s_waitcnt vmcnt(17)
    v_mfma_f32_16x16x32_bf16 a[8:11], a[224:227], a[168:171], 0
    v_cvt_pk_bf16_f32 v64, v64, v65
    v_cvt_pk_bf16_f32 v65, v66, v67
    v_mfma_f32_16x16x32_bf16 a[24:27], a[228:231], a[168:171], 0
    s_waitcnt vmcnt(16)
    v_cvt_pk_bf16_f32 v66, v160, v161
    v_cvt_pk_bf16_f32 v67, v162, v163
    v_mfma_f32_16x16x32_bf16 a[28:31], a[228:231], a[172:175], 0
    v_cvt_pk_bf16_f32 v124, v124, v125
    v_cvt_pk_bf16_f32 v125, v126, v127
    v_mfma_f32_16x16x32_bf16 a[12:15], a[224:227], a[172:175], 0
    s_waitcnt lgkmcnt(2)
    v_cvt_pk_bf16_f32 v126, v220, v221
    v_cvt_pk_bf16_f32 v127, v222, v223
    v_mfma_f32_16x16x32_bf16 a[44:47], a[232:235], a[172:175], 0
    ds_read_b64_tr_b16 a[224:225], v62 offset:18432
    ds_read_b64_tr_b16 a[226:227], v62 offset:18944
    v_mfma_f32_16x16x32_bf16 a[60:63], a[236:239], a[172:175], 0
    ds_read_b64_tr_b16 a[228:229], v63 offset:18432
    ds_read_b64_tr_b16 a[230:231], v63 offset:18944
    v_mfma_f32_16x16x32_bf16 a[56:59], a[236:239], a[168:171], 0
    v_cvt_pk_bf16_f32 v120, v120, v121
    v_cvt_pk_bf16_f32 v121, v122, v123
    v_mfma_f32_16x16x32_bf16 a[40:43], a[232:235], a[168:171], 0
    v_cvt_pk_bf16_f32 v122, v216, v217
    v_cvt_pk_bf16_f32 v123, v218, v219
    v_mfma_f32_16x16x32_bf16 a[36:39], a[232:235], a[164:167], 0
    v_cvt_pk_bf16_f32 v116, v116, v117
    v_cvt_pk_bf16_f32 v117, v118, v119
    v_mfma_f32_16x16x32_bf16 a[52:55], a[236:239], a[164:167], 0
    v_cvt_pk_bf16_f32 v118, v212, v213
    v_cvt_pk_bf16_f32 v119, v214, v215
    v_mfma_f32_16x16x32_bf16 a[48:51], a[236:239], a[160:163], 0
    v_cvt_pk_bf16_f32 v112, v112, v113
    v_cvt_pk_bf16_f32 v113, v114, v115
    v_mfma_f32_16x16x32_bf16 a[32:35], a[232:235], a[160:163], 0
    v_cvt_pk_bf16_f32 v114, v208, v209
    v_cvt_pk_bf16_f32 v115, v210, v211
    v_mfma_f32_16x16x32_bf16 a[64:67], a[240:243], a[160:163], 0
    ds_read_b64_tr_b16 a[232:233], v60 offset:16384
    ds_read_b64_tr_b16 a[234:235], v60 offset:16896
    v_mfma_f32_16x16x32_bf16 a[80:83], a[244:247], a[160:163], 0
    ds_read_b64_tr_b16 a[236:237], v61 offset:16384
    ds_read_b64_tr_b16 a[238:239], v61 offset:16896
    v_mfma_f32_16x16x32_bf16 a[84:87], a[244:247], a[164:167], 0
    v_cvt_pk_bf16_f32 v108, v108, v109
    v_cvt_pk_bf16_f32 v109, v110, v111
    v_mfma_f32_16x16x32_bf16 a[68:71], a[240:243], a[164:167], 0
    v_cvt_pk_bf16_f32 v110, v204, v205
    v_cvt_pk_bf16_f32 v111, v206, v207
    v_mfma_f32_16x16x32_bf16 a[72:75], a[240:243], a[168:171], 0
    v_cvt_pk_bf16_f32 v104, v104, v105
    v_cvt_pk_bf16_f32 v105, v106, v107
    v_mfma_f32_16x16x32_bf16 a[88:91], a[244:247], a[168:171], 0
    v_cvt_pk_bf16_f32 v106, v200, v201
    v_cvt_pk_bf16_f32 v107, v202, v203
    v_mfma_f32_16x16x32_bf16 a[92:95], a[244:247], a[172:175], 0
    v_cvt_pk_bf16_f32 v100, v100, v101
    v_cvt_pk_bf16_f32 v101, v102, v103
    v_mfma_f32_16x16x32_bf16 a[76:79], a[240:243], a[172:175], 0
    v_cvt_pk_bf16_f32 v102, v196, v197
    v_cvt_pk_bf16_f32 v103, v198, v199
    v_mfma_f32_16x16x32_bf16 a[108:111], a[248:251], a[172:175], 0
    s_waitcnt lgkmcnt(0)
    ds_read_b64_tr_b16 a[240:241], v60 offset:18432
    ds_read_b64_tr_b16 a[242:243], v60 offset:18944
    v_mfma_f32_16x16x32_bf16 a[124:127], a[252:255], a[172:175], 0
    ds_read_b64_tr_b16 a[244:245], v61 offset:18432
    ds_read_b64_tr_b16 a[246:247], v61 offset:18944
    v_mfma_f32_16x16x32_bf16 a[120:123], a[252:255], a[168:171], 0
    v_cvt_pk_bf16_f32 v96, v96, v97
    v_cvt_pk_bf16_f32 v97, v98, v99
    v_mfma_f32_16x16x32_bf16 a[104:107], a[248:251], a[168:171], 0
    v_cvt_pk_bf16_f32 v98, v192, v193
    v_cvt_pk_bf16_f32 v99, v194, v195
    v_mfma_f32_16x16x32_bf16 a[100:103], a[248:251], a[164:167], 0
    v_cvt_pk_bf16_f32 v156, v156, v157
    v_cvt_pk_bf16_f32 v157, v158, v159
    v_mfma_f32_16x16x32_bf16 a[116:119], a[252:255], a[164:167], 0
    v_cvt_pk_bf16_f32 v158, v252, v253
    v_cvt_pk_bf16_f32 v159, v254, v255
    v_mfma_f32_16x16x32_bf16 a[112:115], a[252:255], a[160:163], 0
    v_cvt_pk_bf16_f32 v152, v152, v153
    v_cvt_pk_bf16_f32 v153, v154, v155
    v_mfma_f32_16x16x32_bf16 a[96:99], a[248:251], a[160:163], 0
    v_cvt_pk_bf16_f32 v154, v248, v249
    v_cvt_pk_bf16_f32 v155, v250, v251
    v_mfma_f32_16x16x32_bf16 a[128:131], a[224:227], a[160:163], 0
    ds_read_b64_tr_b16 a[248:249], v62 offset:16384
    ds_read_b64_tr_b16 a[250:251], v62 offset:16896
    v_mfma_f32_16x16x32_bf16 a[144:147], a[228:231], a[160:163], 0
    ds_read_b64_tr_b16 a[252:253], v63 offset:16384
    ds_read_b64_tr_b16 a[254:255], v63 offset:16896
    v_mfma_f32_16x16x32_bf16 a[148:151], a[228:231], a[164:167], 0
    v_cvt_pk_bf16_f32 v148, v148, v149
    v_cvt_pk_bf16_f32 v149, v150, v151
    v_mfma_f32_16x16x32_bf16 a[132:135], a[224:227], a[164:167], 0
    v_cvt_pk_bf16_f32 v150, v244, v245
    v_cvt_pk_bf16_f32 v151, v246, v247
    v_mfma_f32_16x16x32_bf16 a[136:139], a[224:227], a[168:171], 0
    v_cvt_pk_bf16_f32 v144, v144, v145
    v_cvt_pk_bf16_f32 v145, v146, v147
    v_mfma_f32_16x16x32_bf16 a[152:155], a[228:231], a[168:171], 0
    v_cvt_pk_bf16_f32 v146, v240, v241
    v_cvt_pk_bf16_f32 v147, v242, v243
    v_mfma_f32_16x16x32_bf16 a[156:159], a[228:231], a[172:175], 0
    v_cvt_pk_bf16_f32 v140, v140, v141
    v_cvt_pk_bf16_f32 v141, v142, v143
    v_mfma_f32_16x16x32_bf16 a[140:143], a[224:227], a[172:175], 0
    v_cvt_pk_bf16_f32 v142, v236, v237
    v_cvt_pk_bf16_f32 v143, v238, v239
    v_mfma_f32_16x16x32_bf16 v[172:175], a[232:235], a[172:175], 0
    ds_read_b64_tr_b16 a[224:225], v52 offset:8192
    ds_read_b64_tr_b16 a[226:227], v52 offset:9216
    v_mfma_f32_16x16x32_bf16 v[188:191], a[236:239], a[172:175], 0
    ds_read_b64_tr_b16 a[228:229], v53 offset:8192
    ds_read_b64_tr_b16 a[230:231], v53 offset:9216
    v_mfma_f32_16x16x32_bf16 v[184:187], a[236:239], a[168:171], 0
    v_cvt_pk_bf16_f32 v136, v136, v137
    v_cvt_pk_bf16_f32 v137, v138, v139
    v_mfma_f32_16x16x32_bf16 v[168:171], a[232:235], a[168:171], 0
    v_cvt_pk_bf16_f32 v138, v232, v233
    v_cvt_pk_bf16_f32 v139, v234, v235
    v_mfma_f32_16x16x32_bf16 v[164:167], a[232:235], a[164:167], 0
    v_cvt_pk_bf16_f32 v132, v132, v133
    v_cvt_pk_bf16_f32 v133, v134, v135
    v_mfma_f32_16x16x32_bf16 v[180:183], a[236:239], a[164:167], 0
    v_cvt_pk_bf16_f32 v134, v228, v229
    v_cvt_pk_bf16_f32 v135, v230, v231
    v_mfma_f32_16x16x32_bf16 v[176:179], a[236:239], a[160:163], 0
    v_cvt_pk_bf16_f32 v128, v128, v129
    v_cvt_pk_bf16_f32 v129, v130, v131
    v_mfma_f32_16x16x32_bf16 v[160:163], a[232:235], a[160:163], 0
    s_waitcnt lgkmcnt(2)
    v_cvt_pk_bf16_f32 v130, v224, v225
    v_cvt_pk_bf16_f32 v131, v226, v227
    v_mfma_f32_16x16x32_bf16 v[192:195], a[240:243], a[160:163], 0
    ds_read_b64_tr_b16 a[232:233], v54 offset:8192
    ds_read_b64_tr_b16 a[234:235], v54 offset:9216
    v_mfma_f32_16x16x32_bf16 v[208:211], a[244:247], a[160:163], 0
    ds_read_b64_tr_b16 a[236:237], v55 offset:8192
    ds_read_b64_tr_b16 a[238:239], v55 offset:9216
    v_mfma_f32_16x16x32_bf16 v[212:215], a[244:247], a[164:167], 0
    buffer_load_dwordx4 a[208:211], v32, s[72:75], s84 offen offset:3072 sc1
    v_mfma_f32_16x16x32_bf16 v[196:199], a[240:243], a[164:167], 0
    buffer_load_dwordx4 v34, s[60:63], s94 offen offset:0 lds
    v_mfma_f32_16x16x32_bf16 v[200:203], a[240:243], a[168:171], 0
    buffer_load_dwordx4 a[212:215], v32, s[72:75], s85 offen offset:3072 sc1
    v_mfma_f32_16x16x32_bf16 v[216:219], a[244:247], a[168:171], 0
    v_mfma_f32_16x16x32_bf16 v[220:223], a[244:247], a[172:175], 0
    buffer_load_dwordx4 a[216:219], v32, s[72:75], s86 offen offset:3072 sc1
    v_mfma_f32_16x16x32_bf16 v[204:207], a[240:243], a[172:175], 0
    v_mfma_f32_16x16x32_bf16 v[236:239], a[248:251], a[172:175], 0
    ds_read_b64_tr_b16 a[240:241], v56 offset:8192
    ds_read_b64_tr_b16 a[242:243], v56 offset:9216
    v_mfma_f32_16x16x32_bf16 v[252:255], a[252:255], a[172:175], 0
    ds_read_b64_tr_b16 a[244:245], v57 offset:8192
    ds_read_b64_tr_b16 a[246:247], v57 offset:9216
    v_mfma_f32_16x16x32_bf16 v[248:251], a[252:255], a[168:171], 0
    buffer_load_dwordx4 a[220:223], v32, s[72:75], s87 offen offset:3072 sc1
    v_mfma_f32_16x16x32_bf16 v[232:235], a[248:251], a[168:171], 0
    buffer_load_dwordx4 v35, s[60:63], s94 offen offset:1024 lds
    v_mfma_f32_16x16x32_bf16 v[228:231], a[248:251], a[164:167], 0
    v_mfma_f32_16x16x32_bf16 v[244:247], a[252:255], a[164:167], 0
    v_mfma_f32_16x16x32_bf16 v[240:243], a[252:255], a[160:163], 0
    v_mfma_f32_16x16x32_bf16 v[224:227], a[248:251], a[160:163], 0
    s_waitcnt vmcnt(21)
    v_mfma_f32_16x16x32_bf16 a[0:3], a[224:227], a[176:179], a[0:3]
    s_waitcnt lgkmcnt(0)
    ds_read_b64_tr_b16 a[248:249], v58 offset:8192
    ds_read_b64_tr_b16 a[250:251], v58 offset:9216
    v_mfma_f32_16x16x32_bf16 a[16:19], a[228:231], a[176:179], a[16:19]
    s_waitcnt vmcnt(20)
    ds_read_b64_tr_b16 a[252:253], v59 offset:8192
    ds_read_b64_tr_b16 a[254:255], v59 offset:9216
    v_mfma_f32_16x16x32_bf16 a[20:23], a[228:231], a[180:183], a[20:23]
    v_add_u32 v32, 4096, v32
    v_mfma_f32_16x16x32_bf16 a[4:7], a[224:227], a[180:183], a[4:7]
    s_waitcnt vmcnt(19)
    buffer_load_dwordx4 a[160:163], v32, s[72:75], s84 offen offset:0 sc1
    v_mfma_f32_16x16x32_bf16 a[8:11], a[224:227], a[184:187], a[8:11]
    buffer_load_dwordx4 v36, s[60:63], s94 offen offset:2048 lds
    v_mfma_f32_16x16x32_bf16 a[24:27], a[228:231], a[184:187], a[24:27]
    s_waitcnt vmcnt(20)
    v_mfma_f32_16x16x32_bf16 a[28:31], a[228:231], a[188:191], a[28:31]
    v_mfma_f32_16x16x32_bf16 a[12:15], a[224:227], a[188:191], a[12:15]
    v_mfma_f32_16x16x32_bf16 a[44:47], a[232:235], a[188:191], a[44:47]
    ds_read_b64_tr_b16 a[224:225], v62 offset:26624
    ds_read_b64_tr_b16 a[226:227], v62 offset:27136
    v_mfma_f32_16x16x32_bf16 a[60:63], a[236:239], a[188:191], a[60:63]
    ds_read_b64_tr_b16 a[228:229], v63 offset:26624
    ds_read_b64_tr_b16 a[230:231], v63 offset:27136
    v_mfma_f32_16x16x32_bf16 a[56:59], a[236:239], a[184:187], a[56:59]
    buffer_load_dwordx4 v37, s[60:63], s94 offen offset:3072 lds
    v_mfma_f32_16x16x32_bf16 a[40:43], a[232:235], a[184:187], a[40:43]
    s_add_u32 m0, s93, 114688
    buffer_load_dwordx4 a[164:167], v32, s[72:75], s85 offen offset:0 sc1
    v_mfma_f32_16x16x32_bf16 a[36:39], a[232:235], a[180:183], a[36:39]
    s_mov_b32 s95, 442368
    v_mfma_f32_16x16x32_bf16 a[52:55], a[236:239], a[180:183], a[52:55]
    v_mfma_f32_16x16x32_bf16 a[48:51], a[236:239], a[176:179], a[48:51]
    v_mfma_f32_16x16x32_bf16 a[32:35], a[232:235], a[176:179], a[32:35]
    buffer_load_dwordx4 v38, s[64:67], s95 offen offset:0 lds
    v_mfma_f32_16x16x32_bf16 a[64:67], a[240:243], a[176:179], a[64:67]
    ds_read_b64_tr_b16 a[232:233], v60 offset:24576
    ds_read_b64_tr_b16 a[234:235], v60 offset:25088
    v_mfma_f32_16x16x32_bf16 a[80:83], a[244:247], a[176:179], a[80:83]
    ds_read_b64_tr_b16 a[236:237], v61 offset:24576
    ds_read_b64_tr_b16 a[238:239], v61 offset:25088
    v_mfma_f32_16x16x32_bf16 a[84:87], a[244:247], a[180:183], a[84:87]
    v_mfma_f32_16x16x32_bf16 a[68:71], a[240:243], a[180:183], a[68:71]
    buffer_load_dwordx4 a[168:171], v32, s[72:75], s86 offen offset:0 sc1
    v_mfma_f32_16x16x32_bf16 a[72:75], a[240:243], a[184:187], a[72:75]
    buffer_load_dwordx4 v39, s[64:67], s95 offen offset:1024 lds
    v_mfma_f32_16x16x32_bf16 a[88:91], a[244:247], a[184:187], a[88:91]
    v_mfma_f32_16x16x32_bf16 a[92:95], a[244:247], a[188:191], a[92:95]
    v_mfma_f32_16x16x32_bf16 a[76:79], a[240:243], a[188:191], a[76:79]
    s_waitcnt lgkmcnt(2)
    v_mfma_f32_16x16x32_bf16 a[108:111], a[248:251], a[188:191], a[108:111]
    ds_read_b64_tr_b16 a[240:241], v60 offset:26624
    ds_read_b64_tr_b16 a[242:243], v60 offset:27136
    v_mfma_f32_16x16x32_bf16 a[124:127], a[252:255], a[188:191], a[124:127]
    ds_read_b64_tr_b16 a[244:245], v61 offset:26624
    ds_read_b64_tr_b16 a[246:247], v61 offset:27136
    v_mfma_f32_16x16x32_bf16 a[120:123], a[252:255], a[184:187], a[120:123]
    buffer_load_dwordx4 v38, s[68:71], s95 offen offset:2048 lds
    v_mfma_f32_16x16x32_bf16 a[104:107], a[248:251], a[184:187], a[104:107]
    buffer_load_dwordx4 a[172:175], v32, s[72:75], s87 offen offset:0 sc1
    v_mfma_f32_16x16x32_bf16 a[100:103], a[248:251], a[180:183], a[100:103]
    v_mfma_f32_16x16x32_bf16 a[116:119], a[252:255], a[180:183], a[116:119]
    v_mfma_f32_16x16x32_bf16 a[112:115], a[252:255], a[176:179], a[112:115]
    v_mfma_f32_16x16x32_bf16 a[96:99], a[248:251], a[176:179], a[96:99]
    buffer_load_dwordx4 v39, s[68:71], s95 offen offset:3072 lds
    v_mfma_f32_16x16x32_bf16 a[128:131], a[224:227], a[176:179], a[128:131]
    ds_read_b64_tr_b16 a[248:249], v62 offset:24576
    ds_read_b64_tr_b16 a[250:251], v62 offset:25088
    v_mfma_f32_16x16x32_bf16 a[144:147], a[228:231], a[176:179], a[144:147]
    ds_read_b64_tr_b16 a[252:253], v63 offset:24576
    ds_read_b64_tr_b16 a[254:255], v63 offset:25088
    v_mfma_f32_16x16x32_bf16 a[148:151], a[228:231], a[180:183], a[148:151]
    v_mfma_f32_16x16x32_bf16 a[132:135], a[224:227], a[180:183], a[132:135]
    v_mfma_f32_16x16x32_bf16 a[136:139], a[224:227], a[184:187], a[136:139]
    v_mfma_f32_16x16x32_bf16 a[152:155], a[228:231], a[184:187], a[152:155]
    v_mfma_f32_16x16x32_bf16 a[156:159], a[228:231], a[188:191], a[156:159]
    v_mfma_f32_16x16x32_bf16 a[140:143], a[224:227], a[188:191], a[140:143]
    s_waitcnt vmcnt(36) lgkmcnt(0)
    v_mfma_f32_16x16x32_bf16 v[172:175], a[232:235], a[188:191], v[172:175]
    s_barrier
    ds_read_b64_tr_b16 a[224:225], v40 offset:0
    ds_read_b64_tr_b16 a[226:227], v40 offset:1024
    v_mfma_f32_16x16x32_bf16 v[188:191], a[236:239], a[188:191], v[188:191]
    s_add_u32 m0, s93, 131072
    ds_read_b64_tr_b16 a[228:229], v41 offset:0
    ds_read_b64_tr_b16 a[230:231], v41 offset:1024
    v_mfma_f32_16x16x32_bf16 v[184:187], a[236:239], a[184:187], v[184:187]
    s_mov_b32 s94, 1572864
    v_mfma_f32_16x16x32_bf16 v[168:171], a[232:235], a[184:187], v[168:171]
    buffer_load_dwordx4 v34, s[60:63], s94 offen offset:0 lds
    v_mfma_f32_16x16x32_bf16 v[164:167], a[232:235], a[180:183], v[164:167]
    v_mfma_f32_16x16x32_bf16 v[180:183], a[236:239], a[180:183], v[180:183]
    v_mfma_f32_16x16x32_bf16 v[176:179], a[236:239], a[176:179], v[176:179]
    v_mfma_f32_16x16x32_bf16 v[160:163], a[232:235], a[176:179], v[160:163]
    v_mfma_f32_16x16x32_bf16 v[192:195], a[240:243], a[176:179], v[192:195]
    ds_read_b64_tr_b16 a[232:233], v42 offset:0
    ds_read_b64_tr_b16 a[234:235], v42 offset:1024
    v_mfma_f32_16x16x32_bf16 v[208:211], a[244:247], a[176:179], v[208:211]
    ds_read_b64_tr_b16 a[236:237], v43 offset:0
    ds_read_b64_tr_b16 a[238:239], v43 offset:1024
    v_mfma_f32_16x16x32_bf16 v[212:215], a[244:247], a[180:183], v[212:215]
    v_mfma_f32_16x16x32_bf16 v[196:199], a[240:243], a[180:183], v[196:199]
    buffer_load_dwordx4 v35, s[60:63], s94 offen offset:1024 lds
    v_mfma_f32_16x16x32_bf16 v[200:203], a[240:243], a[184:187], v[200:203]
    v_mfma_f32_16x16x32_bf16 v[216:219], a[244:247], a[184:187], v[216:219]
    v_mfma_f32_16x16x32_bf16 v[220:223], a[244:247], a[188:191], v[220:223]
    v_mfma_f32_16x16x32_bf16 v[204:207], a[240:243], a[188:191], v[204:207]
    v_mfma_f32_16x16x32_bf16 v[236:239], a[248:251], a[188:191], v[236:239]
    ds_read_b64_tr_b16 a[240:241], v44 offset:0
    ds_read_b64_tr_b16 a[242:243], v44 offset:1024
    v_mfma_f32_16x16x32_bf16 v[252:255], a[252:255], a[188:191], v[252:255]
    ds_read_b64_tr_b16 a[244:245], v45 offset:0
    ds_read_b64_tr_b16 a[246:247], v45 offset:1024
    v_mfma_f32_16x16x32_bf16 v[248:251], a[252:255], a[184:187], v[248:251]
    v_mfma_f32_16x16x32_bf16 v[232:235], a[248:251], a[184:187], v[232:235]
    buffer_load_dwordx4 v36, s[60:63], s94 offen offset:2048 lds
    v_mfma_f32_16x16x32_bf16 v[228:231], a[248:251], a[180:183], v[228:231]
    v_mfma_f32_16x16x32_bf16 v[244:247], a[252:255], a[180:183], v[244:247]
    v_mfma_f32_16x16x32_bf16 v[240:243], a[252:255], a[176:179], v[240:243]
    v_mfma_f32_16x16x32_bf16 v[224:227], a[248:251], a[176:179], v[224:227]
    s_waitcnt lgkmcnt(2) vmcnt(30)
    v_mfma_f32_16x16x32_bf16 a[0:3], a[224:227], a[192:195], a[0:3]
    ds_read_b64_tr_b16 a[248:249], v46 offset:0
    ds_read_b64_tr_b16 a[250:251], v46 offset:1024
    v_mfma_f32_16x16x32_bf16 a[16:19], a[228:231], a[192:195], a[16:19]
    s_waitcnt vmcnt(29)
    ds_read_b64_tr_b16 a[252:253], v47 offset:0
    ds_read_b64_tr_b16 a[254:255], v47 offset:1024
    v_mfma_f32_16x16x32_bf16 a[20:23], a[228:231], a[196:199], a[20:23]
    v_mfma_f32_16x16x32_bf16 a[4:7], a[224:227], a[196:199], a[4:7]
    s_waitcnt vmcnt(27)
    buffer_load_dwordx4 a[176:179], v32, s[72:75], s84 offen offset:1024 sc1
    v_mfma_f32_16x16x32_bf16 a[8:11], a[224:227], a[200:203], a[8:11]
    s_waitcnt vmcnt(27)
    buffer_load_dwordx4 v37, s[60:63], s94 offen offset:3072 lds
    v_mfma_f32_16x16x32_bf16 a[24:27], a[228:231], a[200:203], a[24:27]
    s_add_u32 m0, s93, 147456
    v_mfma_f32_16x16x32_bf16 a[28:31], a[228:231], a[204:207], a[28:31]
    s_mov_b32 s95, 663552
    v_mfma_f32_16x16x32_bf16 a[12:15], a[224:227], a[204:207], a[12:15]
    v_mfma_f32_16x16x32_bf16 a[44:47], a[232:235], a[204:207], a[44:47]
    ds_read_b64_tr_b16 a[224:225], v50 offset:18432
    ds_read_b64_tr_b16 a[226:227], v50 offset:18944
    v_mfma_f32_16x16x32_bf16 a[60:63], a[236:239], a[204:207], a[60:63]
    ds_read_b64_tr_b16 a[228:229], v51 offset:18432
    ds_read_b64_tr_b16 a[230:231], v51 offset:18944
    v_mfma_f32_16x16x32_bf16 a[56:59], a[236:239], a[200:203], a[56:59]
    v_mfma_f32_16x16x32_bf16 a[40:43], a[232:235], a[200:203], a[40:43]
    buffer_load_dwordx4 a[180:183], v32, s[72:75], s85 offen offset:1024 sc1
    v_mfma_f32_16x16x32_bf16 a[36:39], a[232:235], a[196:199], a[36:39]
    buffer_load_dwordx4 v38, s[64:67], s95 offen offset:0 lds
    v_mfma_f32_16x16x32_bf16 a[52:55], a[236:239], a[196:199], a[52:55]
    v_mfma_f32_16x16x32_bf16 a[48:51], a[236:239], a[192:195], a[48:51]
    v_mfma_f32_16x16x32_bf16 a[32:35], a[232:235], a[192:195], a[32:35]
    v_mfma_f32_16x16x32_bf16 a[64:67], a[240:243], a[192:195], a[64:67]
    s_waitcnt lgkmcnt(0)
    ds_read_b64_tr_b16 a[232:233], v48 offset:16384
    ds_read_b64_tr_b16 a[234:235], v48 offset:16896
    v_mfma_f32_16x16x32_bf16 a[80:83], a[244:247], a[192:195], a[80:83]
    ds_read_b64_tr_b16 a[236:237], v49 offset:16384
    ds_read_b64_tr_b16 a[238:239], v49 offset:16896
    v_mfma_f32_16x16x32_bf16 a[84:87], a[244:247], a[196:199], a[84:87]
    v_mfma_f32_16x16x32_bf16 a[68:71], a[240:243], a[196:199], a[68:71]
    buffer_load_dwordx4 a[184:187], v32, s[72:75], s86 offen offset:1024 sc1
    v_mfma_f32_16x16x32_bf16 a[72:75], a[240:243], a[200:203], a[72:75]
    buffer_load_dwordx4 v39, s[64:67], s95 offen offset:1024 lds
    v_mfma_f32_16x16x32_bf16 a[88:91], a[244:247], a[200:203], a[88:91]
    v_mfma_f32_16x16x32_bf16 a[92:95], a[244:247], a[204:207], a[92:95]
    s_mov_b32 s96, 0
    buffer_store_dwordx4 v[64:67], v31, s[44:47], s96 offen offset:2048 sc1
    v_mfma_f32_16x16x32_bf16 a[76:79], a[240:243], a[204:207], a[76:79]
    v_mfma_f32_16x16x32_bf16 a[108:111], a[248:251], a[204:207], a[108:111]
    ds_read_b64_tr_b16 a[240:241], v48 offset:18432
    ds_read_b64_tr_b16 a[242:243], v48 offset:18944
    v_mfma_f32_16x16x32_bf16 a[124:127], a[252:255], a[204:207], a[124:127]
    ds_read_b64_tr_b16 a[244:245], v49 offset:18432
    ds_read_b64_tr_b16 a[246:247], v49 offset:18944
    v_mfma_f32_16x16x32_bf16 a[120:123], a[252:255], a[200:203], a[120:123]
    v_mfma_f32_16x16x32_bf16 a[104:107], a[248:251], a[200:203], a[104:107]
    buffer_load_dwordx4 a[188:191], v32, s[72:75], s87 offen offset:1024 sc1
    v_mfma_f32_16x16x32_bf16 a[100:103], a[248:251], a[196:199], a[100:103]
    buffer_load_dwordx4 v38, s[68:71], s95 offen offset:2048 lds
    v_mfma_f32_16x16x32_bf16 a[116:119], a[252:255], a[196:199], a[116:119]
    v_mfma_f32_16x16x32_bf16 a[112:115], a[252:255], a[192:195], a[112:115]
    v_mfma_f32_16x16x32_bf16 a[96:99], a[248:251], a[192:195], a[96:99]
    v_mfma_f32_16x16x32_bf16 a[128:131], a[224:227], a[192:195], a[128:131]
    ds_read_b64_tr_b16 a[248:249], v50 offset:16384
    ds_read_b64_tr_b16 a[250:251], v50 offset:16896
    v_mfma_f32_16x16x32_bf16 a[144:147], a[228:231], a[192:195], a[144:147]
    ds_read_b64_tr_b16 a[252:253], v51 offset:16384
    ds_read_b64_tr_b16 a[254:255], v51 offset:16896
    v_mfma_f32_16x16x32_bf16 a[148:151], a[228:231], a[196:199], a[148:151]
    v_mfma_f32_16x16x32_bf16 a[132:135], a[224:227], a[196:199], a[132:135]
    v_mfma_f32_16x16x32_bf16 a[136:139], a[224:227], a[200:203], a[136:139]
    buffer_load_dwordx4 v39, s[68:71], s95 offen offset:3072 lds
    v_mfma_f32_16x16x32_bf16 a[152:155], a[228:231], a[200:203], a[152:155]
    v_mfma_f32_16x16x32_bf16 a[156:159], a[228:231], a[204:207], a[156:159]
    v_mfma_f32_16x16x32_bf16 a[140:143], a[224:227], a[204:207], a[140:143]
    s_waitcnt lgkmcnt(2)
    v_mfma_f32_16x16x32_bf16 v[172:175], a[232:235], a[204:207], v[172:175]
    ds_read_b64_tr_b16 a[224:225], v40 offset:8192
    ds_read_b64_tr_b16 a[226:227], v40 offset:9216
    v_mfma_f32_16x16x32_bf16 v[188:191], a[236:239], a[204:207], v[188:191]
    ds_read_b64_tr_b16 a[228:229], v41 offset:8192
    ds_read_b64_tr_b16 a[230:231], v41 offset:9216
    v_mfma_f32_16x16x32_bf16 v[184:187], a[236:239], a[200:203], v[184:187]
    v_mfma_f32_16x16x32_bf16 v[168:171], a[232:235], a[200:203], v[168:171]
    v_mfma_f32_16x16x32_bf16 v[164:167], a[232:235], a[196:199], v[164:167]
    v_mfma_f32_16x16x32_bf16 v[180:183], a[236:239], a[196:199], v[180:183]
    v_mfma_f32_16x16x32_bf16 v[176:179], a[236:239], a[192:195], v[176:179]
    v_mfma_f32_16x16x32_bf16 v[160:163], a[232:235], a[192:195], v[160:163]
    s_mov_b32 s96, 8192
    buffer_store_dwordx4 v[68:71], v31, s[44:47], s96 offen offset:2048 sc1
    v_mfma_f32_16x16x32_bf16 v[192:195], a[240:243], a[192:195], v[192:195]
    ds_read_b64_tr_b16 a[232:233], v42 offset:8192
    ds_read_b64_tr_b16 a[234:235], v42 offset:9216
    v_mfma_f32_16x16x32_bf16 v[208:211], a[244:247], a[192:195], v[208:211]
    ds_read_b64_tr_b16 a[236:237], v43 offset:8192
    ds_read_b64_tr_b16 a[238:239], v43 offset:9216
    v_mfma_f32_16x16x32_bf16 v[212:215], a[244:247], a[196:199], v[212:215]
    v_mfma_f32_16x16x32_bf16 v[196:199], a[240:243], a[196:199], v[196:199]
    v_mfma_f32_16x16x32_bf16 v[200:203], a[240:243], a[200:203], v[200:203]
    v_mfma_f32_16x16x32_bf16 v[216:219], a[244:247], a[200:203], v[216:219]
    v_mfma_f32_16x16x32_bf16 v[220:223], a[244:247], a[204:207], v[220:223]
    v_mfma_f32_16x16x32_bf16 v[204:207], a[240:243], a[204:207], v[204:207]
    v_mfma_f32_16x16x32_bf16 v[236:239], a[248:251], a[204:207], v[236:239]
    s_waitcnt lgkmcnt(0)
    ds_read_b64_tr_b16 a[240:241], v44 offset:8192
    ds_read_b64_tr_b16 a[242:243], v44 offset:9216
    v_mfma_f32_16x16x32_bf16 v[252:255], a[252:255], a[204:207], v[252:255]
    ds_read_b64_tr_b16 a[244:245], v45 offset:8192
    ds_read_b64_tr_b16 a[246:247], v45 offset:9216
    v_mfma_f32_16x16x32_bf16 v[248:251], a[252:255], a[200:203], v[248:251]
    v_mfma_f32_16x16x32_bf16 v[232:235], a[248:251], a[200:203], v[232:235]
    v_mfma_f32_16x16x32_bf16 v[228:231], a[248:251], a[196:199], v[228:231]
    v_mfma_f32_16x16x32_bf16 v[244:247], a[252:255], a[196:199], v[244:247]
    v_mfma_f32_16x16x32_bf16 v[240:243], a[252:255], a[192:195], v[240:243]
    v_mfma_f32_16x16x32_bf16 v[224:227], a[248:251], a[192:195], v[224:227]
    s_waitcnt vmcnt(29)
    v_mfma_f32_16x16x32_bf16 a[0:3], a[224:227], a[208:211], a[0:3]
    ds_read_b64_tr_b16 a[248:249], v46 offset:8192
    ds_read_b64_tr_b16 a[250:251], v46 offset:9216
    v_mfma_f32_16x16x32_bf16 a[16:19], a[228:231], a[208:211], a[16:19]
    s_waitcnt vmcnt(27)
    ds_read_b64_tr_b16 a[252:253], v47 offset:8192
    ds_read_b64_tr_b16 a[254:255], v47 offset:9216
    v_mfma_f32_16x16x32_bf16 a[20:23], a[228:231], a[212:215], a[20:23]
    v_mfma_f32_16x16x32_bf16 a[4:7], a[224:227], a[212:215], a[4:7]
    s_waitcnt vmcnt(26)
    buffer_load_dwordx4 a[192:195], v32, s[72:75], s84 offen offset:2048 sc1
    v_mfma_f32_16x16x32_bf16 a[8:11], a[224:227], a[216:219], a[8:11]
    v_mfma_f32_16x16x32_bf16 a[24:27], a[228:231], a[216:219], a[24:27]
    s_waitcnt vmcnt(26)
    v_mfma_f32_16x16x32_bf16 a[28:31], a[228:231], a[220:223], a[28:31]
    v_mfma_f32_16x16x32_bf16 a[12:15], a[224:227], a[220:223], a[12:15]
    v_mfma_f32_16x16x32_bf16 a[44:47], a[232:235], a[220:223], a[44:47]
    s_mov_b32 s96, 33792
    ds_read_b64_tr_b16 a[224:225], v50 offset:26624
    ds_read_b64_tr_b16 a[226:227], v50 offset:27136
    v_mfma_f32_16x16x32_bf16 a[60:63], a[236:239], a[220:223], a[60:63]
    ds_read_b64_tr_b16 a[228:229], v51 offset:26624
    ds_read_b64_tr_b16 a[230:231], v51 offset:27136
    v_mfma_f32_16x16x32_bf16 a[56:59], a[236:239], a[216:219], a[56:59]
    buffer_store_dwordx4 v[72:75], v31, s[44:47], s96 offen offset:2048 sc1
    v_mfma_f32_16x16x32_bf16 a[40:43], a[232:235], a[216:219], a[40:43]
    buffer_load_dwordx4 a[196:199], v32, s[72:75], s85 offen offset:2048 sc1
    v_mfma_f32_16x16x32_bf16 a[36:39], a[232:235], a[212:215], a[36:39]
    v_mfma_f32_16x16x32_bf16 a[52:55], a[236:239], a[212:215], a[52:55]
    v_mfma_f32_16x16x32_bf16 a[48:51], a[236:239], a[208:211], a[48:51]
    v_mfma_f32_16x16x32_bf16 a[32:35], a[232:235], a[208:211], a[32:35]
    s_waitcnt lgkmcnt(2)
    v_mfma_f32_16x16x32_bf16 a[64:67], a[240:243], a[208:211], a[64:67]
    ds_read_b64_tr_b16 a[232:233], v48 offset:24576
    ds_read_b64_tr_b16 a[234:235], v48 offset:25088
    v_mfma_f32_16x16x32_bf16 a[80:83], a[244:247], a[208:211], a[80:83]
    ds_read_b64_tr_b16 a[236:237], v49 offset:24576
    ds_read_b64_tr_b16 a[238:239], v49 offset:25088
    v_mfma_f32_16x16x32_bf16 a[84:87], a[244:247], a[212:215], a[84:87]
    v_mfma_f32_16x16x32_bf16 a[68:71], a[240:243], a[212:215], a[68:71]
    buffer_load_dwordx4 a[200:203], v32, s[72:75], s86 offen offset:2048 sc1
    v_mfma_f32_16x16x32_bf16 a[72:75], a[240:243], a[216:219], a[72:75]
    v_mfma_f32_16x16x32_bf16 a[88:91], a[244:247], a[216:219], a[88:91]
    v_mfma_f32_16x16x32_bf16 a[92:95], a[244:247], a[220:223], a[92:95]
    v_mfma_f32_16x16x32_bf16 a[76:79], a[240:243], a[220:223], a[76:79]
    v_mfma_f32_16x16x32_bf16 a[108:111], a[248:251], a[220:223], a[108:111]
    ds_read_b64_tr_b16 a[240:241], v48 offset:26624
    ds_read_b64_tr_b16 a[242:243], v48 offset:27136
    v_mfma_f32_16x16x32_bf16 a[124:127], a[252:255], a[220:223], a[124:127]
    ds_read_b64_tr_b16 a[244:245], v49 offset:26624
    ds_read_b64_tr_b16 a[246:247], v49 offset:27136
    v_mfma_f32_16x16x32_bf16 a[120:123], a[252:255], a[216:219], a[120:123]
    v_mfma_f32_16x16x32_bf16 a[104:107], a[248:251], a[216:219], a[104:107]
    buffer_load_dwordx4 a[204:207], v32, s[72:75], s87 offen offset:2048 sc1
    v_mfma_f32_16x16x32_bf16 a[100:103], a[248:251], a[212:215], a[100:103]
    v_mfma_f32_16x16x32_bf16 a[116:119], a[252:255], a[212:215], a[116:119]
    v_mfma_f32_16x16x32_bf16 a[112:115], a[252:255], a[208:211], a[112:115]
    v_mfma_f32_16x16x32_bf16 a[96:99], a[248:251], a[208:211], a[96:99]
    v_mfma_f32_16x16x32_bf16 a[128:131], a[224:227], a[208:211], a[128:131]
    s_waitcnt lgkmcnt(0)
    ds_read_b64_tr_b16 a[248:249], v50 offset:24576
    ds_read_b64_tr_b16 a[250:251], v50 offset:25088
    v_mfma_f32_16x16x32_bf16 a[144:147], a[228:231], a[208:211], a[144:147]
    ds_read_b64_tr_b16 a[252:253], v51 offset:24576
    ds_read_b64_tr_b16 a[254:255], v51 offset:25088
    v_mfma_f32_16x16x32_bf16 a[148:151], a[228:231], a[212:215], a[148:151]
    s_mov_b32 s96, 41984
    buffer_store_dwordx4 v[76:79], v31, s[44:47], s96 offen offset:2048 sc1
    v_mfma_f32_16x16x32_bf16 a[132:135], a[224:227], a[212:215], a[132:135]
    v_mfma_f32_16x16x32_bf16 a[136:139], a[224:227], a[216:219], a[136:139]
    v_mfma_f32_16x16x32_bf16 a[152:155], a[228:231], a[216:219], a[152:155]
    v_mfma_f32_16x16x32_bf16 a[156:159], a[228:231], a[220:223], a[156:159]
    v_mfma_f32_16x16x32_bf16 a[140:143], a[224:227], a[220:223], a[140:143]
    s_waitcnt vmcnt(20) lgkmcnt(0)
    v_mfma_f32_16x16x32_bf16 v[172:175], a[232:235], a[220:223], v[172:175]
    s_barrier
    ds_read_b64_tr_b16 a[224:225], v40 offset:32768
    ds_read_b64_tr_b16 a[226:227], v40 offset:33792
    v_mfma_f32_16x16x32_bf16 v[188:191], a[236:239], a[220:223], v[188:191]
    s_add_u32 m0, s93, 65536
    ds_read_b64_tr_b16 a[228:229], v41 offset:32768
    ds_read_b64_tr_b16 a[230:231], v41 offset:33792
    v_mfma_f32_16x16x32_bf16 v[184:187], a[236:239], a[216:219], v[184:187]
    s_mov_b32 s94, 2097152
    v_mfma_f32_16x16x32_bf16 v[168:171], a[232:235], a[216:219], v[168:171]
    buffer_load_dwordx4 v34, s[60:63], s94 offen offset:0 lds
    v_mfma_f32_16x16x32_bf16 v[164:167], a[232:235], a[212:215], v[164:167]
    v_mfma_f32_16x16x32_bf16 v[180:183], a[236:239], a[212:215], v[180:183]
    v_mfma_f32_16x16x32_bf16 v[176:179], a[236:239], a[208:211], v[176:179]
    v_mfma_f32_16x16x32_bf16 v[160:163], a[232:235], a[208:211], v[160:163]
    v_mfma_f32_16x16x32_bf16 v[192:195], a[240:243], a[208:211], v[192:195]
    ds_read_b64_tr_b16 a[232:233], v42 offset:32768
    ds_read_b64_tr_b16 a[234:235], v42 offset:33792
    v_mfma_f32_16x16x32_bf16 v[208:211], a[244:247], a[208:211], v[208:211]
    ds_read_b64_tr_b16 a[236:237], v43 offset:32768
    ds_read_b64_tr_b16 a[238:239], v43 offset:33792
    v_mfma_f32_16x16x32_bf16 v[212:215], a[244:247], a[212:215], v[212:215]
    v_mfma_f32_16x16x32_bf16 v[196:199], a[240:243], a[212:215], v[196:199]
    buffer_load_dwordx4 v35, s[60:63], s94 offen offset:1024 lds
    v_mfma_f32_16x16x32_bf16 v[200:203], a[240:243], a[216:219], v[200:203]
    v_mfma_f32_16x16x32_bf16 v[216:219], a[244:247], a[216:219], v[216:219]
    v_mfma_f32_16x16x32_bf16 v[220:223], a[244:247], a[220:223], v[220:223]
    v_mfma_f32_16x16x32_bf16 v[204:207], a[240:243], a[220:223], v[204:207]
    v_mfma_f32_16x16x32_bf16 v[236:239], a[248:251], a[220:223], v[236:239]
    ds_read_b64_tr_b16 a[240:241], v44 offset:32768
    ds_read_b64_tr_b16 a[242:243], v44 offset:33792
    v_mfma_f32_16x16x32_bf16 v[252:255], a[252:255], a[220:223], v[252:255]
    ds_read_b64_tr_b16 a[244:245], v45 offset:32768
    ds_read_b64_tr_b16 a[246:247], v45 offset:33792
    v_mfma_f32_16x16x32_bf16 v[248:251], a[252:255], a[216:219], v[248:251]
    v_mfma_f32_16x16x32_bf16 v[232:235], a[248:251], a[216:219], v[232:235]
    s_mov_b32 s96, 0
    buffer_load_dwordx4 v36, s[60:63], s94 offen offset:2048 lds
    v_mfma_f32_16x16x32_bf16 v[228:231], a[248:251], a[212:215], v[228:231]
    buffer_store_dwordx4 v[80:83], v31, s[44:47], s96 offen offset:3072 sc1
    v_mfma_f32_16x16x32_bf16 v[244:247], a[252:255], a[212:215], v[244:247]
    v_mfma_f32_16x16x32_bf16 v[240:243], a[252:255], a[208:211], v[240:243]
    v_mfma_f32_16x16x32_bf16 v[224:227], a[248:251], a[208:211], v[224:227]
    s_waitcnt lgkmcnt(2) vmcnt(33)
    v_mfma_f32_16x16x32_bf16 a[0:3], a[224:227], a[160:163], a[0:3]
    ds_read_b64_tr_b16 a[248:249], v46 offset:32768
    ds_read_b64_tr_b16 a[250:251], v46 offset:33792
    v_mfma_f32_16x16x32_bf16 a[16:19], a[228:231], a[160:163], a[16:19]
    s_waitcnt vmcnt(30)
    ds_read_b64_tr_b16 a[252:253], v47 offset:32768
    ds_read_b64_tr_b16 a[254:255], v47 offset:33792
    v_mfma_f32_16x16x32_bf16 a[20:23], a[228:231], a[164:167], a[20:23]
    v_mfma_f32_16x16x32_bf16 a[4:7], a[224:227], a[164:167], a[4:7]
    s_waitcnt vmcnt(28)
    buffer_load_dwordx4 a[208:211], v32, s[72:75], s84 offen offset:3072 sc1
    v_mfma_f32_16x16x32_bf16 a[8:11], a[224:227], a[168:171], a[8:11]
    s_waitcnt vmcnt(26)
    buffer_load_dwordx4 v37, s[60:63], s94 offen offset:3072 lds
    v_mfma_f32_16x16x32_bf16 a[24:27], a[228:231], a[168:171], a[24:27]
    s_add_u32 m0, s93, 81920
    v_mfma_f32_16x16x32_bf16 a[28:31], a[228:231], a[172:175], a[28:31]
    s_mov_b32 s95, 884736
    v_mfma_f32_16x16x32_bf16 a[12:15], a[224:227], a[172:175], a[12:15]
    v_mfma_f32_16x16x32_bf16 a[44:47], a[232:235], a[172:175], a[44:47]
    ds_read_b64_tr_b16 a[224:225], v50 offset:51200
    ds_read_b64_tr_b16 a[226:227], v50 offset:51712
    v_mfma_f32_16x16x32_bf16 a[60:63], a[236:239], a[172:175], a[60:63]
    ds_read_b64_tr_b16 a[228:229], v51 offset:51200
    ds_read_b64_tr_b16 a[230:231], v51 offset:51712
    v_mfma_f32_16x16x32_bf16 a[56:59], a[236:239], a[168:171], a[56:59]
    v_mfma_f32_16x16x32_bf16 a[40:43], a[232:235], a[168:171], a[40:43]
    buffer_load_dwordx4 a[212:215], v32, s[72:75], s85 offen offset:3072 sc1
    v_mfma_f32_16x16x32_bf16 a[36:39], a[232:235], a[164:167], a[36:39]
    buffer_load_dwordx4 v38, s[64:67], s95 offen offset:0 lds
    v_mfma_f32_16x16x32_bf16 a[52:55], a[236:239], a[164:167], a[52:55]
    v_mfma_f32_16x16x32_bf16 a[48:51], a[236:239], a[160:163], a[48:51]
    v_mfma_f32_16x16x32_bf16 a[32:35], a[232:235], a[160:163], a[32:35]
    v_mfma_f32_16x16x32_bf16 a[64:67], a[240:243], a[160:163], a[64:67]
    s_waitcnt lgkmcnt(0)
    ds_read_b64_tr_b16 a[232:233], v48 offset:49152
    ds_read_b64_tr_b16 a[234:235], v48 offset:49664
    v_mfma_f32_16x16x32_bf16 a[80:83], a[244:247], a[160:163], a[80:83]
    ds_read_b64_tr_b16 a[236:237], v49 offset:49152
    ds_read_b64_tr_b16 a[238:239], v49 offset:49664
    v_mfma_f32_16x16x32_bf16 a[84:87], a[244:247], a[164:167], a[84:87]
    v_mfma_f32_16x16x32_bf16 a[68:71], a[240:243], a[164:167], a[68:71]
    buffer_load_dwordx4 a[216:219], v32, s[72:75], s86 offen offset:3072 sc1
    v_mfma_f32_16x16x32_bf16 a[72:75], a[240:243], a[168:171], a[72:75]
    buffer_load_dwordx4 v39, s[64:67], s95 offen offset:1024 lds
    v_mfma_f32_16x16x32_bf16 a[88:91], a[244:247], a[168:171], a[88:91]
    s_mov_b32 s96, 8192
    buffer_store_dwordx4 v[84:87], v31, s[44:47], s96 offen offset:3072 sc1
    v_mfma_f32_16x16x32_bf16 a[92:95], a[244:247], a[172:175], a[92:95]
    v_mfma_f32_16x16x32_bf16 a[76:79], a[240:243], a[172:175], a[76:79]
    v_mfma_f32_16x16x32_bf16 a[108:111], a[248:251], a[172:175], a[108:111]
    ds_read_b64_tr_b16 a[240:241], v48 offset:51200
    ds_read_b64_tr_b16 a[242:243], v48 offset:51712
    v_mfma_f32_16x16x32_bf16 a[124:127], a[252:255], a[172:175], a[124:127]
    ds_read_b64_tr_b16 a[244:245], v49 offset:51200
    ds_read_b64_tr_b16 a[246:247], v49 offset:51712
    v_mfma_f32_16x16x32_bf16 a[120:123], a[252:255], a[168:171], a[120:123]
    v_mfma_f32_16x16x32_bf16 a[104:107], a[248:251], a[168:171], a[104:107]
    buffer_load_dwordx4 a[220:223], v32, s[72:75], s87 offen offset:3072 sc1
    v_mfma_f32_16x16x32_bf16 a[100:103], a[248:251], a[164:167], a[100:103]
    buffer_load_dwordx4 v38, s[68:71], s95 offen offset:2048 lds
    v_mfma_f32_16x16x32_bf16 a[116:119], a[252:255], a[164:167], a[116:119]
    v_mfma_f32_16x16x32_bf16 a[112:115], a[252:255], a[160:163], a[112:115]
    v_mfma_f32_16x16x32_bf16 a[96:99], a[248:251], a[160:163], a[96:99]
    v_mfma_f32_16x16x32_bf16 a[128:131], a[224:227], a[160:163], a[128:131]
    ds_read_b64_tr_b16 a[248:249], v50 offset:49152
    ds_read_b64_tr_b16 a[250:251], v50 offset:49664
    v_mfma_f32_16x16x32_bf16 a[144:147], a[228:231], a[160:163], a[144:147]
    ds_read_b64_tr_b16 a[252:253], v51 offset:49152
    ds_read_b64_tr_b16 a[254:255], v51 offset:49664
    v_mfma_f32_16x16x32_bf16 a[148:151], a[228:231], a[164:167], a[148:151]
    v_mfma_f32_16x16x32_bf16 a[132:135], a[224:227], a[164:167], a[132:135]
    v_mfma_f32_16x16x32_bf16 a[136:139], a[224:227], a[168:171], a[136:139]
    buffer_load_dwordx4 v39, s[68:71], s95 offen offset:3072 lds
    v_mfma_f32_16x16x32_bf16 a[152:155], a[228:231], a[168:171], a[152:155]
    v_mfma_f32_16x16x32_bf16 a[156:159], a[228:231], a[172:175], a[156:159]
    v_mfma_f32_16x16x32_bf16 a[140:143], a[224:227], a[172:175], a[140:143]
    s_waitcnt lgkmcnt(2)
    v_mfma_f32_16x16x32_bf16 v[172:175], a[232:235], a[172:175], v[172:175]
    ds_read_b64_tr_b16 a[224:225], v40 offset:40960
    ds_read_b64_tr_b16 a[226:227], v40 offset:41984
    v_mfma_f32_16x16x32_bf16 v[188:191], a[236:239], a[172:175], v[188:191]
    ds_read_b64_tr_b16 a[228:229], v41 offset:40960
    ds_read_b64_tr_b16 a[230:231], v41 offset:41984
    v_mfma_f32_16x16x32_bf16 v[184:187], a[236:239], a[168:171], v[184:187]
    v_mfma_f32_16x16x32_bf16 v[168:171], a[232:235], a[168:171], v[168:171]
    v_mfma_f32_16x16x32_bf16 v[164:167], a[232:235], a[164:167], v[164:167]
    v_mfma_f32_16x16x32_bf16 v[180:183], a[236:239], a[164:167], v[180:183]
    v_mfma_f32_16x16x32_bf16 v[176:179], a[236:239], a[160:163], v[176:179]
    s_mov_b32 s96, 33792
    buffer_store_dwordx4 v[88:91], v31, s[44:47], s96 offen offset:3072 sc1
    v_mfma_f32_16x16x32_bf16 v[160:163], a[232:235], a[160:163], v[160:163]
    v_mfma_f32_16x16x32_bf16 v[192:195], a[240:243], a[160:163], v[192:195]
    ds_read_b64_tr_b16 a[232:233], v42 offset:40960
    ds_read_b64_tr_b16 a[234:235], v42 offset:41984
    v_mfma_f32_16x16x32_bf16 v[208:211], a[244:247], a[160:163], v[208:211]
    ds_read_b64_tr_b16 a[236:237], v43 offset:40960
    ds_read_b64_tr_b16 a[238:239], v43 offset:41984
    v_mfma_f32_16x16x32_bf16 v[212:215], a[244:247], a[164:167], v[212:215]
    v_mfma_f32_16x16x32_bf16 v[196:199], a[240:243], a[164:167], v[196:199]
    v_mfma_f32_16x16x32_bf16 v[200:203], a[240:243], a[168:171], v[200:203]
    v_mfma_f32_16x16x32_bf16 v[216:219], a[244:247], a[168:171], v[216:219]
    v_mfma_f32_16x16x32_bf16 v[220:223], a[244:247], a[172:175], v[220:223]
    v_mfma_f32_16x16x32_bf16 v[204:207], a[240:243], a[172:175], v[204:207]
    v_mfma_f32_16x16x32_bf16 v[236:239], a[248:251], a[172:175], v[236:239]
    s_waitcnt lgkmcnt(0)
    ds_read_b64_tr_b16 a[240:241], v44 offset:40960
    ds_read_b64_tr_b16 a[242:243], v44 offset:41984
    v_mfma_f32_16x16x32_bf16 v[252:255], a[252:255], a[172:175], v[252:255]
    ds_read_b64_tr_b16 a[244:245], v45 offset:40960
    ds_read_b64_tr_b16 a[246:247], v45 offset:41984
    v_mfma_f32_16x16x32_bf16 v[248:251], a[252:255], a[168:171], v[248:251]
    v_mfma_f32_16x16x32_bf16 v[232:235], a[248:251], a[168:171], v[232:235]
    v_mfma_f32_16x16x32_bf16 v[228:231], a[248:251], a[164:167], v[228:231]
    v_mfma_f32_16x16x32_bf16 v[244:247], a[252:255], a[164:167], v[244:247]
    v_mfma_f32_16x16x32_bf16 v[240:243], a[252:255], a[160:163], v[240:243]
    v_mfma_f32_16x16x32_bf16 v[224:227], a[248:251], a[160:163], v[224:227]
    s_waitcnt vmcnt(31)
    v_mfma_f32_16x16x32_bf16 a[0:3], a[224:227], a[176:179], a[0:3]
    ds_read_b64_tr_b16 a[248:249], v46 offset:40960
    ds_read_b64_tr_b16 a[250:251], v46 offset:41984
    v_mfma_f32_16x16x32_bf16 a[16:19], a[228:231], a[176:179], a[16:19]
    s_waitcnt vmcnt(29)
    ds_read_b64_tr_b16 a[252:253], v47 offset:40960
    ds_read_b64_tr_b16 a[254:255], v47 offset:41984
    v_mfma_f32_16x16x32_bf16 a[20:23], a[228:231], a[180:183], a[20:23]
    v_add_u32 v32, 4096, v32
    v_mfma_f32_16x16x32_bf16 a[4:7], a[224:227], a[180:183], a[4:7]
    s_waitcnt vmcnt(27)
    buffer_load_dwordx4 a[160:163], v32, s[72:75], s84 offen offset:0 sc1
    v_mfma_f32_16x16x32_bf16 a[8:11], a[224:227], a[184:187], a[8:11]
    v_mfma_f32_16x16x32_bf16 a[24:27], a[228:231], a[184:187], a[24:27]
    s_waitcnt vmcnt(25)
    v_mfma_f32_16x16x32_bf16 a[28:31], a[228:231], a[188:191], a[28:31]
    v_mfma_f32_16x16x32_bf16 a[12:15], a[224:227], a[188:191], a[12:15]
    v_mfma_f32_16x16x32_bf16 a[44:47], a[232:235], a[188:191], a[44:47]
    s_mov_b32 s96, 41984
    ds_read_b64_tr_b16 a[224:225], v50 offset:59392
    ds_read_b64_tr_b16 a[226:227], v50 offset:59904
    v_mfma_f32_16x16x32_bf16 a[60:63], a[236:239], a[188:191], a[60:63]
    ds_read_b64_tr_b16 a[228:229], v51 offset:59392
    ds_read_b64_tr_b16 a[230:231], v51 offset:59904
    v_mfma_f32_16x16x32_bf16 a[56:59], a[236:239], a[184:187], a[56:59]
    buffer_store_dwordx4 v[92:95], v31, s[44:47], s96 offen offset:3072 sc1
    v_mfma_f32_16x16x32_bf16 a[40:43], a[232:235], a[184:187], a[40:43]
    buffer_load_dwordx4 a[164:167], v32, s[72:75], s85 offen offset:0 sc1
    v_mfma_f32_16x16x32_bf16 a[36:39], a[232:235], a[180:183], a[36:39]
    v_mfma_f32_16x16x32_bf16 a[52:55], a[236:239], a[180:183], a[52:55]
    v_mfma_f32_16x16x32_bf16 a[48:51], a[236:239], a[176:179], a[48:51]
    v_mfma_f32_16x16x32_bf16 a[32:35], a[232:235], a[176:179], a[32:35]
    s_waitcnt lgkmcnt(2)
    v_mfma_f32_16x16x32_bf16 a[64:67], a[240:243], a[176:179], a[64:67]
    ds_read_b64_tr_b16 a[232:233], v48 offset:57344
    ds_read_b64_tr_b16 a[234:235], v48 offset:57856
    v_mfma_f32_16x16x32_bf16 a[80:83], a[244:247], a[176:179], a[80:83]
    ds_read_b64_tr_b16 a[236:237], v49 offset:57344
    ds_read_b64_tr_b16 a[238:239], v49 offset:57856
    v_mfma_f32_16x16x32_bf16 a[84:87], a[244:247], a[180:183], a[84:87]
    v_mfma_f32_16x16x32_bf16 a[68:71], a[240:243], a[180:183], a[68:71]
    buffer_load_dwordx4 a[168:171], v32, s[72:75], s86 offen offset:0 sc1
    v_mfma_f32_16x16x32_bf16 a[72:75], a[240:243], a[184:187], a[72:75]
    v_mfma_f32_16x16x32_bf16 a[88:91], a[244:247], a[184:187], a[88:91]
    v_mfma_f32_16x16x32_bf16 a[92:95], a[244:247], a[188:191], a[92:95]
    v_mfma_f32_16x16x32_bf16 a[76:79], a[240:243], a[188:191], a[76:79]
    v_mfma_f32_16x16x32_bf16 a[108:111], a[248:251], a[188:191], a[108:111]
    ds_read_b64_tr_b16 a[240:241], v48 offset:59392
    ds_read_b64_tr_b16 a[242:243], v48 offset:59904
    v_mfma_f32_16x16x32_bf16 a[124:127], a[252:255], a[188:191], a[124:127]
    ds_read_b64_tr_b16 a[244:245], v49 offset:59392
    ds_read_b64_tr_b16 a[246:247], v49 offset:59904
    v_mfma_f32_16x16x32_bf16 a[120:123], a[252:255], a[184:187], a[120:123]
    v_mfma_f32_16x16x32_bf16 a[104:107], a[248:251], a[184:187], a[104:107]
    buffer_load_dwordx4 a[172:175], v32, s[72:75], s87 offen offset:0 sc1
    v_mfma_f32_16x16x32_bf16 a[100:103], a[248:251], a[180:183], a[100:103]
    v_mfma_f32_16x16x32_bf16 a[116:119], a[252:255], a[180:183], a[116:119]
    v_mfma_f32_16x16x32_bf16 a[112:115], a[252:255], a[176:179], a[112:115]
    v_mfma_f32_16x16x32_bf16 a[96:99], a[248:251], a[176:179], a[96:99]
    v_mfma_f32_16x16x32_bf16 a[128:131], a[224:227], a[176:179], a[128:131]
    s_waitcnt lgkmcnt(0)
    ds_read_b64_tr_b16 a[248:249], v50 offset:57344
    ds_read_b64_tr_b16 a[250:251], v50 offset:57856
    v_mfma_f32_16x16x32_bf16 a[144:147], a[228:231], a[176:179], a[144:147]
    s_mov_b32 s96, 0
    ds_read_b64_tr_b16 a[252:253], v51 offset:57344
    ds_read_b64_tr_b16 a[254:255], v51 offset:57856
    v_mfma_f32_16x16x32_bf16 a[148:151], a[228:231], a[180:183], a[148:151]
    buffer_store_dwordx4 v[96:99], v30, s[44:47], s96 offen offset:0 sc1
    v_mfma_f32_16x16x32_bf16 a[132:135], a[224:227], a[180:183], a[132:135]
    v_mfma_f32_16x16x32_bf16 a[136:139], a[224:227], a[184:187], a[136:139]
    v_mfma_f32_16x16x32_bf16 a[152:155], a[228:231], a[184:187], a[152:155]
    v_mfma_f32_16x16x32_bf16 a[156:159], a[228:231], a[188:191], a[156:159]
    v_mfma_f32_16x16x32_bf16 a[140:143], a[224:227], a[188:191], a[140:143]
    s_waitcnt vmcnt(28) lgkmcnt(0)
    v_mfma_f32_16x16x32_bf16 v[172:175], a[232:235], a[188:191], v[172:175]
    s_barrier
    ds_read_b64_tr_b16 a[224:225], v52 offset:0
    ds_read_b64_tr_b16 a[226:227], v52 offset:1024
    v_mfma_f32_16x16x32_bf16 v[188:191], a[236:239], a[188:191], v[188:191]
    s_add_u32 m0, s93, 98304
    ds_read_b64_tr_b16 a[228:229], v53 offset:0
    ds_read_b64_tr_b16 a[230:231], v53 offset:1024
    v_mfma_f32_16x16x32_bf16 v[184:187], a[236:239], a[184:187], v[184:187]
    s_mov_b32 s94, 2621440
    v_mfma_f32_16x16x32_bf16 v[168:171], a[232:235], a[184:187], v[168:171]
    buffer_load_dwordx4 v34, s[60:63], s94 offen offset:0 lds
    v_mfma_f32_16x16x32_bf16 v[164:167], a[232:235], a[180:183], v[164:167]
    v_mfma_f32_16x16x32_bf16 v[180:183], a[236:239], a[180:183], v[180:183]
    v_mfma_f32_16x16x32_bf16 v[176:179], a[236:239], a[176:179], v[176:179]
    v_mfma_f32_16x16x32_bf16 v[160:163], a[232:235], a[176:179], v[160:163]
    v_mfma_f32_16x16x32_bf16 v[192:195], a[240:243], a[176:179], v[192:195]
    ds_read_b64_tr_b16 a[232:233], v54 offset:0
    ds_read_b64_tr_b16 a[234:235], v54 offset:1024
    v_mfma_f32_16x16x32_bf16 v[208:211], a[244:247], a[176:179], v[208:211]
    ds_read_b64_tr_b16 a[236:237], v55 offset:0
    ds_read_b64_tr_b16 a[238:239], v55 offset:1024
    v_mfma_f32_16x16x32_bf16 v[212:215], a[244:247], a[180:183], v[212:215]
    v_mfma_f32_16x16x32_bf16 v[196:199], a[240:243], a[180:183], v[196:199]
    buffer_load_dwordx4 v35, s[60:63], s94 offen offset:1024 lds
    v_mfma_f32_16x16x32_bf16 v[200:203], a[240:243], a[184:187], v[200:203]
    v_mfma_f32_16x16x32_bf16 v[216:219], a[244:247], a[184:187], v[216:219]
    v_mfma_f32_16x16x32_bf16 v[220:223], a[244:247], a[188:191], v[220:223]
    v_mfma_f32_16x16x32_bf16 v[204:207], a[240:243], a[188:191], v[204:207]
    v_mfma_f32_16x16x32_bf16 v[236:239], a[248:251], a[188:191], v[236:239]
    ds_read_b64_tr_b16 a[240:241], v56 offset:0
    ds_read_b64_tr_b16 a[242:243], v56 offset:1024
    v_mfma_f32_16x16x32_bf16 v[252:255], a[252:255], a[188:191], v[252:255]
    ds_read_b64_tr_b16 a[244:245], v57 offset:0
    ds_read_b64_tr_b16 a[246:247], v57 offset:1024
    v_mfma_f32_16x16x32_bf16 v[248:251], a[252:255], a[184:187], v[248:251]
    v_mfma_f32_16x16x32_bf16 v[232:235], a[248:251], a[184:187], v[232:235]
    s_mov_b32 s96, 4096
    buffer_load_dwordx4 v36, s[60:63], s94 offen offset:2048 lds
    v_mfma_f32_16x16x32_bf16 v[228:231], a[248:251], a[180:183], v[228:231]
    buffer_store_dwordx4 v[100:103], v30, s[44:47], s96 offen offset:0 sc1
    v_mfma_f32_16x16x32_bf16 v[244:247], a[252:255], a[180:183], v[244:247]
    v_mfma_f32_16x16x32_bf16 v[240:243], a[252:255], a[176:179], v[240:243]
    v_mfma_f32_16x16x32_bf16 v[224:227], a[248:251], a[176:179], v[224:227]
    s_waitcnt lgkmcnt(2) vmcnt(30)
    v_mfma_f32_16x16x32_bf16 a[0:3], a[224:227], a[192:195], a[0:3]
    ds_read_b64_tr_b16 a[248:249], v58 offset:0
    ds_read_b64_tr_b16 a[250:251], v58 offset:1024
    v_mfma_f32_16x16x32_bf16 a[16:19], a[228:231], a[192:195], a[16:19]
    s_waitcnt vmcnt(28)
    ds_read_b64_tr_b16 a[252:253], v59 offset:0
    ds_read_b64_tr_b16 a[254:255], v59 offset:1024
    v_mfma_f32_16x16x32_bf16 a[20:23], a[228:231], a[196:199], a[20:23]
    v_mfma_f32_16x16x32_bf16 a[4:7], a[224:227], a[196:199], a[4:7]
    s_waitcnt vmcnt(27)
    buffer_load_dwordx4 a[176:179], v32, s[72:75], s84 offen offset:1024 sc1
    v_mfma_f32_16x16x32_bf16 a[8:11], a[224:227], a[200:203], a[8:11]
    s_waitcnt vmcnt(27)
    buffer_load_dwordx4 v37, s[60:63], s94 offen offset:3072 lds
    v_mfma_f32_16x16x32_bf16 a[24:27], a[228:231], a[200:203], a[24:27]
    s_add_u32 m0, s93, 114688
    v_mfma_f32_16x16x32_bf16 a[28:31], a[228:231], a[204:207], a[28:31]
    s_mov_b32 s95, 1105920
    v_mfma_f32_16x16x32_bf16 a[12:15], a[224:227], a[204:207], a[12:15]
    v_mfma_f32_16x16x32_bf16 a[44:47], a[232:235], a[204:207], a[44:47]
    ds_read_b64_tr_b16 a[224:225], v62 offset:18432
    ds_read_b64_tr_b16 a[226:227], v62 offset:18944
    v_mfma_f32_16x16x32_bf16 a[60:63], a[236:239], a[204:207], a[60:63]
    ds_read_b64_tr_b16 a[228:229], v63 offset:18432
    ds_read_b64_tr_b16 a[230:231], v63 offset:18944
    v_mfma_f32_16x16x32_bf16 a[56:59], a[236:239], a[200:203], a[56:59]
    v_mfma_f32_16x16x32_bf16 a[40:43], a[232:235], a[200:203], a[40:43]
    buffer_load_dwordx4 a[180:183], v32, s[72:75], s85 offen offset:1024 sc1
    v_mfma_f32_16x16x32_bf16 a[36:39], a[232:235], a[196:199], a[36:39]
    buffer_load_dwordx4 v38, s[64:67], s95 offen offset:0 lds
    v_mfma_f32_16x16x32_bf16 a[52:55], a[236:239], a[196:199], a[52:55]
    v_mfma_f32_16x16x32_bf16 a[48:51], a[236:239], a[192:195], a[48:51]
    v_mfma_f32_16x16x32_bf16 a[32:35], a[232:235], a[192:195], a[32:35]
    v_mfma_f32_16x16x32_bf16 a[64:67], a[240:243], a[192:195], a[64:67]
    s_waitcnt lgkmcnt(0)
    ds_read_b64_tr_b16 a[232:233], v60 offset:16384
    ds_read_b64_tr_b16 a[234:235], v60 offset:16896
    v_mfma_f32_16x16x32_bf16 a[80:83], a[244:247], a[192:195], a[80:83]
    ds_read_b64_tr_b16 a[236:237], v61 offset:16384
    ds_read_b64_tr_b16 a[238:239], v61 offset:16896
    v_mfma_f32_16x16x32_bf16 a[84:87], a[244:247], a[196:199], a[84:87]
    v_mfma_f32_16x16x32_bf16 a[68:71], a[240:243], a[196:199], a[68:71]
    buffer_load_dwordx4 a[184:187], v32, s[72:75], s86 offen offset:1024 sc1
    v_mfma_f32_16x16x32_bf16 a[72:75], a[240:243], a[200:203], a[72:75]
    s_mov_b32 s96, 8192
    buffer_load_dwordx4 v39, s[64:67], s95 offen offset:1024 lds
    v_mfma_f32_16x16x32_bf16 a[88:91], a[244:247], a[200:203], a[88:91]
    buffer_store_dwordx4 v[104:107], v30, s[44:47], s96 offen offset:0 sc1
    v_mfma_f32_16x16x32_bf16 a[92:95], a[244:247], a[204:207], a[92:95]
    v_mfma_f32_16x16x32_bf16 a[76:79], a[240:243], a[204:207], a[76:79]
    v_mfma_f32_16x16x32_bf16 a[108:111], a[248:251], a[204:207], a[108:111]
    ds_read_b64_tr_b16 a[240:241], v60 offset:18432
    ds_read_b64_tr_b16 a[242:243], v60 offset:18944
    v_mfma_f32_16x16x32_bf16 a[124:127], a[252:255], a[204:207], a[124:127]
    ds_read_b64_tr_b16 a[244:245], v61 offset:18432
    ds_read_b64_tr_b16 a[246:247], v61 offset:18944
    v_mfma_f32_16x16x32_bf16 a[120:123], a[252:255], a[200:203], a[120:123]
    v_mfma_f32_16x16x32_bf16 a[104:107], a[248:251], a[200:203], a[104:107]
    buffer_load_dwordx4 a[188:191], v32, s[72:75], s87 offen offset:1024 sc1
    v_mfma_f32_16x16x32_bf16 a[100:103], a[248:251], a[196:199], a[100:103]
    buffer_load_dwordx4 v38, s[68:71], s95 offen offset:2048 lds
    v_mfma_f32_16x16x32_bf16 a[116:119], a[252:255], a[196:199], a[116:119]
    v_mfma_f32_16x16x32_bf16 a[112:115], a[252:255], a[192:195], a[112:115]
    v_mfma_f32_16x16x32_bf16 a[96:99], a[248:251], a[192:195], a[96:99]
    v_mfma_f32_16x16x32_bf16 a[128:131], a[224:227], a[192:195], a[128:131]
    ds_read_b64_tr_b16 a[248:249], v62 offset:16384
    ds_read_b64_tr_b16 a[250:251], v62 offset:16896
    v_mfma_f32_16x16x32_bf16 a[144:147], a[228:231], a[192:195], a[144:147]
    ds_read_b64_tr_b16 a[252:253], v63 offset:16384
    ds_read_b64_tr_b16 a[254:255], v63 offset:16896
    v_mfma_f32_16x16x32_bf16 a[148:151], a[228:231], a[196:199], a[148:151]
    v_mfma_f32_16x16x32_bf16 a[132:135], a[224:227], a[196:199], a[132:135]
    v_mfma_f32_16x16x32_bf16 a[136:139], a[224:227], a[200:203], a[136:139]
    buffer_load_dwordx4 v39, s[68:71], s95 offen offset:3072 lds
    v_mfma_f32_16x16x32_bf16 a[152:155], a[228:231], a[200:203], a[152:155]
    v_mfma_f32_16x16x32_bf16 a[156:159], a[228:231], a[204:207], a[156:159]
    v_mfma_f32_16x16x32_bf16 a[140:143], a[224:227], a[204:207], a[140:143]
    s_waitcnt lgkmcnt(2)
    v_mfma_f32_16x16x32_bf16 v[172:175], a[232:235], a[204:207], v[172:175]
    ds_read_b64_tr_b16 a[224:225], v52 offset:8192
    ds_read_b64_tr_b16 a[226:227], v52 offset:9216
    v_mfma_f32_16x16x32_bf16 v[188:191], a[236:239], a[204:207], v[188:191]
    ds_read_b64_tr_b16 a[228:229], v53 offset:8192
    ds_read_b64_tr_b16 a[230:231], v53 offset:9216
    v_mfma_f32_16x16x32_bf16 v[184:187], a[236:239], a[200:203], v[184:187]
    v_mfma_f32_16x16x32_bf16 v[168:171], a[232:235], a[200:203], v[168:171]
    v_mfma_f32_16x16x32_bf16 v[164:167], a[232:235], a[196:199], v[164:167]
    v_mfma_f32_16x16x32_bf16 v[180:183], a[236:239], a[196:199], v[180:183]
    v_mfma_f32_16x16x32_bf16 v[176:179], a[236:239], a[192:195], v[176:179]
    s_mov_b32 s96, 12288
    buffer_store_dwordx4 v[108:111], v30, s[44:47], s96 offen offset:0 sc1
    v_mfma_f32_16x16x32_bf16 v[160:163], a[232:235], a[192:195], v[160:163]
    v_mfma_f32_16x16x32_bf16 v[192:195], a[240:243], a[192:195], v[192:195]
    ds_read_b64_tr_b16 a[232:233], v54 offset:8192
    ds_read_b64_tr_b16 a[234:235], v54 offset:9216
    v_mfma_f32_16x16x32_bf16 v[208:211], a[244:247], a[192:195], v[208:211]
    ds_read_b64_tr_b16 a[236:237], v55 offset:8192
    ds_read_b64_tr_b16 a[238:239], v55 offset:9216
    v_mfma_f32_16x16x32_bf16 v[212:215], a[244:247], a[196:199], v[212:215]
    v_mfma_f32_16x16x32_bf16 v[196:199], a[240:243], a[196:199], v[196:199]
    v_mfma_f32_16x16x32_bf16 v[200:203], a[240:243], a[200:203], v[200:203]
    v_mfma_f32_16x16x32_bf16 v[216:219], a[244:247], a[200:203], v[216:219]
    v_mfma_f32_16x16x32_bf16 v[220:223], a[244:247], a[204:207], v[220:223]
    v_mfma_f32_16x16x32_bf16 v[204:207], a[240:243], a[204:207], v[204:207]
    v_mfma_f32_16x16x32_bf16 v[236:239], a[248:251], a[204:207], v[236:239]
    s_waitcnt lgkmcnt(0)
    ds_read_b64_tr_b16 a[240:241], v56 offset:8192
    ds_read_b64_tr_b16 a[242:243], v56 offset:9216
    v_mfma_f32_16x16x32_bf16 v[252:255], a[252:255], a[204:207], v[252:255]
    ds_read_b64_tr_b16 a[244:245], v57 offset:8192
    ds_read_b64_tr_b16 a[246:247], v57 offset:9216
    v_mfma_f32_16x16x32_bf16 v[248:251], a[252:255], a[200:203], v[248:251]
    v_mfma_f32_16x16x32_bf16 v[232:235], a[248:251], a[200:203], v[232:235]
    v_mfma_f32_16x16x32_bf16 v[228:231], a[248:251], a[196:199], v[228:231]
    v_mfma_f32_16x16x32_bf16 v[244:247], a[252:255], a[196:199], v[244:247]
    v_mfma_f32_16x16x32_bf16 v[240:243], a[252:255], a[192:195], v[240:243]
    v_mfma_f32_16x16x32_bf16 v[224:227], a[248:251], a[192:195], v[224:227]
    s_waitcnt vmcnt(31)
    v_mfma_f32_16x16x32_bf16 a[0:3], a[224:227], a[208:211], a[0:3]
    ds_read_b64_tr_b16 a[248:249], v58 offset:8192
    ds_read_b64_tr_b16 a[250:251], v58 offset:9216
    v_mfma_f32_16x16x32_bf16 a[16:19], a[228:231], a[208:211], a[16:19]
    s_waitcnt vmcnt(29)
    ds_read_b64_tr_b16 a[252:253], v59 offset:8192
    ds_read_b64_tr_b16 a[254:255], v59 offset:9216
    v_mfma_f32_16x16x32_bf16 a[20:23], a[228:231], a[212:215], a[20:23]
    v_mfma_f32_16x16x32_bf16 a[4:7], a[224:227], a[212:215], a[4:7]
    s_waitcnt vmcnt(27)
    buffer_load_dwordx4 a[192:195], v32, s[72:75], s84 offen offset:2048 sc1
    v_mfma_f32_16x16x32_bf16 a[8:11], a[224:227], a[216:219], a[8:11]
    v_mfma_f32_16x16x32_bf16 a[24:27], a[228:231], a[216:219], a[24:27]
    s_waitcnt vmcnt(25)
    v_mfma_f32_16x16x32_bf16 a[28:31], a[228:231], a[220:223], a[28:31]
    v_mfma_f32_16x16x32_bf16 a[12:15], a[224:227], a[220:223], a[12:15]
    s_mov_b32 s96, 33792
    buffer_store_dwordx4 v[112:115], v30, s[44:47], s96 offen offset:0 sc1
    v_mfma_f32_16x16x32_bf16 a[44:47], a[232:235], a[220:223], a[44:47]
    ds_read_b64_tr_b16 a[224:225], v62 offset:26624
    ds_read_b64_tr_b16 a[226:227], v62 offset:27136
    v_mfma_f32_16x16x32_bf16 a[60:63], a[236:239], a[220:223], a[60:63]
    ds_read_b64_tr_b16 a[228:229], v63 offset:26624
    ds_read_b64_tr_b16 a[230:231], v63 offset:27136
    v_mfma_f32_16x16x32_bf16 a[56:59], a[236:239], a[216:219], a[56:59]
    v_mfma_f32_16x16x32_bf16 a[40:43], a[232:235], a[216:219], a[40:43]
    buffer_load_dwordx4 a[196:199], v32, s[72:75], s85 offen offset:2048 sc1
    v_mfma_f32_16x16x32_bf16 a[36:39], a[232:235], a[212:215], a[36:39]
    v_mfma_f32_16x16x32_bf16 a[52:55], a[236:239], a[212:215], a[52:55]
    v_mfma_f32_16x16x32_bf16 a[48:51], a[236:239], a[208:211], a[48:51]
    v_mfma_f32_16x16x32_bf16 a[32:35], a[232:235], a[208:211], a[32:35]
    s_waitcnt lgkmcnt(2)
    v_mfma_f32_16x16x32_bf16 a[64:67], a[240:243], a[208:211], a[64:67]
    ds_read_b64_tr_b16 a[232:233], v60 offset:24576
    ds_read_b64_tr_b16 a[234:235], v60 offset:25088
    v_mfma_f32_16x16x32_bf16 a[80:83], a[244:247], a[208:211], a[80:83]
    ds_read_b64_tr_b16 a[236:237], v61 offset:24576
    ds_read_b64_tr_b16 a[238:239], v61 offset:25088
    v_mfma_f32_16x16x32_bf16 a[84:87], a[244:247], a[212:215], a[84:87]
    v_mfma_f32_16x16x32_bf16 a[68:71], a[240:243], a[212:215], a[68:71]
    buffer_load_dwordx4 a[200:203], v32, s[72:75], s86 offen offset:2048 sc1
    v_mfma_f32_16x16x32_bf16 a[72:75], a[240:243], a[216:219], a[72:75]
    v_mfma_f32_16x16x32_bf16 a[88:91], a[244:247], a[216:219], a[88:91]
    v_mfma_f32_16x16x32_bf16 a[92:95], a[244:247], a[220:223], a[92:95]
    v_mfma_f32_16x16x32_bf16 a[76:79], a[240:243], a[220:223], a[76:79]
    v_mfma_f32_16x16x32_bf16 a[108:111], a[248:251], a[220:223], a[108:111]
    ds_read_b64_tr_b16 a[240:241], v60 offset:26624
    ds_read_b64_tr_b16 a[242:243], v60 offset:27136
    v_mfma_f32_16x16x32_bf16 a[124:127], a[252:255], a[220:223], a[124:127]
    ds_read_b64_tr_b16 a[244:245], v61 offset:26624
    ds_read_b64_tr_b16 a[246:247], v61 offset:27136
    v_mfma_f32_16x16x32_bf16 a[120:123], a[252:255], a[216:219], a[120:123]
    v_mfma_f32_16x16x32_bf16 a[104:107], a[248:251], a[216:219], a[104:107]
    buffer_load_dwordx4 a[204:207], v32, s[72:75], s87 offen offset:2048 sc1
    v_mfma_f32_16x16x32_bf16 a[100:103], a[248:251], a[212:215], a[100:103]
    v_mfma_f32_16x16x32_bf16 a[116:119], a[252:255], a[212:215], a[116:119]
    v_mfma_f32_16x16x32_bf16 a[112:115], a[252:255], a[208:211], a[112:115]
    v_mfma_f32_16x16x32_bf16 a[96:99], a[248:251], a[208:211], a[96:99]
    v_mfma_f32_16x16x32_bf16 a[128:131], a[224:227], a[208:211], a[128:131]
    s_waitcnt lgkmcnt(0)
    ds_read_b64_tr_b16 a[248:249], v62 offset:24576
    ds_read_b64_tr_b16 a[250:251], v62 offset:25088
    v_mfma_f32_16x16x32_bf16 a[144:147], a[228:231], a[208:211], a[144:147]
    s_mov_b32 s96, 37888
    ds_read_b64_tr_b16 a[252:253], v63 offset:24576
    ds_read_b64_tr_b16 a[254:255], v63 offset:25088
    v_mfma_f32_16x16x32_bf16 a[148:151], a[228:231], a[212:215], a[148:151]
    buffer_store_dwordx4 v[116:119], v30, s[44:47], s96 offen offset:0 sc1
    v_mfma_f32_16x16x32_bf16 a[132:135], a[224:227], a[212:215], a[132:135]
    v_mfma_f32_16x16x32_bf16 a[136:139], a[224:227], a[216:219], a[136:139]
    v_mfma_f32_16x16x32_bf16 a[152:155], a[228:231], a[216:219], a[152:155]
    v_mfma_f32_16x16x32_bf16 a[156:159], a[228:231], a[220:223], a[156:159]
    v_mfma_f32_16x16x32_bf16 a[140:143], a[224:227], a[220:223], a[140:143]
    s_waitcnt vmcnt(28) lgkmcnt(0)
    v_mfma_f32_16x16x32_bf16 v[172:175], a[232:235], a[220:223], v[172:175]
    s_barrier
    ds_read_b64_tr_b16 a[224:225], v40 offset:0
    ds_read_b64_tr_b16 a[226:227], v40 offset:1024
    v_mfma_f32_16x16x32_bf16 v[188:191], a[236:239], a[220:223], v[188:191]
    s_add_u32 m0, s93, 131072
    ds_read_b64_tr_b16 a[228:229], v41 offset:0
    ds_read_b64_tr_b16 a[230:231], v41 offset:1024
    v_mfma_f32_16x16x32_bf16 v[184:187], a[236:239], a[216:219], v[184:187]
    s_mov_b32 s94, 3145728
    v_mfma_f32_16x16x32_bf16 v[168:171], a[232:235], a[216:219], v[168:171]
    buffer_load_dwordx4 v34, s[60:63], s94 offen offset:0 lds
    v_mfma_f32_16x16x32_bf16 v[164:167], a[232:235], a[212:215], v[164:167]
    v_mfma_f32_16x16x32_bf16 v[180:183], a[236:239], a[212:215], v[180:183]
    v_mfma_f32_16x16x32_bf16 v[176:179], a[236:239], a[208:211], v[176:179]
    v_mfma_f32_16x16x32_bf16 v[160:163], a[232:235], a[208:211], v[160:163]
    v_mfma_f32_16x16x32_bf16 v[192:195], a[240:243], a[208:211], v[192:195]
    ds_read_b64_tr_b16 a[232:233], v42 offset:0
    ds_read_b64_tr_b16 a[234:235], v42 offset:1024
    v_mfma_f32_16x16x32_bf16 v[208:211], a[244:247], a[208:211], v[208:211]
    ds_read_b64_tr_b16 a[236:237], v43 offset:0
    ds_read_b64_tr_b16 a[238:239], v43 offset:1024
    v_mfma_f32_16x16x32_bf16 v[212:215], a[244:247], a[212:215], v[212:215]
    v_mfma_f32_16x16x32_bf16 v[196:199], a[240:243], a[212:215], v[196:199]
    buffer_load_dwordx4 v35, s[60:63], s94 offen offset:1024 lds
    v_mfma_f32_16x16x32_bf16 v[200:203], a[240:243], a[216:219], v[200:203]
    v_mfma_f32_16x16x32_bf16 v[216:219], a[244:247], a[216:219], v[216:219]
    v_mfma_f32_16x16x32_bf16 v[220:223], a[244:247], a[220:223], v[220:223]
    v_mfma_f32_16x16x32_bf16 v[204:207], a[240:243], a[220:223], v[204:207]
    v_mfma_f32_16x16x32_bf16 v[236:239], a[248:251], a[220:223], v[236:239]
    ds_read_b64_tr_b16 a[240:241], v44 offset:0
    ds_read_b64_tr_b16 a[242:243], v44 offset:1024
    v_mfma_f32_16x16x32_bf16 v[252:255], a[252:255], a[220:223], v[252:255]
    ds_read_b64_tr_b16 a[244:245], v45 offset:0
    ds_read_b64_tr_b16 a[246:247], v45 offset:1024
    v_mfma_f32_16x16x32_bf16 v[248:251], a[252:255], a[216:219], v[248:251]
    s_mov_b32 s96, 41984
    buffer_store_dwordx4 v[120:123], v30, s[44:47], s96 offen offset:0 sc1
    v_mfma_f32_16x16x32_bf16 v[232:235], a[248:251], a[216:219], v[232:235]
    buffer_load_dwordx4 v36, s[60:63], s94 offen offset:2048 lds
    v_mfma_f32_16x16x32_bf16 v[228:231], a[248:251], a[212:215], v[228:231]
    v_mfma_f32_16x16x32_bf16 v[244:247], a[252:255], a[212:215], v[244:247]
    v_mfma_f32_16x16x32_bf16 v[240:243], a[252:255], a[208:211], v[240:243]
    v_mfma_f32_16x16x32_bf16 v[224:227], a[248:251], a[208:211], v[224:227]
    s_waitcnt lgkmcnt(2) vmcnt(30)
    v_mfma_f32_16x16x32_bf16 a[0:3], a[224:227], a[160:163], a[0:3]
    ds_read_b64_tr_b16 a[248:249], v46 offset:0
    ds_read_b64_tr_b16 a[250:251], v46 offset:1024
    v_mfma_f32_16x16x32_bf16 a[16:19], a[228:231], a[160:163], a[16:19]
    s_waitcnt vmcnt(28)
    ds_read_b64_tr_b16 a[252:253], v47 offset:0
    ds_read_b64_tr_b16 a[254:255], v47 offset:1024
    v_mfma_f32_16x16x32_bf16 a[20:23], a[228:231], a[164:167], a[20:23]
    v_mfma_f32_16x16x32_bf16 a[4:7], a[224:227], a[164:167], a[4:7]
    s_waitcnt vmcnt(27)
    buffer_load_dwordx4 a[208:211], v32, s[72:75], s84 offen offset:3072 sc1
    v_mfma_f32_16x16x32_bf16 a[8:11], a[224:227], a[168:171], a[8:11]
    s_waitcnt vmcnt(27)
    buffer_load_dwordx4 v37, s[60:63], s94 offen offset:3072 lds
    v_mfma_f32_16x16x32_bf16 a[24:27], a[228:231], a[168:171], a[24:27]
    s_add_u32 m0, s93, 147456
    v_mfma_f32_16x16x32_bf16 a[28:31], a[228:231], a[172:175], a[28:31]
    s_mov_b32 s95, 1327104
    v_mfma_f32_16x16x32_bf16 a[12:15], a[224:227], a[172:175], a[12:15]
    v_mfma_f32_16x16x32_bf16 a[44:47], a[232:235], a[172:175], a[44:47]
    ds_read_b64_tr_b16 a[224:225], v50 offset:18432
    ds_read_b64_tr_b16 a[226:227], v50 offset:18944
    v_mfma_f32_16x16x32_bf16 a[60:63], a[236:239], a[172:175], a[60:63]
    ds_read_b64_tr_b16 a[228:229], v51 offset:18432
    ds_read_b64_tr_b16 a[230:231], v51 offset:18944
    v_mfma_f32_16x16x32_bf16 a[56:59], a[236:239], a[168:171], a[56:59]
    v_mfma_f32_16x16x32_bf16 a[40:43], a[232:235], a[168:171], a[40:43]
    buffer_load_dwordx4 a[212:215], v32, s[72:75], s85 offen offset:3072 sc1
    v_mfma_f32_16x16x32_bf16 a[36:39], a[232:235], a[164:167], a[36:39]
    buffer_load_dwordx4 v38, s[64:67], s95 offen offset:0 lds
    v_mfma_f32_16x16x32_bf16 a[52:55], a[236:239], a[164:167], a[52:55]
    v_mfma_f32_16x16x32_bf16 a[48:51], a[236:239], a[160:163], a[48:51]
    v_mfma_f32_16x16x32_bf16 a[32:35], a[232:235], a[160:163], a[32:35]
    v_mfma_f32_16x16x32_bf16 a[64:67], a[240:243], a[160:163], a[64:67]
    s_waitcnt lgkmcnt(0)
    ds_read_b64_tr_b16 a[232:233], v48 offset:16384
    ds_read_b64_tr_b16 a[234:235], v48 offset:16896
    v_mfma_f32_16x16x32_bf16 a[80:83], a[244:247], a[160:163], a[80:83]
    ds_read_b64_tr_b16 a[236:237], v49 offset:16384
    ds_read_b64_tr_b16 a[238:239], v49 offset:16896
    v_mfma_f32_16x16x32_bf16 a[84:87], a[244:247], a[164:167], a[84:87]
    v_mfma_f32_16x16x32_bf16 a[68:71], a[240:243], a[164:167], a[68:71]
    buffer_load_dwordx4 a[216:219], v32, s[72:75], s86 offen offset:3072 sc1
    v_mfma_f32_16x16x32_bf16 a[72:75], a[240:243], a[168:171], a[72:75]
    s_mov_b32 s96, 46080
    buffer_load_dwordx4 v39, s[64:67], s95 offen offset:1024 lds
    v_mfma_f32_16x16x32_bf16 a[88:91], a[244:247], a[168:171], a[88:91]
    buffer_store_dwordx4 v[124:127], v30, s[44:47], s96 offen offset:0 sc1
    v_mfma_f32_16x16x32_bf16 a[92:95], a[244:247], a[172:175], a[92:95]
    v_mfma_f32_16x16x32_bf16 a[76:79], a[240:243], a[172:175], a[76:79]
    v_mfma_f32_16x16x32_bf16 a[108:111], a[248:251], a[172:175], a[108:111]
    ds_read_b64_tr_b16 a[240:241], v48 offset:18432
    ds_read_b64_tr_b16 a[242:243], v48 offset:18944
    v_mfma_f32_16x16x32_bf16 a[124:127], a[252:255], a[172:175], a[124:127]
    ds_read_b64_tr_b16 a[244:245], v49 offset:18432
    ds_read_b64_tr_b16 a[246:247], v49 offset:18944
    v_mfma_f32_16x16x32_bf16 a[120:123], a[252:255], a[168:171], a[120:123]
    v_mfma_f32_16x16x32_bf16 a[104:107], a[248:251], a[168:171], a[104:107]
    buffer_load_dwordx4 a[220:223], v32, s[72:75], s87 offen offset:3072 sc1
    v_mfma_f32_16x16x32_bf16 a[100:103], a[248:251], a[164:167], a[100:103]
    buffer_load_dwordx4 v38, s[68:71], s95 offen offset:2048 lds
    v_mfma_f32_16x16x32_bf16 a[116:119], a[252:255], a[164:167], a[116:119]
    v_mfma_f32_16x16x32_bf16 a[112:115], a[252:255], a[160:163], a[112:115]
    v_mfma_f32_16x16x32_bf16 a[96:99], a[248:251], a[160:163], a[96:99]
    v_mfma_f32_16x16x32_bf16 a[128:131], a[224:227], a[160:163], a[128:131]
    ds_read_b64_tr_b16 a[248:249], v50 offset:16384
    ds_read_b64_tr_b16 a[250:251], v50 offset:16896
    v_mfma_f32_16x16x32_bf16 a[144:147], a[228:231], a[160:163], a[144:147]
    ds_read_b64_tr_b16 a[252:253], v51 offset:16384
    ds_read_b64_tr_b16 a[254:255], v51 offset:16896
    v_mfma_f32_16x16x32_bf16 a[148:151], a[228:231], a[164:167], a[148:151]
    v_mfma_f32_16x16x32_bf16 a[132:135], a[224:227], a[164:167], a[132:135]
    v_mfma_f32_16x16x32_bf16 a[136:139], a[224:227], a[168:171], a[136:139]
    buffer_load_dwordx4 v39, s[68:71], s95 offen offset:3072 lds
    v_mfma_f32_16x16x32_bf16 a[152:155], a[228:231], a[168:171], a[152:155]
    v_mfma_f32_16x16x32_bf16 a[156:159], a[228:231], a[172:175], a[156:159]
    v_mfma_f32_16x16x32_bf16 a[140:143], a[224:227], a[172:175], a[140:143]
    s_waitcnt lgkmcnt(2)
    v_mfma_f32_16x16x32_bf16 v[172:175], a[232:235], a[172:175], v[172:175]
    ds_read_b64_tr_b16 a[224:225], v40 offset:8192
    ds_read_b64_tr_b16 a[226:227], v40 offset:9216
    v_mfma_f32_16x16x32_bf16 v[188:191], a[236:239], a[172:175], v[188:191]
    ds_read_b64_tr_b16 a[228:229], v41 offset:8192
    ds_read_b64_tr_b16 a[230:231], v41 offset:9216
    v_mfma_f32_16x16x32_bf16 v[184:187], a[236:239], a[168:171], v[184:187]
    v_mfma_f32_16x16x32_bf16 v[168:171], a[232:235], a[168:171], v[168:171]
    v_mfma_f32_16x16x32_bf16 v[164:167], a[232:235], a[164:167], v[164:167]
    v_mfma_f32_16x16x32_bf16 v[180:183], a[236:239], a[164:167], v[180:183]
    s_mov_b32 s96, 0
    buffer_store_dwordx4 v[128:131], v30, s[44:47], s96 offen offset:1024 sc1
    v_mfma_f32_16x16x32_bf16 v[176:179], a[236:239], a[160:163], v[176:179]
    v_mfma_f32_16x16x32_bf16 v[160:163], a[232:235], a[160:163], v[160:163]
    v_mfma_f32_16x16x32_bf16 v[192:195], a[240:243], a[160:163], v[192:195]
    ds_read_b64_tr_b16 a[232:233], v42 offset:8192
    ds_read_b64_tr_b16 a[234:235], v42 offset:9216
    v_mfma_f32_16x16x32_bf16 v[208:211], a[244:247], a[160:163], v[208:211]
    ds_read_b64_tr_b16 a[236:237], v43 offset:8192
    ds_read_b64_tr_b16 a[238:239], v43 offset:9216
    v_mfma_f32_16x16x32_bf16 v[212:215], a[244:247], a[164:167], v[212:215]
    v_mfma_f32_16x16x32_bf16 v[196:199], a[240:243], a[164:167], v[196:199]
    v_mfma_f32_16x16x32_bf16 v[200:203], a[240:243], a[168:171], v[200:203]
    v_mfma_f32_16x16x32_bf16 v[216:219], a[244:247], a[168:171], v[216:219]
    v_mfma_f32_16x16x32_bf16 v[220:223], a[244:247], a[172:175], v[220:223]
    v_mfma_f32_16x16x32_bf16 v[204:207], a[240:243], a[172:175], v[204:207]
    v_mfma_f32_16x16x32_bf16 v[236:239], a[248:251], a[172:175], v[236:239]
    s_waitcnt lgkmcnt(0)
    ds_read_b64_tr_b16 a[240:241], v44 offset:8192
    ds_read_b64_tr_b16 a[242:243], v44 offset:9216
    v_mfma_f32_16x16x32_bf16 v[252:255], a[252:255], a[172:175], v[252:255]
    ds_read_b64_tr_b16 a[244:245], v45 offset:8192
    ds_read_b64_tr_b16 a[246:247], v45 offset:9216
    v_mfma_f32_16x16x32_bf16 v[248:251], a[252:255], a[168:171], v[248:251]
    v_mfma_f32_16x16x32_bf16 v[232:235], a[248:251], a[168:171], v[232:235]
    v_mfma_f32_16x16x32_bf16 v[228:231], a[248:251], a[164:167], v[228:231]
    v_mfma_f32_16x16x32_bf16 v[244:247], a[252:255], a[164:167], v[244:247]
    v_mfma_f32_16x16x32_bf16 v[240:243], a[252:255], a[160:163], v[240:243]
    v_mfma_f32_16x16x32_bf16 v[224:227], a[248:251], a[160:163], v[224:227]
    s_waitcnt vmcnt(31)
    v_mfma_f32_16x16x32_bf16 a[0:3], a[224:227], a[176:179], a[0:3]
    ds_read_b64_tr_b16 a[248:249], v46 offset:8192
    ds_read_b64_tr_b16 a[250:251], v46 offset:9216
    v_mfma_f32_16x16x32_bf16 a[16:19], a[228:231], a[176:179], a[16:19]
    s_waitcnt vmcnt(29)
    ds_read_b64_tr_b16 a[252:253], v47 offset:8192
    ds_read_b64_tr_b16 a[254:255], v47 offset:9216
    v_mfma_f32_16x16x32_bf16 a[20:23], a[228:231], a[180:183], a[20:23]
    v_add_u32 v32, 4096, v32
    v_mfma_f32_16x16x32_bf16 a[4:7], a[224:227], a[180:183], a[4:7]
    s_waitcnt vmcnt(27)
    buffer_load_dwordx4 a[160:163], v32, s[72:75], s84 offen offset:0 sc1
    v_mfma_f32_16x16x32_bf16 a[8:11], a[224:227], a[184:187], a[8:11]
    v_mfma_f32_16x16x32_bf16 a[24:27], a[228:231], a[184:187], a[24:27]
    s_waitcnt vmcnt(25)
    v_mfma_f32_16x16x32_bf16 a[28:31], a[228:231], a[188:191], a[28:31]
    v_mfma_f32_16x16x32_bf16 a[12:15], a[224:227], a[188:191], a[12:15]
    s_mov_b32 s96, 4096
    buffer_store_dwordx4 v[132:135], v30, s[44:47], s96 offen offset:1024 sc1
    v_mfma_f32_16x16x32_bf16 a[44:47], a[232:235], a[188:191], a[44:47]
    ds_read_b64_tr_b16 a[224:225], v50 offset:26624
    ds_read_b64_tr_b16 a[226:227], v50 offset:27136
    v_mfma_f32_16x16x32_bf16 a[60:63], a[236:239], a[188:191], a[60:63]
    ds_read_b64_tr_b16 a[228:229], v51 offset:26624
    ds_read_b64_tr_b16 a[230:231], v51 offset:27136
    v_mfma_f32_16x16x32_bf16 a[56:59], a[236:239], a[184:187], a[56:59]
    v_mfma_f32_16x16x32_bf16 a[40:43], a[232:235], a[184:187], a[40:43]
    buffer_load_dwordx4 a[164:167], v32, s[72:75], s85 offen offset:0 sc1
    v_mfma_f32_16x16x32_bf16 a[36:39], a[232:235], a[180:183], a[36:39]
    v_mfma_f32_16x16x32_bf16 a[52:55], a[236:239], a[180:183], a[52:55]
    v_mfma_f32_16x16x32_bf16 a[48:51], a[236:239], a[176:179], a[48:51]
    v_mfma_f32_16x16x32_bf16 a[32:35], a[232:235], a[176:179], a[32:35]
    s_waitcnt lgkmcnt(2)
    v_mfma_f32_16x16x32_bf16 a[64:67], a[240:243], a[176:179], a[64:67]
    ds_read_b64_tr_b16 a[232:233], v48 offset:24576
    ds_read_b64_tr_b16 a[234:235], v48 offset:25088
    v_mfma_f32_16x16x32_bf16 a[80:83], a[244:247], a[176:179], a[80:83]
    ds_read_b64_tr_b16 a[236:237], v49 offset:24576
    ds_read_b64_tr_b16 a[238:239], v49 offset:25088
    v_mfma_f32_16x16x32_bf16 a[84:87], a[244:247], a[180:183], a[84:87]
    v_mfma_f32_16x16x32_bf16 a[68:71], a[240:243], a[180:183], a[68:71]
    buffer_load_dwordx4 a[168:171], v32, s[72:75], s86 offen offset:0 sc1
    v_mfma_f32_16x16x32_bf16 a[72:75], a[240:243], a[184:187], a[72:75]
    v_mfma_f32_16x16x32_bf16 a[88:91], a[244:247], a[184:187], a[88:91]
    v_mfma_f32_16x16x32_bf16 a[92:95], a[244:247], a[188:191], a[92:95]
    v_mfma_f32_16x16x32_bf16 a[76:79], a[240:243], a[188:191], a[76:79]
    v_mfma_f32_16x16x32_bf16 a[108:111], a[248:251], a[188:191], a[108:111]
    ds_read_b64_tr_b16 a[240:241], v48 offset:26624
    ds_read_b64_tr_b16 a[242:243], v48 offset:27136
    v_mfma_f32_16x16x32_bf16 a[124:127], a[252:255], a[188:191], a[124:127]
    ds_read_b64_tr_b16 a[244:245], v49 offset:26624
    ds_read_b64_tr_b16 a[246:247], v49 offset:27136
    v_mfma_f32_16x16x32_bf16 a[120:123], a[252:255], a[184:187], a[120:123]
    v_mfma_f32_16x16x32_bf16 a[104:107], a[248:251], a[184:187], a[104:107]
    buffer_load_dwordx4 a[172:175], v32, s[72:75], s87 offen offset:0 sc1
    v_mfma_f32_16x16x32_bf16 a[100:103], a[248:251], a[180:183], a[100:103]
    v_mfma_f32_16x16x32_bf16 a[116:119], a[252:255], a[180:183], a[116:119]
    v_mfma_f32_16x16x32_bf16 a[112:115], a[252:255], a[176:179], a[112:115]
    v_mfma_f32_16x16x32_bf16 a[96:99], a[248:251], a[176:179], a[96:99]
    s_waitcnt lgkmcnt(2)
    v_mfma_f32_16x16x32_bf16 a[128:131], a[224:227], a[176:179], a[128:131]
    s_mov_b32 s96, 8192
    ds_read_b64_tr_b16 a[248:249], v50 offset:24576
    ds_read_b64_tr_b16 a[250:251], v50 offset:25088
    v_mfma_f32_16x16x32_bf16 a[144:147], a[228:231], a[176:179], a[144:147]
    ds_read_b64_tr_b16 a[252:253], v51 offset:24576
    ds_read_b64_tr_b16 a[254:255], v51 offset:25088
    v_mfma_f32_16x16x32_bf16 a[148:151], a[228:231], a[180:183], a[148:151]
    buffer_store_dwordx4 v[136:139], v30, s[44:47], s96 offen offset:1024 sc1
    v_mfma_f32_16x16x32_bf16 a[132:135], a[224:227], a[180:183], a[132:135]
    v_mfma_f32_16x16x32_bf16 a[136:139], a[224:227], a[184:187], a[136:139]
    v_mfma_f32_16x16x32_bf16 a[152:155], a[228:231], a[184:187], a[152:155]
    v_mfma_f32_16x16x32_bf16 a[156:159], a[228:231], a[188:191], a[156:159]
    v_mfma_f32_16x16x32_bf16 a[140:143], a[224:227], a[188:191], a[140:143]
    s_waitcnt vmcnt(28) lgkmcnt(0)
    v_mfma_f32_16x16x32_bf16 v[172:175], a[232:235], a[188:191], v[172:175]
    s_barrier
    ds_read_b64_tr_b16 a[224:225], v40 offset:32768
    ds_read_b64_tr_b16 a[226:227], v40 offset:33792
    v_mfma_f32_16x16x32_bf16 v[188:191], a[236:239], a[188:191], v[188:191]
    s_add_u32 m0, s93, 65536
    ds_read_b64_tr_b16 a[228:229], v41 offset:32768
    ds_read_b64_tr_b16 a[230:231], v41 offset:33792
    v_mfma_f32_16x16x32_bf16 v[184:187], a[236:239], a[184:187], v[184:187]
    s_mov_b32 s94, 3670016
    v_mfma_f32_16x16x32_bf16 v[168:171], a[232:235], a[184:187], v[168:171]
    buffer_load_dwordx4 v34, s[60:63], s94 offen offset:0 lds
    v_mfma_f32_16x16x32_bf16 v[164:167], a[232:235], a[180:183], v[164:167]
    v_mfma_f32_16x16x32_bf16 v[180:183], a[236:239], a[180:183], v[180:183]
    v_mfma_f32_16x16x32_bf16 v[176:179], a[236:239], a[176:179], v[176:179]
    v_mfma_f32_16x16x32_bf16 v[160:163], a[232:235], a[176:179], v[160:163]
    v_mfma_f32_16x16x32_bf16 v[192:195], a[240:243], a[176:179], v[192:195]
    ds_read_b64_tr_b16 a[232:233], v42 offset:32768
    ds_read_b64_tr_b16 a[234:235], v42 offset:33792
    v_mfma_f32_16x16x32_bf16 v[208:211], a[244:247], a[176:179], v[208:211]
    ds_read_b64_tr_b16 a[236:237], v43 offset:32768
    ds_read_b64_tr_b16 a[238:239], v43 offset:33792
    v_mfma_f32_16x16x32_bf16 v[212:215], a[244:247], a[180:183], v[212:215]
    v_mfma_f32_16x16x32_bf16 v[196:199], a[240:243], a[180:183], v[196:199]
    buffer_load_dwordx4 v35, s[60:63], s94 offen offset:1024 lds
    v_mfma_f32_16x16x32_bf16 v[200:203], a[240:243], a[184:187], v[200:203]
    v_mfma_f32_16x16x32_bf16 v[216:219], a[244:247], a[184:187], v[216:219]
    v_mfma_f32_16x16x32_bf16 v[220:223], a[244:247], a[188:191], v[220:223]
    v_mfma_f32_16x16x32_bf16 v[204:207], a[240:243], a[188:191], v[204:207]
    v_mfma_f32_16x16x32_bf16 v[236:239], a[248:251], a[188:191], v[236:239]
    ds_read_b64_tr_b16 a[240:241], v44 offset:32768
    ds_read_b64_tr_b16 a[242:243], v44 offset:33792
    v_mfma_f32_16x16x32_bf16 v[252:255], a[252:255], a[188:191], v[252:255]
    ds_read_b64_tr_b16 a[244:245], v45 offset:32768
    ds_read_b64_tr_b16 a[246:247], v45 offset:33792
    v_mfma_f32_16x16x32_bf16 v[248:251], a[252:255], a[184:187], v[248:251]
    s_mov_b32 s96, 12288
    buffer_store_dwordx4 v[140:143], v30, s[44:47], s96 offen offset:1024 sc1
    v_mfma_f32_16x16x32_bf16 v[232:235], a[248:251], a[184:187], v[232:235]
    buffer_load_dwordx4 v36, s[60:63], s94 offen offset:2048 lds
    v_mfma_f32_16x16x32_bf16 v[228:231], a[248:251], a[180:183], v[228:231]
    v_mfma_f32_16x16x32_bf16 v[244:247], a[252:255], a[180:183], v[244:247]
    v_mfma_f32_16x16x32_bf16 v[240:243], a[252:255], a[176:179], v[240:243]
    v_mfma_f32_16x16x32_bf16 v[224:227], a[248:251], a[176:179], v[224:227]
    s_waitcnt lgkmcnt(2) vmcnt(30)
    v_mfma_f32_16x16x32_bf16 a[0:3], a[224:227], a[192:195], a[0:3]
    ds_read_b64_tr_b16 a[248:249], v46 offset:32768
    ds_read_b64_tr_b16 a[250:251], v46 offset:33792
    v_mfma_f32_16x16x32_bf16 a[16:19], a[228:231], a[192:195], a[16:19]
    s_waitcnt vmcnt(28)
    ds_read_b64_tr_b16 a[252:253], v47 offset:32768
    ds_read_b64_tr_b16 a[254:255], v47 offset:33792
    v_mfma_f32_16x16x32_bf16 a[20:23], a[228:231], a[196:199], a[20:23]
    v_mfma_f32_16x16x32_bf16 a[4:7], a[224:227], a[196:199], a[4:7]
    s_waitcnt vmcnt(27)
    buffer_load_dwordx4 a[176:179], v32, s[72:75], s84 offen offset:1024 sc1
    v_mfma_f32_16x16x32_bf16 a[8:11], a[224:227], a[200:203], a[8:11]
    s_waitcnt vmcnt(27)
    buffer_load_dwordx4 v37, s[60:63], s94 offen offset:3072 lds
    v_mfma_f32_16x16x32_bf16 a[24:27], a[228:231], a[200:203], a[24:27]
    s_add_u32 m0, s93, 81920
    v_mfma_f32_16x16x32_bf16 a[28:31], a[228:231], a[204:207], a[28:31]
    s_mov_b32 s95, 1548288
    v_mfma_f32_16x16x32_bf16 a[12:15], a[224:227], a[204:207], a[12:15]
    v_mfma_f32_16x16x32_bf16 a[44:47], a[232:235], a[204:207], a[44:47]
    ds_read_b64_tr_b16 a[224:225], v50 offset:51200
    ds_read_b64_tr_b16 a[226:227], v50 offset:51712
    v_mfma_f32_16x16x32_bf16 a[60:63], a[236:239], a[204:207], a[60:63]
    ds_read_b64_tr_b16 a[228:229], v51 offset:51200
    ds_read_b64_tr_b16 a[230:231], v51 offset:51712
    v_mfma_f32_16x16x32_bf16 a[56:59], a[236:239], a[200:203], a[56:59]
    v_mfma_f32_16x16x32_bf16 a[40:43], a[232:235], a[200:203], a[40:43]
    buffer_load_dwordx4 a[180:183], v32, s[72:75], s85 offen offset:1024 sc1
    v_mfma_f32_16x16x32_bf16 a[36:39], a[232:235], a[196:199], a[36:39]
    buffer_load_dwordx4 v38, s[64:67], s95 offen offset:0 lds
    v_mfma_f32_16x16x32_bf16 a[52:55], a[236:239], a[196:199], a[52:55]
    v_mfma_f32_16x16x32_bf16 a[48:51], a[236:239], a[192:195], a[48:51]
    v_mfma_f32_16x16x32_bf16 a[32:35], a[232:235], a[192:195], a[32:35]
    v_mfma_f32_16x16x32_bf16 a[64:67], a[240:243], a[192:195], a[64:67]
    s_waitcnt lgkmcnt(0)
    ds_read_b64_tr_b16 a[232:233], v48 offset:49152
    ds_read_b64_tr_b16 a[234:235], v48 offset:49664
    v_mfma_f32_16x16x32_bf16 a[80:83], a[244:247], a[192:195], a[80:83]
    ds_read_b64_tr_b16 a[236:237], v49 offset:49152
    ds_read_b64_tr_b16 a[238:239], v49 offset:49664
    v_mfma_f32_16x16x32_bf16 a[84:87], a[244:247], a[196:199], a[84:87]
    v_mfma_f32_16x16x32_bf16 a[68:71], a[240:243], a[196:199], a[68:71]
    s_mov_b32 s96, 33792
    buffer_load_dwordx4 a[184:187], v32, s[72:75], s86 offen offset:1024 sc1
    v_mfma_f32_16x16x32_bf16 a[72:75], a[240:243], a[200:203], a[72:75]
    buffer_load_dwordx4 v39, s[64:67], s95 offen offset:1024 lds
    v_mfma_f32_16x16x32_bf16 a[88:91], a[244:247], a[200:203], a[88:91]
    buffer_store_dwordx4 v[144:147], v30, s[44:47], s96 offen offset:1024 sc1
    v_mfma_f32_16x16x32_bf16 a[92:95], a[244:247], a[204:207], a[92:95]
    v_mfma_f32_16x16x32_bf16 a[76:79], a[240:243], a[204:207], a[76:79]
    v_mfma_f32_16x16x32_bf16 a[108:111], a[248:251], a[204:207], a[108:111]
    ds_read_b64_tr_b16 a[240:241], v48 offset:51200
    ds_read_b64_tr_b16 a[242:243], v48 offset:51712
    v_mfma_f32_16x16x32_bf16 a[124:127], a[252:255], a[204:207], a[124:127]
    ds_read_b64_tr_b16 a[244:245], v49 offset:51200
    ds_read_b64_tr_b16 a[246:247], v49 offset:51712
    v_mfma_f32_16x16x32_bf16 a[120:123], a[252:255], a[200:203], a[120:123]
    v_mfma_f32_16x16x32_bf16 a[104:107], a[248:251], a[200:203], a[104:107]
    buffer_load_dwordx4 a[188:191], v32, s[72:75], s87 offen offset:1024 sc1
    v_mfma_f32_16x16x32_bf16 a[100:103], a[248:251], a[196:199], a[100:103]
    buffer_load_dwordx4 v38, s[68:71], s95 offen offset:2048 lds
    v_mfma_f32_16x16x32_bf16 a[116:119], a[252:255], a[196:199], a[116:119]
    v_mfma_f32_16x16x32_bf16 a[112:115], a[252:255], a[192:195], a[112:115]
    v_mfma_f32_16x16x32_bf16 a[96:99], a[248:251], a[192:195], a[96:99]
    v_mfma_f32_16x16x32_bf16 a[128:131], a[224:227], a[192:195], a[128:131]
    ds_read_b64_tr_b16 a[248:249], v50 offset:49152
    ds_read_b64_tr_b16 a[250:251], v50 offset:49664
    v_mfma_f32_16x16x32_bf16 a[144:147], a[228:231], a[192:195], a[144:147]
    ds_read_b64_tr_b16 a[252:253], v51 offset:49152
    ds_read_b64_tr_b16 a[254:255], v51 offset:49664
    v_mfma_f32_16x16x32_bf16 a[148:151], a[228:231], a[196:199], a[148:151]
    v_mfma_f32_16x16x32_bf16 a[132:135], a[224:227], a[196:199], a[132:135]
    v_mfma_f32_16x16x32_bf16 a[136:139], a[224:227], a[200:203], a[136:139]
    buffer_load_dwordx4 v39, s[68:71], s95 offen offset:3072 lds
    v_mfma_f32_16x16x32_bf16 a[152:155], a[228:231], a[200:203], a[152:155]
    v_mfma_f32_16x16x32_bf16 a[156:159], a[228:231], a[204:207], a[156:159]
    v_mfma_f32_16x16x32_bf16 a[140:143], a[224:227], a[204:207], a[140:143]
    s_waitcnt lgkmcnt(2)
    v_mfma_f32_16x16x32_bf16 v[172:175], a[232:235], a[204:207], v[172:175]
    ds_read_b64_tr_b16 a[224:225], v40 offset:40960
    ds_read_b64_tr_b16 a[226:227], v40 offset:41984
    v_mfma_f32_16x16x32_bf16 v[188:191], a[236:239], a[204:207], v[188:191]
    ds_read_b64_tr_b16 a[228:229], v41 offset:40960
    ds_read_b64_tr_b16 a[230:231], v41 offset:41984
    v_mfma_f32_16x16x32_bf16 v[184:187], a[236:239], a[200:203], v[184:187]
    v_mfma_f32_16x16x32_bf16 v[168:171], a[232:235], a[200:203], v[168:171]
    v_mfma_f32_16x16x32_bf16 v[164:167], a[232:235], a[196:199], v[164:167]
    v_mfma_f32_16x16x32_bf16 v[180:183], a[236:239], a[196:199], v[180:183]
    s_mov_b32 s96, 37888
    buffer_store_dwordx4 v[148:151], v30, s[44:47], s96 offen offset:1024 sc1
    v_mfma_f32_16x16x32_bf16 v[176:179], a[236:239], a[192:195], v[176:179]
    v_mfma_f32_16x16x32_bf16 v[160:163], a[232:235], a[192:195], v[160:163]
    v_mfma_f32_16x16x32_bf16 v[192:195], a[240:243], a[192:195], v[192:195]
    ds_read_b64_tr_b16 a[232:233], v42 offset:40960
    ds_read_b64_tr_b16 a[234:235], v42 offset:41984
    v_mfma_f32_16x16x32_bf16 v[208:211], a[244:247], a[192:195], v[208:211]
    ds_read_b64_tr_b16 a[236:237], v43 offset:40960
    ds_read_b64_tr_b16 a[238:239], v43 offset:41984
    v_mfma_f32_16x16x32_bf16 v[212:215], a[244:247], a[196:199], v[212:215]
    v_mfma_f32_16x16x32_bf16 v[196:199], a[240:243], a[196:199], v[196:199]
    v_mfma_f32_16x16x32_bf16 v[200:203], a[240:243], a[200:203], v[200:203]
    v_mfma_f32_16x16x32_bf16 v[216:219], a[244:247], a[200:203], v[216:219]
    v_mfma_f32_16x16x32_bf16 v[220:223], a[244:247], a[204:207], v[220:223]
    v_mfma_f32_16x16x32_bf16 v[204:207], a[240:243], a[204:207], v[204:207]
    v_mfma_f32_16x16x32_bf16 v[236:239], a[248:251], a[204:207], v[236:239]
    s_waitcnt lgkmcnt(0)
    ds_read_b64_tr_b16 a[240:241], v44 offset:40960
    ds_read_b64_tr_b16 a[242:243], v44 offset:41984
    v_mfma_f32_16x16x32_bf16 v[252:255], a[252:255], a[204:207], v[252:255]
    ds_read_b64_tr_b16 a[244:245], v45 offset:40960
    ds_read_b64_tr_b16 a[246:247], v45 offset:41984
    v_mfma_f32_16x16x32_bf16 v[248:251], a[252:255], a[200:203], v[248:251]
    v_mfma_f32_16x16x32_bf16 v[232:235], a[248:251], a[200:203], v[232:235]
    v_mfma_f32_16x16x32_bf16 v[228:231], a[248:251], a[196:199], v[228:231]
    v_mfma_f32_16x16x32_bf16 v[244:247], a[252:255], a[196:199], v[244:247]
    v_mfma_f32_16x16x32_bf16 v[240:243], a[252:255], a[192:195], v[240:243]
    v_mfma_f32_16x16x32_bf16 v[224:227], a[248:251], a[192:195], v[224:227]
    s_waitcnt vmcnt(31)
    v_mfma_f32_16x16x32_bf16 a[0:3], a[224:227], a[208:211], a[0:3]
    ds_read_b64_tr_b16 a[248:249], v46 offset:40960
    ds_read_b64_tr_b16 a[250:251], v46 offset:41984
    v_mfma_f32_16x16x32_bf16 a[16:19], a[228:231], a[208:211], a[16:19]
    s_waitcnt vmcnt(29)
    ds_read_b64_tr_b16 a[252:253], v47 offset:40960
    ds_read_b64_tr_b16 a[254:255], v47 offset:41984
    v_mfma_f32_16x16x32_bf16 a[20:23], a[228:231], a[212:215], a[20:23]
    v_mfma_f32_16x16x32_bf16 a[4:7], a[224:227], a[212:215], a[4:7]
    s_waitcnt vmcnt(27)
    buffer_load_dwordx4 a[192:195], v32, s[72:75], s84 offen offset:2048 sc1
    v_mfma_f32_16x16x32_bf16 a[8:11], a[224:227], a[216:219], a[8:11]
    v_mfma_f32_16x16x32_bf16 a[24:27], a[228:231], a[216:219], a[24:27]
    s_waitcnt vmcnt(25)
    v_mfma_f32_16x16x32_bf16 a[28:31], a[228:231], a[220:223], a[28:31]
    s_mov_b32 s96, 41984
    buffer_store_dwordx4 v[152:155], v30, s[44:47], s96 offen offset:1024 sc1
    v_mfma_f32_16x16x32_bf16 a[12:15], a[224:227], a[220:223], a[12:15]
    v_mfma_f32_16x16x32_bf16 a[44:47], a[232:235], a[220:223], a[44:47]
    ds_read_b64_tr_b16 a[224:225], v50 offset:59392
    ds_read_b64_tr_b16 a[226:227], v50 offset:59904
    v_mfma_f32_16x16x32_bf16 a[60:63], a[236:239], a[220:223], a[60:63]
    ds_read_b64_tr_b16 a[228:229], v51 offset:59392
    ds_read_b64_tr_b16 a[230:231], v51 offset:59904
    v_mfma_f32_16x16x32_bf16 a[56:59], a[236:239], a[216:219], a[56:59]
    v_mfma_f32_16x16x32_bf16 a[40:43], a[232:235], a[216:219], a[40:43]
    buffer_load_dwordx4 a[196:199], v32, s[72:75], s85 offen offset:2048 sc1
    v_mfma_f32_16x16x32_bf16 a[36:39], a[232:235], a[212:215], a[36:39]
    v_mfma_f32_16x16x32_bf16 a[52:55], a[236:239], a[212:215], a[52:55]
    v_mfma_f32_16x16x32_bf16 a[48:51], a[236:239], a[208:211], a[48:51]
    v_mfma_f32_16x16x32_bf16 a[32:35], a[232:235], a[208:211], a[32:35]
    s_waitcnt lgkmcnt(2)
    v_mfma_f32_16x16x32_bf16 a[64:67], a[240:243], a[208:211], a[64:67]
    ds_read_b64_tr_b16 a[232:233], v48 offset:57344
    ds_read_b64_tr_b16 a[234:235], v48 offset:57856
    v_mfma_f32_16x16x32_bf16 a[80:83], a[244:247], a[208:211], a[80:83]
    ds_read_b64_tr_b16 a[236:237], v49 offset:57344
    ds_read_b64_tr_b16 a[238:239], v49 offset:57856
    v_mfma_f32_16x16x32_bf16 a[84:87], a[244:247], a[212:215], a[84:87]
    v_mfma_f32_16x16x32_bf16 a[68:71], a[240:243], a[212:215], a[68:71]
    buffer_load_dwordx4 a[200:203], v32, s[72:75], s86 offen offset:2048 sc1
    v_mfma_f32_16x16x32_bf16 a[72:75], a[240:243], a[216:219], a[72:75]
    v_mfma_f32_16x16x32_bf16 a[88:91], a[244:247], a[216:219], a[88:91]
    v_mfma_f32_16x16x32_bf16 a[92:95], a[244:247], a[220:223], a[92:95]
    v_mfma_f32_16x16x32_bf16 a[76:79], a[240:243], a[220:223], a[76:79]
    v_mfma_f32_16x16x32_bf16 a[108:111], a[248:251], a[220:223], a[108:111]
    ds_read_b64_tr_b16 a[240:241], v48 offset:59392
    ds_read_b64_tr_b16 a[242:243], v48 offset:59904
    v_mfma_f32_16x16x32_bf16 a[124:127], a[252:255], a[220:223], a[124:127]
    ds_read_b64_tr_b16 a[244:245], v49 offset:59392
    ds_read_b64_tr_b16 a[246:247], v49 offset:59904
    v_mfma_f32_16x16x32_bf16 a[120:123], a[252:255], a[216:219], a[120:123]
    v_mfma_f32_16x16x32_bf16 a[104:107], a[248:251], a[216:219], a[104:107]
    buffer_load_dwordx4 a[204:207], v32, s[72:75], s87 offen offset:2048 sc1
    v_mfma_f32_16x16x32_bf16 a[100:103], a[248:251], a[212:215], a[100:103]
    v_mfma_f32_16x16x32_bf16 a[116:119], a[252:255], a[212:215], a[116:119]
    v_mfma_f32_16x16x32_bf16 a[112:115], a[252:255], a[208:211], a[112:115]
    v_mfma_f32_16x16x32_bf16 a[96:99], a[248:251], a[208:211], a[96:99]
    s_waitcnt lgkmcnt(2)
    v_mfma_f32_16x16x32_bf16 a[128:131], a[224:227], a[208:211], a[128:131]
    s_mov_b32 s96, 46080
    ds_read_b64_tr_b16 a[248:249], v50 offset:57344
    ds_read_b64_tr_b16 a[250:251], v50 offset:57856
    v_mfma_f32_16x16x32_bf16 a[144:147], a[228:231], a[208:211], a[144:147]
    ds_read_b64_tr_b16 a[252:253], v51 offset:57344
    ds_read_b64_tr_b16 a[254:255], v51 offset:57856
    v_mfma_f32_16x16x32_bf16 a[148:151], a[228:231], a[212:215], a[148:151]
    buffer_store_dwordx4 v[156:159], v30, s[44:47], s96 offen offset:1024 sc1
    v_mfma_f32_16x16x32_bf16 a[132:135], a[224:227], a[212:215], a[132:135]
    v_mfma_f32_16x16x32_bf16 a[136:139], a[224:227], a[216:219], a[136:139]
    v_lshrrev_b32 v28, 4, v1
    v_lshlrev_b32 v28, 2, v28
    v_mfma_f32_16x16x32_bf16 a[152:155], a[228:231], a[216:219], a[152:155]
    v_and_b32 v29, 15, v1
    v_sub_u32 v28, v29, v28
    v_mfma_f32_16x16x32_bf16 a[156:159], a[228:231], a[220:223], a[156:159]
    v_lshlrev_b32_e64 v29, 4, s30
    v_sub_u32 v30, v28, v29
    v_mfma_f32_16x16x32_bf16 a[140:143], a[224:227], a[220:223], a[140:143]
    s_waitcnt vmcnt(28) lgkmcnt(0)
    v_add_u32 v30, 48, v30
    v_add_u32 v29, v28, v29
    v_mfma_f32_16x16x32_bf16 v[172:175], a[232:235], a[220:223], v[172:175]
    s_barrier
    ds_read_b64_tr_b16 a[224:225], v52 offset:0
    ds_read_b64_tr_b16 a[226:227], v52 offset:1024
    v_mfma_f32_16x16x32_bf16 v[188:191], a[236:239], a[220:223], v[188:191]
    s_add_u32 m0, s93, 98304
    ds_read_b64_tr_b16 a[228:229], v53 offset:0
    ds_read_b64_tr_b16 a[230:231], v53 offset:1024
    v_mfma_f32_16x16x32_bf16 v[184:187], a[236:239], a[216:219], v[184:187]
    s_mov_b32 s94, 4194304
    v_subrev_u32 v128, 0, v29
    v_and_b32 v128, 0xff000000, v128
    v_mfma_f32_16x16x32_bf16 v[168:171], a[232:235], a[216:219], v[168:171]
    buffer_load_dwordx4 v34, s[60:63], s94 offen offset:0 lds
    v_mfma_f32_16x16x32_bf16 v[164:167], a[232:235], a[212:215], v[164:167]
    v_subrev_u32 v129, 1, v29
    v_and_b32 v129, 0xff000000, v129
    v_mfma_f32_16x16x32_bf16 v[180:183], a[236:239], a[212:215], v[180:183]
    v_subrev_u32 v130, 2, v29
    v_and_b32 v130, 0xff000000, v130
    v_mfma_f32_16x16x32_bf16 v[176:179], a[236:239], a[208:211], v[176:179]
    v_subrev_u32 v131, 3, v29
    v_and_b32 v131, 0xff000000, v131
    v_mfma_f32_16x16x32_bf16 v[160:163], a[232:235], a[208:211], v[160:163]
    v_subrev_u32 v132, 16, v29
    v_and_b32 v132, 0xff000000, v132
    v_mfma_f32_16x16x32_bf16 v[192:195], a[240:243], a[208:211], v[192:195]
    ds_read_b64_tr_b16 a[232:233], v54 offset:0
    ds_read_b64_tr_b16 a[234:235], v54 offset:1024
    v_mfma_f32_16x16x32_bf16 v[208:211], a[244:247], a[208:211], v[208:211]
    ds_read_b64_tr_b16 a[236:237], v55 offset:0
    ds_read_b64_tr_b16 a[238:239], v55 offset:1024
    v_mfma_f32_16x16x32_bf16 v[212:215], a[244:247], a[212:215], v[212:215]
    v_subrev_u32 v133, 17, v29
    v_and_b32 v133, 0xff000000, v133
    v_mfma_f32_16x16x32_bf16 v[196:199], a[240:243], a[212:215], v[196:199]
    buffer_load_dwordx4 v35, s[60:63], s94 offen offset:1024 lds
    v_mfma_f32_16x16x32_bf16 v[200:203], a[240:243], a[216:219], v[200:203]
    v_subrev_u32 v134, 18, v29
    v_and_b32 v134, 0xff000000, v134
    v_mfma_f32_16x16x32_bf16 v[216:219], a[244:247], a[216:219], v[216:219]
    v_subrev_u32 v135, 19, v29
    v_and_b32 v135, 0xff000000, v135
    v_mfma_f32_16x16x32_bf16 v[220:223], a[244:247], a[220:223], v[220:223]
    v_subrev_u32 v136, 32, v29
    v_and_b32 v136, 0xff000000, v136
    v_mfma_f32_16x16x32_bf16 v[204:207], a[240:243], a[220:223], v[204:207]
    v_subrev_u32 v137, 33, v29
    v_and_b32 v137, 0xff000000, v137
    v_mfma_f32_16x16x32_bf16 v[236:239], a[248:251], a[220:223], v[236:239]
    ds_read_b64_tr_b16 a[240:241], v56 offset:0
    ds_read_b64_tr_b16 a[242:243], v56 offset:1024
    v_mfma_f32_16x16x32_bf16 v[252:255], a[252:255], a[220:223], v[252:255]
    ds_read_b64_tr_b16 a[244:245], v57 offset:0
    ds_read_b64_tr_b16 a[246:247], v57 offset:1024
    v_mfma_f32_16x16x32_bf16 v[248:251], a[252:255], a[216:219], v[248:251]
    v_subrev_u32 v138, 34, v29
    v_and_b32 v138, 0xff000000, v138
    v_mfma_f32_16x16x32_bf16 v[232:235], a[248:251], a[216:219], v[232:235]
    buffer_load_dwordx4 v36, s[60:63], s94 offen offset:2048 lds
    v_mfma_f32_16x16x32_bf16 v[228:231], a[248:251], a[212:215], v[228:231]
    v_subrev_u32 v139, 35, v29
    v_and_b32 v139, 0xff000000, v139
    v_mfma_f32_16x16x32_bf16 v[244:247], a[252:255], a[212:215], v[244:247]
    v_subrev_u32 v140, 48, v29
    v_and_b32 v140, 0xff000000, v140
    v_mfma_f32_16x16x32_bf16 v[240:243], a[252:255], a[208:211], v[240:243]
    v_subrev_u32 v141, 49, v29
    v_and_b32 v141, 0xff000000, v141
    v_mfma_f32_16x16x32_bf16 v[224:227], a[248:251], a[208:211], v[224:227]
    s_waitcnt lgkmcnt(2) vmcnt(29)
    v_subrev_u32 v142, 50, v29
    v_and_b32 v142, 0xff000000, v142
    v_mfma_f32_16x16x32_bf16 a[0:3], a[224:227], a[160:163], a[0:3]
    ds_read_b64_tr_b16 a[248:249], v58 offset:0
    ds_read_b64_tr_b16 a[250:251], v58 offset:1024
    v_mfma_f32_16x16x32_bf16 a[16:19], a[228:231], a[160:163], a[16:19]
    s_waitcnt vmcnt(27)
    ds_read_b64_tr_b16 a[252:253], v59 offset:0
    ds_read_b64_tr_b16 a[254:255], v59 offset:1024
    v_mfma_f32_16x16x32_bf16 a[20:23], a[228:231], a[164:167], a[20:23]
    v_subrev_u32 v143, 51, v29
    v_and_b32 v143, 0xff000000, v143
    v_mfma_f32_16x16x32_bf16 a[4:7], a[224:227], a[164:167], a[4:7]
    s_waitcnt vmcnt(26)
    buffer_load_dwordx4 a[208:211], v32, s[72:75], s84 offen offset:3072 sc1
    v_mfma_f32_16x16x32_bf16 a[8:11], a[224:227], a[168:171], a[8:11]
    s_waitcnt vmcnt(26)
    buffer_load_dwordx4 v37, s[60:63], s94 offen offset:3072 lds
    v_mfma_f32_16x16x32_bf16 a[24:27], a[228:231], a[168:171], a[24:27]
    s_add_u32 m0, s93, 114688
    v_subrev_u32 v144, 0, v30
    v_and_b32 v144, 0xff000000, v144
    v_mfma_f32_16x16x32_bf16 a[28:31], a[228:231], a[172:175], a[28:31]
    s_mov_b32 s95, 1769472
    v_subrev_u32 v145, 1, v30
    v_and_b32 v145, 0xff000000, v145
    v_mfma_f32_16x16x32_bf16 a[12:15], a[224:227], a[172:175], a[12:15]
    v_subrev_u32 v146, 2, v30
    v_and_b32 v146, 0xff000000, v146
    v_mfma_f32_16x16x32_bf16 a[44:47], a[232:235], a[172:175], a[44:47]
    ds_read_b64_tr_b16 a[224:225], v62 offset:18432
    ds_read_b64_tr_b16 a[226:227], v62 offset:18944
    v_mfma_f32_16x16x32_bf16 a[60:63], a[236:239], a[172:175], a[60:63]
    ds_read_b64_tr_b16 a[228:229], v63 offset:18432
    ds_read_b64_tr_b16 a[230:231], v63 offset:18944
    v_mfma_f32_16x16x32_bf16 a[56:59], a[236:239], a[168:171], a[56:59]
    v_subrev_u32 v147, 3, v30
    v_and_b32 v147, 0xff000000, v147
    v_mfma_f32_16x16x32_bf16 a[40:43], a[232:235], a[168:171], a[40:43]
    buffer_load_dwordx4 a[212:215], v32, s[72:75], s85 offen offset:3072 sc1
    v_mfma_f32_16x16x32_bf16 a[36:39], a[232:235], a[164:167], a[36:39]
    buffer_load_dwordx4 v38, s[64:67], s95 offen offset:0 lds
    v_mfma_f32_16x16x32_bf16 a[52:55], a[236:239], a[164:167], a[52:55]
    v_subrev_u32 v148, 16, v30
    v_and_b32 v148, 0xff000000, v148
    v_mfma_f32_16x16x32_bf16 a[48:51], a[236:239], a[160:163], a[48:51]
    v_subrev_u32 v149, 17, v30
    v_and_b32 v149, 0xff000000, v149
    v_mfma_f32_16x16x32_bf16 a[32:35], a[232:235], a[160:163], a[32:35]
    v_subrev_u32 v150, 18, v30
    v_and_b32 v150, 0xff000000, v150
    v_mfma_f32_16x16x32_bf16 a[64:67], a[240:243], a[160:163], a[64:67]
    s_waitcnt lgkmcnt(0)
    ds_read_b64_tr_b16 a[232:233], v60 offset:16384
    ds_read_b64_tr_b16 a[234:235], v60 offset:16896
    v_mfma_f32_16x16x32_bf16 a[80:83], a[244:247], a[160:163], a[80:83]
    ds_read_b64_tr_b16 a[236:237], v61 offset:16384
    ds_read_b64_tr_b16 a[238:239], v61 offset:16896
    v_mfma_f32_16x16x32_bf16 a[84:87], a[244:247], a[164:167], a[84:87]
    v_subrev_u32 v151, 19, v30
    v_and_b32 v151, 0xff000000, v151
    v_mfma_f32_16x16x32_bf16 a[68:71], a[240:243], a[164:167], a[68:71]
    buffer_load_dwordx4 a[216:219], v32, s[72:75], s86 offen offset:3072 sc1
    v_mfma_f32_16x16x32_bf16 a[72:75], a[240:243], a[168:171], a[72:75]
    buffer_load_dwordx4 v39, s[64:67], s95 offen offset:1024 lds
    v_mfma_f32_16x16x32_bf16 a[88:91], a[244:247], a[168:171], a[88:91]
    v_subrev_u32 v152, 32, v30
    v_and_b32 v152, 0xff000000, v152
    v_mfma_f32_16x16x32_bf16 a[92:95], a[244:247], a[172:175], a[92:95]
    v_subrev_u32 v153, 33, v30
    v_and_b32 v153, 0xff000000, v153
    v_mfma_f32_16x16x32_bf16 a[76:79], a[240:243], a[172:175], a[76:79]
    v_subrev_u32 v154, 34, v30
    v_and_b32 v154, 0xff000000, v154
    v_mfma_f32_16x16x32_bf16 a[108:111], a[248:251], a[172:175], a[108:111]
    ds_read_b64_tr_b16 a[240:241], v60 offset:18432
    ds_read_b64_tr_b16 a[242:243], v60 offset:18944
    v_mfma_f32_16x16x32_bf16 a[124:127], a[252:255], a[172:175], a[124:127]
    ds_read_b64_tr_b16 a[244:245], v61 offset:18432
    ds_read_b64_tr_b16 a[246:247], v61 offset:18944
    v_mfma_f32_16x16x32_bf16 a[120:123], a[252:255], a[168:171], a[120:123]
    v_subrev_u32 v155, 35, v30
    v_and_b32 v155, 0xff000000, v155
    v_mfma_f32_16x16x32_bf16 a[104:107], a[248:251], a[168:171], a[104:107]
    buffer_load_dwordx4 a[220:223], v32, s[72:75], s87 offen offset:3072 sc1
    v_mfma_f32_16x16x32_bf16 a[100:103], a[248:251], a[164:167], a[100:103]
    buffer_load_dwordx4 v38, s[68:71], s95 offen offset:2048 lds
    v_mfma_f32_16x16x32_bf16 a[116:119], a[252:255], a[164:167], a[116:119]
    v_subrev_u32 v156, 48, v30
    v_and_b32 v156, 0xff000000, v156
    v_mfma_f32_16x16x32_bf16 a[112:115], a[252:255], a[160:163], a[112:115]
    v_subrev_u32 v157, 49, v30
    v_and_b32 v157, 0xff000000, v157
    v_mfma_f32_16x16x32_bf16 a[96:99], a[248:251], a[160:163], a[96:99]
    v_subrev_u32 v158, 50, v30
    v_and_b32 v158, 0xff000000, v158
    v_mfma_f32_16x16x32_bf16 a[128:131], a[224:227], a[160:163], a[128:131]
    ds_read_b64_tr_b16 a[248:249], v62 offset:16384
    ds_read_b64_tr_b16 a[250:251], v62 offset:16896
    v_mfma_f32_16x16x32_bf16 a[144:147], a[228:231], a[160:163], a[144:147]
    ds_read_b64_tr_b16 a[252:253], v63 offset:16384
    ds_read_b64_tr_b16 a[254:255], v63 offset:16896
    v_mfma_f32_16x16x32_bf16 a[148:151], a[228:231], a[164:167], a[148:151]
    v_subrev_u32 v159, 51, v30
    v_and_b32 v159, 0xff000000, v159
    v_mfma_f32_16x16x32_bf16 a[132:135], a[224:227], a[164:167], a[132:135]
    v_mov_b32 v24, 0x3f803f80
    v_mov_b32 v25, 0x3f803f80
    v_mfma_f32_16x16x32_bf16 a[136:139], a[224:227], a[168:171], a[136:139]
    buffer_load_dwordx4 v39, s[68:71], s95 offen offset:3072 lds
    v_mfma_f32_16x16x32_bf16 a[152:155], a[228:231], a[168:171], a[152:155]
    v_mov_b32 v26, 0x3f803f80
    v_mov_b32 v27, 0x3f803f80
    v_mfma_f32_16x16x32_bf16 a[156:159], a[228:231], a[172:175], a[156:159]
    v_mov_b32 v8, 0
    v_mov_b32 v9, 0
    v_mfma_f32_16x16x32_bf16 a[140:143], a[224:227], a[172:175], a[140:143]
    s_waitcnt lgkmcnt(2)
    v_mov_b32 v10, 0
    v_mov_b32 v11, 0
    v_mfma_f32_16x16x32_bf16 v[172:175], a[232:235], a[172:175], v[172:175]
    ds_read_b64_tr_b16 a[224:225], v52 offset:8192
    ds_read_b64_tr_b16 a[226:227], v52 offset:9216
    v_mfma_f32_16x16x32_bf16 v[188:191], a[236:239], a[172:175], v[188:191]
    ds_read_b64_tr_b16 a[228:229], v53 offset:8192
    ds_read_b64_tr_b16 a[230:231], v53 offset:9216
    v_mfma_f32_16x16x32_bf16 v[184:187], a[236:239], a[168:171], v[184:187]
    v_mov_b32 v12, 0
    v_mov_b32 v13, 0
    v_mfma_f32_16x16x32_bf16 v[168:171], a[232:235], a[168:171], v[168:171]
    v_mov_b32 v14, 0
    v_mov_b32 v15, 0
    v_mfma_f32_16x16x32_bf16 v[164:167], a[232:235], a[164:167], v[164:167]
    v_mov_b32 v16, 0
    v_mov_b32 v17, 0
    v_mfma_f32_16x16x32_bf16 v[180:183], a[236:239], a[164:167], v[180:183]
    v_mov_b32 v18, 0
    v_mov_b32 v19, 0
    v_mfma_f32_16x16x32_bf16 v[176:179], a[236:239], a[160:163], v[176:179]
    v_mov_b32 v20, 0
    v_mov_b32 v21, 0
    v_mfma_f32_16x16x32_bf16 v[160:163], a[232:235], a[160:163], v[160:163]
    v_mov_b32 v22, 0
    v_mov_b32 v23, 0
    v_mfma_f32_16x16x32_bf16 v[192:195], a[240:243], a[160:163], v[192:195]
    ds_read_b64_tr_b16 a[232:233], v54 offset:8192
    ds_read_b64_tr_b16 a[234:235], v54 offset:9216
    v_mfma_f32_16x16x32_bf16 v[208:211], a[244:247], a[160:163], v[208:211]
    ds_read_b64_tr_b16 a[236:237], v55 offset:8192
    ds_read_b64_tr_b16 a[238:239], v55 offset:9216
    v_mfma_f32_16x16x32_bf16 v[212:215], a[244:247], a[164:167], v[212:215]
    v_and_b32 v28, 7, v1
    v_mfma_f32_16x16x32_bf16 v[196:199], a[240:243], a[164:167], v[196:199]
    s_and_b32 s33, s2, 31
    v_lshl_add_u32 v28, v28, 5, s33
    v_lshlrev_b32 v3, 7, v28
    v_mfma_f32_16x16x32_bf16 v[200:203], a[240:243], a[168:171], v[200:203]
    s_lshl_b32 s33, s3, 11
    v_mfma_f32_16x16x32_bf16 v[216:219], a[244:247], a[168:171], v[216:219]
    s_add_u32 s33, s33, 42074112
    v_mfma_f32_16x16x32_bf16 v[220:223], a[244:247], a[172:175], v[220:223]
    s_add_u32 s48, s28, s33
    s_addc_u32 s49, s29, 0
    v_mfma_f32_16x16x32_bf16 v[204:207], a[240:243], a[172:175], v[204:207]
    s_mov_b32 s50, 23930880
    v_mfma_f32_16x16x32_bf16 v[236:239], a[248:251], a[172:175], v[236:239]
    s_mov_b32 s51, 0x00020000
    ds_read_b64_tr_b16 a[240:241], v56 offset:8192
    ds_read_b64_tr_b16 a[242:243], v56 offset:9216
    s_waitcnt lgkmcnt(10)
    v_mfma_f32_16x16x32_bf16 v[252:255], a[252:255], a[172:175], v[252:255]
    ds_read_b64_tr_b16 a[244:245], v57 offset:8192
    ds_read_b64_tr_b16 a[246:247], v57 offset:9216
    v_mfma_f32_16x16x32_bf16 v[248:251], a[252:255], a[168:171], v[248:251]
    v_mfma_f32_16x16x32_bf16 v[232:235], a[248:251], a[168:171], v[232:235]
    v_mfma_f32_16x16x32_bf16 v[228:231], a[248:251], a[164:167], v[228:231]
    v_mfma_f32_16x16x32_bf16 v[244:247], a[252:255], a[164:167], v[244:247]
    v_mfma_f32_16x16x32_bf16 v[240:243], a[252:255], a[160:163], v[240:243]
    v_mfma_f32_16x16x32_bf16 v[224:227], a[248:251], a[160:163], v[224:227]
    s_waitcnt lgkmcnt(2) vmcnt(28)
    v_mfma_f32_16x16x32_bf16 a[0:3], a[224:227], a[176:179], a[0:3]
    ds_read_b64_tr_b16 a[248:249], v58 offset:8192
    ds_read_b64_tr_b16 a[250:251], v58 offset:9216
    v_mfma_f32_16x16x32_bf16 a[16:19], a[228:231], a[176:179], a[16:19]
    s_waitcnt vmcnt(26)
    ds_read_b64_tr_b16 a[252:253], v59 offset:8192
    ds_read_b64_tr_b16 a[254:255], v59 offset:9216
    v_mfma_f32_16x16x32_bf16 a[20:23], a[228:231], a[180:183], a[20:23]
    v_add_u32 v32, 4096, v32
    v_mfma_f32_16x16x32_bf16 a[4:7], a[224:227], a[180:183], a[4:7]
    s_waitcnt vmcnt(24)
    buffer_load_dwordx4 a[160:163], v32, s[72:75], s84 offen offset:0 sc1
    v_mfma_f32_16x16x32_bf16 a[8:11], a[224:227], a[184:187], a[8:11]
    v_mfma_f32_16x16x32_bf16 a[24:27], a[228:231], a[184:187], a[24:27]
    s_waitcnt vmcnt(22)
    v_mfma_f32_16x16x32_bf16 a[28:31], a[228:231], a[188:191], a[28:31]
    v_mfma_f32_16x16x32_bf16 a[12:15], a[224:227], a[188:191], a[12:15]
    v_mfma_f32_16x16x32_bf16 a[44:47], a[232:235], a[188:191], a[44:47]
    ds_read_b64_tr_b16 a[224:225], v62 offset:26624
    ds_read_b64_tr_b16 a[226:227], v62 offset:27136
    v_mfma_f32_16x16x32_bf16 a[60:63], a[236:239], a[188:191], a[60:63]
    ds_read_b64_tr_b16 a[228:229], v63 offset:26624
    ds_read_b64_tr_b16 a[230:231], v63 offset:27136
    v_mfma_f32_16x16x32_bf16 a[56:59], a[236:239], a[184:187], a[56:59]
    v_mfma_f32_16x16x32_bf16 a[40:43], a[232:235], a[184:187], a[40:43]
    buffer_load_dwordx4 a[164:167], v32, s[72:75], s85 offen offset:0 sc1
    v_mfma_f32_16x16x32_bf16 a[36:39], a[232:235], a[180:183], a[36:39]
    v_mfma_f32_16x16x32_bf16 a[52:55], a[236:239], a[180:183], a[52:55]
    v_mfma_f32_16x16x32_bf16 a[48:51], a[236:239], a[176:179], a[48:51]
    v_mfma_f32_16x16x32_bf16 a[32:35], a[232:235], a[176:179], a[32:35]
    v_mfma_f32_16x16x32_bf16 a[64:67], a[240:243], a[176:179], a[64:67]
    s_waitcnt lgkmcnt(0)
    ds_read_b64_tr_b16 a[232:233], v60 offset:24576
    ds_read_b64_tr_b16 a[234:235], v60 offset:25088
    v_mfma_f32_16x16x32_bf16 a[80:83], a[244:247], a[176:179], a[80:83]
    ds_read_b64_tr_b16 a[236:237], v61 offset:24576
    ds_read_b64_tr_b16 a[238:239], v61 offset:25088
    v_mfma_f32_16x16x32_bf16 a[84:87], a[244:247], a[180:183], a[84:87]
    v_mfma_f32_16x16x32_bf16 a[68:71], a[240:243], a[180:183], a[68:71]
    buffer_load_dwordx4 a[168:171], v32, s[72:75], s86 offen offset:0 sc1
    v_mfma_f32_16x16x32_bf16 a[72:75], a[240:243], a[184:187], a[72:75]
    v_mfma_f32_16x16x32_bf16 a[88:91], a[244:247], a[184:187], a[88:91]
    v_mfma_f32_16x16x32_bf16 a[92:95], a[244:247], a[188:191], a[92:95]
    v_mfma_f32_16x16x32_bf16 a[76:79], a[240:243], a[188:191], a[76:79]
    v_mfma_f32_16x16x32_bf16 a[108:111], a[248:251], a[188:191], a[108:111]
    ds_read_b64_tr_b16 a[240:241], v60 offset:26624
    ds_read_b64_tr_b16 a[242:243], v60 offset:27136
    v_mfma_f32_16x16x32_bf16 a[124:127], a[252:255], a[188:191], a[124:127]
    ds_read_b64_tr_b16 a[244:245], v61 offset:26624
    ds_read_b64_tr_b16 a[246:247], v61 offset:27136
    v_mfma_f32_16x16x32_bf16 a[120:123], a[252:255], a[184:187], a[120:123]
    v_mfma_f32_16x16x32_bf16 a[104:107], a[248:251], a[184:187], a[104:107]
    buffer_load_dwordx4 a[172:175], v32, s[72:75], s87 offen offset:0 sc1
    v_mfma_f32_16x16x32_bf16 a[100:103], a[248:251], a[180:183], a[100:103]
    v_mfma_f32_16x16x32_bf16 a[116:119], a[252:255], a[180:183], a[116:119]
    v_mfma_f32_16x16x32_bf16 a[112:115], a[252:255], a[176:179], a[112:115]
    v_mfma_f32_16x16x32_bf16 a[96:99], a[248:251], a[176:179], a[96:99]
    v_mfma_f32_16x16x32_bf16 a[128:131], a[224:227], a[176:179], a[128:131]
    ds_read_b64_tr_b16 a[248:249], v62 offset:24576
    ds_read_b64_tr_b16 a[250:251], v62 offset:25088
    v_mfma_f32_16x16x32_bf16 a[144:147], a[228:231], a[176:179], a[144:147]
    ds_read_b64_tr_b16 a[252:253], v63 offset:24576
    ds_read_b64_tr_b16 a[254:255], v63 offset:25088
    v_mfma_f32_16x16x32_bf16 a[148:151], a[228:231], a[180:183], a[148:151]
    v_mfma_f32_16x16x32_bf16 a[132:135], a[224:227], a[180:183], a[132:135]
    v_mfma_f32_16x16x32_bf16 a[136:139], a[224:227], a[184:187], a[136:139]
    v_mfma_f32_16x16x32_bf16 a[152:155], a[228:231], a[184:187], a[152:155]
    v_mfma_f32_16x16x32_bf16 a[156:159], a[228:231], a[188:191], a[156:159]
    v_mfma_f32_16x16x32_bf16 a[140:143], a[224:227], a[188:191], a[140:143]
    s_waitcnt vmcnt(23) lgkmcnt(0)
    v_mfma_f32_16x16x32_bf16 v[172:175], a[232:235], a[188:191], v[172:175]
    s_barrier
    ds_read_b64_tr_b16 a[224:225], v40 offset:0
    ds_read_b64_tr_b16 a[226:227], v40 offset:1024
    v_mfma_f32_16x16x32_bf16 v[188:191], a[236:239], a[188:191], v[188:191]
    s_add_u32 m0, s93, 131072
    ds_read_b64_tr_b16 a[228:229], v41 offset:0
    ds_read_b64_tr_b16 a[230:231], v41 offset:1024
    v_mfma_f32_16x16x32_bf16 v[184:187], a[236:239], a[184:187], v[184:187]
    s_mov_b32 s94, 4718592
    v_mfma_f32_16x16x32_bf16 v[168:171], a[232:235], a[184:187], v[168:171]
    buffer_load_dwordx4 v34, s[60:63], s94 offen offset:0 lds
    v_mfma_f32_16x16x32_bf16 v[164:167], a[232:235], a[180:183], v[164:167]
    v_mfma_f32_16x16x32_bf16 v[180:183], a[236:239], a[180:183], v[180:183]
    v_mfma_f32_16x16x32_bf16 v[176:179], a[236:239], a[176:179], v[176:179]
    v_mfma_f32_16x16x32_bf16 v[160:163], a[232:235], a[176:179], v[160:163]
    v_mfma_f32_16x16x32_bf16 v[192:195], a[240:243], a[176:179], v[192:195]
    ds_read_b64_tr_b16 a[232:233], v42 offset:0
    ds_read_b64_tr_b16 a[234:235], v42 offset:1024
    v_mfma_f32_16x16x32_bf16 v[208:211], a[244:247], a[176:179], v[208:211]
    ds_read_b64_tr_b16 a[236:237], v43 offset:0
    ds_read_b64_tr_b16 a[238:239], v43 offset:1024
    v_mfma_f32_16x16x32_bf16 v[212:215], a[244:247], a[180:183], v[212:215]
    v_mfma_f32_16x16x32_bf16 v[196:199], a[240:243], a[180:183], v[196:199]
    buffer_load_dwordx4 v35, s[60:63], s94 offen offset:1024 lds
    v_mfma_f32_16x16x32_bf16 v[200:203], a[240:243], a[184:187], v[200:203]
    v_mfma_f32_16x16x32_bf16 v[216:219], a[244:247], a[184:187], v[216:219]
    v_mfma_f32_16x16x32_bf16 v[220:223], a[244:247], a[188:191], v[220:223]
    v_mfma_f32_16x16x32_bf16 v[204:207], a[240:243], a[188:191], v[204:207]
    v_mfma_f32_16x16x32_bf16 v[236:239], a[248:251], a[188:191], v[236:239]
    ds_read_b64_tr_b16 a[240:241], v44 offset:0
    ds_read_b64_tr_b16 a[242:243], v44 offset:1024
    v_mfma_f32_16x16x32_bf16 v[252:255], a[252:255], a[188:191], v[252:255]
    ds_read_b64_tr_b16 a[244:245], v45 offset:0
    ds_read_b64_tr_b16 a[246:247], v45 offset:1024
    v_mfma_f32_16x16x32_bf16 v[248:251], a[252:255], a[184:187], v[248:251]
    v_mfma_f32_16x16x32_bf16 v[232:235], a[248:251], a[184:187], v[232:235]
    buffer_load_dwordx4 v36, s[60:63], s94 offen offset:2048 lds
    v_mfma_f32_16x16x32_bf16 v[228:231], a[248:251], a[180:183], v[228:231]
    v_mfma_f32_16x16x32_bf16 v[244:247], a[252:255], a[180:183], v[244:247]
    v_mfma_f32_16x16x32_bf16 v[240:243], a[252:255], a[176:179], v[240:243]
    v_mfma_f32_16x16x32_bf16 v[224:227], a[248:251], a[176:179], v[224:227]
    s_waitcnt lgkmcnt(2) vmcnt(24)
    v_mfma_f32_16x16x32_bf16 a[0:3], a[224:227], a[192:195], a[0:3]
    ds_read_b64_tr_b16 a[248:249], v46 offset:0
    ds_read_b64_tr_b16 a[250:251], v46 offset:1024
    v_mfma_f32_16x16x32_bf16 a[16:19], a[228:231], a[192:195], a[16:19]
    s_waitcnt vmcnt(22)
    ds_read_b64_tr_b16 a[252:253], v47 offset:0
    ds_read_b64_tr_b16 a[254:255], v47 offset:1024
    v_mfma_f32_16x16x32_bf16 a[20:23], a[228:231], a[196:199], a[20:23]
    v_mfma_f32_16x16x32_bf16 a[4:7], a[224:227], a[196:199], a[4:7]
    s_waitcnt vmcnt(21)
    buffer_load_dwordx4 a[176:179], v32, s[72:75], s84 offen offset:1024 sc1
    v_mfma_f32_16x16x32_bf16 a[8:11], a[224:227], a[200:203], a[8:11]
    s_waitcnt vmcnt(21)
    buffer_load_dwordx4 v37, s[60:63], s94 offen offset:3072 lds
    v_mfma_f32_16x16x32_bf16 a[24:27], a[228:231], a[200:203], a[24:27]
    s_add_u32 m0, s93, 147456
    v_mfma_f32_16x16x32_bf16 a[28:31], a[228:231], a[204:207], a[28:31]
    s_mov_b32 s95, 1990656
    v_mfma_f32_16x16x32_bf16 a[12:15], a[224:227], a[204:207], a[12:15]
    v_mfma_f32_16x16x32_bf16 a[44:47], a[232:235], a[204:207], a[44:47]
    ds_read_b64_tr_b16 a[224:225], v50 offset:18432
    ds_read_b64_tr_b16 a[226:227], v50 offset:18944
    v_mfma_f32_16x16x32_bf16 a[60:63], a[236:239], a[204:207], a[60:63]
    ds_read_b64_tr_b16 a[228:229], v51 offset:18432
    ds_read_b64_tr_b16 a[230:231], v51 offset:18944
    v_mfma_f32_16x16x32_bf16 a[56:59], a[236:239], a[200:203], a[56:59]
    v_mfma_f32_16x16x32_bf16 a[40:43], a[232:235], a[200:203], a[40:43]
    buffer_load_dwordx4 a[180:183], v32, s[72:75], s85 offen offset:1024 sc1
    v_mfma_f32_16x16x32_bf16 a[36:39], a[232:235], a[196:199], a[36:39]
    buffer_load_dwordx4 v38, s[64:67], s95 offen offset:0 lds
    v_mfma_f32_16x16x32_bf16 a[52:55], a[236:239], a[196:199], a[52:55]
    v_mfma_f32_16x16x32_bf16 a[48:51], a[236:239], a[192:195], a[48:51]
    v_mfma_f32_16x16x32_bf16 a[32:35], a[232:235], a[192:195], a[32:35]
    v_mfma_f32_16x16x32_bf16 a[64:67], a[240:243], a[192:195], a[64:67]
    s_waitcnt lgkmcnt(0)
    ds_read_b64_tr_b16 a[232:233], v48 offset:16384
    ds_read_b64_tr_b16 a[234:235], v48 offset:16896
    v_mfma_f32_16x16x32_bf16 a[80:83], a[244:247], a[192:195], a[80:83]
    ds_read_b64_tr_b16 a[236:237], v49 offset:16384
    ds_read_b64_tr_b16 a[238:239], v49 offset:16896
    v_mfma_f32_16x16x32_bf16 a[84:87], a[244:247], a[196:199], a[84:87]
    v_mfma_f32_16x16x32_bf16 a[68:71], a[240:243], a[196:199], a[68:71]
    buffer_load_dwordx4 a[184:187], v32, s[72:75], s86 offen offset:1024 sc1
    v_mfma_f32_16x16x32_bf16 a[72:75], a[240:243], a[200:203], a[72:75]
    buffer_load_dwordx4 v39, s[64:67], s95 offen offset:1024 lds
    v_mfma_f32_16x16x32_bf16 a[88:91], a[244:247], a[200:203], a[88:91]
    v_mfma_f32_16x16x32_bf16 a[92:95], a[244:247], a[204:207], a[92:95]
    v_mfma_f32_16x16x32_bf16 a[76:79], a[240:243], a[204:207], a[76:79]
    v_mfma_f32_16x16x32_bf16 a[108:111], a[248:251], a[204:207], a[108:111]
    ds_read_b64_tr_b16 a[240:241], v48 offset:18432
    ds_read_b64_tr_b16 a[242:243], v48 offset:18944
    v_mfma_f32_16x16x32_bf16 a[124:127], a[252:255], a[204:207], a[124:127]
    ds_read_b64_tr_b16 a[244:245], v49 offset:18432
    ds_read_b64_tr_b16 a[246:247], v49 offset:18944
    v_mfma_f32_16x16x32_bf16 a[120:123], a[252:255], a[200:203], a[120:123]
    v_mfma_f32_16x16x32_bf16 a[104:107], a[248:251], a[200:203], a[104:107]
    buffer_load_dwordx4 a[188:191], v32, s[72:75], s87 offen offset:1024 sc1
    v_mfma_f32_16x16x32_bf16 a[100:103], a[248:251], a[196:199], a[100:103]
    buffer_load_dwordx4 v38, s[68:71], s95 offen offset:2048 lds
    v_mfma_f32_16x16x32_bf16 a[116:119], a[252:255], a[196:199], a[116:119]
    v_mfma_f32_16x16x32_bf16 a[112:115], a[252:255], a[192:195], a[112:115]
    v_mfma_f32_16x16x32_bf16 a[96:99], a[248:251], a[192:195], a[96:99]
    v_mfma_f32_16x16x32_bf16 a[128:131], a[224:227], a[192:195], a[128:131]
    ds_read_b64_tr_b16 a[248:249], v50 offset:16384
    ds_read_b64_tr_b16 a[250:251], v50 offset:16896
    v_mfma_f32_16x16x32_bf16 a[144:147], a[228:231], a[192:195], a[144:147]
    ds_read_b64_tr_b16 a[252:253], v51 offset:16384
    ds_read_b64_tr_b16 a[254:255], v51 offset:16896
    v_mfma_f32_16x16x32_bf16 a[148:151], a[228:231], a[196:199], a[148:151]
    v_mfma_f32_16x16x32_bf16 a[132:135], a[224:227], a[196:199], a[132:135]
    v_mfma_f32_16x16x32_bf16 a[136:139], a[224:227], a[200:203], a[136:139]
    buffer_load_dwordx4 v39, s[68:71], s95 offen offset:3072 lds
    v_mfma_f32_16x16x32_bf16 a[152:155], a[228:231], a[200:203], a[152:155]
    v_mfma_f32_16x16x32_bf16 a[156:159], a[228:231], a[204:207], a[156:159]
    v_mfma_f32_16x16x32_bf16 a[140:143], a[224:227], a[204:207], a[140:143]
    s_waitcnt lgkmcnt(2)
    v_mfma_f32_16x16x32_bf16 v[172:175], a[232:235], a[204:207], v[172:175]
    ds_read_b64_tr_b16 a[224:225], v40 offset:8192
    ds_read_b64_tr_b16 a[226:227], v40 offset:9216
    v_mfma_f32_16x16x32_bf16 v[188:191], a[236:239], a[204:207], v[188:191]
    ds_read_b64_tr_b16 a[228:229], v41 offset:8192
    ds_read_b64_tr_b16 a[230:231], v41 offset:9216
    v_mfma_f32_16x16x32_bf16 v[184:187], a[236:239], a[200:203], v[184:187]
    v_mfma_f32_16x16x32_bf16 v[168:171], a[232:235], a[200:203], v[168:171]
    v_mfma_f32_16x16x32_bf16 v[164:167], a[232:235], a[196:199], v[164:167]
    v_mfma_f32_16x16x32_bf16 v[180:183], a[236:239], a[196:199], v[180:183]
    v_mfma_f32_16x16x32_bf16 v[176:179], a[236:239], a[192:195], v[176:179]
    v_mfma_f32_16x16x32_bf16 v[160:163], a[232:235], a[192:195], v[160:163]
    v_mfma_f32_16x16x32_bf16 v[192:195], a[240:243], a[192:195], v[192:195]
    ds_read_b64_tr_b16 a[232:233], v42 offset:8192
    ds_read_b64_tr_b16 a[234:235], v42 offset:9216
    v_mfma_f32_16x16x32_bf16 v[208:211], a[244:247], a[192:195], v[208:211]
    ds_read_b64_tr_b16 a[236:237], v43 offset:8192
    ds_read_b64_tr_b16 a[238:239], v43 offset:9216
    v_mfma_f32_16x16x32_bf16 v[212:215], a[244:247], a[196:199], v[212:215]
    v_mfma_f32_16x16x32_bf16 v[196:199], a[240:243], a[196:199], v[196:199]
    v_mfma_f32_16x16x32_bf16 v[200:203], a[240:243], a[200:203], v[200:203]
    v_mfma_f32_16x16x32_bf16 v[216:219], a[244:247], a[200:203], v[216:219]
    v_mfma_f32_16x16x32_bf16 v[220:223], a[244:247], a[204:207], v[220:223]
    v_mfma_f32_16x16x32_bf16 v[204:207], a[240:243], a[204:207], v[204:207]
    v_mfma_f32_16x16x32_bf16 v[236:239], a[248:251], a[204:207], v[236:239]
    s_waitcnt lgkmcnt(0)
    ds_read_b64_tr_b16 a[240:241], v44 offset:8192
    ds_read_b64_tr_b16 a[242:243], v44 offset:9216
    v_mfma_f32_16x16x32_bf16 v[252:255], a[252:255], a[204:207], v[252:255]
    ds_read_b64_tr_b16 a[244:245], v45 offset:8192
    ds_read_b64_tr_b16 a[246:247], v45 offset:9216
    v_mfma_f32_16x16x32_bf16 v[248:251], a[252:255], a[200:203], v[248:251]
    v_mfma_f32_16x16x32_bf16 v[232:235], a[248:251], a[200:203], v[232:235]
    v_mfma_f32_16x16x32_bf16 v[228:231], a[248:251], a[196:199], v[228:231]
    v_mfma_f32_16x16x32_bf16 v[244:247], a[252:255], a[196:199], v[244:247]
    v_mfma_f32_16x16x32_bf16 v[240:243], a[252:255], a[192:195], v[240:243]
    v_mfma_f32_16x16x32_bf16 v[224:227], a[248:251], a[192:195], v[224:227]
    s_waitcnt vmcnt(24)
    v_mfma_f32_16x16x32_bf16 a[0:3], a[224:227], a[208:211], a[0:3]
    ds_read_b64_tr_b16 a[248:249], v46 offset:8192
    ds_read_b64_tr_b16 a[250:251], v46 offset:9216
    v_mfma_f32_16x16x32_bf16 a[16:19], a[228:231], a[208:211], a[16:19]
    s_waitcnt vmcnt(22)
    ds_read_b64_tr_b16 a[252:253], v47 offset:8192
    ds_read_b64_tr_b16 a[254:255], v47 offset:9216
    v_mfma_f32_16x16x32_bf16 a[20:23], a[228:231], a[212:215], a[20:23]
    v_mfma_f32_16x16x32_bf16 a[4:7], a[224:227], a[212:215], a[4:7]
    s_waitcnt vmcnt(20)
    buffer_load_dwordx4 a[192:195], v32, s[72:75], s84 offen offset:2048 sc1
    v_mfma_f32_16x16x32_bf16 a[8:11], a[224:227], a[216:219], a[8:11]
    v_mfma_f32_16x16x32_bf16 a[24:27], a[228:231], a[216:219], a[24:27]
    s_waitcnt vmcnt(19)
    v_mfma_f32_16x16x32_bf16 a[28:31], a[228:231], a[220:223], a[28:31]
    v_mfma_f32_16x16x32_bf16 a[12:15], a[224:227], a[220:223], a[12:15]
    v_mfma_f32_16x16x32_bf16 a[44:47], a[232:235], a[220:223], a[44:47]
    ds_read_b64_tr_b16 a[224:225], v50 offset:26624
    ds_read_b64_tr_b16 a[226:227], v50 offset:27136
    v_mfma_f32_16x16x32_bf16 a[60:63], a[236:239], a[220:223], a[60:63]
    ds_read_b64_tr_b16 a[228:229], v51 offset:26624
    ds_read_b64_tr_b16 a[230:231], v51 offset:27136
    v_mfma_f32_16x16x32_bf16 a[56:59], a[236:239], a[216:219], a[56:59]
    v_mfma_f32_16x16x32_bf16 a[40:43], a[232:235], a[216:219], a[40:43]
    buffer_load_dwordx4 a[196:199], v32, s[72:75], s85 offen offset:2048 sc1
    v_mfma_f32_16x16x32_bf16 a[36:39], a[232:235], a[212:215], a[36:39]
    v_mfma_f32_16x16x32_bf16 a[52:55], a[236:239], a[212:215], a[52:55]
    v_mfma_f32_16x16x32_bf16 a[48:51], a[236:239], a[208:211], a[48:51]
    v_mfma_f32_16x16x32_bf16 a[32:35], a[232:235], a[208:211], a[32:35]
    s_waitcnt lgkmcnt(2)
    v_mfma_f32_16x16x32_bf16 a[64:67], a[240:243], a[208:211], a[64:67]
    ds_read_b64_tr_b16 a[232:233], v48 offset:24576
    ds_read_b64_tr_b16 a[234:235], v48 offset:25088
    v_mfma_f32_16x16x32_bf16 a[80:83], a[244:247], a[208:211], a[80:83]
    ds_read_b64_tr_b16 a[236:237], v49 offset:24576
    ds_read_b64_tr_b16 a[238:239], v49 offset:25088
    v_mfma_f32_16x16x32_bf16 a[84:87], a[244:247], a[212:215], a[84:87]
    v_mfma_f32_16x16x32_bf16 a[68:71], a[240:243], a[212:215], a[68:71]
    buffer_load_dwordx4 a[200:203], v32, s[72:75], s86 offen offset:2048 sc1
    v_mfma_f32_16x16x32_bf16 a[72:75], a[240:243], a[216:219], a[72:75]
    v_mfma_f32_16x16x32_bf16 a[88:91], a[244:247], a[216:219], a[88:91]
    v_mfma_f32_16x16x32_bf16 a[92:95], a[244:247], a[220:223], a[92:95]
    v_mfma_f32_16x16x32_bf16 a[76:79], a[240:243], a[220:223], a[76:79]
    v_mfma_f32_16x16x32_bf16 a[108:111], a[248:251], a[220:223], a[108:111]
    ds_read_b64_tr_b16 a[240:241], v48 offset:26624
    ds_read_b64_tr_b16 a[242:243], v48 offset:27136
    v_mfma_f32_16x16x32_bf16 a[124:127], a[252:255], a[220:223], a[124:127]
    ds_read_b64_tr_b16 a[244:245], v49 offset:26624
    ds_read_b64_tr_b16 a[246:247], v49 offset:27136
    v_mfma_f32_16x16x32_bf16 a[120:123], a[252:255], a[216:219], a[120:123]
    v_mfma_f32_16x16x32_bf16 a[104:107], a[248:251], a[216:219], a[104:107]
    buffer_load_dwordx4 a[204:207], v32, s[72:75], s87 offen offset:2048 sc1
    v_mfma_f32_16x16x32_bf16 a[100:103], a[248:251], a[212:215], a[100:103]
    v_mfma_f32_16x16x32_bf16 a[116:119], a[252:255], a[212:215], a[116:119]
    v_mfma_f32_16x16x32_bf16 a[112:115], a[252:255], a[208:211], a[112:115]
    v_mfma_f32_16x16x32_bf16 a[96:99], a[248:251], a[208:211], a[96:99]
    v_mfma_f32_16x16x32_bf16 a[128:131], a[224:227], a[208:211], a[128:131]
    s_waitcnt lgkmcnt(0)
    ds_read_b64_tr_b16 a[248:249], v50 offset:24576
    ds_read_b64_tr_b16 a[250:251], v50 offset:25088
    v_mfma_f32_16x16x32_bf16 a[144:147], a[228:231], a[208:211], a[144:147]
    ds_read_b64_tr_b16 a[252:253], v51 offset:24576
    ds_read_b64_tr_b16 a[254:255], v51 offset:25088
    v_mfma_f32_16x16x32_bf16 a[148:151], a[228:231], a[212:215], a[148:151]
    v_mfma_f32_16x16x32_bf16 a[132:135], a[224:227], a[212:215], a[132:135]
    v_mfma_f32_16x16x32_bf16 a[136:139], a[224:227], a[216:219], a[136:139]
    v_mfma_f32_16x16x32_bf16 a[152:155], a[228:231], a[216:219], a[152:155]
    v_mfma_f32_16x16x32_bf16 a[156:159], a[228:231], a[220:223], a[156:159]
    v_mfma_f32_16x16x32_bf16 a[140:143], a[224:227], a[220:223], a[140:143]
    s_waitcnt vmcnt(20) lgkmcnt(0)
    v_mfma_f32_16x16x32_bf16 v[172:175], a[232:235], a[220:223], v[172:175]
    s_barrier
    ds_read_b64_tr_b16 a[224:225], v40 offset:32768
    ds_read_b64_tr_b16 a[226:227], v40 offset:33792
    v_mfma_f32_16x16x32_bf16 v[188:191], a[236:239], a[220:223], v[188:191]
    ds_read_b64_tr_b16 a[228:229], v41 offset:32768
    ds_read_b64_tr_b16 a[230:231], v41 offset:33792
    v_mfma_f32_16x16x32_bf16 v[184:187], a[236:239], a[216:219], v[184:187]
    v_mov_b32 v5, 2
    v_mfma_f32_16x16x32_bf16 v[168:171], a[232:235], a[216:219], v[168:171]
    buffer_store_dword v5, v0, s[76:79], 0 offen sc1
    v_mfma_f32_16x16x32_bf16 v[164:167], a[232:235], a[212:215], v[164:167]
    v_mfma_f32_16x16x32_bf16 v[180:183], a[236:239], a[212:215], v[180:183]
    v_mfma_f32_16x16x32_bf16 v[176:179], a[236:239], a[208:211], v[176:179]
    v_mfma_f32_16x16x32_bf16 v[160:163], a[232:235], a[208:211], v[160:163]
    v_mfma_f32_16x16x32_bf16 v[192:195], a[240:243], a[208:211], v[192:195]
    ds_read_b64_tr_b16 a[232:233], v42 offset:32768
    ds_read_b64_tr_b16 a[234:235], v42 offset:33792
    v_mfma_f32_16x16x32_bf16 v[208:211], a[244:247], a[208:211], v[208:211]
    ds_read_b64_tr_b16 a[236:237], v43 offset:32768
    ds_read_b64_tr_b16 a[238:239], v43 offset:33792
    v_mfma_f32_16x16x32_bf16 v[212:215], a[244:247], a[212:215], v[212:215]
    v_mfma_f32_16x16x32_bf16 v[196:199], a[240:243], a[212:215], v[196:199]
    v_mfma_f32_16x16x32_bf16 v[200:203], a[240:243], a[216:219], v[200:203]
    v_mfma_f32_16x16x32_bf16 v[216:219], a[244:247], a[216:219], v[216:219]
    v_mfma_f32_16x16x32_bf16 v[220:223], a[244:247], a[220:223], v[220:223]
    v_mfma_f32_16x16x32_bf16 v[204:207], a[240:243], a[220:223], v[204:207]
    v_mfma_f32_16x16x32_bf16 v[236:239], a[248:251], a[220:223], v[236:239]
    ds_read_b64_tr_b16 a[240:241], v44 offset:32768
    ds_read_b64_tr_b16 a[242:243], v44 offset:33792
    v_mfma_f32_16x16x32_bf16 v[252:255], a[252:255], a[220:223], v[252:255]
    ds_read_b64_tr_b16 a[244:245], v45 offset:32768
    ds_read_b64_tr_b16 a[246:247], v45 offset:33792
    v_mfma_f32_16x16x32_bf16 v[248:251], a[252:255], a[216:219], v[248:251]
    v_mfma_f32_16x16x32_bf16 v[232:235], a[248:251], a[216:219], v[232:235]
    v_mfma_f32_16x16x32_bf16 v[228:231], a[248:251], a[212:215], v[228:231]
    v_mfma_f32_16x16x32_bf16 v[244:247], a[252:255], a[212:215], v[244:247]
    v_mfma_f32_16x16x32_bf16 v[240:243], a[252:255], a[208:211], v[240:243]
    v_mfma_f32_16x16x32_bf16 v[224:227], a[248:251], a[208:211], v[224:227]
    s_waitcnt lgkmcnt(2) vmcnt(20)
    v_mfma_f32_16x16x32_bf16 a[0:3], a[224:227], a[160:163], a[0:3]
    ds_read_b64_tr_b16 a[248:249], v46 offset:32768
    ds_read_b64_tr_b16 a[250:251], v46 offset:33792
    v_mfma_f32_16x16x32_bf16 a[16:19], a[228:231], a[160:163], a[16:19]
    s_waitcnt vmcnt(19)
    ds_read_b64_tr_b16 a[252:253], v47 offset:32768
    ds_read_b64_tr_b16 a[254:255], v47 offset:33792
    v_mfma_f32_16x16x32_bf16 a[20:23], a[228:231], a[164:167], a[20:23]
    v_mfma_f32_16x16x32_bf16 a[4:7], a[224:227], a[164:167], a[4:7]
    s_waitcnt vmcnt(18)
    buffer_load_dwordx4 a[208:211], v32, s[72:75], s84 offen offset:3072 sc1
    v_mfma_f32_16x16x32_bf16 a[8:11], a[224:227], a[168:171], a[8:11]
    v_mfma_f32_16x16x32_bf16 a[24:27], a[228:231], a[168:171], a[24:27]
    s_waitcnt vmcnt(18)
    v_mfma_f32_16x16x32_bf16 a[28:31], a[228:231], a[172:175], a[28:31]
    v_mfma_f32_16x16x32_bf16 a[12:15], a[224:227], a[172:175], a[12:15]
    v_mfma_f32_16x16x32_bf16 a[44:47], a[232:235], a[172:175], a[44:47]
    ds_read_b64_tr_b16 a[224:225], v50 offset:51200
    ds_read_b64_tr_b16 a[226:227], v50 offset:51712
    v_mfma_f32_16x16x32_bf16 a[60:63], a[236:239], a[172:175], a[60:63]
    ds_read_b64_tr_b16 a[228:229], v51 offset:51200
    ds_read_b64_tr_b16 a[230:231], v51 offset:51712
    v_mfma_f32_16x16x32_bf16 a[56:59], a[236:239], a[168:171], a[56:59]
    v_mfma_f32_16x16x32_bf16 a[40:43], a[232:235], a[168:171], a[40:43]
    buffer_load_dwordx4 a[212:215], v32, s[72:75], s85 offen offset:3072 sc1
    v_mfma_f32_16x16x32_bf16 a[36:39], a[232:235], a[164:167], a[36:39]
    v_mfma_f32_16x16x32_bf16 a[52:55], a[236:239], a[164:167], a[52:55]
    v_mfma_f32_16x16x32_bf16 a[48:51], a[236:239], a[160:163], a[48:51]
    v_mfma_f32_16x16x32_bf16 a[32:35], a[232:235], a[160:163], a[32:35]
    v_mfma_f32_16x16x32_bf16 a[64:67], a[240:243], a[160:163], a[64:67]
    s_waitcnt lgkmcnt(0)
    ds_read_b64_tr_b16 a[232:233], v48 offset:49152
    ds_read_b64_tr_b16 a[234:235], v48 offset:49664
    v_mfma_f32_16x16x32_bf16 a[80:83], a[244:247], a[160:163], a[80:83]
    ds_read_b64_tr_b16 a[236:237], v49 offset:49152
    ds_read_b64_tr_b16 a[238:239], v49 offset:49664
    v_mfma_f32_16x16x32_bf16 a[84:87], a[244:247], a[164:167], a[84:87]
    v_mfma_f32_16x16x32_bf16 a[68:71], a[240:243], a[164:167], a[68:71]
    buffer_load_dwordx4 a[216:219], v32, s[72:75], s86 offen offset:3072 sc1
    v_mfma_f32_16x16x32_bf16 a[72:75], a[240:243], a[168:171], a[72:75]
    v_mfma_f32_16x16x32_bf16 a[88:91], a[244:247], a[168:171], a[88:91]
    v_mfma_f32_16x16x32_bf16 a[92:95], a[244:247], a[172:175], a[92:95]
    v_mfma_f32_16x16x32_bf16 a[76:79], a[240:243], a[172:175], a[76:79]
    v_mfma_f32_16x16x32_bf16 a[108:111], a[248:251], a[172:175], a[108:111]
    ds_read_b64_tr_b16 a[240:241], v48 offset:51200
    ds_read_b64_tr_b16 a[242:243], v48 offset:51712
    v_mfma_f32_16x16x32_bf16 a[124:127], a[252:255], a[172:175], a[124:127]
    ds_read_b64_tr_b16 a[244:245], v49 offset:51200
    ds_read_b64_tr_b16 a[246:247], v49 offset:51712
    v_mfma_f32_16x16x32_bf16 a[120:123], a[252:255], a[168:171], a[120:123]
    v_mfma_f32_16x16x32_bf16 a[104:107], a[248:251], a[168:171], a[104:107]
    buffer_load_dwordx4 a[220:223], v32, s[72:75], s87 offen offset:3072 sc1
    v_mfma_f32_16x16x32_bf16 a[100:103], a[248:251], a[164:167], a[100:103]
    v_mfma_f32_16x16x32_bf16 a[116:119], a[252:255], a[164:167], a[116:119]
    v_mfma_f32_16x16x32_bf16 a[112:115], a[252:255], a[160:163], a[112:115]
    v_mfma_f32_16x16x32_bf16 a[96:99], a[248:251], a[160:163], a[96:99]
    v_mfma_f32_16x16x32_bf16 a[128:131], a[224:227], a[160:163], a[128:131]
    ds_read_b64_tr_b16 a[248:249], v50 offset:49152
    ds_read_b64_tr_b16 a[250:251], v50 offset:49664
    v_mfma_f32_16x16x32_bf16 a[144:147], a[228:231], a[160:163], a[144:147]
    ds_read_b64_tr_b16 a[252:253], v51 offset:49152
    ds_read_b64_tr_b16 a[254:255], v51 offset:49664
    v_mfma_f32_16x16x32_bf16 a[148:151], a[228:231], a[164:167], a[148:151]
    v_mfma_f32_16x16x32_bf16 a[132:135], a[224:227], a[164:167], a[132:135]
    v_mfma_f32_16x16x32_bf16 a[136:139], a[224:227], a[168:171], a[136:139]
    v_mfma_f32_16x16x32_bf16 a[152:155], a[228:231], a[168:171], a[152:155]
    s_and_b32 s67, s31, 7
    s_bitcmp1_b32 s32, 1
    v_mfma_f32_16x16x32_bf16 a[156:159], a[228:231], a[172:175], a[156:159]
    s_cselect_b32 s33, 9, 4
    s_add_u32 s33, s33, s67
    v_mfma_f32_16x16x32_bf16 a[140:143], a[224:227], a[172:175], a[140:143]
    s_waitcnt lgkmcnt(2)
    v_mfma_f32_16x16x32_bf16 v[172:175], a[232:235], a[172:175], v[172:175]
    ds_read_b64_tr_b16 a[224:225], v40 offset:40960
    ds_read_b64_tr_b16 a[226:227], v40 offset:41984
    v_mfma_f32_16x16x32_bf16 v[188:191], a[236:239], a[172:175], v[188:191]
    ds_read_b64_tr_b16 a[228:229], v41 offset:40960
    ds_read_b64_tr_b16 a[230:231], v41 offset:41984
    v_mfma_f32_16x16x32_bf16 v[184:187], a[236:239], a[168:171], v[184:187]
    s_and_b32 s34, s33, 3
    s_lshl_b32 s34, s34, 6
    v_mfma_f32_16x16x32_bf16 v[168:171], a[232:235], a[168:171], v[168:171]
    s_and_b32 s33, s33, 12
    s_lshl1_add_u32 s33, s33, s34
    v_mfma_f32_16x16x32_bf16 v[164:167], a[232:235], a[164:167], v[164:167]
    s_and_b32 s34, s2, 32
    s_add_u32 s33, s33, s34
    v_mfma_f32_16x16x32_bf16 v[180:183], a[236:239], a[164:167], v[180:183]
    s_lshr_b32 s34, s32, 2
    s_lshl1_add_u32 s33, s34, s33
    v_mfma_f32_16x16x32_bf16 v[176:179], a[236:239], a[160:163], v[176:179]
    s_add_u32 s0, s33, 1
    s_add_u32 s1, s33, 5
    v_mfma_f32_16x16x32_bf16 v[160:163], a[232:235], a[160:163], v[160:163]
    v_mfma_f32_16x16x32_bf16 v[192:195], a[240:243], a[160:163], v[192:195]
    ds_read_b64_tr_b16 a[232:233], v42 offset:40960
    ds_read_b64_tr_b16 a[234:235], v42 offset:41984
    v_mfma_f32_16x16x32_bf16 v[208:211], a[244:247], a[160:163], v[208:211]
    ds_read_b64_tr_b16 a[236:237], v43 offset:40960
    ds_read_b64_tr_b16 a[238:239], v43 offset:41984
    v_mfma_f32_16x16x32_bf16 v[212:215], a[244:247], a[164:167], v[212:215]
    s_lshr_b32 s33, s32, 1
    s_lshl2_add_u32 s72, s67, s33
    v_mfma_f32_16x16x32_bf16 v[196:199], a[240:243], a[164:167], v[196:199]
    s_cmp_ge_u32 s72, 25
    s_cselect_b32 s33, 25, 20
    v_mfma_f32_16x16x32_bf16 v[200:203], a[240:243], a[168:171], v[200:203]
    s_cselect_b32 s34, 2, 0
    s_cselect_b32 s35, 16, 0
    v_mfma_f32_16x16x32_bf16 v[216:219], a[244:247], a[168:171], v[216:219]
    s_sub_u32 s68, s72, s33
    s_bfe_u32 s33, s31, 0x10003
    v_mfma_f32_16x16x32_bf16 v[220:223], a[244:247], a[172:175], v[220:223]
    s_lshl2_add_u32 s34, s33, s34
    s_and_b32 s33, s32, 1
    v_mfma_f32_16x16x32_bf16 v[204:207], a[240:243], a[172:175], v[204:207]
    v_mfma_f32_16x16x32_bf16 v[236:239], a[248:251], a[172:175], v[236:239]
    s_waitcnt lgkmcnt(0)
    ds_read_b64_tr_b16 a[240:241], v44 offset:40960
    ds_read_b64_tr_b16 a[242:243], v44 offset:41984
    v_mfma_f32_16x16x32_bf16 v[252:255], a[252:255], a[172:175], v[252:255]
    ds_read_b64_tr_b16 a[244:245], v45 offset:40960
    ds_read_b64_tr_b16 a[246:247], v45 offset:41984
    v_mfma_f32_16x16x32_bf16 v[248:251], a[252:255], a[168:171], v[248:251]
    s_add_u32 s69, s33, s34
    s_mul_i32 s33, s68, 11
    v_mfma_f32_16x16x32_bf16 v[232:235], a[248:251], a[168:171], v[232:235]
    s_lshr_b32 s33, s33, 3
    s_lshl2_add_u32 s33, s33, s35
    v_mfma_f32_16x16x32_bf16 v[228:231], a[248:251], a[164:167], v[228:231]
    s_mov_b32 s74, 0x6543210
    s_mov_b32 s75, 0x10654321
    v_mfma_f32_16x16x32_bf16 v[244:247], a[252:255], a[164:167], v[244:247]
    s_lshr_b64 s[74:75], s[74:75], s33
    s_cmp_ge_u32 s72, 30
    v_mfma_f32_16x16x32_bf16 v[240:243], a[252:255], a[160:163], v[240:243]
    s_cselect_b32 s41, 3, 1
    s_bitcmp1_b32 s31, 4
    v_mfma_f32_16x16x32_bf16 v[224:227], a[248:251], a[160:163], v[224:227]
    s_waitcnt vmcnt(17)
    v_mfma_f32_16x16x32_bf16 a[0:3], a[224:227], a[176:179], a[0:3]
    ds_read_b64_tr_b16 a[248:249], v46 offset:40960
    ds_read_b64_tr_b16 a[250:251], v46 offset:41984
    v_mfma_f32_16x16x32_bf16 a[16:19], a[228:231], a[176:179], a[16:19]
    s_waitcnt vmcnt(15)
    ds_read_b64_tr_b16 a[252:253], v47 offset:40960
    ds_read_b64_tr_b16 a[254:255], v47 offset:41984
    v_mfma_f32_16x16x32_bf16 a[20:23], a[228:231], a[180:183], a[20:23]
    s_cselect_b32 s72, 7, 0
    s_add_u32 s73, s72, 32
    v_mfma_f32_16x16x32_bf16 a[4:7], a[224:227], a[180:183], a[4:7]
    s_mov_b32 s34, 0x76543210
    s_bitcmp1_b32 s32, 1
    s_waitcnt vmcnt(13)
    v_mfma_f32_16x16x32_bf16 a[8:11], a[224:227], a[184:187], a[8:11]
    s_cmov_b32 s34, 0x32147650
    s_mul_i32 s33, s67, 0x11111111
    v_mfma_f32_16x16x32_bf16 a[24:27], a[228:231], a[184:187], a[24:27]
    s_xor_b32 s33, s33, s34
    s_and_b32 s34, s31, 24
    s_waitcnt vmcnt(11)
    v_mfma_f32_16x16x32_bf16 a[28:31], a[228:231], a[188:191], a[28:31]
    s_cmp_lt_u32 s67, 5
    s_cselect_b32 s41, 0, s41
    v_mfma_f32_16x16x32_bf16 a[12:15], a[224:227], a[188:191], a[12:15]
    v_mfma_f32_16x16x32_bf16 a[44:47], a[232:235], a[188:191], a[44:47]
    ds_read_b64_tr_b16 a[224:225], v50 offset:59392
    ds_read_b64_tr_b16 a[226:227], v50 offset:59904
    v_mfma_f32_16x16x32_bf16 a[60:63], a[236:239], a[188:191], a[60:63]
    ds_read_b64_tr_b16 a[228:229], v51 offset:59392
    ds_read_b64_tr_b16 a[230:231], v51 offset:59904
    v_mfma_f32_16x16x32_bf16 a[56:59], a[236:239], a[184:187], a[56:59]
    s_cselect_b32 s68, s67, s68
    s_cselect_b32 s69, s32, s69
    v_mfma_f32_16x16x32_bf16 a[40:43], a[232:235], a[184:187], a[40:43]
    s_cselect_b32 s40, s33, s74
    s_cselect_b32 s72, s34, s72
    v_mfma_f32_16x16x32_bf16 a[36:39], a[232:235], a[180:183], a[36:39]
    s_cselect_b32 s73, s34, s73
    s_cselect_b32 s67, s31, 0
    v_mfma_f32_16x16x32_bf16 a[52:55], a[236:239], a[180:183], a[52:55]
    s_cselect_b32 s8, s8, s16
    s_cselect_b32 s9, s9, s17
    v_mfma_f32_16x16x32_bf16 a[48:51], a[236:239], a[176:179], a[48:51]
    s_cselect_b32 s10, s10, s18
    s_lshl2_add_u32 s72, s72, s30
    v_mfma_f32_16x16x32_bf16 a[32:35], a[232:235], a[176:179], a[32:35]
    s_waitcnt lgkmcnt(2)
    v_mfma_f32_16x16x32_bf16 a[64:67], a[240:243], a[176:179], a[64:67]
    ds_read_b64_tr_b16 a[232:233], v48 offset:57344
    ds_read_b64_tr_b16 a[234:235], v48 offset:57856
    v_mfma_f32_16x16x32_bf16 a[80:83], a[244:247], a[176:179], a[80:83]
    ds_read_b64_tr_b16 a[236:237], v49 offset:57344
    ds_read_b64_tr_b16 a[238:239], v49 offset:57856
    v_mfma_f32_16x16x32_bf16 a[84:87], a[244:247], a[180:183], a[84:87]
    s_mul_i32 s72, s72, 160
    s_add_u32 s72, s72, s68
    v_mfma_f32_16x16x32_bf16 a[68:71], a[240:243], a[180:183], a[68:71]
    s_lshl_b32 s72, s72, 8
    s_sub_u32 s10, s10, s72
    v_mfma_f32_16x16x32_bf16 a[72:75], a[240:243], a[184:187], a[72:75]
    s_add_u32 s8, s8, s72
    s_addc_u32 s9, s9, 0
    v_mfma_f32_16x16x32_bf16 a[88:91], a[244:247], a[184:187], a[88:91]
    s_cmp_eq_u32 s41, 3
    s_cselect_b32 s10, 0, s10
    v_mfma_f32_16x16x32_bf16 a[92:95], a[244:247], a[188:191], a[92:95]
    s_and_b32 s42, s40, 15
    s_lshl_b32 s42, s42, 12
    v_mfma_f32_16x16x32_bf16 a[76:79], a[240:243], a[188:191], a[76:79]
    v_mfma_f32_16x16x32_bf16 a[108:111], a[248:251], a[188:191], a[108:111]
    ds_read_b64_tr_b16 a[240:241], v48 offset:59392
    ds_read_b64_tr_b16 a[242:243], v48 offset:59904
    v_mfma_f32_16x16x32_bf16 a[124:127], a[252:255], a[188:191], a[124:127]
    ds_read_b64_tr_b16 a[244:245], v49 offset:59392
    ds_read_b64_tr_b16 a[246:247], v49 offset:59904
    v_mfma_f32_16x16x32_bf16 a[120:123], a[252:255], a[184:187], a[120:123]
    s_cmp_eq_u32 s41, 1
    s_cselect_b32 s42, s42, 0x40000000
    v_mfma_f32_16x16x32_bf16 a[104:107], a[248:251], a[184:187], a[104:107]
    s_lshl_b32 s33, s69, 5
    v_and_b32 v33, 31, v1
    v_mfma_f32_16x16x32_bf16 a[100:103], a[248:251], a[180:183], a[100:103]
    v_add_lshl_u32 v33, v33, s33, 7
    v_mfma_f32_16x16x32_bf16 a[116:119], a[252:255], a[180:183], a[116:119]
    s_sub_u32 s33, s69, s32
    s_mul_i32 s33, s33, 1507328
    v_mfma_f32_16x16x32_bf16 a[112:115], a[252:255], a[176:179], a[112:115]
    s_lshl_b32 s73, s73, 12
    s_sub_u32 s34, s73, s33
    v_mfma_f32_16x16x32_bf16 a[96:99], a[248:251], a[176:179], a[96:99]
    v_mfma_f32_16x16x32_bf16 a[128:131], a[224:227], a[176:179], a[128:131]
    s_waitcnt lgkmcnt(0)
    ds_read_b64_tr_b16 a[248:249], v50 offset:57344
    ds_read_b64_tr_b16 a[250:251], v50 offset:57856
    v_mfma_f32_16x16x32_bf16 a[144:147], a[228:231], a[176:179], a[144:147]
    ds_read_b64_tr_b16 a[252:253], v51 offset:57344
    ds_read_b64_tr_b16 a[254:255], v51 offset:57856
    v_mfma_f32_16x16x32_bf16 a[148:151], a[228:231], a[180:183], a[148:151]
    s_add_u32 s33, s73, s33
    s_mov_b32 s35, s67
    v_mfma_f32_16x16x32_bf16 a[132:135], a[224:227], a[180:183], a[132:135]
    s_add_u32 s72, s56, s33
    s_add_u32 s73, s57, s33
    v_mfma_f32_16x16x32_bf16 a[136:139], a[224:227], a[184:187], a[136:139]
    s_add_u32 s74, s58, s34
    s_add_u32 s75, s59, s34
    v_mfma_f32_16x16x32_bf16 a[152:155], a[228:231], a[184:187], a[152:155]
    s_bitcmp1_b32 s35, 3
    s_cselect_b32 s66, s73, s72
    v_mfma_f32_16x16x32_bf16 a[156:159], a[228:231], a[188:191], a[156:159]
    s_cselect_b32 s67, s72, s73
    s_cselect_b32 s68, s75, s74
    v_mfma_f32_16x16x32_bf16 a[140:143], a[224:227], a[188:191], a[140:143]
    s_waitcnt vmcnt(9) lgkmcnt(0)
    v_mfma_f32_16x16x32_bf16 v[172:175], a[232:235], a[188:191], v[172:175]
    s_barrier
    ds_read_b64_tr_b16 a[224:225], v52 offset:0
    ds_read_b64_tr_b16 a[226:227], v52 offset:1024
    v_mfma_f32_16x16x32_bf16 v[188:191], a[236:239], a[188:191], v[188:191]
    ds_read_b64_tr_b16 a[228:229], v53 offset:0
    ds_read_b64_tr_b16 a[230:231], v53 offset:1024
    v_mfma_f32_16x16x32_bf16 v[184:187], a[236:239], a[184:187], v[184:187]
    s_cselect_b32 s69, s74, s75
    s_bitcmp1_b32 s35, 4
    v_mfma_f32_16x16x32_bf16 v[168:171], a[232:235], a[184:187], v[168:171]
    s_cselect_b32 s72, s68, s66
    s_cselect_b32 s73, s69, s67
    v_mfma_f32_16x16x32_bf16 v[164:167], a[232:235], a[180:183], v[164:167]
    s_cselect_b32 s74, s66, s68
    s_cselect_b32 s75, s67, s69
    v_lshrrev_b32 v29, 4, v1
    v_mfma_f32_16x16x32_bf16 v[180:183], a[236:239], a[180:183], v[180:183]
    v_lshlrev_b32 v28, 5, v29
    v_mfma_f32_16x16x32_bf16 v[176:179], a[236:239], a[176:179], v[176:179]
    v_xor_b32 v28, v28, v2
    v_mfma_f32_16x16x32_bf16 v[160:163], a[232:235], a[176:179], v[160:163]
    v_lshl_add_u32 v28, v29, 10, v28
    v_mfma_f32_16x16x32_bf16 v[192:195], a[240:243], a[176:179], v[192:195]
    ds_read_b64_tr_b16 a[232:233], v54 offset:0
    ds_read_b64_tr_b16 a[234:235], v54 offset:1024
    v_mfma_f32_16x16x32_bf16 v[208:211], a[244:247], a[176:179], v[208:211]
    ds_read_b64_tr_b16 a[236:237], v55 offset:0
    ds_read_b64_tr_b16 a[238:239], v55 offset:1024
    v_mfma_f32_16x16x32_bf16 v[212:215], a[244:247], a[180:183], v[212:215]
    v_xor_b32 v29, 128, v28
    v_mfma_f32_16x16x32_bf16 v[196:199], a[240:243], a[180:183], v[196:199]
    v_add_u32 v29, 4096, v29
    v_mfma_f32_16x16x32_bf16 v[200:203], a[240:243], a[184:187], v[200:203]
    v_add_u32 v30, 8192, v28
    v_mfma_f32_16x16x32_bf16 v[216:219], a[244:247], a[184:187], v[216:219]
    v_add_u32 v31, 8192, v29
    v_mfma_f32_16x16x32_bf16 v[220:223], a[244:247], a[188:191], v[220:223]
    v_lshrrev_b32 v40, 2, v1
    v_mfma_f32_16x16x32_bf16 v[204:207], a[240:243], a[188:191], v[204:207]
    v_and_b32 v41, 31, v1
    v_mfma_f32_16x16x32_bf16 v[236:239], a[248:251], a[188:191], v[236:239]
    ds_read_b64_tr_b16 a[240:241], v56 offset:0
    ds_read_b64_tr_b16 a[242:243], v56 offset:1024
    v_mfma_f32_16x16x32_bf16 v[252:255], a[252:255], a[188:191], v[252:255]
    ds_read_b64_tr_b16 a[244:245], v57 offset:0
    ds_read_b64_tr_b16 a[246:247], v57 offset:1024
    v_mfma_f32_16x16x32_bf16 v[248:251], a[252:255], a[184:187], v[248:251]
    v_lshlrev_b32 v41, 3, v41
    v_mfma_f32_16x16x32_bf16 v[232:235], a[248:251], a[184:187], v[232:235]
    v_lshl_add_u32 v40, v40, 8, v41
    v_mfma_f32_16x16x32_bf16 v[228:231], a[248:251], a[180:183], v[228:231]
    s_and_b32 s33, s32, 1
    s_lshl_b32 s62, s33, 16
    v_add_u32 v41, s62, v40
    v_mfma_f32_16x16x32_bf16 v[244:247], a[252:255], a[180:183], v[244:247]
    v_mov_b32 v44, -1
    v_mfma_f32_16x16x32_bf16 v[240:243], a[252:255], a[176:179], v[240:243]
    v_mov_b32 v45, -1
    v_mfma_f32_16x16x32_bf16 v[224:227], a[248:251], a[176:179], v[224:227]
    s_waitcnt lgkmcnt(2) vmcnt(8)
    v_mov_b32 v46, -1
    v_mfma_f32_16x16x32_bf16 a[0:3], a[224:227], a[192:195], a[0:3]
    ds_read_b64_tr_b16 a[248:249], v58 offset:0
    ds_read_b64_tr_b16 a[250:251], v58 offset:1024
    v_mfma_f32_16x16x32_bf16 a[16:19], a[228:231], a[192:195], a[16:19]
    s_waitcnt vmcnt(7)
    ds_read_b64_tr_b16 a[252:253], v59 offset:0
    ds_read_b64_tr_b16 a[254:255], v59 offset:1024
    v_mfma_f32_16x16x32_bf16 a[20:23], a[228:231], a[196:199], a[20:23]
    buffer_load_dword v6, v3, s[88:91], 0 offen sc1
    v_mfma_f32_16x16x32_bf16 a[4:7], a[224:227], a[196:199], a[4:7]
    s_waitcnt vmcnt(7)
    v_mov_b32 v47, -1
    v_mfma_f32_16x16x32_bf16 a[8:11], a[224:227], a[200:203], a[8:11]
    s_lshl2_add_u32 s63, s2, s30
    s_mul_i32 s63, s63, 16384
    v_mfma_f32_16x16x32_bf16 a[24:27], a[228:231], a[200:203], a[24:27]
    s_waitcnt vmcnt(6)
    v_mfma_f32_16x16x32_bf16 a[28:31], a[228:231], a[204:207], a[28:31]
    v_mfma_f32_16x16x32_bf16 a[12:15], a[224:227], a[204:207], a[12:15]
    v_mfma_f32_16x16x32_bf16 a[44:47], a[232:235], a[204:207], a[44:47]
    ds_read_b64_tr_b16 a[224:225], v62 offset:18432
    ds_read_b64_tr_b16 a[226:227], v62 offset:18944
    v_mfma_f32_16x16x32_bf16 a[60:63], a[236:239], a[204:207], a[60:63]
    ds_read_b64_tr_b16 a[228:229], v63 offset:18432
    ds_read_b64_tr_b16 a[230:231], v63 offset:18944
    v_mfma_f32_16x16x32_bf16 a[56:59], a[236:239], a[200:203], a[56:59]
    v_mfma_f32_16x16x32_bf16 a[40:43], a[232:235], a[200:203], a[40:43]
    v_mfma_f32_16x16x32_bf16 a[36:39], a[232:235], a[196:199], a[36:39]
    v_mfma_f32_16x16x32_bf16 a[52:55], a[236:239], a[196:199], a[52:55]
    v_mfma_f32_16x16x32_bf16 a[48:51], a[236:239], a[192:195], a[48:51]
    v_mfma_f32_16x16x32_bf16 a[32:35], a[232:235], a[192:195], a[32:35]
    v_mfma_f32_16x16x32_bf16 a[64:67], a[240:243], a[192:195], a[64:67]
    s_waitcnt lgkmcnt(0)
    ds_read_b64_tr_b16 a[232:233], v60 offset:16384
    ds_read_b64_tr_b16 a[234:235], v60 offset:16896
    v_mfma_f32_16x16x32_bf16 a[80:83], a[244:247], a[192:195], a[80:83]
    ds_read_b64_tr_b16 a[236:237], v61 offset:16384
    ds_read_b64_tr_b16 a[238:239], v61 offset:16896
    v_mfma_f32_16x16x32_bf16 a[84:87], a[244:247], a[196:199], a[84:87]
    s_mul_i32 s33, s31, 1082368
    v_mfma_f32_16x16x32_bf16 a[68:71], a[240:243], a[196:199], a[68:71]
    v_mfma_f32_16x16x32_bf16 a[72:75], a[240:243], a[200:203], a[72:75]
    s_add_u32 s36, s28, s33
    s_addc_u32 s37, s29, 0
    v_mfma_f32_16x16x32_bf16 a[88:91], a[244:247], a[200:203], a[88:91]
    v_mfma_f32_16x16x32_bf16 a[92:95], a[244:247], a[204:207], a[92:95]
    v_mfma_f32_16x16x32_bf16 a[76:79], a[240:243], a[204:207], a[76:79]
    v_mfma_f32_16x16x32_bf16 a[108:111], a[248:251], a[204:207], a[108:111]
    ds_read_b64_tr_b16 a[240:241], v60 offset:18432
    ds_read_b64_tr_b16 a[242:243], v60 offset:18944
    v_mfma_f32_16x16x32_bf16 a[124:127], a[252:255], a[204:207], a[124:127]
    ds_read_b64_tr_b16 a[244:245], v61 offset:18432
    ds_read_b64_tr_b16 a[246:247], v61 offset:18944
    v_mfma_f32_16x16x32_bf16 a[120:123], a[252:255], a[200:203], a[120:123]
    s_mov_b32 s38, 1081344
    v_mfma_f32_16x16x32_bf16 a[104:107], a[248:251], a[200:203], a[104:107]
    v_mfma_f32_16x16x32_bf16 a[100:103], a[248:251], a[196:199], a[100:103]
    s_mov_b32 s39, 0x00020000
    v_mfma_f32_16x16x32_bf16 a[116:119], a[252:255], a[196:199], a[116:119]
    v_mfma_f32_16x16x32_bf16 a[112:115], a[252:255], a[192:195], a[112:115]
    v_mfma_f32_16x16x32_bf16 a[96:99], a[248:251], a[192:195], a[96:99]
    v_mfma_f32_16x16x32_bf16 a[128:131], a[224:227], a[192:195], a[128:131]
    ds_read_b64_tr_b16 a[248:249], v62 offset:16384
    ds_read_b64_tr_b16 a[250:251], v62 offset:16896
    v_mfma_f32_16x16x32_bf16 a[144:147], a[228:231], a[192:195], a[144:147]
    ds_read_b64_tr_b16 a[252:253], v63 offset:16384
    ds_read_b64_tr_b16 a[254:255], v63 offset:16896
    v_mfma_f32_16x16x32_bf16 a[148:151], a[228:231], a[196:199], a[148:151]
    s_lshl_b32 s33, s30, 12
    v_mfma_f32_16x16x32_bf16 a[132:135], a[224:227], a[196:199], a[132:135]
    v_mfma_f32_16x16x32_bf16 a[136:139], a[224:227], a[200:203], a[136:139]
    s_add_u32 m0, s33, 16384
    v_mfma_f32_16x16x32_bf16 a[152:155], a[228:231], a[200:203], a[152:155]
    v_mfma_f32_16x16x32_bf16 a[156:159], a[228:231], a[204:207], a[156:159]
    v_mfma_f32_16x16x32_bf16 a[140:143], a[224:227], a[204:207], a[140:143]
    s_waitcnt lgkmcnt(2)
    v_mfma_f32_16x16x32_bf16 v[172:175], a[232:235], a[204:207], v[172:175]
    ds_read_b64_tr_b16 a[224:225], v52 offset:8192
    ds_read_b64_tr_b16 a[226:227], v52 offset:9216
    v_mfma_f32_16x16x32_bf16 v[188:191], a[236:239], a[204:207], v[188:191]
    ds_read_b64_tr_b16 a[228:229], v53 offset:8192
    ds_read_b64_tr_b16 a[230:231], v53 offset:9216
    v_mfma_f32_16x16x32_bf16 v[184:187], a[236:239], a[200:203], v[184:187]
    s_lshl_b32 s92, s30, 13
    v_mfma_f32_16x16x32_bf16 v[168:171], a[232:235], a[200:203], v[168:171]
    v_mfma_f32_16x16x32_bf16 v[164:167], a[232:235], a[196:199], v[164:167]
    v_mfma_f32_16x16x32_bf16 v[180:183], a[236:239], a[196:199], v[180:183]
    v_mfma_f32_16x16x32_bf16 v[176:179], a[236:239], a[192:195], v[176:179]
    s_waitcnt vmcnt(0)
    v_cmp_gt_u32 vcc, 2, v6
    v_mfma_f32_16x16x32_bf16 v[160:163], a[232:235], a[192:195], v[160:163]
    s_cbranch_vccnz SP_kv
SR_kv:
    v_mfma_f32_16x16x32_bf16 v[192:195], a[240:243], a[192:195], v[192:195]
    ds_read_b64_tr_b16 a[232:233], v54 offset:8192
    ds_read_b64_tr_b16 a[234:235], v54 offset:9216
    v_mfma_f32_16x16x32_bf16 v[208:211], a[244:247], a[192:195], v[208:211]
    ds_read_b64_tr_b16 a[236:237], v55 offset:8192
    ds_read_b64_tr_b16 a[238:239], v55 offset:9216
    v_mfma_f32_16x16x32_bf16 v[212:215], a[244:247], a[196:199], v[212:215]
    buffer_load_dwordx4 v2, s[36:39], s33 offen offset:0 sc1 lds
    v_mfma_f32_16x16x32_bf16 v[196:199], a[240:243], a[196:199], v[196:199]
    v_mfma_f32_16x16x32_bf16 v[200:203], a[240:243], a[200:203], v[200:203]
    v_mfma_f32_16x16x32_bf16 v[216:219], a[244:247], a[200:203], v[216:219]
    buffer_load_dwordx4 v2, s[36:39], s33 offen offset:1024 sc1 lds
    v_mfma_f32_16x16x32_bf16 v[220:223], a[244:247], a[204:207], v[220:223]
    v_mfma_f32_16x16x32_bf16 v[204:207], a[240:243], a[204:207], v[204:207]
    v_mfma_f32_16x16x32_bf16 v[236:239], a[248:251], a[204:207], v[236:239]
    s_waitcnt lgkmcnt(0)
    ds_read_b64_tr_b16 a[240:241], v56 offset:8192
    ds_read_b64_tr_b16 a[242:243], v56 offset:9216
    v_mfma_f32_16x16x32_bf16 v[252:255], a[252:255], a[204:207], v[252:255]
    ds_read_b64_tr_b16 a[244:245], v57 offset:8192
    ds_read_b64_tr_b16 a[246:247], v57 offset:9216
    v_mfma_f32_16x16x32_bf16 v[248:251], a[252:255], a[200:203], v[248:251]
    buffer_load_dwordx4 v2, s[36:39], s33 offen offset:2048 sc1 lds
    v_mfma_f32_16x16x32_bf16 v[232:235], a[248:251], a[200:203], v[232:235]
    v_mfma_f32_16x16x32_bf16 v[228:231], a[248:251], a[196:199], v[228:231]
    v_mfma_f32_16x16x32_bf16 v[244:247], a[252:255], a[196:199], v[244:247]
    buffer_load_dwordx4 v2, s[36:39], s33 offen offset:3072 sc1 lds
    v_mfma_f32_16x16x32_bf16 v[240:243], a[252:255], a[192:195], v[240:243]
    s_add_u32 s93, s92, 32768
    v_mfma_f32_16x16x32_bf16 v[224:227], a[248:251], a[192:195], v[224:227]
    s_add_u32 s92, s92, 17408
    v_mfma_f32_16x16x32_bf16 a[0:3], a[224:227], a[208:211], a[0:3]
    s_add_u32 m0, s93, 0
    ds_read_b64_tr_b16 a[248:249], v58 offset:8192
    ds_read_b64_tr_b16 a[250:251], v58 offset:9216
    v_mfma_f32_16x16x32_bf16 a[16:19], a[228:231], a[208:211], a[16:19]
    ds_read_b64_tr_b16 a[252:253], v59 offset:8192
    ds_read_b64_tr_b16 a[254:255], v59 offset:9216
    v_mfma_f32_16x16x32_bf16 a[20:23], a[228:231], a[212:215], a[20:23]
    buffer_load_dwordx4 v2, s[36:39], s92 offen offset:0 sc1 lds
    v_mfma_f32_16x16x32_bf16 a[4:7], a[224:227], a[212:215], a[4:7]
    v_mfma_f32_16x16x32_bf16 a[8:11], a[224:227], a[216:219], a[8:11]
    v_mfma_f32_16x16x32_bf16 a[24:27], a[228:231], a[216:219], a[24:27]
    buffer_load_dwordx4 v2, s[36:39], s92 offen offset:1024 sc1 lds
    v_mfma_f32_16x16x32_bf16 a[28:31], a[228:231], a[220:223], a[28:31]
    v_mfma_f32_16x16x32_bf16 a[12:15], a[224:227], a[220:223], a[12:15]
    v_mfma_f32_16x16x32_bf16 a[44:47], a[232:235], a[220:223], a[44:47]
    ds_read_b64_tr_b16 a[224:225], v62 offset:26624
    ds_read_b64_tr_b16 a[226:227], v62 offset:27136
    v_mfma_f32_16x16x32_bf16 a[60:63], a[236:239], a[220:223], a[60:63]
    ds_read_b64_tr_b16 a[228:229], v63 offset:26624
    ds_read_b64_tr_b16 a[230:231], v63 offset:27136
    v_mfma_f32_16x16x32_bf16 a[56:59], a[236:239], a[216:219], a[56:59]
    buffer_load_dwordx4 v2, s[36:39], s92 offen offset:2048 sc1 lds
    v_mfma_f32_16x16x32_bf16 a[40:43], a[232:235], a[216:219], a[40:43]
    v_mfma_f32_16x16x32_bf16 a[36:39], a[232:235], a[212:215], a[36:39]
    v_mfma_f32_16x16x32_bf16 a[52:55], a[236:239], a[212:215], a[52:55]
    buffer_load_dwordx4 v2, s[36:39], s92 offen offset:3072 sc1 lds
    v_mfma_f32_16x16x32_bf16 a[48:51], a[236:239], a[208:211], a[48:51]
    s_add_u32 m0, s93, 4096
    v_mfma_f32_16x16x32_bf16 a[32:35], a[232:235], a[208:211], a[32:35]
    s_waitcnt lgkmcnt(2)
    v_mfma_f32_16x16x32_bf16 a[64:67], a[240:243], a[208:211], a[64:67]
    ds_read_b64_tr_b16 a[232:233], v60 offset:24576
    ds_read_b64_tr_b16 a[234:235], v60 offset:25088
    v_mfma_f32_16x16x32_bf16 a[80:83], a[244:247], a[208:211], a[80:83]
    ds_read_b64_tr_b16 a[236:237], v61 offset:24576
    ds_read_b64_tr_b16 a[238:239], v61 offset:25088
    v_mfma_f32_16x16x32_bf16 a[84:87], a[244:247], a[212:215], a[84:87]
    buffer_load_dwordx4 v4, s[36:39], s92 offen offset:0 sc1 lds
    v_mfma_f32_16x16x32_bf16 a[68:71], a[240:243], a[212:215], a[68:71]
    v_mfma_f32_16x16x32_bf16 a[72:75], a[240:243], a[216:219], a[72:75]
    v_mfma_f32_16x16x32_bf16 a[88:91], a[244:247], a[216:219], a[88:91]
    buffer_load_dwordx4 v4, s[36:39], s92 offen offset:1024 sc1 lds
    v_mfma_f32_16x16x32_bf16 a[92:95], a[244:247], a[220:223], a[92:95]
    v_mfma_f32_16x16x32_bf16 a[76:79], a[240:243], a[220:223], a[76:79]
    v_mfma_f32_16x16x32_bf16 a[108:111], a[248:251], a[220:223], a[108:111]
    ds_read_b64_tr_b16 a[240:241], v60 offset:26624
    ds_read_b64_tr_b16 a[242:243], v60 offset:27136
    v_mfma_f32_16x16x32_bf16 a[124:127], a[252:255], a[220:223], a[124:127]
    ds_read_b64_tr_b16 a[244:245], v61 offset:26624
    ds_read_b64_tr_b16 a[246:247], v61 offset:27136
    v_mfma_f32_16x16x32_bf16 a[120:123], a[252:255], a[216:219], a[120:123]
    buffer_load_dwordx4 v4, s[36:39], s92 offen offset:2048 sc1 lds
    v_mfma_f32_16x16x32_bf16 a[104:107], a[248:251], a[216:219], a[104:107]
    v_mfma_f32_16x16x32_bf16 a[100:103], a[248:251], a[212:215], a[100:103]
    v_mfma_f32_16x16x32_bf16 a[116:119], a[252:255], a[212:215], a[116:119]
    buffer_load_dwordx4 v4, s[36:39], s92 offen offset:3072 sc1 lds
    v_mfma_f32_16x16x32_bf16 a[112:115], a[252:255], a[208:211], a[112:115]
    s_add_u32 s92, s92, 33792
    v_mfma_f32_16x16x32_bf16 a[96:99], a[248:251], a[208:211], a[96:99]
    s_add_u32 s93, s93, 32768
    v_mfma_f32_16x16x32_bf16 a[128:131], a[224:227], a[208:211], a[128:131]
    s_and_b32 s93, s93, 0x1ffff
    ds_read_b64_tr_b16 a[248:249], v62 offset:24576
    ds_read_b64_tr_b16 a[250:251], v62 offset:25088
    s_waitcnt lgkmcnt(10)
    v_mfma_f32_16x16x32_bf16 a[144:147], a[228:231], a[208:211], a[144:147]
    s_add_u32 m0, s93, 0
    ds_read_b64_tr_b16 a[252:253], v63 offset:24576
    ds_read_b64_tr_b16 a[254:255], v63 offset:25088
    v_mfma_f32_16x16x32_bf16 a[148:151], a[228:231], a[212:215], a[148:151]
    buffer_load_dwordx4 v2, s[36:39], s92 offen offset:0 sc1 lds
    v_mfma_f32_16x16x32_bf16 a[132:135], a[224:227], a[212:215], a[132:135]
    v_mfma_f32_16x16x32_bf16 a[136:139], a[224:227], a[216:219], a[136:139]
    v_mfma_f32_16x16x32_bf16 a[152:155], a[228:231], a[216:219], a[152:155]
    buffer_load_dwordx4 v2, s[36:39], s92 offen offset:1024 sc1 lds
    v_mfma_f32_16x16x32_bf16 a[156:159], a[228:231], a[220:223], a[156:159]
    v_mfma_f32_16x16x32_bf16 a[140:143], a[224:227], a[220:223], a[140:143]
    s_waitcnt lgkmcnt(2)
    v_mfma_f32_16x16x32_bf16 v[172:175], a[232:235], a[220:223], v[172:175]
    buffer_load_dwordx4 v2, s[36:39], s92 offen offset:2048 sc1 lds
    v_mfma_f32_16x16x32_bf16 v[188:191], a[236:239], a[220:223], v[188:191]
    v_mfma_f32_16x16x32_bf16 v[184:187], a[236:239], a[216:219], v[184:187]
    v_mfma_f32_16x16x32_bf16 v[168:171], a[232:235], a[216:219], v[168:171]
    buffer_load_dwordx4 v2, s[36:39], s92 offen offset:3072 sc1 lds
    v_mfma_f32_16x16x32_bf16 v[164:167], a[232:235], a[212:215], v[164:167]
    s_add_u32 m0, s93, 4096
    v_mfma_f32_16x16x32_bf16 v[180:183], a[236:239], a[212:215], v[180:183]
    v_mfma_f32_16x16x32_bf16 v[176:179], a[236:239], a[208:211], v[176:179]
    buffer_load_dwordx4 v4, s[36:39], s92 offen offset:0 sc1 lds
    v_mfma_f32_16x16x32_bf16 v[160:163], a[232:235], a[208:211], v[160:163]
    v_mfma_f32_16x16x32_bf16 v[192:195], a[240:243], a[208:211], v[192:195]
    v_mfma_f32_16x16x32_bf16 v[208:211], a[244:247], a[208:211], v[208:211]
    buffer_load_dwordx4 v4, s[36:39], s92 offen offset:1024 sc1 lds
    v_mfma_f32_16x16x32_bf16 v[212:215], a[244:247], a[212:215], v[212:215]
    v_mfma_f32_16x16x32_bf16 v[196:199], a[240:243], a[212:215], v[196:199]
    v_mfma_f32_16x16x32_bf16 v[200:203], a[240:243], a[216:219], v[200:203]
    buffer_load_dwordx4 v4, s[36:39], s92 offen offset:2048 sc1 lds
    v_mfma_f32_16x16x32_bf16 v[216:219], a[244:247], a[216:219], v[216:219]
    v_mfma_f32_16x16x32_bf16 v[220:223], a[244:247], a[220:223], v[220:223]
    v_mfma_f32_16x16x32_bf16 v[204:207], a[240:243], a[220:223], v[204:207]
    s_waitcnt lgkmcnt(0)
    buffer_load_dwordx4 v4, s[36:39], s92 offen offset:3072 sc1 lds
    v_mfma_f32_16x16x32_bf16 v[236:239], a[248:251], a[220:223], v[236:239]
    s_add_u32 s92, s92, 33792
    v_mfma_f32_16x16x32_bf16 v[252:255], a[252:255], a[220:223], v[252:255]
    s_add_u32 s93, s93, 32768
    v_mfma_f32_16x16x32_bf16 v[248:251], a[252:255], a[216:219], v[248:251]
    s_and_b32 s93, s93, 0x1ffff
    v_mfma_f32_16x16x32_bf16 v[232:235], a[248:251], a[216:219], v[232:235]
    v_mfma_f32_16x16x32_bf16 v[228:231], a[248:251], a[212:215], v[228:231]
    v_mfma_f32_16x16x32_bf16 v[244:247], a[252:255], a[212:215], v[244:247]
    v_mfma_f32_16x16x32_bf16 v[240:243], a[252:255], a[208:211], v[240:243]
    v_mfma_f32_16x16x32_bf16 v[224:227], a[248:251], a[208:211], v[224:227]
QG_epi:
    s_mov_b32 s84, 0x3e0293ee
    s_mov_b32 s85, 0x3e0293ee
    s_mov_b32 s86, 0xbdd2d3e8
    s_mov_b32 s87, 0xbdd2d3e8
    v_mov_b32 v34, 0xc0135761
    v_mov_b32 v35, 0xc0135761
    v_mov_b32 v36, 1.0
    v_mov_b32 v37, 1.0
    v_pk_mul_f32 v[64:65], v[160:161], v[160:161]
    v_pk_mul_f32 v[66:67], v[162:163], v[162:163]
    v_pk_mul_f32 v[68:69], v[176:177], v[176:177]
    v_pk_mul_f32 v[70:71], v[178:179], v[178:179]
    v_pk_fma_f32 v[64:65], v[64:65], s[86:87], v[34:35]
    v_pk_fma_f32 v[66:67], v[66:67], s[86:87], v[34:35]
    v_pk_fma_f32 v[68:69], v[68:69], s[86:87], v[34:35]
    v_pk_fma_f32 v[70:71], v[70:71], s[86:87], v[34:35]
    v_pk_mul_f32 v[64:65], v[64:65], v[160:161]
    v_pk_mul_f32 v[66:67], v[66:67], v[162:163]
    v_pk_mul_f32 v[68:69], v[68:69], v[176:177]
    v_pk_mul_f32 v[70:71], v[70:71], v[178:179]
    v_exp_f32 v64, v64
    v_exp_f32 v65, v65
    v_exp_f32 v66, v66
    v_exp_f32 v67, v67
    v_exp_f32 v68, v68
    v_exp_f32 v69, v69
    v_exp_f32 v70, v70
    v_exp_f32 v71, v71
    v_pk_mul_f32 v[160:161], v[160:161], v[192:193]
    v_pk_mul_f32 v[162:163], v[162:163], v[194:195]
    v_pk_mul_f32 v[176:177], v[176:177], v[208:209]
    v_pk_mul_f32 v[178:179], v[178:179], v[210:211]
    v_pk_add_f32 v[64:65], v[64:65], v[36:37]
    v_pk_add_f32 v[66:67], v[66:67], v[36:37]
    v_pk_add_f32 v[68:69], v[68:69], v[36:37]
    v_pk_add_f32 v[70:71], v[70:71], v[36:37]
    v_rcp_f32 v64, v64
    v_rcp_f32 v65, v65
    v_rcp_f32 v66, v66
    v_rcp_f32 v67, v67
    v_rcp_f32 v68, v68
    v_rcp_f32 v69, v69
    v_rcp_f32 v70, v70
    v_rcp_f32 v71, v71
    v_pk_mul_f32 v[64:65], v[64:65], v[160:161]
    v_pk_mul_f32 v[66:67], v[66:67], v[162:163]
    v_pk_mul_f32 v[68:69], v[68:69], v[176:177]
    v_pk_mul_f32 v[70:71], v[70:71], v[178:179]
    v_cvt_pk_bf16_f32 v72, v64, v65
    v_cvt_pk_bf16_f32 v73, v66, v67
    v_cvt_pk_bf16_f32 v74, v68, v69
    v_cvt_pk_bf16_f32 v75, v70, v71
    buffer_store_dwordx4 v[72:75], v2, s[48:51], s56 offen offset:0 sc1
    v_pk_mul_f32 v[80:81], v[164:165], v[164:165]
    v_pk_mul_f32 v[82:83], v[166:167], v[166:167]
    v_pk_mul_f32 v[84:85], v[180:181], v[180:181]
    v_pk_mul_f32 v[86:87], v[182:183], v[182:183]
    v_pk_fma_f32 v[80:81], v[80:81], s[86:87], v[34:35]
    v_pk_fma_f32 v[82:83], v[82:83], s[86:87], v[34:35]
    v_pk_fma_f32 v[84:85], v[84:85], s[86:87], v[34:35]
    v_pk_fma_f32 v[86:87], v[86:87], s[86:87], v[34:35]
    v_pk_mul_f32 v[80:81], v[80:81], v[164:165]
    v_pk_mul_f32 v[82:83], v[82:83], v[166:167]
    v_pk_mul_f32 v[84:85], v[84:85], v[180:181]
    v_pk_mul_f32 v[86:87], v[86:87], v[182:183]
    v_exp_f32 v80, v80
    v_exp_f32 v81, v81
    v_exp_f32 v82, v82
    v_exp_f32 v83, v83
    v_exp_f32 v84, v84
    v_exp_f32 v85, v85
    v_exp_f32 v86, v86
    v_exp_f32 v87, v87
    v_pk_mul_f32 v[164:165], v[164:165], v[196:197]
    v_pk_mul_f32 v[166:167], v[166:167], v[198:199]
    v_pk_mul_f32 v[180:181], v[180:181], v[212:213]
    v_pk_mul_f32 v[182:183], v[182:183], v[214:215]
    v_pk_add_f32 v[80:81], v[80:81], v[36:37]
    v_pk_add_f32 v[82:83], v[82:83], v[36:37]
    v_pk_add_f32 v[84:85], v[84:85], v[36:37]
    v_pk_add_f32 v[86:87], v[86:87], v[36:37]
    v_rcp_f32 v80, v80
    v_rcp_f32 v81, v81
    v_rcp_f32 v82, v82
    v_rcp_f32 v83, v83
    v_rcp_f32 v84, v84
    v_rcp_f32 v85, v85
    v_rcp_f32 v86, v86
    v_rcp_f32 v87, v87
    v_pk_mul_f32 v[80:81], v[80:81], v[164:165]
    v_pk_mul_f32 v[82:83], v[82:83], v[166:167]
    v_pk_mul_f32 v[84:85], v[84:85], v[180:181]
    v_pk_mul_f32 v[86:87], v[86:87], v[182:183]
    v_cvt_pk_bf16_f32 v88, v80, v81
    v_cvt_pk_bf16_f32 v89, v82, v83
    v_cvt_pk_bf16_f32 v90, v84, v85
    v_cvt_pk_bf16_f32 v91, v86, v87
    buffer_store_dwordx4 v[88:91], v2, s[48:51], s57 offen offset:0 sc1
    v_pk_mul_f32 v[96:97], v[168:169], v[168:169]
    v_pk_mul_f32 v[98:99], v[170:171], v[170:171]
    v_pk_mul_f32 v[100:101], v[184:185], v[184:185]
    v_pk_mul_f32 v[102:103], v[186:187], v[186:187]
    v_pk_fma_f32 v[96:97], v[96:97], s[86:87], v[34:35]
    v_pk_fma_f32 v[98:99], v[98:99], s[86:87], v[34:35]
    v_pk_fma_f32 v[100:101], v[100:101], s[86:87], v[34:35]
    v_pk_fma_f32 v[102:103], v[102:103], s[86:87], v[34:35]
    v_pk_mul_f32 v[96:97], v[96:97], v[168:169]
    v_pk_mul_f32 v[98:99], v[98:99], v[170:171]
    v_pk_mul_f32 v[100:101], v[100:101], v[184:185]
    v_pk_mul_f32 v[102:103], v[102:103], v[186:187]
    v_exp_f32 v96, v96
    v_exp_f32 v97, v97
    v_exp_f32 v98, v98
    v_exp_f32 v99, v99
    v_exp_f32 v100, v100
    v_exp_f32 v101, v101
    v_exp_f32 v102, v102
    v_exp_f32 v103, v103
    v_pk_mul_f32 v[168:169], v[168:169], v[200:201]
    v_pk_mul_f32 v[170:171], v[170:171], v[202:203]
    v_pk_mul_f32 v[184:185], v[184:185], v[216:217]
    v_pk_mul_f32 v[186:187], v[186:187], v[218:219]
    v_pk_add_f32 v[96:97], v[96:97], v[36:37]
    v_pk_add_f32 v[98:99], v[98:99], v[36:37]
    v_pk_add_f32 v[100:101], v[100:101], v[36:37]
    v_pk_add_f32 v[102:103], v[102:103], v[36:37]
    v_rcp_f32 v96, v96
    v_rcp_f32 v97, v97
    v_rcp_f32 v98, v98
    v_rcp_f32 v99, v99
    v_rcp_f32 v100, v100
    v_rcp_f32 v101, v101
    v_rcp_f32 v102, v102
    v_rcp_f32 v103, v103
    v_pk_mul_f32 v[96:97], v[96:97], v[168:169]
    v_pk_mul_f32 v[98:99], v[98:99], v[170:171]
    v_pk_mul_f32 v[100:101], v[100:101], v[184:185]
    v_pk_mul_f32 v[102:103], v[102:103], v[186:187]
    v_cvt_pk_bf16_f32 v104, v96, v97
    v_cvt_pk_bf16_f32 v105, v98, v99
    v_cvt_pk_bf16_f32 v106, v100, v101
    v_cvt_pk_bf16_f32 v107, v102, v103
    buffer_store_dwordx4 v[104:107], v2, s[48:51], s58 offen offset:0 sc1
    v_pk_mul_f32 v[112:113], v[172:173], v[172:173]
    v_pk_mul_f32 v[114:115], v[174:175], v[174:175]
    v_pk_mul_f32 v[116:117], v[188:189], v[188:189]
    v_pk_mul_f32 v[118:119], v[190:191], v[190:191]
    v_pk_fma_f32 v[112:113], v[112:113], s[86:87], v[34:35]
    v_pk_fma_f32 v[114:115], v[114:115], s[86:87], v[34:35]
    v_pk_fma_f32 v[116:117], v[116:117], s[86:87], v[34:35]
    v_pk_fma_f32 v[118:119], v[118:119], s[86:87], v[34:35]
    v_pk_mul_f32 v[112:113], v[112:113], v[172:173]
    v_pk_mul_f32 v[114:115], v[114:115], v[174:175]
    v_pk_mul_f32 v[116:117], v[116:117], v[188:189]
    v_pk_mul_f32 v[118:119], v[118:119], v[190:191]
    v_exp_f32 v112, v112
    v_exp_f32 v113, v113
    v_exp_f32 v114, v114
    v_exp_f32 v115, v115
    v_exp_f32 v116, v116
    v_exp_f32 v117, v117
    v_exp_f32 v118, v118
    v_exp_f32 v119, v119
    v_pk_mul_f32 v[172:173], v[172:173], v[204:205]
    v_pk_mul_f32 v[174:175], v[174:175], v[206:207]
    v_pk_mul_f32 v[188:189], v[188:189], v[220:221]
    v_pk_mul_f32 v[190:191], v[190:191], v[222:223]
    v_pk_add_f32 v[112:113], v[112:113], v[36:37]
    v_pk_add_f32 v[114:115], v[114:115], v[36:37]
    v_pk_add_f32 v[116:117], v[116:117], v[36:37]
    v_pk_add_f32 v[118:119], v[118:119], v[36:37]
    v_rcp_f32 v112, v112
    v_rcp_f32 v113, v113
    v_rcp_f32 v114, v114
    v_rcp_f32 v115, v115
    v_rcp_f32 v116, v116
    v_rcp_f32 v117, v117
    v_rcp_f32 v118, v118
    v_rcp_f32 v119, v119
    v_pk_mul_f32 v[112:113], v[112:113], v[172:173]
    v_pk_mul_f32 v[114:115], v[114:115], v[174:175]
    v_pk_mul_f32 v[116:117], v[116:117], v[188:189]
    v_pk_mul_f32 v[118:119], v[118:119], v[190:191]
    v_cvt_pk_bf16_f32 v120, v112, v113
    v_cvt_pk_bf16_f32 v121, v114, v115
    v_cvt_pk_bf16_f32 v122, v116, v117
    v_cvt_pk_bf16_f32 v123, v118, v119
    buffer_store_dwordx4 v[120:123], v2, s[48:51], s59 offen offset:0 sc1
    v_pk_mul_f32 v[64:65], v[224:225], v[224:225]
    v_pk_mul_f32 v[66:67], v[226:227], v[226:227]
    v_pk_mul_f32 v[68:69], v[240:241], v[240:241]
    v_pk_mul_f32 v[70:71], v[242:243], v[242:243]
    v_pk_fma_f32 v[64:65], v[64:65], s[86:87], v[34:35]
    v_pk_fma_f32 v[66:67], v[66:67], s[86:87], v[34:35]
    v_pk_fma_f32 v[68:69], v[68:69], s[86:87], v[34:35]
    v_pk_fma_f32 v[70:71], v[70:71], s[86:87], v[34:35]
    v_pk_mul_f32 v[64:65], v[64:65], v[224:225]
    v_pk_mul_f32 v[66:67], v[66:67], v[226:227]
    v_pk_mul_f32 v[68:69], v[68:69], v[240:241]
    v_pk_mul_f32 v[70:71], v[70:71], v[242:243]
    v_accvgpr_read_b32 v72, a128
    v_accvgpr_read_b32 v73, a129
    v_accvgpr_read_b32 v74, a130
    v_accvgpr_read_b32 v75, a131
    v_accvgpr_read_b32 v76, a144
    v_accvgpr_read_b32 v77, a145
    v_accvgpr_read_b32 v78, a146
    v_accvgpr_read_b32 v79, a147
    v_exp_f32 v64, v64
    v_exp_f32 v65, v65
    v_exp_f32 v66, v66
    v_exp_f32 v67, v67
    v_exp_f32 v68, v68
    v_exp_f32 v69, v69
    v_exp_f32 v70, v70
    v_exp_f32 v71, v71
    v_pk_mul_f32 v[224:225], v[224:225], v[72:73]
    v_pk_mul_f32 v[226:227], v[226:227], v[74:75]
    v_pk_mul_f32 v[240:241], v[240:241], v[76:77]
    v_pk_mul_f32 v[242:243], v[242:243], v[78:79]
    v_pk_add_f32 v[64:65], v[64:65], v[36:37]
    v_pk_add_f32 v[66:67], v[66:67], v[36:37]
    v_pk_add_f32 v[68:69], v[68:69], v[36:37]
    v_pk_add_f32 v[70:71], v[70:71], v[36:37]
    v_rcp_f32 v64, v64
    v_rcp_f32 v65, v65
    v_rcp_f32 v66, v66
    v_rcp_f32 v67, v67
    v_rcp_f32 v68, v68
    v_rcp_f32 v69, v69
    v_rcp_f32 v70, v70
    v_rcp_f32 v71, v71
    v_pk_mul_f32 v[64:65], v[64:65], v[224:225]
    v_pk_mul_f32 v[66:67], v[66:67], v[226:227]
    v_pk_mul_f32 v[68:69], v[68:69], v[240:241]
    v_pk_mul_f32 v[70:71], v[70:71], v[242:243]
    v_cvt_pk_bf16_f32 v72, v64, v65
    v_cvt_pk_bf16_f32 v73, v66, v67
    v_cvt_pk_bf16_f32 v74, v68, v69
    v_cvt_pk_bf16_f32 v75, v70, v71
    buffer_store_dwordx4 v[72:75], v2, s[48:51], s56 offen offset:1024 sc1
    v_pk_mul_f32 v[80:81], v[228:229], v[228:229]
    v_pk_mul_f32 v[82:83], v[230:231], v[230:231]
    v_pk_mul_f32 v[84:85], v[244:245], v[244:245]
    v_pk_mul_f32 v[86:87], v[246:247], v[246:247]
    v_pk_fma_f32 v[80:81], v[80:81], s[86:87], v[34:35]
    v_pk_fma_f32 v[82:83], v[82:83], s[86:87], v[34:35]
    v_pk_fma_f32 v[84:85], v[84:85], s[86:87], v[34:35]
    v_pk_fma_f32 v[86:87], v[86:87], s[86:87], v[34:35]
    v_pk_mul_f32 v[80:81], v[80:81], v[228:229]
    v_pk_mul_f32 v[82:83], v[82:83], v[230:231]
    v_pk_mul_f32 v[84:85], v[84:85], v[244:245]
    v_pk_mul_f32 v[86:87], v[86:87], v[246:247]
    v_accvgpr_read_b32 v88, a132
    v_accvgpr_read_b32 v89, a133
    v_accvgpr_read_b32 v90, a134
    v_accvgpr_read_b32 v91, a135
    v_accvgpr_read_b32 v92, a148
    v_accvgpr_read_b32 v93, a149
    v_accvgpr_read_b32 v94, a150
    v_accvgpr_read_b32 v95, a151
    v_exp_f32 v80, v80
    v_exp_f32 v81, v81
    v_exp_f32 v82, v82
    v_exp_f32 v83, v83
    v_exp_f32 v84, v84
    v_exp_f32 v85, v85
    v_exp_f32 v86, v86
    v_exp_f32 v87, v87
    v_pk_mul_f32 v[228:229], v[228:229], v[88:89]
    v_pk_mul_f32 v[230:231], v[230:231], v[90:91]
    v_pk_mul_f32 v[244:245], v[244:245], v[92:93]
    v_pk_mul_f32 v[246:247], v[246:247], v[94:95]
    v_pk_add_f32 v[80:81], v[80:81], v[36:37]
    v_pk_add_f32 v[82:83], v[82:83], v[36:37]
    v_pk_add_f32 v[84:85], v[84:85], v[36:37]
    v_pk_add_f32 v[86:87], v[86:87], v[36:37]
    v_rcp_f32 v80, v80
    v_rcp_f32 v81, v81
    v_rcp_f32 v82, v82
    v_rcp_f32 v83, v83
    v_rcp_f32 v84, v84
    v_rcp_f32 v85, v85
    v_rcp_f32 v86, v86
    v_rcp_f32 v87, v87
    v_pk_mul_f32 v[80:81], v[80:81], v[228:229]
    v_pk_mul_f32 v[82:83], v[82:83], v[230:231]
    v_pk_mul_f32 v[84:85], v[84:85], v[244:245]
    v_pk_mul_f32 v[86:87], v[86:87], v[246:247]
    v_cvt_pk_bf16_f32 v88, v80, v81
    v_cvt_pk_bf16_f32 v89, v82, v83
    v_cvt_pk_bf16_f32 v90, v84, v85
    v_cvt_pk_bf16_f32 v91, v86, v87
    buffer_store_dwordx4 v[88:91], v2, s[48:51], s57 offen offset:1024 sc1
    v_pk_mul_f32 v[96:97], v[232:233], v[232:233]
    v_pk_mul_f32 v[98:99], v[234:235], v[234:235]
    v_pk_mul_f32 v[100:101], v[248:249], v[248:249]
    v_pk_mul_f32 v[102:103], v[250:251], v[250:251]
    v_pk_fma_f32 v[96:97], v[96:97], s[86:87], v[34:35]
    v_pk_fma_f32 v[98:99], v[98:99], s[86:87], v[34:35]
    v_pk_fma_f32 v[100:101], v[100:101], s[86:87], v[34:35]
    v_pk_fma_f32 v[102:103], v[102:103], s[86:87], v[34:35]
    v_pk_mul_f32 v[96:97], v[96:97], v[232:233]
    v_pk_mul_f32 v[98:99], v[98:99], v[234:235]
    v_pk_mul_f32 v[100:101], v[100:101], v[248:249]
    v_pk_mul_f32 v[102:103], v[102:103], v[250:251]
    v_accvgpr_read_b32 v104, a136
    v_accvgpr_read_b32 v105, a137
    v_accvgpr_read_b32 v106, a138
    v_accvgpr_read_b32 v107, a139
    v_accvgpr_read_b32 v108, a152
    v_accvgpr_read_b32 v109, a153
    v_accvgpr_read_b32 v110, a154
    v_accvgpr_read_b32 v111, a155
    v_exp_f32 v96, v96
    v_exp_f32 v97, v97
    v_exp_f32 v98, v98
    v_exp_f32 v99, v99
    v_exp_f32 v100, v100
    v_exp_f32 v101, v101
    v_exp_f32 v102, v102
    v_exp_f32 v103, v103
    v_pk_mul_f32 v[232:233], v[232:233], v[104:105]
    v_pk_mul_f32 v[234:235], v[234:235], v[106:107]
    v_pk_mul_f32 v[248:249], v[248:249], v[108:109]
    v_pk_mul_f32 v[250:251], v[250:251], v[110:111]
    v_pk_add_f32 v[96:97], v[96:97], v[36:37]
    v_pk_add_f32 v[98:99], v[98:99], v[36:37]
    v_pk_add_f32 v[100:101], v[100:101], v[36:37]
    v_pk_add_f32 v[102:103], v[102:103], v[36:37]
    v_rcp_f32 v96, v96
    v_rcp_f32 v97, v97
    v_rcp_f32 v98, v98
    v_rcp_f32 v99, v99
    v_rcp_f32 v100, v100
    v_rcp_f32 v101, v101
    v_rcp_f32 v102, v102
    v_rcp_f32 v103, v103
    v_pk_mul_f32 v[96:97], v[96:97], v[232:233]
    v_pk_mul_f32 v[98:99], v[98:99], v[234:235]
    v_pk_mul_f32 v[100:101], v[100:101], v[248:249]
    v_pk_mul_f32 v[102:103], v[102:103], v[250:251]
    v_cvt_pk_bf16_f32 v104, v96, v97
    v_cvt_pk_bf16_f32 v105, v98, v99
    v_cvt_pk_bf16_f32 v106, v100, v101
    v_cvt_pk_bf16_f32 v107, v102, v103
    buffer_store_dwordx4 v[104:107], v2, s[48:51], s58 offen offset:1024 sc1
    v_pk_mul_f32 v[112:113], v[236:237], v[236:237]
    v_pk_mul_f32 v[114:115], v[238:239], v[238:239]
    v_pk_mul_f32 v[116:117], v[252:253], v[252:253]
    v_pk_mul_f32 v[118:119], v[254:255], v[254:255]
    v_pk_fma_f32 v[112:113], v[112:113], s[86:87], v[34:35]
    v_pk_fma_f32 v[114:115], v[114:115], s[86:87], v[34:35]
    v_pk_fma_f32 v[116:117], v[116:117], s[86:87], v[34:35]
    v_pk_fma_f32 v[118:119], v[118:119], s[86:87], v[34:35]
    v_pk_mul_f32 v[112:113], v[112:113], v[236:237]
    v_pk_mul_f32 v[114:115], v[114:115], v[238:239]
    v_pk_mul_f32 v[116:117], v[116:117], v[252:253]
    v_pk_mul_f32 v[118:119], v[118:119], v[254:255]
    v_accvgpr_read_b32 v120, a140
    v_accvgpr_read_b32 v121, a141
    v_accvgpr_read_b32 v122, a142
    v_accvgpr_read_b32 v123, a143
    v_accvgpr_read_b32 v124, a156
    v_accvgpr_read_b32 v125, a157
    v_accvgpr_read_b32 v126, a158
    v_accvgpr_read_b32 v127, a159
    v_exp_f32 v112, v112
    v_exp_f32 v113, v113
    v_exp_f32 v114, v114
    v_exp_f32 v115, v115
    v_exp_f32 v116, v116
    v_exp_f32 v117, v117
    v_exp_f32 v118, v118
    v_exp_f32 v119, v119
    v_pk_mul_f32 v[236:237], v[236:237], v[120:121]
    v_pk_mul_f32 v[238:239], v[238:239], v[122:123]
    v_pk_mul_f32 v[252:253], v[252:253], v[124:125]
    v_pk_mul_f32 v[254:255], v[254:255], v[126:127]
    v_pk_add_f32 v[112:113], v[112:113], v[36:37]
    v_pk_add_f32 v[114:115], v[114:115], v[36:37]
    v_pk_add_f32 v[116:117], v[116:117], v[36:37]
    v_pk_add_f32 v[118:119], v[118:119], v[36:37]
    v_rcp_f32 v112, v112
    v_rcp_f32 v113, v113
    v_rcp_f32 v114, v114
    v_rcp_f32 v115, v115
    v_rcp_f32 v116, v116
    v_rcp_f32 v117, v117
    v_rcp_f32 v118, v118
    v_rcp_f32 v119, v119
    v_pk_mul_f32 v[112:113], v[112:113], v[236:237]
    v_pk_mul_f32 v[114:115], v[114:115], v[238:239]
    v_pk_mul_f32 v[116:117], v[116:117], v[252:253]
    v_pk_mul_f32 v[118:119], v[118:119], v[254:255]
    v_cvt_pk_bf16_f32 v120, v112, v113
    v_cvt_pk_bf16_f32 v121, v114, v115
    v_cvt_pk_bf16_f32 v122, v116, v117
    v_cvt_pk_bf16_f32 v123, v118, v119
    buffer_store_dwordx4 v[120:123], v2, s[48:51], s59 offen offset:1024 sc1
    s_add_u32 m0, s93, 0
    s_nop 0
    buffer_load_dwordx4 v2, s[36:39], s92 offen offset:0 sc1 lds
    v_accvgpr_read_b32 v160, a0
    v_accvgpr_read_b32 v161, a1
    v_accvgpr_read_b32 v162, a2
    v_accvgpr_read_b32 v163, a3
    v_accvgpr_read_b32 v164, a16
    v_accvgpr_read_b32 v165, a17
    v_accvgpr_read_b32 v166, a18
    v_accvgpr_read_b32 v167, a19
    v_pk_mul_f32 v[160:161], v[160:161], s[84:85]
    v_pk_mul_f32 v[162:163], v[162:163], s[84:85]
    v_pk_mul_f32 v[164:165], v[164:165], s[84:85]
    v_pk_mul_f32 v[166:167], v[166:167], s[84:85]
    v_cvt_pk_bf16_f32 v64, v160, v161
    v_cvt_pk_bf16_f32 v65, v162, v163
    v_cvt_pk_bf16_f32 v66, v164, v165
    v_cvt_pk_bf16_f32 v67, v166, v167
    v_accvgpr_read_b32 v168, a4
    v_accvgpr_read_b32 v169, a5
    v_accvgpr_read_b32 v170, a6
    v_accvgpr_read_b32 v171, a7
    v_accvgpr_read_b32 v172, a20
    v_accvgpr_read_b32 v173, a21
    v_accvgpr_read_b32 v174, a22
    v_accvgpr_read_b32 v175, a23
    v_pk_mul_f32 v[168:169], v[168:169], s[84:85]
    v_pk_mul_f32 v[170:171], v[170:171], s[84:85]
    v_pk_mul_f32 v[172:173], v[172:173], s[84:85]
    v_pk_mul_f32 v[174:175], v[174:175], s[84:85]
    v_cvt_pk_bf16_f32 v68, v168, v169
    v_cvt_pk_bf16_f32 v69, v170, v171
    v_cvt_pk_bf16_f32 v70, v172, v173
    v_cvt_pk_bf16_f32 v71, v174, v175
    buffer_load_dwordx4 v2, s[36:39], s92 offen offset:1024 sc1 lds
    v_accvgpr_read_b32 v176, a8
    v_accvgpr_read_b32 v177, a9
    v_accvgpr_read_b32 v178, a10
    v_accvgpr_read_b32 v179, a11
    v_accvgpr_read_b32 v180, a24
    v_accvgpr_read_b32 v181, a25
    v_accvgpr_read_b32 v182, a26
    v_accvgpr_read_b32 v183, a27
    v_pk_mul_f32 v[176:177], v[176:177], s[84:85]
    v_pk_mul_f32 v[178:179], v[178:179], s[84:85]
    v_pk_mul_f32 v[180:181], v[180:181], s[84:85]
    v_pk_mul_f32 v[182:183], v[182:183], s[84:85]
    v_cvt_pk_bf16_f32 v72, v176, v177
    v_cvt_pk_bf16_f32 v73, v178, v179
    v_cvt_pk_bf16_f32 v74, v180, v181
    v_cvt_pk_bf16_f32 v75, v182, v183
    v_accvgpr_read_b32 v184, a12
    v_accvgpr_read_b32 v185, a13
    v_accvgpr_read_b32 v186, a14
    v_accvgpr_read_b32 v187, a15
    v_accvgpr_read_b32 v188, a28
    v_accvgpr_read_b32 v189, a29
    v_accvgpr_read_b32 v190, a30
    v_accvgpr_read_b32 v191, a31
    v_pk_mul_f32 v[184:185], v[184:185], s[84:85]
    v_pk_mul_f32 v[186:187], v[186:187], s[84:85]
    v_pk_mul_f32 v[188:189], v[188:189], s[84:85]
    v_pk_mul_f32 v[190:191], v[190:191], s[84:85]
    v_cvt_pk_bf16_f32 v76, v184, v185
    v_cvt_pk_bf16_f32 v77, v186, v187
    v_cvt_pk_bf16_f32 v78, v188, v189
    v_cvt_pk_bf16_f32 v79, v190, v191
    buffer_load_dwordx4 v2, s[36:39], s92 offen offset:2048 sc1 lds
    v_accvgpr_read_b32 v160, a32
    v_accvgpr_read_b32 v161, a33
    v_accvgpr_read_b32 v162, a34
    v_accvgpr_read_b32 v163, a35
    v_accvgpr_read_b32 v164, a48
    v_accvgpr_read_b32 v165, a49
    v_accvgpr_read_b32 v166, a50
    v_accvgpr_read_b32 v167, a51
    v_pk_mul_f32 v[160:161], v[160:161], s[84:85]
    v_pk_mul_f32 v[162:163], v[162:163], s[84:85]
    v_pk_mul_f32 v[164:165], v[164:165], s[84:85]
    v_pk_mul_f32 v[166:167], v[166:167], s[84:85]
    v_cvt_pk_bf16_f32 v80, v160, v161
    v_cvt_pk_bf16_f32 v81, v162, v163
    v_cvt_pk_bf16_f32 v82, v164, v165
    v_cvt_pk_bf16_f32 v83, v166, v167
    v_accvgpr_read_b32 v168, a36
    v_accvgpr_read_b32 v169, a37
    v_accvgpr_read_b32 v170, a38
    v_accvgpr_read_b32 v171, a39
    v_accvgpr_read_b32 v172, a52
    v_accvgpr_read_b32 v173, a53
    v_accvgpr_read_b32 v174, a54
    v_accvgpr_read_b32 v175, a55
    v_pk_mul_f32 v[168:169], v[168:169], s[84:85]
    v_pk_mul_f32 v[170:171], v[170:171], s[84:85]
    v_pk_mul_f32 v[172:173], v[172:173], s[84:85]
    v_pk_mul_f32 v[174:175], v[174:175], s[84:85]
    v_cvt_pk_bf16_f32 v84, v168, v169
    v_cvt_pk_bf16_f32 v85, v170, v171
    v_cvt_pk_bf16_f32 v86, v172, v173
    v_cvt_pk_bf16_f32 v87, v174, v175
    buffer_load_dwordx4 v2, s[36:39], s92 offen offset:3072 sc1 lds
    v_accvgpr_read_b32 v176, a40
    v_accvgpr_read_b32 v177, a41
    v_accvgpr_read_b32 v178, a42
    v_accvgpr_read_b32 v179, a43
    v_accvgpr_read_b32 v180, a56
    v_accvgpr_read_b32 v181, a57
    v_accvgpr_read_b32 v182, a58
    v_accvgpr_read_b32 v183, a59
    v_pk_mul_f32 v[176:177], v[176:177], s[84:85]
    v_pk_mul_f32 v[178:179], v[178:179], s[84:85]
    v_pk_mul_f32 v[180:181], v[180:181], s[84:85]
    v_pk_mul_f32 v[182:183], v[182:183], s[84:85]
    v_cvt_pk_bf16_f32 v88, v176, v177
    v_cvt_pk_bf16_f32 v89, v178, v179
    v_cvt_pk_bf16_f32 v90, v180, v181
    v_cvt_pk_bf16_f32 v91, v182, v183
    v_accvgpr_read_b32 v184, a44
    v_accvgpr_read_b32 v185, a45
    v_accvgpr_read_b32 v186, a46
    v_accvgpr_read_b32 v187, a47
    v_accvgpr_read_b32 v188, a60
    v_accvgpr_read_b32 v189, a61
    v_accvgpr_read_b32 v190, a62
    v_accvgpr_read_b32 v191, a63
    v_pk_mul_f32 v[184:185], v[184:185], s[84:85]
    v_pk_mul_f32 v[186:187], v[186:187], s[84:85]
    v_pk_mul_f32 v[188:189], v[188:189], s[84:85]
    v_pk_mul_f32 v[190:191], v[190:191], s[84:85]
    v_cvt_pk_bf16_f32 v92, v184, v185
    v_cvt_pk_bf16_f32 v93, v186, v187
    v_cvt_pk_bf16_f32 v94, v188, v189
    v_cvt_pk_bf16_f32 v95, v190, v191
    s_add_u32 m0, s93, 4096
    s_nop 0
    buffer_load_dwordx4 v4, s[36:39], s92 offen offset:0 sc1 lds
    v_accvgpr_read_b32 v160, a64
    v_accvgpr_read_b32 v161, a65
    v_accvgpr_read_b32 v162, a66
    v_accvgpr_read_b32 v163, a67
    v_accvgpr_read_b32 v164, a80
    v_accvgpr_read_b32 v165, a81
    v_accvgpr_read_b32 v166, a82
    v_accvgpr_read_b32 v167, a83
    v_pk_mul_f32 v[160:161], v[160:161], s[84:85]
    v_pk_mul_f32 v[162:163], v[162:163], s[84:85]
    v_pk_mul_f32 v[164:165], v[164:165], s[84:85]
    v_pk_mul_f32 v[166:167], v[166:167], s[84:85]
    v_cvt_pk_bf16_f32 v96, v160, v161
    v_cvt_pk_bf16_f32 v97, v162, v163
    v_cvt_pk_bf16_f32 v98, v164, v165
    v_cvt_pk_bf16_f32 v99, v166, v167
    v_accvgpr_read_b32 v168, a68
    v_accvgpr_read_b32 v169, a69
    v_accvgpr_read_b32 v170, a70
    v_accvgpr_read_b32 v171, a71
    v_accvgpr_read_b32 v172, a84
    v_accvgpr_read_b32 v173, a85
    v_accvgpr_read_b32 v174, a86
    v_accvgpr_read_b32 v175, a87
    v_pk_mul_f32 v[168:169], v[168:169], s[84:85]
    v_pk_mul_f32 v[170:171], v[170:171], s[84:85]
    v_pk_mul_f32 v[172:173], v[172:173], s[84:85]
    v_pk_mul_f32 v[174:175], v[174:175], s[84:85]
    v_cvt_pk_bf16_f32 v100, v168, v169
    v_cvt_pk_bf16_f32 v101, v170, v171
    v_cvt_pk_bf16_f32 v102, v172, v173
    v_cvt_pk_bf16_f32 v103, v174, v175
    buffer_load_dwordx4 v4, s[36:39], s92 offen offset:1024 sc1 lds
    v_accvgpr_read_b32 v176, a72
    v_accvgpr_read_b32 v177, a73
    v_accvgpr_read_b32 v178, a74
    v_accvgpr_read_b32 v179, a75
    v_accvgpr_read_b32 v180, a88
    v_accvgpr_read_b32 v181, a89
    v_accvgpr_read_b32 v182, a90
    v_accvgpr_read_b32 v183, a91
    v_pk_mul_f32 v[176:177], v[176:177], s[84:85]
    v_pk_mul_f32 v[178:179], v[178:179], s[84:85]
    v_pk_mul_f32 v[180:181], v[180:181], s[84:85]
    v_pk_mul_f32 v[182:183], v[182:183], s[84:85]
    v_cvt_pk_bf16_f32 v104, v176, v177
    v_cvt_pk_bf16_f32 v105, v178, v179
    v_cvt_pk_bf16_f32 v106, v180, v181
    v_cvt_pk_bf16_f32 v107, v182, v183
    v_accvgpr_read_b32 v184, a76
    v_accvgpr_read_b32 v185, a77
    v_accvgpr_read_b32 v186, a78
    v_accvgpr_read_b32 v187, a79
    v_accvgpr_read_b32 v188, a92
    v_accvgpr_read_b32 v189, a93
    v_accvgpr_read_b32 v190, a94
    v_accvgpr_read_b32 v191, a95
    v_pk_mul_f32 v[184:185], v[184:185], s[84:85]
    v_pk_mul_f32 v[186:187], v[186:187], s[84:85]
    v_pk_mul_f32 v[188:189], v[188:189], s[84:85]
    v_pk_mul_f32 v[190:191], v[190:191], s[84:85]
    v_cvt_pk_bf16_f32 v108, v184, v185
    v_cvt_pk_bf16_f32 v109, v186, v187
    v_cvt_pk_bf16_f32 v110, v188, v189
    v_cvt_pk_bf16_f32 v111, v190, v191
    buffer_load_dwordx4 v4, s[36:39], s92 offen offset:2048 sc1 lds
    v_accvgpr_read_b32 v160, a96
    v_accvgpr_read_b32 v161, a97
    v_accvgpr_read_b32 v162, a98
    v_accvgpr_read_b32 v163, a99
    v_accvgpr_read_b32 v164, a112
    v_accvgpr_read_b32 v165, a113
    v_accvgpr_read_b32 v166, a114
    v_accvgpr_read_b32 v167, a115
    v_pk_mul_f32 v[160:161], v[160:161], s[84:85]
    v_pk_mul_f32 v[162:163], v[162:163], s[84:85]
    v_pk_mul_f32 v[164:165], v[164:165], s[84:85]
    v_pk_mul_f32 v[166:167], v[166:167], s[84:85]
    v_cvt_pk_bf16_f32 v112, v160, v161
    v_cvt_pk_bf16_f32 v113, v162, v163
    v_cvt_pk_bf16_f32 v114, v164, v165
    v_cvt_pk_bf16_f32 v115, v166, v167
    v_accvgpr_read_b32 v168, a100
    v_accvgpr_read_b32 v169, a101
    v_accvgpr_read_b32 v170, a102
    v_accvgpr_read_b32 v171, a103
    v_accvgpr_read_b32 v172, a116
    v_accvgpr_read_b32 v173, a117
    v_accvgpr_read_b32 v174, a118
    v_accvgpr_read_b32 v175, a119
    v_pk_mul_f32 v[168:169], v[168:169], s[84:85]
    v_pk_mul_f32 v[170:171], v[170:171], s[84:85]
    v_pk_mul_f32 v[172:173], v[172:173], s[84:85]
    v_pk_mul_f32 v[174:175], v[174:175], s[84:85]
    v_cvt_pk_bf16_f32 v116, v168, v169
    v_cvt_pk_bf16_f32 v117, v170, v171
    v_cvt_pk_bf16_f32 v118, v172, v173
    v_cvt_pk_bf16_f32 v119, v174, v175
    buffer_load_dwordx4 v4, s[36:39], s92 offen offset:3072 sc1 lds
    s_add_u32 s92, s92, 33792
    s_add_u32 s93, s93, 32768
    s_and_b32 s93, s93, 0x1ffff
    v_accvgpr_read_b32 v176, a104
    v_accvgpr_read_b32 v177, a105
    v_accvgpr_read_b32 v178, a106
    v_accvgpr_read_b32 v179, a107
    v_accvgpr_read_b32 v180, a120
    v_accvgpr_read_b32 v181, a121
    v_accvgpr_read_b32 v182, a122
    v_accvgpr_read_b32 v183, a123
    v_pk_mul_f32 v[176:177], v[176:177], s[84:85]
    v_pk_mul_f32 v[178:179], v[178:179], s[84:85]
    v_pk_mul_f32 v[180:181], v[180:181], s[84:85]
    v_pk_mul_f32 v[182:183], v[182:183], s[84:85]
    v_cvt_pk_bf16_f32 v120, v176, v177
    v_cvt_pk_bf16_f32 v121, v178, v179
    v_cvt_pk_bf16_f32 v122, v180, v181
    v_cvt_pk_bf16_f32 v123, v182, v183
    v_accvgpr_read_b32 v184, a108
    v_accvgpr_read_b32 v185, a109
    v_accvgpr_read_b32 v186, a110
    v_accvgpr_read_b32 v187, a111
    v_accvgpr_read_b32 v188, a124
    v_accvgpr_read_b32 v189, a125
    v_accvgpr_read_b32 v190, a126
    v_accvgpr_read_b32 v191, a127
    v_pk_mul_f32 v[184:185], v[184:185], s[84:85]
    v_pk_mul_f32 v[186:187], v[186:187], s[84:85]
    v_pk_mul_f32 v[188:189], v[188:189], s[84:85]
    v_pk_mul_f32 v[190:191], v[190:191], s[84:85]
    v_cvt_pk_bf16_f32 v124, v184, v185
    v_cvt_pk_bf16_f32 v125, v186, v187
    v_cvt_pk_bf16_f32 v126, v188, v189
    v_cvt_pk_bf16_f32 v127, v190, v191
    v_add_u32 v36, s72, v2
    v_add_u32 v37, s73, v2
    v_add_u32 v38, s74, v2
    v_add_u32 v39, s75, v2
    v_and_b32 v34, 15, v1
    v_lshrrev_b32 v35, 4, v1
    v_mul_u32_u24 v34, 1280, v34
    v_lshl_add_u32 v43, v35, 3, v34
    s_lshl_b32 s86, s30, 13
    s_add_u32 s84, s86, s62
    s_xor_b32 s85, s84, 0x10000
    s_add_u32 s86, s86, 0x20000
    s_bfe_u32 s44, s40, 0x40000
    s_mul_i32 s44, s44, 163840
    s_bfe_u32 s45, s40, 0x40004
    s_mul_i32 s45, s45, 163840
    s_bfe_u32 s46, s40, 0x40008
    s_mul_i32 s46, s46, 163840
    s_bfe_u32 s47, s40, 0x4000c
    s_mul_i32 s47, s47, 163840
    s_bfe_u32 s48, s40, 0x40010
    s_mul_i32 s48, s48, 163840
    s_bfe_u32 s49, s40, 0x40014
    s_mul_i32 s49, s49, 163840
    s_bfe_u32 s50, s40, 0x40018
    s_mul_i32 s50, s50, 163840
    s_bfe_u32 s51, s40, 0x4001c
    s_mul_i32 s51, s51, 163840
    s_add_u32 s74, s63, 8192
    s_cmp_eq_u32 s41, 0
    s_cselect_b32 s43, s47, 0x40000000
    v_mov_b32 v5, 3
    s_mov_b32 s94, 32768
    v_mov_b32 v3, v2
    s_lshl_b32 s95, s32, 1
    s_waitcnt vmcnt(32)
    s_barrier
    ds_read_b128 a[128:131], v3 offset:16384
    ds_read_b128 a[132:135], v3 offset:17408
    ds_read_b128 a[136:139], v3 offset:18432
    ds_read_b128 a[140:143], v3 offset:19456
    ds_read_b128 a[144:147], v3 offset:20480
    ds_read_b128 a[148:151], v3 offset:21504
    ds_read_b128 a[152:155], v3 offset:22528
    ds_read_b128 a[156:159], v3 offset:23552
    ds_read_b128 a[160:163], v3 offset:24576
    ds_read_b128 a[164:167], v3 offset:25600
    ds_read_b128 a[168:171], v3 offset:26624
    ds_read_b128 a[172:175], v3 offset:27648
    ds_read_b128 a[176:179], v3 offset:28672
    ds_read_b128 a[180:183], v3 offset:29696
    ds_read_b128 a[184:187], v3 offset:30720
    ds_read_b128 a[188:191], v3 offset:31744
    v_accvgpr_write_b32 a0, 0
    v_accvgpr_write_b32 a1, 0
    v_accvgpr_write_b32 a2, 0
    v_accvgpr_write_b32 a3, 0
    v_accvgpr_write_b32 a4, 0
    v_accvgpr_write_b32 a5, 0
    v_accvgpr_write_b32 a6, 0
    v_accvgpr_write_b32 a7, 0
    v_accvgpr_write_b32 a8, 0
    v_accvgpr_write_b32 a9, 0
    v_accvgpr_write_b32 a10, 0
    v_accvgpr_write_b32 a11, 0
    v_accvgpr_write_b32 a12, 0
    v_accvgpr_write_b32 a13, 0
    v_accvgpr_write_b32 a14, 0
    v_accvgpr_write_b32 a15, 0
    v_accvgpr_write_b32 a16, 0
    v_accvgpr_write_b32 a17, 0
    v_accvgpr_write_b32 a18, 0
    v_accvgpr_write_b32 a19, 0
    v_accvgpr_write_b32 a20, 0
    v_accvgpr_write_b32 a21, 0
    v_accvgpr_write_b32 a22, 0
    v_accvgpr_write_b32 a23, 0
    v_accvgpr_write_b32 a24, 0
    v_accvgpr_write_b32 a25, 0
    v_accvgpr_write_b32 a26, 0
    v_accvgpr_write_b32 a27, 0
    v_accvgpr_write_b32 a28, 0
    v_accvgpr_write_b32 a29, 0
    v_accvgpr_write_b32 a30, 0
    v_accvgpr_write_b32 a31, 0
    s_cmp_eq_u32 s32, 0
    s_waitcnt lgkmcnt(0)
    s_cbranch_scc1 AT_p0
    v_mfma_f32_16x16x32_bf16 v[160:163], a[128:131], v[64:67], 0
    v_accvgpr_write_b32 a32, 0
    v_accvgpr_write_b32 a33, 0
    v_mfma_f32_16x16x32_bf16 v[164:167], a[128:131], v[68:71], 0
    v_accvgpr_write_b32 a34, 0
    v_accvgpr_write_b32 a35, 0
    v_mfma_f32_16x16x32_bf16 v[160:163], a[132:135], v[80:83], v[160:163]
    v_accvgpr_write_b32 a36, 0
    v_accvgpr_write_b32 a37, 0
    v_mfma_f32_16x16x32_bf16 v[164:167], a[132:135], v[84:87], v[164:167]
    v_accvgpr_write_b32 a38, 0
    v_accvgpr_write_b32 a39, 0
    v_mfma_f32_16x16x32_bf16 v[160:163], a[136:139], v[96:99], v[160:163]
    v_accvgpr_write_b32 a40, 0
    v_accvgpr_write_b32 a41, 0
    v_mfma_f32_16x16x32_bf16 v[164:167], a[136:139], v[100:103], v[164:167]
    v_accvgpr_write_b32 a42, 0
    v_accvgpr_write_b32 a43, 0
    v_mfma_f32_16x16x32_bf16 v[160:163], a[140:143], v[112:115], v[160:163]
    v_accvgpr_write_b32 a44, 0
    v_accvgpr_write_b32 a45, 0
    v_mfma_f32_16x16x32_bf16 v[164:167], a[140:143], v[116:119], v[164:167]
    v_accvgpr_write_b32 a46, 0
    v_accvgpr_write_b32 a47, 0
    v_mfma_f32_16x16x32_bf16 v[168:171], a[144:147], v[64:67], 0
    v_accvgpr_write_b32 a48, 0
    v_accvgpr_write_b32 a49, 0
    v_mfma_f32_16x16x32_bf16 v[172:175], a[144:147], v[68:71], 0
    v_accvgpr_write_b32 a50, 0
    v_accvgpr_write_b32 a51, 0
    v_mfma_f32_16x16x32_bf16 v[168:171], a[148:151], v[80:83], v[168:171]
    v_accvgpr_write_b32 a52, 0
    v_accvgpr_write_b32 a53, 0
    v_mfma_f32_16x16x32_bf16 v[172:175], a[148:151], v[84:87], v[172:175]
    v_accvgpr_write_b32 a54, 0
    v_accvgpr_write_b32 a55, 0
    v_mfma_f32_16x16x32_bf16 v[168:171], a[152:155], v[96:99], v[168:171]
    v_accvgpr_write_b32 a56, 0
    v_accvgpr_write_b32 a57, 0
    v_mfma_f32_16x16x32_bf16 v[172:175], a[152:155], v[100:103], v[172:175]
    v_accvgpr_write_b32 a58, 0
    v_accvgpr_write_b32 a59, 0
    v_mfma_f32_16x16x32_bf16 v[168:171], a[156:159], v[112:115], v[168:171]
    v_accvgpr_write_b32 a60, 0
    v_accvgpr_write_b32 a61, 0
    v_mfma_f32_16x16x32_bf16 v[172:175], a[156:159], v[116:119], v[172:175]
    v_accvgpr_write_b32 a62, 0
    v_accvgpr_write_b32 a63, 0
    v_mfma_f32_16x16x32_bf16 v[176:179], a[128:131], v[72:75], 0
    v_accvgpr_write_b32 a64, 0
    v_accvgpr_write_b32 a65, 0
    v_mfma_f32_16x16x32_bf16 v[180:183], a[128:131], v[76:79], 0
    v_accvgpr_write_b32 a66, 0
    v_accvgpr_write_b32 a67, 0
    v_mfma_f32_16x16x32_bf16 v[176:179], a[132:135], v[88:91], v[176:179]
    v_accvgpr_write_b32 a68, 0
    v_accvgpr_write_b32 a69, 0
    v_mfma_f32_16x16x32_bf16 v[180:183], a[132:135], v[92:95], v[180:183]
    v_accvgpr_write_b32 a70, 0
    v_accvgpr_write_b32 a71, 0
    v_mfma_f32_16x16x32_bf16 v[176:179], a[136:139], v[104:107], v[176:179]
    v_accvgpr_write_b32 a72, 0
    v_accvgpr_write_b32 a73, 0
    v_mfma_f32_16x16x32_bf16 v[180:183], a[136:139], v[108:111], v[180:183]
    v_accvgpr_write_b32 a74, 0
    v_accvgpr_write_b32 a75, 0
    v_mfma_f32_16x16x32_bf16 v[176:179], a[140:143], v[120:123], v[176:179]
    v_accvgpr_write_b32 a76, 0
    v_accvgpr_write_b32 a77, 0
    v_mfma_f32_16x16x32_bf16 v[180:183], a[140:143], v[124:127], v[180:183]
    v_accvgpr_write_b32 a78, 0
    v_accvgpr_write_b32 a79, 0
    v_mfma_f32_16x16x32_bf16 v[184:187], a[144:147], v[72:75], 0
    v_accvgpr_write_b32 a80, 0
    v_accvgpr_write_b32 a81, 0
    v_mfma_f32_16x16x32_bf16 v[188:191], a[144:147], v[76:79], 0
    v_accvgpr_write_b32 a82, 0
    v_accvgpr_write_b32 a83, 0
    v_mfma_f32_16x16x32_bf16 v[184:187], a[148:151], v[88:91], v[184:187]
    v_accvgpr_write_b32 a84, 0
    v_accvgpr_write_b32 a85, 0
    v_mfma_f32_16x16x32_bf16 v[188:191], a[148:151], v[92:95], v[188:191]
    v_accvgpr_write_b32 a86, 0
    v_accvgpr_write_b32 a87, 0
    v_mfma_f32_16x16x32_bf16 v[184:187], a[152:155], v[104:107], v[184:187]
    v_accvgpr_write_b32 a88, 0
    v_accvgpr_write_b32 a89, 0
    v_mfma_f32_16x16x32_bf16 v[188:191], a[152:155], v[108:111], v[188:191]
    v_accvgpr_write_b32 a90, 0
    v_accvgpr_write_b32 a91, 0
    v_mfma_f32_16x16x32_bf16 v[184:187], a[156:159], v[120:123], v[184:187]
    v_accvgpr_write_b32 a92, 0
    v_accvgpr_write_b32 a93, 0
    v_mfma_f32_16x16x32_bf16 v[188:191], a[156:159], v[124:127], v[188:191]
    s_waitcnt vmcnt(21) lgkmcnt(0)
    v_accvgpr_write_b32 a94, 0
    v_accvgpr_write_b32 a95, 0
    v_mfma_f32_16x16x32_bf16 v[192:195], a[160:163], v[64:67], 0
    s_barrier
    v_add_u32 v3, s94, v2
    ds_read_b128 a[192:195], v3 offset:0
    ds_read_b128 a[196:199], v3 offset:1024
    ds_read_b128 a[200:203], v3 offset:2048
    ds_read_b128 a[204:207], v3 offset:3072
    v_mfma_f32_16x16x32_bf16 v[196:199], a[160:163], v[68:71], 0
    s_add_u32 s94, s94, 32768
    ds_read_b128 a[208:211], v3 offset:4096
    ds_read_b128 a[212:215], v3 offset:5120
    v_exp_f32 v160, v160
    v_mfma_f32_16x16x32_bf16 v[192:195], a[164:167], v[80:83], v[192:195]
    s_and_b32 s94, s94, 0x18000
    v_exp_f32 v161, v161
    ds_read_b128 a[216:219], v3 offset:6144
    ds_read_b128 a[220:223], v3 offset:7168
    v_mfma_f32_16x16x32_bf16 v[196:199], a[164:167], v[84:87], v[196:199]
    v_exp_f32 v162, v162
    v_exp_f32 v163, v163
    v_mfma_f32_16x16x32_bf16 v[192:195], a[168:171], v[96:99], v[192:195]
    v_cvt_pk_bf16_f32 v224, v160, v161
    v_cvt_pk_bf16_f32 v225, v162, v163
    ds_read_b128 a[128:131], v3 offset:16384
    ds_read_b128 a[132:135], v3 offset:17408
    v_mfma_f32_16x16x32_bf16 v[196:199], a[168:171], v[100:103], v[196:199]
    ds_read_b128 a[136:139], v3 offset:18432
    ds_read_b128 a[140:143], v3 offset:19456
    v_exp_f32 v164, v164
    v_mfma_f32_16x16x32_bf16 v[192:195], a[172:175], v[112:115], v[192:195]
    s_add_u32 m0, s93, 0
    v_exp_f32 v165, v165
    ds_read_b128 a[144:147], v3 offset:20480
    ds_read_b128 a[148:151], v3 offset:21504
    v_exp_f32 v166, v166
    v_mfma_f32_16x16x32_bf16 v[196:199], a[172:175], v[116:119], v[196:199]
    buffer_load_dwordx4 v2, s[36:39], s92 offen offset:0 sc1 lds
    v_exp_f32 v167, v167
    v_mfma_f32_16x16x32_bf16 v[200:203], a[176:179], v[64:67], 0
    v_cvt_pk_bf16_f32 v228, v164, v165
    v_cvt_pk_bf16_f32 v229, v166, v167
    ds_read_b128 a[152:155], v3 offset:22528
    ds_read_b128 a[156:159], v3 offset:23552
    v_mfma_f32_16x16x32_bf16 v[204:207], a[176:179], v[68:71], 0
    v_accvgpr_write_b32 a96, 0
    v_accvgpr_write_b32 a97, 0
    v_exp_f32 v168, v168
    v_mfma_f32_16x16x32_bf16 v[200:203], a[180:183], v[80:83], v[200:203]
    v_exp_f32 v169, v169
    v_accvgpr_write_b32 a98, 0
    v_accvgpr_write_b32 a99, 0
    v_mfma_f32_16x16x32_bf16 v[204:207], a[180:183], v[84:87], v[204:207]
    v_exp_f32 v170, v170
    v_exp_f32 v171, v171
    v_mfma_f32_16x16x32_bf16 v[200:203], a[184:187], v[96:99], v[200:203]
    v_cvt_pk_bf16_f32 v226, v168, v169
    v_cvt_pk_bf16_f32 v227, v170, v171
    v_accvgpr_write_b32 a100, 0
    v_accvgpr_write_b32 a101, 0
    v_accvgpr_write_b32 a102, 0
    v_accvgpr_write_b32 a103, 0
    v_mfma_f32_16x16x32_bf16 v[204:207], a[184:187], v[100:103], v[204:207]
    v_exp_f32 v172, v172
    v_exp_f32 v173, v173
    v_mfma_f32_16x16x32_bf16 v[200:203], a[188:191], v[112:115], v[200:203]
    v_accvgpr_write_b32 a104, 0
    v_accvgpr_write_b32 a105, 0
    v_exp_f32 v174, v174
    v_mfma_f32_16x16x32_bf16 v[204:207], a[188:191], v[116:119], v[204:207]
    buffer_load_dwordx4 v2, s[36:39], s92 offen offset:1024 sc1 lds
    v_exp_f32 v175, v175
    v_mfma_f32_16x16x32_bf16 v[208:211], a[160:163], v[72:75], 0
    v_cvt_pk_bf16_f32 v230, v172, v173
    v_cvt_pk_bf16_f32 v231, v174, v175
    v_accvgpr_write_b32 a106, 0
    v_accvgpr_write_b32 a107, 0
    v_mfma_f32_16x16x32_bf16 v[212:215], a[160:163], v[76:79], 0
    v_accvgpr_write_b32 a108, 0
    v_accvgpr_write_b32 a109, 0
    v_exp_f32 v176, v176
    v_mfma_f32_16x16x32_bf16 v[208:211], a[164:167], v[88:91], v[208:211]
    v_exp_f32 v177, v177
    v_accvgpr_write_b32 a110, 0
    v_accvgpr_write_b32 a111, 0
    v_mfma_f32_16x16x32_bf16 v[212:215], a[164:167], v[92:95], v[212:215]
    v_exp_f32 v178, v178
    v_exp_f32 v179, v179
    v_cvt_pk_bf16_f32 v232, v176, v177
    v_cvt_pk_bf16_f32 v233, v178, v179
    v_mfma_f32_16x16x32_bf16 v[208:211], a[168:171], v[104:107], v[208:211]
    v_accvgpr_write_b32 a112, 0
    v_accvgpr_write_b32 a113, 0
    v_accvgpr_write_b32 a114, 0
    v_accvgpr_write_b32 a115, 0
    v_mfma_f32_16x16x32_bf16 v[212:215], a[168:171], v[108:111], v[212:215]
    v_exp_f32 v180, v180
    v_exp_f32 v181, v181
    v_mfma_f32_16x16x32_bf16 v[208:211], a[172:175], v[120:123], v[208:211]
    v_accvgpr_write_b32 a116, 0
    v_accvgpr_write_b32 a117, 0
    v_exp_f32 v182, v182
    v_mfma_f32_16x16x32_bf16 v[212:215], a[172:175], v[124:127], v[212:215]
    buffer_load_dwordx4 v2, s[36:39], s92 offen offset:2048 sc1 lds
    v_exp_f32 v183, v183
    v_mfma_f32_16x16x32_bf16 v[216:219], a[176:179], v[72:75], 0
    v_cvt_pk_bf16_f32 v236, v180, v181
    v_cvt_pk_bf16_f32 v237, v182, v183
    v_accvgpr_write_b32 a118, 0
    v_accvgpr_write_b32 a119, 0
    v_mfma_f32_16x16x32_bf16 v[220:223], a[176:179], v[76:79], 0
    v_accvgpr_write_b32 a120, 0
    v_accvgpr_write_b32 a121, 0
    v_exp_f32 v184, v184
    v_exp_f32 v185, v185
    v_mfma_f32_16x16x32_bf16 v[216:219], a[180:183], v[88:91], v[216:219]
    v_accvgpr_write_b32 a122, 0
    v_accvgpr_write_b32 a123, 0
    v_exp_f32 v186, v186
    v_mfma_f32_16x16x32_bf16 v[220:223], a[180:183], v[92:95], v[220:223]
    v_exp_f32 v187, v187
    v_cvt_pk_bf16_f32 v234, v184, v185
    v_cvt_pk_bf16_f32 v235, v186, v187
    v_mfma_f32_16x16x32_bf16 v[216:219], a[184:187], v[104:107], v[216:219]
    v_accvgpr_write_b32 a124, 0
    v_accvgpr_write_b32 a125, 0
    v_exp_f32 v188, v188
    v_mfma_f32_16x16x32_bf16 v[220:223], a[184:187], v[108:111], v[220:223]
    v_exp_f32 v189, v189
    v_accvgpr_write_b32 a126, 0
    v_accvgpr_write_b32 a127, 0
    v_mfma_f32_16x16x32_bf16 v[216:219], a[188:191], v[120:123], v[216:219]
    v_exp_f32 v190, v190
    v_exp_f32 v191, v191
    v_mfma_f32_16x16x32_bf16 v[220:223], a[188:191], v[124:127], v[220:223]
    buffer_load_dwordx4 v2, s[36:39], s92 offen offset:3072 sc1 lds
    v_cvt_pk_bf16_f32 v238, v188, v189
    v_cvt_pk_bf16_f32 v239, v190, v191
    s_waitcnt lgkmcnt(0)
    s_sub_u32 s95, s95, 1
.p2align 4
AT_full:
    v_mfma_f32_16x16x32_bf16 a[0:3], a[192:195], v[224:227], a[0:3]
    ds_read_b128 a[224:227], v3 offset:8192
    ds_read_b128 a[228:231], v3 offset:9216
    v_mfma_f32_16x16x32_bf16 a[32:35], a[192:195], v[228:231], a[32:35]
    v_exp_f32 v192, v192
    v_mfma_f32_16x16x32_bf16 a[36:39], a[196:199], v[228:231], a[36:39]
    v_exp_f32 v193, v193
    v_mfma_f32_16x16x32_bf16 a[4:7], a[196:199], v[224:227], a[4:7]
    v_exp_f32 v194, v194
    v_mfma_f32_16x16x32_bf16 a[8:11], a[200:203], v[224:227], a[8:11]
    v_mfma_f32_16x16x32_bf16 a[40:43], a[200:203], v[228:231], a[40:43]
    v_exp_f32 v195, v195
    v_mfma_f32_16x16x32_bf16 a[44:47], a[204:207], v[228:231], a[44:47]
    v_cvt_pk_bf16_f32 v240, v192, v193
    v_cvt_pk_bf16_f32 v241, v194, v195
    v_mfma_f32_16x16x32_bf16 a[12:15], a[204:207], v[224:227], a[12:15]
    ds_read_b128 a[232:235], v3 offset:10240
    ds_read_b128 a[236:239], v3 offset:11264
    v_mfma_f32_16x16x32_bf16 a[16:19], a[208:211], v[224:227], a[16:19]
    v_mfma_f32_16x16x32_bf16 a[48:51], a[208:211], v[228:231], a[48:51]
    v_exp_f32 v196, v196
    v_mfma_f32_16x16x32_bf16 a[52:55], a[212:215], v[228:231], a[52:55]
    v_exp_f32 v197, v197
    v_mfma_f32_16x16x32_bf16 a[20:23], a[212:215], v[224:227], a[20:23]
    v_exp_f32 v198, v198
    v_mfma_f32_16x16x32_bf16 a[24:27], a[216:219], v[224:227], a[24:27]
    v_exp_f32 v199, v199
    v_mfma_f32_16x16x32_bf16 a[56:59], a[216:219], v[228:231], a[56:59]
    s_add_u32 m0, s93, 4096
    v_mfma_f32_16x16x32_bf16 a[60:63], a[220:223], v[228:231], a[60:63]
    s_add_u32 s93, s93, 32768
    buffer_load_dwordx4 v4, s[36:39], s92 offen offset:0 sc1 lds
    v_mfma_f32_16x16x32_bf16 a[28:31], a[220:223], v[224:227], a[28:31]
    s_and_b32 s93, s93, 0x1ffff
    v_cvt_pk_bf16_f32 v244, v196, v197
    v_cvt_pk_bf16_f32 v245, v198, v199
    v_mfma_f32_16x16x32_bf16 v[8:11], v[24:27], v[224:227], v[8:11]
    ds_read_b128 a[240:243], v3 offset:12288
    ds_read_b128 a[244:247], v3 offset:13312
    v_mfma_f32_16x16x32_bf16 v[12:15], v[24:27], v[228:231], v[12:15]
    v_mfma_f32_16x16x32_bf16 a[64:67], a[192:195], v[232:235], a[64:67]
    v_exp_f32 v200, v200
    v_mfma_f32_16x16x32_bf16 a[96:99], a[192:195], v[236:239], a[96:99]
    v_exp_f32 v201, v201
    v_mfma_f32_16x16x32_bf16 a[100:103], a[196:199], v[236:239], a[100:103]
    v_exp_f32 v202, v202
    v_mfma_f32_16x16x32_bf16 a[68:71], a[196:199], v[232:235], a[68:71]
    v_exp_f32 v203, v203
    v_mfma_f32_16x16x32_bf16 a[72:75], a[200:203], v[232:235], a[72:75]
    v_mfma_f32_16x16x32_bf16 a[104:107], a[200:203], v[236:239], a[104:107]
    v_cvt_pk_bf16_f32 v242, v200, v201
    v_cvt_pk_bf16_f32 v243, v202, v203
    v_mfma_f32_16x16x32_bf16 a[108:111], a[204:207], v[236:239], a[108:111]
    ds_read_b128 a[248:251], v3 offset:14336
    ds_read_b128 a[252:255], v3 offset:15360
    v_mfma_f32_16x16x32_bf16 a[76:79], a[204:207], v[232:235], a[76:79]
    v_exp_f32 v204, v204
    v_mfma_f32_16x16x32_bf16 a[80:83], a[208:211], v[232:235], a[80:83]
    v_mfma_f32_16x16x32_bf16 a[112:115], a[208:211], v[236:239], a[112:115]
    v_exp_f32 v205, v205
    v_mfma_f32_16x16x32_bf16 a[116:119], a[212:215], v[236:239], a[116:119]
    v_exp_f32 v206, v206
    v_mfma_f32_16x16x32_bf16 a[84:87], a[212:215], v[232:235], a[84:87]
    v_exp_f32 v207, v207
    v_mfma_f32_16x16x32_bf16 a[88:91], a[216:219], v[232:235], a[88:91]
    buffer_load_dwordx4 v4, s[36:39], s92 offen offset:1024 sc1 lds
    v_mfma_f32_16x16x32_bf16 a[120:123], a[216:219], v[236:239], a[120:123]
    v_mfma_f32_16x16x32_bf16 a[124:127], a[220:223], v[236:239], a[124:127]
    v_cvt_pk_bf16_f32 v246, v204, v205
    v_cvt_pk_bf16_f32 v247, v206, v207
    v_mfma_f32_16x16x32_bf16 a[92:95], a[220:223], v[232:235], a[92:95]
    ds_read_b128 a[160:163], v3 offset:24576
    ds_read_b128 a[164:167], v3 offset:25600
    v_mfma_f32_16x16x32_bf16 v[16:19], v[24:27], v[232:235], v[16:19]
    v_exp_f32 v208, v208
    v_mfma_f32_16x16x32_bf16 v[20:23], v[24:27], v[236:239], v[20:23]
    v_mfma_f32_16x16x32_bf16 v[160:163], a[128:131], v[64:67], 0
    v_exp_f32 v209, v209
    v_mfma_f32_16x16x32_bf16 v[164:167], a[128:131], v[68:71], 0
    v_exp_f32 v210, v210
    v_mfma_f32_16x16x32_bf16 v[160:163], a[132:135], v[80:83], v[160:163]
    v_exp_f32 v211, v211
    v_mfma_f32_16x16x32_bf16 v[164:167], a[132:135], v[84:87], v[164:167]
    v_cvt_pk_bf16_f32 v248, v208, v209
    v_cvt_pk_bf16_f32 v249, v210, v211
    v_mfma_f32_16x16x32_bf16 v[160:163], a[136:139], v[96:99], v[160:163]
    v_mfma_f32_16x16x32_bf16 v[164:167], a[136:139], v[100:103], v[164:167]
    ds_read_b128 a[168:171], v3 offset:26624
    ds_read_b128 a[172:175], v3 offset:27648
    v_mfma_f32_16x16x32_bf16 v[160:163], a[140:143], v[112:115], v[160:163]
    v_exp_f32 v212, v212
    v_mfma_f32_16x16x32_bf16 v[164:167], a[140:143], v[116:119], v[164:167]
    v_exp_f32 v213, v213
    v_mfma_f32_16x16x32_bf16 v[168:171], a[144:147], v[64:67], 0
    v_mfma_f32_16x16x32_bf16 v[172:175], a[144:147], v[68:71], 0
    v_exp_f32 v214, v214
    v_mfma_f32_16x16x32_bf16 v[168:171], a[148:151], v[80:83], v[168:171]
    v_exp_f32 v215, v215
    v_mfma_f32_16x16x32_bf16 v[172:175], a[148:151], v[84:87], v[172:175]
    buffer_load_dwordx4 v4, s[36:39], s92 offen offset:2048 sc1 lds
    v_mfma_f32_16x16x32_bf16 v[168:171], a[152:155], v[96:99], v[168:171]
    v_cvt_pk_bf16_f32 v252, v212, v213
    v_cvt_pk_bf16_f32 v253, v214, v215
    v_mfma_f32_16x16x32_bf16 v[172:175], a[152:155], v[100:103], v[172:175]
    v_mfma_f32_16x16x32_bf16 v[168:171], a[156:159], v[112:115], v[168:171]
    ds_read_b128 a[176:179], v3 offset:28672
    ds_read_b128 a[180:183], v3 offset:29696
    v_mfma_f32_16x16x32_bf16 v[172:175], a[156:159], v[116:119], v[172:175]
    v_exp_f32 v216, v216
    v_mfma_f32_16x16x32_bf16 v[176:179], a[128:131], v[72:75], 0
    v_exp_f32 v217, v217
    v_mfma_f32_16x16x32_bf16 v[180:183], a[128:131], v[76:79], 0
    v_mfma_f32_16x16x32_bf16 v[176:179], a[132:135], v[88:91], v[176:179]
    v_exp_f32 v218, v218
    v_mfma_f32_16x16x32_bf16 v[180:183], a[132:135], v[92:95], v[180:183]
    v_exp_f32 v219, v219
    v_mfma_f32_16x16x32_bf16 v[176:179], a[136:139], v[104:107], v[176:179]
    v_cvt_pk_bf16_f32 v250, v216, v217
    v_cvt_pk_bf16_f32 v251, v218, v219
    v_mfma_f32_16x16x32_bf16 v[180:183], a[136:139], v[108:111], v[180:183]
    ds_read_b128 a[184:187], v3 offset:30720
    ds_read_b128 a[188:191], v3 offset:31744
    v_mfma_f32_16x16x32_bf16 v[176:179], a[140:143], v[120:123], v[176:179]
    v_mfma_f32_16x16x32_bf16 v[180:183], a[140:143], v[124:127], v[180:183]
    v_exp_f32 v220, v220
    v_mfma_f32_16x16x32_bf16 v[184:187], a[144:147], v[72:75], 0
    v_exp_f32 v221, v221
    v_mfma_f32_16x16x32_bf16 v[188:191], a[144:147], v[76:79], 0
    v_exp_f32 v222, v222
    v_mfma_f32_16x16x32_bf16 v[184:187], a[148:151], v[88:91], v[184:187]
    v_mfma_f32_16x16x32_bf16 v[188:191], a[148:151], v[92:95], v[188:191]
    v_exp_f32 v223, v223
    v_mfma_f32_16x16x32_bf16 v[184:187], a[152:155], v[104:107], v[184:187]
    buffer_load_dwordx4 v4, s[36:39], s92 offen offset:3072 sc1 lds
    v_mfma_f32_16x16x32_bf16 v[188:191], a[152:155], v[108:111], v[188:191]
    s_add_u32 s92, s92, 33792
    v_cvt_pk_bf16_f32 v254, v220, v221
    v_cvt_pk_bf16_f32 v255, v222, v223
    v_mfma_f32_16x16x32_bf16 v[184:187], a[156:159], v[120:123], v[184:187]
    v_mfma_f32_16x16x32_bf16 v[188:191], a[156:159], v[124:127], v[188:191]
    s_waitcnt vmcnt(16) lgkmcnt(0)
    v_mfma_f32_16x16x32_bf16 a[0:3], a[224:227], v[240:243], a[0:3]
    s_barrier
    v_add_u32 v3, s94, v2
    v_mfma_f32_16x16x32_bf16 a[32:35], a[224:227], v[244:247], a[32:35]
    s_add_u32 s94, s94, 32768
    ds_read_b128 a[192:195], v3 offset:0
    ds_read_b128 a[196:199], v3 offset:1024
    v_mfma_f32_16x16x32_bf16 a[36:39], a[228:231], v[244:247], a[36:39]
    s_and_b32 s94, s94, 0x18000
    ds_read_b128 a[200:203], v3 offset:2048
    ds_read_b128 a[204:207], v3 offset:3072
    v_mfma_f32_16x16x32_bf16 a[4:7], a[228:231], v[240:243], a[4:7]
    v_exp_f32 v160, v160
    v_mfma_f32_16x16x32_bf16 a[8:11], a[232:235], v[240:243], a[8:11]
    v_exp_f32 v161, v161
    v_mfma_f32_16x16x32_bf16 a[40:43], a[232:235], v[244:247], a[40:43]
    v_mfma_f32_16x16x32_bf16 a[44:47], a[236:239], v[244:247], a[44:47]
    v_exp_f32 v162, v162
    v_mfma_f32_16x16x32_bf16 a[12:15], a[236:239], v[240:243], a[12:15]
    v_exp_f32 v163, v163
    v_mfma_f32_16x16x32_bf16 a[16:19], a[240:243], v[240:243], a[16:19]
    v_cvt_pk_bf16_f32 v224, v160, v161
    v_cvt_pk_bf16_f32 v225, v162, v163
    v_mfma_f32_16x16x32_bf16 a[48:51], a[240:243], v[244:247], a[48:51]
    ds_read_b128 a[208:211], v3 offset:4096
    ds_read_b128 a[212:215], v3 offset:5120
    v_mfma_f32_16x16x32_bf16 a[52:55], a[244:247], v[244:247], a[52:55]
    v_mfma_f32_16x16x32_bf16 a[20:23], a[244:247], v[240:243], a[20:23]
    v_exp_f32 v164, v164
    v_mfma_f32_16x16x32_bf16 a[24:27], a[248:251], v[240:243], a[24:27]
    v_exp_f32 v165, v165
    v_mfma_f32_16x16x32_bf16 a[56:59], a[248:251], v[244:247], a[56:59]
    v_exp_f32 v166, v166
    v_mfma_f32_16x16x32_bf16 a[60:63], a[252:255], v[244:247], a[60:63]
    v_exp_f32 v167, v167
    v_mfma_f32_16x16x32_bf16 a[28:31], a[252:255], v[240:243], a[28:31]
    v_mfma_f32_16x16x32_bf16 v[8:11], v[24:27], v[240:243], v[8:11]
    buffer_store_dword v5, v0, s[76:79], 0 offen sc1
    v_mfma_f32_16x16x32_bf16 v[12:15], v[24:27], v[244:247], v[12:15]
    v_cvt_pk_bf16_f32 v228, v164, v165
    v_cvt_pk_bf16_f32 v229, v166, v167
    v_mfma_f32_16x16x32_bf16 a[64:67], a[224:227], v[248:251], a[64:67]
    ds_read_b128 a[216:219], v3 offset:6144
    ds_read_b128 a[220:223], v3 offset:7168
    v_mfma_f32_16x16x32_bf16 a[96:99], a[224:227], v[252:255], a[96:99]
    v_exp_f32 v168, v168
    v_mfma_f32_16x16x32_bf16 a[100:103], a[228:231], v[252:255], a[100:103]
    v_mfma_f32_16x16x32_bf16 a[68:71], a[228:231], v[248:251], a[68:71]
    v_exp_f32 v169, v169
    v_mfma_f32_16x16x32_bf16 a[72:75], a[232:235], v[248:251], a[72:75]
    v_exp_f32 v170, v170
    v_mfma_f32_16x16x32_bf16 a[104:107], a[232:235], v[252:255], a[104:107]
    v_exp_f32 v171, v171
    v_mfma_f32_16x16x32_bf16 a[108:111], a[236:239], v[252:255], a[108:111]
    v_cvt_pk_bf16_f32 v226, v168, v169
    v_cvt_pk_bf16_f32 v227, v170, v171
    v_mfma_f32_16x16x32_bf16 a[76:79], a[236:239], v[248:251], a[76:79]
    v_mfma_f32_16x16x32_bf16 a[80:83], a[240:243], v[248:251], a[80:83]
    ds_read_b128 a[128:131], v3 offset:16384
    ds_read_b128 a[132:135], v3 offset:17408
    v_mfma_f32_16x16x32_bf16 a[112:115], a[240:243], v[252:255], a[112:115]
    v_exp_f32 v172, v172
    v_mfma_f32_16x16x32_bf16 a[116:119], a[244:247], v[252:255], a[116:119]
    v_exp_f32 v173, v173
    v_mfma_f32_16x16x32_bf16 a[84:87], a[244:247], v[248:251], a[84:87]
    v_exp_f32 v174, v174
    v_mfma_f32_16x16x32_bf16 a[88:91], a[248:251], v[248:251], a[88:91]
    v_mfma_f32_16x16x32_bf16 a[120:123], a[248:251], v[252:255], a[120:123]
    s_add_u32 m0, s93, 0
    v_exp_f32 v175, v175
    v_mfma_f32_16x16x32_bf16 a[124:127], a[252:255], v[252:255], a[124:127]
    buffer_load_dwordx4 v2, s[36:39], s92 offen offset:0 sc1 lds
    v_mfma_f32_16x16x32_bf16 a[92:95], a[252:255], v[248:251], a[92:95]
    v_cvt_pk_bf16_f32 v230, v172, v173
    v_cvt_pk_bf16_f32 v231, v174, v175
    v_mfma_f32_16x16x32_bf16 v[16:19], v[24:27], v[248:251], v[16:19]
    ds_read_b128 a[136:139], v3 offset:18432
    ds_read_b128 a[140:143], v3 offset:19456
    v_mfma_f32_16x16x32_bf16 v[20:23], v[24:27], v[252:255], v[20:23]
    v_exp_f32 v176, v176
    v_mfma_f32_16x16x32_bf16 v[192:195], a[160:163], v[64:67], 0
    v_mfma_f32_16x16x32_bf16 v[196:199], a[160:163], v[68:71], 0
    v_exp_f32 v177, v177
    v_mfma_f32_16x16x32_bf16 v[192:195], a[164:167], v[80:83], v[192:195]
    v_exp_f32 v178, v178
    v_mfma_f32_16x16x32_bf16 v[196:199], a[164:167], v[84:87], v[196:199]
    v_exp_f32 v179, v179
    v_mfma_f32_16x16x32_bf16 v[192:195], a[168:171], v[96:99], v[192:195]
    buffer_load_dwordx4 v2, s[36:39], s92 offen offset:1024 sc1 lds
    v_mfma_f32_16x16x32_bf16 v[196:199], a[168:171], v[100:103], v[196:199]
    v_mfma_f32_16x16x32_bf16 v[192:195], a[172:175], v[112:115], v[192:195]
    v_cvt_pk_bf16_f32 v232, v176, v177
    v_cvt_pk_bf16_f32 v233, v178, v179
    v_mfma_f32_16x16x32_bf16 v[196:199], a[172:175], v[116:119], v[196:199]
    ds_read_b128 a[144:147], v3 offset:20480
    ds_read_b128 a[148:151], v3 offset:21504
    v_mfma_f32_16x16x32_bf16 v[200:203], a[176:179], v[64:67], 0
    v_exp_f32 v180, v180
    v_mfma_f32_16x16x32_bf16 v[204:207], a[176:179], v[68:71], 0
    v_exp_f32 v181, v181
    v_mfma_f32_16x16x32_bf16 v[200:203], a[180:183], v[80:83], v[200:203]
    v_mfma_f32_16x16x32_bf16 v[204:207], a[180:183], v[84:87], v[204:207]
    v_exp_f32 v182, v182
    v_mfma_f32_16x16x32_bf16 v[200:203], a[184:187], v[96:99], v[200:203]
    v_exp_f32 v183, v183
    v_mfma_f32_16x16x32_bf16 v[204:207], a[184:187], v[100:103], v[204:207]
    v_cvt_pk_bf16_f32 v236, v180, v181
    v_cvt_pk_bf16_f32 v237, v182, v183
    v_mfma_f32_16x16x32_bf16 v[200:203], a[188:191], v[112:115], v[200:203]
    ds_read_b128 a[152:155], v3 offset:22528
    ds_read_b128 a[156:159], v3 offset:23552
    v_mfma_f32_16x16x32_bf16 v[204:207], a[188:191], v[116:119], v[204:207]
    v_mfma_f32_16x16x32_bf16 v[208:211], a[160:163], v[72:75], 0
    v_exp_f32 v184, v184
    v_mfma_f32_16x16x32_bf16 v[212:215], a[160:163], v[76:79], 0
    v_exp_f32 v185, v185
    v_mfma_f32_16x16x32_bf16 v[208:211], a[164:167], v[88:91], v[208:211]
    v_exp_f32 v186, v186
    v_mfma_f32_16x16x32_bf16 v[212:215], a[164:167], v[92:95], v[212:215]
    v_exp_f32 v187, v187
    v_mfma_f32_16x16x32_bf16 v[208:211], a[168:171], v[104:107], v[208:211]
    v_mfma_f32_16x16x32_bf16 v[212:215], a[168:171], v[108:111], v[212:215]
    buffer_load_dwordx4 v2, s[36:39], s92 offen offset:2048 sc1 lds
    v_mfma_f32_16x16x32_bf16 v[208:211], a[172:175], v[120:123], v[208:211]
    v_cvt_pk_bf16_f32 v234, v184, v185
    v_cvt_pk_bf16_f32 v235, v186, v187
    v_mfma_f32_16x16x32_bf16 v[212:215], a[172:175], v[124:127], v[212:215]
    v_exp_f32 v188, v188
    v_mfma_f32_16x16x32_bf16 v[216:219], a[176:179], v[72:75], 0
    v_exp_f32 v189, v189
    v_mfma_f32_16x16x32_bf16 v[220:223], a[176:179], v[76:79], 0
    v_mfma_f32_16x16x32_bf16 v[216:219], a[180:183], v[88:91], v[216:219]
    v_exp_f32 v190, v190
    v_mfma_f32_16x16x32_bf16 v[220:223], a[180:183], v[92:95], v[220:223]
    v_exp_f32 v191, v191
    v_mfma_f32_16x16x32_bf16 v[216:219], a[184:187], v[104:107], v[216:219]
    buffer_load_dwordx4 v2, s[36:39], s92 offen offset:3072 sc1 lds
    v_mfma_f32_16x16x32_bf16 v[220:223], a[184:187], v[108:111], v[220:223]
    s_sub_u32 s95, s95, 1
    v_cvt_pk_bf16_f32 v238, v188, v189
    v_cvt_pk_bf16_f32 v239, v190, v191
    v_mfma_f32_16x16x32_bf16 v[216:219], a[188:191], v[120:123], v[216:219]
    s_cmp_lg_u32 s95, 0
    v_mfma_f32_16x16x32_bf16 v[220:223], a[188:191], v[124:127], v[220:223]
    s_waitcnt lgkmcnt(0)
    s_cbranch_scc1 AT_full
    v_mfma_f32_16x16x32_bf16 a[0:3], a[192:195], v[224:227], a[0:3]
    ds_read_b128 a[224:227], v3 offset:8192
    ds_read_b128 a[228:231], v3 offset:9216
    v_mfma_f32_16x16x32_bf16 a[32:35], a[192:195], v[228:231], a[32:35]
    v_exp_f32 v192, v192
    v_mfma_f32_16x16x32_bf16 a[36:39], a[196:199], v[228:231], a[36:39]
    v_exp_f32 v193, v193
    v_mfma_f32_16x16x32_bf16 a[4:7], a[196:199], v[224:227], a[4:7]
    v_exp_f32 v194, v194
    v_mfma_f32_16x16x32_bf16 a[8:11], a[200:203], v[224:227], a[8:11]
    v_mfma_f32_16x16x32_bf16 a[40:43], a[200:203], v[228:231], a[40:43]
    v_exp_f32 v195, v195
    v_mfma_f32_16x16x32_bf16 a[44:47], a[204:207], v[228:231], a[44:47]
    v_cvt_pk_bf16_f32 v240, v192, v193
    v_cvt_pk_bf16_f32 v241, v194, v195
    v_mfma_f32_16x16x32_bf16 a[12:15], a[204:207], v[224:227], a[12:15]
    ds_read_b128 a[232:235], v3 offset:10240
    ds_read_b128 a[236:239], v3 offset:11264
    v_mfma_f32_16x16x32_bf16 a[16:19], a[208:211], v[224:227], a[16:19]
    v_mfma_f32_16x16x32_bf16 a[48:51], a[208:211], v[228:231], a[48:51]
    v_exp_f32 v196, v196
    v_mfma_f32_16x16x32_bf16 a[52:55], a[212:215], v[228:231], a[52:55]
    v_exp_f32 v197, v197
    v_mfma_f32_16x16x32_bf16 a[20:23], a[212:215], v[224:227], a[20:23]
    v_exp_f32 v198, v198
    v_mfma_f32_16x16x32_bf16 a[24:27], a[216:219], v[224:227], a[24:27]
    v_exp_f32 v199, v199
    v_mfma_f32_16x16x32_bf16 a[56:59], a[216:219], v[228:231], a[56:59]
    s_add_u32 m0, s93, 4096
    v_mfma_f32_16x16x32_bf16 a[60:63], a[220:223], v[228:231], a[60:63]
    s_add_u32 s93, s93, 32768
    buffer_load_dwordx4 v4, s[36:39], s92 offen offset:0 sc1 lds
    v_mfma_f32_16x16x32_bf16 a[28:31], a[220:223], v[224:227], a[28:31]
    s_and_b32 s93, s93, 0x1ffff
    v_cvt_pk_bf16_f32 v244, v196, v197
    v_cvt_pk_bf16_f32 v245, v198, v199
    v_mfma_f32_16x16x32_bf16 v[8:11], v[24:27], v[224:227], v[8:11]
    ds_read_b128 a[240:243], v3 offset:12288
    ds_read_b128 a[244:247], v3 offset:13312
    v_mfma_f32_16x16x32_bf16 v[12:15], v[24:27], v[228:231], v[12:15]
    v_mfma_f32_16x16x32_bf16 a[64:67], a[192:195], v[232:235], a[64:67]
    v_exp_f32 v200, v200
    v_mfma_f32_16x16x32_bf16 a[96:99], a[192:195], v[236:239], a[96:99]
    v_exp_f32 v201, v201
    v_mfma_f32_16x16x32_bf16 a[100:103], a[196:199], v[236:239], a[100:103]
    v_exp_f32 v202, v202
    v_mfma_f32_16x16x32_bf16 a[68:71], a[196:199], v[232:235], a[68:71]
    v_exp_f32 v203, v203
    v_mfma_f32_16x16x32_bf16 a[72:75], a[200:203], v[232:235], a[72:75]
    v_mfma_f32_16x16x32_bf16 a[104:107], a[200:203], v[236:239], a[104:107]
    v_cvt_pk_bf16_f32 v242, v200, v201
    v_cvt_pk_bf16_f32 v243, v202, v203
    v_mfma_f32_16x16x32_bf16 a[108:111], a[204:207], v[236:239], a[108:111]
    ds_read_b128 a[248:251], v3 offset:14336
    ds_read_b128 a[252:255], v3 offset:15360
    v_mfma_f32_16x16x32_bf16 a[76:79], a[204:207], v[232:235], a[76:79]
    v_exp_f32 v204, v204
    v_mfma_f32_16x16x32_bf16 a[80:83], a[208:211], v[232:235], a[80:83]
    v_mfma_f32_16x16x32_bf16 a[112:115], a[208:211], v[236:239], a[112:115]
    v_exp_f32 v205, v205
    v_mfma_f32_16x16x32_bf16 a[116:119], a[212:215], v[236:239], a[116:119]
    v_exp_f32 v206, v206
    v_mfma_f32_16x16x32_bf16 a[84:87], a[212:215], v[232:235], a[84:87]
    v_exp_f32 v207, v207
    v_mfma_f32_16x16x32_bf16 a[88:91], a[216:219], v[232:235], a[88:91]
    buffer_load_dwordx4 v4, s[36:39], s92 offen offset:1024 sc1 lds
    v_mfma_f32_16x16x32_bf16 a[120:123], a[216:219], v[236:239], a[120:123]
    v_mfma_f32_16x16x32_bf16 a[124:127], a[220:223], v[236:239], a[124:127]
    v_cvt_pk_bf16_f32 v246, v204, v205
    v_cvt_pk_bf16_f32 v247, v206, v207
    v_mfma_f32_16x16x32_bf16 a[92:95], a[220:223], v[232:235], a[92:95]
    ds_read_b128 a[160:163], v3 offset:24576
    ds_read_b128 a[164:167], v3 offset:25600
    v_mfma_f32_16x16x32_bf16 v[16:19], v[24:27], v[232:235], v[16:19]
    v_exp_f32 v208, v208
    v_mfma_f32_16x16x32_bf16 v[20:23], v[24:27], v[236:239], v[20:23]
    v_mfma_f32_16x16x32_bf16 v[160:163], a[128:131], v[64:67], v[128:131]
    v_exp_f32 v209, v209
    v_mfma_f32_16x16x32_bf16 v[164:167], a[128:131], v[68:71], 0
    v_exp_f32 v210, v210
    v_mfma_f32_16x16x32_bf16 v[160:163], a[132:135], v[80:83], v[160:163]
    v_exp_f32 v211, v211
    v_mfma_f32_16x16x32_bf16 v[164:167], a[132:135], v[84:87], v[164:167]
    v_cvt_pk_bf16_f32 v248, v208, v209
    v_cvt_pk_bf16_f32 v249, v210, v211
    v_mfma_f32_16x16x32_bf16 v[160:163], a[136:139], v[96:99], v[160:163]
    v_mfma_f32_16x16x32_bf16 v[164:167], a[136:139], v[100:103], v[164:167]
    ds_read_b128 a[168:171], v3 offset:26624
    ds_read_b128 a[172:175], v3 offset:27648
    v_mfma_f32_16x16x32_bf16 v[160:163], a[140:143], v[112:115], v[160:163]
    v_exp_f32 v212, v212
    v_mfma_f32_16x16x32_bf16 v[164:167], a[140:143], v[116:119], v[164:167]
    v_exp_f32 v213, v213
    v_mfma_f32_16x16x32_bf16 v[168:171], a[144:147], v[64:67], v[132:135]
    v_mfma_f32_16x16x32_bf16 v[172:175], a[144:147], v[68:71], 0
    v_exp_f32 v214, v214
    v_mfma_f32_16x16x32_bf16 v[168:171], a[148:151], v[80:83], v[168:171]
    v_exp_f32 v215, v215
    v_mfma_f32_16x16x32_bf16 v[172:175], a[148:151], v[84:87], v[172:175]
    buffer_load_dwordx4 v4, s[36:39], s92 offen offset:2048 sc1 lds
    v_mfma_f32_16x16x32_bf16 v[168:171], a[152:155], v[96:99], v[168:171]
    v_cvt_pk_bf16_f32 v252, v212, v213
    v_cvt_pk_bf16_f32 v253, v214, v215
    v_mfma_f32_16x16x32_bf16 v[172:175], a[152:155], v[100:103], v[172:175]
    v_mfma_f32_16x16x32_bf16 v[168:171], a[156:159], v[112:115], v[168:171]
    ds_read_b128 a[176:179], v3 offset:28672
    ds_read_b128 a[180:183], v3 offset:29696
    v_mfma_f32_16x16x32_bf16 v[172:175], a[156:159], v[116:119], v[172:175]
    v_exp_f32 v216, v216
    v_mfma_f32_16x16x32_bf16 v[176:179], a[128:131], v[72:75], 0
    v_exp_f32 v217, v217
    v_mfma_f32_16x16x32_bf16 v[180:183], a[128:131], v[76:79], 0
    v_mfma_f32_16x16x32_bf16 v[176:179], a[132:135], v[88:91], v[176:179]
    v_exp_f32 v218, v218
    v_mfma_f32_16x16x32_bf16 v[180:183], a[132:135], v[92:95], v[180:183]
    v_exp_f32 v219, v219
    v_mfma_f32_16x16x32_bf16 v[176:179], a[136:139], v[104:107], v[176:179]
    v_cvt_pk_bf16_f32 v250, v216, v217
    v_cvt_pk_bf16_f32 v251, v218, v219
    v_mfma_f32_16x16x32_bf16 v[180:183], a[136:139], v[108:111], v[180:183]
    ds_read_b128 a[184:187], v3 offset:30720
    ds_read_b128 a[188:191], v3 offset:31744
    v_mfma_f32_16x16x32_bf16 v[176:179], a[140:143], v[120:123], v[176:179]
    v_mfma_f32_16x16x32_bf16 v[180:183], a[140:143], v[124:127], v[180:183]
    v_exp_f32 v220, v220
    v_mfma_f32_16x16x32_bf16 v[184:187], a[144:147], v[72:75], 0
    v_exp_f32 v221, v221
    v_mfma_f32_16x16x32_bf16 v[188:191], a[144:147], v[76:79], 0
    v_exp_f32 v222, v222
    v_mfma_f32_16x16x32_bf16 v[184:187], a[148:151], v[88:91], v[184:187]
    v_mfma_f32_16x16x32_bf16 v[188:191], a[148:151], v[92:95], v[188:191]
    v_exp_f32 v223, v223
    v_mfma_f32_16x16x32_bf16 v[184:187], a[152:155], v[104:107], v[184:187]
    buffer_load_dwordx4 v4, s[36:39], s92 offen offset:3072 sc1 lds
    v_mfma_f32_16x16x32_bf16 v[188:191], a[152:155], v[108:111], v[188:191]
    s_add_u32 s92, s92, 33792
    v_cvt_pk_bf16_f32 v254, v220, v221
    v_cvt_pk_bf16_f32 v255, v222, v223
    v_mfma_f32_16x16x32_bf16 v[184:187], a[156:159], v[120:123], v[184:187]
    v_mfma_f32_16x16x32_bf16 v[188:191], a[156:159], v[124:127], v[188:191]
    s_waitcnt vmcnt(16) lgkmcnt(0)
    v_mfma_f32_16x16x32_bf16 a[0:3], a[224:227], v[240:243], a[0:3]
    s_barrier
    v_add_u32 v3, s94, v2
    v_mfma_f32_16x16x32_bf16 a[32:35], a[224:227], v[244:247], a[32:35]
    s_add_u32 s94, s94, 32768
    ds_read_b128 a[192:195], v3 offset:0
    ds_read_b128 a[196:199], v3 offset:1024
    v_mfma_f32_16x16x32_bf16 a[36:39], a[228:231], v[244:247], a[36:39]
    s_and_b32 s94, s94, 0x18000
    ds_read_b128 a[200:203], v3 offset:2048
    ds_read_b128 a[204:207], v3 offset:3072
    v_mfma_f32_16x16x32_bf16 a[4:7], a[228:231], v[240:243], a[4:7]
    v_exp_f32 v160, v160
    v_mfma_f32_16x16x32_bf16 a[8:11], a[232:235], v[240:243], a[8:11]
    v_exp_f32 v161, v161
    v_mfma_f32_16x16x32_bf16 a[40:43], a[232:235], v[244:247], a[40:43]
    v_mfma_f32_16x16x32_bf16 a[44:47], a[236:239], v[244:247], a[44:47]
    v_exp_f32 v162, v162
    v_mfma_f32_16x16x32_bf16 a[12:15], a[236:239], v[240:243], a[12:15]
    v_exp_f32 v163, v163
    v_mfma_f32_16x16x32_bf16 a[16:19], a[240:243], v[240:243], a[16:19]
    v_cvt_pk_bf16_f32 v224, v160, v161
    v_cvt_pk_bf16_f32 v225, v162, v163
    v_mfma_f32_16x16x32_bf16 a[48:51], a[240:243], v[244:247], a[48:51]
    ds_read_b128 a[208:211], v3 offset:4096
    ds_read_b128 a[212:215], v3 offset:5120
    v_mfma_f32_16x16x32_bf16 a[52:55], a[244:247], v[244:247], a[52:55]
    v_mfma_f32_16x16x32_bf16 a[20:23], a[244:247], v[240:243], a[20:23]
    v_exp_f32 v164, v164
    v_mfma_f32_16x16x32_bf16 a[24:27], a[248:251], v[240:243], a[24:27]
    v_exp_f32 v165, v165
    v_mfma_f32_16x16x32_bf16 a[56:59], a[248:251], v[244:247], a[56:59]
    v_exp_f32 v166, v166
    v_mfma_f32_16x16x32_bf16 a[60:63], a[252:255], v[244:247], a[60:63]
    v_exp_f32 v167, v167
    v_mfma_f32_16x16x32_bf16 a[28:31], a[252:255], v[240:243], a[28:31]
    v_mfma_f32_16x16x32_bf16 v[8:11], v[24:27], v[240:243], v[8:11]
    buffer_store_dword v5, v0, s[76:79], 0 offen sc1
    v_mfma_f32_16x16x32_bf16 v[12:15], v[24:27], v[244:247], v[12:15]
    v_cvt_pk_bf16_f32 v228, v164, v165
    v_cvt_pk_bf16_f32 v229, v166, v167
    v_mfma_f32_16x16x32_bf16 a[64:67], a[224:227], v[248:251], a[64:67]
    ds_read_b128 a[216:219], v3 offset:6144
    ds_read_b128 a[220:223], v3 offset:7168
    v_mfma_f32_16x16x32_bf16 a[96:99], a[224:227], v[252:255], a[96:99]
    v_exp_f32 v168, v168
    v_mfma_f32_16x16x32_bf16 a[100:103], a[228:231], v[252:255], a[100:103]
    v_mfma_f32_16x16x32_bf16 a[68:71], a[228:231], v[248:251], a[68:71]
    v_exp_f32 v169, v169
    v_mfma_f32_16x16x32_bf16 a[72:75], a[232:235], v[248:251], a[72:75]
    v_exp_f32 v170, v170
    v_mfma_f32_16x16x32_bf16 a[104:107], a[232:235], v[252:255], a[104:107]
    v_exp_f32 v171, v171
    v_mfma_f32_16x16x32_bf16 a[108:111], a[236:239], v[252:255], a[108:111]
    v_cvt_pk_bf16_f32 v226, v168, v169
    v_cvt_pk_bf16_f32 v227, v170, v171
    v_mfma_f32_16x16x32_bf16 a[76:79], a[236:239], v[248:251], a[76:79]
    v_mfma_f32_16x16x32_bf16 a[80:83], a[240:243], v[248:251], a[80:83]
    ds_read_b128 a[128:131], v3 offset:16384
    ds_read_b128 a[132:135], v3 offset:17408
    v_mfma_f32_16x16x32_bf16 a[112:115], a[240:243], v[252:255], a[112:115]
    v_exp_f32 v172, v172
    v_mfma_f32_16x16x32_bf16 a[116:119], a[244:247], v[252:255], a[116:119]
    v_exp_f32 v173, v173
    v_mfma_f32_16x16x32_bf16 a[84:87], a[244:247], v[248:251], a[84:87]
    v_exp_f32 v174, v174
    v_mfma_f32_16x16x32_bf16 a[88:91], a[248:251], v[248:251], a[88:91]
    v_mfma_f32_16x16x32_bf16 a[120:123], a[248:251], v[252:255], a[120:123]
    s_add_u32 m0, s93, 0
    v_exp_f32 v175, v175
    v_mfma_f32_16x16x32_bf16 a[124:127], a[252:255], v[252:255], a[124:127]
    buffer_load_dwordx4 v2, s[36:39], s92 offen offset:0 sc1 lds
    v_mfma_f32_16x16x32_bf16 a[92:95], a[252:255], v[248:251], a[92:95]
    v_cvt_pk_bf16_f32 v230, v172, v173
    v_cvt_pk_bf16_f32 v231, v174, v175
    v_mfma_f32_16x16x32_bf16 v[16:19], v[24:27], v[248:251], v[16:19]
    ds_read_b128 a[136:139], v3 offset:18432
    ds_read_b128 a[140:143], v3 offset:19456
    v_mfma_f32_16x16x32_bf16 v[20:23], v[24:27], v[252:255], v[20:23]
    v_exp_f32 v176, v176
    v_mfma_f32_16x16x32_bf16 v[192:195], a[160:163], v[64:67], v[136:139]
    v_mfma_f32_16x16x32_bf16 v[196:199], a[160:163], v[68:71], 0
    v_exp_f32 v177, v177
    v_mfma_f32_16x16x32_bf16 v[192:195], a[164:167], v[80:83], v[192:195]
    v_exp_f32 v178, v178
    v_mfma_f32_16x16x32_bf16 v[196:199], a[164:167], v[84:87], v[196:199]
    v_exp_f32 v179, v179
    v_mfma_f32_16x16x32_bf16 v[192:195], a[168:171], v[96:99], v[192:195]
    buffer_load_dwordx4 v2, s[36:39], s92 offen offset:1024 sc1 lds
    v_mfma_f32_16x16x32_bf16 v[196:199], a[168:171], v[100:103], v[196:199]
    v_mfma_f32_16x16x32_bf16 v[192:195], a[172:175], v[112:115], v[192:195]
    v_cvt_pk_bf16_f32 v232, v176, v177
    v_cvt_pk_bf16_f32 v233, v178, v179
    v_mfma_f32_16x16x32_bf16 v[196:199], a[172:175], v[116:119], v[196:199]
    ds_read_b128 a[144:147], v3 offset:20480
    ds_read_b128 a[148:151], v3 offset:21504
    v_mfma_f32_16x16x32_bf16 v[200:203], a[176:179], v[64:67], v[140:143]
    v_exp_f32 v180, v180
    v_mfma_f32_16x16x32_bf16 v[204:207], a[176:179], v[68:71], 0
    v_exp_f32 v181, v181
    v_mfma_f32_16x16x32_bf16 v[200:203], a[180:183], v[80:83], v[200:203]
    v_mfma_f32_16x16x32_bf16 v[204:207], a[180:183], v[84:87], v[204:207]
    v_exp_f32 v182, v182
    v_mfma_f32_16x16x32_bf16 v[200:203], a[184:187], v[96:99], v[200:203]
    v_exp_f32 v183, v183
    v_mfma_f32_16x16x32_bf16 v[204:207], a[184:187], v[100:103], v[204:207]
    v_cvt_pk_bf16_f32 v236, v180, v181
    v_cvt_pk_bf16_f32 v237, v182, v183
    v_mfma_f32_16x16x32_bf16 v[200:203], a[188:191], v[112:115], v[200:203]
    ds_read_b128 a[152:155], v3 offset:22528
    ds_read_b128 a[156:159], v3 offset:23552
    v_mfma_f32_16x16x32_bf16 v[204:207], a[188:191], v[116:119], v[204:207]
    v_mfma_f32_16x16x32_bf16 v[208:211], a[160:163], v[72:75], 0
    v_exp_f32 v184, v184
    v_mfma_f32_16x16x32_bf16 v[212:215], a[160:163], v[76:79], 0
    v_exp_f32 v185, v185
    v_mfma_f32_16x16x32_bf16 v[208:211], a[164:167], v[88:91], v[208:211]
    v_exp_f32 v186, v186
    v_mfma_f32_16x16x32_bf16 v[212:215], a[164:167], v[92:95], v[212:215]
    v_exp_f32 v187, v187
    v_mfma_f32_16x16x32_bf16 v[208:211], a[168:171], v[104:107], v[208:211]
    v_mfma_f32_16x16x32_bf16 v[212:215], a[168:171], v[108:111], v[212:215]
    buffer_load_dwordx4 v2, s[36:39], s92 offen offset:2048 sc1 lds
    v_mfma_f32_16x16x32_bf16 v[208:211], a[172:175], v[120:123], v[208:211]
    v_cvt_pk_bf16_f32 v234, v184, v185
    v_cvt_pk_bf16_f32 v235, v186, v187
    v_mfma_f32_16x16x32_bf16 v[212:215], a[172:175], v[124:127], v[212:215]
    v_exp_f32 v188, v188
    v_mfma_f32_16x16x32_bf16 v[216:219], a[176:179], v[72:75], 0
    v_exp_f32 v189, v189
    v_mfma_f32_16x16x32_bf16 v[220:223], a[176:179], v[76:79], 0
    v_mfma_f32_16x16x32_bf16 v[216:219], a[180:183], v[88:91], v[216:219]
    v_exp_f32 v190, v190
    v_mfma_f32_16x16x32_bf16 v[220:223], a[180:183], v[92:95], v[220:223]
    v_exp_f32 v191, v191
    v_mfma_f32_16x16x32_bf16 v[216:219], a[184:187], v[104:107], v[216:219]
    buffer_load_dwordx4 v2, s[36:39], s92 offen offset:3072 sc1 lds
    v_mfma_f32_16x16x32_bf16 v[220:223], a[184:187], v[108:111], v[220:223]
    v_cvt_pk_bf16_f32 v238, v188, v189
    v_cvt_pk_bf16_f32 v239, v190, v191
    v_mfma_f32_16x16x32_bf16 v[216:219], a[188:191], v[120:123], v[216:219]
    v_mfma_f32_16x16x32_bf16 v[220:223], a[188:191], v[124:127], v[220:223]
    s_waitcnt lgkmcnt(0)
AT_d1:
    v_mfma_f32_16x16x32_bf16 a[0:3], a[192:195], v[224:227], a[0:3]
    ds_read_b128 a[224:227], v3 offset:8192
    ds_read_b128 a[228:231], v3 offset:9216
    v_mfma_f32_16x16x32_bf16 a[32:35], a[192:195], v[228:231], a[32:35]
    v_exp_f32 v192, v192
    v_mfma_f32_16x16x32_bf16 a[36:39], a[196:199], v[228:231], a[36:39]
    v_exp_f32 v193, v193
    v_mfma_f32_16x16x32_bf16 a[4:7], a[196:199], v[224:227], a[4:7]
    v_exp_f32 v194, v194
    v_mfma_f32_16x16x32_bf16 a[8:11], a[200:203], v[224:227], a[8:11]
    s_add_u32 m0, s93, 4096
    v_exp_f32 v195, v195
    v_mfma_f32_16x16x32_bf16 a[40:43], a[200:203], v[228:231], a[40:43]
    buffer_load_dwordx4 v4, s[36:39], s92 offen offset:0 sc1 lds
    v_mfma_f32_16x16x32_bf16 a[44:47], a[204:207], v[228:231], a[44:47]
    v_cvt_pk_bf16_f32 v240, v192, v193
    v_cvt_pk_bf16_f32 v241, v194, v195
    v_mfma_f32_16x16x32_bf16 a[12:15], a[204:207], v[224:227], a[12:15]
    ds_read_b128 a[232:235], v3 offset:10240
    ds_read_b128 a[236:239], v3 offset:11264
    v_mfma_f32_16x16x32_bf16 a[16:19], a[208:211], v[224:227], a[16:19]
    v_exp_f32 v196, v196
    v_mfma_f32_16x16x32_bf16 a[48:51], a[208:211], v[228:231], a[48:51]
    v_exp_f32 v197, v197
    v_mfma_f32_16x16x32_bf16 a[52:55], a[212:215], v[228:231], a[52:55]
    v_exp_f32 v198, v198
    v_mfma_f32_16x16x32_bf16 a[20:23], a[212:215], v[224:227], a[20:23]
    v_exp_f32 v199, v199
    v_mfma_f32_16x16x32_bf16 a[24:27], a[216:219], v[224:227], a[24:27]
    buffer_load_dwordx4 v4, s[36:39], s92 offen offset:1024 sc1 lds
    v_mfma_f32_16x16x32_bf16 a[56:59], a[216:219], v[228:231], a[56:59]
    buffer_load_dwordx4 v4, s[36:39], s92 offen offset:2048 sc1 lds
    v_mfma_f32_16x16x32_bf16 a[60:63], a[220:223], v[228:231], a[60:63]
    v_cvt_pk_bf16_f32 v244, v196, v197
    v_cvt_pk_bf16_f32 v245, v198, v199
    v_mfma_f32_16x16x32_bf16 a[28:31], a[220:223], v[224:227], a[28:31]
    ds_read_b128 a[240:243], v3 offset:12288
    ds_read_b128 a[244:247], v3 offset:13312
    v_mfma_f32_16x16x32_bf16 v[8:11], v[24:27], v[224:227], v[8:11]
    v_exp_f32 v200, v200
    v_mfma_f32_16x16x32_bf16 v[12:15], v[24:27], v[228:231], v[12:15]
    v_exp_f32 v201, v201
    v_mfma_f32_16x16x32_bf16 a[64:67], a[192:195], v[232:235], a[64:67]
    v_exp_f32 v202, v202
    v_mfma_f32_16x16x32_bf16 a[96:99], a[192:195], v[236:239], a[96:99]
    v_exp_f32 v203, v203
    v_mfma_f32_16x16x32_bf16 a[100:103], a[196:199], v[236:239], a[100:103]
    buffer_load_dwordx4 v4, s[36:39], s92 offen offset:3072 sc1 lds
    v_mfma_f32_16x16x32_bf16 a[68:71], a[196:199], v[232:235], a[68:71]
    v_cvt_pk_bf16_f32 v242, v200, v201
    v_cvt_pk_bf16_f32 v243, v202, v203
    v_mfma_f32_16x16x32_bf16 a[72:75], a[200:203], v[232:235], a[72:75]
    ds_read_b128 a[248:251], v3 offset:14336
    ds_read_b128 a[252:255], v3 offset:15360
    v_mfma_f32_16x16x32_bf16 a[104:107], a[200:203], v[236:239], a[104:107]
    v_exp_f32 v204, v204
    v_mfma_f32_16x16x32_bf16 a[108:111], a[204:207], v[236:239], a[108:111]
    v_exp_f32 v205, v205
    v_mfma_f32_16x16x32_bf16 a[76:79], a[204:207], v[232:235], a[76:79]
    v_exp_f32 v206, v206
    v_mfma_f32_16x16x32_bf16 a[80:83], a[208:211], v[232:235], a[80:83]
    v_exp_f32 v207, v207
    v_mfma_f32_16x16x32_bf16 a[112:115], a[208:211], v[236:239], a[112:115]
    s_add_u32 m0, s86, 0
    buffer_store_dwordx4 v[44:47], v2, s[12:15], s63 offen offset:0 sc1
    v_mfma_f32_16x16x32_bf16 a[116:119], a[212:215], v[236:239], a[116:119]
    s_add_u32 s93, s93, 32768
    buffer_load_dwordx4 v28, s[8:11], s44 offen offset:0 lds
    v_mfma_f32_16x16x32_bf16 a[84:87], a[212:215], v[232:235], a[84:87]
    s_and_b32 s93, s93, 0x1ffff
    v_cvt_pk_bf16_f32 v246, v204, v205
    v_cvt_pk_bf16_f32 v247, v206, v207
    v_mfma_f32_16x16x32_bf16 a[88:91], a[216:219], v[232:235], a[88:91]
    ds_read_b128 a[160:163], v3 offset:24576
    ds_read_b128 a[164:167], v3 offset:25600
    v_mfma_f32_16x16x32_bf16 a[120:123], a[216:219], v[236:239], a[120:123]
    v_exp_f32 v208, v208
    v_mfma_f32_16x16x32_bf16 a[124:127], a[220:223], v[236:239], a[124:127]
    v_exp_f32 v209, v209
    v_mfma_f32_16x16x32_bf16 a[92:95], a[220:223], v[232:235], a[92:95]
    v_exp_f32 v210, v210
    v_mfma_f32_16x16x32_bf16 v[16:19], v[24:27], v[232:235], v[16:19]
    v_exp_f32 v211, v211
    v_mfma_f32_16x16x32_bf16 v[20:23], v[24:27], v[236:239], v[20:23]
    buffer_load_dwordx4 v29, s[8:11], s44 offen offset:1024 lds
    v_mfma_f32_16x16x32_bf16 v[164:167], a[128:131], v[68:71], v[144:147]
    v_cvt_pk_bf16_f32 v248, v208, v209
    v_cvt_pk_bf16_f32 v249, v210, v211
    v_mfma_f32_16x16x32_bf16 v[172:175], a[144:147], v[68:71], v[148:151]
    ds_read_b128 a[168:171], v3 offset:26624
    ds_read_b128 a[172:175], v3 offset:27648
    v_mfma_f32_16x16x32_bf16 v[164:167], a[132:135], v[84:87], v[164:167]
    v_exp_f32 v212, v212
    v_mfma_f32_16x16x32_bf16 v[172:175], a[148:151], v[84:87], v[172:175]
    v_exp_f32 v213, v213
    v_mfma_f32_16x16x32_bf16 v[164:167], a[136:139], v[100:103], v[164:167]
    v_exp_f32 v214, v214
    v_mfma_f32_16x16x32_bf16 v[172:175], a[152:155], v[100:103], v[172:175]
    v_exp_f32 v215, v215
    v_mfma_f32_16x16x32_bf16 v[164:167], a[140:143], v[116:119], v[164:167]
    buffer_load_dwordx4 v30, s[8:11], s44 offen offset:2048 lds
    v_mfma_f32_16x16x32_bf16 v[172:175], a[156:159], v[116:119], v[172:175]
    buffer_load_dwordx4 v31, s[8:11], s44 offen offset:3072 lds
    v_mfma_f32_16x16x32_bf16 v[176:179], a[128:131], v[72:75], 0
    s_add_u32 s92, s92, 33792
    v_cvt_pk_bf16_f32 v252, v212, v213
    v_cvt_pk_bf16_f32 v253, v214, v215
    v_mfma_f32_16x16x32_bf16 v[180:183], a[128:131], v[76:79], 0
    ds_read_b128 a[176:179], v3 offset:28672
    ds_read_b128 a[180:183], v3 offset:29696
    v_mfma_f32_16x16x32_bf16 v[176:179], a[132:135], v[88:91], v[176:179]
    v_exp_f32 v216, v216
    v_mfma_f32_16x16x32_bf16 v[180:183], a[132:135], v[92:95], v[180:183]
    v_exp_f32 v217, v217
    v_mfma_f32_16x16x32_bf16 v[176:179], a[136:139], v[104:107], v[176:179]
    v_exp_f32 v218, v218
    v_mfma_f32_16x16x32_bf16 v[180:183], a[136:139], v[108:111], v[180:183]
    v_exp_f32 v219, v219
    v_mfma_f32_16x16x32_bf16 v[176:179], a[140:143], v[120:123], v[176:179]
    buffer_store_dwordx4 v[44:47], v2, s[12:15], s63 offen offset:1024 sc1
    v_mfma_f32_16x16x32_bf16 v[180:183], a[140:143], v[124:127], v[180:183]
    v_cvt_pk_bf16_f32 v250, v216, v217
    v_cvt_pk_bf16_f32 v251, v218, v219
    v_mfma_f32_16x16x32_bf16 v[184:187], a[144:147], v[72:75], 0
    ds_read_b128 a[184:187], v3 offset:30720
    ds_read_b128 a[188:191], v3 offset:31744
    v_mfma_f32_16x16x32_bf16 v[188:191], a[144:147], v[76:79], 0
    v_exp_f32 v220, v220
    v_mfma_f32_16x16x32_bf16 v[184:187], a[148:151], v[88:91], v[184:187]
    v_exp_f32 v221, v221
    v_mfma_f32_16x16x32_bf16 v[188:191], a[148:151], v[92:95], v[188:191]
    v_exp_f32 v222, v222
    v_mfma_f32_16x16x32_bf16 v[184:187], a[152:155], v[104:107], v[184:187]
    v_exp_f32 v223, v223
    v_mfma_f32_16x16x32_bf16 v[188:191], a[152:155], v[108:111], v[188:191]
    buffer_store_dwordx4 v[44:47], v2, s[12:15], s63 offen offset:2048 sc1
    v_mfma_f32_16x16x32_bf16 v[184:187], a[156:159], v[120:123], v[184:187]
    buffer_store_dwordx4 v[44:47], v2, s[12:15], s63 offen offset:3072 sc1
    v_mfma_f32_16x16x32_bf16 v[188:191], a[156:159], v[124:127], v[188:191]
    s_waitcnt vmcnt(24) lgkmcnt(0)
    v_cvt_pk_bf16_f32 v254, v220, v221
    v_cvt_pk_bf16_f32 v255, v222, v223
    v_mfma_f32_16x16x32_bf16 a[0:3], a[224:227], v[240:243], a[0:3]
    s_barrier
    v_add_u32 v3, s94, v2
    v_mfma_f32_16x16x32_bf16 a[32:35], a[224:227], v[244:247], a[32:35]
    s_add_u32 s94, s94, 32768
    ds_read_b128 a[192:195], v3 offset:0
    ds_read_b128 a[196:199], v3 offset:1024
    v_mfma_f32_16x16x32_bf16 a[36:39], a[228:231], v[244:247], a[36:39]
    s_and_b32 s94, s94, 0x18000
    ds_read_b128 a[200:203], v3 offset:2048
    ds_read_b128 a[204:207], v3 offset:3072
    v_mfma_f32_16x16x32_bf16 a[4:7], a[228:231], v[240:243], a[4:7]
    v_exp_f32 v164, v164
    v_mfma_f32_16x16x32_bf16 a[8:11], a[232:235], v[240:243], a[8:11]
    v_exp_f32 v165, v165
    v_mfma_f32_16x16x32_bf16 a[40:43], a[232:235], v[244:247], a[40:43]
    ds_read_b128 a[208:211], v3 offset:4096
    ds_read_b128 a[212:215], v3 offset:5120
    v_mfma_f32_16x16x32_bf16 a[44:47], a[236:239], v[244:247], a[44:47]
    v_exp_f32 v166, v166
    v_mfma_f32_16x16x32_bf16 a[12:15], a[236:239], v[240:243], a[12:15]
    v_exp_f32 v167, v167
    v_mfma_f32_16x16x32_bf16 a[16:19], a[240:243], v[240:243], a[16:19]
    s_add_u32 m0, s93, 0
    buffer_store_dword v5, v0, s[76:79], 0 offen sc1
    v_mfma_f32_16x16x32_bf16 a[48:51], a[240:243], v[244:247], a[48:51]
    buffer_load_dwordx4 v2, s[36:39], s92 offen offset:0 sc1 lds
    v_mfma_f32_16x16x32_bf16 a[52:55], a[244:247], v[244:247], a[52:55]
    v_cvt_pk_bf16_f32 v228, v164, v165
    v_cvt_pk_bf16_f32 v229, v166, v167
    v_mfma_f32_16x16x32_bf16 a[20:23], a[244:247], v[240:243], a[20:23]
    ds_read_b128 a[216:219], v3 offset:6144
    ds_read_b128 a[220:223], v3 offset:7168
    v_mfma_f32_16x16x32_bf16 a[24:27], a[248:251], v[240:243], a[24:27]
    v_exp_f32 v172, v172
    v_mfma_f32_16x16x32_bf16 a[56:59], a[248:251], v[244:247], a[56:59]
    v_exp_f32 v173, v173
    v_mfma_f32_16x16x32_bf16 a[60:63], a[252:255], v[244:247], a[60:63]
    v_exp_f32 v174, v174
    v_mfma_f32_16x16x32_bf16 a[28:31], a[252:255], v[240:243], a[28:31]
    v_exp_f32 v175, v175
    v_mfma_f32_16x16x32_bf16 v[8:11], v[24:27], v[240:243], v[8:11]
    buffer_load_dwordx4 v2, s[36:39], s92 offen offset:1024 sc1 lds
    v_mfma_f32_16x16x32_bf16 v[12:15], v[24:27], v[244:247], v[12:15]
    buffer_load_dwordx4 v2, s[36:39], s92 offen offset:2048 sc1 lds
    v_mfma_f32_16x16x32_bf16 a[64:67], a[224:227], v[248:251], a[64:67]
    buffer_load_dwordx4 v2, s[36:39], s92 offen offset:3072 sc1 lds
    v_mfma_f32_16x16x32_bf16 a[96:99], a[224:227], v[252:255], a[96:99]
    v_mfma_f32_16x16x32_bf16 a[100:103], a[228:231], v[252:255], a[100:103]
    v_cvt_pk_bf16_f32 v230, v172, v173
    v_cvt_pk_bf16_f32 v231, v174, v175
    v_mfma_f32_16x16x32_bf16 a[68:71], a[228:231], v[248:251], a[68:71]
    ds_read_b128 a[128:131], v3 offset:16384
    ds_read_b128 a[132:135], v3 offset:17408
    v_mfma_f32_16x16x32_bf16 a[72:75], a[232:235], v[248:251], a[72:75]
    v_exp_f32 v176, v176
    v_mfma_f32_16x16x32_bf16 a[104:107], a[232:235], v[252:255], a[104:107]
    v_exp_f32 v177, v177
    v_mfma_f32_16x16x32_bf16 a[108:111], a[236:239], v[252:255], a[108:111]
    v_exp_f32 v178, v178
    v_mfma_f32_16x16x32_bf16 a[76:79], a[236:239], v[248:251], a[76:79]
    v_exp_f32 v179, v179
    v_mfma_f32_16x16x32_bf16 a[80:83], a[240:243], v[248:251], a[80:83]
    buffer_store_dwordx4 v[44:47], v4, s[12:15], s63 offen offset:0 sc1
    v_mfma_f32_16x16x32_bf16 a[112:115], a[240:243], v[252:255], a[112:115]
    s_add_u32 m0, s86, 4096
    buffer_store_dwordx4 v[44:47], v4, s[12:15], s63 offen offset:1024 sc1
    v_mfma_f32_16x16x32_bf16 a[116:119], a[244:247], v[252:255], a[116:119]
    s_add_u32 s44, s44, 20480
    buffer_load_dwordx4 v28, s[8:11], s44 offen offset:0 lds
    v_mfma_f32_16x16x32_bf16 a[84:87], a[244:247], v[248:251], a[84:87]
    v_cvt_pk_bf16_f32 v232, v176, v177
    v_cvt_pk_bf16_f32 v233, v178, v179
    v_mfma_f32_16x16x32_bf16 a[88:91], a[248:251], v[248:251], a[88:91]
    ds_read_b128 a[136:139], v3 offset:18432
    ds_read_b128 a[140:143], v3 offset:19456
    v_mfma_f32_16x16x32_bf16 a[120:123], a[248:251], v[252:255], a[120:123]
    v_exp_f32 v180, v180
    v_mfma_f32_16x16x32_bf16 a[124:127], a[252:255], v[252:255], a[124:127]
    v_exp_f32 v181, v181
    v_mfma_f32_16x16x32_bf16 a[92:95], a[252:255], v[248:251], a[92:95]
    v_exp_f32 v182, v182
    v_mfma_f32_16x16x32_bf16 v[16:19], v[24:27], v[248:251], v[16:19]
    v_exp_f32 v183, v183
    v_mfma_f32_16x16x32_bf16 v[20:23], v[24:27], v[252:255], v[20:23]
    buffer_load_dwordx4 v29, s[8:11], s44 offen offset:1024 lds
    v_mfma_f32_16x16x32_bf16 v[196:199], a[160:163], v[68:71], v[152:155]
    buffer_load_dwordx4 v30, s[8:11], s44 offen offset:2048 lds
    v_mfma_f32_16x16x32_bf16 v[204:207], a[176:179], v[68:71], v[156:159]
    buffer_load_dwordx4 v31, s[8:11], s44 offen offset:3072 lds
    v_mfma_f32_16x16x32_bf16 v[196:199], a[164:167], v[84:87], v[196:199]
    v_cvt_pk_bf16_f32 v236, v180, v181
    v_cvt_pk_bf16_f32 v237, v182, v183
    v_mfma_f32_16x16x32_bf16 v[204:207], a[180:183], v[84:87], v[204:207]
    v_mfma_f32_16x16x32_bf16 v[196:199], a[168:171], v[100:103], v[196:199]
    ds_read_b128 a[144:147], v3 offset:20480
    ds_read_b128 a[148:151], v3 offset:21504
    v_mfma_f32_16x16x32_bf16 v[204:207], a[184:187], v[100:103], v[204:207]
    v_exp_f32 v184, v184
    v_mfma_f32_16x16x32_bf16 v[196:199], a[172:175], v[116:119], v[196:199]
    v_exp_f32 v185, v185
    v_mfma_f32_16x16x32_bf16 v[204:207], a[188:191], v[116:119], v[204:207]
    v_exp_f32 v186, v186
    v_mfma_f32_16x16x32_bf16 v[208:211], a[160:163], v[72:75], 0
    v_exp_f32 v187, v187
    v_mfma_f32_16x16x32_bf16 v[212:215], a[160:163], v[76:79], 0
    buffer_store_dwordx4 v[44:47], v4, s[12:15], s63 offen offset:2048 sc1
    v_mfma_f32_16x16x32_bf16 v[208:211], a[164:167], v[88:91], v[208:211]
    buffer_store_dwordx4 v[44:47], v4, s[12:15], s63 offen offset:3072 sc1
    v_mfma_f32_16x16x32_bf16 v[212:215], a[164:167], v[92:95], v[212:215]
    buffer_store_dwordx4 v[44:47], v2, s[12:15], s74 offen offset:0 sc1
    v_mfma_f32_16x16x32_bf16 v[208:211], a[168:171], v[104:107], v[208:211]
    v_cvt_pk_bf16_f32 v234, v184, v185
    v_cvt_pk_bf16_f32 v235, v186, v187
    v_mfma_f32_16x16x32_bf16 v[212:215], a[168:171], v[108:111], v[212:215]
    ds_read_b128 a[152:155], v3 offset:22528
    ds_read_b128 a[156:159], v3 offset:23552
    v_mfma_f32_16x16x32_bf16 v[208:211], a[172:175], v[120:123], v[208:211]
    v_exp_f32 v188, v188
    v_mfma_f32_16x16x32_bf16 v[212:215], a[172:175], v[124:127], v[212:215]
    v_exp_f32 v189, v189
    v_mfma_f32_16x16x32_bf16 v[216:219], a[176:179], v[72:75], 0
    v_exp_f32 v190, v190
    v_mfma_f32_16x16x32_bf16 v[220:223], a[176:179], v[76:79], 0
    v_exp_f32 v191, v191
    v_mfma_f32_16x16x32_bf16 v[216:219], a[180:183], v[88:91], v[216:219]
    buffer_store_dwordx4 v[44:47], v2, s[12:15], s74 offen offset:1024 sc1
    v_mfma_f32_16x16x32_bf16 v[220:223], a[180:183], v[92:95], v[220:223]
    buffer_store_dwordx4 v[44:47], v2, s[12:15], s74 offen offset:2048 sc1
    v_mfma_f32_16x16x32_bf16 v[216:219], a[184:187], v[104:107], v[216:219]
    buffer_store_dwordx4 v[44:47], v2, s[12:15], s74 offen offset:3072 sc1
    v_mfma_f32_16x16x32_bf16 v[220:223], a[184:187], v[108:111], v[220:223]
    s_lshl_b32 s95, s32, 1
    v_cvt_pk_bf16_f32 v238, v188, v189
    v_cvt_pk_bf16_f32 v239, v190, v191
    v_mfma_f32_16x16x32_bf16 v[216:219], a[188:191], v[120:123], v[216:219]
    s_sub_u32 s95, 13, s95
    v_mfma_f32_16x16x32_bf16 v[220:223], a[188:191], v[124:127], v[220:223]
    s_waitcnt lgkmcnt(0)
    s_cbranch_scc1 AT_p7
    v_mfma_f32_16x16x32_bf16 a[32:35], a[192:195], v[228:231], a[32:35]
    ds_read_b128 a[160:163], v3 offset:24576
    ds_read_b128 a[164:167], v3 offset:25600
    v_mfma_f32_16x16x32_bf16 a[36:39], a[196:199], v[228:231], a[36:39]
    v_exp_f32 v196, v196
    v_mfma_f32_16x16x32_bf16 a[40:43], a[200:203], v[228:231], a[40:43]
    v_exp_f32 v197, v197
    v_mfma_f32_16x16x32_bf16 a[44:47], a[204:207], v[228:231], a[44:47]
    v_mfma_f32_16x16x32_bf16 a[48:51], a[208:211], v[228:231], a[48:51]
    ds_read_b128 a[168:171], v3 offset:26624
    ds_read_b128 a[172:175], v3 offset:27648
    v_mfma_f32_16x16x32_bf16 a[52:55], a[212:215], v[228:231], a[52:55]
    v_exp_f32 v198, v198
    v_mfma_f32_16x16x32_bf16 a[56:59], a[216:219], v[228:231], a[56:59]
    v_exp_f32 v199, v199
    v_mfma_f32_16x16x32_bf16 a[60:63], a[220:223], v[228:231], a[60:63]
    v_mfma_f32_16x16x32_bf16 v[12:15], v[24:27], v[228:231], v[12:15]
    v_cvt_pk_bf16_f32 v244, v196, v197
    v_cvt_pk_bf16_f32 v245, v198, v199
    v_mfma_f32_16x16x32_bf16 a[64:67], a[192:195], v[232:235], a[64:67]
    ds_read_b128 a[176:179], v3 offset:28672
    ds_read_b128 a[180:183], v3 offset:29696
    v_mfma_f32_16x16x32_bf16 a[96:99], a[192:195], v[236:239], a[96:99]
    v_mfma_f32_16x16x32_bf16 a[100:103], a[196:199], v[236:239], a[100:103]
    v_exp_f32 v204, v204
    v_mfma_f32_16x16x32_bf16 a[68:71], a[196:199], v[232:235], a[68:71]
    v_exp_f32 v205, v205
    v_mfma_f32_16x16x32_bf16 a[72:75], a[200:203], v[232:235], a[72:75]
    v_exp_f32 v206, v206
    v_mfma_f32_16x16x32_bf16 a[104:107], a[200:203], v[236:239], a[104:107]
    v_mfma_f32_16x16x32_bf16 a[108:111], a[204:207], v[236:239], a[108:111]
    s_add_u32 m0, s93, 4096
    v_exp_f32 v207, v207
    v_mfma_f32_16x16x32_bf16 a[76:79], a[204:207], v[232:235], a[76:79]
    s_add_u32 s93, s93, 32768
    buffer_load_dwordx4 v4, s[36:39], s92 offen offset:0 sc1 lds
    v_mfma_f32_16x16x32_bf16 a[80:83], a[208:211], v[232:235], a[80:83]
    s_and_b32 s93, s93, 0x1ffff
    v_cvt_pk_bf16_f32 v246, v204, v205
    v_cvt_pk_bf16_f32 v247, v206, v207
    v_mfma_f32_16x16x32_bf16 a[112:115], a[208:211], v[236:239], a[112:115]
    v_mfma_f32_16x16x32_bf16 a[116:119], a[212:215], v[236:239], a[116:119]
    ds_read_b128 a[184:187], v3 offset:30720
    ds_read_b128 a[188:191], v3 offset:31744
    v_mfma_f32_16x16x32_bf16 a[84:87], a[212:215], v[232:235], a[84:87]
    v_exp_f32 v208, v208
    v_mfma_f32_16x16x32_bf16 a[88:91], a[216:219], v[232:235], a[88:91]
    v_mfma_f32_16x16x32_bf16 a[120:123], a[216:219], v[236:239], a[120:123]
    v_exp_f32 v209, v209
    v_mfma_f32_16x16x32_bf16 a[124:127], a[220:223], v[236:239], a[124:127]
    v_exp_f32 v210, v210
    v_mfma_f32_16x16x32_bf16 a[92:95], a[220:223], v[232:235], a[92:95]
    v_exp_f32 v211, v211
    v_mfma_f32_16x16x32_bf16 v[16:19], v[24:27], v[232:235], v[16:19]
    v_mfma_f32_16x16x32_bf16 v[20:23], v[24:27], v[236:239], v[20:23]
    buffer_load_dwordx4 v4, s[36:39], s92 offen offset:1024 sc1 lds
    v_mfma_f32_16x16x32_bf16 v[160:163], a[128:131], v[72:75], 0
    v_cvt_pk_bf16_f32 v248, v208, v209
    v_cvt_pk_bf16_f32 v249, v210, v211
    v_mfma_f32_16x16x32_bf16 v[164:167], a[128:131], v[76:79], 0
    v_mfma_f32_16x16x32_bf16 v[160:163], a[132:135], v[88:91], v[160:163]
    ds_read_b128 a[224:227], v3 offset:8192
    ds_read_b128 a[228:231], v3 offset:9216
    v_mfma_f32_16x16x32_bf16 v[164:167], a[132:135], v[92:95], v[164:167]
    v_exp_f32 v212, v212
    v_mfma_f32_16x16x32_bf16 v[160:163], a[136:139], v[104:107], v[160:163]
    v_exp_f32 v213, v213
    v_mfma_f32_16x16x32_bf16 v[164:167], a[136:139], v[108:111], v[164:167]
    v_mfma_f32_16x16x32_bf16 v[160:163], a[140:143], v[120:123], v[160:163]
    ds_read_b128 a[232:235], v3 offset:10240
    ds_read_b128 a[236:239], v3 offset:11264
    v_mfma_f32_16x16x32_bf16 v[164:167], a[140:143], v[124:127], v[164:167]
    v_exp_f32 v214, v214
    v_mfma_f32_16x16x32_bf16 v[168:171], a[144:147], v[72:75], 0
    v_exp_f32 v215, v215
    v_mfma_f32_16x16x32_bf16 v[172:175], a[144:147], v[76:79], 0
    v_mfma_f32_16x16x32_bf16 v[168:171], a[148:151], v[88:91], v[168:171]
    v_cvt_pk_bf16_f32 v252, v212, v213
    v_cvt_pk_bf16_f32 v253, v214, v215
    v_mfma_f32_16x16x32_bf16 v[172:175], a[148:151], v[92:95], v[172:175]
    ds_read_b128 a[240:243], v3 offset:12288
    ds_read_b128 a[244:247], v3 offset:13312
    v_mfma_f32_16x16x32_bf16 v[168:171], a[152:155], v[104:107], v[168:171]
    v_mfma_f32_16x16x32_bf16 v[172:175], a[152:155], v[108:111], v[172:175]
    v_exp_f32 v216, v216
    v_mfma_f32_16x16x32_bf16 v[168:171], a[156:159], v[120:123], v[168:171]
    v_exp_f32 v217, v217
    v_mfma_f32_16x16x32_bf16 v[172:175], a[156:159], v[124:127], v[172:175]
    s_waitcnt lgkmcnt(2)
    v_exp_f32 v218, v218
    v_mfma_f32_16x16x32_bf16 v[176:179], a[160:163], v[72:75], 0
    v_mfma_f32_16x16x32_bf16 v[180:183], a[160:163], v[76:79], 0
    v_exp_f32 v219, v219
    v_mfma_f32_16x16x32_bf16 v[176:179], a[164:167], v[88:91], v[176:179]
    buffer_load_dwordx4 v4, s[36:39], s92 offen offset:2048 sc1 lds
    v_mfma_f32_16x16x32_bf16 v[180:183], a[164:167], v[92:95], v[180:183]
    v_cvt_pk_bf16_f32 v250, v216, v217
    v_cvt_pk_bf16_f32 v251, v218, v219
    v_mfma_f32_16x16x32_bf16 v[176:179], a[168:171], v[104:107], v[176:179]
    v_mfma_f32_16x16x32_bf16 v[180:183], a[168:171], v[108:111], v[180:183]
    ds_read_b128 a[248:251], v3 offset:14336
    ds_read_b128 a[252:255], v3 offset:15360
    v_mfma_f32_16x16x32_bf16 v[176:179], a[172:175], v[120:123], v[176:179]
    v_exp_f32 v220, v220
    v_mfma_f32_16x16x32_bf16 v[180:183], a[172:175], v[124:127], v[180:183]
    v_mfma_f32_16x16x32_bf16 v[184:187], a[176:179], v[72:75], 0
    v_exp_f32 v221, v221
    v_mfma_f32_16x16x32_bf16 v[188:191], a[176:179], v[76:79], 0
    v_exp_f32 v222, v222
    v_mfma_f32_16x16x32_bf16 v[184:187], a[180:183], v[88:91], v[184:187]
    v_exp_f32 v223, v223
    v_mfma_f32_16x16x32_bf16 v[188:191], a[180:183], v[92:95], v[188:191]
    v_mfma_f32_16x16x32_bf16 v[184:187], a[184:187], v[104:107], v[184:187]
    buffer_load_dwordx4 v4, s[36:39], s92 offen offset:3072 sc1 lds
    v_mfma_f32_16x16x32_bf16 v[188:191], a[184:187], v[108:111], v[188:191]
    s_add_u32 s92, s92, 33792
    v_cvt_pk_bf16_f32 v254, v220, v221
    v_cvt_pk_bf16_f32 v255, v222, v223
    v_mfma_f32_16x16x32_bf16 v[184:187], a[188:191], v[120:123], v[184:187]
    v_mfma_f32_16x16x32_bf16 v[188:191], a[188:191], v[124:127], v[188:191]
    s_waitcnt vmcnt(37) lgkmcnt(0)
    v_mfma_f32_16x16x32_bf16 a[32:35], a[224:227], v[244:247], a[32:35]
    s_barrier
    v_add_u32 v3, s94, v2
    ds_read_b128 a[128:131], v3 offset:16384
    ds_read_b128 a[132:135], v3 offset:17408
    v_mfma_f32_16x16x32_bf16 a[36:39], a[228:231], v[244:247], a[36:39]
    s_add_u32 s94, s94, 32768
    ds_read_b128 a[136:139], v3 offset:18432
    ds_read_b128 a[140:143], v3 offset:19456
    v_mfma_f32_16x16x32_bf16 a[40:43], a[232:235], v[244:247], a[40:43]
    s_and_b32 s94, s94, 0x18000
    v_exp_f32 v160, v160
    v_mfma_f32_16x16x32_bf16 a[44:47], a[236:239], v[244:247], a[44:47]
    v_exp_f32 v161, v161
    v_mfma_f32_16x16x32_bf16 a[48:51], a[240:243], v[244:247], a[48:51]
    ds_read_b128 a[144:147], v3 offset:20480
    ds_read_b128 a[148:151], v3 offset:21504
    v_mfma_f32_16x16x32_bf16 a[52:55], a[244:247], v[244:247], a[52:55]
    v_exp_f32 v162, v162
    v_mfma_f32_16x16x32_bf16 a[56:59], a[248:251], v[244:247], a[56:59]
    s_add_u32 m0, s93, 0
    v_exp_f32 v163, v163
    v_mfma_f32_16x16x32_bf16 a[60:63], a[252:255], v[244:247], a[60:63]
    buffer_load_dwordx4 v2, s[36:39], s92 offen offset:0 sc1 lds
    v_mfma_f32_16x16x32_bf16 v[12:15], v[24:27], v[244:247], v[12:15]
    v_cvt_pk_bf16_f32 v224, v160, v161
    v_cvt_pk_bf16_f32 v225, v162, v163
    v_mfma_f32_16x16x32_bf16 a[64:67], a[224:227], v[248:251], a[64:67]
    ds_read_b128 a[152:155], v3 offset:22528
    ds_read_b128 a[156:159], v3 offset:23552
    v_exp_f32 v164, v164
    v_mfma_f32_16x16x32_bf16 a[96:99], a[224:227], v[252:255], a[96:99]
    v_exp_f32 v165, v165
    v_mfma_f32_16x16x32_bf16 a[100:103], a[228:231], v[252:255], a[100:103]
    ds_read_b128 a[160:163], v3 offset:24576
    ds_read_b128 a[164:167], v3 offset:25600
    v_mfma_f32_16x16x32_bf16 a[68:71], a[228:231], v[248:251], a[68:71]
    v_exp_f32 v166, v166
    v_mfma_f32_16x16x32_bf16 a[72:75], a[232:235], v[248:251], a[72:75]
    v_exp_f32 v167, v167
    v_mfma_f32_16x16x32_bf16 a[104:107], a[232:235], v[252:255], a[104:107]
    buffer_load_dwordx4 v2, s[36:39], s92 offen offset:1024 sc1 lds
    v_mfma_f32_16x16x32_bf16 a[108:111], a[236:239], v[252:255], a[108:111]
    v_cvt_pk_bf16_f32 v228, v164, v165
    v_cvt_pk_bf16_f32 v229, v166, v167
    v_mfma_f32_16x16x32_bf16 a[76:79], a[236:239], v[248:251], a[76:79]
    ds_read_b128 a[168:171], v3 offset:26624
    ds_read_b128 a[172:175], v3 offset:27648
    v_mfma_f32_16x16x32_bf16 a[80:83], a[240:243], v[248:251], a[80:83]
    v_exp_f32 v168, v168
    v_mfma_f32_16x16x32_bf16 a[112:115], a[240:243], v[252:255], a[112:115]
    v_exp_f32 v169, v169
    v_mfma_f32_16x16x32_bf16 a[116:119], a[244:247], v[252:255], a[116:119]
    ds_read_b128 a[176:179], v3 offset:28672
    ds_read_b128 a[180:183], v3 offset:29696
    v_exp_f32 v170, v170
    v_mfma_f32_16x16x32_bf16 a[84:87], a[244:247], v[248:251], a[84:87]
    v_exp_f32 v171, v171
    v_mfma_f32_16x16x32_bf16 a[88:91], a[248:251], v[248:251], a[88:91]
    buffer_load_dwordx4 v2, s[36:39], s92 offen offset:2048 sc1 lds
    v_mfma_f32_16x16x32_bf16 a[120:123], a[248:251], v[252:255], a[120:123]
    v_cvt_pk_bf16_f32 v226, v168, v169
    v_cvt_pk_bf16_f32 v227, v170, v171
    v_mfma_f32_16x16x32_bf16 a[124:127], a[252:255], v[252:255], a[124:127]
    ds_read_b128 a[184:187], v3 offset:30720
    ds_read_b128 a[188:191], v3 offset:31744
    v_mfma_f32_16x16x32_bf16 a[92:95], a[252:255], v[248:251], a[92:95]
    v_exp_f32 v172, v172
    v_mfma_f32_16x16x32_bf16 v[16:19], v[24:27], v[248:251], v[16:19]
    v_exp_f32 v173, v173
    v_mfma_f32_16x16x32_bf16 v[20:23], v[24:27], v[252:255], v[20:23]
    s_waitcnt lgkmcnt(2)
    ds_read_b128 a[192:195], v3 offset:0
    ds_read_b128 a[196:199], v3 offset:1024
    v_mfma_f32_16x16x32_bf16 v[192:195], a[128:131], v[72:75], 0
    v_exp_f32 v174, v174
    v_mfma_f32_16x16x32_bf16 v[196:199], a[128:131], v[76:79], 0
    v_exp_f32 v175, v175
    v_mfma_f32_16x16x32_bf16 v[192:195], a[132:135], v[88:91], v[192:195]
    buffer_load_dwordx4 v2, s[36:39], s92 offen offset:3072 sc1 lds
    v_cvt_pk_bf16_f32 v230, v172, v173
    v_cvt_pk_bf16_f32 v231, v174, v175
    v_mfma_f32_16x16x32_bf16 v[196:199], a[132:135], v[92:95], v[196:199]
    ds_read_b128 a[200:203], v3 offset:2048
    ds_read_b128 a[204:207], v3 offset:3072
    v_mfma_f32_16x16x32_bf16 v[192:195], a[136:139], v[104:107], v[192:195]
    v_exp_f32 v176, v176
    v_mfma_f32_16x16x32_bf16 v[196:199], a[136:139], v[108:111], v[196:199]
    v_exp_f32 v177, v177
    v_mfma_f32_16x16x32_bf16 v[192:195], a[140:143], v[120:123], v[192:195]
    ds_read_b128 a[208:211], v3 offset:4096
    ds_read_b128 a[212:215], v3 offset:5120
    v_mfma_f32_16x16x32_bf16 v[196:199], a[140:143], v[124:127], v[196:199]
    v_exp_f32 v178, v178
    v_mfma_f32_16x16x32_bf16 v[200:203], a[144:147], v[72:75], 0
    s_add_u32 m0, s93, 4096
    v_exp_f32 v179, v179
    v_mfma_f32_16x16x32_bf16 v[204:207], a[144:147], v[76:79], 0
    s_add_u32 s93, s93, 32768
    buffer_load_dwordx4 v4, s[36:39], s92 offen offset:0 sc1 lds
    v_mfma_f32_16x16x32_bf16 v[200:203], a[148:151], v[88:91], v[200:203]
    s_and_b32 s93, s93, 0x1ffff
    v_cvt_pk_bf16_f32 v232, v176, v177
    v_cvt_pk_bf16_f32 v233, v178, v179
    v_mfma_f32_16x16x32_bf16 v[204:207], a[148:151], v[92:95], v[204:207]
    ds_read_b128 a[216:219], v3 offset:6144
    ds_read_b128 a[220:223], v3 offset:7168
    v_mfma_f32_16x16x32_bf16 v[200:203], a[152:155], v[104:107], v[200:203]
    v_exp_f32 v180, v180
    v_exp_f32 v181, v181
    v_mfma_f32_16x16x32_bf16 v[204:207], a[152:155], v[108:111], v[204:207]
    ds_read_b128 a[224:227], v3 offset:8192
    ds_read_b128 a[228:231], v3 offset:9216
    v_mfma_f32_16x16x32_bf16 v[200:203], a[156:159], v[120:123], v[200:203]
    v_exp_f32 v182, v182
    v_mfma_f32_16x16x32_bf16 v[204:207], a[156:159], v[124:127], v[204:207]
    v_exp_f32 v183, v183
    v_mfma_f32_16x16x32_bf16 v[208:211], a[160:163], v[72:75], 0
    buffer_load_dwordx4 v4, s[36:39], s92 offen offset:1024 sc1 lds
    v_mfma_f32_16x16x32_bf16 v[212:215], a[160:163], v[76:79], 0
    v_cvt_pk_bf16_f32 v236, v180, v181
    v_cvt_pk_bf16_f32 v237, v182, v183
    v_mfma_f32_16x16x32_bf16 v[208:211], a[164:167], v[88:91], v[208:211]
    ds_read_b128 a[232:235], v3 offset:10240
    ds_read_b128 a[236:239], v3 offset:11264
    v_mfma_f32_16x16x32_bf16 v[212:215], a[164:167], v[92:95], v[212:215]
    v_exp_f32 v184, v184
    v_mfma_f32_16x16x32_bf16 v[208:211], a[168:171], v[104:107], v[208:211]
    v_exp_f32 v185, v185
    v_mfma_f32_16x16x32_bf16 v[212:215], a[168:171], v[108:111], v[212:215]
    ds_read_b128 a[240:243], v3 offset:12288
    ds_read_b128 a[244:247], v3 offset:13312
    v_mfma_f32_16x16x32_bf16 v[208:211], a[172:175], v[120:123], v[208:211]
    v_exp_f32 v186, v186
    v_exp_f32 v187, v187
    v_mfma_f32_16x16x32_bf16 v[212:215], a[172:175], v[124:127], v[212:215]
    buffer_load_dwordx4 v4, s[36:39], s92 offen offset:2048 sc1 lds
    v_mfma_f32_16x16x32_bf16 v[216:219], a[176:179], v[72:75], 0
    v_cvt_pk_bf16_f32 v234, v184, v185
    v_cvt_pk_bf16_f32 v235, v186, v187
    v_mfma_f32_16x16x32_bf16 v[220:223], a[176:179], v[76:79], 0
    ds_read_b128 a[248:251], v3 offset:14336
    ds_read_b128 a[252:255], v3 offset:15360
    v_mfma_f32_16x16x32_bf16 v[216:219], a[180:183], v[88:91], v[216:219]
    v_exp_f32 v188, v188
    v_mfma_f32_16x16x32_bf16 v[220:223], a[180:183], v[92:95], v[220:223]
    s_waitcnt lgkmcnt(2)
    v_exp_f32 v189, v189
    v_mfma_f32_16x16x32_bf16 v[216:219], a[184:187], v[104:107], v[216:219]
    v_exp_f32 v190, v190
    v_mfma_f32_16x16x32_bf16 v[220:223], a[184:187], v[108:111], v[220:223]
    v_exp_f32 v191, v191
    v_mfma_f32_16x16x32_bf16 v[216:219], a[188:191], v[120:123], v[216:219]
    buffer_load_dwordx4 v4, s[36:39], s92 offen offset:3072 sc1 lds
    v_mfma_f32_16x16x32_bf16 v[220:223], a[188:191], v[124:127], v[220:223]
    s_waitcnt vmcnt(37) lgkmcnt(0)
    v_cvt_pk_bf16_f32 v238, v188, v189
    v_cvt_pk_bf16_f32 v239, v190, v191
    s_add_u32 s92, s92, 33792
.p2align 4
AT_half:
    v_mfma_f32_16x16x32_bf16 a[64:67], a[192:195], v[224:227], a[64:67]
    s_barrier
    v_add_u32 v3, s94, v2
    v_mfma_f32_16x16x32_bf16 a[96:99], a[192:195], v[228:231], a[96:99]
    s_add_u32 s94, s94, 32768
    ds_read_b128 a[128:131], v3 offset:16384
    ds_read_b128 a[132:135], v3 offset:17408
    v_mfma_f32_16x16x32_bf16 a[100:103], a[196:199], v[228:231], a[100:103]
    s_and_b32 s94, s94, 0x18000
    ds_read_b128 a[136:139], v3 offset:18432
    ds_read_b128 a[140:143], v3 offset:19456
    v_mfma_f32_16x16x32_bf16 a[68:71], a[196:199], v[224:227], a[68:71]
    v_exp_f32 v192, v192
    v_mfma_f32_16x16x32_bf16 a[72:75], a[200:203], v[224:227], a[72:75]
    v_exp_f32 v193, v193
    v_mfma_f32_16x16x32_bf16 a[104:107], a[200:203], v[228:231], a[104:107]
    ds_read_b128 a[144:147], v3 offset:20480
    ds_read_b128 a[148:151], v3 offset:21504
    v_mfma_f32_16x16x32_bf16 a[108:111], a[204:207], v[228:231], a[108:111]
    v_exp_f32 v194, v194
    v_mfma_f32_16x16x32_bf16 a[76:79], a[204:207], v[224:227], a[76:79]
    s_add_u32 m0, s93, 0
    v_exp_f32 v195, v195
    v_mfma_f32_16x16x32_bf16 a[80:83], a[208:211], v[224:227], a[80:83]
    buffer_load_dwordx4 v2, s[36:39], s92 offen offset:0 sc1 lds
    v_mfma_f32_16x16x32_bf16 a[112:115], a[208:211], v[228:231], a[112:115]
    v_cvt_pk_bf16_f32 v240, v192, v193
    v_cvt_pk_bf16_f32 v241, v194, v195
    v_mfma_f32_16x16x32_bf16 a[116:119], a[212:215], v[228:231], a[116:119]
    ds_read_b128 a[152:155], v3 offset:22528
    ds_read_b128 a[156:159], v3 offset:23552
    v_mfma_f32_16x16x32_bf16 a[84:87], a[212:215], v[224:227], a[84:87]
    v_exp_f32 v196, v196
    v_mfma_f32_16x16x32_bf16 a[88:91], a[216:219], v[224:227], a[88:91]
    v_exp_f32 v197, v197
    v_mfma_f32_16x16x32_bf16 a[120:123], a[216:219], v[228:231], a[120:123]
    ds_read_b128 a[160:163], v3 offset:24576
    ds_read_b128 a[164:167], v3 offset:25600
    v_mfma_f32_16x16x32_bf16 a[124:127], a[220:223], v[228:231], a[124:127]
    v_exp_f32 v198, v198
    v_mfma_f32_16x16x32_bf16 a[92:95], a[220:223], v[224:227], a[92:95]
    v_exp_f32 v199, v199
    v_mfma_f32_16x16x32_bf16 v[16:19], v[24:27], v[224:227], v[16:19]
    buffer_load_dwordx4 v2, s[36:39], s92 offen offset:1024 sc1 lds
    v_mfma_f32_16x16x32_bf16 v[20:23], v[24:27], v[228:231], v[20:23]
    v_cvt_pk_bf16_f32 v244, v196, v197
    v_cvt_pk_bf16_f32 v245, v198, v199
    v_mfma_f32_16x16x32_bf16 a[64:67], a[224:227], v[232:235], a[64:67]
    ds_read_b128 a[168:171], v3 offset:26624
    ds_read_b128 a[172:175], v3 offset:27648
    v_mfma_f32_16x16x32_bf16 a[96:99], a[224:227], v[236:239], a[96:99]
    v_exp_f32 v200, v200
    v_mfma_f32_16x16x32_bf16 a[100:103], a[228:231], v[236:239], a[100:103]
    v_exp_f32 v201, v201
    v_mfma_f32_16x16x32_bf16 a[68:71], a[228:231], v[232:235], a[68:71]
    ds_read_b128 a[176:179], v3 offset:28672
    ds_read_b128 a[180:183], v3 offset:29696
    v_mfma_f32_16x16x32_bf16 a[72:75], a[232:235], v[232:235], a[72:75]
    v_exp_f32 v202, v202
    v_mfma_f32_16x16x32_bf16 a[104:107], a[232:235], v[236:239], a[104:107]
    v_exp_f32 v203, v203
    v_mfma_f32_16x16x32_bf16 a[108:111], a[236:239], v[236:239], a[108:111]
    buffer_load_dwordx4 v2, s[36:39], s92 offen offset:2048 sc1 lds
    v_mfma_f32_16x16x32_bf16 a[76:79], a[236:239], v[232:235], a[76:79]
    v_cvt_pk_bf16_f32 v242, v200, v201
    v_cvt_pk_bf16_f32 v243, v202, v203
    v_mfma_f32_16x16x32_bf16 a[80:83], a[240:243], v[232:235], a[80:83]
    ds_read_b128 a[184:187], v3 offset:30720
    ds_read_b128 a[188:191], v3 offset:31744
    v_mfma_f32_16x16x32_bf16 a[112:115], a[240:243], v[236:239], a[112:115]
    v_exp_f32 v204, v204
    v_mfma_f32_16x16x32_bf16 a[116:119], a[244:247], v[236:239], a[116:119]
    v_exp_f32 v205, v205
    v_mfma_f32_16x16x32_bf16 a[84:87], a[244:247], v[232:235], a[84:87]
    ds_read_b128 a[192:195], v3 offset:0
    ds_read_b128 a[196:199], v3 offset:1024
    v_mfma_f32_16x16x32_bf16 a[88:91], a[248:251], v[232:235], a[88:91]
    v_exp_f32 v206, v206
    v_mfma_f32_16x16x32_bf16 a[120:123], a[248:251], v[236:239], a[120:123]
    v_exp_f32 v207, v207
    v_mfma_f32_16x16x32_bf16 a[124:127], a[252:255], v[236:239], a[124:127]
    buffer_load_dwordx4 v2, s[36:39], s92 offen offset:3072 sc1 lds
    v_mfma_f32_16x16x32_bf16 a[92:95], a[252:255], v[232:235], a[92:95]
    v_mfma_f32_16x16x32_bf16 v[16:19], v[24:27], v[232:235], v[16:19]
    v_cvt_pk_bf16_f32 v246, v204, v205
    v_cvt_pk_bf16_f32 v247, v206, v207
    v_mfma_f32_16x16x32_bf16 v[20:23], v[24:27], v[236:239], v[20:23]
    s_waitcnt lgkmcnt(0)
    ds_read_b128 a[200:203], v3 offset:2048
    ds_read_b128 a[204:207], v3 offset:3072
    v_mfma_f32_16x16x32_bf16 v[160:163], a[128:131], v[72:75], 0
    v_exp_f32 v208, v208
    v_mfma_f32_16x16x32_bf16 v[164:167], a[128:131], v[76:79], 0
    v_exp_f32 v209, v209
    v_mfma_f32_16x16x32_bf16 v[160:163], a[132:135], v[88:91], v[160:163]
    ds_read_b128 a[208:211], v3 offset:4096
    ds_read_b128 a[212:215], v3 offset:5120
    v_mfma_f32_16x16x32_bf16 v[164:167], a[132:135], v[92:95], v[164:167]
    v_exp_f32 v210, v210
    v_mfma_f32_16x16x32_bf16 v[160:163], a[136:139], v[104:107], v[160:163]
    s_add_u32 m0, s93, 4096
    v_exp_f32 v211, v211
    v_mfma_f32_16x16x32_bf16 v[164:167], a[136:139], v[108:111], v[164:167]
    s_add_u32 s93, s93, 32768
    buffer_load_dwordx4 v4, s[36:39], s92 offen offset:0 sc1 lds
    v_mfma_f32_16x16x32_bf16 v[160:163], a[140:143], v[120:123], v[160:163]
    s_and_b32 s93, s93, 0x1ffff
    v_cvt_pk_bf16_f32 v248, v208, v209
    v_cvt_pk_bf16_f32 v249, v210, v211
    v_mfma_f32_16x16x32_bf16 v[164:167], a[140:143], v[124:127], v[164:167]
    ds_read_b128 a[216:219], v3 offset:6144
    ds_read_b128 a[220:223], v3 offset:7168
    v_mfma_f32_16x16x32_bf16 v[168:171], a[144:147], v[72:75], 0
    v_exp_f32 v212, v212
    v_mfma_f32_16x16x32_bf16 v[172:175], a[144:147], v[76:79], 0
    v_exp_f32 v213, v213
    v_mfma_f32_16x16x32_bf16 v[168:171], a[148:151], v[88:91], v[168:171]
    ds_read_b128 a[224:227], v3 offset:8192
    ds_read_b128 a[228:231], v3 offset:9216
    v_mfma_f32_16x16x32_bf16 v[172:175], a[148:151], v[92:95], v[172:175]
    v_exp_f32 v214, v214
    v_mfma_f32_16x16x32_bf16 v[168:171], a[152:155], v[104:107], v[168:171]
    v_exp_f32 v215, v215
    v_mfma_f32_16x16x32_bf16 v[172:175], a[152:155], v[108:111], v[172:175]
    buffer_load_dwordx4 v4, s[36:39], s92 offen offset:1024 sc1 lds
    v_mfma_f32_16x16x32_bf16 v[168:171], a[156:159], v[120:123], v[168:171]
    v_cvt_pk_bf16_f32 v252, v212, v213
    v_cvt_pk_bf16_f32 v253, v214, v215
    v_mfma_f32_16x16x32_bf16 v[172:175], a[156:159], v[124:127], v[172:175]
    ds_read_b128 a[232:235], v3 offset:10240
    ds_read_b128 a[236:239], v3 offset:11264
    v_mfma_f32_16x16x32_bf16 v[176:179], a[160:163], v[72:75], 0
    v_exp_f32 v216, v216
    v_mfma_f32_16x16x32_bf16 v[180:183], a[160:163], v[76:79], 0
    v_exp_f32 v217, v217
    v_mfma_f32_16x16x32_bf16 v[176:179], a[164:167], v[88:91], v[176:179]
    ds_read_b128 a[240:243], v3 offset:12288
    ds_read_b128 a[244:247], v3 offset:13312
    v_mfma_f32_16x16x32_bf16 v[180:183], a[164:167], v[92:95], v[180:183]
    v_exp_f32 v218, v218
    v_mfma_f32_16x16x32_bf16 v[176:179], a[168:171], v[104:107], v[176:179]
    v_exp_f32 v219, v219
    v_mfma_f32_16x16x32_bf16 v[180:183], a[168:171], v[108:111], v[180:183]
    buffer_load_dwordx4 v4, s[36:39], s92 offen offset:2048 sc1 lds
    v_mfma_f32_16x16x32_bf16 v[176:179], a[172:175], v[120:123], v[176:179]
    v_cvt_pk_bf16_f32 v250, v216, v217
    v_cvt_pk_bf16_f32 v251, v218, v219
    v_mfma_f32_16x16x32_bf16 v[180:183], a[172:175], v[124:127], v[180:183]
    ds_read_b128 a[248:251], v3 offset:14336
    ds_read_b128 a[252:255], v3 offset:15360
    v_mfma_f32_16x16x32_bf16 v[184:187], a[176:179], v[72:75], 0
    v_exp_f32 v220, v220
    v_mfma_f32_16x16x32_bf16 v[188:191], a[176:179], v[76:79], 0
    v_exp_f32 v221, v221
    v_mfma_f32_16x16x32_bf16 v[184:187], a[180:183], v[88:91], v[184:187]
    v_exp_f32 v222, v222
    v_mfma_f32_16x16x32_bf16 v[188:191], a[180:183], v[92:95], v[188:191]
    v_exp_f32 v223, v223
    v_mfma_f32_16x16x32_bf16 v[184:187], a[184:187], v[104:107], v[184:187]
    buffer_load_dwordx4 v4, s[36:39], s92 offen offset:3072 sc1 lds
    v_mfma_f32_16x16x32_bf16 v[188:191], a[184:187], v[108:111], v[188:191]
    s_add_u32 s92, s92, 33792
    v_cvt_pk_bf16_f32 v254, v220, v221
    v_cvt_pk_bf16_f32 v255, v222, v223
    v_mfma_f32_16x16x32_bf16 v[184:187], a[188:191], v[120:123], v[184:187]
    v_mfma_f32_16x16x32_bf16 v[188:191], a[188:191], v[124:127], v[188:191]
    s_waitcnt vmcnt(16) lgkmcnt(0)
    v_mfma_f32_16x16x32_bf16 a[64:67], a[192:195], v[240:243], a[64:67]
    s_barrier
    v_add_u32 v3, s94, v2
    v_mfma_f32_16x16x32_bf16 a[96:99], a[192:195], v[244:247], a[96:99]
    s_add_u32 s94, s94, 32768
    ds_read_b128 a[128:131], v3 offset:16384
    ds_read_b128 a[132:135], v3 offset:17408
    v_mfma_f32_16x16x32_bf16 a[100:103], a[196:199], v[244:247], a[100:103]
    s_and_b32 s94, s94, 0x18000
    ds_read_b128 a[136:139], v3 offset:18432
    ds_read_b128 a[140:143], v3 offset:19456
    v_mfma_f32_16x16x32_bf16 a[68:71], a[196:199], v[240:243], a[68:71]
    v_exp_f32 v160, v160
    v_mfma_f32_16x16x32_bf16 a[72:75], a[200:203], v[240:243], a[72:75]
    v_exp_f32 v161, v161
    v_mfma_f32_16x16x32_bf16 a[104:107], a[200:203], v[244:247], a[104:107]
    ds_read_b128 a[144:147], v3 offset:20480
    ds_read_b128 a[148:151], v3 offset:21504
    v_mfma_f32_16x16x32_bf16 a[108:111], a[204:207], v[244:247], a[108:111]
    v_exp_f32 v162, v162
    v_mfma_f32_16x16x32_bf16 a[76:79], a[204:207], v[240:243], a[76:79]
    s_add_u32 m0, s93, 0
    v_exp_f32 v163, v163
    v_mfma_f32_16x16x32_bf16 a[80:83], a[208:211], v[240:243], a[80:83]
    buffer_load_dwordx4 v2, s[36:39], s92 offen offset:0 sc1 lds
    v_mfma_f32_16x16x32_bf16 a[112:115], a[208:211], v[244:247], a[112:115]
    v_cvt_pk_bf16_f32 v224, v160, v161
    v_cvt_pk_bf16_f32 v225, v162, v163
    v_mfma_f32_16x16x32_bf16 a[116:119], a[212:215], v[244:247], a[116:119]
    ds_read_b128 a[152:155], v3 offset:22528
    ds_read_b128 a[156:159], v3 offset:23552
    v_mfma_f32_16x16x32_bf16 a[84:87], a[212:215], v[240:243], a[84:87]
    v_exp_f32 v164, v164
    v_mfma_f32_16x16x32_bf16 a[88:91], a[216:219], v[240:243], a[88:91]
    v_exp_f32 v165, v165
    v_mfma_f32_16x16x32_bf16 a[120:123], a[216:219], v[244:247], a[120:123]
    ds_read_b128 a[160:163], v3 offset:24576
    ds_read_b128 a[164:167], v3 offset:25600
    v_mfma_f32_16x16x32_bf16 a[124:127], a[220:223], v[244:247], a[124:127]
    v_exp_f32 v166, v166
    v_mfma_f32_16x16x32_bf16 a[92:95], a[220:223], v[240:243], a[92:95]
    v_exp_f32 v167, v167
    v_mfma_f32_16x16x32_bf16 v[16:19], v[24:27], v[240:243], v[16:19]
    buffer_load_dwordx4 v2, s[36:39], s92 offen offset:1024 sc1 lds
    v_mfma_f32_16x16x32_bf16 v[20:23], v[24:27], v[244:247], v[20:23]
    v_cvt_pk_bf16_f32 v228, v164, v165
    v_cvt_pk_bf16_f32 v229, v166, v167
    v_mfma_f32_16x16x32_bf16 a[64:67], a[224:227], v[248:251], a[64:67]
    ds_read_b128 a[168:171], v3 offset:26624
    ds_read_b128 a[172:175], v3 offset:27648
    v_mfma_f32_16x16x32_bf16 a[96:99], a[224:227], v[252:255], a[96:99]
    v_exp_f32 v168, v168
    v_mfma_f32_16x16x32_bf16 a[100:103], a[228:231], v[252:255], a[100:103]
    v_exp_f32 v169, v169
    v_mfma_f32_16x16x32_bf16 a[68:71], a[228:231], v[248:251], a[68:71]
    ds_read_b128 a[176:179], v3 offset:28672
    ds_read_b128 a[180:183], v3 offset:29696
    v_mfma_f32_16x16x32_bf16 a[72:75], a[232:235], v[248:251], a[72:75]
    v_exp_f32 v170, v170
    v_mfma_f32_16x16x32_bf16 a[104:107], a[232:235], v[252:255], a[104:107]
    v_exp_f32 v171, v171
    v_mfma_f32_16x16x32_bf16 a[108:111], a[236:239], v[252:255], a[108:111]
    buffer_load_dwordx4 v2, s[36:39], s92 offen offset:2048 sc1 lds
    v_mfma_f32_16x16x32_bf16 a[76:79], a[236:239], v[248:251], a[76:79]
    v_cvt_pk_bf16_f32 v226, v168, v169
    v_cvt_pk_bf16_f32 v227, v170, v171
    v_mfma_f32_16x16x32_bf16 a[80:83], a[240:243], v[248:251], a[80:83]
    ds_read_b128 a[184:187], v3 offset:30720
    ds_read_b128 a[188:191], v3 offset:31744
    v_mfma_f32_16x16x32_bf16 a[112:115], a[240:243], v[252:255], a[112:115]
    v_exp_f32 v172, v172
    v_mfma_f32_16x16x32_bf16 a[116:119], a[244:247], v[252:255], a[116:119]
    v_exp_f32 v173, v173
    v_mfma_f32_16x16x32_bf16 a[84:87], a[244:247], v[248:251], a[84:87]
    ds_read_b128 a[192:195], v3 offset:0
    ds_read_b128 a[196:199], v3 offset:1024
    v_mfma_f32_16x16x32_bf16 a[88:91], a[248:251], v[248:251], a[88:91]
    v_exp_f32 v174, v174
    v_mfma_f32_16x16x32_bf16 a[120:123], a[248:251], v[252:255], a[120:123]
    v_exp_f32 v175, v175
    v_mfma_f32_16x16x32_bf16 a[124:127], a[252:255], v[252:255], a[124:127]
    buffer_load_dwordx4 v2, s[36:39], s92 offen offset:3072 sc1 lds
    v_mfma_f32_16x16x32_bf16 a[92:95], a[252:255], v[248:251], a[92:95]
    v_mfma_f32_16x16x32_bf16 v[16:19], v[24:27], v[248:251], v[16:19]
    v_cvt_pk_bf16_f32 v230, v172, v173
    v_cvt_pk_bf16_f32 v231, v174, v175
    v_mfma_f32_16x16x32_bf16 v[20:23], v[24:27], v[252:255], v[20:23]
    s_waitcnt lgkmcnt(0)
    ds_read_b128 a[200:203], v3 offset:2048
    ds_read_b128 a[204:207], v3 offset:3072
    v_mfma_f32_16x16x32_bf16 v[192:195], a[128:131], v[72:75], 0
    v_exp_f32 v176, v176
    v_mfma_f32_16x16x32_bf16 v[196:199], a[128:131], v[76:79], 0
    v_exp_f32 v177, v177
    v_mfma_f32_16x16x32_bf16 v[192:195], a[132:135], v[88:91], v[192:195]
    ds_read_b128 a[208:211], v3 offset:4096
    ds_read_b128 a[212:215], v3 offset:5120
    v_mfma_f32_16x16x32_bf16 v[196:199], a[132:135], v[92:95], v[196:199]
    v_exp_f32 v178, v178
    v_mfma_f32_16x16x32_bf16 v[192:195], a[136:139], v[104:107], v[192:195]
    s_add_u32 m0, s93, 4096
    v_exp_f32 v179, v179
    v_mfma_f32_16x16x32_bf16 v[196:199], a[136:139], v[108:111], v[196:199]
    s_add_u32 s93, s93, 32768
    buffer_load_dwordx4 v4, s[36:39], s92 offen offset:0 sc1 lds
    v_mfma_f32_16x16x32_bf16 v[192:195], a[140:143], v[120:123], v[192:195]
    s_and_b32 s93, s93, 0x1ffff
    v_cvt_pk_bf16_f32 v232, v176, v177
    v_cvt_pk_bf16_f32 v233, v178, v179
    v_mfma_f32_16x16x32_bf16 v[196:199], a[140:143], v[124:127], v[196:199]
    ds_read_b128 a[216:219], v3 offset:6144
    ds_read_b128 a[220:223], v3 offset:7168
    v_mfma_f32_16x16x32_bf16 v[200:203], a[144:147], v[72:75], 0
    v_exp_f32 v180, v180
    v_mfma_f32_16x16x32_bf16 v[204:207], a[144:147], v[76:79], 0
    v_exp_f32 v181, v181
    v_mfma_f32_16x16x32_bf16 v[200:203], a[148:151], v[88:91], v[200:203]
    ds_read_b128 a[224:227], v3 offset:8192
    ds_read_b128 a[228:231], v3 offset:9216
    v_mfma_f32_16x16x32_bf16 v[204:207], a[148:151], v[92:95], v[204:207]
    v_exp_f32 v182, v182
    v_mfma_f32_16x16x32_bf16 v[200:203], a[152:155], v[104:107], v[200:203]
    v_exp_f32 v183, v183
    v_mfma_f32_16x16x32_bf16 v[204:207], a[152:155], v[108:111], v[204:207]
    buffer_load_dwordx4 v4, s[36:39], s92 offen offset:1024 sc1 lds
    v_mfma_f32_16x16x32_bf16 v[200:203], a[156:159], v[120:123], v[200:203]
    v_cvt_pk_bf16_f32 v236, v180, v181
    v_cvt_pk_bf16_f32 v237, v182, v183
    v_mfma_f32_16x16x32_bf16 v[204:207], a[156:159], v[124:127], v[204:207]
    ds_read_b128 a[232:235], v3 offset:10240
    ds_read_b128 a[236:239], v3 offset:11264
    v_mfma_f32_16x16x32_bf16 v[208:211], a[160:163], v[72:75], 0
    v_exp_f32 v184, v184
    v_mfma_f32_16x16x32_bf16 v[212:215], a[160:163], v[76:79], 0
    v_exp_f32 v185, v185
    v_mfma_f32_16x16x32_bf16 v[208:211], a[164:167], v[88:91], v[208:211]
    ds_read_b128 a[240:243], v3 offset:12288
    ds_read_b128 a[244:247], v3 offset:13312
    v_mfma_f32_16x16x32_bf16 v[212:215], a[164:167], v[92:95], v[212:215]
    v_exp_f32 v186, v186
    v_mfma_f32_16x16x32_bf16 v[208:211], a[168:171], v[104:107], v[208:211]
    v_exp_f32 v187, v187
    v_mfma_f32_16x16x32_bf16 v[212:215], a[168:171], v[108:111], v[212:215]
    buffer_load_dwordx4 v4, s[36:39], s92 offen offset:2048 sc1 lds
    v_mfma_f32_16x16x32_bf16 v[208:211], a[172:175], v[120:123], v[208:211]
    v_cvt_pk_bf16_f32 v234, v184, v185
    v_cvt_pk_bf16_f32 v235, v186, v187
    v_mfma_f32_16x16x32_bf16 v[212:215], a[172:175], v[124:127], v[212:215]
    ds_read_b128 a[248:251], v3 offset:14336
    ds_read_b128 a[252:255], v3 offset:15360
    v_mfma_f32_16x16x32_bf16 v[216:219], a[176:179], v[72:75], 0
    v_exp_f32 v188, v188
    v_mfma_f32_16x16x32_bf16 v[220:223], a[176:179], v[76:79], 0
    v_exp_f32 v189, v189
    v_mfma_f32_16x16x32_bf16 v[216:219], a[180:183], v[88:91], v[216:219]
    v_exp_f32 v190, v190
    v_mfma_f32_16x16x32_bf16 v[220:223], a[180:183], v[92:95], v[220:223]
    v_exp_f32 v191, v191
    v_mfma_f32_16x16x32_bf16 v[216:219], a[184:187], v[104:107], v[216:219]
    buffer_load_dwordx4 v4, s[36:39], s92 offen offset:3072 sc1 lds
    v_mfma_f32_16x16x32_bf16 v[220:223], a[184:187], v[108:111], v[220:223]
    s_add_u32 s92, s92, 33792
    v_cvt_pk_bf16_f32 v238, v188, v189
    v_cvt_pk_bf16_f32 v239, v190, v191
    v_mfma_f32_16x16x32_bf16 v[216:219], a[188:191], v[120:123], v[216:219]
    v_mfma_f32_16x16x32_bf16 v[220:223], a[188:191], v[124:127], v[220:223]
    s_waitcnt vmcnt(16) lgkmcnt(0)
    s_sub_u32 s95, s95, 1
    s_cmp_lg_u32 s95, 0
    s_cbranch_scc1 AT_half
    v_mfma_f32_16x16x32_bf16 a[64:67], a[192:195], v[224:227], a[64:67]
    s_barrier
    v_add_u32 v3, s94, v2
    v_mfma_f32_16x16x32_bf16 a[96:99], a[192:195], v[228:231], a[96:99]
    s_add_u32 s94, s94, 32768
    ds_read_b128 a[128:131], v3 offset:16384
    ds_read_b128 a[132:135], v3 offset:17408
    v_mfma_f32_16x16x32_bf16 a[100:103], a[196:199], v[228:231], a[100:103]
    s_and_b32 s94, s94, 0x18000
    ds_read_b128 a[136:139], v3 offset:18432
    ds_read_b128 a[140:143], v3 offset:19456
    v_mfma_f32_16x16x32_bf16 a[68:71], a[196:199], v[224:227], a[68:71]
    v_exp_f32 v192, v192
    v_mfma_f32_16x16x32_bf16 a[72:75], a[200:203], v[224:227], a[72:75]
    v_exp_f32 v193, v193
    v_mfma_f32_16x16x32_bf16 a[104:107], a[200:203], v[228:231], a[104:107]
    ds_read_b128 a[144:147], v3 offset:20480
    ds_read_b128 a[148:151], v3 offset:21504
    v_mfma_f32_16x16x32_bf16 a[108:111], a[204:207], v[228:231], a[108:111]
    v_exp_f32 v194, v194
    v_mfma_f32_16x16x32_bf16 a[76:79], a[204:207], v[224:227], a[76:79]
    v_exp_f32 v195, v195
    v_mfma_f32_16x16x32_bf16 a[80:83], a[208:211], v[224:227], a[80:83]
    buffer_load_dword v34, v33, s[88:91], 0 offen sc1
    v_mfma_f32_16x16x32_bf16 a[112:115], a[208:211], v[228:231], a[112:115]
    v_cvt_pk_bf16_f32 v240, v192, v193
    v_cvt_pk_bf16_f32 v241, v194, v195
    v_mfma_f32_16x16x32_bf16 a[116:119], a[212:215], v[228:231], a[116:119]
    ds_read_b128 a[152:155], v3 offset:22528
    ds_read_b128 a[156:159], v3 offset:23552
    v_mfma_f32_16x16x32_bf16 a[84:87], a[212:215], v[224:227], a[84:87]
    v_exp_f32 v196, v196
    v_mfma_f32_16x16x32_bf16 a[88:91], a[216:219], v[224:227], a[88:91]
    v_exp_f32 v197, v197
    v_mfma_f32_16x16x32_bf16 a[120:123], a[216:219], v[228:231], a[120:123]
    ds_read_b128 a[160:163], v3 offset:24576
    ds_read_b128 a[164:167], v3 offset:25600
    v_mfma_f32_16x16x32_bf16 a[124:127], a[220:223], v[228:231], a[124:127]
    v_exp_f32 v198, v198
    v_mfma_f32_16x16x32_bf16 a[92:95], a[220:223], v[224:227], a[92:95]
    s_add_u32 m0, s84, 32768
    v_exp_f32 v199, v199
    v_mfma_f32_16x16x32_bf16 v[16:19], v[24:27], v[224:227], v[16:19]
    buffer_load_dwordx4 v28, s[8:11], s45 offen offset:0 lds
    v_mfma_f32_16x16x32_bf16 v[20:23], v[24:27], v[228:231], v[20:23]
    v_cvt_pk_bf16_f32 v244, v196, v197
    v_cvt_pk_bf16_f32 v245, v198, v199
    v_mfma_f32_16x16x32_bf16 a[64:67], a[224:227], v[232:235], a[64:67]
    ds_read_b128 a[168:171], v3 offset:26624
    ds_read_b128 a[172:175], v3 offset:27648
    v_mfma_f32_16x16x32_bf16 a[96:99], a[224:227], v[236:239], a[96:99]
    v_exp_f32 v200, v200
    v_mfma_f32_16x16x32_bf16 a[100:103], a[228:231], v[236:239], a[100:103]
    v_exp_f32 v201, v201
    v_mfma_f32_16x16x32_bf16 a[68:71], a[228:231], v[232:235], a[68:71]
    ds_read_b128 a[176:179], v3 offset:28672
    ds_read_b128 a[180:183], v3 offset:29696
    v_mfma_f32_16x16x32_bf16 a[72:75], a[232:235], v[232:235], a[72:75]
    v_exp_f32 v202, v202
    v_mfma_f32_16x16x32_bf16 a[104:107], a[232:235], v[236:239], a[104:107]
    v_exp_f32 v203, v203
    v_mfma_f32_16x16x32_bf16 a[108:111], a[236:239], v[236:239], a[108:111]
    buffer_load_dwordx4 v29, s[8:11], s45 offen offset:1024 lds
    v_mfma_f32_16x16x32_bf16 a[76:79], a[236:239], v[232:235], a[76:79]
    v_cvt_pk_bf16_f32 v242, v200, v201
    v_cvt_pk_bf16_f32 v243, v202, v203
    v_mfma_f32_16x16x32_bf16 a[80:83], a[240:243], v[232:235], a[80:83]
    ds_read_b128 a[184:187], v3 offset:30720
    ds_read_b128 a[188:191], v3 offset:31744
    v_mfma_f32_16x16x32_bf16 a[112:115], a[240:243], v[236:239], a[112:115]
    v_exp_f32 v204, v204
    v_mfma_f32_16x16x32_bf16 a[116:119], a[244:247], v[236:239], a[116:119]
    v_exp_f32 v205, v205
    v_mfma_f32_16x16x32_bf16 a[84:87], a[244:247], v[232:235], a[84:87]
    ds_read_b128 a[192:195], v3 offset:0
    ds_read_b128 a[196:199], v3 offset:1024
    v_mfma_f32_16x16x32_bf16 a[88:91], a[248:251], v[232:235], a[88:91]
    v_exp_f32 v206, v206
    v_mfma_f32_16x16x32_bf16 a[120:123], a[248:251], v[236:239], a[120:123]
    v_exp_f32 v207, v207
    v_mfma_f32_16x16x32_bf16 a[124:127], a[252:255], v[236:239], a[124:127]
    buffer_load_dwordx4 v30, s[8:11], s45 offen offset:2048 lds
    v_mfma_f32_16x16x32_bf16 a[92:95], a[252:255], v[232:235], a[92:95]
    v_cvt_pk_bf16_f32 v246, v204, v205
    v_cvt_pk_bf16_f32 v247, v206, v207
    v_mfma_f32_16x16x32_bf16 v[16:19], v[24:27], v[232:235], v[16:19]
    ds_read_b128 a[200:203], v3 offset:2048
    ds_read_b128 a[204:207], v3 offset:3072
    v_mfma_f32_16x16x32_bf16 v[20:23], v[24:27], v[236:239], v[20:23]
    s_waitcnt lgkmcnt(2)
    v_exp_f32 v208, v208
    v_mfma_f32_16x16x32_bf16 v[160:163], a[128:131], v[72:75], v[128:131]
    v_exp_f32 v209, v209
    v_mfma_f32_16x16x32_bf16 v[164:167], a[128:131], v[76:79], 0
    ds_read_b128 a[208:211], v3 offset:4096
    ds_read_b128 a[212:215], v3 offset:5120
    v_mfma_f32_16x16x32_bf16 v[160:163], a[132:135], v[88:91], v[160:163]
    v_exp_f32 v210, v210
    v_mfma_f32_16x16x32_bf16 v[164:167], a[132:135], v[92:95], v[164:167]
    v_exp_f32 v211, v211
    v_mfma_f32_16x16x32_bf16 v[160:163], a[136:139], v[104:107], v[160:163]
    buffer_load_dwordx4 v31, s[8:11], s45 offen offset:3072 lds
    v_mfma_f32_16x16x32_bf16 v[164:167], a[136:139], v[108:111], v[164:167]
    v_cvt_pk_bf16_f32 v248, v208, v209
    v_cvt_pk_bf16_f32 v249, v210, v211
    v_mfma_f32_16x16x32_bf16 v[160:163], a[140:143], v[120:123], v[160:163]
    ds_read_b128 a[216:219], v3 offset:6144
    ds_read_b128 a[220:223], v3 offset:7168
    v_mfma_f32_16x16x32_bf16 v[164:167], a[140:143], v[124:127], v[164:167]
    v_exp_f32 v212, v212
    v_mfma_f32_16x16x32_bf16 v[168:171], a[144:147], v[72:75], v[132:135]
    v_exp_f32 v213, v213
    v_mfma_f32_16x16x32_bf16 v[172:175], a[144:147], v[76:79], 0
    ds_read_b128 a[224:227], v3 offset:8192
    ds_read_b128 a[228:231], v3 offset:9216
    v_mfma_f32_16x16x32_bf16 v[168:171], a[148:151], v[88:91], v[168:171]
    v_exp_f32 v214, v214
    v_mfma_f32_16x16x32_bf16 v[172:175], a[148:151], v[92:95], v[172:175]
    s_add_u32 m0, s84, 36864
    v_exp_f32 v215, v215
    v_mfma_f32_16x16x32_bf16 v[168:171], a[152:155], v[104:107], v[168:171]
    s_add_u32 s45, s45, 20480
    buffer_load_dwordx4 v28, s[8:11], s45 offen offset:0 lds
    v_mfma_f32_16x16x32_bf16 v[172:175], a[152:155], v[108:111], v[172:175]
    v_cvt_pk_bf16_f32 v252, v212, v213
    v_cvt_pk_bf16_f32 v253, v214, v215
    v_mfma_f32_16x16x32_bf16 v[168:171], a[156:159], v[120:123], v[168:171]
    ds_read_b128 a[232:235], v3 offset:10240
    ds_read_b128 a[236:239], v3 offset:11264
    v_mfma_f32_16x16x32_bf16 v[172:175], a[156:159], v[124:127], v[172:175]
    v_exp_f32 v216, v216
    v_mfma_f32_16x16x32_bf16 v[176:179], a[160:163], v[72:75], v[136:139]
    v_exp_f32 v217, v217
    v_mfma_f32_16x16x32_bf16 v[180:183], a[160:163], v[76:79], 0
    ds_read_b128 a[240:243], v3 offset:12288
    ds_read_b128 a[244:247], v3 offset:13312
    v_mfma_f32_16x16x32_bf16 v[176:179], a[164:167], v[88:91], v[176:179]
    v_exp_f32 v218, v218
    v_mfma_f32_16x16x32_bf16 v[180:183], a[164:167], v[92:95], v[180:183]
    v_exp_f32 v219, v219
    v_mfma_f32_16x16x32_bf16 v[176:179], a[168:171], v[104:107], v[176:179]
    buffer_load_dwordx4 v29, s[8:11], s45 offen offset:1024 lds
    v_mfma_f32_16x16x32_bf16 v[180:183], a[168:171], v[108:111], v[180:183]
    v_cvt_pk_bf16_f32 v250, v216, v217
    v_cvt_pk_bf16_f32 v251, v218, v219
    v_mfma_f32_16x16x32_bf16 v[176:179], a[172:175], v[120:123], v[176:179]
    ds_read_b128 a[248:251], v3 offset:14336
    ds_read_b128 a[252:255], v3 offset:15360
    v_mfma_f32_16x16x32_bf16 v[180:183], a[172:175], v[124:127], v[180:183]
    v_exp_f32 v220, v220
    v_mfma_f32_16x16x32_bf16 v[184:187], a[176:179], v[72:75], v[140:143]
    v_exp_f32 v221, v221
    v_mfma_f32_16x16x32_bf16 v[188:191], a[176:179], v[76:79], 0
    v_exp_f32 v222, v222
    v_mfma_f32_16x16x32_bf16 v[184:187], a[180:183], v[88:91], v[184:187]
    v_exp_f32 v223, v223
    v_mfma_f32_16x16x32_bf16 v[188:191], a[180:183], v[92:95], v[188:191]
    buffer_load_dwordx4 v30, s[8:11], s45 offen offset:2048 lds
    v_mfma_f32_16x16x32_bf16 v[184:187], a[184:187], v[104:107], v[184:187]
    buffer_load_dwordx4 v31, s[8:11], s45 offen offset:3072 lds
    v_mfma_f32_16x16x32_bf16 v[188:191], a[184:187], v[108:111], v[188:191]
    v_cvt_pk_bf16_f32 v254, v220, v221
    v_cvt_pk_bf16_f32 v255, v222, v223
    v_mfma_f32_16x16x32_bf16 v[184:187], a[188:191], v[120:123], v[184:187]
    v_mfma_f32_16x16x32_bf16 v[188:191], a[188:191], v[124:127], v[188:191]
    s_waitcnt vmcnt(17) lgkmcnt(0)
    v_mfma_f32_16x16x32_bf16 a[64:67], a[192:195], v[240:243], a[64:67]
    s_barrier
    v_add_u32 v3, s94, v2
    ds_read_b128 a[128:131], v3 offset:16384
    ds_read_b128 a[132:135], v3 offset:17408
    v_mfma_f32_16x16x32_bf16 a[96:99], a[192:195], v[244:247], a[96:99]
    s_add_u32 s94, s94, 32768
    ds_read_b128 a[136:139], v3 offset:18432
    ds_read_b128 a[140:143], v3 offset:19456
    v_mfma_f32_16x16x32_bf16 a[100:103], a[196:199], v[244:247], a[100:103]
    s_and_b32 s94, s94, 0x18000
    v_exp_f32 v160, v160
    v_mfma_f32_16x16x32_bf16 a[68:71], a[196:199], v[240:243], a[68:71]
    v_exp_f32 v161, v161
    v_mfma_f32_16x16x32_bf16 a[72:75], a[200:203], v[240:243], a[72:75]
    ds_read_b128 a[144:147], v3 offset:20480
    ds_read_b128 a[148:151], v3 offset:21504
    v_exp_f32 v162, v162
    v_mfma_f32_16x16x32_bf16 a[104:107], a[200:203], v[244:247], a[104:107]
    s_add_u32 m0, s85, 0
    v_exp_f32 v163, v163
    v_mfma_f32_16x16x32_bf16 a[108:111], a[204:207], v[244:247], a[108:111]
    buffer_load_dwordx4 v28, s[8:11], s46 offen offset:0 lds
    v_mfma_f32_16x16x32_bf16 a[76:79], a[204:207], v[240:243], a[76:79]
    v_cvt_pk_bf16_f32 v224, v160, v161
    v_cvt_pk_bf16_f32 v225, v162, v163
    v_mfma_f32_16x16x32_bf16 a[80:83], a[208:211], v[240:243], a[80:83]
    ds_read_b128 a[152:155], v3 offset:22528
    ds_read_b128 a[156:159], v3 offset:23552
    v_exp_f32 v164, v164
    v_mfma_f32_16x16x32_bf16 a[112:115], a[208:211], v[244:247], a[112:115]
    v_exp_f32 v165, v165
    v_mfma_f32_16x16x32_bf16 a[116:119], a[212:215], v[244:247], a[116:119]
    ds_read_b128 a[160:163], v3 offset:24576
    ds_read_b128 a[164:167], v3 offset:25600
    v_mfma_f32_16x16x32_bf16 a[84:87], a[212:215], v[240:243], a[84:87]
    v_exp_f32 v166, v166
    v_mfma_f32_16x16x32_bf16 a[88:91], a[216:219], v[240:243], a[88:91]
    buffer_load_dwordx4 v29, s[8:11], s46 offen offset:1024 lds
    v_exp_f32 v167, v167
    v_mfma_f32_16x16x32_bf16 a[120:123], a[216:219], v[244:247], a[120:123]
    v_cvt_pk_bf16_f32 v228, v164, v165
    v_cvt_pk_bf16_f32 v229, v166, v167
    v_mfma_f32_16x16x32_bf16 a[124:127], a[220:223], v[244:247], a[124:127]
    ds_read_b128 a[168:171], v3 offset:26624
    ds_read_b128 a[172:175], v3 offset:27648
    v_mfma_f32_16x16x32_bf16 a[92:95], a[220:223], v[240:243], a[92:95]
    v_exp_f32 v168, v168
    v_mfma_f32_16x16x32_bf16 v[16:19], v[24:27], v[240:243], v[16:19]
    v_exp_f32 v169, v169
    ds_read_b128 a[176:179], v3 offset:28672
    ds_read_b128 a[180:183], v3 offset:29696
    v_mfma_f32_16x16x32_bf16 v[20:23], v[24:27], v[244:247], v[20:23]
    v_exp_f32 v170, v170
    v_mfma_f32_16x16x32_bf16 a[64:67], a[224:227], v[248:251], a[64:67]
    v_exp_f32 v171, v171
    v_mfma_f32_16x16x32_bf16 a[96:99], a[224:227], v[252:255], a[96:99]
    buffer_load_dwordx4 v30, s[8:11], s46 offen offset:2048 lds
    v_mfma_f32_16x16x32_bf16 a[100:103], a[228:231], v[252:255], a[100:103]
    v_cvt_pk_bf16_f32 v226, v168, v169
    v_cvt_pk_bf16_f32 v227, v170, v171
    ds_read_b128 a[184:187], v3 offset:30720
    ds_read_b128 a[188:191], v3 offset:31744
    v_mfma_f32_16x16x32_bf16 a[68:71], a[228:231], v[248:251], a[68:71]
    v_exp_f32 v172, v172
    v_mfma_f32_16x16x32_bf16 a[72:75], a[232:235], v[248:251], a[72:75]
    v_exp_f32 v173, v173
    v_mfma_f32_16x16x32_bf16 a[104:107], a[232:235], v[252:255], a[104:107]
    ds_read_b128 a[192:195], v3 offset:0
    ds_read_b128 a[196:199], v3 offset:1024
    v_mfma_f32_16x16x32_bf16 a[108:111], a[236:239], v[252:255], a[108:111]
    v_exp_f32 v174, v174
    v_exp_f32 v175, v175
    v_mfma_f32_16x16x32_bf16 a[76:79], a[236:239], v[248:251], a[76:79]
    buffer_load_dwordx4 v31, s[8:11], s46 offen offset:3072 lds
    v_mfma_f32_16x16x32_bf16 a[80:83], a[240:243], v[248:251], a[80:83]
    v_cvt_pk_bf16_f32 v230, v172, v173
    v_cvt_pk_bf16_f32 v231, v174, v175
    v_mfma_f32_16x16x32_bf16 a[112:115], a[240:243], v[252:255], a[112:115]
    ds_read_b128 a[200:203], v3 offset:2048
    ds_read_b128 a[204:207], v3 offset:3072
    v_mfma_f32_16x16x32_bf16 a[116:119], a[244:247], v[252:255], a[116:119]
    v_exp_f32 v176, v176
    v_exp_f32 v177, v177
    v_mfma_f32_16x16x32_bf16 a[84:87], a[244:247], v[248:251], a[84:87]
    ds_read_b128 a[208:211], v3 offset:4096
    ds_read_b128 a[212:215], v3 offset:5120
    v_mfma_f32_16x16x32_bf16 a[88:91], a[248:251], v[248:251], a[88:91]
    v_exp_f32 v178, v178
    v_mfma_f32_16x16x32_bf16 a[120:123], a[248:251], v[252:255], a[120:123]
    s_add_u32 m0, s85, 4096
    v_exp_f32 v179, v179
    v_mfma_f32_16x16x32_bf16 a[124:127], a[252:255], v[252:255], a[124:127]
    s_add_u32 s46, s46, 20480
    buffer_load_dwordx4 v28, s[8:11], s46 offen offset:0 lds
    v_cvt_pk_bf16_f32 v232, v176, v177
    v_cvt_pk_bf16_f32 v233, v178, v179
    v_mfma_f32_16x16x32_bf16 a[92:95], a[252:255], v[248:251], a[92:95]
    ds_read_b128 a[216:219], v3 offset:6144
    ds_read_b128 a[220:223], v3 offset:7168
    v_mfma_f32_16x16x32_bf16 v[16:19], v[24:27], v[248:251], v[16:19]
    v_exp_f32 v180, v180
    v_mfma_f32_16x16x32_bf16 v[20:23], v[24:27], v[252:255], v[20:23]
    s_waitcnt lgkmcnt(2)
    v_exp_f32 v181, v181
    v_mfma_f32_16x16x32_bf16 v[196:199], a[128:131], v[76:79], v[144:147]
    ds_read_b128 a[224:227], v3 offset:8192
    ds_read_b128 a[228:231], v3 offset:9216
    v_exp_f32 v182, v182
    v_mfma_f32_16x16x32_bf16 v[204:207], a[144:147], v[76:79], v[148:151]
    v_exp_f32 v183, v183
    v_mfma_f32_16x16x32_bf16 v[196:199], a[132:135], v[92:95], v[196:199]
    buffer_load_dwordx4 v29, s[8:11], s46 offen offset:1024 lds
    v_mfma_f32_16x16x32_bf16 v[204:207], a[148:151], v[92:95], v[204:207]
    v_cvt_pk_bf16_f32 v236, v180, v181
    v_cvt_pk_bf16_f32 v237, v182, v183
    v_mfma_f32_16x16x32_bf16 v[196:199], a[136:139], v[108:111], v[196:199]
    ds_read_b128 a[232:235], v3 offset:10240
    ds_read_b128 a[236:239], v3 offset:11264
    v_exp_f32 v184, v184
    v_mfma_f32_16x16x32_bf16 v[204:207], a[152:155], v[108:111], v[204:207]
    v_exp_f32 v185, v185
    v_mfma_f32_16x16x32_bf16 v[196:199], a[140:143], v[124:127], v[196:199]
    ds_read_b128 a[240:243], v3 offset:12288
    ds_read_b128 a[244:247], v3 offset:13312
    v_mfma_f32_16x16x32_bf16 v[204:207], a[156:159], v[124:127], v[204:207]
    v_exp_f32 v186, v186
    v_mfma_f32_16x16x32_bf16 v[212:215], a[160:163], v[76:79], v[152:155]
    buffer_load_dwordx4 v30, s[8:11], s46 offen offset:2048 lds
    v_exp_f32 v187, v187
    v_mfma_f32_16x16x32_bf16 v[220:223], a[176:179], v[76:79], v[156:159]
    v_cvt_pk_bf16_f32 v234, v184, v185
    v_cvt_pk_bf16_f32 v235, v186, v187
    v_mfma_f32_16x16x32_bf16 v[212:215], a[164:167], v[92:95], v[212:215]
    ds_read_b128 a[248:251], v3 offset:14336
    ds_read_b128 a[252:255], v3 offset:15360
    v_mfma_f32_16x16x32_bf16 v[220:223], a[180:183], v[92:95], v[220:223]
    v_exp_f32 v188, v188
    v_mfma_f32_16x16x32_bf16 v[212:215], a[168:171], v[108:111], v[212:215]
    v_exp_f32 v189, v189
    v_exp_f32 v190, v190
    v_mfma_f32_16x16x32_bf16 v[220:223], a[184:187], v[108:111], v[220:223]
    v_exp_f32 v191, v191
    v_mfma_f32_16x16x32_bf16 v[212:215], a[172:175], v[124:127], v[212:215]
    buffer_load_dwordx4 v31, s[8:11], s46 offen offset:3072 lds
    v_mfma_f32_16x16x32_bf16 v[220:223], a[188:191], v[124:127], v[220:223]
    s_waitcnt vmcnt(8) lgkmcnt(0)
    v_cvt_pk_bf16_f32 v238, v188, v189
    v_cvt_pk_bf16_f32 v239, v190, v191
AT_f3:
    v_cmp_gt_u32 vcc, 3, v34
    s_nop 0
    s_cbranch_vccnz SP_hw
SR_hw:
    v_mfma_f32_16x16x32_bf16 a[64:67], a[192:195], v[224:227], a[64:67]
    s_barrier
    v_add_u32 v3, s94, v2
    v_exp_f32 v196, v196
    v_mfma_f32_16x16x32_bf16 a[96:99], a[192:195], v[228:231], a[96:99]
    s_add_u32 s94, s94, 32768
    v_exp_f32 v197, v197
    v_mfma_f32_16x16x32_bf16 a[100:103], a[196:199], v[228:231], a[100:103]
    ds_read_b128 a[192:195], v3 offset:0
    s_and_b32 s94, s94, 0x18000
    v_exp_f32 v198, v198
    v_mfma_f32_16x16x32_bf16 a[68:71], a[196:199], v[224:227], a[68:71]
    v_exp_f32 v199, v199
    v_mfma_f32_16x16x32_bf16 a[72:75], a[200:203], v[224:227], a[72:75]
    ds_read_b128 a[196:199], v3 offset:1024
    s_add_u32 m0, s85, 32768
    buffer_load_dwordx4 a[132:135], v37, s[20:23], s42 offen offset:0 sc1
    v_mfma_f32_16x16x32_bf16 a[104:107], a[200:203], v[228:231], a[104:107]
    buffer_load_dwordx4 v28, s[8:11], s43 offen offset:0 lds
    v_mfma_f32_16x16x32_bf16 a[108:111], a[204:207], v[228:231], a[108:111]
    ds_read_b128 a[200:203], v3 offset:2048
    buffer_load_dwordx4 a[136:139], v38, s[20:23], s42 offen offset:0 sc1
    v_mfma_f32_16x16x32_bf16 a[76:79], a[204:207], v[224:227], a[76:79]
    buffer_load_dwordx4 v29, s[8:11], s43 offen offset:1024 lds
    v_mfma_f32_16x16x32_bf16 a[80:83], a[208:211], v[224:227], a[80:83]
    ds_read_b128 a[204:207], v3 offset:3072
    v_cvt_pk_bf16_f32 v244, v196, v197
    v_cvt_pk_bf16_f32 v245, v198, v199
    v_mfma_f32_16x16x32_bf16 a[112:115], a[208:211], v[228:231], a[112:115]
    v_exp_f32 v204, v204
    v_mfma_f32_16x16x32_bf16 a[116:119], a[212:215], v[228:231], a[116:119]
    ds_read_b128 a[208:211], v3 offset:4096
    v_exp_f32 v205, v205
    v_mfma_f32_16x16x32_bf16 a[84:87], a[212:215], v[224:227], a[84:87]
    v_exp_f32 v206, v206
    v_mfma_f32_16x16x32_bf16 a[88:91], a[216:219], v[224:227], a[88:91]
    ds_read_b128 a[212:215], v3 offset:5120
    v_exp_f32 v207, v207
    v_mfma_f32_16x16x32_bf16 a[120:123], a[216:219], v[228:231], a[120:123]
    buffer_load_dwordx4 a[140:143], v39, s[20:23], s42 offen offset:0 sc1
    v_mfma_f32_16x16x32_bf16 a[124:127], a[220:223], v[228:231], a[124:127]
    ds_read_b128 a[216:219], v3 offset:6144
    buffer_load_dwordx4 v30, s[8:11], s43 offen offset:2048 lds
    v_mfma_f32_16x16x32_bf16 a[92:95], a[220:223], v[224:227], a[92:95]
    buffer_load_dwordx4 a[128:131], v36, s[20:23], s42 offen offset:0 sc1
    v_mfma_f32_16x16x32_bf16 v[16:19], v[24:27], v[224:227], v[16:19]
    ds_read_b128 a[220:223], v3 offset:7168
    buffer_load_dwordx4 v31, s[8:11], s43 offen offset:3072 lds
    v_mfma_f32_16x16x32_bf16 v[20:23], v[24:27], v[228:231], v[20:23]
    v_cvt_pk_bf16_f32 v246, v204, v205
    v_cvt_pk_bf16_f32 v247, v206, v207
    v_mfma_f32_16x16x32_bf16 a[64:67], a[224:227], v[232:235], a[64:67]
    v_exp_f32 v212, v212
    v_mfma_f32_16x16x32_bf16 a[96:99], a[224:227], v[236:239], a[96:99]
    v_exp_f32 v213, v213
    v_mfma_f32_16x16x32_bf16 a[100:103], a[228:231], v[236:239], a[100:103]
    ds_read_b128 a[224:227], v3 offset:8192
    v_exp_f32 v214, v214
    v_mfma_f32_16x16x32_bf16 a[68:71], a[228:231], v[232:235], a[68:71]
    v_exp_f32 v215, v215
    v_mfma_f32_16x16x32_bf16 a[72:75], a[232:235], v[232:235], a[72:75]
    ds_read_b128 a[228:231], v3 offset:9216
    s_add_u32 m0, s85, 36864
    buffer_load_dwordx4 a[148:151], v37, s[20:23], s42 offen offset:1024 sc1
    v_mfma_f32_16x16x32_bf16 a[104:107], a[232:235], v[236:239], a[104:107]
    s_add_u32 s43, s43, 20480
    buffer_load_dwordx4 v28, s[8:11], s43 offen offset:0 lds
    v_mfma_f32_16x16x32_bf16 a[108:111], a[236:239], v[236:239], a[108:111]
    ds_read_b128 a[232:235], v3 offset:10240
    buffer_load_dwordx4 a[152:155], v38, s[20:23], s42 offen offset:1024 sc1
    v_mfma_f32_16x16x32_bf16 a[76:79], a[236:239], v[232:235], a[76:79]
    buffer_load_dwordx4 v29, s[8:11], s43 offen offset:1024 lds
    v_mfma_f32_16x16x32_bf16 a[80:83], a[240:243], v[232:235], a[80:83]
    ds_read_b128 a[236:239], v3 offset:11264
    v_cvt_pk_bf16_f32 v252, v212, v213
    v_cvt_pk_bf16_f32 v253, v214, v215
    v_mfma_f32_16x16x32_bf16 a[112:115], a[240:243], v[236:239], a[112:115]
    v_exp_f32 v220, v220
    v_mfma_f32_16x16x32_bf16 a[116:119], a[244:247], v[236:239], a[116:119]
    ds_read_b128 a[240:243], v3 offset:12288
    v_exp_f32 v221, v221
    v_mfma_f32_16x16x32_bf16 a[84:87], a[244:247], v[232:235], a[84:87]
    v_exp_f32 v222, v222
    v_mfma_f32_16x16x32_bf16 a[88:91], a[248:251], v[232:235], a[88:91]
    ds_read_b128 a[244:247], v3 offset:13312
    v_exp_f32 v223, v223
    v_mfma_f32_16x16x32_bf16 a[120:123], a[248:251], v[236:239], a[120:123]
    buffer_load_dwordx4 a[156:159], v39, s[20:23], s42 offen offset:1024 sc1
    v_mfma_f32_16x16x32_bf16 a[124:127], a[252:255], v[236:239], a[124:127]
    ds_read_b128 a[248:251], v3 offset:14336
    buffer_load_dwordx4 v30, s[8:11], s43 offen offset:2048 lds
    v_mfma_f32_16x16x32_bf16 a[92:95], a[252:255], v[232:235], a[92:95]
    buffer_load_dwordx4 a[144:147], v36, s[20:23], s42 offen offset:1024 sc1
    v_mfma_f32_16x16x32_bf16 v[16:19], v[24:27], v[232:235], v[16:19]
    ds_read_b128 a[252:255], v3 offset:15360
    buffer_load_dwordx4 v31, s[8:11], s43 offen offset:3072 lds
    v_mfma_f32_16x16x32_bf16 v[20:23], v[24:27], v[236:239], v[20:23]
    v_cvt_pk_bf16_f32 v254, v220, v221
    v_cvt_pk_bf16_f32 v255, v222, v223
    s_waitcnt lgkmcnt(15)
    v_mfma_f32_16x16x32_bf16 a[96:99], a[192:195], v[244:247], a[96:99]
    s_waitcnt lgkmcnt(14)
    v_mfma_f32_16x16x32_bf16 a[100:103], a[196:199], v[244:247], a[100:103]
    s_waitcnt lgkmcnt(13)
    v_mfma_f32_16x16x32_bf16 a[104:107], a[200:203], v[244:247], a[104:107]
    buffer_load_dwordx4 a[164:167], v37, s[20:23], s42 offen offset:2048 sc1
    s_waitcnt lgkmcnt(12)
    v_mfma_f32_16x16x32_bf16 a[108:111], a[204:207], v[244:247], a[108:111]
    s_waitcnt lgkmcnt(11)
    v_mfma_f32_16x16x32_bf16 a[112:115], a[208:211], v[244:247], a[112:115]
    buffer_load_dwordx4 a[168:171], v38, s[20:23], s42 offen offset:2048 sc1
    s_waitcnt lgkmcnt(10)
    v_mfma_f32_16x16x32_bf16 a[116:119], a[212:215], v[244:247], a[116:119]
    s_waitcnt lgkmcnt(9)
    v_mfma_f32_16x16x32_bf16 a[120:123], a[216:219], v[244:247], a[120:123]
    buffer_load_dwordx4 a[172:175], v39, s[20:23], s42 offen offset:2048 sc1
    s_waitcnt lgkmcnt(8)
    v_mfma_f32_16x16x32_bf16 a[124:127], a[220:223], v[244:247], a[124:127]
    v_mfma_f32_16x16x32_bf16 v[20:23], v[24:27], v[244:247], v[20:23]
    buffer_load_dwordx4 a[160:163], v36, s[20:23], s42 offen offset:2048 sc1
    s_waitcnt lgkmcnt(7)
    v_mfma_f32_16x16x32_bf16 a[96:99], a[224:227], v[252:255], a[96:99]
    s_waitcnt lgkmcnt(6)
    v_mfma_f32_16x16x32_bf16 a[100:103], a[228:231], v[252:255], a[100:103]
    s_waitcnt lgkmcnt(5)
    v_mfma_f32_16x16x32_bf16 a[104:107], a[232:235], v[252:255], a[104:107]
    buffer_load_dwordx4 a[180:183], v37, s[20:23], s42 offen offset:3072 sc1
    s_waitcnt lgkmcnt(4)
    v_mfma_f32_16x16x32_bf16 a[108:111], a[236:239], v[252:255], a[108:111]
    s_waitcnt lgkmcnt(3)
    v_mfma_f32_16x16x32_bf16 a[112:115], a[240:243], v[252:255], a[112:115]
    buffer_load_dwordx4 a[184:187], v38, s[20:23], s42 offen offset:3072 sc1
    s_waitcnt lgkmcnt(2)
    v_mfma_f32_16x16x32_bf16 a[116:119], a[244:247], v[252:255], a[116:119]
    s_waitcnt lgkmcnt(1)
    v_mfma_f32_16x16x32_bf16 a[120:123], a[248:251], v[252:255], a[120:123]
    buffer_load_dwordx4 a[188:191], v39, s[20:23], s42 offen offset:3072 sc1
    s_waitcnt lgkmcnt(0)
    v_mfma_f32_16x16x32_bf16 a[124:127], a[252:255], v[252:255], a[124:127]
    v_mfma_f32_16x16x32_bf16 v[20:23], v[24:27], v[252:255], v[20:23]
    buffer_load_dwordx4 a[176:179], v36, s[20:23], s42 offen offset:3072 sc1
    v_subrev_u32 v44, 0x2b800000, v8
    v_subrev_u32 v45, 0x2b800000, v12
    v_subrev_u32 v46, 0x2b800000, v16
    s_nop 3
    v_subrev_u32 v47, 0x2b800000, v20
    v_max3_u32 v44, v44, v45, v46
    v_max_u32 v44, v44, v47
    v_cmp_lt_u32 vcc, 0x28000000, v44
    s_nop 0
    s_cbranch_vccnz AT_slow
AT_fin:
    v_rcp_f32 v8, v8
    v_rcp_f32 v9, v9
    v_rcp_f32 v12, v12
    v_rcp_f32 v13, v13
    v_rcp_f32 v16, v16
    v_rcp_f32 v17, v17
    v_rcp_f32 v20, v20
    v_rcp_f32 v21, v21
    s_bitcmp1_b32 s31, 4
    s_cbranch_scc1 CE_23
    s_bitcmp1_b32 s31, 3
    s_cbranch_scc1 CE_1
    v_accvgpr_read_b32 v44, a0
    v_accvgpr_read_b32 v45, a1
    v_accvgpr_read_b32 v46, a2
    v_accvgpr_read_b32 v47, a3
    v_accvgpr_read_b32 v48, a4
    v_accvgpr_read_b32 v49, a5
    v_accvgpr_read_b32 v50, a6
    v_accvgpr_read_b32 v51, a7
    v_pk_mul_f32 v[44:45], v[44:45], v[8:9]
    v_pk_mul_f32 v[46:47], v[46:47], v[8:9]
    v_pk_mul_f32 v[48:49], v[48:49], v[8:9]
    v_pk_mul_f32 v[50:51], v[50:51], v[8:9]
    v_cvt_pk_bf16_f32 v192, v44, v45
    v_cvt_pk_bf16_f32 v193, v46, v47
    v_cvt_pk_bf16_f32 v194, v48, v49
    v_cvt_pk_bf16_f32 v195, v50, v51
    buffer_store_dwordx4 v[192:195], v2, s[52:55], s56 offen offset:0 sc1
    v_accvgpr_read_b32 v52, a8
    v_accvgpr_read_b32 v53, a9
    v_accvgpr_read_b32 v54, a10
    v_accvgpr_read_b32 v55, a11
    v_accvgpr_read_b32 v56, a12
    v_accvgpr_read_b32 v57, a13
    v_accvgpr_read_b32 v58, a14
    v_accvgpr_read_b32 v59, a15
    v_pk_mul_f32 v[52:53], v[52:53], v[8:9]
    v_pk_mul_f32 v[54:55], v[54:55], v[8:9]
    v_pk_mul_f32 v[56:57], v[56:57], v[8:9]
    v_pk_mul_f32 v[58:59], v[58:59], v[8:9]
    v_cvt_pk_bf16_f32 v208, v52, v53
    v_cvt_pk_bf16_f32 v209, v54, v55
    v_cvt_pk_bf16_f32 v210, v56, v57
    v_cvt_pk_bf16_f32 v211, v58, v59
    buffer_store_dwordx4 v[208:211], v2, s[52:55], s56 offen offset:1024 sc1
    v_accvgpr_read_b32 v44, a16
    v_accvgpr_read_b32 v45, a17
    v_accvgpr_read_b32 v46, a18
    v_accvgpr_read_b32 v47, a19
    v_accvgpr_read_b32 v48, a20
    v_accvgpr_read_b32 v49, a21
    v_accvgpr_read_b32 v50, a22
    v_accvgpr_read_b32 v51, a23
    v_pk_mul_f32 v[44:45], v[44:45], v[8:9]
    v_pk_mul_f32 v[46:47], v[46:47], v[8:9]
    v_pk_mul_f32 v[48:49], v[48:49], v[8:9]
    v_pk_mul_f32 v[50:51], v[50:51], v[8:9]
    v_cvt_pk_bf16_f32 v224, v44, v45
    v_cvt_pk_bf16_f32 v225, v46, v47
    v_cvt_pk_bf16_f32 v226, v48, v49
    v_cvt_pk_bf16_f32 v227, v50, v51
    buffer_store_dwordx4 v[224:227], v2, s[52:55], s56 offen offset:2048 sc1
    v_accvgpr_read_b32 v52, a24
    v_accvgpr_read_b32 v53, a25
    v_accvgpr_read_b32 v54, a26
    v_accvgpr_read_b32 v55, a27
    v_accvgpr_read_b32 v56, a28
    v_accvgpr_read_b32 v57, a29
    v_accvgpr_read_b32 v58, a30
    v_accvgpr_read_b32 v59, a31
    v_pk_mul_f32 v[52:53], v[52:53], v[8:9]
    v_pk_mul_f32 v[54:55], v[54:55], v[8:9]
    v_pk_mul_f32 v[56:57], v[56:57], v[8:9]
    v_pk_mul_f32 v[58:59], v[58:59], v[8:9]
    v_cvt_pk_bf16_f32 v240, v52, v53
    v_cvt_pk_bf16_f32 v241, v54, v55
    v_cvt_pk_bf16_f32 v242, v56, v57
    v_cvt_pk_bf16_f32 v243, v58, v59
    buffer_store_dwordx4 v[240:243], v2, s[52:55], s56 offen offset:3072 sc1
    v_accvgpr_read_b32 v44, a32
    v_accvgpr_read_b32 v45, a33
    v_accvgpr_read_b32 v46, a34
    v_accvgpr_read_b32 v47, a35
    v_accvgpr_read_b32 v48, a36
    v_accvgpr_read_b32 v49, a37
    v_accvgpr_read_b32 v50, a38
    v_accvgpr_read_b32 v51, a39
    v_pk_mul_f32 v[44:45], v[44:45], v[12:13]
    v_pk_mul_f32 v[46:47], v[46:47], v[12:13]
    v_pk_mul_f32 v[48:49], v[48:49], v[12:13]
    v_pk_mul_f32 v[50:51], v[50:51], v[12:13]
    v_cvt_pk_bf16_f32 v196, v44, v45
    v_cvt_pk_bf16_f32 v197, v46, v47
    v_cvt_pk_bf16_f32 v198, v48, v49
    v_cvt_pk_bf16_f32 v199, v50, v51
    buffer_store_dwordx4 v[196:199], v2, s[52:55], s57 offen offset:0 sc1
    v_accvgpr_read_b32 v52, a40
    v_accvgpr_read_b32 v53, a41
    v_accvgpr_read_b32 v54, a42
    v_accvgpr_read_b32 v55, a43
    v_accvgpr_read_b32 v56, a44
    v_accvgpr_read_b32 v57, a45
    v_accvgpr_read_b32 v58, a46
    v_accvgpr_read_b32 v59, a47
    v_pk_mul_f32 v[52:53], v[52:53], v[12:13]
    v_pk_mul_f32 v[54:55], v[54:55], v[12:13]
    v_pk_mul_f32 v[56:57], v[56:57], v[12:13]
    v_pk_mul_f32 v[58:59], v[58:59], v[12:13]
    v_cvt_pk_bf16_f32 v212, v52, v53
    v_cvt_pk_bf16_f32 v213, v54, v55
    v_cvt_pk_bf16_f32 v214, v56, v57
    v_cvt_pk_bf16_f32 v215, v58, v59
    buffer_store_dwordx4 v[212:215], v2, s[52:55], s57 offen offset:1024 sc1
    v_accvgpr_read_b32 v44, a48
    v_accvgpr_read_b32 v45, a49
    v_accvgpr_read_b32 v46, a50
    v_accvgpr_read_b32 v47, a51
    v_accvgpr_read_b32 v48, a52
    v_accvgpr_read_b32 v49, a53
    v_accvgpr_read_b32 v50, a54
    v_accvgpr_read_b32 v51, a55
    v_pk_mul_f32 v[44:45], v[44:45], v[12:13]
    v_pk_mul_f32 v[46:47], v[46:47], v[12:13]
    v_pk_mul_f32 v[48:49], v[48:49], v[12:13]
    v_pk_mul_f32 v[50:51], v[50:51], v[12:13]
    v_cvt_pk_bf16_f32 v228, v44, v45
    v_cvt_pk_bf16_f32 v229, v46, v47
    v_cvt_pk_bf16_f32 v230, v48, v49
    v_cvt_pk_bf16_f32 v231, v50, v51
    buffer_store_dwordx4 v[228:231], v2, s[52:55], s57 offen offset:2048 sc1
    v_accvgpr_read_b32 v52, a56
    v_accvgpr_read_b32 v53, a57
    v_accvgpr_read_b32 v54, a58
    v_accvgpr_read_b32 v55, a59
    v_accvgpr_read_b32 v56, a60
    v_accvgpr_read_b32 v57, a61
    v_accvgpr_read_b32 v58, a62
    v_accvgpr_read_b32 v59, a63
    v_pk_mul_f32 v[52:53], v[52:53], v[12:13]
    v_pk_mul_f32 v[54:55], v[54:55], v[12:13]
    v_pk_mul_f32 v[56:57], v[56:57], v[12:13]
    v_pk_mul_f32 v[58:59], v[58:59], v[12:13]
    v_cvt_pk_bf16_f32 v244, v52, v53
    v_cvt_pk_bf16_f32 v245, v54, v55
    v_cvt_pk_bf16_f32 v246, v56, v57
    v_cvt_pk_bf16_f32 v247, v58, v59
    buffer_store_dwordx4 v[244:247], v2, s[52:55], s57 offen offset:3072 sc1
    v_accvgpr_read_b32 v44, a64
    v_accvgpr_read_b32 v45, a65
    v_accvgpr_read_b32 v46, a66
    v_accvgpr_read_b32 v47, a67
    v_accvgpr_read_b32 v48, a68
    v_accvgpr_read_b32 v49, a69
    v_accvgpr_read_b32 v50, a70
    v_accvgpr_read_b32 v51, a71
    v_pk_mul_f32 v[44:45], v[44:45], v[16:17]
    v_pk_mul_f32 v[46:47], v[46:47], v[16:17]
    v_pk_mul_f32 v[48:49], v[48:49], v[16:17]
    v_pk_mul_f32 v[50:51], v[50:51], v[16:17]
    v_cvt_pk_bf16_f32 v200, v44, v45
    v_cvt_pk_bf16_f32 v201, v46, v47
    v_cvt_pk_bf16_f32 v202, v48, v49
    v_cvt_pk_bf16_f32 v203, v50, v51
    buffer_store_dwordx4 v[200:203], v2, s[52:55], s58 offen offset:0 sc1
    v_accvgpr_read_b32 v52, a72
    v_accvgpr_read_b32 v53, a73
    v_accvgpr_read_b32 v54, a74
    v_accvgpr_read_b32 v55, a75
    v_accvgpr_read_b32 v56, a76
    v_accvgpr_read_b32 v57, a77
    v_accvgpr_read_b32 v58, a78
    v_accvgpr_read_b32 v59, a79
    v_pk_mul_f32 v[52:53], v[52:53], v[16:17]
    v_pk_mul_f32 v[54:55], v[54:55], v[16:17]
    v_pk_mul_f32 v[56:57], v[56:57], v[16:17]
    v_pk_mul_f32 v[58:59], v[58:59], v[16:17]
    v_cvt_pk_bf16_f32 v216, v52, v53
    v_cvt_pk_bf16_f32 v217, v54, v55
    v_cvt_pk_bf16_f32 v218, v56, v57
    v_cvt_pk_bf16_f32 v219, v58, v59
    buffer_store_dwordx4 v[216:219], v2, s[52:55], s58 offen offset:1024 sc1
    v_accvgpr_read_b32 v44, a80
    v_accvgpr_read_b32 v45, a81
    v_accvgpr_read_b32 v46, a82
    v_accvgpr_read_b32 v47, a83
    v_accvgpr_read_b32 v48, a84
    v_accvgpr_read_b32 v49, a85
    v_accvgpr_read_b32 v50, a86
    v_accvgpr_read_b32 v51, a87
    v_pk_mul_f32 v[44:45], v[44:45], v[16:17]
    v_pk_mul_f32 v[46:47], v[46:47], v[16:17]
    v_pk_mul_f32 v[48:49], v[48:49], v[16:17]
    v_pk_mul_f32 v[50:51], v[50:51], v[16:17]
    v_cvt_pk_bf16_f32 v232, v44, v45
    v_cvt_pk_bf16_f32 v233, v46, v47
    v_cvt_pk_bf16_f32 v234, v48, v49
    v_cvt_pk_bf16_f32 v235, v50, v51
    buffer_store_dwordx4 v[232:235], v2, s[52:55], s58 offen offset:2048 sc1
    v_accvgpr_read_b32 v52, a88
    v_accvgpr_read_b32 v53, a89
    v_accvgpr_read_b32 v54, a90
    v_accvgpr_read_b32 v55, a91
    v_accvgpr_read_b32 v56, a92
    v_accvgpr_read_b32 v57, a93
    v_accvgpr_read_b32 v58, a94
    v_accvgpr_read_b32 v59, a95
    v_pk_mul_f32 v[52:53], v[52:53], v[16:17]
    v_pk_mul_f32 v[54:55], v[54:55], v[16:17]
    v_pk_mul_f32 v[56:57], v[56:57], v[16:17]
    v_pk_mul_f32 v[58:59], v[58:59], v[16:17]
    v_cvt_pk_bf16_f32 v248, v52, v53
    v_cvt_pk_bf16_f32 v249, v54, v55
    v_cvt_pk_bf16_f32 v250, v56, v57
    v_cvt_pk_bf16_f32 v251, v58, v59
    buffer_store_dwordx4 v[248:251], v2, s[52:55], s58 offen offset:3072 sc1
    v_accvgpr_read_b32 v44, a96
    v_accvgpr_read_b32 v45, a97
    v_accvgpr_read_b32 v46, a98
    v_accvgpr_read_b32 v47, a99
    v_accvgpr_read_b32 v48, a100
    v_accvgpr_read_b32 v49, a101
    v_accvgpr_read_b32 v50, a102
    v_accvgpr_read_b32 v51, a103
    v_pk_mul_f32 v[44:45], v[44:45], v[20:21]
    v_pk_mul_f32 v[46:47], v[46:47], v[20:21]
    v_pk_mul_f32 v[48:49], v[48:49], v[20:21]
    v_pk_mul_f32 v[50:51], v[50:51], v[20:21]
    v_cvt_pk_bf16_f32 v204, v44, v45
    v_cvt_pk_bf16_f32 v205, v46, v47
    v_cvt_pk_bf16_f32 v206, v48, v49
    v_cvt_pk_bf16_f32 v207, v50, v51
    buffer_store_dwordx4 v[204:207], v2, s[52:55], s59 offen offset:0 sc1
    v_accvgpr_read_b32 v52, a104
    v_accvgpr_read_b32 v53, a105
    v_accvgpr_read_b32 v54, a106
    v_accvgpr_read_b32 v55, a107
    v_accvgpr_read_b32 v56, a108
    v_accvgpr_read_b32 v57, a109
    v_accvgpr_read_b32 v58, a110
    v_accvgpr_read_b32 v59, a111
    v_pk_mul_f32 v[52:53], v[52:53], v[20:21]
    v_pk_mul_f32 v[54:55], v[54:55], v[20:21]
    v_pk_mul_f32 v[56:57], v[56:57], v[20:21]
    v_pk_mul_f32 v[58:59], v[58:59], v[20:21]
    v_cvt_pk_bf16_f32 v220, v52, v53
    v_cvt_pk_bf16_f32 v221, v54, v55
    v_cvt_pk_bf16_f32 v222, v56, v57
    v_cvt_pk_bf16_f32 v223, v58, v59
    buffer_store_dwordx4 v[220:223], v2, s[52:55], s59 offen offset:1024 sc1
    v_accvgpr_read_b32 v44, a112
    v_accvgpr_read_b32 v45, a113
    v_accvgpr_read_b32 v46, a114
    v_accvgpr_read_b32 v47, a115
    v_accvgpr_read_b32 v48, a116
    v_accvgpr_read_b32 v49, a117
    v_accvgpr_read_b32 v50, a118
    v_accvgpr_read_b32 v51, a119
    v_pk_mul_f32 v[44:45], v[44:45], v[20:21]
    v_pk_mul_f32 v[46:47], v[46:47], v[20:21]
    v_pk_mul_f32 v[48:49], v[48:49], v[20:21]
    v_pk_mul_f32 v[50:51], v[50:51], v[20:21]
    v_cvt_pk_bf16_f32 v236, v44, v45
    v_cvt_pk_bf16_f32 v237, v46, v47
    v_cvt_pk_bf16_f32 v238, v48, v49
    v_cvt_pk_bf16_f32 v239, v50, v51
    buffer_store_dwordx4 v[236:239], v2, s[52:55], s59 offen offset:2048 sc1
    v_accvgpr_read_b32 v52, a120
    v_accvgpr_read_b32 v53, a121
    v_accvgpr_read_b32 v54, a122
    v_accvgpr_read_b32 v55, a123
    v_accvgpr_read_b32 v56, a124
    v_accvgpr_read_b32 v57, a125
    v_accvgpr_read_b32 v58, a126
    v_accvgpr_read_b32 v59, a127
    v_pk_mul_f32 v[52:53], v[52:53], v[20:21]
    v_pk_mul_f32 v[54:55], v[54:55], v[20:21]
    v_pk_mul_f32 v[56:57], v[56:57], v[20:21]
    v_pk_mul_f32 v[58:59], v[58:59], v[20:21]
    v_cvt_pk_bf16_f32 v252, v52, v53
    v_cvt_pk_bf16_f32 v253, v54, v55
    v_cvt_pk_bf16_f32 v254, v56, v57
    v_cvt_pk_bf16_f32 v255, v58, v59
    buffer_store_dwordx4 v[252:255], v2, s[52:55], s59 offen offset:3072 sc1
CE_end:
    v_xor_b32 v8, 131072, v40
    v_xor_b32 v9, 131104, v40
    v_xor_b32 v10, 131136, v40
    v_xor_b32 v11, 131168, v40
    v_xor_b32 v12, 131200, v40
    v_xor_b32 v13, 131232, v40
    v_xor_b32 v14, 131264, v40
    v_xor_b32 v15, 131296, v40
    ds_read_b64_tr_b16 a[192:193], v8 offset:0
    ds_read_b64_tr_b16 a[194:195], v8 offset:4096
    ds_read_b64_tr_b16 a[196:197], v9 offset:0
    ds_read_b64_tr_b16 a[198:199], v9 offset:4096
    ds_read_b64_tr_b16 a[200:201], v10 offset:0
    ds_read_b64_tr_b16 a[202:203], v10 offset:4096
    ds_read_b64_tr_b16 a[204:205], v11 offset:0
    ds_read_b64_tr_b16 a[206:207], v11 offset:4096
    ds_read_b64_tr_b16 a[208:209], v12 offset:0
    ds_read_b64_tr_b16 a[210:211], v12 offset:4096
    ds_read_b64_tr_b16 a[212:213], v13 offset:0
    ds_read_b64_tr_b16 a[214:215], v13 offset:4096
    ds_read_b64_tr_b16 a[216:217], v14 offset:0
    ds_read_b64_tr_b16 a[218:219], v14 offset:4096
    ds_read_b64_tr_b16 a[220:221], v15 offset:0
    ds_read_b64_tr_b16 a[222:223], v15 offset:4096
    s_cmp_lg_u32 s41, 0
    s_cbranch_scc1 DN_go
    s_waitcnt lgkmcnt(14)
    v_mfma_f32_16x16x32_bf16 v[96:99], a[192:195], v[196:199], 0
    s_waitcnt lgkmcnt(12)
    v_xor_b32 v16, 0, v41
    v_xor_b32 v17, 32, v41
    v_mfma_f32_16x16x32_bf16 v[100:103], a[196:199], v[196:199], 0
    s_waitcnt lgkmcnt(10)
    ds_read_b64_tr_b16 a[224:225], v8 offset:8192
    ds_read_b64_tr_b16 a[226:227], v8 offset:12288
    v_mfma_f32_16x16x32_bf16 v[104:107], a[200:203], v[196:199], 0
    s_waitcnt lgkmcnt(10)
    v_xor_b32 v18, 64, v41
    v_xor_b32 v19, 96, v41
    v_mfma_f32_16x16x32_bf16 v[108:111], a[204:207], v[196:199], 0
    s_waitcnt lgkmcnt(8)
    ds_read_b64_tr_b16 a[228:229], v9 offset:8192
    ds_read_b64_tr_b16 a[230:231], v9 offset:12288
    v_mfma_f32_16x16x32_bf16 v[112:115], a[208:211], v[196:199], 0
    s_waitcnt lgkmcnt(8)
    v_xor_b32 v20, 128, v41
    v_xor_b32 v21, 160, v41
    v_mfma_f32_16x16x32_bf16 v[116:119], a[212:215], v[196:199], 0
    s_waitcnt lgkmcnt(6)
    ds_read_b64_tr_b16 a[232:233], v10 offset:8192
    ds_read_b64_tr_b16 a[234:235], v10 offset:12288
    v_mfma_f32_16x16x32_bf16 v[120:123], a[216:219], v[196:199], 0
    s_waitcnt lgkmcnt(6)
    v_xor_b32 v22, 192, v41
    v_xor_b32 v23, 224, v41
    v_mfma_f32_16x16x32_bf16 v[124:127], a[220:223], v[196:199], 0
    ds_read_b64_tr_b16 a[236:237], v11 offset:8192
    ds_read_b64_tr_b16 a[238:239], v11 offset:12288
    v_mfma_f32_16x16x32_bf16 v[156:159], a[220:223], v[200:203], 0
    v_xor_b32 v44, 65536, v41
    v_xor_b32 v45, 65568, v41
    v_mfma_f32_16x16x32_bf16 v[152:155], a[216:219], v[200:203], 0
    ds_read_b64_tr_b16 a[240:241], v12 offset:8192
    ds_read_b64_tr_b16 a[242:243], v12 offset:12288
    v_mfma_f32_16x16x32_bf16 v[148:151], a[212:215], v[200:203], 0
    v_xor_b32 v46, 65600, v41
    v_xor_b32 v47, 65632, v41
    v_mfma_f32_16x16x32_bf16 v[144:147], a[208:211], v[200:203], 0
    ds_read_b64_tr_b16 a[244:245], v13 offset:8192
    ds_read_b64_tr_b16 a[246:247], v13 offset:12288
    v_mfma_f32_16x16x32_bf16 v[140:143], a[204:207], v[200:203], 0
    v_xor_b32 v48, 65664, v41
    v_xor_b32 v49, 65696, v41
    v_mfma_f32_16x16x32_bf16 v[136:139], a[200:203], v[200:203], 0
    ds_read_b64_tr_b16 a[248:249], v14 offset:8192
    ds_read_b64_tr_b16 a[250:251], v14 offset:12288
    v_mfma_f32_16x16x32_bf16 v[132:135], a[196:199], v[200:203], 0
    v_xor_b32 v50, 65728, v41
    v_xor_b32 v51, 65760, v41
    v_mfma_f32_16x16x32_bf16 v[128:131], a[192:195], v[200:203], 0
    s_sub_u32 s34, s57, s56
    ds_read_b64_tr_b16 a[252:253], v15 offset:8192
    ds_read_b64_tr_b16 a[254:255], v15 offset:12288
    v_mfma_f32_16x16x32_bf16 v[160:163], a[192:195], v[204:207], 0
    v_lshrrev_b32 v52, 5, v1
    v_and_b32 v53, 31, v1
    v_mfma_f32_16x16x32_bf16 v[164:167], a[196:199], v[204:207], 0
    v_mul_u32_u24 v52, s34, v52
    v_lshl_add_u32 v52, v53, 7, v52
    v_mfma_f32_16x16x32_bf16 v[168:171], a[200:203], v[204:207], 0
    v_and_b32 v34, 0x19, v1
    v_mfma_f32_16x16x32_bf16 v[172:175], a[204:207], v[204:207], 0
    v_xor_b32 v34, s2, v34
    v_mfma_f32_16x16x32_bf16 v[176:179], a[208:211], v[204:207], 0
    v_lshlrev_b32 v3, 7, v34
    v_mfma_f32_16x16x32_bf16 v[180:183], a[212:215], v[204:207], 0
    v_and_b32 v34, 6, v1
    v_mfma_f32_16x16x32_bf16 v[184:187], a[216:219], v[204:207], 0
    v_xor_b32 v34, s2, v34
    v_mfma_f32_16x16x32_bf16 v[188:191], a[220:223], v[204:207], 0
    v_mov_b32 v32, 4
    v_mfma_f32_16x16x32_bf16 v[92:95], a[220:223], v[192:195], 0
    v_writelane_b32 v34, s0, 0
    v_mfma_f32_16x16x32_bf16 v[88:91], a[216:219], v[192:195], 0
    v_writelane_b32 v32, 5, 0
    v_mfma_f32_16x16x32_bf16 v[84:87], a[212:215], v[192:195], 0
    v_writelane_b32 v34, s1, 1
    v_mfma_f32_16x16x32_bf16 v[80:83], a[208:211], v[192:195], 0
    v_writelane_b32 v32, 5, 1
    v_mfma_f32_16x16x32_bf16 v[76:79], a[204:207], v[192:195], 0
    v_lshlrev_b32 v33, 7, v34
    v_mfma_f32_16x16x32_bf16 v[72:75], a[200:203], v[192:195], 0
    v_mfma_f32_16x16x32_bf16 v[68:71], a[196:199], v[192:195], 0
    s_waitcnt lgkmcnt(0)
    v_mfma_f32_16x16x32_bf16 v[64:67], a[192:195], v[192:195], 0
    s_lshr_b32 s33, s31, 3
    v_mfma_f32_16x16x32_bf16 v[96:99], a[224:227], v[212:215], v[96:99]
    s_lshl2_add_u32 s0, s0, s30
    v_mfma_f32_16x16x32_bf16 v[100:103], a[228:231], v[212:215], v[100:103]
    s_lshl2_add_u32 s0, s0, s33
    ds_read_b64_tr_b16 a[192:193], v8 offset:16384
    ds_read_b64_tr_b16 a[194:195], v8 offset:20480
    v_mfma_f32_16x16x32_bf16 v[104:107], a[232:235], v[212:215], v[104:107]
    s_lshl_b32 s0, s0, 12
    v_mfma_f32_16x16x32_bf16 v[108:111], a[236:239], v[212:215], v[108:111]
    s_lshl2_add_u32 s1, s1, s30
    ds_read_b64_tr_b16 a[196:197], v9 offset:16384
    ds_read_b64_tr_b16 a[198:199], v9 offset:20480
    v_mfma_f32_16x16x32_bf16 v[112:115], a[240:243], v[212:215], v[112:115]
    s_lshl2_add_u32 s1, s1, s33
    v_mfma_f32_16x16x32_bf16 v[116:119], a[244:247], v[212:215], v[116:119]
    s_lshl_b32 s1, s1, 12
    ds_read_b64_tr_b16 a[200:201], v10 offset:16384
    ds_read_b64_tr_b16 a[202:203], v10 offset:20480
    v_mfma_f32_16x16x32_bf16 v[120:123], a[248:251], v[212:215], v[120:123]
    s_xor_b32 s72, s2, 2
    v_mfma_f32_16x16x32_bf16 v[124:127], a[252:255], v[212:215], v[124:127]
    s_lshl2_add_u32 s72, s72, s30
    ds_read_b64_tr_b16 a[204:205], v11 offset:16384
    ds_read_b64_tr_b16 a[206:207], v11 offset:20480
    v_mfma_f32_16x16x32_bf16 v[156:159], a[252:255], v[216:219], v[156:159]
    s_lshl_b32 s72, s72, 14
    v_mfma_f32_16x16x32_bf16 v[152:155], a[248:251], v[216:219], v[152:155]
    s_xor_b32 s73, s2, 4
    ds_read_b64_tr_b16 a[208:209], v12 offset:16384
    ds_read_b64_tr_b16 a[210:211], v12 offset:20480
    v_mfma_f32_16x16x32_bf16 v[148:151], a[244:247], v[216:219], v[148:151]
    s_lshl2_add_u32 s73, s73, s30
    v_mfma_f32_16x16x32_bf16 v[144:147], a[240:243], v[216:219], v[144:147]
    s_lshl_b32 s73, s73, 14
    ds_read_b64_tr_b16 a[212:213], v13 offset:16384
    ds_read_b64_tr_b16 a[214:215], v13 offset:20480
    v_mfma_f32_16x16x32_bf16 v[140:143], a[236:239], v[216:219], v[140:143]
    s_add_u32 s73, s73, 4096
    v_mfma_f32_16x16x32_bf16 v[136:139], a[232:235], v[216:219], v[136:139]
    s_xor_b32 s74, s2, 6
    ds_read_b64_tr_b16 a[216:217], v14 offset:16384
    ds_read_b64_tr_b16 a[218:219], v14 offset:20480
    v_mfma_f32_16x16x32_bf16 v[132:135], a[228:231], v[216:219], v[132:135]
    s_lshl2_add_u32 s74, s74, s30
    v_mfma_f32_16x16x32_bf16 v[128:131], a[224:227], v[216:219], v[128:131]
    s_lshl_b32 s74, s74, 14
    ds_read_b64_tr_b16 a[220:221], v15 offset:16384
    ds_read_b64_tr_b16 a[222:223], v15 offset:20480
    v_mfma_f32_16x16x32_bf16 v[160:163], a[224:227], v[220:223], v[160:163]
    s_add_u32 s74, s74, 8192
    v_mfma_f32_16x16x32_bf16 v[164:167], a[228:231], v[220:223], v[164:167]
    v_mfma_f32_16x16x32_bf16 v[168:171], a[232:235], v[220:223], v[168:171]
    v_mfma_f32_16x16x32_bf16 v[172:175], a[236:239], v[220:223], v[172:175]
    v_mfma_f32_16x16x32_bf16 v[176:179], a[240:243], v[220:223], v[176:179]
    v_mfma_f32_16x16x32_bf16 v[180:183], a[244:247], v[220:223], v[180:183]
    v_mfma_f32_16x16x32_bf16 v[184:187], a[248:251], v[220:223], v[184:187]
    v_mfma_f32_16x16x32_bf16 v[188:191], a[252:255], v[220:223], v[188:191]
    v_mfma_f32_16x16x32_bf16 v[92:95], a[252:255], v[208:211], v[92:95]
    v_mfma_f32_16x16x32_bf16 v[88:91], a[248:251], v[208:211], v[88:91]
    v_mfma_f32_16x16x32_bf16 v[84:87], a[244:247], v[208:211], v[84:87]
    v_mfma_f32_16x16x32_bf16 v[80:83], a[240:243], v[208:211], v[80:83]
    v_mfma_f32_16x16x32_bf16 v[76:79], a[236:239], v[208:211], v[76:79]
    v_mfma_f32_16x16x32_bf16 v[72:75], a[232:235], v[208:211], v[72:75]
    v_mfma_f32_16x16x32_bf16 v[68:71], a[228:231], v[208:211], v[68:71]
    v_mfma_f32_16x16x32_bf16 v[64:67], a[224:227], v[208:211], v[64:67]
    s_waitcnt lgkmcnt(0)
    v_mfma_f32_16x16x32_bf16 v[96:99], a[192:195], v[228:231], v[96:99]
    v_mfma_f32_16x16x32_bf16 v[100:103], a[196:199], v[228:231], v[100:103]
    ds_read_b64_tr_b16 a[224:225], v8 offset:24576
    ds_read_b64_tr_b16 a[226:227], v8 offset:28672
    v_mfma_f32_16x16x32_bf16 v[104:107], a[200:203], v[228:231], v[104:107]
    v_mfma_f32_16x16x32_bf16 v[108:111], a[204:207], v[228:231], v[108:111]
    ds_read_b64_tr_b16 a[228:229], v9 offset:24576
    ds_read_b64_tr_b16 a[230:231], v9 offset:28672
    v_mfma_f32_16x16x32_bf16 v[112:115], a[208:211], v[228:231], v[112:115]
    v_mfma_f32_16x16x32_bf16 v[116:119], a[212:215], v[228:231], v[116:119]
    ds_read_b64_tr_b16 a[232:233], v10 offset:24576
    ds_read_b64_tr_b16 a[234:235], v10 offset:28672
    v_mfma_f32_16x16x32_bf16 v[120:123], a[216:219], v[228:231], v[120:123]
    v_mfma_f32_16x16x32_bf16 v[124:127], a[220:223], v[228:231], v[124:127]
    ds_read_b64_tr_b16 a[236:237], v11 offset:24576
    ds_read_b64_tr_b16 a[238:239], v11 offset:28672
    v_mfma_f32_16x16x32_bf16 v[156:159], a[220:223], v[232:235], v[156:159]
    v_mfma_f32_16x16x32_bf16 v[152:155], a[216:219], v[232:235], v[152:155]
    ds_read_b64_tr_b16 a[240:241], v12 offset:24576
    ds_read_b64_tr_b16 a[242:243], v12 offset:28672
    v_mfma_f32_16x16x32_bf16 v[148:151], a[212:215], v[232:235], v[148:151]
    v_mfma_f32_16x16x32_bf16 v[144:147], a[208:211], v[232:235], v[144:147]
    ds_read_b64_tr_b16 a[244:245], v13 offset:24576
    ds_read_b64_tr_b16 a[246:247], v13 offset:28672
    v_mfma_f32_16x16x32_bf16 v[140:143], a[204:207], v[232:235], v[140:143]
    v_mfma_f32_16x16x32_bf16 v[136:139], a[200:203], v[232:235], v[136:139]
    ds_read_b64_tr_b16 a[248:249], v14 offset:24576
    ds_read_b64_tr_b16 a[250:251], v14 offset:28672
    v_mfma_f32_16x16x32_bf16 v[132:135], a[196:199], v[232:235], v[132:135]
    v_mfma_f32_16x16x32_bf16 v[128:131], a[192:195], v[232:235], v[128:131]
    ds_read_b64_tr_b16 a[252:253], v15 offset:24576
    ds_read_b64_tr_b16 a[254:255], v15 offset:28672
    v_mfma_f32_16x16x32_bf16 v[160:163], a[192:195], v[236:239], v[160:163]
    v_mfma_f32_16x16x32_bf16 v[164:167], a[196:199], v[236:239], v[164:167]
    v_mfma_f32_16x16x32_bf16 v[168:171], a[200:203], v[236:239], v[168:171]
    v_mfma_f32_16x16x32_bf16 v[172:175], a[204:207], v[236:239], v[172:175]
    v_mfma_f32_16x16x32_bf16 v[176:179], a[208:211], v[236:239], v[176:179]
    v_mfma_f32_16x16x32_bf16 v[180:183], a[212:215], v[236:239], v[180:183]
    v_mfma_f32_16x16x32_bf16 v[184:187], a[216:219], v[236:239], v[184:187]
    v_mfma_f32_16x16x32_bf16 v[188:191], a[220:223], v[236:239], v[188:191]
    v_mfma_f32_16x16x32_bf16 v[92:95], a[220:223], v[224:227], v[92:95]
    v_mfma_f32_16x16x32_bf16 v[88:91], a[216:219], v[224:227], v[88:91]
    v_mfma_f32_16x16x32_bf16 v[84:87], a[212:215], v[224:227], v[84:87]
    v_mfma_f32_16x16x32_bf16 v[80:83], a[208:211], v[224:227], v[80:83]
    v_mfma_f32_16x16x32_bf16 v[76:79], a[204:207], v[224:227], v[76:79]
    v_mfma_f32_16x16x32_bf16 v[72:75], a[200:203], v[224:227], v[72:75]
    v_mov_b32 v5, 4
    v_mfma_f32_16x16x32_bf16 v[68:71], a[196:199], v[224:227], v[68:71]
    v_mfma_f32_16x16x32_bf16 v[64:67], a[192:195], v[224:227], v[64:67]
    s_waitcnt lgkmcnt(0)
    v_mfma_f32_16x16x32_bf16 v[96:99], a[224:227], v[244:247], v[96:99]
    s_waitcnt vmcnt(0) lgkmcnt(0)
    v_mfma_f32_16x16x32_bf16 v[100:103], a[228:231], v[244:247], v[100:103]
    s_barrier
    buffer_store_dword v5, v0, s[76:79], 0 offen sc1
    v_mfma_f32_16x16x32_bf16 v[104:107], a[232:235], v[244:247], v[104:107]
    s_add_u32 m0, s84, 0
    ds_read_b64_tr_b16 a[192:193], v16 offset:32768
    ds_read_b64_tr_b16 a[194:195], v16 offset:36864
    v_mfma_f32_16x16x32_bf16 v[108:111], a[236:239], v[244:247], v[108:111]
    buffer_load_dwordx4 v28, s[8:11], s48 offen offset:0 lds
    v_mfma_f32_16x16x32_bf16 v[112:115], a[240:243], v[244:247], v[112:115]
    ds_read_b64_tr_b16 a[196:197], v17 offset:32768
    ds_read_b64_tr_b16 a[198:199], v17 offset:36864
    v_mfma_f32_16x16x32_bf16 v[116:119], a[244:247], v[244:247], v[116:119]
    buffer_load_dwordx4 v29, s[8:11], s48 offen offset:1024 lds
    v_mfma_f32_16x16x32_bf16 v[120:123], a[248:251], v[244:247], v[120:123]
    ds_read_b64_tr_b16 a[200:201], v18 offset:32768
    ds_read_b64_tr_b16 a[202:203], v18 offset:36864
    v_mfma_f32_16x16x32_bf16 v[124:127], a[252:255], v[244:247], v[124:127]
    buffer_load_dwordx4 v30, s[8:11], s48 offen offset:2048 lds
    v_mfma_f32_16x16x32_bf16 v[156:159], a[252:255], v[248:251], v[156:159]
    ds_read_b64_tr_b16 a[204:205], v19 offset:32768
    ds_read_b64_tr_b16 a[206:207], v19 offset:36864
    v_mfma_f32_16x16x32_bf16 v[152:155], a[248:251], v[248:251], v[152:155]
    buffer_load_dwordx4 v31, s[8:11], s48 offen offset:3072 lds
    v_mfma_f32_16x16x32_bf16 v[148:151], a[244:247], v[248:251], v[148:151]
    s_add_u32 m0, s84, 4096
    ds_read_b64_tr_b16 a[208:209], v20 offset:32768
    ds_read_b64_tr_b16 a[210:211], v20 offset:36864
    v_mfma_f32_16x16x32_bf16 v[144:147], a[240:243], v[248:251], v[144:147]
    s_add_u32 s48, s48, 20480
    v_mfma_f32_16x16x32_bf16 v[140:143], a[236:239], v[248:251], v[140:143]
    ds_read_b64_tr_b16 a[212:213], v21 offset:32768
    ds_read_b64_tr_b16 a[214:215], v21 offset:36864
    v_mfma_f32_16x16x32_bf16 v[136:139], a[232:235], v[248:251], v[136:139]
    buffer_load_dwordx4 v28, s[8:11], s48 offen offset:0 lds
    v_mfma_f32_16x16x32_bf16 v[132:135], a[228:231], v[248:251], v[132:135]
    ds_read_b64_tr_b16 a[216:217], v22 offset:32768
    ds_read_b64_tr_b16 a[218:219], v22 offset:36864
    v_mfma_f32_16x16x32_bf16 v[128:131], a[224:227], v[248:251], v[128:131]
    buffer_load_dwordx4 v29, s[8:11], s48 offen offset:1024 lds
    v_mfma_f32_16x16x32_bf16 v[160:163], a[224:227], v[252:255], v[160:163]
    ds_read_b64_tr_b16 a[220:221], v23 offset:32768
    ds_read_b64_tr_b16 a[222:223], v23 offset:36864
    v_mfma_f32_16x16x32_bf16 v[164:167], a[228:231], v[252:255], v[164:167]
    buffer_load_dwordx4 v30, s[8:11], s48 offen offset:2048 lds
    v_mfma_f32_16x16x32_bf16 v[168:171], a[232:235], v[252:255], v[168:171]
    buffer_load_dwordx4 v31, s[8:11], s48 offen offset:3072 lds
    v_mfma_f32_16x16x32_bf16 v[172:175], a[236:239], v[252:255], v[172:175]
    s_add_u32 m0, s86, 0
    v_mfma_f32_16x16x32_bf16 v[176:179], a[240:243], v[252:255], v[176:179]
    buffer_load_dwordx4 v28, s[8:11], s49 offen offset:0 lds
    v_mfma_f32_16x16x32_bf16 v[180:183], a[244:247], v[252:255], v[180:183]
    buffer_load_dwordx4 v29, s[8:11], s49 offen offset:1024 lds
    v_mfma_f32_16x16x32_bf16 v[184:187], a[248:251], v[252:255], v[184:187]
    buffer_load_dwordx4 v30, s[8:11], s49 offen offset:2048 lds
    v_mfma_f32_16x16x32_bf16 v[188:191], a[252:255], v[252:255], v[188:191]
    buffer_load_dwordx4 v31, s[8:11], s49 offen offset:3072 lds
    v_mfma_f32_16x16x32_bf16 v[92:95], a[252:255], v[240:243], v[92:95]
    s_add_u32 m0, s86, 4096
    v_mfma_f32_16x16x32_bf16 v[88:91], a[248:251], v[240:243], v[88:91]
    s_add_u32 s49, s49, 20480
    v_mfma_f32_16x16x32_bf16 v[84:87], a[244:247], v[240:243], v[84:87]
    buffer_load_dwordx4 v28, s[8:11], s49 offen offset:0 lds
    v_mfma_f32_16x16x32_bf16 v[80:83], a[240:243], v[240:243], v[80:83]
    buffer_load_dwordx4 v29, s[8:11], s49 offen offset:1024 lds
    v_mfma_f32_16x16x32_bf16 v[76:79], a[236:239], v[240:243], v[76:79]
    buffer_load_dwordx4 v30, s[8:11], s49 offen offset:2048 lds
    v_mfma_f32_16x16x32_bf16 v[72:75], a[232:235], v[240:243], v[72:75]
    buffer_load_dwordx4 v31, s[8:11], s49 offen offset:3072 lds
    v_mfma_f32_16x16x32_bf16 v[68:71], a[228:231], v[240:243], v[68:71]
    v_mfma_f32_16x16x32_bf16 v[64:67], a[224:227], v[240:243], v[64:67]
    s_waitcnt lgkmcnt(0)
    buffer_load_dword v34, v3, s[88:91], 0 offen sc1
    s_waitcnt vmcnt(0)
    v_cmp_gt_u32 vcc, 4, v34
    s_nop 0
    s_cbranch_vccnz SP_ctx
SR_ctx:
    s_bfe_u32 s61, s40, 0x40004
    s_lshl_b32 s61, s61, 12
    buffer_load_dwordx4 a[132:135], v37, s[20:23], s61 offen offset:0 sc1
    buffer_load_dwordx4 a[136:139], v38, s[20:23], s61 offen offset:0 sc1
    buffer_load_dwordx4 a[140:143], v39, s[20:23], s61 offen offset:0 sc1
    buffer_load_dwordx4 a[128:131], v36, s[20:23], s61 offen offset:0 sc1
    buffer_load_dwordx4 a[148:151], v37, s[20:23], s61 offen offset:1024 sc1
    buffer_load_dwordx4 a[152:155], v38, s[20:23], s61 offen offset:1024 sc1
    buffer_load_dwordx4 a[156:159], v39, s[20:23], s61 offen offset:1024 sc1
    buffer_load_dwordx4 a[144:147], v36, s[20:23], s61 offen offset:1024 sc1
    buffer_load_dwordx4 a[164:167], v37, s[20:23], s61 offen offset:2048 sc1
    buffer_load_dwordx4 a[168:171], v38, s[20:23], s61 offen offset:2048 sc1
    buffer_load_dwordx4 a[172:175], v39, s[20:23], s61 offen offset:2048 sc1
    buffer_load_dwordx4 a[160:163], v36, s[20:23], s61 offen offset:2048 sc1
    buffer_load_dwordx4 a[180:183], v37, s[20:23], s61 offen offset:3072 sc1
    buffer_load_dwordx4 a[184:187], v38, s[20:23], s61 offen offset:3072 sc1
    buffer_load_dwordx4 a[188:191], v39, s[20:23], s61 offen offset:3072 sc1
    buffer_load_dwordx4 a[176:179], v36, s[20:23], s61 offen offset:3072 sc1
    s_waitcnt vmcnt(15)
    v_mfma_f32_16x16x32_bf16 v[96:99], a[192:195], a[132:135], v[96:99]
    s_bfe_u32 s61, s40, 0x40008
    v_mfma_f32_16x16x32_bf16 v[100:103], a[196:199], a[132:135], v[100:103]
    s_lshl_b32 s61, s61, 12
    ds_read_b64_tr_b16 a[224:225], v16 offset:40960
    ds_read_b64_tr_b16 a[226:227], v16 offset:45056
    v_mfma_f32_16x16x32_bf16 v[104:107], a[200:203], a[132:135], v[104:107]
    buffer_load_dwordx4 v[196:199], v37, s[20:23], s61 offen offset:0 sc1
    v_mfma_f32_16x16x32_bf16 v[108:111], a[204:207], a[132:135], v[108:111]
    ds_read_b64_tr_b16 a[228:229], v17 offset:40960
    ds_read_b64_tr_b16 a[230:231], v17 offset:45056
    v_mfma_f32_16x16x32_bf16 v[112:115], a[208:211], a[132:135], v[112:115]
    buffer_load_dwordx4 v[200:203], v38, s[20:23], s61 offen offset:0 sc1
    v_mfma_f32_16x16x32_bf16 v[116:119], a[212:215], a[132:135], v[116:119]
    ds_read_b64_tr_b16 a[232:233], v18 offset:40960
    ds_read_b64_tr_b16 a[234:235], v18 offset:45056
    v_mfma_f32_16x16x32_bf16 v[120:123], a[216:219], a[132:135], v[120:123]
    buffer_load_dwordx4 v[204:207], v39, s[20:23], s61 offen offset:0 sc1
    v_mfma_f32_16x16x32_bf16 v[124:127], a[220:223], a[132:135], v[124:127]
    s_waitcnt vmcnt(17)
    ds_read_b64_tr_b16 a[236:237], v19 offset:40960
    ds_read_b64_tr_b16 a[238:239], v19 offset:45056
    v_mfma_f32_16x16x32_bf16 v[156:159], a[220:223], a[136:139], v[156:159]
    buffer_load_dwordx4 v[192:195], v36, s[20:23], s61 offen offset:0 sc1
    v_mfma_f32_16x16x32_bf16 v[152:155], a[216:219], a[136:139], v[152:155]
    ds_read_b64_tr_b16 a[240:241], v20 offset:40960
    ds_read_b64_tr_b16 a[242:243], v20 offset:45056
    v_mfma_f32_16x16x32_bf16 v[148:151], a[212:215], a[136:139], v[148:151]
    v_mfma_f32_16x16x32_bf16 v[144:147], a[208:211], a[136:139], v[144:147]
    ds_read_b64_tr_b16 a[244:245], v21 offset:40960
    ds_read_b64_tr_b16 a[246:247], v21 offset:45056
    v_mfma_f32_16x16x32_bf16 v[140:143], a[204:207], a[136:139], v[140:143]
    buffer_load_dwordx4 v[212:215], v37, s[20:23], s61 offen offset:1024 sc1
    v_mfma_f32_16x16x32_bf16 v[136:139], a[200:203], a[136:139], v[136:139]
    ds_read_b64_tr_b16 a[248:249], v22 offset:40960
    ds_read_b64_tr_b16 a[250:251], v22 offset:45056
    v_mfma_f32_16x16x32_bf16 v[132:135], a[196:199], a[136:139], v[132:135]
    buffer_load_dwordx4 v[216:219], v38, s[20:23], s61 offen offset:1024 sc1
    v_mfma_f32_16x16x32_bf16 v[128:131], a[192:195], a[136:139], v[128:131]
    s_waitcnt vmcnt(19)
    ds_read_b64_tr_b16 a[252:253], v23 offset:40960
    ds_read_b64_tr_b16 a[254:255], v23 offset:45056
    v_mfma_f32_16x16x32_bf16 v[160:163], a[192:195], a[140:143], v[160:163]
    buffer_load_dwordx4 v[220:223], v39, s[20:23], s61 offen offset:1024 sc1
    v_mfma_f32_16x16x32_bf16 v[164:167], a[196:199], a[140:143], v[164:167]
    v_mfma_f32_16x16x32_bf16 v[168:171], a[200:203], a[140:143], v[168:171]
    buffer_load_dwordx4 v[208:211], v36, s[20:23], s61 offen offset:1024 sc1
    v_mfma_f32_16x16x32_bf16 v[172:175], a[204:207], a[140:143], v[172:175]
    v_mfma_f32_16x16x32_bf16 v[176:179], a[208:211], a[140:143], v[176:179]
    v_mfma_f32_16x16x32_bf16 v[180:183], a[212:215], a[140:143], v[180:183]
    buffer_load_dwordx4 v[228:231], v37, s[20:23], s61 offen offset:2048 sc1
    v_mfma_f32_16x16x32_bf16 v[184:187], a[216:219], a[140:143], v[184:187]
    v_mfma_f32_16x16x32_bf16 v[188:191], a[220:223], a[140:143], v[188:191]
    s_waitcnt vmcnt(21)
    buffer_load_dwordx4 v[232:235], v38, s[20:23], s61 offen offset:2048 sc1
    v_mfma_f32_16x16x32_bf16 v[92:95], a[220:223], a[128:131], v[92:95]
    v_mfma_f32_16x16x32_bf16 v[88:91], a[216:219], a[128:131], v[88:91]
    buffer_load_dwordx4 v[236:239], v39, s[20:23], s61 offen offset:2048 sc1
    v_mfma_f32_16x16x32_bf16 v[84:87], a[212:215], a[128:131], v[84:87]
    v_mfma_f32_16x16x32_bf16 v[80:83], a[208:211], a[128:131], v[80:83]
    buffer_load_dwordx4 v[224:227], v36, s[20:23], s61 offen offset:2048 sc1
    v_mfma_f32_16x16x32_bf16 v[76:79], a[204:207], a[128:131], v[76:79]
    v_mfma_f32_16x16x32_bf16 v[72:75], a[200:203], a[128:131], v[72:75]
    v_mfma_f32_16x16x32_bf16 v[68:71], a[196:199], a[128:131], v[68:71]
    buffer_load_dwordx4 v[244:247], v37, s[20:23], s61 offen offset:3072 sc1
    v_mfma_f32_16x16x32_bf16 v[64:67], a[192:195], a[128:131], v[64:67]
    s_waitcnt lgkmcnt(0) vmcnt(24)
    v_mfma_f32_16x16x32_bf16 v[96:99], a[224:227], a[148:151], v[96:99]
    buffer_load_dwordx4 v[248:251], v38, s[20:23], s61 offen offset:3072 sc1
    v_mfma_f32_16x16x32_bf16 v[100:103], a[228:231], a[148:151], v[100:103]
    ds_read_b64_tr_b16 a[192:193], v16 offset:49152
    ds_read_b64_tr_b16 a[194:195], v16 offset:53248
    v_mfma_f32_16x16x32_bf16 v[104:107], a[232:235], a[148:151], v[104:107]
    buffer_load_dwordx4 v[252:255], v39, s[20:23], s61 offen offset:3072 sc1
    v_mfma_f32_16x16x32_bf16 v[108:111], a[236:239], a[148:151], v[108:111]
    ds_read_b64_tr_b16 a[196:197], v17 offset:49152
    ds_read_b64_tr_b16 a[198:199], v17 offset:53248
    v_mfma_f32_16x16x32_bf16 v[112:115], a[240:243], a[148:151], v[112:115]
    buffer_load_dwordx4 v[240:243], v36, s[20:23], s61 offen offset:3072 sc1
    v_mfma_f32_16x16x32_bf16 v[116:119], a[244:247], a[148:151], v[116:119]
    ds_read_b64_tr_b16 a[200:201], v18 offset:49152
    ds_read_b64_tr_b16 a[202:203], v18 offset:53248
    v_mfma_f32_16x16x32_bf16 v[120:123], a[248:251], a[148:151], v[120:123]
    s_waitcnt vmcnt(26)
    v_mfma_f32_16x16x32_bf16 v[124:127], a[252:255], a[148:151], v[124:127]
    s_bfe_u32 s61, s40, 0x4000c
    ds_read_b64_tr_b16 a[204:205], v19 offset:49152
    ds_read_b64_tr_b16 a[206:207], v19 offset:53248
    v_mfma_f32_16x16x32_bf16 v[156:159], a[252:255], a[152:155], v[156:159]
    s_lshl_b32 s61, s61, 12
    buffer_load_dwordx4 a[132:135], v37, s[20:23], s61 offen offset:0 sc1
    v_mfma_f32_16x16x32_bf16 v[152:155], a[248:251], a[152:155], v[152:155]
    ds_read_b64_tr_b16 a[208:209], v20 offset:49152
    ds_read_b64_tr_b16 a[210:211], v20 offset:53248
    v_mfma_f32_16x16x32_bf16 v[148:151], a[244:247], a[152:155], v[148:151]
    buffer_load_dwordx4 a[136:139], v38, s[20:23], s61 offen offset:0 sc1
    v_mfma_f32_16x16x32_bf16 v[144:147], a[240:243], a[152:155], v[144:147]
    ds_read_b64_tr_b16 a[212:213], v21 offset:49152
    ds_read_b64_tr_b16 a[214:215], v21 offset:53248
    v_mfma_f32_16x16x32_bf16 v[140:143], a[236:239], a[152:155], v[140:143]
    buffer_load_dwordx4 a[140:143], v39, s[20:23], s61 offen offset:0 sc1
    v_mfma_f32_16x16x32_bf16 v[136:139], a[232:235], a[152:155], v[136:139]
    ds_read_b64_tr_b16 a[216:217], v22 offset:49152
    ds_read_b64_tr_b16 a[218:219], v22 offset:53248
    v_mfma_f32_16x16x32_bf16 v[132:135], a[228:231], a[152:155], v[132:135]
    v_mfma_f32_16x16x32_bf16 v[128:131], a[224:227], a[152:155], v[128:131]
    s_waitcnt vmcnt(28)
    ds_read_b64_tr_b16 a[220:221], v23 offset:49152
    ds_read_b64_tr_b16 a[222:223], v23 offset:53248
    v_mfma_f32_16x16x32_bf16 v[160:163], a[224:227], a[156:159], v[160:163]
    v_mfma_f32_16x16x32_bf16 v[164:167], a[228:231], a[156:159], v[164:167]
    v_mfma_f32_16x16x32_bf16 v[168:171], a[232:235], a[156:159], v[168:171]
    v_mfma_f32_16x16x32_bf16 v[172:175], a[236:239], a[156:159], v[172:175]
    v_mfma_f32_16x16x32_bf16 v[176:179], a[240:243], a[156:159], v[176:179]
    v_mfma_f32_16x16x32_bf16 v[180:183], a[244:247], a[156:159], v[180:183]
    v_mfma_f32_16x16x32_bf16 v[184:187], a[248:251], a[156:159], v[184:187]
    v_mfma_f32_16x16x32_bf16 v[188:191], a[252:255], a[156:159], v[188:191]
    s_waitcnt vmcnt(27)
    v_mfma_f32_16x16x32_bf16 v[92:95], a[252:255], a[144:147], v[92:95]
    v_mfma_f32_16x16x32_bf16 v[88:91], a[248:251], a[144:147], v[88:91]
    v_mfma_f32_16x16x32_bf16 v[84:87], a[244:247], a[144:147], v[84:87]
    v_mfma_f32_16x16x32_bf16 v[80:83], a[240:243], a[144:147], v[80:83]
    v_mfma_f32_16x16x32_bf16 v[76:79], a[236:239], a[144:147], v[76:79]
    v_mfma_f32_16x16x32_bf16 v[72:75], a[232:235], a[144:147], v[72:75]
    v_mfma_f32_16x16x32_bf16 v[68:71], a[228:231], a[144:147], v[68:71]
    v_mfma_f32_16x16x32_bf16 v[64:67], a[224:227], a[144:147], v[64:67]
    s_waitcnt lgkmcnt(0) vmcnt(26)
    v_mfma_f32_16x16x32_bf16 v[96:99], a[192:195], a[164:167], v[96:99]
    buffer_load_dwordx4 a[148:151], v37, s[20:23], s61 offen offset:1024 sc1
    v_mfma_f32_16x16x32_bf16 v[100:103], a[196:199], a[164:167], v[100:103]
    ds_read_b64_tr_b16 a[224:225], v16 offset:57344
    ds_read_b64_tr_b16 a[226:227], v16 offset:61440
    v_mfma_f32_16x16x32_bf16 v[104:107], a[200:203], a[164:167], v[104:107]
    buffer_load_dwordx4 a[152:155], v38, s[20:23], s61 offen offset:1024 sc1
    v_mfma_f32_16x16x32_bf16 v[108:111], a[204:207], a[164:167], v[108:111]
    ds_read_b64_tr_b16 a[228:229], v17 offset:57344
    ds_read_b64_tr_b16 a[230:231], v17 offset:61440
    v_mfma_f32_16x16x32_bf16 v[112:115], a[208:211], a[164:167], v[112:115]
    buffer_load_dwordx4 a[156:159], v39, s[20:23], s61 offen offset:1024 sc1
    v_mfma_f32_16x16x32_bf16 v[116:119], a[212:215], a[164:167], v[116:119]
    ds_read_b64_tr_b16 a[232:233], v18 offset:57344
    ds_read_b64_tr_b16 a[234:235], v18 offset:61440
    v_mfma_f32_16x16x32_bf16 v[120:123], a[216:219], a[164:167], v[120:123]
    v_mfma_f32_16x16x32_bf16 v[124:127], a[220:223], a[164:167], v[124:127]
    s_waitcnt vmcnt(28)
    ds_read_b64_tr_b16 a[236:237], v19 offset:57344
    ds_read_b64_tr_b16 a[238:239], v19 offset:61440
    v_mfma_f32_16x16x32_bf16 v[156:159], a[220:223], a[168:171], v[156:159]
    v_mfma_f32_16x16x32_bf16 v[152:155], a[216:219], a[168:171], v[152:155]
    ds_read_b64_tr_b16 a[240:241], v20 offset:57344
    ds_read_b64_tr_b16 a[242:243], v20 offset:61440
    v_mfma_f32_16x16x32_bf16 v[148:151], a[212:215], a[168:171], v[148:151]
    v_mfma_f32_16x16x32_bf16 v[144:147], a[208:211], a[168:171], v[144:147]
    ds_read_b64_tr_b16 a[244:245], v21 offset:57344
    ds_read_b64_tr_b16 a[246:247], v21 offset:61440
    v_mfma_f32_16x16x32_bf16 v[140:143], a[204:207], a[168:171], v[140:143]
    v_mfma_f32_16x16x32_bf16 v[136:139], a[200:203], a[168:171], v[136:139]
    ds_read_b64_tr_b16 a[248:249], v22 offset:57344
    ds_read_b64_tr_b16 a[250:251], v22 offset:61440
    v_mfma_f32_16x16x32_bf16 v[132:135], a[196:199], a[168:171], v[132:135]
    v_mfma_f32_16x16x32_bf16 v[128:131], a[192:195], a[168:171], v[128:131]
    s_waitcnt vmcnt(27)
    ds_read_b64_tr_b16 a[252:253], v23 offset:57344
    ds_read_b64_tr_b16 a[254:255], v23 offset:61440
    v_mfma_f32_16x16x32_bf16 v[160:163], a[192:195], a[172:175], v[160:163]
    v_mfma_f32_16x16x32_bf16 v[164:167], a[196:199], a[172:175], v[164:167]
    v_mfma_f32_16x16x32_bf16 v[168:171], a[200:203], a[172:175], v[168:171]
    v_mfma_f32_16x16x32_bf16 v[172:175], a[204:207], a[172:175], v[172:175]
    v_mfma_f32_16x16x32_bf16 v[176:179], a[208:211], a[172:175], v[176:179]
    v_mfma_f32_16x16x32_bf16 v[180:183], a[212:215], a[172:175], v[180:183]
    v_mfma_f32_16x16x32_bf16 v[184:187], a[216:219], a[172:175], v[184:187]
    v_mfma_f32_16x16x32_bf16 v[188:191], a[220:223], a[172:175], v[188:191]
    s_waitcnt vmcnt(26)
    v_mfma_f32_16x16x32_bf16 v[92:95], a[220:223], a[160:163], v[92:95]
    v_mfma_f32_16x16x32_bf16 v[88:91], a[216:219], a[160:163], v[88:91]
    v_mfma_f32_16x16x32_bf16 v[84:87], a[212:215], a[160:163], v[84:87]
    v_mfma_f32_16x16x32_bf16 v[80:83], a[208:211], a[160:163], v[80:83]
    v_mfma_f32_16x16x32_bf16 v[76:79], a[204:207], a[160:163], v[76:79]
    v_mfma_f32_16x16x32_bf16 v[72:75], a[200:203], a[160:163], v[72:75]
    v_mfma_f32_16x16x32_bf16 v[68:71], a[196:199], a[160:163], v[68:71]
    v_mfma_f32_16x16x32_bf16 v[64:67], a[192:195], a[160:163], v[64:67]
    s_waitcnt lgkmcnt(0) vmcnt(25)
    v_mfma_f32_16x16x32_bf16 v[96:99], a[224:227], a[180:183], v[96:99]
    buffer_load_dwordx4 a[164:167], v37, s[20:23], s61 offen offset:2048 sc1
    v_mfma_f32_16x16x32_bf16 v[100:103], a[228:231], a[180:183], v[100:103]
    ds_read_b64_tr_b16 a[192:193], v44 offset:0
    ds_read_b64_tr_b16 a[194:195], v44 offset:4096
    v_mfma_f32_16x16x32_bf16 v[104:107], a[232:235], a[180:183], v[104:107]
    buffer_load_dwordx4 a[168:171], v38, s[20:23], s61 offen offset:2048 sc1
    v_mfma_f32_16x16x32_bf16 v[108:111], a[236:239], a[180:183], v[108:111]
    ds_read_b64_tr_b16 a[196:197], v45 offset:0
    ds_read_b64_tr_b16 a[198:199], v45 offset:4096
    v_mfma_f32_16x16x32_bf16 v[112:115], a[240:243], a[180:183], v[112:115]
    buffer_load_dwordx4 a[172:175], v39, s[20:23], s61 offen offset:2048 sc1
    v_mfma_f32_16x16x32_bf16 v[116:119], a[244:247], a[180:183], v[116:119]
    ds_read_b64_tr_b16 a[200:201], v46 offset:0
    ds_read_b64_tr_b16 a[202:203], v46 offset:4096
    v_mfma_f32_16x16x32_bf16 v[120:123], a[248:251], a[180:183], v[120:123]
    v_mfma_f32_16x16x32_bf16 v[124:127], a[252:255], a[180:183], v[124:127]
    s_waitcnt vmcnt(27)
    ds_read_b64_tr_b16 a[204:205], v47 offset:0
    ds_read_b64_tr_b16 a[206:207], v47 offset:4096
    v_mfma_f32_16x16x32_bf16 v[156:159], a[252:255], a[184:187], v[156:159]
    v_mfma_f32_16x16x32_bf16 v[152:155], a[248:251], a[184:187], v[152:155]
    ds_read_b64_tr_b16 a[208:209], v48 offset:0
    ds_read_b64_tr_b16 a[210:211], v48 offset:4096
    v_mfma_f32_16x16x32_bf16 v[148:151], a[244:247], a[184:187], v[148:151]
    v_mfma_f32_16x16x32_bf16 v[144:147], a[240:243], a[184:187], v[144:147]
    ds_read_b64_tr_b16 a[212:213], v49 offset:0
    ds_read_b64_tr_b16 a[214:215], v49 offset:4096
    v_mfma_f32_16x16x32_bf16 v[140:143], a[236:239], a[184:187], v[140:143]
    v_mfma_f32_16x16x32_bf16 v[136:139], a[232:235], a[184:187], v[136:139]
    ds_read_b64_tr_b16 a[216:217], v50 offset:0
    ds_read_b64_tr_b16 a[218:219], v50 offset:4096
    v_mfma_f32_16x16x32_bf16 v[132:135], a[228:231], a[184:187], v[132:135]
    v_mfma_f32_16x16x32_bf16 v[128:131], a[224:227], a[184:187], v[128:131]
    s_waitcnt vmcnt(26)
    ds_read_b64_tr_b16 a[220:221], v51 offset:0
    ds_read_b64_tr_b16 a[222:223], v51 offset:4096
    v_mfma_f32_16x16x32_bf16 v[160:163], a[224:227], a[188:191], v[160:163]
    v_mfma_f32_16x16x32_bf16 v[164:167], a[228:231], a[188:191], v[164:167]
    v_mfma_f32_16x16x32_bf16 v[168:171], a[232:235], a[188:191], v[168:171]
    v_mfma_f32_16x16x32_bf16 v[172:175], a[236:239], a[188:191], v[172:175]
    v_mfma_f32_16x16x32_bf16 v[176:179], a[240:243], a[188:191], v[176:179]
    v_mfma_f32_16x16x32_bf16 v[180:183], a[244:247], a[188:191], v[180:183]
    v_mfma_f32_16x16x32_bf16 v[184:187], a[248:251], a[188:191], v[184:187]
    v_mfma_f32_16x16x32_bf16 v[188:191], a[252:255], a[188:191], v[188:191]
    s_waitcnt vmcnt(25)
    v_mfma_f32_16x16x32_bf16 v[92:95], a[252:255], a[176:179], v[92:95]
    v_mfma_f32_16x16x32_bf16 v[88:91], a[248:251], a[176:179], v[88:91]
    v_mfma_f32_16x16x32_bf16 v[84:87], a[244:247], a[176:179], v[84:87]
    v_mfma_f32_16x16x32_bf16 v[80:83], a[240:243], a[176:179], v[80:83]
    v_mfma_f32_16x16x32_bf16 v[76:79], a[236:239], a[176:179], v[76:79]
    v_mfma_f32_16x16x32_bf16 v[72:75], a[232:235], a[176:179], v[72:75]
    v_mfma_f32_16x16x32_bf16 v[68:71], a[228:231], a[176:179], v[68:71]
    v_mfma_f32_16x16x32_bf16 v[64:67], a[224:227], a[176:179], v[64:67]
    s_waitcnt lgkmcnt(0) vmcnt(24)
    v_mfma_f32_16x16x32_bf16 v[96:99], a[192:195], v[196:199], v[96:99]
    buffer_load_dwordx4 a[180:183], v37, s[20:23], s61 offen offset:3072 sc1
    v_mfma_f32_16x16x32_bf16 v[100:103], a[196:199], v[196:199], v[100:103]
    ds_read_b64_tr_b16 a[224:225], v44 offset:8192
    ds_read_b64_tr_b16 a[226:227], v44 offset:12288
    v_mfma_f32_16x16x32_bf16 v[104:107], a[200:203], v[196:199], v[104:107]
    buffer_load_dwordx4 a[184:187], v38, s[20:23], s61 offen offset:3072 sc1
    v_mfma_f32_16x16x32_bf16 v[108:111], a[204:207], v[196:199], v[108:111]
    ds_read_b64_tr_b16 a[228:229], v45 offset:8192
    ds_read_b64_tr_b16 a[230:231], v45 offset:12288
    v_mfma_f32_16x16x32_bf16 v[112:115], a[208:211], v[196:199], v[112:115]
    buffer_load_dwordx4 a[188:191], v39, s[20:23], s61 offen offset:3072 sc1
    v_mfma_f32_16x16x32_bf16 v[116:119], a[212:215], v[196:199], v[116:119]
    ds_read_b64_tr_b16 a[232:233], v46 offset:8192
    ds_read_b64_tr_b16 a[234:235], v46 offset:12288
    v_mfma_f32_16x16x32_bf16 v[120:123], a[216:219], v[196:199], v[120:123]
    v_mfma_f32_16x16x32_bf16 v[124:127], a[220:223], v[196:199], v[124:127]
    s_waitcnt vmcnt(26)
    ds_read_b64_tr_b16 a[236:237], v47 offset:8192
    ds_read_b64_tr_b16 a[238:239], v47 offset:12288
    v_mfma_f32_16x16x32_bf16 v[156:159], a[220:223], v[200:203], v[156:159]
    v_mfma_f32_16x16x32_bf16 v[152:155], a[216:219], v[200:203], v[152:155]
    ds_read_b64_tr_b16 a[240:241], v48 offset:8192
    ds_read_b64_tr_b16 a[242:243], v48 offset:12288
    v_mfma_f32_16x16x32_bf16 v[148:151], a[212:215], v[200:203], v[148:151]
    v_mfma_f32_16x16x32_bf16 v[144:147], a[208:211], v[200:203], v[144:147]
    ds_read_b64_tr_b16 a[244:245], v49 offset:8192
    ds_read_b64_tr_b16 a[246:247], v49 offset:12288
    v_mfma_f32_16x16x32_bf16 v[140:143], a[204:207], v[200:203], v[140:143]
    v_mfma_f32_16x16x32_bf16 v[136:139], a[200:203], v[200:203], v[136:139]
    ds_read_b64_tr_b16 a[248:249], v50 offset:8192
    ds_read_b64_tr_b16 a[250:251], v50 offset:12288
    v_mfma_f32_16x16x32_bf16 v[132:135], a[196:199], v[200:203], v[132:135]
    v_mfma_f32_16x16x32_bf16 v[128:131], a[192:195], v[200:203], v[128:131]
    s_waitcnt vmcnt(25)
    ds_read_b64_tr_b16 a[252:253], v51 offset:8192
    ds_read_b64_tr_b16 a[254:255], v51 offset:12288
    v_mfma_f32_16x16x32_bf16 v[160:163], a[192:195], v[204:207], v[160:163]
    v_mfma_f32_16x16x32_bf16 v[164:167], a[196:199], v[204:207], v[164:167]
    v_mfma_f32_16x16x32_bf16 v[168:171], a[200:203], v[204:207], v[168:171]
    v_mfma_f32_16x16x32_bf16 v[172:175], a[204:207], v[204:207], v[172:175]
    v_mfma_f32_16x16x32_bf16 v[176:179], a[208:211], v[204:207], v[176:179]
    v_mfma_f32_16x16x32_bf16 v[180:183], a[212:215], v[204:207], v[180:183]
    v_mfma_f32_16x16x32_bf16 v[184:187], a[216:219], v[204:207], v[184:187]
    v_mfma_f32_16x16x32_bf16 v[188:191], a[220:223], v[204:207], v[188:191]
    s_waitcnt vmcnt(24)
    v_mfma_f32_16x16x32_bf16 v[92:95], a[220:223], v[192:195], v[92:95]
    v_mfma_f32_16x16x32_bf16 v[88:91], a[216:219], v[192:195], v[88:91]
    v_mfma_f32_16x16x32_bf16 v[84:87], a[212:215], v[192:195], v[84:87]
    v_mfma_f32_16x16x32_bf16 v[80:83], a[208:211], v[192:195], v[80:83]
    v_mfma_f32_16x16x32_bf16 v[76:79], a[204:207], v[192:195], v[76:79]
    v_mfma_f32_16x16x32_bf16 v[72:75], a[200:203], v[192:195], v[72:75]
    v_mfma_f32_16x16x32_bf16 v[68:71], a[196:199], v[192:195], v[68:71]
    v_mfma_f32_16x16x32_bf16 v[64:67], a[192:195], v[192:195], v[64:67]
    s_waitcnt lgkmcnt(0) vmcnt(23)
    v_mfma_f32_16x16x32_bf16 v[96:99], a[224:227], v[212:215], v[96:99]
    s_bfe_u32 s61, s40, 0x40010
    v_mfma_f32_16x16x32_bf16 v[100:103], a[228:231], v[212:215], v[100:103]
    s_lshl_b32 s61, s61, 12
    ds_read_b64_tr_b16 a[192:193], v44 offset:16384
    ds_read_b64_tr_b16 a[194:195], v44 offset:20480
    v_mfma_f32_16x16x32_bf16 v[104:107], a[232:235], v[212:215], v[104:107]
    buffer_load_dwordx4 v[196:199], v37, s[20:23], s61 offen offset:0 sc1
    v_mfma_f32_16x16x32_bf16 v[108:111], a[236:239], v[212:215], v[108:111]
    ds_read_b64_tr_b16 a[196:197], v45 offset:16384
    ds_read_b64_tr_b16 a[198:199], v45 offset:20480
    v_mfma_f32_16x16x32_bf16 v[112:115], a[240:243], v[212:215], v[112:115]
    buffer_load_dwordx4 v[200:203], v38, s[20:23], s61 offen offset:0 sc1
    v_mfma_f32_16x16x32_bf16 v[116:119], a[244:247], v[212:215], v[116:119]
    ds_read_b64_tr_b16 a[200:201], v46 offset:16384
    ds_read_b64_tr_b16 a[202:203], v46 offset:20480
    v_mfma_f32_16x16x32_bf16 v[120:123], a[248:251], v[212:215], v[120:123]
    buffer_load_dwordx4 v[204:207], v39, s[20:23], s61 offen offset:0 sc1
    v_mfma_f32_16x16x32_bf16 v[124:127], a[252:255], v[212:215], v[124:127]
    s_waitcnt vmcnt(25)
    ds_read_b64_tr_b16 a[204:205], v47 offset:16384
    ds_read_b64_tr_b16 a[206:207], v47 offset:20480
    v_mfma_f32_16x16x32_bf16 v[156:159], a[252:255], v[216:219], v[156:159]
    v_mfma_f32_16x16x32_bf16 v[152:155], a[248:251], v[216:219], v[152:155]
    ds_read_b64_tr_b16 a[208:209], v48 offset:16384
    ds_read_b64_tr_b16 a[210:211], v48 offset:20480
    v_mfma_f32_16x16x32_bf16 v[148:151], a[244:247], v[216:219], v[148:151]
    v_mfma_f32_16x16x32_bf16 v[144:147], a[240:243], v[216:219], v[144:147]
    ds_read_b64_tr_b16 a[212:213], v49 offset:16384
    ds_read_b64_tr_b16 a[214:215], v49 offset:20480
    v_mfma_f32_16x16x32_bf16 v[140:143], a[236:239], v[216:219], v[140:143]
    v_mfma_f32_16x16x32_bf16 v[136:139], a[232:235], v[216:219], v[136:139]
    ds_read_b64_tr_b16 a[216:217], v50 offset:16384
    ds_read_b64_tr_b16 a[218:219], v50 offset:20480
    v_mfma_f32_16x16x32_bf16 v[132:135], a[228:231], v[216:219], v[132:135]
    v_mfma_f32_16x16x32_bf16 v[128:131], a[224:227], v[216:219], v[128:131]
    s_waitcnt vmcnt(24)
    ds_read_b64_tr_b16 a[220:221], v51 offset:16384
    ds_read_b64_tr_b16 a[222:223], v51 offset:20480
    v_mfma_f32_16x16x32_bf16 v[160:163], a[224:227], v[220:223], v[160:163]
    v_mfma_f32_16x16x32_bf16 v[164:167], a[228:231], v[220:223], v[164:167]
    v_mfma_f32_16x16x32_bf16 v[168:171], a[232:235], v[220:223], v[168:171]
    v_mfma_f32_16x16x32_bf16 v[172:175], a[236:239], v[220:223], v[172:175]
    v_mfma_f32_16x16x32_bf16 v[176:179], a[240:243], v[220:223], v[176:179]
    v_mfma_f32_16x16x32_bf16 v[180:183], a[244:247], v[220:223], v[180:183]
    v_mfma_f32_16x16x32_bf16 v[184:187], a[248:251], v[220:223], v[184:187]
    v_mfma_f32_16x16x32_bf16 v[188:191], a[252:255], v[220:223], v[188:191]
    s_waitcnt vmcnt(23)
    v_mfma_f32_16x16x32_bf16 v[92:95], a[252:255], v[208:211], v[92:95]
    v_mfma_f32_16x16x32_bf16 v[88:91], a[248:251], v[208:211], v[88:91]
    v_mfma_f32_16x16x32_bf16 v[84:87], a[244:247], v[208:211], v[84:87]
    v_mfma_f32_16x16x32_bf16 v[80:83], a[240:243], v[208:211], v[80:83]
    v_mfma_f32_16x16x32_bf16 v[76:79], a[236:239], v[208:211], v[76:79]
    v_mfma_f32_16x16x32_bf16 v[72:75], a[232:235], v[208:211], v[72:75]
    v_mfma_f32_16x16x32_bf16 v[68:71], a[228:231], v[208:211], v[68:71]
    v_mfma_f32_16x16x32_bf16 v[64:67], a[224:227], v[208:211], v[64:67]
    s_waitcnt lgkmcnt(0) vmcnt(22)
    v_mfma_f32_16x16x32_bf16 v[96:99], a[192:195], v[228:231], v[96:99]
    buffer_load_dwordx4 v[212:215], v37, s[20:23], s61 offen offset:1024 sc1
    v_mfma_f32_16x16x32_bf16 v[100:103], a[196:199], v[228:231], v[100:103]
    ds_read_b64_tr_b16 a[224:225], v44 offset:24576
    ds_read_b64_tr_b16 a[226:227], v44 offset:28672
    v_mfma_f32_16x16x32_bf16 v[104:107], a[200:203], v[228:231], v[104:107]
    buffer_load_dwordx4 v[216:219], v38, s[20:23], s61 offen offset:1024 sc1
    v_mfma_f32_16x16x32_bf16 v[108:111], a[204:207], v[228:231], v[108:111]
    ds_read_b64_tr_b16 a[228:229], v45 offset:24576
    ds_read_b64_tr_b16 a[230:231], v45 offset:28672
    v_mfma_f32_16x16x32_bf16 v[112:115], a[208:211], v[228:231], v[112:115]
    buffer_load_dwordx4 v[220:223], v39, s[20:23], s61 offen offset:1024 sc1
    v_mfma_f32_16x16x32_bf16 v[116:119], a[212:215], v[228:231], v[116:119]
    ds_read_b64_tr_b16 a[232:233], v46 offset:24576
    ds_read_b64_tr_b16 a[234:235], v46 offset:28672
    v_mfma_f32_16x16x32_bf16 v[120:123], a[216:219], v[228:231], v[120:123]
    v_mfma_f32_16x16x32_bf16 v[124:127], a[220:223], v[228:231], v[124:127]
    s_waitcnt vmcnt(24)
    ds_read_b64_tr_b16 a[236:237], v47 offset:24576
    ds_read_b64_tr_b16 a[238:239], v47 offset:28672
    v_mfma_f32_16x16x32_bf16 v[156:159], a[220:223], v[232:235], v[156:159]
    v_mfma_f32_16x16x32_bf16 v[152:155], a[216:219], v[232:235], v[152:155]
    ds_read_b64_tr_b16 a[240:241], v48 offset:24576
    ds_read_b64_tr_b16 a[242:243], v48 offset:28672
    v_mfma_f32_16x16x32_bf16 v[148:151], a[212:215], v[232:235], v[148:151]
    v_mfma_f32_16x16x32_bf16 v[144:147], a[208:211], v[232:235], v[144:147]
    ds_read_b64_tr_b16 a[244:245], v49 offset:24576
    ds_read_b64_tr_b16 a[246:247], v49 offset:28672
    v_mfma_f32_16x16x32_bf16 v[140:143], a[204:207], v[232:235], v[140:143]
    v_mfma_f32_16x16x32_bf16 v[136:139], a[200:203], v[232:235], v[136:139]
    ds_read_b64_tr_b16 a[248:249], v50 offset:24576
    ds_read_b64_tr_b16 a[250:251], v50 offset:28672
    v_mfma_f32_16x16x32_bf16 v[132:135], a[196:199], v[232:235], v[132:135]
    v_mfma_f32_16x16x32_bf16 v[128:131], a[192:195], v[232:235], v[128:131]
    s_waitcnt vmcnt(23)
    ds_read_b64_tr_b16 a[252:253], v51 offset:24576
    ds_read_b64_tr_b16 a[254:255], v51 offset:28672
    v_mfma_f32_16x16x32_bf16 v[160:163], a[192:195], v[236:239], v[160:163]
    v_mfma_f32_16x16x32_bf16 v[164:167], a[196:199], v[236:239], v[164:167]
    v_mfma_f32_16x16x32_bf16 v[168:171], a[200:203], v[236:239], v[168:171]
    v_mfma_f32_16x16x32_bf16 v[172:175], a[204:207], v[236:239], v[172:175]
    v_mfma_f32_16x16x32_bf16 v[176:179], a[208:211], v[236:239], v[176:179]
    v_mfma_f32_16x16x32_bf16 v[180:183], a[212:215], v[236:239], v[180:183]
    v_mfma_f32_16x16x32_bf16 v[184:187], a[216:219], v[236:239], v[184:187]
    v_mfma_f32_16x16x32_bf16 v[188:191], a[220:223], v[236:239], v[188:191]
    s_waitcnt vmcnt(22)
    v_mfma_f32_16x16x32_bf16 v[92:95], a[220:223], v[224:227], v[92:95]
    v_mfma_f32_16x16x32_bf16 v[88:91], a[216:219], v[224:227], v[88:91]
    v_mfma_f32_16x16x32_bf16 v[84:87], a[212:215], v[224:227], v[84:87]
    v_mfma_f32_16x16x32_bf16 v[80:83], a[208:211], v[224:227], v[80:83]
    v_mfma_f32_16x16x32_bf16 v[76:79], a[204:207], v[224:227], v[76:79]
    v_mfma_f32_16x16x32_bf16 v[72:75], a[200:203], v[224:227], v[72:75]
    v_mfma_f32_16x16x32_bf16 v[68:71], a[196:199], v[224:227], v[68:71]
    v_mfma_f32_16x16x32_bf16 v[64:67], a[192:195], v[224:227], v[64:67]
    s_waitcnt lgkmcnt(0) vmcnt(21)
    v_mfma_f32_16x16x32_bf16 v[96:99], a[224:227], v[244:247], v[96:99]
    s_waitcnt vmcnt(51) lgkmcnt(0)
    buffer_load_dwordx4 v[228:231], v37, s[20:23], s61 offen offset:2048 sc1
    v_mfma_f32_16x16x32_bf16 v[100:103], a[228:231], v[244:247], v[100:103]
    s_barrier
    v_mfma_f32_16x16x32_bf16 v[104:107], a[232:235], v[244:247], v[104:107]
    s_add_u32 m0, s84, 32768
    ds_read_b64_tr_b16 a[192:193], v44 offset:32768
    ds_read_b64_tr_b16 a[194:195], v44 offset:36864
    v_mfma_f32_16x16x32_bf16 v[108:111], a[236:239], v[244:247], v[108:111]
    buffer_load_dwordx4 v[232:235], v38, s[20:23], s61 offen offset:2048 sc1
    v_mfma_f32_16x16x32_bf16 v[112:115], a[240:243], v[244:247], v[112:115]
    ds_read_b64_tr_b16 a[196:197], v45 offset:32768
    ds_read_b64_tr_b16 a[198:199], v45 offset:36864
    v_mfma_f32_16x16x32_bf16 v[116:119], a[244:247], v[244:247], v[116:119]
    buffer_load_dwordx4 v[236:239], v39, s[20:23], s61 offen offset:2048 sc1
    v_mfma_f32_16x16x32_bf16 v[120:123], a[248:251], v[244:247], v[120:123]
    ds_read_b64_tr_b16 a[200:201], v46 offset:32768
    ds_read_b64_tr_b16 a[202:203], v46 offset:36864
    v_mfma_f32_16x16x32_bf16 v[124:127], a[252:255], v[244:247], v[124:127]
    s_waitcnt vmcnt(23)
    buffer_load_dwordx4 v28, s[8:11], s50 offen offset:0 lds
    v_mfma_f32_16x16x32_bf16 v[156:159], a[252:255], v[248:251], v[156:159]
    ds_read_b64_tr_b16 a[204:205], v47 offset:32768
    ds_read_b64_tr_b16 a[206:207], v47 offset:36864
    v_mfma_f32_16x16x32_bf16 v[152:155], a[248:251], v[248:251], v[152:155]
    v_mfma_f32_16x16x32_bf16 v[148:151], a[244:247], v[248:251], v[148:151]
    ds_read_b64_tr_b16 a[208:209], v48 offset:32768
    ds_read_b64_tr_b16 a[210:211], v48 offset:36864
    v_mfma_f32_16x16x32_bf16 v[144:147], a[240:243], v[248:251], v[144:147]
    v_mfma_f32_16x16x32_bf16 v[140:143], a[236:239], v[248:251], v[140:143]
    ds_read_b64_tr_b16 a[212:213], v49 offset:32768
    ds_read_b64_tr_b16 a[214:215], v49 offset:36864
    v_mfma_f32_16x16x32_bf16 v[136:139], a[232:235], v[248:251], v[136:139]
    v_mfma_f32_16x16x32_bf16 v[132:135], a[228:231], v[248:251], v[132:135]
    ds_read_b64_tr_b16 a[216:217], v50 offset:32768
    ds_read_b64_tr_b16 a[218:219], v50 offset:36864
    v_mfma_f32_16x16x32_bf16 v[128:131], a[224:227], v[248:251], v[128:131]
    s_waitcnt vmcnt(23)
    buffer_load_dwordx4 v29, s[8:11], s50 offen offset:1024 lds
    v_mfma_f32_16x16x32_bf16 v[160:163], a[224:227], v[252:255], v[160:163]
    ds_read_b64_tr_b16 a[220:221], v51 offset:32768
    ds_read_b64_tr_b16 a[222:223], v51 offset:36864
    v_mfma_f32_16x16x32_bf16 v[164:167], a[228:231], v[252:255], v[164:167]
    v_mfma_f32_16x16x32_bf16 v[168:171], a[232:235], v[252:255], v[168:171]
    v_mfma_f32_16x16x32_bf16 v[172:175], a[236:239], v[252:255], v[172:175]
    v_mfma_f32_16x16x32_bf16 v[176:179], a[240:243], v[252:255], v[176:179]
    v_mfma_f32_16x16x32_bf16 v[180:183], a[244:247], v[252:255], v[180:183]
    v_mfma_f32_16x16x32_bf16 v[184:187], a[248:251], v[252:255], v[184:187]
    v_mfma_f32_16x16x32_bf16 v[188:191], a[252:255], v[252:255], v[188:191]
    s_waitcnt vmcnt(23)
    buffer_load_dwordx4 v30, s[8:11], s50 offen offset:2048 lds
    v_mfma_f32_16x16x32_bf16 v[92:95], a[252:255], v[240:243], v[92:95]
    v_mfma_f32_16x16x32_bf16 v[88:91], a[248:251], v[240:243], v[88:91]
    v_mfma_f32_16x16x32_bf16 v[84:87], a[244:247], v[240:243], v[84:87]
    v_mfma_f32_16x16x32_bf16 v[80:83], a[240:243], v[240:243], v[80:83]
    v_mfma_f32_16x16x32_bf16 v[76:79], a[236:239], v[240:243], v[76:79]
    v_mfma_f32_16x16x32_bf16 v[72:75], a[232:235], v[240:243], v[72:75]
    v_mfma_f32_16x16x32_bf16 v[68:71], a[228:231], v[240:243], v[68:71]
    v_mfma_f32_16x16x32_bf16 v[64:67], a[224:227], v[240:243], v[64:67]
    s_waitcnt lgkmcnt(0) vmcnt(23)
    buffer_load_dwordx4 v31, s[8:11], s50 offen offset:3072 lds
    v_mfma_f32_16x16x32_bf16 v[96:99], a[192:195], a[132:135], v[96:99]
    s_add_u32 m0, s84, 36864
    buffer_load_dwordx4 v[244:247], v37, s[20:23], s61 offen offset:3072 sc1
    v_mfma_f32_16x16x32_bf16 v[100:103], a[196:199], a[132:135], v[100:103]
    s_add_u32 s50, s50, 20480
    ds_read_b64_tr_b16 a[224:225], v44 offset:40960
    ds_read_b64_tr_b16 a[226:227], v44 offset:45056
    v_mfma_f32_16x16x32_bf16 v[104:107], a[200:203], a[132:135], v[104:107]
    buffer_load_dwordx4 v[248:251], v38, s[20:23], s61 offen offset:3072 sc1
    v_mfma_f32_16x16x32_bf16 v[108:111], a[204:207], a[132:135], v[108:111]
    ds_read_b64_tr_b16 a[228:229], v45 offset:40960
    ds_read_b64_tr_b16 a[230:231], v45 offset:45056
    v_mfma_f32_16x16x32_bf16 v[112:115], a[208:211], a[132:135], v[112:115]
    buffer_load_dwordx4 v[252:255], v39, s[20:23], s61 offen offset:3072 sc1
    v_mfma_f32_16x16x32_bf16 v[116:119], a[212:215], a[132:135], v[116:119]
    ds_read_b64_tr_b16 a[232:233], v46 offset:40960
    ds_read_b64_tr_b16 a[234:235], v46 offset:45056
    v_mfma_f32_16x16x32_bf16 v[120:123], a[216:219], a[132:135], v[120:123]
    v_mfma_f32_16x16x32_bf16 v[124:127], a[220:223], a[132:135], v[124:127]
    s_waitcnt vmcnt(26)
    ds_read_b64_tr_b16 a[236:237], v47 offset:40960
    ds_read_b64_tr_b16 a[238:239], v47 offset:45056
    v_mfma_f32_16x16x32_bf16 v[156:159], a[220:223], a[136:139], v[156:159]
    buffer_load_dwordx4 v28, s[8:11], s50 offen offset:0 lds
    v_mfma_f32_16x16x32_bf16 v[152:155], a[216:219], a[136:139], v[152:155]
    ds_read_b64_tr_b16 a[240:241], v48 offset:40960
    ds_read_b64_tr_b16 a[242:243], v48 offset:45056
    v_mfma_f32_16x16x32_bf16 v[148:151], a[212:215], a[136:139], v[148:151]
    v_mfma_f32_16x16x32_bf16 v[144:147], a[208:211], a[136:139], v[144:147]
    ds_read_b64_tr_b16 a[244:245], v49 offset:40960
    ds_read_b64_tr_b16 a[246:247], v49 offset:45056
    v_mfma_f32_16x16x32_bf16 v[140:143], a[204:207], a[136:139], v[140:143]
    v_mfma_f32_16x16x32_bf16 v[136:139], a[200:203], a[136:139], v[136:139]
    ds_read_b64_tr_b16 a[248:249], v50 offset:40960
    ds_read_b64_tr_b16 a[250:251], v50 offset:45056
    v_mfma_f32_16x16x32_bf16 v[132:135], a[196:199], a[136:139], v[132:135]
    v_mfma_f32_16x16x32_bf16 v[128:131], a[192:195], a[136:139], v[128:131]
    s_waitcnt vmcnt(26)
    ds_read_b64_tr_b16 a[252:253], v51 offset:40960
    ds_read_b64_tr_b16 a[254:255], v51 offset:45056
    v_mfma_f32_16x16x32_bf16 v[160:163], a[192:195], a[140:143], v[160:163]
    buffer_load_dwordx4 v29, s[8:11], s50 offen offset:1024 lds
    v_mfma_f32_16x16x32_bf16 v[164:167], a[196:199], a[140:143], v[164:167]
    v_mfma_f32_16x16x32_bf16 v[168:171], a[200:203], a[140:143], v[168:171]
    v_mfma_f32_16x16x32_bf16 v[172:175], a[204:207], a[140:143], v[172:175]
    v_mfma_f32_16x16x32_bf16 v[176:179], a[208:211], a[140:143], v[176:179]
    v_mfma_f32_16x16x32_bf16 v[180:183], a[212:215], a[140:143], v[180:183]
    v_mfma_f32_16x16x32_bf16 v[184:187], a[216:219], a[140:143], v[184:187]
    v_mfma_f32_16x16x32_bf16 v[188:191], a[220:223], a[140:143], v[188:191]
    s_waitcnt lgkmcnt(0) vmcnt(26)
    v_mfma_f32_16x16x32_bf16 v[96:99], a[224:227], a[148:151], v[96:99]
    s_bfe_u32 s61, s40, 0x40014
    buffer_load_dwordx4 v30, s[8:11], s50 offen offset:2048 lds
    v_mfma_f32_16x16x32_bf16 v[100:103], a[228:231], a[148:151], v[100:103]
    s_lshl_b32 s61, s61, 12
    ds_read_b64_tr_b16 a[192:193], v44 offset:49152
    ds_read_b64_tr_b16 a[194:195], v44 offset:53248
    v_mfma_f32_16x16x32_bf16 v[104:107], a[232:235], a[148:151], v[104:107]
    buffer_load_dwordx4 a[132:135], v37, s[20:23], s61 offen offset:0 sc1
    v_mfma_f32_16x16x32_bf16 v[108:111], a[236:239], a[148:151], v[108:111]
    ds_read_b64_tr_b16 a[196:197], v45 offset:49152
    ds_read_b64_tr_b16 a[198:199], v45 offset:53248
    v_mfma_f32_16x16x32_bf16 v[112:115], a[240:243], a[148:151], v[112:115]
    buffer_load_dwordx4 a[136:139], v38, s[20:23], s61 offen offset:0 sc1
    v_mfma_f32_16x16x32_bf16 v[116:119], a[244:247], a[148:151], v[116:119]
    ds_read_b64_tr_b16 a[200:201], v46 offset:49152
    ds_read_b64_tr_b16 a[202:203], v46 offset:53248
    v_mfma_f32_16x16x32_bf16 v[120:123], a[248:251], a[148:151], v[120:123]
    buffer_load_dwordx4 a[140:143], v39, s[20:23], s61 offen offset:0 sc1
    v_mfma_f32_16x16x32_bf16 v[124:127], a[252:255], a[148:151], v[124:127]
    s_waitcnt vmcnt(29)
    ds_read_b64_tr_b16 a[204:205], v47 offset:49152
    ds_read_b64_tr_b16 a[206:207], v47 offset:53248
    v_mfma_f32_16x16x32_bf16 v[156:159], a[252:255], a[152:155], v[156:159]
    buffer_load_dwordx4 v31, s[8:11], s50 offen offset:3072 lds
    v_mfma_f32_16x16x32_bf16 v[152:155], a[248:251], a[152:155], v[152:155]
    s_add_u32 m0, s85, 0
    ds_read_b64_tr_b16 a[208:209], v48 offset:49152
    ds_read_b64_tr_b16 a[210:211], v48 offset:53248
    v_mfma_f32_16x16x32_bf16 v[148:151], a[244:247], a[152:155], v[148:151]
    v_mfma_f32_16x16x32_bf16 v[144:147], a[240:243], a[152:155], v[144:147]
    ds_read_b64_tr_b16 a[212:213], v49 offset:49152
    ds_read_b64_tr_b16 a[214:215], v49 offset:53248
    v_mfma_f32_16x16x32_bf16 v[140:143], a[236:239], a[152:155], v[140:143]
    v_mfma_f32_16x16x32_bf16 v[136:139], a[232:235], a[152:155], v[136:139]
    ds_read_b64_tr_b16 a[216:217], v50 offset:49152
    ds_read_b64_tr_b16 a[218:219], v50 offset:53248
    v_mfma_f32_16x16x32_bf16 v[132:135], a[228:231], a[152:155], v[132:135]
    v_mfma_f32_16x16x32_bf16 v[128:131], a[224:227], a[152:155], v[128:131]
    s_waitcnt vmcnt(29)
    ds_read_b64_tr_b16 a[220:221], v51 offset:49152
    ds_read_b64_tr_b16 a[222:223], v51 offset:53248
    v_mfma_f32_16x16x32_bf16 v[160:163], a[224:227], a[156:159], v[160:163]
    buffer_load_dwordx4 v28, s[8:11], s51 offen offset:0 lds
    v_mfma_f32_16x16x32_bf16 v[164:167], a[228:231], a[156:159], v[164:167]
    v_mfma_f32_16x16x32_bf16 v[168:171], a[232:235], a[156:159], v[168:171]
    v_mfma_f32_16x16x32_bf16 v[172:175], a[236:239], a[156:159], v[172:175]
    v_mfma_f32_16x16x32_bf16 v[176:179], a[240:243], a[156:159], v[176:179]
    v_mfma_f32_16x16x32_bf16 v[180:183], a[244:247], a[156:159], v[180:183]
    v_mfma_f32_16x16x32_bf16 v[184:187], a[248:251], a[156:159], v[184:187]
    v_mfma_f32_16x16x32_bf16 v[188:191], a[252:255], a[156:159], v[188:191]
    s_waitcnt lgkmcnt(0) vmcnt(29)
    v_mfma_f32_16x16x32_bf16 v[96:99], a[192:195], a[164:167], v[96:99]
    buffer_load_dwordx4 a[148:151], v37, s[20:23], s61 offen offset:1024 sc1
    v_mfma_f32_16x16x32_bf16 v[100:103], a[196:199], a[164:167], v[100:103]
    ds_read_b64_tr_b16 a[224:225], v44 offset:57344
    ds_read_b64_tr_b16 a[226:227], v44 offset:61440
    v_mfma_f32_16x16x32_bf16 v[104:107], a[200:203], a[164:167], v[104:107]
    buffer_load_dwordx4 a[152:155], v38, s[20:23], s61 offen offset:1024 sc1
    v_mfma_f32_16x16x32_bf16 v[108:111], a[204:207], a[164:167], v[108:111]
    ds_read_b64_tr_b16 a[228:229], v45 offset:57344
    ds_read_b64_tr_b16 a[230:231], v45 offset:61440
    v_mfma_f32_16x16x32_bf16 v[112:115], a[208:211], a[164:167], v[112:115]
    buffer_load_dwordx4 a[156:159], v39, s[20:23], s61 offen offset:1024 sc1
    v_mfma_f32_16x16x32_bf16 v[116:119], a[212:215], a[164:167], v[116:119]
    ds_read_b64_tr_b16 a[232:233], v46 offset:57344
    ds_read_b64_tr_b16 a[234:235], v46 offset:61440
    v_mfma_f32_16x16x32_bf16 v[120:123], a[216:219], a[164:167], v[120:123]
    buffer_load_dwordx4 v29, s[8:11], s51 offen offset:1024 lds
    v_mfma_f32_16x16x32_bf16 v[124:127], a[220:223], a[164:167], v[124:127]
    s_waitcnt vmcnt(32)
    ds_read_b64_tr_b16 a[236:237], v47 offset:57344
    ds_read_b64_tr_b16 a[238:239], v47 offset:61440
    v_mfma_f32_16x16x32_bf16 v[156:159], a[220:223], a[168:171], v[156:159]
    v_mfma_f32_16x16x32_bf16 v[152:155], a[216:219], a[168:171], v[152:155]
    ds_read_b64_tr_b16 a[240:241], v48 offset:57344
    ds_read_b64_tr_b16 a[242:243], v48 offset:61440
    v_mfma_f32_16x16x32_bf16 v[148:151], a[212:215], a[168:171], v[148:151]
    v_mfma_f32_16x16x32_bf16 v[144:147], a[208:211], a[168:171], v[144:147]
    ds_read_b64_tr_b16 a[244:245], v49 offset:57344
    ds_read_b64_tr_b16 a[246:247], v49 offset:61440
    v_mfma_f32_16x16x32_bf16 v[140:143], a[204:207], a[168:171], v[140:143]
    v_mfma_f32_16x16x32_bf16 v[136:139], a[200:203], a[168:171], v[136:139]
    ds_read_b64_tr_b16 a[248:249], v50 offset:57344
    ds_read_b64_tr_b16 a[250:251], v50 offset:61440
    v_mfma_f32_16x16x32_bf16 v[132:135], a[196:199], a[168:171], v[132:135]
    buffer_load_dwordx4 v30, s[8:11], s51 offen offset:2048 lds
    v_mfma_f32_16x16x32_bf16 v[128:131], a[192:195], a[168:171], v[128:131]
    s_waitcnt vmcnt(32)
    ds_read_b64_tr_b16 a[252:253], v51 offset:57344
    ds_read_b64_tr_b16 a[254:255], v51 offset:61440
    v_mfma_f32_16x16x32_bf16 v[160:163], a[192:195], a[172:175], v[160:163]
    v_mfma_f32_16x16x32_bf16 v[164:167], a[196:199], a[172:175], v[164:167]
    v_mfma_f32_16x16x32_bf16 v[168:171], a[200:203], a[172:175], v[168:171]
    v_mfma_f32_16x16x32_bf16 v[172:175], a[204:207], a[172:175], v[172:175]
    v_mfma_f32_16x16x32_bf16 v[176:179], a[208:211], a[172:175], v[176:179]
    v_mfma_f32_16x16x32_bf16 v[180:183], a[212:215], a[172:175], v[180:183]
    v_mfma_f32_16x16x32_bf16 v[184:187], a[216:219], a[172:175], v[184:187]
    s_waitcnt lgkmcnt(0) vmcnt(31)
    buffer_load_dwordx4 v31, s[8:11], s51 offen offset:3072 lds
    v_mfma_f32_16x16x32_bf16 v[188:191], a[220:223], a[172:175], v[188:191]
    s_add_u32 m0, s85, 4096
    v_mfma_f32_16x16x32_bf16 v[96:99], a[224:227], a[180:183], v[96:99]
    s_add_u32 s51, s51, 20480
    buffer_load_dwordx4 a[164:167], v37, s[20:23], s61 offen offset:2048 sc1
    v_mfma_f32_16x16x32_bf16 v[100:103], a[228:231], a[180:183], v[100:103]
    ds_read_b64_tr_b16 a[192:193], v16 offset:0
    ds_read_b64_tr_b16 a[194:195], v16 offset:4096
    v_mfma_f32_16x16x32_bf16 v[104:107], a[232:235], a[180:183], v[104:107]
    buffer_load_dwordx4 a[168:171], v38, s[20:23], s61 offen offset:2048 sc1
    v_mfma_f32_16x16x32_bf16 v[108:111], a[236:239], a[180:183], v[108:111]
    ds_read_b64_tr_b16 a[196:197], v17 offset:0
    ds_read_b64_tr_b16 a[198:199], v17 offset:4096
    v_mfma_f32_16x16x32_bf16 v[112:115], a[240:243], a[180:183], v[112:115]
    buffer_load_dwordx4 a[172:175], v39, s[20:23], s61 offen offset:2048 sc1
    v_mfma_f32_16x16x32_bf16 v[116:119], a[244:247], a[180:183], v[116:119]
    ds_read_b64_tr_b16 a[200:201], v18 offset:0
    ds_read_b64_tr_b16 a[202:203], v18 offset:4096
    v_mfma_f32_16x16x32_bf16 v[120:123], a[248:251], a[180:183], v[120:123]
    buffer_load_dwordx4 v28, s[8:11], s51 offen offset:0 lds
    v_mfma_f32_16x16x32_bf16 v[124:127], a[252:255], a[180:183], v[124:127]
    s_waitcnt vmcnt(35)
    ds_read_b64_tr_b16 a[204:205], v19 offset:0
    ds_read_b64_tr_b16 a[206:207], v19 offset:4096
    v_mfma_f32_16x16x32_bf16 v[156:159], a[252:255], a[184:187], v[156:159]
    v_mfma_f32_16x16x32_bf16 v[152:155], a[248:251], a[184:187], v[152:155]
    ds_read_b64_tr_b16 a[208:209], v20 offset:0
    ds_read_b64_tr_b16 a[210:211], v20 offset:4096
    v_mfma_f32_16x16x32_bf16 v[148:151], a[244:247], a[184:187], v[148:151]
    v_mfma_f32_16x16x32_bf16 v[144:147], a[240:243], a[184:187], v[144:147]
    ds_read_b64_tr_b16 a[212:213], v21 offset:0
    ds_read_b64_tr_b16 a[214:215], v21 offset:4096
    v_mfma_f32_16x16x32_bf16 v[140:143], a[236:239], a[184:187], v[140:143]
    v_mfma_f32_16x16x32_bf16 v[136:139], a[232:235], a[184:187], v[136:139]
    ds_read_b64_tr_b16 a[216:217], v22 offset:0
    ds_read_b64_tr_b16 a[218:219], v22 offset:4096
    v_mfma_f32_16x16x32_bf16 v[132:135], a[228:231], a[184:187], v[132:135]
    buffer_load_dwordx4 v29, s[8:11], s51 offen offset:1024 lds
    v_mfma_f32_16x16x32_bf16 v[128:131], a[224:227], a[184:187], v[128:131]
    s_waitcnt vmcnt(35)
    ds_read_b64_tr_b16 a[220:221], v23 offset:0
    ds_read_b64_tr_b16 a[222:223], v23 offset:4096
    v_mfma_f32_16x16x32_bf16 v[160:163], a[224:227], a[188:191], v[160:163]
    v_mfma_f32_16x16x32_bf16 v[164:167], a[228:231], a[188:191], v[164:167]
    v_mfma_f32_16x16x32_bf16 v[168:171], a[232:235], a[188:191], v[168:171]
    v_mfma_f32_16x16x32_bf16 v[172:175], a[236:239], a[188:191], v[172:175]
    v_mfma_f32_16x16x32_bf16 v[176:179], a[240:243], a[188:191], v[176:179]
    v_mfma_f32_16x16x32_bf16 v[180:183], a[244:247], a[188:191], v[180:183]
    v_mfma_f32_16x16x32_bf16 v[184:187], a[248:251], a[188:191], v[184:187]
    buffer_load_dwordx4 v30, s[8:11], s51 offen offset:2048 lds
    v_mfma_f32_16x16x32_bf16 v[188:191], a[252:255], a[188:191], v[188:191]
    s_waitcnt lgkmcnt(0) vmcnt(35)
    v_mfma_f32_16x16x32_bf16 v[96:99], a[192:195], v[196:199], v[96:99]
    buffer_load_dwordx4 a[180:183], v37, s[20:23], s61 offen offset:3072 sc1
    v_mfma_f32_16x16x32_bf16 v[100:103], a[196:199], v[196:199], v[100:103]
    ds_read_b64_tr_b16 a[224:225], v16 offset:8192
    ds_read_b64_tr_b16 a[226:227], v16 offset:12288
    v_mfma_f32_16x16x32_bf16 v[104:107], a[200:203], v[196:199], v[104:107]
    buffer_load_dwordx4 a[184:187], v38, s[20:23], s61 offen offset:3072 sc1
    v_mfma_f32_16x16x32_bf16 v[108:111], a[204:207], v[196:199], v[108:111]
    ds_read_b64_tr_b16 a[228:229], v17 offset:8192
    ds_read_b64_tr_b16 a[230:231], v17 offset:12288
    v_mfma_f32_16x16x32_bf16 v[112:115], a[208:211], v[196:199], v[112:115]
    buffer_load_dwordx4 a[188:191], v39, s[20:23], s61 offen offset:3072 sc1
    v_mfma_f32_16x16x32_bf16 v[116:119], a[212:215], v[196:199], v[116:119]
    ds_read_b64_tr_b16 a[232:233], v18 offset:8192
    ds_read_b64_tr_b16 a[234:235], v18 offset:12288
    v_mfma_f32_16x16x32_bf16 v[120:123], a[216:219], v[196:199], v[120:123]
    buffer_load_dwordx4 v31, s[8:11], s51 offen offset:3072 lds
    v_mfma_f32_16x16x32_bf16 v[124:127], a[220:223], v[196:199], v[124:127]
    s_waitcnt vmcnt(38)
    ds_read_b64_tr_b16 a[236:237], v19 offset:8192
    ds_read_b64_tr_b16 a[238:239], v19 offset:12288
    v_mfma_f32_16x16x32_bf16 v[156:159], a[220:223], v[200:203], v[156:159]
    v_mfma_f32_16x16x32_bf16 v[152:155], a[216:219], v[200:203], v[152:155]
    ds_read_b64_tr_b16 a[240:241], v20 offset:8192
    ds_read_b64_tr_b16 a[242:243], v20 offset:12288
    v_mfma_f32_16x16x32_bf16 v[148:151], a[212:215], v[200:203], v[148:151]
    v_mfma_f32_16x16x32_bf16 v[144:147], a[208:211], v[200:203], v[144:147]
    ds_read_b64_tr_b16 a[244:245], v21 offset:8192
    ds_read_b64_tr_b16 a[246:247], v21 offset:12288
    v_mfma_f32_16x16x32_bf16 v[140:143], a[204:207], v[200:203], v[140:143]
    v_mfma_f32_16x16x32_bf16 v[136:139], a[200:203], v[200:203], v[136:139]
    ds_read_b64_tr_b16 a[248:249], v22 offset:8192
    ds_read_b64_tr_b16 a[250:251], v22 offset:12288
    v_mfma_f32_16x16x32_bf16 v[132:135], a[196:199], v[200:203], v[132:135]
    v_mfma_f32_16x16x32_bf16 v[128:131], a[192:195], v[200:203], v[128:131]
    s_waitcnt vmcnt(37)
    ds_read_b64_tr_b16 a[252:253], v23 offset:8192
    ds_read_b64_tr_b16 a[254:255], v23 offset:12288
    v_mfma_f32_16x16x32_bf16 v[160:163], a[192:195], v[204:207], v[160:163]
    v_mfma_f32_16x16x32_bf16 v[164:167], a[196:199], v[204:207], v[164:167]
    v_mfma_f32_16x16x32_bf16 v[168:171], a[200:203], v[204:207], v[168:171]
    v_mfma_f32_16x16x32_bf16 v[172:175], a[204:207], v[204:207], v[172:175]
    v_mfma_f32_16x16x32_bf16 v[176:179], a[208:211], v[204:207], v[176:179]
    v_mfma_f32_16x16x32_bf16 v[180:183], a[212:215], v[204:207], v[180:183]
    v_mfma_f32_16x16x32_bf16 v[184:187], a[216:219], v[204:207], v[184:187]
    v_mfma_f32_16x16x32_bf16 v[188:191], a[220:223], v[204:207], v[188:191]
    s_waitcnt lgkmcnt(0) vmcnt(36)
    v_mfma_f32_16x16x32_bf16 v[96:99], a[224:227], v[212:215], v[96:99]
    s_bfe_u32 s61, s40, 0x40018
    v_mfma_f32_16x16x32_bf16 v[100:103], a[228:231], v[212:215], v[100:103]
    s_lshl_b32 s61, s61, 12
    ds_read_b64_tr_b16 a[192:193], v16 offset:16384
    ds_read_b64_tr_b16 a[194:195], v16 offset:20480
    v_mfma_f32_16x16x32_bf16 v[104:107], a[232:235], v[212:215], v[104:107]
    buffer_load_dwordx4 v[196:199], v37, s[20:23], s61 offen offset:0 sc1
    v_mfma_f32_16x16x32_bf16 v[108:111], a[236:239], v[212:215], v[108:111]
    ds_read_b64_tr_b16 a[196:197], v17 offset:16384
    ds_read_b64_tr_b16 a[198:199], v17 offset:20480
    v_mfma_f32_16x16x32_bf16 v[112:115], a[240:243], v[212:215], v[112:115]
    buffer_load_dwordx4 v[200:203], v38, s[20:23], s61 offen offset:0 sc1
    v_mfma_f32_16x16x32_bf16 v[116:119], a[244:247], v[212:215], v[116:119]
    ds_read_b64_tr_b16 a[200:201], v18 offset:16384
    ds_read_b64_tr_b16 a[202:203], v18 offset:20480
    v_mfma_f32_16x16x32_bf16 v[120:123], a[248:251], v[212:215], v[120:123]
    buffer_load_dwordx4 v[204:207], v39, s[20:23], s61 offen offset:0 sc1
    v_mfma_f32_16x16x32_bf16 v[124:127], a[252:255], v[212:215], v[124:127]
    s_waitcnt vmcnt(38)
    ds_read_b64_tr_b16 a[204:205], v19 offset:16384
    ds_read_b64_tr_b16 a[206:207], v19 offset:20480
    v_mfma_f32_16x16x32_bf16 v[156:159], a[252:255], v[216:219], v[156:159]
    v_mfma_f32_16x16x32_bf16 v[152:155], a[248:251], v[216:219], v[152:155]
    ds_read_b64_tr_b16 a[208:209], v20 offset:16384
    ds_read_b64_tr_b16 a[210:211], v20 offset:20480
    v_mfma_f32_16x16x32_bf16 v[148:151], a[244:247], v[216:219], v[148:151]
    v_mfma_f32_16x16x32_bf16 v[144:147], a[240:243], v[216:219], v[144:147]
    ds_read_b64_tr_b16 a[212:213], v21 offset:16384
    ds_read_b64_tr_b16 a[214:215], v21 offset:20480
    v_mfma_f32_16x16x32_bf16 v[140:143], a[236:239], v[216:219], v[140:143]
    v_mfma_f32_16x16x32_bf16 v[136:139], a[232:235], v[216:219], v[136:139]
    ds_read_b64_tr_b16 a[216:217], v22 offset:16384
    ds_read_b64_tr_b16 a[218:219], v22 offset:20480
    v_mfma_f32_16x16x32_bf16 v[132:135], a[228:231], v[216:219], v[132:135]
    v_mfma_f32_16x16x32_bf16 v[128:131], a[224:227], v[216:219], v[128:131]
    s_waitcnt vmcnt(37)
    ds_read_b64_tr_b16 a[220:221], v23 offset:16384
    ds_read_b64_tr_b16 a[222:223], v23 offset:20480
    v_mfma_f32_16x16x32_bf16 v[160:163], a[224:227], v[220:223], v[160:163]
    v_mfma_f32_16x16x32_bf16 v[164:167], a[228:231], v[220:223], v[164:167]
    v_mfma_f32_16x16x32_bf16 v[168:171], a[232:235], v[220:223], v[168:171]
    v_mfma_f32_16x16x32_bf16 v[172:175], a[236:239], v[220:223], v[172:175]
    v_mfma_f32_16x16x32_bf16 v[176:179], a[240:243], v[220:223], v[176:179]
    v_mfma_f32_16x16x32_bf16 v[180:183], a[244:247], v[220:223], v[180:183]
    v_mfma_f32_16x16x32_bf16 v[184:187], a[248:251], v[220:223], v[184:187]
    v_mfma_f32_16x16x32_bf16 v[188:191], a[252:255], v[220:223], v[188:191]
    s_waitcnt lgkmcnt(0) vmcnt(36)
    v_mfma_f32_16x16x32_bf16 v[96:99], a[192:195], v[228:231], v[96:99]
    buffer_load_dwordx4 v[212:215], v37, s[20:23], s61 offen offset:1024 sc1
    v_mfma_f32_16x16x32_bf16 v[100:103], a[196:199], v[228:231], v[100:103]
    ds_read_b64_tr_b16 a[224:225], v16 offset:24576
    ds_read_b64_tr_b16 a[226:227], v16 offset:28672
    v_mfma_f32_16x16x32_bf16 v[104:107], a[200:203], v[228:231], v[104:107]
    buffer_load_dwordx4 v[216:219], v38, s[20:23], s61 offen offset:1024 sc1
    v_mfma_f32_16x16x32_bf16 v[108:111], a[204:207], v[228:231], v[108:111]
    ds_read_b64_tr_b16 a[228:229], v17 offset:24576
    ds_read_b64_tr_b16 a[230:231], v17 offset:28672
    v_mfma_f32_16x16x32_bf16 v[112:115], a[208:211], v[228:231], v[112:115]
    buffer_load_dwordx4 v[220:223], v39, s[20:23], s61 offen offset:1024 sc1
    v_mfma_f32_16x16x32_bf16 v[116:119], a[212:215], v[228:231], v[116:119]
    ds_read_b64_tr_b16 a[232:233], v18 offset:24576
    ds_read_b64_tr_b16 a[234:235], v18 offset:28672
    v_mfma_f32_16x16x32_bf16 v[120:123], a[216:219], v[228:231], v[120:123]
    v_mfma_f32_16x16x32_bf16 v[124:127], a[220:223], v[228:231], v[124:127]
    s_waitcnt vmcnt(38)
    ds_read_b64_tr_b16 a[236:237], v19 offset:24576
    ds_read_b64_tr_b16 a[238:239], v19 offset:28672
    v_mfma_f32_16x16x32_bf16 v[156:159], a[220:223], v[232:235], v[156:159]
    v_mfma_f32_16x16x32_bf16 v[152:155], a[216:219], v[232:235], v[152:155]
    ds_read_b64_tr_b16 a[240:241], v20 offset:24576
    ds_read_b64_tr_b16 a[242:243], v20 offset:28672
    v_mfma_f32_16x16x32_bf16 v[148:151], a[212:215], v[232:235], v[148:151]
    v_mfma_f32_16x16x32_bf16 v[144:147], a[208:211], v[232:235], v[144:147]
    ds_read_b64_tr_b16 a[244:245], v21 offset:24576
    ds_read_b64_tr_b16 a[246:247], v21 offset:28672
    v_mfma_f32_16x16x32_bf16 v[140:143], a[204:207], v[232:235], v[140:143]
    v_mfma_f32_16x16x32_bf16 v[136:139], a[200:203], v[232:235], v[136:139]
    ds_read_b64_tr_b16 a[248:249], v22 offset:24576
    ds_read_b64_tr_b16 a[250:251], v22 offset:28672
    v_mfma_f32_16x16x32_bf16 v[132:135], a[196:199], v[232:235], v[132:135]
    v_mfma_f32_16x16x32_bf16 v[128:131], a[192:195], v[232:235], v[128:131]
    s_waitcnt vmcnt(37)
    ds_read_b64_tr_b16 a[252:253], v23 offset:24576
    ds_read_b64_tr_b16 a[254:255], v23 offset:28672
    v_mfma_f32_16x16x32_bf16 v[160:163], a[192:195], v[236:239], v[160:163]
    v_mfma_f32_16x16x32_bf16 v[164:167], a[196:199], v[236:239], v[164:167]
    v_mfma_f32_16x16x32_bf16 v[168:171], a[200:203], v[236:239], v[168:171]
    v_mfma_f32_16x16x32_bf16 v[172:175], a[204:207], v[236:239], v[172:175]
    v_mfma_f32_16x16x32_bf16 v[176:179], a[208:211], v[236:239], v[176:179]
    v_mfma_f32_16x16x32_bf16 v[180:183], a[212:215], v[236:239], v[180:183]
    v_mfma_f32_16x16x32_bf16 v[184:187], a[216:219], v[236:239], v[184:187]
    v_mfma_f32_16x16x32_bf16 v[188:191], a[220:223], v[236:239], v[188:191]
    s_waitcnt lgkmcnt(0) vmcnt(32)
    v_mfma_f32_16x16x32_bf16 v[96:99], a[224:227], v[244:247], v[96:99]
    buffer_load_dwordx4 v[228:231], v37, s[20:23], s61 offen offset:2048 sc1
    v_mfma_f32_16x16x32_bf16 v[100:103], a[228:231], v[244:247], v[100:103]
    ds_read_b64_tr_b16 a[192:193], v8 offset:0
    ds_read_b64_tr_b16 a[194:195], v8 offset:4096
    v_mfma_f32_16x16x32_bf16 v[104:107], a[232:235], v[244:247], v[104:107]
    buffer_load_dwordx4 v[232:235], v38, s[20:23], s61 offen offset:2048 sc1
    v_mfma_f32_16x16x32_bf16 v[108:111], a[236:239], v[244:247], v[108:111]
    ds_read_b64_tr_b16 a[196:197], v9 offset:0
    ds_read_b64_tr_b16 a[198:199], v9 offset:4096
    v_mfma_f32_16x16x32_bf16 v[112:115], a[240:243], v[244:247], v[112:115]
    buffer_load_dwordx4 v[236:239], v39, s[20:23], s61 offen offset:2048 sc1
    v_mfma_f32_16x16x32_bf16 v[116:119], a[244:247], v[244:247], v[116:119]
    ds_read_b64_tr_b16 a[200:201], v10 offset:0
    ds_read_b64_tr_b16 a[202:203], v10 offset:4096
    v_mfma_f32_16x16x32_bf16 v[120:123], a[248:251], v[244:247], v[120:123]
    v_mfma_f32_16x16x32_bf16 v[124:127], a[252:255], v[244:247], v[124:127]
    s_waitcnt vmcnt(34)
    ds_read_b64_tr_b16 a[204:205], v11 offset:0
    ds_read_b64_tr_b16 a[206:207], v11 offset:4096
    v_mfma_f32_16x16x32_bf16 v[156:159], a[252:255], v[248:251], v[156:159]
    v_mfma_f32_16x16x32_bf16 v[152:155], a[248:251], v[248:251], v[152:155]
    ds_read_b64_tr_b16 a[208:209], v12 offset:0
    ds_read_b64_tr_b16 a[210:211], v12 offset:4096
    v_mfma_f32_16x16x32_bf16 v[148:151], a[244:247], v[248:251], v[148:151]
    v_mfma_f32_16x16x32_bf16 v[144:147], a[240:243], v[248:251], v[144:147]
    ds_read_b64_tr_b16 a[212:213], v13 offset:0
    ds_read_b64_tr_b16 a[214:215], v13 offset:4096
    v_mfma_f32_16x16x32_bf16 v[140:143], a[236:239], v[248:251], v[140:143]
    v_mfma_f32_16x16x32_bf16 v[136:139], a[232:235], v[248:251], v[136:139]
    ds_read_b64_tr_b16 a[216:217], v14 offset:0
    ds_read_b64_tr_b16 a[218:219], v14 offset:4096
    v_mfma_f32_16x16x32_bf16 v[132:135], a[228:231], v[248:251], v[132:135]
    v_mfma_f32_16x16x32_bf16 v[128:131], a[224:227], v[248:251], v[128:131]
    s_waitcnt vmcnt(33)
    ds_read_b64_tr_b16 a[220:221], v15 offset:0
    ds_read_b64_tr_b16 a[222:223], v15 offset:4096
    v_mfma_f32_16x16x32_bf16 v[160:163], a[224:227], v[252:255], v[160:163]
    v_mfma_f32_16x16x32_bf16 v[164:167], a[228:231], v[252:255], v[164:167]
    v_mfma_f32_16x16x32_bf16 v[168:171], a[232:235], v[252:255], v[168:171]
    v_mfma_f32_16x16x32_bf16 v[172:175], a[236:239], v[252:255], v[172:175]
    v_mfma_f32_16x16x32_bf16 v[176:179], a[240:243], v[252:255], v[176:179]
    v_mfma_f32_16x16x32_bf16 v[180:183], a[244:247], v[252:255], v[180:183]
    v_mfma_f32_16x16x32_bf16 v[184:187], a[248:251], v[252:255], v[184:187]
    v_mfma_f32_16x16x32_bf16 v[188:191], a[252:255], v[252:255], v[188:191]
    s_waitcnt lgkmcnt(0) vmcnt(29)
    v_mfma_f32_16x16x32_bf16 v[96:99], a[192:195], a[132:135], v[96:99]
    buffer_load_dwordx4 v[244:247], v37, s[20:23], s61 offen offset:3072 sc1
    v_mfma_f32_16x16x32_bf16 v[100:103], a[196:199], a[132:135], v[100:103]
    ds_read_b64_tr_b16 a[224:225], v8 offset:8192
    ds_read_b64_tr_b16 a[226:227], v8 offset:12288
    v_mfma_f32_16x16x32_bf16 v[104:107], a[200:203], a[132:135], v[104:107]
    buffer_load_dwordx4 v[248:251], v38, s[20:23], s61 offen offset:3072 sc1
    v_mfma_f32_16x16x32_bf16 v[108:111], a[204:207], a[132:135], v[108:111]
    ds_read_b64_tr_b16 a[228:229], v9 offset:8192
    ds_read_b64_tr_b16 a[230:231], v9 offset:12288
    v_mfma_f32_16x16x32_bf16 v[112:115], a[208:211], a[132:135], v[112:115]
    buffer_load_dwordx4 v[252:255], v39, s[20:23], s61 offen offset:3072 sc1
    v_mfma_f32_16x16x32_bf16 v[116:119], a[212:215], a[132:135], v[116:119]
    ds_read_b64_tr_b16 a[232:233], v10 offset:8192
    ds_read_b64_tr_b16 a[234:235], v10 offset:12288
    v_mfma_f32_16x16x32_bf16 v[120:123], a[216:219], a[132:135], v[120:123]
    v_mfma_f32_16x16x32_bf16 v[124:127], a[220:223], a[132:135], v[124:127]
    s_waitcnt vmcnt(31)
    ds_read_b64_tr_b16 a[236:237], v11 offset:8192
    ds_read_b64_tr_b16 a[238:239], v11 offset:12288
    v_mfma_f32_16x16x32_bf16 v[156:159], a[220:223], a[136:139], v[156:159]
    v_mfma_f32_16x16x32_bf16 v[152:155], a[216:219], a[136:139], v[152:155]
    ds_read_b64_tr_b16 a[240:241], v12 offset:8192
    ds_read_b64_tr_b16 a[242:243], v12 offset:12288
    v_mfma_f32_16x16x32_bf16 v[148:151], a[212:215], a[136:139], v[148:151]
    v_mfma_f32_16x16x32_bf16 v[144:147], a[208:211], a[136:139], v[144:147]
    ds_read_b64_tr_b16 a[244:245], v13 offset:8192
    ds_read_b64_tr_b16 a[246:247], v13 offset:12288
    v_mfma_f32_16x16x32_bf16 v[140:143], a[204:207], a[136:139], v[140:143]
    v_mfma_f32_16x16x32_bf16 v[136:139], a[200:203], a[136:139], v[136:139]
    ds_read_b64_tr_b16 a[248:249], v14 offset:8192
    ds_read_b64_tr_b16 a[250:251], v14 offset:12288
    v_mfma_f32_16x16x32_bf16 v[132:135], a[196:199], a[136:139], v[132:135]
    v_mfma_f32_16x16x32_bf16 v[128:131], a[192:195], a[136:139], v[128:131]
    s_waitcnt vmcnt(30)
    ds_read_b64_tr_b16 a[252:253], v15 offset:8192
    ds_read_b64_tr_b16 a[254:255], v15 offset:12288
    v_mfma_f32_16x16x32_bf16 v[160:163], a[192:195], a[140:143], v[160:163]
    v_mfma_f32_16x16x32_bf16 v[164:167], a[196:199], a[140:143], v[164:167]
    v_mfma_f32_16x16x32_bf16 v[168:171], a[200:203], a[140:143], v[168:171]
    v_mfma_f32_16x16x32_bf16 v[172:175], a[204:207], a[140:143], v[172:175]
    v_mfma_f32_16x16x32_bf16 v[176:179], a[208:211], a[140:143], v[176:179]
    v_mfma_f32_16x16x32_bf16 v[180:183], a[212:215], a[140:143], v[180:183]
    v_mfma_f32_16x16x32_bf16 v[184:187], a[216:219], a[140:143], v[184:187]
    v_mfma_f32_16x16x32_bf16 v[188:191], a[220:223], a[140:143], v[188:191]
    s_waitcnt lgkmcnt(0) vmcnt(27)
    v_mfma_f32_16x16x32_bf16 v[96:99], a[224:227], a[148:151], v[96:99]
    s_bfe_u32 s61, s40, 0x4001c
    v_mfma_f32_16x16x32_bf16 v[100:103], a[228:231], a[148:151], v[100:103]
    s_lshl_b32 s61, s61, 12
    ds_read_b64_tr_b16 a[192:193], v8 offset:16384
    ds_read_b64_tr_b16 a[194:195], v8 offset:20480
    v_mfma_f32_16x16x32_bf16 v[104:107], a[232:235], a[148:151], v[104:107]
    buffer_load_dwordx4 a[132:135], v37, s[20:23], s61 offen offset:0 sc1
    v_mfma_f32_16x16x32_bf16 v[108:111], a[236:239], a[148:151], v[108:111]
    ds_read_b64_tr_b16 a[196:197], v9 offset:16384
    ds_read_b64_tr_b16 a[198:199], v9 offset:20480
    v_mfma_f32_16x16x32_bf16 v[112:115], a[240:243], a[148:151], v[112:115]
    buffer_load_dwordx4 a[136:139], v38, s[20:23], s61 offen offset:0 sc1
    v_mfma_f32_16x16x32_bf16 v[116:119], a[244:247], a[148:151], v[116:119]
    ds_read_b64_tr_b16 a[200:201], v10 offset:16384
    ds_read_b64_tr_b16 a[202:203], v10 offset:20480
    v_mfma_f32_16x16x32_bf16 v[120:123], a[248:251], a[148:151], v[120:123]
    buffer_load_dwordx4 a[140:143], v39, s[20:23], s61 offen offset:0 sc1
    v_mfma_f32_16x16x32_bf16 v[124:127], a[252:255], a[148:151], v[124:127]
    s_waitcnt vmcnt(29)
    ds_read_b64_tr_b16 a[204:205], v11 offset:16384
    ds_read_b64_tr_b16 a[206:207], v11 offset:20480
    v_mfma_f32_16x16x32_bf16 v[156:159], a[252:255], a[152:155], v[156:159]
    v_mfma_f32_16x16x32_bf16 v[152:155], a[248:251], a[152:155], v[152:155]
    ds_read_b64_tr_b16 a[208:209], v12 offset:16384
    ds_read_b64_tr_b16 a[210:211], v12 offset:20480
    v_mfma_f32_16x16x32_bf16 v[148:151], a[244:247], a[152:155], v[148:151]
    v_mfma_f32_16x16x32_bf16 v[144:147], a[240:243], a[152:155], v[144:147]
    ds_read_b64_tr_b16 a[212:213], v13 offset:16384
    ds_read_b64_tr_b16 a[214:215], v13 offset:20480
    v_mfma_f32_16x16x32_bf16 v[140:143], a[236:239], a[152:155], v[140:143]
    v_mfma_f32_16x16x32_bf16 v[136:139], a[232:235], a[152:155], v[136:139]
    ds_read_b64_tr_b16 a[216:217], v14 offset:16384
    ds_read_b64_tr_b16 a[218:219], v14 offset:20480
    v_mfma_f32_16x16x32_bf16 v[132:135], a[228:231], a[152:155], v[132:135]
    v_mfma_f32_16x16x32_bf16 v[128:131], a[224:227], a[152:155], v[128:131]
    s_waitcnt vmcnt(28)
    ds_read_b64_tr_b16 a[220:221], v15 offset:16384
    ds_read_b64_tr_b16 a[222:223], v15 offset:20480
    v_mfma_f32_16x16x32_bf16 v[160:163], a[224:227], a[156:159], v[160:163]
    v_mfma_f32_16x16x32_bf16 v[164:167], a[228:231], a[156:159], v[164:167]
    v_mfma_f32_16x16x32_bf16 v[168:171], a[232:235], a[156:159], v[168:171]
    v_mfma_f32_16x16x32_bf16 v[172:175], a[236:239], a[156:159], v[172:175]
    v_mfma_f32_16x16x32_bf16 v[176:179], a[240:243], a[156:159], v[176:179]
    v_mfma_f32_16x16x32_bf16 v[180:183], a[244:247], a[156:159], v[180:183]
    v_mfma_f32_16x16x32_bf16 v[184:187], a[248:251], a[156:159], v[184:187]
    v_mfma_f32_16x16x32_bf16 v[188:191], a[252:255], a[156:159], v[188:191]
    s_waitcnt lgkmcnt(0) vmcnt(24)
    v_mfma_f32_16x16x32_bf16 v[96:99], a[192:195], a[164:167], v[96:99]
    buffer_load_dwordx4 a[148:151], v37, s[20:23], s61 offen offset:1024 sc1
    v_mfma_f32_16x16x32_bf16 v[100:103], a[196:199], a[164:167], v[100:103]
    ds_read_b64_tr_b16 a[224:225], v8 offset:24576
    ds_read_b64_tr_b16 a[226:227], v8 offset:28672
    v_mfma_f32_16x16x32_bf16 v[104:107], a[200:203], a[164:167], v[104:107]
    buffer_load_dwordx4 a[152:155], v38, s[20:23], s61 offen offset:1024 sc1
    v_mfma_f32_16x16x32_bf16 v[108:111], a[204:207], a[164:167], v[108:111]
    ds_read_b64_tr_b16 a[228:229], v9 offset:24576
    ds_read_b64_tr_b16 a[230:231], v9 offset:28672
    v_mfma_f32_16x16x32_bf16 v[112:115], a[208:211], a[164:167], v[112:115]
    buffer_load_dwordx4 a[156:159], v39, s[20:23], s61 offen offset:1024 sc1
    v_mfma_f32_16x16x32_bf16 v[116:119], a[212:215], a[164:167], v[116:119]
    ds_read_b64_tr_b16 a[232:233], v10 offset:24576
    ds_read_b64_tr_b16 a[234:235], v10 offset:28672
    v_mfma_f32_16x16x32_bf16 v[120:123], a[216:219], a[164:167], v[120:123]
    v_mfma_f32_16x16x32_bf16 v[124:127], a[220:223], a[164:167], v[124:127]
    s_waitcnt vmcnt(26)
    ds_read_b64_tr_b16 a[236:237], v11 offset:24576
    ds_read_b64_tr_b16 a[238:239], v11 offset:28672
    v_mfma_f32_16x16x32_bf16 v[156:159], a[220:223], a[168:171], v[156:159]
    v_mfma_f32_16x16x32_bf16 v[152:155], a[216:219], a[168:171], v[152:155]
    ds_read_b64_tr_b16 a[240:241], v12 offset:24576
    ds_read_b64_tr_b16 a[242:243], v12 offset:28672
    v_mfma_f32_16x16x32_bf16 v[148:151], a[212:215], a[168:171], v[148:151]
    v_mfma_f32_16x16x32_bf16 v[144:147], a[208:211], a[168:171], v[144:147]
    ds_read_b64_tr_b16 a[244:245], v13 offset:24576
    ds_read_b64_tr_b16 a[246:247], v13 offset:28672
    v_mfma_f32_16x16x32_bf16 v[140:143], a[204:207], a[168:171], v[140:143]
    v_mfma_f32_16x16x32_bf16 v[136:139], a[200:203], a[168:171], v[136:139]
    ds_read_b64_tr_b16 a[248:249], v14 offset:24576
    ds_read_b64_tr_b16 a[250:251], v14 offset:28672
    v_mfma_f32_16x16x32_bf16 v[132:135], a[196:199], a[168:171], v[132:135]
    v_mfma_f32_16x16x32_bf16 v[128:131], a[192:195], a[168:171], v[128:131]
    s_waitcnt vmcnt(25)
    ds_read_b64_tr_b16 a[252:253], v15 offset:24576
    ds_read_b64_tr_b16 a[254:255], v15 offset:28672
    v_mfma_f32_16x16x32_bf16 v[160:163], a[192:195], a[172:175], v[160:163]
    v_mfma_f32_16x16x32_bf16 v[164:167], a[196:199], a[172:175], v[164:167]
    v_mfma_f32_16x16x32_bf16 v[168:171], a[200:203], a[172:175], v[168:171]
    v_mfma_f32_16x16x32_bf16 v[172:175], a[204:207], a[172:175], v[172:175]
    v_mfma_f32_16x16x32_bf16 v[176:179], a[208:211], a[172:175], v[176:179]
    v_mfma_f32_16x16x32_bf16 v[180:183], a[212:215], a[172:175], v[180:183]
    v_mfma_f32_16x16x32_bf16 v[184:187], a[216:219], a[172:175], v[184:187]
    v_mfma_f32_16x16x32_bf16 v[188:191], a[220:223], a[172:175], v[188:191]
    s_waitcnt lgkmcnt(0) vmcnt(21)
    v_mfma_f32_16x16x32_bf16 v[96:99], a[224:227], a[180:183], v[96:99]
    s_waitcnt vmcnt(18) lgkmcnt(0)
    buffer_load_dwordx4 a[164:167], v37, s[20:23], s61 offen offset:2048 sc1
    v_mfma_f32_16x16x32_bf16 v[100:103], a[228:231], a[180:183], v[100:103]
    s_barrier
    v_mfma_f32_16x16x32_bf16 v[104:107], a[232:235], a[180:183], v[104:107]
    ds_read_b64_tr_b16 a[192:193], v16 offset:32768
    ds_read_b64_tr_b16 a[194:195], v16 offset:36864
    v_mfma_f32_16x16x32_bf16 v[108:111], a[236:239], a[180:183], v[108:111]
    buffer_load_dwordx4 a[168:171], v38, s[20:23], s61 offen offset:2048 sc1
    v_mfma_f32_16x16x32_bf16 v[112:115], a[240:243], a[180:183], v[112:115]
    ds_read_b64_tr_b16 a[196:197], v17 offset:32768
    ds_read_b64_tr_b16 a[198:199], v17 offset:36864
    v_mfma_f32_16x16x32_bf16 v[116:119], a[244:247], a[180:183], v[116:119]
    buffer_load_dwordx4 a[172:175], v39, s[20:23], s61 offen offset:2048 sc1
    v_mfma_f32_16x16x32_bf16 v[120:123], a[248:251], a[180:183], v[120:123]
    ds_read_b64_tr_b16 a[200:201], v18 offset:32768
    ds_read_b64_tr_b16 a[202:203], v18 offset:36864
    v_mfma_f32_16x16x32_bf16 v[124:127], a[252:255], a[180:183], v[124:127]
    s_waitcnt vmcnt(23)
    v_mfma_f32_16x16x32_bf16 v[156:159], a[252:255], a[184:187], v[156:159]
    ds_read_b64_tr_b16 a[204:205], v19 offset:32768
    ds_read_b64_tr_b16 a[206:207], v19 offset:36864
    v_mfma_f32_16x16x32_bf16 v[152:155], a[248:251], a[184:187], v[152:155]
    v_mfma_f32_16x16x32_bf16 v[148:151], a[244:247], a[184:187], v[148:151]
    ds_read_b64_tr_b16 a[208:209], v20 offset:32768
    ds_read_b64_tr_b16 a[210:211], v20 offset:36864
    v_mfma_f32_16x16x32_bf16 v[144:147], a[240:243], a[184:187], v[144:147]
    v_mfma_f32_16x16x32_bf16 v[140:143], a[236:239], a[184:187], v[140:143]
    ds_read_b64_tr_b16 a[212:213], v21 offset:32768
    ds_read_b64_tr_b16 a[214:215], v21 offset:36864
    v_mfma_f32_16x16x32_bf16 v[136:139], a[232:235], a[184:187], v[136:139]
    v_mfma_f32_16x16x32_bf16 v[132:135], a[228:231], a[184:187], v[132:135]
    ds_read_b64_tr_b16 a[216:217], v22 offset:32768
    ds_read_b64_tr_b16 a[218:219], v22 offset:36864
    v_mfma_f32_16x16x32_bf16 v[128:131], a[224:227], a[184:187], v[128:131]
    s_waitcnt vmcnt(22)
    v_mfma_f32_16x16x32_bf16 v[160:163], a[224:227], a[188:191], v[160:163]
    ds_read_b64_tr_b16 a[220:221], v23 offset:32768
    ds_read_b64_tr_b16 a[222:223], v23 offset:36864
    v_mfma_f32_16x16x32_bf16 v[164:167], a[228:231], a[188:191], v[164:167]
    v_mfma_f32_16x16x32_bf16 v[168:171], a[232:235], a[188:191], v[168:171]
    v_mfma_f32_16x16x32_bf16 v[172:175], a[236:239], a[188:191], v[172:175]
    v_mfma_f32_16x16x32_bf16 v[176:179], a[240:243], a[188:191], v[176:179]
    v_mfma_f32_16x16x32_bf16 v[180:183], a[244:247], a[188:191], v[180:183]
    v_mfma_f32_16x16x32_bf16 v[184:187], a[248:251], a[188:191], v[184:187]
    v_mfma_f32_16x16x32_bf16 v[188:191], a[252:255], a[188:191], v[188:191]
    s_waitcnt lgkmcnt(0) vmcnt(20)
    v_mfma_f32_16x16x32_bf16 v[96:99], a[192:195], v[196:199], v[96:99]
    buffer_load_dwordx4 a[180:183], v37, s[20:23], s61 offen offset:3072 sc1
    v_mfma_f32_16x16x32_bf16 v[100:103], a[196:199], v[196:199], v[100:103]
    ds_read_b64_tr_b16 a[224:225], v16 offset:40960
    ds_read_b64_tr_b16 a[226:227], v16 offset:45056
    v_mfma_f32_16x16x32_bf16 v[104:107], a[200:203], v[196:199], v[104:107]
    buffer_load_dwordx4 a[184:187], v38, s[20:23], s61 offen offset:3072 sc1
    v_mfma_f32_16x16x32_bf16 v[108:111], a[204:207], v[196:199], v[108:111]
    ds_read_b64_tr_b16 a[228:229], v17 offset:40960
    ds_read_b64_tr_b16 a[230:231], v17 offset:45056
    v_mfma_f32_16x16x32_bf16 v[112:115], a[208:211], v[196:199], v[112:115]
    buffer_load_dwordx4 a[188:191], v39, s[20:23], s61 offen offset:3072 sc1
    v_mfma_f32_16x16x32_bf16 v[116:119], a[212:215], v[196:199], v[116:119]
    ds_read_b64_tr_b16 a[232:233], v18 offset:40960
    ds_read_b64_tr_b16 a[234:235], v18 offset:45056
    v_mfma_f32_16x16x32_bf16 v[120:123], a[216:219], v[196:199], v[120:123]
    s_waitcnt vmcnt(22)
    v_mfma_f32_16x16x32_bf16 v[124:127], a[220:223], v[196:199], v[124:127]
    s_bfe_u32 s61, s40, 0x4000c
    ds_read_b64_tr_b16 a[236:237], v19 offset:40960
    ds_read_b64_tr_b16 a[238:239], v19 offset:45056
    v_mfma_f32_16x16x32_bf16 v[156:159], a[220:223], v[200:203], v[156:159]
    s_lshl_b32 s61, s61, 12
    buffer_load_dwordx4 a[0:3], v36, s[20:23], s61 offen offset:0 sc1
    v_mfma_f32_16x16x32_bf16 v[152:155], a[216:219], v[200:203], v[152:155]
    ds_read_b64_tr_b16 a[240:241], v20 offset:40960
    ds_read_b64_tr_b16 a[242:243], v20 offset:45056
    v_mfma_f32_16x16x32_bf16 v[148:151], a[212:215], v[200:203], v[148:151]
    v_mfma_f32_16x16x32_bf16 v[144:147], a[208:211], v[200:203], v[144:147]
    ds_read_b64_tr_b16 a[244:245], v21 offset:40960
    ds_read_b64_tr_b16 a[246:247], v21 offset:45056
    v_mfma_f32_16x16x32_bf16 v[140:143], a[204:207], v[200:203], v[140:143]
    buffer_load_dwordx4 a[4:7], v36, s[20:23], s61 offen offset:1024 sc1
    v_mfma_f32_16x16x32_bf16 v[136:139], a[200:203], v[200:203], v[136:139]
    ds_read_b64_tr_b16 a[248:249], v22 offset:40960
    ds_read_b64_tr_b16 a[250:251], v22 offset:45056
    v_mfma_f32_16x16x32_bf16 v[132:135], a[196:199], v[200:203], v[132:135]
    v_mfma_f32_16x16x32_bf16 v[128:131], a[192:195], v[200:203], v[128:131]
    s_waitcnt vmcnt(23)
    ds_read_b64_tr_b16 a[252:253], v23 offset:40960
    ds_read_b64_tr_b16 a[254:255], v23 offset:45056
    v_mfma_f32_16x16x32_bf16 v[160:163], a[192:195], v[204:207], v[160:163]
    buffer_load_dwordx4 a[8:11], v36, s[20:23], s61 offen offset:2048 sc1
    v_mfma_f32_16x16x32_bf16 v[164:167], a[196:199], v[204:207], v[164:167]
    v_mfma_f32_16x16x32_bf16 v[168:171], a[200:203], v[204:207], v[168:171]
    v_mfma_f32_16x16x32_bf16 v[172:175], a[204:207], v[204:207], v[172:175]
    buffer_load_dwordx4 a[12:15], v36, s[20:23], s61 offen offset:3072 sc1
    v_mfma_f32_16x16x32_bf16 v[176:179], a[208:211], v[204:207], v[176:179]
    v_mfma_f32_16x16x32_bf16 v[180:183], a[212:215], v[204:207], v[180:183]
    s_waitcnt lgkmcnt(2) vmcnt(24)
    v_mfma_f32_16x16x32_bf16 v[184:187], a[216:219], v[204:207], v[184:187]
    s_bfe_u32 s61, s40, 0x40010
    v_mfma_f32_16x16x32_bf16 v[188:191], a[220:223], v[204:207], v[188:191]
    s_lshl_b32 s61, s61, 12
    buffer_load_dwordx4 a[16:19], v36, s[20:23], s61 offen offset:0 sc1
    v_mfma_f32_16x16x32_bf16 v[96:99], a[224:227], v[212:215], v[96:99]
    v_mfma_f32_16x16x32_bf16 v[100:103], a[228:231], v[212:215], v[100:103]
    ds_read_b64_tr_b16 a[192:193], v16 offset:49152
    ds_read_b64_tr_b16 a[194:195], v16 offset:53248
    v_mfma_f32_16x16x32_bf16 v[104:107], a[232:235], v[212:215], v[104:107]
    buffer_load_dwordx4 a[20:23], v36, s[20:23], s61 offen offset:1024 sc1
    v_mfma_f32_16x16x32_bf16 v[108:111], a[236:239], v[212:215], v[108:111]
    ds_read_b64_tr_b16 a[196:197], v17 offset:49152
    ds_read_b64_tr_b16 a[198:199], v17 offset:53248
    v_mfma_f32_16x16x32_bf16 v[112:115], a[240:243], v[212:215], v[112:115]
    v_mfma_f32_16x16x32_bf16 v[116:119], a[244:247], v[212:215], v[116:119]
    ds_read_b64_tr_b16 a[200:201], v18 offset:49152
    ds_read_b64_tr_b16 a[202:203], v18 offset:53248
    v_mfma_f32_16x16x32_bf16 v[120:123], a[248:251], v[212:215], v[120:123]
    s_waitcnt lgkmcnt(6)
    buffer_load_dwordx4 a[24:27], v36, s[20:23], s61 offen offset:2048 sc1
    v_mfma_f32_16x16x32_bf16 v[124:127], a[252:255], v[212:215], v[124:127]
    s_waitcnt vmcnt(26)
    ds_read_b64_tr_b16 a[204:205], v19 offset:49152
    ds_read_b64_tr_b16 a[206:207], v19 offset:53248
    v_mfma_f32_16x16x32_bf16 v[156:159], a[252:255], v[216:219], v[156:159]
    v_mfma_f32_16x16x32_bf16 v[152:155], a[248:251], v[216:219], v[152:155]
    ds_read_b64_tr_b16 a[208:209], v20 offset:49152
    ds_read_b64_tr_b16 a[210:211], v20 offset:53248
    v_mfma_f32_16x16x32_bf16 v[148:151], a[244:247], v[216:219], v[148:151]
    buffer_load_dwordx4 a[28:31], v36, s[20:23], s61 offen offset:3072 sc1
    v_mfma_f32_16x16x32_bf16 v[144:147], a[240:243], v[216:219], v[144:147]
    ds_read_b64_tr_b16 a[212:213], v21 offset:49152
    ds_read_b64_tr_b16 a[214:215], v21 offset:53248
    v_mfma_f32_16x16x32_bf16 v[140:143], a[236:239], v[216:219], v[140:143]
    v_mfma_f32_16x16x32_bf16 v[136:139], a[232:235], v[216:219], v[136:139]
    s_bfe_u32 s61, s40, 0x40014
    ds_read_b64_tr_b16 a[216:217], v22 offset:49152
    ds_read_b64_tr_b16 a[218:219], v22 offset:53248
    v_mfma_f32_16x16x32_bf16 v[132:135], a[228:231], v[216:219], v[132:135]
    s_lshl_b32 s61, s61, 12
    buffer_load_dwordx4 a[32:35], v36, s[20:23], s61 offen offset:0 sc1
    v_mfma_f32_16x16x32_bf16 v[128:131], a[224:227], v[216:219], v[128:131]
    s_waitcnt vmcnt(27)
    ds_read_b64_tr_b16 a[220:221], v23 offset:49152
    ds_read_b64_tr_b16 a[222:223], v23 offset:53248
    v_mfma_f32_16x16x32_bf16 v[160:163], a[224:227], v[220:223], v[160:163]
    v_mfma_f32_16x16x32_bf16 v[164:167], a[228:231], v[220:223], v[164:167]
    buffer_load_dwordx4 a[36:39], v36, s[20:23], s61 offen offset:1024 sc1
    v_mfma_f32_16x16x32_bf16 v[168:171], a[232:235], v[220:223], v[168:171]
    v_mfma_f32_16x16x32_bf16 v[172:175], a[236:239], v[220:223], v[172:175]
    v_mfma_f32_16x16x32_bf16 v[176:179], a[240:243], v[220:223], v[176:179]
    buffer_load_dwordx4 a[40:43], v36, s[20:23], s61 offen offset:2048 sc1
    v_mfma_f32_16x16x32_bf16 v[180:183], a[244:247], v[220:223], v[180:183]
    v_mfma_f32_16x16x32_bf16 v[184:187], a[248:251], v[220:223], v[184:187]
    v_mfma_f32_16x16x32_bf16 v[188:191], a[252:255], v[220:223], v[188:191]
    s_waitcnt lgkmcnt(0) vmcnt(28)
    buffer_load_dwordx4 a[44:47], v36, s[20:23], s61 offen offset:3072 sc1
    v_mfma_f32_16x16x32_bf16 v[96:99], a[192:195], v[228:231], v[96:99]
    v_mfma_f32_16x16x32_bf16 v[100:103], a[196:199], v[228:231], v[100:103]
    ds_read_b64_tr_b16 a[224:225], v16 offset:57344
    ds_read_b64_tr_b16 a[226:227], v16 offset:61440
    v_mfma_f32_16x16x32_bf16 v[104:107], a[200:203], v[228:231], v[104:107]
    s_bfe_u32 s61, s40, 0x40018
    v_mfma_f32_16x16x32_bf16 v[108:111], a[204:207], v[228:231], v[108:111]
    s_lshl_b32 s61, s61, 12
    ds_read_b64_tr_b16 a[228:229], v17 offset:57344
    ds_read_b64_tr_b16 a[230:231], v17 offset:61440
    v_mfma_f32_16x16x32_bf16 v[112:115], a[208:211], v[228:231], v[112:115]
    buffer_load_dwordx4 a[48:51], v36, s[20:23], s61 offen offset:0 sc1
    v_mfma_f32_16x16x32_bf16 v[116:119], a[212:215], v[228:231], v[116:119]
    ds_read_b64_tr_b16 a[232:233], v18 offset:57344
    ds_read_b64_tr_b16 a[234:235], v18 offset:61440
    v_mfma_f32_16x16x32_bf16 v[120:123], a[216:219], v[228:231], v[120:123]
    v_mfma_f32_16x16x32_bf16 v[124:127], a[220:223], v[228:231], v[124:127]
    s_waitcnt vmcnt(29)
    ds_read_b64_tr_b16 a[236:237], v19 offset:57344
    ds_read_b64_tr_b16 a[238:239], v19 offset:61440
    v_mfma_f32_16x16x32_bf16 v[156:159], a[220:223], v[232:235], v[156:159]
    buffer_load_dwordx4 a[52:55], v36, s[20:23], s61 offen offset:1024 sc1
    v_mfma_f32_16x16x32_bf16 v[152:155], a[216:219], v[232:235], v[152:155]
    ds_read_b64_tr_b16 a[240:241], v20 offset:57344
    ds_read_b64_tr_b16 a[242:243], v20 offset:61440
    v_mfma_f32_16x16x32_bf16 v[148:151], a[212:215], v[232:235], v[148:151]
    v_mfma_f32_16x16x32_bf16 v[144:147], a[208:211], v[232:235], v[144:147]
    ds_read_b64_tr_b16 a[244:245], v21 offset:57344
    ds_read_b64_tr_b16 a[246:247], v21 offset:61440
    v_mfma_f32_16x16x32_bf16 v[140:143], a[204:207], v[232:235], v[140:143]
    buffer_load_dwordx4 a[56:59], v36, s[20:23], s61 offen offset:2048 sc1
    v_mfma_f32_16x16x32_bf16 v[136:139], a[200:203], v[232:235], v[136:139]
    ds_read_b64_tr_b16 a[248:249], v22 offset:57344
    ds_read_b64_tr_b16 a[250:251], v22 offset:61440
    v_mfma_f32_16x16x32_bf16 v[132:135], a[196:199], v[232:235], v[132:135]
    v_mfma_f32_16x16x32_bf16 v[128:131], a[192:195], v[232:235], v[128:131]
    s_waitcnt vmcnt(30)
    ds_read_b64_tr_b16 a[252:253], v23 offset:57344
    ds_read_b64_tr_b16 a[254:255], v23 offset:61440
    v_mfma_f32_16x16x32_bf16 v[160:163], a[192:195], v[236:239], v[160:163]
    buffer_load_dwordx4 a[60:63], v36, s[20:23], s61 offen offset:3072 sc1
    v_mfma_f32_16x16x32_bf16 v[164:167], a[196:199], v[236:239], v[164:167]
    v_mfma_f32_16x16x32_bf16 v[168:171], a[200:203], v[236:239], v[168:171]
    v_mfma_f32_16x16x32_bf16 v[172:175], a[204:207], v[236:239], v[172:175]
    s_bfe_u32 s61, s40, 0x4001c
    v_mfma_f32_16x16x32_bf16 v[176:179], a[208:211], v[236:239], v[176:179]
    s_lshl_b32 s61, s61, 12
    buffer_load_dwordx4 a[64:67], v36, s[20:23], s61 offen offset:0 sc1
    v_mfma_f32_16x16x32_bf16 v[180:183], a[212:215], v[236:239], v[180:183]
    v_mfma_f32_16x16x32_bf16 v[184:187], a[216:219], v[236:239], v[184:187]
    v_mfma_f32_16x16x32_bf16 v[188:191], a[220:223], v[236:239], v[188:191]
    s_waitcnt lgkmcnt(0) vmcnt(31)
    buffer_load_dwordx4 a[68:71], v36, s[20:23], s61 offen offset:1024 sc1
    v_mfma_f32_16x16x32_bf16 v[96:99], a[224:227], v[244:247], v[96:99]
    v_mfma_f32_16x16x32_bf16 v[100:103], a[228:231], v[244:247], v[100:103]
    ds_read_b64_tr_b16 a[192:193], v44 offset:0
    ds_read_b64_tr_b16 a[194:195], v44 offset:4096
    v_mfma_f32_16x16x32_bf16 v[104:107], a[232:235], v[244:247], v[104:107]
    buffer_load_dwordx4 a[72:75], v36, s[20:23], s61 offen offset:2048 sc1
    v_mfma_f32_16x16x32_bf16 v[108:111], a[236:239], v[244:247], v[108:111]
    ds_read_b64_tr_b16 a[196:197], v45 offset:0
    ds_read_b64_tr_b16 a[198:199], v45 offset:4096
    v_mfma_f32_16x16x32_bf16 v[112:115], a[240:243], v[244:247], v[112:115]
    v_mfma_f32_16x16x32_bf16 v[116:119], a[244:247], v[244:247], v[116:119]
    ds_read_b64_tr_b16 a[200:201], v46 offset:0
    ds_read_b64_tr_b16 a[202:203], v46 offset:4096
    v_mfma_f32_16x16x32_bf16 v[120:123], a[248:251], v[244:247], v[120:123]
    buffer_load_dwordx4 a[76:79], v36, s[20:23], s61 offen offset:3072 sc1
    v_mfma_f32_16x16x32_bf16 v[124:127], a[252:255], v[244:247], v[124:127]
    s_waitcnt vmcnt(33)
    ds_read_b64_tr_b16 a[204:205], v47 offset:0
    ds_read_b64_tr_b16 a[206:207], v47 offset:4096
    v_mfma_f32_16x16x32_bf16 v[156:159], a[252:255], v[248:251], v[156:159]
    v_mfma_f32_16x16x32_bf16 v[152:155], a[248:251], v[248:251], v[152:155]
    ds_read_b64_tr_b16 a[208:209], v48 offset:0
    ds_read_b64_tr_b16 a[210:211], v48 offset:4096
    v_mfma_f32_16x16x32_bf16 v[148:151], a[244:247], v[248:251], v[148:151]
    v_mfma_f32_16x16x32_bf16 v[144:147], a[240:243], v[248:251], v[144:147]
    ds_read_b64_tr_b16 a[212:213], v49 offset:0
    ds_read_b64_tr_b16 a[214:215], v49 offset:4096
    v_mfma_f32_16x16x32_bf16 v[140:143], a[236:239], v[248:251], v[140:143]
    v_mfma_f32_16x16x32_bf16 v[136:139], a[232:235], v[248:251], v[136:139]
    ds_read_b64_tr_b16 a[216:217], v50 offset:0
    ds_read_b64_tr_b16 a[218:219], v50 offset:4096
    v_mfma_f32_16x16x32_bf16 v[132:135], a[228:231], v[248:251], v[132:135]
    v_mfma_f32_16x16x32_bf16 v[128:131], a[224:227], v[248:251], v[128:131]
    s_waitcnt vmcnt(32)
    ds_read_b64_tr_b16 a[220:221], v51 offset:0
    ds_read_b64_tr_b16 a[222:223], v51 offset:4096
    v_mfma_f32_16x16x32_bf16 v[160:163], a[224:227], v[252:255], v[160:163]
    v_mfma_f32_16x16x32_bf16 v[164:167], a[228:231], v[252:255], v[164:167]
    v_mfma_f32_16x16x32_bf16 v[168:171], a[232:235], v[252:255], v[168:171]
    v_mfma_f32_16x16x32_bf16 v[172:175], a[236:239], v[252:255], v[172:175]
    v_mfma_f32_16x16x32_bf16 v[176:179], a[240:243], v[252:255], v[176:179]
    v_mfma_f32_16x16x32_bf16 v[180:183], a[244:247], v[252:255], v[180:183]
    v_mfma_f32_16x16x32_bf16 v[184:187], a[248:251], v[252:255], v[184:187]
    v_mfma_f32_16x16x32_bf16 v[188:191], a[252:255], v[252:255], v[188:191]
    s_waitcnt lgkmcnt(0) vmcnt(31)
    v_mfma_f32_16x16x32_bf16 v[96:99], a[192:195], a[132:135], v[96:99]
    buffer_load_dwordx2 v[224:225], v43, s[4:7], 0 offen offset:0
    v_mfma_f32_16x16x32_bf16 v[100:103], a[196:199], a[132:135], v[100:103]
    ds_read_b64_tr_b16 a[224:225], v44 offset:8192
    ds_read_b64_tr_b16 a[226:227], v44 offset:12288
    v_mfma_f32_16x16x32_bf16 v[104:107], a[200:203], a[132:135], v[104:107]
    buffer_load_dwordx2 v[226:227], v43, s[4:7], 0 offen offset:32
    v_mfma_f32_16x16x32_bf16 v[108:111], a[204:207], a[132:135], v[108:111]
    ds_read_b64_tr_b16 a[228:229], v45 offset:8192
    ds_read_b64_tr_b16 a[230:231], v45 offset:12288
    v_mfma_f32_16x16x32_bf16 v[112:115], a[208:211], a[132:135], v[112:115]
    buffer_load_dwordx2 v[228:229], v43, s[4:7], 0 offen offset:64
    v_mfma_f32_16x16x32_bf16 v[116:119], a[212:215], a[132:135], v[116:119]
    ds_read_b64_tr_b16 a[232:233], v46 offset:8192
    ds_read_b64_tr_b16 a[234:235], v46 offset:12288
    v_mfma_f32_16x16x32_bf16 v[120:123], a[216:219], a[132:135], v[120:123]
    buffer_load_dwordx2 v[230:231], v43, s[4:7], 0 offen offset:96
    v_mfma_f32_16x16x32_bf16 v[124:127], a[220:223], a[132:135], v[124:127]
    s_waitcnt vmcnt(34)
    ds_read_b64_tr_b16 a[236:237], v47 offset:8192
    ds_read_b64_tr_b16 a[238:239], v47 offset:12288
    v_mfma_f32_16x16x32_bf16 v[156:159], a[220:223], a[136:139], v[156:159]
    buffer_load_dwordx2 v[232:233], v43, s[4:7], 0 offen offset:128
    v_mfma_f32_16x16x32_bf16 v[152:155], a[216:219], a[136:139], v[152:155]
    ds_read_b64_tr_b16 a[240:241], v48 offset:8192
    ds_read_b64_tr_b16 a[242:243], v48 offset:12288
    v_mfma_f32_16x16x32_bf16 v[148:151], a[212:215], a[136:139], v[148:151]
    buffer_load_dwordx2 v[234:235], v43, s[4:7], 0 offen offset:160
    v_mfma_f32_16x16x32_bf16 v[144:147], a[208:211], a[136:139], v[144:147]
    ds_read_b64_tr_b16 a[244:245], v49 offset:8192
    ds_read_b64_tr_b16 a[246:247], v49 offset:12288
    v_mfma_f32_16x16x32_bf16 v[140:143], a[204:207], a[136:139], v[140:143]
    buffer_load_dwordx2 v[236:237], v43, s[4:7], 0 offen offset:192
    v_mfma_f32_16x16x32_bf16 v[136:139], a[200:203], a[136:139], v[136:139]
    ds_read_b64_tr_b16 a[248:249], v50 offset:8192
    ds_read_b64_tr_b16 a[250:251], v50 offset:12288
    v_mfma_f32_16x16x32_bf16 v[132:135], a[196:199], a[136:139], v[132:135]
    buffer_load_dwordx2 v[238:239], v43, s[4:7], 0 offen offset:224
    v_mfma_f32_16x16x32_bf16 v[128:131], a[192:195], a[136:139], v[128:131]
    s_waitcnt vmcnt(37)
    ds_read_b64_tr_b16 a[252:253], v51 offset:8192
    ds_read_b64_tr_b16 a[254:255], v51 offset:12288
    v_mfma_f32_16x16x32_bf16 v[160:163], a[192:195], a[140:143], v[160:163]
    v_mfma_f32_16x16x32_bf16 v[164:167], a[196:199], a[140:143], v[164:167]
    v_mfma_f32_16x16x32_bf16 v[168:171], a[200:203], a[140:143], v[168:171]
    v_mfma_f32_16x16x32_bf16 v[172:175], a[204:207], a[140:143], v[172:175]
    v_mfma_f32_16x16x32_bf16 v[176:179], a[208:211], a[140:143], v[176:179]
    v_mfma_f32_16x16x32_bf16 v[180:183], a[212:215], a[140:143], v[180:183]
    v_mfma_f32_16x16x32_bf16 v[184:187], a[216:219], a[140:143], v[184:187]
    v_mfma_f32_16x16x32_bf16 v[188:191], a[220:223], a[140:143], v[188:191]
    s_waitcnt lgkmcnt(0) vmcnt(36)
    v_mfma_f32_16x16x32_bf16 v[96:99], a[224:227], a[148:151], v[96:99]
    v_mfma_f32_16x16x32_bf16 v[100:103], a[228:231], a[148:151], v[100:103]
    ds_read_b64_tr_b16 a[192:193], v44 offset:16384
    ds_read_b64_tr_b16 a[194:195], v44 offset:20480
    v_mfma_f32_16x16x32_bf16 v[104:107], a[232:235], a[148:151], v[104:107]
    v_mfma_f32_16x16x32_bf16 v[108:111], a[236:239], a[148:151], v[108:111]
    ds_read_b64_tr_b16 a[196:197], v45 offset:16384
    ds_read_b64_tr_b16 a[198:199], v45 offset:20480
    v_mfma_f32_16x16x32_bf16 v[112:115], a[240:243], a[148:151], v[112:115]
    v_mfma_f32_16x16x32_bf16 v[116:119], a[244:247], a[148:151], v[116:119]
    ds_read_b64_tr_b16 a[200:201], v46 offset:16384
    ds_read_b64_tr_b16 a[202:203], v46 offset:20480
    v_mfma_f32_16x16x32_bf16 v[120:123], a[248:251], a[148:151], v[120:123]
    v_mfma_f32_16x16x32_bf16 v[124:127], a[252:255], a[148:151], v[124:127]
    s_waitcnt vmcnt(35)
    ds_read_b64_tr_b16 a[204:205], v47 offset:16384
    ds_read_b64_tr_b16 a[206:207], v47 offset:20480
    v_mfma_f32_16x16x32_bf16 v[156:159], a[252:255], a[152:155], v[156:159]
    v_mfma_f32_16x16x32_bf16 v[152:155], a[248:251], a[152:155], v[152:155]
    ds_read_b64_tr_b16 a[208:209], v48 offset:16384
    ds_read_b64_tr_b16 a[210:211], v48 offset:20480
    v_mfma_f32_16x16x32_bf16 v[148:151], a[244:247], a[152:155], v[148:151]
    v_mfma_f32_16x16x32_bf16 v[144:147], a[240:243], a[152:155], v[144:147]
    ds_read_b64_tr_b16 a[212:213], v49 offset:16384
    ds_read_b64_tr_b16 a[214:215], v49 offset:20480
    v_mfma_f32_16x16x32_bf16 v[140:143], a[236:239], a[152:155], v[140:143]
    v_mfma_f32_16x16x32_bf16 v[136:139], a[232:235], a[152:155], v[136:139]
    ds_read_b64_tr_b16 a[216:217], v50 offset:16384
    ds_read_b64_tr_b16 a[218:219], v50 offset:20480
    v_mfma_f32_16x16x32_bf16 v[132:135], a[228:231], a[152:155], v[132:135]
    v_mfma_f32_16x16x32_bf16 v[128:131], a[224:227], a[152:155], v[128:131]
    s_waitcnt vmcnt(34)
    ds_read_b64_tr_b16 a[220:221], v51 offset:16384
    ds_read_b64_tr_b16 a[222:223], v51 offset:20480
    v_mfma_f32_16x16x32_bf16 v[160:163], a[224:227], a[156:159], v[160:163]
    v_mfma_f32_16x16x32_bf16 v[164:167], a[228:231], a[156:159], v[164:167]
    v_mfma_f32_16x16x32_bf16 v[168:171], a[232:235], a[156:159], v[168:171]
    v_mfma_f32_16x16x32_bf16 v[172:175], a[236:239], a[156:159], v[172:175]
    v_mfma_f32_16x16x32_bf16 v[176:179], a[240:243], a[156:159], v[176:179]
    v_mfma_f32_16x16x32_bf16 v[180:183], a[244:247], a[156:159], v[180:183]
    v_mfma_f32_16x16x32_bf16 v[184:187], a[248:251], a[156:159], v[184:187]
    v_mfma_f32_16x16x32_bf16 v[188:191], a[252:255], a[156:159], v[188:191]
    s_waitcnt lgkmcnt(0) vmcnt(33)
    v_mfma_f32_16x16x32_bf16 v[96:99], a[192:195], a[164:167], v[96:99]
    v_mfma_f32_16x16x32_bf16 v[100:103], a[196:199], a[164:167], v[100:103]
    ds_read_b64_tr_b16 a[224:225], v44 offset:24576
    ds_read_b64_tr_b16 a[226:227], v44 offset:28672
    v_mfma_f32_16x16x32_bf16 v[104:107], a[200:203], a[164:167], v[104:107]
    v_mfma_f32_16x16x32_bf16 v[108:111], a[204:207], a[164:167], v[108:111]
    ds_read_b64_tr_b16 a[228:229], v45 offset:24576
    ds_read_b64_tr_b16 a[230:231], v45 offset:28672
    v_mfma_f32_16x16x32_bf16 v[112:115], a[208:211], a[164:167], v[112:115]
    v_mfma_f32_16x16x32_bf16 v[116:119], a[212:215], a[164:167], v[116:119]
    ds_read_b64_tr_b16 a[232:233], v46 offset:24576
    ds_read_b64_tr_b16 a[234:235], v46 offset:28672
    v_mfma_f32_16x16x32_bf16 v[120:123], a[216:219], a[164:167], v[120:123]
    v_mfma_f32_16x16x32_bf16 v[124:127], a[220:223], a[164:167], v[124:127]
    s_waitcnt vmcnt(32)
    ds_read_b64_tr_b16 a[236:237], v47 offset:24576
    ds_read_b64_tr_b16 a[238:239], v47 offset:28672
    v_mfma_f32_16x16x32_bf16 v[156:159], a[220:223], a[168:171], v[156:159]
    v_mfma_f32_16x16x32_bf16 v[152:155], a[216:219], a[168:171], v[152:155]
    ds_read_b64_tr_b16 a[240:241], v48 offset:24576
    ds_read_b64_tr_b16 a[242:243], v48 offset:28672
    v_mfma_f32_16x16x32_bf16 v[148:151], a[212:215], a[168:171], v[148:151]
    v_mfma_f32_16x16x32_bf16 v[144:147], a[208:211], a[168:171], v[144:147]
    ds_read_b64_tr_b16 a[244:245], v49 offset:24576
    ds_read_b64_tr_b16 a[246:247], v49 offset:28672
    v_mfma_f32_16x16x32_bf16 v[140:143], a[204:207], a[168:171], v[140:143]
    v_mfma_f32_16x16x32_bf16 v[136:139], a[200:203], a[168:171], v[136:139]
    ds_read_b64_tr_b16 a[248:249], v50 offset:24576
    ds_read_b64_tr_b16 a[250:251], v50 offset:28672
    v_mfma_f32_16x16x32_bf16 v[132:135], a[196:199], a[168:171], v[132:135]
    v_mfma_f32_16x16x32_bf16 v[128:131], a[192:195], a[168:171], v[128:131]
    s_waitcnt vmcnt(31)
    ds_read_b64_tr_b16 a[252:253], v51 offset:24576
    ds_read_b64_tr_b16 a[254:255], v51 offset:28672
    v_mfma_f32_16x16x32_bf16 v[160:163], a[192:195], a[172:175], v[160:163]
    v_mfma_f32_16x16x32_bf16 v[164:167], a[196:199], a[172:175], v[164:167]
    v_mfma_f32_16x16x32_bf16 v[168:171], a[200:203], a[172:175], v[168:171]
    v_mfma_f32_16x16x32_bf16 v[172:175], a[204:207], a[172:175], v[172:175]
    v_mfma_f32_16x16x32_bf16 v[176:179], a[208:211], a[172:175], v[176:179]
    v_mfma_f32_16x16x32_bf16 v[180:183], a[212:215], a[172:175], v[180:183]
    v_mfma_f32_16x16x32_bf16 v[184:187], a[216:219], a[172:175], v[184:187]
    v_mfma_f32_16x16x32_bf16 v[188:191], a[220:223], a[172:175], v[188:191]
    s_waitcnt lgkmcnt(0) vmcnt(30)
    v_mfma_f32_16x16x32_bf16 v[96:99], a[224:227], a[180:183], v[96:99]
    v_mfma_f32_16x16x32_bf16 v[100:103], a[228:231], a[180:183], v[100:103]
    ds_read_b64_tr_b16 a[96:97], v44 offset:32768
    ds_read_b64_tr_b16 a[98:99], v44 offset:36864
    v_mfma_f32_16x16x32_bf16 v[104:107], a[232:235], a[180:183], v[104:107]
    ds_read_b64_tr_b16 a[100:101], v45 offset:32768
    ds_read_b64_tr_b16 a[102:103], v45 offset:36864
    v_mfma_f32_16x16x32_bf16 v[108:111], a[236:239], a[180:183], v[108:111]
    ds_read_b64_tr_b16 a[104:105], v46 offset:32768
    ds_read_b64_tr_b16 a[106:107], v46 offset:36864
    v_mfma_f32_16x16x32_bf16 v[112:115], a[240:243], a[180:183], v[112:115]
    ds_read_b64_tr_b16 a[108:109], v47 offset:32768
    ds_read_b64_tr_b16 a[110:111], v47 offset:36864
    v_mfma_f32_16x16x32_bf16 v[116:119], a[244:247], a[180:183], v[116:119]
    ds_read_b64_tr_b16 a[112:113], v48 offset:32768
    ds_read_b64_tr_b16 a[114:115], v48 offset:36864
    v_mfma_f32_16x16x32_bf16 v[120:123], a[248:251], a[180:183], v[120:123]
    ds_read_b64_tr_b16 a[116:117], v49 offset:32768
    ds_read_b64_tr_b16 a[118:119], v49 offset:36864
    v_mfma_f32_16x16x32_bf16 v[124:127], a[252:255], a[180:183], v[124:127]
    s_waitcnt vmcnt(29)
    ds_read_b64_tr_b16 a[120:121], v50 offset:32768
    ds_read_b64_tr_b16 a[122:123], v50 offset:36864
    v_mfma_f32_16x16x32_bf16 v[156:159], a[252:255], a[184:187], v[156:159]
    ds_read_b64_tr_b16 a[124:125], v51 offset:32768
    ds_read_b64_tr_b16 a[126:127], v51 offset:36864
    v_mfma_f32_16x16x32_bf16 v[152:155], a[248:251], a[184:187], v[152:155]
    ds_read_b64_tr_b16 a[192:193], v44 offset:40960
    ds_read_b64_tr_b16 a[194:195], v44 offset:45056
    v_mfma_f32_16x16x32_bf16 v[148:151], a[244:247], a[184:187], v[148:151]
    ds_read_b64_tr_b16 a[196:197], v45 offset:40960
    ds_read_b64_tr_b16 a[198:199], v45 offset:45056
    v_mfma_f32_16x16x32_bf16 v[144:147], a[240:243], a[184:187], v[144:147]
    ds_read_b64_tr_b16 a[200:201], v46 offset:40960
    ds_read_b64_tr_b16 a[202:203], v46 offset:45056
    v_mfma_f32_16x16x32_bf16 v[140:143], a[236:239], a[184:187], v[140:143]
    ds_read_b64_tr_b16 a[204:205], v47 offset:40960
    ds_read_b64_tr_b16 a[206:207], v47 offset:45056
    v_mfma_f32_16x16x32_bf16 v[136:139], a[232:235], a[184:187], v[136:139]
    ds_read_b64_tr_b16 a[208:209], v48 offset:40960
    ds_read_b64_tr_b16 a[210:211], v48 offset:45056
    v_mfma_f32_16x16x32_bf16 v[132:135], a[228:231], a[184:187], v[132:135]
    ds_read_b64_tr_b16 a[212:213], v49 offset:40960
    ds_read_b64_tr_b16 a[214:215], v49 offset:45056
    v_mfma_f32_16x16x32_bf16 v[128:131], a[224:227], a[184:187], v[128:131]
    s_waitcnt vmcnt(28)
    ds_read_b64_tr_b16 a[216:217], v50 offset:40960
    ds_read_b64_tr_b16 a[218:219], v50 offset:45056
    v_mfma_f32_16x16x32_bf16 v[160:163], a[224:227], a[188:191], v[160:163]
    ds_read_b64_tr_b16 a[220:221], v51 offset:40960
    ds_read_b64_tr_b16 a[222:223], v51 offset:45056
    v_mfma_f32_16x16x32_bf16 v[164:167], a[228:231], a[188:191], v[164:167]
    v_mfma_f32_16x16x32_bf16 v[168:171], a[232:235], a[188:191], v[168:171]
    v_mfma_f32_16x16x32_bf16 v[172:175], a[236:239], a[188:191], v[172:175]
    v_mfma_f32_16x16x32_bf16 v[176:179], a[240:243], a[188:191], v[176:179]
    v_mfma_f32_16x16x32_bf16 v[180:183], a[244:247], a[188:191], v[180:183]
    v_mfma_f32_16x16x32_bf16 v[184:187], a[248:251], a[188:191], v[184:187]
    v_mfma_f32_16x16x32_bf16 v[188:191], a[252:255], a[188:191], v[188:191]
    s_add_u32 s65, s63, 0
    v_cvt_pk_bf16_f32 v96, v96, v97
    v_cvt_pk_bf16_f32 v97, v98, v99
    v_cvt_pk_bf16_f32 v98, v100, v101
    v_cvt_pk_bf16_f32 v99, v102, v103
    v_cvt_pk_bf16_f32 v100, v104, v105
    v_cvt_pk_bf16_f32 v101, v106, v107
    v_cvt_pk_bf16_f32 v102, v108, v109
    v_cvt_pk_bf16_f32 v103, v110, v111
    buffer_store_dwordx4 v[96:99], v2, s[12:15], s65 offen offset:0 sc1
    v_cvt_pk_bf16_f32 v104, v112, v113
    v_cvt_pk_bf16_f32 v105, v114, v115
    v_cvt_pk_bf16_f32 v106, v116, v117
    v_cvt_pk_bf16_f32 v107, v118, v119
    buffer_store_dwordx4 v[100:103], v2, s[12:15], s65 offen offset:1024 sc1
    v_cvt_pk_bf16_f32 v108, v120, v121
    v_cvt_pk_bf16_f32 v109, v122, v123
    v_cvt_pk_bf16_f32 v110, v124, v125
    v_cvt_pk_bf16_f32 v111, v126, v127
    buffer_store_dwordx4 v[104:107], v2, s[12:15], s65 offen offset:2048 sc1
    buffer_store_dwordx4 v[108:111], v2, s[12:15], s65 offen offset:3072 sc1
    s_add_u32 s65, s63, 4096
    v_cvt_pk_bf16_f32 v128, v128, v129
    v_cvt_pk_bf16_f32 v129, v130, v131
    v_cvt_pk_bf16_f32 v130, v132, v133
    v_cvt_pk_bf16_f32 v131, v134, v135
    v_cvt_pk_bf16_f32 v132, v136, v137
    v_cvt_pk_bf16_f32 v133, v138, v139
    v_cvt_pk_bf16_f32 v134, v140, v141
    v_cvt_pk_bf16_f32 v135, v142, v143
    buffer_store_dwordx4 v[128:131], v2, s[12:15], s65 offen offset:0 sc1
    v_cvt_pk_bf16_f32 v136, v144, v145
    v_cvt_pk_bf16_f32 v137, v146, v147
    v_cvt_pk_bf16_f32 v138, v148, v149
    v_cvt_pk_bf16_f32 v139, v150, v151
    buffer_store_dwordx4 v[132:135], v2, s[12:15], s65 offen offset:1024 sc1
    v_cvt_pk_bf16_f32 v140, v152, v153
    v_cvt_pk_bf16_f32 v141, v154, v155
    v_cvt_pk_bf16_f32 v142, v156, v157
    v_cvt_pk_bf16_f32 v143, v158, v159
    buffer_store_dwordx4 v[136:139], v2, s[12:15], s65 offen offset:2048 sc1
    buffer_store_dwordx4 v[140:143], v2, s[12:15], s65 offen offset:3072 sc1
    s_add_u32 s65, s63, 8192
    v_cvt_pk_bf16_f32 v160, v160, v161
    v_cvt_pk_bf16_f32 v161, v162, v163
    v_cvt_pk_bf16_f32 v162, v164, v165
    v_cvt_pk_bf16_f32 v163, v166, v167
    v_cvt_pk_bf16_f32 v164, v168, v169
    v_cvt_pk_bf16_f32 v165, v170, v171
    v_cvt_pk_bf16_f32 v166, v172, v173
    v_cvt_pk_bf16_f32 v167, v174, v175
    buffer_store_dwordx4 v[160:163], v2, s[12:15], s65 offen offset:0 sc1
    v_cvt_pk_bf16_f32 v168, v176, v177
    v_cvt_pk_bf16_f32 v169, v178, v179
    v_cvt_pk_bf16_f32 v170, v180, v181
    v_cvt_pk_bf16_f32 v171, v182, v183
    buffer_store_dwordx4 v[164:167], v2, s[12:15], s65 offen offset:1024 sc1
    v_cvt_pk_bf16_f32 v172, v184, v185
    v_cvt_pk_bf16_f32 v173, v186, v187
    v_cvt_pk_bf16_f32 v174, v188, v189
    v_cvt_pk_bf16_f32 v175, v190, v191
    buffer_store_dwordx4 v[168:171], v2, s[12:15], s65 offen offset:2048 sc1
    buffer_store_dwordx4 v[172:175], v2, s[12:15], s65 offen offset:3072 sc1
    s_waitcnt vmcnt(39) lgkmcnt(15)
    v_mfma_f32_16x16x32_bf16 v[64:67], a[96:99], a[0:3], v[64:67]
    s_waitcnt lgkmcnt(15)
    ds_read_b64_tr_b16 a[224:225], v44 offset:49152
    ds_read_b64_tr_b16 a[226:227], v44 offset:53248
    v_mfma_f32_16x16x32_bf16 v[68:71], a[100:103], a[0:3], v[68:71]
    ds_read_b64_tr_b16 a[228:229], v45 offset:49152
    ds_read_b64_tr_b16 a[230:231], v45 offset:53248
    v_mfma_f32_16x16x32_bf16 v[72:75], a[104:107], a[0:3], v[72:75]
    ds_read_b64_tr_b16 a[232:233], v46 offset:49152
    ds_read_b64_tr_b16 a[234:235], v46 offset:53248
    v_mfma_f32_16x16x32_bf16 v[76:79], a[108:111], a[0:3], v[76:79]
    ds_read_b64_tr_b16 a[236:237], v47 offset:49152
    ds_read_b64_tr_b16 a[238:239], v47 offset:53248
    v_mfma_f32_16x16x32_bf16 v[80:83], a[112:115], a[0:3], v[80:83]
    ds_read_b64_tr_b16 a[240:241], v48 offset:49152
    ds_read_b64_tr_b16 a[242:243], v48 offset:53248
    v_mfma_f32_16x16x32_bf16 v[84:87], a[116:119], a[0:3], v[84:87]
    ds_read_b64_tr_b16 a[244:245], v49 offset:49152
    ds_read_b64_tr_b16 a[246:247], v49 offset:53248
    v_mfma_f32_16x16x32_bf16 v[88:91], a[120:123], a[0:3], v[88:91]
    ds_read_b64_tr_b16 a[248:249], v50 offset:49152
    ds_read_b64_tr_b16 a[250:251], v50 offset:53248
    v_mfma_f32_16x16x32_bf16 v[92:95], a[124:127], a[0:3], v[92:95]
    s_waitcnt lgkmcnt(12) vmcnt(38)
    ds_read_b64_tr_b16 a[252:253], v51 offset:49152
    ds_read_b64_tr_b16 a[254:255], v51 offset:53248
    v_mfma_f32_16x16x32_bf16 v[64:67], a[192:195], a[4:7], v[64:67]
    ds_read_b64_tr_b16 a[96:97], v44 offset:57344
    ds_read_b64_tr_b16 a[98:99], v44 offset:61440
    v_mfma_f32_16x16x32_bf16 v[68:71], a[196:199], a[4:7], v[68:71]
    ds_read_b64_tr_b16 a[100:101], v45 offset:57344
    ds_read_b64_tr_b16 a[102:103], v45 offset:61440
    v_mfma_f32_16x16x32_bf16 v[72:75], a[200:203], a[4:7], v[72:75]
    ds_read_b64_tr_b16 a[104:105], v46 offset:57344
    ds_read_b64_tr_b16 a[106:107], v46 offset:61440
    v_mfma_f32_16x16x32_bf16 v[76:79], a[204:207], a[4:7], v[76:79]
    ds_read_b64_tr_b16 a[108:109], v47 offset:57344
    ds_read_b64_tr_b16 a[110:111], v47 offset:61440
    v_mfma_f32_16x16x32_bf16 v[80:83], a[208:211], a[4:7], v[80:83]
    ds_read_b64_tr_b16 a[112:113], v48 offset:57344
    ds_read_b64_tr_b16 a[114:115], v48 offset:61440
    v_mfma_f32_16x16x32_bf16 v[84:87], a[212:215], a[4:7], v[84:87]
    ds_read_b64_tr_b16 a[116:117], v49 offset:57344
    ds_read_b64_tr_b16 a[118:119], v49 offset:61440
    v_mfma_f32_16x16x32_bf16 v[88:91], a[216:219], a[4:7], v[88:91]
    ds_read_b64_tr_b16 a[120:121], v50 offset:57344
    ds_read_b64_tr_b16 a[122:123], v50 offset:61440
    v_mfma_f32_16x16x32_bf16 v[92:95], a[220:223], a[4:7], v[92:95]
    s_waitcnt vmcnt(37)
    ds_read_b64_tr_b16 a[124:125], v51 offset:57344
    ds_read_b64_tr_b16 a[126:127], v51 offset:61440
    v_mfma_f32_16x16x32_bf16 v[64:67], a[224:227], a[8:11], v[64:67]
    s_waitcnt lgkmcnt(12)
    ds_read_b64_tr_b16 a[192:193], v16 offset:0
    ds_read_b64_tr_b16 a[194:195], v16 offset:4096
    v_mfma_f32_16x16x32_bf16 v[68:71], a[228:231], a[8:11], v[68:71]
    ds_read_b64_tr_b16 a[196:197], v17 offset:0
    ds_read_b64_tr_b16 a[198:199], v17 offset:4096
    v_mfma_f32_16x16x32_bf16 v[72:75], a[232:235], a[8:11], v[72:75]
    ds_read_b64_tr_b16 a[200:201], v18 offset:0
    ds_read_b64_tr_b16 a[202:203], v18 offset:4096
    v_mfma_f32_16x16x32_bf16 v[76:79], a[236:239], a[8:11], v[76:79]
    ds_read_b64_tr_b16 a[204:205], v19 offset:0
    ds_read_b64_tr_b16 a[206:207], v19 offset:4096
    v_mfma_f32_16x16x32_bf16 v[80:83], a[240:243], a[8:11], v[80:83]
    ds_read_b64_tr_b16 a[208:209], v20 offset:0
    ds_read_b64_tr_b16 a[210:211], v20 offset:4096
    v_mfma_f32_16x16x32_bf16 v[84:87], a[244:247], a[8:11], v[84:87]
    ds_read_b64_tr_b16 a[212:213], v21 offset:0
    ds_read_b64_tr_b16 a[214:215], v21 offset:4096
    v_mfma_f32_16x16x32_bf16 v[88:91], a[248:251], a[8:11], v[88:91]
    ds_read_b64_tr_b16 a[216:217], v22 offset:0
    ds_read_b64_tr_b16 a[218:219], v22 offset:4096
    v_mfma_f32_16x16x32_bf16 v[92:95], a[252:255], a[8:11], v[92:95]
    s_waitcnt vmcnt(36)
    ds_read_b64_tr_b16 a[220:221], v23 offset:0
    ds_read_b64_tr_b16 a[222:223], v23 offset:4096
    v_mfma_f32_16x16x32_bf16 v[64:67], a[96:99], a[12:15], v[64:67]
    ds_read_b64_tr_b16 a[224:225], v16 offset:8192
    ds_read_b64_tr_b16 a[226:227], v16 offset:12288
    v_mfma_f32_16x16x32_bf16 v[68:71], a[100:103], a[12:15], v[68:71]
    s_waitcnt lgkmcnt(12)
    ds_read_b64_tr_b16 a[228:229], v17 offset:8192
    ds_read_b64_tr_b16 a[230:231], v17 offset:12288
    v_mfma_f32_16x16x32_bf16 v[72:75], a[104:107], a[12:15], v[72:75]
    ds_read_b64_tr_b16 a[232:233], v18 offset:8192
    ds_read_b64_tr_b16 a[234:235], v18 offset:12288
    v_mfma_f32_16x16x32_bf16 v[76:79], a[108:111], a[12:15], v[76:79]
    ds_read_b64_tr_b16 a[236:237], v19 offset:8192
    ds_read_b64_tr_b16 a[238:239], v19 offset:12288
    v_mfma_f32_16x16x32_bf16 v[80:83], a[112:115], a[12:15], v[80:83]
    ds_read_b64_tr_b16 a[240:241], v20 offset:8192
    ds_read_b64_tr_b16 a[242:243], v20 offset:12288
    v_mfma_f32_16x16x32_bf16 v[84:87], a[116:119], a[12:15], v[84:87]
    ds_read_b64_tr_b16 a[244:245], v21 offset:8192
    ds_read_b64_tr_b16 a[246:247], v21 offset:12288
    v_mfma_f32_16x16x32_bf16 v[88:91], a[120:123], a[12:15], v[88:91]
    ds_read_b64_tr_b16 a[248:249], v22 offset:8192
    ds_read_b64_tr_b16 a[250:251], v22 offset:12288
    v_mfma_f32_16x16x32_bf16 v[92:95], a[124:127], a[12:15], v[92:95]
    s_waitcnt vmcnt(35)
    ds_read_b64_tr_b16 a[252:253], v23 offset:8192
    ds_read_b64_tr_b16 a[254:255], v23 offset:12288
    v_mfma_f32_16x16x32_bf16 v[64:67], a[192:195], a[16:19], v[64:67]
    ds_read_b64_tr_b16 a[96:97], v16 offset:16384
    ds_read_b64_tr_b16 a[98:99], v16 offset:20480
    v_mfma_f32_16x16x32_bf16 v[68:71], a[196:199], a[16:19], v[68:71]
    ds_read_b64_tr_b16 a[100:101], v17 offset:16384
    ds_read_b64_tr_b16 a[102:103], v17 offset:20480
    v_mfma_f32_16x16x32_bf16 v[72:75], a[200:203], a[16:19], v[72:75]
    s_waitcnt lgkmcnt(12)
    ds_read_b64_tr_b16 a[104:105], v18 offset:16384
    ds_read_b64_tr_b16 a[106:107], v18 offset:20480
    v_mfma_f32_16x16x32_bf16 v[76:79], a[204:207], a[16:19], v[76:79]
    ds_read_b64_tr_b16 a[108:109], v19 offset:16384
    ds_read_b64_tr_b16 a[110:111], v19 offset:20480
    v_mfma_f32_16x16x32_bf16 v[80:83], a[208:211], a[16:19], v[80:83]
    ds_read_b64_tr_b16 a[112:113], v20 offset:16384
    ds_read_b64_tr_b16 a[114:115], v20 offset:20480
    v_mfma_f32_16x16x32_bf16 v[84:87], a[212:215], a[16:19], v[84:87]
    ds_read_b64_tr_b16 a[116:117], v21 offset:16384
    ds_read_b64_tr_b16 a[118:119], v21 offset:20480
    v_mfma_f32_16x16x32_bf16 v[88:91], a[216:219], a[16:19], v[88:91]
    ds_read_b64_tr_b16 a[120:121], v22 offset:16384
    ds_read_b64_tr_b16 a[122:123], v22 offset:20480
    v_mfma_f32_16x16x32_bf16 v[92:95], a[220:223], a[16:19], v[92:95]
    s_waitcnt vmcnt(34)
    ds_read_b64_tr_b16 a[124:125], v23 offset:16384
    ds_read_b64_tr_b16 a[126:127], v23 offset:20480
    v_mfma_f32_16x16x32_bf16 v[64:67], a[224:227], a[20:23], v[64:67]
    ds_read_b64_tr_b16 a[192:193], v16 offset:24576
    ds_read_b64_tr_b16 a[194:195], v16 offset:28672
    v_mfma_f32_16x16x32_bf16 v[68:71], a[228:231], a[20:23], v[68:71]
    ds_read_b64_tr_b16 a[196:197], v17 offset:24576
    ds_read_b64_tr_b16 a[198:199], v17 offset:28672
    v_mfma_f32_16x16x32_bf16 v[72:75], a[232:235], a[20:23], v[72:75]
    ds_read_b64_tr_b16 a[200:201], v18 offset:24576
    ds_read_b64_tr_b16 a[202:203], v18 offset:28672
    v_mfma_f32_16x16x32_bf16 v[76:79], a[236:239], a[20:23], v[76:79]
    s_waitcnt lgkmcnt(12)
    ds_read_b64_tr_b16 a[204:205], v19 offset:24576
    ds_read_b64_tr_b16 a[206:207], v19 offset:28672
    v_mfma_f32_16x16x32_bf16 v[80:83], a[240:243], a[20:23], v[80:83]
    ds_read_b64_tr_b16 a[208:209], v20 offset:24576
    ds_read_b64_tr_b16 a[210:211], v20 offset:28672
    v_mfma_f32_16x16x32_bf16 v[84:87], a[244:247], a[20:23], v[84:87]
    ds_read_b64_tr_b16 a[212:213], v21 offset:24576
    ds_read_b64_tr_b16 a[214:215], v21 offset:28672
    v_mfma_f32_16x16x32_bf16 v[88:91], a[248:251], a[20:23], v[88:91]
    ds_read_b64_tr_b16 a[216:217], v22 offset:24576
    ds_read_b64_tr_b16 a[218:219], v22 offset:28672
    v_mfma_f32_16x16x32_bf16 v[92:95], a[252:255], a[20:23], v[92:95]
    s_waitcnt vmcnt(33)
    ds_read_b64_tr_b16 a[220:221], v23 offset:24576
    ds_read_b64_tr_b16 a[222:223], v23 offset:28672
    v_mfma_f32_16x16x32_bf16 v[64:67], a[96:99], a[24:27], v[64:67]
    ds_read_b64_tr_b16 a[224:225], v8 offset:0
    ds_read_b64_tr_b16 a[226:227], v8 offset:4096
    v_mfma_f32_16x16x32_bf16 v[68:71], a[100:103], a[24:27], v[68:71]
    ds_read_b64_tr_b16 a[228:229], v9 offset:0
    ds_read_b64_tr_b16 a[230:231], v9 offset:4096
    v_mfma_f32_16x16x32_bf16 v[72:75], a[104:107], a[24:27], v[72:75]
    ds_read_b64_tr_b16 a[232:233], v10 offset:0
    ds_read_b64_tr_b16 a[234:235], v10 offset:4096
    v_mfma_f32_16x16x32_bf16 v[76:79], a[108:111], a[24:27], v[76:79]
    ds_read_b64_tr_b16 a[236:237], v11 offset:0
    ds_read_b64_tr_b16 a[238:239], v11 offset:4096
    v_mfma_f32_16x16x32_bf16 v[80:83], a[112:115], a[24:27], v[80:83]
    s_waitcnt lgkmcnt(12)
    ds_read_b64_tr_b16 a[240:241], v12 offset:0
    ds_read_b64_tr_b16 a[242:243], v12 offset:4096
    v_mfma_f32_16x16x32_bf16 v[84:87], a[116:119], a[24:27], v[84:87]
    ds_read_b64_tr_b16 a[244:245], v13 offset:0
    ds_read_b64_tr_b16 a[246:247], v13 offset:4096
    v_mfma_f32_16x16x32_bf16 v[88:91], a[120:123], a[24:27], v[88:91]
    ds_read_b64_tr_b16 a[248:249], v14 offset:0
    ds_read_b64_tr_b16 a[250:251], v14 offset:4096
    v_mfma_f32_16x16x32_bf16 v[92:95], a[124:127], a[24:27], v[92:95]
    s_waitcnt vmcnt(32)
    ds_read_b64_tr_b16 a[252:253], v15 offset:0
    ds_read_b64_tr_b16 a[254:255], v15 offset:4096
    v_mfma_f32_16x16x32_bf16 v[64:67], a[192:195], a[28:31], v[64:67]
    ds_read_b64_tr_b16 a[96:97], v8 offset:8192
    ds_read_b64_tr_b16 a[98:99], v8 offset:12288
    v_mfma_f32_16x16x32_bf16 v[68:71], a[196:199], a[28:31], v[68:71]
    ds_read_b64_tr_b16 a[100:101], v9 offset:8192
    ds_read_b64_tr_b16 a[102:103], v9 offset:12288
    v_mfma_f32_16x16x32_bf16 v[72:75], a[200:203], a[28:31], v[72:75]
    ds_read_b64_tr_b16 a[104:105], v10 offset:8192
    ds_read_b64_tr_b16 a[106:107], v10 offset:12288
    v_mfma_f32_16x16x32_bf16 v[76:79], a[204:207], a[28:31], v[76:79]
    ds_read_b64_tr_b16 a[108:109], v11 offset:8192
    ds_read_b64_tr_b16 a[110:111], v11 offset:12288
    v_mfma_f32_16x16x32_bf16 v[80:83], a[208:211], a[28:31], v[80:83]
    ds_read_b64_tr_b16 a[112:113], v12 offset:8192
    ds_read_b64_tr_b16 a[114:115], v12 offset:12288
    buffer_load_dword v34, v33, s[88:91], 0 offen sc1
    v_mfma_f32_16x16x32_bf16 v[84:87], a[212:215], a[28:31], v[84:87]
    s_waitcnt lgkmcnt(12)
    ds_read_b64_tr_b16 a[116:117], v13 offset:8192
    ds_read_b64_tr_b16 a[118:119], v13 offset:12288
    v_mfma_f32_16x16x32_bf16 v[88:91], a[216:219], a[28:31], v[88:91]
    ds_read_b64_tr_b16 a[120:121], v14 offset:8192
    ds_read_b64_tr_b16 a[122:123], v14 offset:12288
    v_mfma_f32_16x16x32_bf16 v[92:95], a[220:223], a[28:31], v[92:95]
    s_waitcnt vmcnt(32)
    ds_read_b64_tr_b16 a[124:125], v15 offset:8192
    ds_read_b64_tr_b16 a[126:127], v15 offset:12288
    v_mfma_f32_16x16x32_bf16 v[64:67], a[224:227], a[32:35], v[64:67]
    ds_read_b64_tr_b16 a[192:193], v8 offset:16384
    ds_read_b64_tr_b16 a[194:195], v8 offset:20480
    v_mfma_f32_16x16x32_bf16 v[68:71], a[228:231], a[32:35], v[68:71]
    ds_read_b64_tr_b16 a[196:197], v9 offset:16384
    ds_read_b64_tr_b16 a[198:199], v9 offset:20480
    v_mfma_f32_16x16x32_bf16 v[72:75], a[232:235], a[32:35], v[72:75]
    ds_read_b64_tr_b16 a[200:201], v10 offset:16384
    ds_read_b64_tr_b16 a[202:203], v10 offset:20480
    v_mfma_f32_16x16x32_bf16 v[76:79], a[236:239], a[32:35], v[76:79]
    ds_read_b64_tr_b16 a[204:205], v11 offset:16384
    ds_read_b64_tr_b16 a[206:207], v11 offset:20480
    v_mfma_f32_16x16x32_bf16 v[80:83], a[240:243], a[32:35], v[80:83]
    ds_read_b64_tr_b16 a[208:209], v12 offset:16384
    ds_read_b64_tr_b16 a[210:211], v12 offset:20480
    v_mfma_f32_16x16x32_bf16 v[84:87], a[244:247], a[32:35], v[84:87]
    ds_read_b64_tr_b16 a[212:213], v13 offset:16384
    ds_read_b64_tr_b16 a[214:215], v13 offset:20480
    v_mfma_f32_16x16x32_bf16 v[88:91], a[248:251], a[32:35], v[88:91]
    s_waitcnt lgkmcnt(12)
    ds_read_b64_tr_b16 a[216:217], v14 offset:16384
    ds_read_b64_tr_b16 a[218:219], v14 offset:20480
    v_mfma_f32_16x16x32_bf16 v[92:95], a[252:255], a[32:35], v[92:95]
    s_waitcnt vmcnt(31)
    ds_read_b64_tr_b16 a[220:221], v15 offset:16384
    ds_read_b64_tr_b16 a[222:223], v15 offset:20480
    v_mfma_f32_16x16x32_bf16 v[64:67], a[96:99], a[36:39], v[64:67]
    ds_read_b64_tr_b16 a[224:225], v8 offset:24576
    ds_read_b64_tr_b16 a[226:227], v8 offset:28672
    v_mfma_f32_16x16x32_bf16 v[68:71], a[100:103], a[36:39], v[68:71]
    ds_read_b64_tr_b16 a[228:229], v9 offset:24576
    ds_read_b64_tr_b16 a[230:231], v9 offset:28672
    v_mfma_f32_16x16x32_bf16 v[72:75], a[104:107], a[36:39], v[72:75]
    ds_read_b64_tr_b16 a[232:233], v10 offset:24576
    ds_read_b64_tr_b16 a[234:235], v10 offset:28672
    v_mfma_f32_16x16x32_bf16 v[76:79], a[108:111], a[36:39], v[76:79]
    ds_read_b64_tr_b16 a[236:237], v11 offset:24576
    ds_read_b64_tr_b16 a[238:239], v11 offset:28672
    v_mfma_f32_16x16x32_bf16 v[80:83], a[112:115], a[36:39], v[80:83]
    ds_read_b64_tr_b16 a[240:241], v12 offset:24576
    ds_read_b64_tr_b16 a[242:243], v12 offset:28672
    v_mfma_f32_16x16x32_bf16 v[84:87], a[116:119], a[36:39], v[84:87]
    ds_read_b64_tr_b16 a[244:245], v13 offset:24576
    ds_read_b64_tr_b16 a[246:247], v13 offset:28672
    v_mfma_f32_16x16x32_bf16 v[88:91], a[120:123], a[36:39], v[88:91]
    ds_read_b64_tr_b16 a[248:249], v14 offset:24576
    ds_read_b64_tr_b16 a[250:251], v14 offset:28672
    v_mfma_f32_16x16x32_bf16 v[92:95], a[124:127], a[36:39], v[92:95]
    s_waitcnt lgkmcnt(12) vmcnt(30)
    ds_read_b64_tr_b16 a[252:253], v15 offset:24576
    ds_read_b64_tr_b16 a[254:255], v15 offset:28672
    v_mfma_f32_16x16x32_bf16 v[64:67], a[192:195], a[40:43], v[64:67]
    ds_read_b64_tr_b16 a[96:97], v16 offset:32768
    ds_read_b64_tr_b16 a[98:99], v16 offset:36864
    v_mfma_f32_16x16x32_bf16 v[68:71], a[196:199], a[40:43], v[68:71]
    ds_read_b64_tr_b16 a[100:101], v17 offset:32768
    ds_read_b64_tr_b16 a[102:103], v17 offset:36864
    v_mfma_f32_16x16x32_bf16 v[72:75], a[200:203], a[40:43], v[72:75]
    ds_read_b64_tr_b16 a[104:105], v18 offset:32768
    ds_read_b64_tr_b16 a[106:107], v18 offset:36864
    v_mfma_f32_16x16x32_bf16 v[76:79], a[204:207], a[40:43], v[76:79]
    ds_read_b64_tr_b16 a[108:109], v19 offset:32768
    ds_read_b64_tr_b16 a[110:111], v19 offset:36864
    v_mfma_f32_16x16x32_bf16 v[80:83], a[208:211], a[40:43], v[80:83]
    ds_read_b64_tr_b16 a[112:113], v20 offset:32768
    ds_read_b64_tr_b16 a[114:115], v20 offset:36864
    v_mfma_f32_16x16x32_bf16 v[84:87], a[212:215], a[40:43], v[84:87]
    ds_read_b64_tr_b16 a[116:117], v21 offset:32768
    ds_read_b64_tr_b16 a[118:119], v21 offset:36864
    v_mfma_f32_16x16x32_bf16 v[88:91], a[216:219], a[40:43], v[88:91]
    ds_read_b64_tr_b16 a[120:121], v22 offset:32768
    ds_read_b64_tr_b16 a[122:123], v22 offset:36864
    v_mfma_f32_16x16x32_bf16 v[92:95], a[220:223], a[40:43], v[92:95]
    s_waitcnt vmcnt(29)
    ds_read_b64_tr_b16 a[124:125], v23 offset:32768
    ds_read_b64_tr_b16 a[126:127], v23 offset:36864
    v_mfma_f32_16x16x32_bf16 v[64:67], a[224:227], a[44:47], v[64:67]
    s_waitcnt lgkmcnt(12)
    ds_read_b64_tr_b16 a[192:193], v16 offset:40960
    ds_read_b64_tr_b16 a[194:195], v16 offset:45056
    v_mfma_f32_16x16x32_bf16 v[68:71], a[228:231], a[44:47], v[68:71]
    ds_read_b64_tr_b16 a[196:197], v17 offset:40960
    ds_read_b64_tr_b16 a[198:199], v17 offset:45056
    v_mfma_f32_16x16x32_bf16 v[72:75], a[232:235], a[44:47], v[72:75]
    ds_read_b64_tr_b16 a[200:201], v18 offset:40960
    ds_read_b64_tr_b16 a[202:203], v18 offset:45056
    v_mfma_f32_16x16x32_bf16 v[76:79], a[236:239], a[44:47], v[76:79]
    ds_read_b64_tr_b16 a[204:205], v19 offset:40960
    ds_read_b64_tr_b16 a[206:207], v19 offset:45056
    v_mfma_f32_16x16x32_bf16 v[80:83], a[240:243], a[44:47], v[80:83]
    ds_read_b64_tr_b16 a[208:209], v20 offset:40960
    ds_read_b64_tr_b16 a[210:211], v20 offset:45056
    v_mfma_f32_16x16x32_bf16 v[84:87], a[244:247], a[44:47], v[84:87]
    ds_read_b64_tr_b16 a[212:213], v21 offset:40960
    ds_read_b64_tr_b16 a[214:215], v21 offset:45056
    v_mfma_f32_16x16x32_bf16 v[88:91], a[248:251], a[44:47], v[88:91]
    ds_read_b64_tr_b16 a[216:217], v22 offset:40960
    ds_read_b64_tr_b16 a[218:219], v22 offset:45056
    v_mfma_f32_16x16x32_bf16 v[92:95], a[252:255], a[44:47], v[92:95]
    s_waitcnt vmcnt(28)
    ds_read_b64_tr_b16 a[220:221], v23 offset:40960
    ds_read_b64_tr_b16 a[222:223], v23 offset:45056
    v_mfma_f32_16x16x32_bf16 v[64:67], a[96:99], a[48:51], v[64:67]
    ds_read_b64_tr_b16 a[224:225], v16 offset:49152
    ds_read_b64_tr_b16 a[226:227], v16 offset:53248
    v_mfma_f32_16x16x32_bf16 v[68:71], a[100:103], a[48:51], v[68:71]
    s_waitcnt lgkmcnt(12)
    ds_read_b64_tr_b16 a[228:229], v17 offset:49152
    ds_read_b64_tr_b16 a[230:231], v17 offset:53248
    v_mfma_f32_16x16x32_bf16 v[72:75], a[104:107], a[48:51], v[72:75]
    ds_read_b64_tr_b16 a[232:233], v18 offset:49152
    ds_read_b64_tr_b16 a[234:235], v18 offset:53248
    v_mfma_f32_16x16x32_bf16 v[76:79], a[108:111], a[48:51], v[76:79]
    ds_read_b64_tr_b16 a[236:237], v19 offset:49152
    ds_read_b64_tr_b16 a[238:239], v19 offset:53248
    v_mfma_f32_16x16x32_bf16 v[80:83], a[112:115], a[48:51], v[80:83]
    ds_read_b64_tr_b16 a[240:241], v20 offset:49152
    ds_read_b64_tr_b16 a[242:243], v20 offset:53248
    v_mfma_f32_16x16x32_bf16 v[84:87], a[116:119], a[48:51], v[84:87]
    ds_read_b64_tr_b16 a[244:245], v21 offset:49152
    ds_read_b64_tr_b16 a[246:247], v21 offset:53248
    v_mfma_f32_16x16x32_bf16 v[88:91], a[120:123], a[48:51], v[88:91]
    ds_read_b64_tr_b16 a[248:249], v22 offset:49152
    ds_read_b64_tr_b16 a[250:251], v22 offset:53248
    v_mfma_f32_16x16x32_bf16 v[92:95], a[124:127], a[48:51], v[92:95]
    s_waitcnt vmcnt(27)
    ds_read_b64_tr_b16 a[252:253], v23 offset:49152
    ds_read_b64_tr_b16 a[254:255], v23 offset:53248
    v_mfma_f32_16x16x32_bf16 v[64:67], a[192:195], a[52:55], v[64:67]
    ds_read_b64_tr_b16 a[96:97], v16 offset:57344
    ds_read_b64_tr_b16 a[98:99], v16 offset:61440
    v_mfma_f32_16x16x32_bf16 v[68:71], a[196:199], a[52:55], v[68:71]
    ds_read_b64_tr_b16 a[100:101], v17 offset:57344
    ds_read_b64_tr_b16 a[102:103], v17 offset:61440
    v_mfma_f32_16x16x32_bf16 v[72:75], a[200:203], a[52:55], v[72:75]
    s_waitcnt lgkmcnt(12)
    ds_read_b64_tr_b16 a[104:105], v18 offset:57344
    ds_read_b64_tr_b16 a[106:107], v18 offset:61440
    v_mfma_f32_16x16x32_bf16 v[76:79], a[204:207], a[52:55], v[76:79]
    ds_read_b64_tr_b16 a[108:109], v19 offset:57344
    ds_read_b64_tr_b16 a[110:111], v19 offset:61440
    v_mfma_f32_16x16x32_bf16 v[80:83], a[208:211], a[52:55], v[80:83]
    ds_read_b64_tr_b16 a[112:113], v20 offset:57344
    ds_read_b64_tr_b16 a[114:115], v20 offset:61440
    v_mfma_f32_16x16x32_bf16 v[84:87], a[212:215], a[52:55], v[84:87]
    ds_read_b64_tr_b16 a[116:117], v21 offset:57344
    ds_read_b64_tr_b16 a[118:119], v21 offset:61440
    v_mfma_f32_16x16x32_bf16 v[88:91], a[216:219], a[52:55], v[88:91]
    ds_read_b64_tr_b16 a[120:121], v22 offset:57344
    ds_read_b64_tr_b16 a[122:123], v22 offset:61440
    v_mfma_f32_16x16x32_bf16 v[92:95], a[220:223], a[52:55], v[92:95]
    s_waitcnt vmcnt(26)
    ds_read_b64_tr_b16 a[124:125], v23 offset:57344
    ds_read_b64_tr_b16 a[126:127], v23 offset:61440
    v_mfma_f32_16x16x32_bf16 v[64:67], a[224:227], a[56:59], v[64:67]
    ds_read_b64_tr_b16 a[192:193], v44 offset:0
    ds_read_b64_tr_b16 a[194:195], v44 offset:4096
    v_mfma_f32_16x16x32_bf16 v[68:71], a[228:231], a[56:59], v[68:71]
    ds_read_b64_tr_b16 a[196:197], v45 offset:0
    ds_read_b64_tr_b16 a[198:199], v45 offset:4096
    v_mfma_f32_16x16x32_bf16 v[72:75], a[232:235], a[56:59], v[72:75]
    ds_read_b64_tr_b16 a[200:201], v46 offset:0
    ds_read_b64_tr_b16 a[202:203], v46 offset:4096
    v_mfma_f32_16x16x32_bf16 v[76:79], a[236:239], a[56:59], v[76:79]
    s_waitcnt lgkmcnt(12)
    ds_read_b64_tr_b16 a[204:205], v47 offset:0
    ds_read_b64_tr_b16 a[206:207], v47 offset:4096
    v_mfma_f32_16x16x32_bf16 v[80:83], a[240:243], a[56:59], v[80:83]
    ds_read_b64_tr_b16 a[208:209], v48 offset:0
    ds_read_b64_tr_b16 a[210:211], v48 offset:4096
    v_mfma_f32_16x16x32_bf16 v[84:87], a[244:247], a[56:59], v[84:87]
    ds_read_b64_tr_b16 a[212:213], v49 offset:0
    ds_read_b64_tr_b16 a[214:215], v49 offset:4096
    v_mfma_f32_16x16x32_bf16 v[88:91], a[248:251], a[56:59], v[88:91]
    ds_read_b64_tr_b16 a[216:217], v50 offset:0
    ds_read_b64_tr_b16 a[218:219], v50 offset:4096
    v_mfma_f32_16x16x32_bf16 v[92:95], a[252:255], a[56:59], v[92:95]
    s_waitcnt vmcnt(25)
    ds_read_b64_tr_b16 a[220:221], v51 offset:0
    ds_read_b64_tr_b16 a[222:223], v51 offset:4096
    s_waitcnt vmcnt(0)
    v_cmp_gt_u32 vcc, v32, v34
    s_nop 0
    s_cbranch_vccnz SP_pp
SR_pp:
    v_mfma_f32_16x16x32_bf16 v[64:67], a[96:99], a[60:63], v[64:67]
    ds_read_b64_tr_b16 a[224:225], v44 offset:8192
    ds_read_b64_tr_b16 a[226:227], v44 offset:12288
    buffer_load_dwordx4 v[192:195], v2, s[12:15], s0 offen offset:0 sc1
    v_mfma_f32_16x16x32_bf16 v[68:71], a[100:103], a[60:63], v[68:71]
    ds_read_b64_tr_b16 a[228:229], v45 offset:8192
    ds_read_b64_tr_b16 a[230:231], v45 offset:12288
    v_mfma_f32_16x16x32_bf16 v[72:75], a[104:107], a[60:63], v[72:75]
    ds_read_b64_tr_b16 a[232:233], v46 offset:8192
    ds_read_b64_tr_b16 a[234:235], v46 offset:12288
    buffer_load_dwordx4 v[196:199], v2, s[12:15], s0 offen offset:1024 sc1
    v_mfma_f32_16x16x32_bf16 v[76:79], a[108:111], a[60:63], v[76:79]
    ds_read_b64_tr_b16 a[236:237], v47 offset:8192
    ds_read_b64_tr_b16 a[238:239], v47 offset:12288
    v_mfma_f32_16x16x32_bf16 v[80:83], a[112:115], a[60:63], v[80:83]
    s_waitcnt lgkmcnt(12)
    ds_read_b64_tr_b16 a[240:241], v48 offset:8192
    ds_read_b64_tr_b16 a[242:243], v48 offset:12288
    buffer_load_dwordx4 v[200:203], v2, s[12:15], s0 offen offset:2048 sc1
    v_mfma_f32_16x16x32_bf16 v[84:87], a[116:119], a[60:63], v[84:87]
    ds_read_b64_tr_b16 a[244:245], v49 offset:8192
    ds_read_b64_tr_b16 a[246:247], v49 offset:12288
    v_mfma_f32_16x16x32_bf16 v[88:91], a[120:123], a[60:63], v[88:91]
    ds_read_b64_tr_b16 a[248:249], v50 offset:8192
    ds_read_b64_tr_b16 a[250:251], v50 offset:12288
    buffer_load_dwordx4 v[204:207], v2, s[12:15], s0 offen offset:3072 sc1
    v_mfma_f32_16x16x32_bf16 v[92:95], a[124:127], a[60:63], v[92:95]
    s_waitcnt vmcnt(28)
    ds_read_b64_tr_b16 a[252:253], v51 offset:8192
    ds_read_b64_tr_b16 a[254:255], v51 offset:12288
    v_mfma_f32_16x16x32_bf16 v[64:67], a[192:195], a[64:67], v[64:67]
    ds_read_b64_tr_b16 a[96:97], v44 offset:16384
    ds_read_b64_tr_b16 a[98:99], v44 offset:20480
    buffer_load_dwordx4 v[208:211], v2, s[12:15], s1 offen offset:0 sc1
    v_mfma_f32_16x16x32_bf16 v[68:71], a[196:199], a[64:67], v[68:71]
    ds_read_b64_tr_b16 a[100:101], v45 offset:16384
    ds_read_b64_tr_b16 a[102:103], v45 offset:20480
    v_mfma_f32_16x16x32_bf16 v[72:75], a[200:203], a[64:67], v[72:75]
    ds_read_b64_tr_b16 a[104:105], v46 offset:16384
    ds_read_b64_tr_b16 a[106:107], v46 offset:20480
    buffer_load_dwordx4 v[212:215], v2, s[12:15], s1 offen offset:1024 sc1
    v_mfma_f32_16x16x32_bf16 v[76:79], a[204:207], a[64:67], v[76:79]
    ds_read_b64_tr_b16 a[108:109], v47 offset:16384
    ds_read_b64_tr_b16 a[110:111], v47 offset:20480
    v_mfma_f32_16x16x32_bf16 v[80:83], a[208:211], a[64:67], v[80:83]
    ds_read_b64_tr_b16 a[112:113], v48 offset:16384
    ds_read_b64_tr_b16 a[114:115], v48 offset:20480
    buffer_load_dwordx4 v[216:219], v2, s[12:15], s1 offen offset:2048 sc1
    v_mfma_f32_16x16x32_bf16 v[84:87], a[212:215], a[64:67], v[84:87]
    s_waitcnt lgkmcnt(12)
    ds_read_b64_tr_b16 a[116:117], v49 offset:16384
    ds_read_b64_tr_b16 a[118:119], v49 offset:20480
    v_mfma_f32_16x16x32_bf16 v[88:91], a[216:219], a[64:67], v[88:91]
    ds_read_b64_tr_b16 a[120:121], v50 offset:16384
    ds_read_b64_tr_b16 a[122:123], v50 offset:20480
    buffer_load_dwordx4 v[220:223], v2, s[12:15], s1 offen offset:3072 sc1
    v_mfma_f32_16x16x32_bf16 v[92:95], a[220:223], a[64:67], v[92:95]
    s_waitcnt vmcnt(31)
    ds_read_b64_tr_b16 a[124:125], v51 offset:16384
    ds_read_b64_tr_b16 a[126:127], v51 offset:20480
    v_mfma_f32_16x16x32_bf16 v[64:67], a[224:227], a[68:71], v[64:67]
    ds_read_b64_tr_b16 a[192:193], v44 offset:24576
    ds_read_b64_tr_b16 a[194:195], v44 offset:28672
    buffer_load_dwordx4 v[112:115], v2, s[12:15], s72 offen offset:0 sc1
    v_mfma_f32_16x16x32_bf16 v[68:71], a[228:231], a[68:71], v[68:71]
    ds_read_b64_tr_b16 a[196:197], v45 offset:24576
    ds_read_b64_tr_b16 a[198:199], v45 offset:28672
    v_mfma_f32_16x16x32_bf16 v[72:75], a[232:235], a[68:71], v[72:75]
    ds_read_b64_tr_b16 a[200:201], v46 offset:24576
    ds_read_b64_tr_b16 a[202:203], v46 offset:28672
    buffer_load_dwordx4 v[116:119], v2, s[12:15], s72 offen offset:1024 sc1
    v_mfma_f32_16x16x32_bf16 v[76:79], a[236:239], a[68:71], v[76:79]
    ds_read_b64_tr_b16 a[204:205], v47 offset:24576
    ds_read_b64_tr_b16 a[206:207], v47 offset:28672
    v_mfma_f32_16x16x32_bf16 v[80:83], a[240:243], a[68:71], v[80:83]
    ds_read_b64_tr_b16 a[208:209], v48 offset:24576
    ds_read_b64_tr_b16 a[210:211], v48 offset:28672
    buffer_load_dwordx4 v[120:123], v2, s[12:15], s72 offen offset:2048 sc1
    v_mfma_f32_16x16x32_bf16 v[84:87], a[244:247], a[68:71], v[84:87]
    ds_read_b64_tr_b16 a[212:213], v49 offset:24576
    ds_read_b64_tr_b16 a[214:215], v49 offset:28672
    v_mfma_f32_16x16x32_bf16 v[88:91], a[248:251], a[68:71], v[88:91]
    s_waitcnt lgkmcnt(12)
    ds_read_b64_tr_b16 a[216:217], v50 offset:24576
    ds_read_b64_tr_b16 a[218:219], v50 offset:28672
    buffer_load_dwordx4 v[124:127], v2, s[12:15], s72 offen offset:3072 sc1
    v_mfma_f32_16x16x32_bf16 v[92:95], a[252:255], a[68:71], v[92:95]
    s_waitcnt vmcnt(34)
    ds_read_b64_tr_b16 a[220:221], v51 offset:24576
    ds_read_b64_tr_b16 a[222:223], v51 offset:28672
    v_mfma_f32_16x16x32_bf16 v[64:67], a[96:99], a[72:75], v[64:67]
    buffer_load_dwordx4 v[144:147], v2, s[12:15], s73 offen offset:0 sc1
    v_mfma_f32_16x16x32_bf16 v[68:71], a[100:103], a[72:75], v[68:71]
    v_mfma_f32_16x16x32_bf16 v[72:75], a[104:107], a[72:75], v[72:75]
    buffer_load_dwordx4 v[148:151], v2, s[12:15], s73 offen offset:1024 sc1
    v_mfma_f32_16x16x32_bf16 v[76:79], a[108:111], a[72:75], v[76:79]
    v_mfma_f32_16x16x32_bf16 v[80:83], a[112:115], a[72:75], v[80:83]
    buffer_load_dwordx4 v[152:155], v2, s[12:15], s73 offen offset:2048 sc1
    v_mfma_f32_16x16x32_bf16 v[84:87], a[116:119], a[72:75], v[84:87]
    v_mfma_f32_16x16x32_bf16 v[88:91], a[120:123], a[72:75], v[88:91]
    buffer_load_dwordx4 v[156:159], v2, s[12:15], s73 offen offset:3072 sc1
    v_mfma_f32_16x16x32_bf16 v[92:95], a[124:127], a[72:75], v[92:95]
    s_waitcnt lgkmcnt(0) vmcnt(37)
    v_mfma_f32_16x16x32_bf16 v[64:67], a[192:195], a[76:79], v[64:67]
    buffer_load_dwordx4 v[176:179], v2, s[12:15], s74 offen offset:0 sc1
    v_mfma_f32_16x16x32_bf16 v[68:71], a[196:199], a[76:79], v[68:71]
    v_mfma_f32_16x16x32_bf16 v[72:75], a[200:203], a[76:79], v[72:75]
    buffer_load_dwordx4 v[180:183], v2, s[12:15], s74 offen offset:1024 sc1
    v_mfma_f32_16x16x32_bf16 v[76:79], a[204:207], a[76:79], v[76:79]
    v_mfma_f32_16x16x32_bf16 v[80:83], a[208:211], a[76:79], v[80:83]
    buffer_load_dwordx4 v[184:187], v2, s[12:15], s74 offen offset:2048 sc1
    v_mfma_f32_16x16x32_bf16 v[84:87], a[212:215], a[76:79], v[84:87]
    v_mfma_f32_16x16x32_bf16 v[88:91], a[216:219], a[76:79], v[88:91]
    buffer_load_dwordx4 v[188:191], v2, s[12:15], s74 offen offset:3072 sc1
    v_mfma_f32_16x16x32_bf16 v[92:95], a[220:223], a[76:79], v[92:95]
    s_waitcnt vmcnt(19)
    v_lshlrev_b32 v96, 16, v192
    v_and_b32 v97, 0xffff0000, v192
    s_waitcnt vmcnt(15)
    v_lshlrev_b32 v160, 16, v208
    v_and_b32 v161, 0xffff0000, v208
    v_lshlrev_b32 v98, 16, v193
    v_and_b32 v99, 0xffff0000, v193
    v_lshlrev_b32 v162, 16, v209
    v_and_b32 v163, 0xffff0000, v209
    v_lshlrev_b32 v100, 16, v194
    v_and_b32 v101, 0xffff0000, v194
    v_lshlrev_b32 v164, 16, v210
    v_and_b32 v165, 0xffff0000, v210
    v_lshlrev_b32 v102, 16, v195
    v_and_b32 v103, 0xffff0000, v195
    v_lshlrev_b32 v166, 16, v211
    v_and_b32 v167, 0xffff0000, v211
    v_lshlrev_b32 v104, 16, v196
    v_and_b32 v105, 0xffff0000, v196
    s_waitcnt vmcnt(14)
    v_lshlrev_b32 v168, 16, v212
    v_and_b32 v169, 0xffff0000, v212
    v_lshlrev_b32 v106, 16, v197
    v_and_b32 v107, 0xffff0000, v197
    v_lshlrev_b32 v170, 16, v213
    v_and_b32 v171, 0xffff0000, v213
    v_lshlrev_b32 v108, 16, v198
    v_and_b32 v109, 0xffff0000, v198
    v_lshlrev_b32 v172, 16, v214
    v_and_b32 v173, 0xffff0000, v214
    v_lshlrev_b32 v110, 16, v199
    v_and_b32 v111, 0xffff0000, v199
    v_lshlrev_b32 v174, 16, v215
    v_and_b32 v175, 0xffff0000, v215
    v_lshlrev_b32 v128, 16, v200
    v_and_b32 v129, 0xffff0000, v200
    s_waitcnt vmcnt(13)
    v_lshlrev_b32 v240, 16, v216
    v_and_b32 v241, 0xffff0000, v216
    v_lshlrev_b32 v130, 16, v201
    v_and_b32 v131, 0xffff0000, v201
    v_lshlrev_b32 v242, 16, v217
    v_and_b32 v243, 0xffff0000, v217
    v_lshlrev_b32 v132, 16, v202
    v_and_b32 v133, 0xffff0000, v202
    v_lshlrev_b32 v244, 16, v218
    v_and_b32 v245, 0xffff0000, v218
    v_lshlrev_b32 v134, 16, v203
    v_and_b32 v135, 0xffff0000, v203
    v_lshlrev_b32 v246, 16, v219
    v_and_b32 v247, 0xffff0000, v219
    v_lshlrev_b32 v136, 16, v204
    v_and_b32 v137, 0xffff0000, v204
    s_waitcnt vmcnt(12)
    v_lshlrev_b32 v248, 16, v220
    v_and_b32 v249, 0xffff0000, v220
    v_lshlrev_b32 v138, 16, v205
    v_and_b32 v139, 0xffff0000, v205
    v_lshlrev_b32 v250, 16, v221
    v_and_b32 v251, 0xffff0000, v221
    v_lshlrev_b32 v140, 16, v206
    v_and_b32 v141, 0xffff0000, v206
    v_lshlrev_b32 v252, 16, v222
    v_and_b32 v253, 0xffff0000, v222
    v_lshlrev_b32 v142, 16, v207
    v_and_b32 v143, 0xffff0000, v207
    v_lshlrev_b32 v254, 16, v223
    v_and_b32 v255, 0xffff0000, v223
    s_mov_b32 s66, 0xbfb8aa3b
    s_mov_b32 s67, 0xbfb8aa3b
    s_mov_b32 s68, 1.0
    s_mov_b32 s69, 1.0
    v_pk_add_f32 v[96:97], v[96:97], v[160:161]
    v_pk_add_f32 v[98:99], v[98:99], v[162:163]
    v_pk_add_f32 v[100:101], v[100:101], v[164:165]
    v_pk_add_f32 v[102:103], v[102:103], v[166:167]
    v_pk_add_f32 v[104:105], v[104:105], v[168:169]
    v_pk_add_f32 v[106:107], v[106:107], v[170:171]
    v_pk_add_f32 v[108:109], v[108:109], v[172:173]
    v_pk_add_f32 v[110:111], v[110:111], v[174:175]
    v_pk_add_f32 v[128:129], v[128:129], v[240:241]
    v_pk_add_f32 v[130:131], v[130:131], v[242:243]
    v_pk_add_f32 v[132:133], v[132:133], v[244:245]
    v_pk_add_f32 v[134:135], v[134:135], v[246:247]
    v_pk_add_f32 v[136:137], v[136:137], v[248:249]
    v_pk_add_f32 v[138:139], v[138:139], v[250:251]
    v_pk_add_f32 v[140:141], v[140:141], v[252:253]
    v_pk_add_f32 v[142:143], v[142:143], v[254:255]
    v_pk_mul_f32 v[160:161], v[96:97], s[66:67]
    v_pk_mul_f32 v[162:163], v[98:99], s[66:67]
    v_pk_mul_f32 v[164:165], v[100:101], s[66:67]
    v_pk_mul_f32 v[166:167], v[102:103], s[66:67]
    v_pk_mul_f32 v[168:169], v[104:105], s[66:67]
    v_pk_mul_f32 v[170:171], v[106:107], s[66:67]
    v_pk_mul_f32 v[172:173], v[108:109], s[66:67]
    v_pk_mul_f32 v[174:175], v[110:111], s[66:67]
    v_pk_mul_f32 v[240:241], v[128:129], s[66:67]
    v_pk_mul_f32 v[242:243], v[130:131], s[66:67]
    v_pk_mul_f32 v[244:245], v[132:133], s[66:67]
    v_pk_mul_f32 v[246:247], v[134:135], s[66:67]
    v_pk_mul_f32 v[248:249], v[136:137], s[66:67]
    v_pk_mul_f32 v[250:251], v[138:139], s[66:67]
    v_pk_mul_f32 v[252:253], v[140:141], s[66:67]
    v_pk_mul_f32 v[254:255], v[142:143], s[66:67]
    v_exp_f32 v160, v160
    v_exp_f32 v161, v161
    v_exp_f32 v162, v162
    v_exp_f32 v163, v163
    v_exp_f32 v164, v164
    v_exp_f32 v165, v165
    v_exp_f32 v166, v166
    v_exp_f32 v167, v167
    v_exp_f32 v168, v168
    v_exp_f32 v169, v169
    v_exp_f32 v170, v170
    v_exp_f32 v171, v171
    v_exp_f32 v172, v172
    v_exp_f32 v173, v173
    v_exp_f32 v174, v174
    v_exp_f32 v175, v175
    v_exp_f32 v240, v240
    v_exp_f32 v241, v241
    v_exp_f32 v242, v242
    v_exp_f32 v243, v243
    v_exp_f32 v244, v244
    v_exp_f32 v245, v245
    v_exp_f32 v246, v246
    v_exp_f32 v247, v247
    v_exp_f32 v248, v248
    v_exp_f32 v249, v249
    v_exp_f32 v250, v250
    v_exp_f32 v251, v251
    v_exp_f32 v252, v252
    v_exp_f32 v253, v253
    v_exp_f32 v254, v254
    v_exp_f32 v255, v255
    v_pk_add_f32 v[160:161], v[160:161], s[68:69]
    v_pk_add_f32 v[162:163], v[162:163], s[68:69]
    v_pk_add_f32 v[164:165], v[164:165], s[68:69]
    v_pk_add_f32 v[166:167], v[166:167], s[68:69]
    v_pk_add_f32 v[168:169], v[168:169], s[68:69]
    v_pk_add_f32 v[170:171], v[170:171], s[68:69]
    v_pk_add_f32 v[172:173], v[172:173], s[68:69]
    v_pk_add_f32 v[174:175], v[174:175], s[68:69]
    v_pk_add_f32 v[240:241], v[240:241], s[68:69]
    v_pk_add_f32 v[242:243], v[242:243], s[68:69]
    v_pk_add_f32 v[244:245], v[244:245], s[68:69]
    v_pk_add_f32 v[246:247], v[246:247], s[68:69]
    v_pk_add_f32 v[248:249], v[248:249], s[68:69]
    v_pk_add_f32 v[250:251], v[250:251], s[68:69]
    v_pk_add_f32 v[252:253], v[252:253], s[68:69]
    v_pk_add_f32 v[254:255], v[254:255], s[68:69]
    v_rcp_f32 v160, v160
    v_rcp_f32 v161, v161
    v_rcp_f32 v162, v162
    v_rcp_f32 v163, v163
    v_rcp_f32 v164, v164
    v_rcp_f32 v165, v165
    v_rcp_f32 v166, v166
    v_rcp_f32 v167, v167
    v_rcp_f32 v168, v168
    v_rcp_f32 v169, v169
    v_rcp_f32 v170, v170
    v_rcp_f32 v171, v171
    v_rcp_f32 v172, v172
    v_rcp_f32 v173, v173
    v_rcp_f32 v174, v174
    v_rcp_f32 v175, v175
    v_rcp_f32 v240, v240
    v_rcp_f32 v241, v241
    v_rcp_f32 v242, v242
    v_rcp_f32 v243, v243
    v_rcp_f32 v244, v244
    v_rcp_f32 v245, v245
    v_rcp_f32 v246, v246
    v_rcp_f32 v247, v247
    v_rcp_f32 v248, v248
    v_rcp_f32 v249, v249
    v_rcp_f32 v250, v250
    v_rcp_f32 v251, v251
    v_rcp_f32 v252, v252
    v_rcp_f32 v253, v253
    v_rcp_f32 v254, v254
    v_rcp_f32 v255, v255
    v_lshlrev_b32 v192, 16, v224
    v_and_b32 v193, 0xffff0000, v224
    v_lshlrev_b32 v194, 16, v225
    v_and_b32 v195, 0xffff0000, v225
    v_lshlrev_b32 v196, 16, v226
    v_and_b32 v197, 0xffff0000, v226
    v_lshlrev_b32 v198, 16, v227
    v_and_b32 v199, 0xffff0000, v227
    v_lshlrev_b32 v200, 16, v228
    v_and_b32 v201, 0xffff0000, v228
    v_lshlrev_b32 v202, 16, v229
    v_and_b32 v203, 0xffff0000, v229
    v_lshlrev_b32 v204, 16, v230
    v_and_b32 v205, 0xffff0000, v230
    v_lshlrev_b32 v206, 16, v231
    v_and_b32 v207, 0xffff0000, v231
    v_lshlrev_b32 v208, 16, v232
    v_and_b32 v209, 0xffff0000, v232
    v_lshlrev_b32 v210, 16, v233
    v_and_b32 v211, 0xffff0000, v233
    v_lshlrev_b32 v212, 16, v234
    v_and_b32 v213, 0xffff0000, v234
    v_lshlrev_b32 v214, 16, v235
    v_and_b32 v215, 0xffff0000, v235
    v_lshlrev_b32 v216, 16, v236
    v_and_b32 v217, 0xffff0000, v236
    v_lshlrev_b32 v218, 16, v237
    v_and_b32 v219, 0xffff0000, v237
    v_lshlrev_b32 v220, 16, v238
    v_and_b32 v221, 0xffff0000, v238
    v_lshlrev_b32 v222, 16, v239
    v_and_b32 v223, 0xffff0000, v239
    v_pk_mul_f32 v[96:97], v[96:97], v[160:161]
    v_pk_mul_f32 v[98:99], v[98:99], v[162:163]
    v_pk_mul_f32 v[100:101], v[100:101], v[164:165]
    v_pk_mul_f32 v[102:103], v[102:103], v[166:167]
    v_pk_mul_f32 v[104:105], v[104:105], v[168:169]
    v_pk_mul_f32 v[106:107], v[106:107], v[170:171]
    v_pk_mul_f32 v[108:109], v[108:109], v[172:173]
    v_pk_mul_f32 v[110:111], v[110:111], v[174:175]
    v_pk_mul_f32 v[128:129], v[128:129], v[240:241]
    v_pk_mul_f32 v[130:131], v[130:131], v[242:243]
    v_pk_mul_f32 v[132:133], v[132:133], v[244:245]
    v_pk_mul_f32 v[134:135], v[134:135], v[246:247]
    v_pk_mul_f32 v[136:137], v[136:137], v[248:249]
    v_pk_mul_f32 v[138:139], v[138:139], v[250:251]
    v_pk_mul_f32 v[140:141], v[140:141], v[252:253]
    v_pk_mul_f32 v[142:143], v[142:143], v[254:255]
    s_waitcnt vmcnt(11)
    v_max3_u32 v34, v112, v113, v114
    s_waitcnt vmcnt(5)
    v_max3_u32 v35, v152, v153, v154
    v_max3_u32 v34, v34, v115, v116
    s_waitcnt vmcnt(4)
    v_max3_u32 v35, v35, v155, v156
    v_max3_u32 v34, v34, v117, v118
    v_max3_u32 v35, v35, v157, v158
    v_max3_u32 v34, v34, v119, v120
    s_waitcnt vmcnt(3)
    v_max3_u32 v35, v35, v159, v176
    v_max3_u32 v34, v34, v121, v122
    v_max3_u32 v35, v35, v177, v178
    v_max3_u32 v34, v34, v123, v124
    s_waitcnt vmcnt(2)
    v_max3_u32 v35, v35, v179, v180
    v_max3_u32 v34, v34, v125, v126
    v_max3_u32 v35, v35, v181, v182
    v_max3_u32 v34, v34, v127, v144
    s_waitcnt vmcnt(1)
    v_max3_u32 v35, v35, v183, v184
    v_max3_u32 v34, v34, v145, v146
    v_max3_u32 v35, v35, v185, v186
    v_max3_u32 v34, v34, v147, v148
    s_waitcnt vmcnt(0)
    v_max3_u32 v35, v35, v187, v188
    v_max3_u32 v34, v34, v149, v150
    v_max3_u32 v35, v35, v189, v190
    v_max3_u32 v34, v34, v151, v191
    v_max_u32 v34, v34, v35
    v_cmp_eq_u32 vcc, -1, v34
    s_nop 0
    s_cbranch_vccnz SP_ps
SR_ps:
    v_lshlrev_b32 v8, 16, v112
    v_and_b32 v9, 0xffff0000, v112
    v_lshlrev_b32 v10, 16, v113
    v_and_b32 v11, 0xffff0000, v113
    v_lshlrev_b32 v12, 16, v144
    v_and_b32 v13, 0xffff0000, v144
    v_lshlrev_b32 v14, 16, v145
    v_and_b32 v15, 0xffff0000, v145
    v_lshlrev_b32 v16, 16, v176
    v_and_b32 v17, 0xffff0000, v176
    v_lshlrev_b32 v18, 16, v177
    v_and_b32 v19, 0xffff0000, v177
    v_pk_add_f32 v[64:65], v[64:65], v[8:9]
    v_pk_add_f32 v[66:67], v[66:67], v[10:11]
    v_pk_add_f32 v[64:65], v[64:65], v[12:13]
    v_pk_add_f32 v[66:67], v[66:67], v[14:15]
    v_pk_add_f32 v[64:65], v[64:65], v[16:17]
    v_pk_add_f32 v[66:67], v[66:67], v[18:19]
    v_pk_fma_f32 v[192:193], v[64:65], v[96:97], v[192:193]
    v_pk_fma_f32 v[194:195], v[66:67], v[98:99], v[194:195]
    v_cvt_pk_bf16_f32 v192, v192, v193
    v_cvt_pk_bf16_f32 v193, v194, v195
    buffer_store_dwordx2 v[192:193], v43, s[24:27], 0 offen offset:0
    v_lshlrev_b32 v8, 16, v114
    v_and_b32 v9, 0xffff0000, v114
    v_lshlrev_b32 v10, 16, v115
    v_and_b32 v11, 0xffff0000, v115
    v_lshlrev_b32 v12, 16, v146
    v_and_b32 v13, 0xffff0000, v146
    v_lshlrev_b32 v14, 16, v147
    v_and_b32 v15, 0xffff0000, v147
    v_lshlrev_b32 v16, 16, v178
    v_and_b32 v17, 0xffff0000, v178
    v_lshlrev_b32 v18, 16, v179
    v_and_b32 v19, 0xffff0000, v179
    v_pk_add_f32 v[68:69], v[68:69], v[8:9]
    v_pk_add_f32 v[70:71], v[70:71], v[10:11]
    v_pk_add_f32 v[68:69], v[68:69], v[12:13]
    v_pk_add_f32 v[70:71], v[70:71], v[14:15]
    v_pk_add_f32 v[68:69], v[68:69], v[16:17]
    v_pk_add_f32 v[70:71], v[70:71], v[18:19]
    v_pk_fma_f32 v[196:197], v[68:69], v[100:101], v[196:197]
    v_pk_fma_f32 v[198:199], v[70:71], v[102:103], v[198:199]
    v_cvt_pk_bf16_f32 v196, v196, v197
    v_cvt_pk_bf16_f32 v197, v198, v199
    buffer_store_dwordx2 v[196:197], v43, s[24:27], 0 offen offset:32
    v_lshlrev_b32 v8, 16, v116
    v_and_b32 v9, 0xffff0000, v116
    v_lshlrev_b32 v10, 16, v117
    v_and_b32 v11, 0xffff0000, v117
    v_lshlrev_b32 v12, 16, v148
    v_and_b32 v13, 0xffff0000, v148
    v_lshlrev_b32 v14, 16, v149
    v_and_b32 v15, 0xffff0000, v149
    v_lshlrev_b32 v16, 16, v180
    v_and_b32 v17, 0xffff0000, v180
    v_lshlrev_b32 v18, 16, v181
    v_and_b32 v19, 0xffff0000, v181
    v_pk_add_f32 v[72:73], v[72:73], v[8:9]
    v_pk_add_f32 v[74:75], v[74:75], v[10:11]
    v_pk_add_f32 v[72:73], v[72:73], v[12:13]
    v_pk_add_f32 v[74:75], v[74:75], v[14:15]
    v_pk_add_f32 v[72:73], v[72:73], v[16:17]
    v_pk_add_f32 v[74:75], v[74:75], v[18:19]
    v_pk_fma_f32 v[200:201], v[72:73], v[104:105], v[200:201]
    v_pk_fma_f32 v[202:203], v[74:75], v[106:107], v[202:203]
    v_cvt_pk_bf16_f32 v200, v200, v201
    v_cvt_pk_bf16_f32 v201, v202, v203
    buffer_store_dwordx2 v[200:201], v43, s[24:27], 0 offen offset:64
    v_lshlrev_b32 v8, 16, v118
    v_and_b32 v9, 0xffff0000, v118
    v_lshlrev_b32 v10, 16, v119
    v_and_b32 v11, 0xffff0000, v119
    v_lshlrev_b32 v12, 16, v150
    v_and_b32 v13, 0xffff0000, v150
    v_lshlrev_b32 v14, 16, v151
    v_and_b32 v15, 0xffff0000, v151
    v_lshlrev_b32 v16, 16, v182
    v_and_b32 v17, 0xffff0000, v182
    v_lshlrev_b32 v18, 16, v183
    v_and_b32 v19, 0xffff0000, v183
    v_pk_add_f32 v[76:77], v[76:77], v[8:9]
    v_pk_add_f32 v[78:79], v[78:79], v[10:11]
    v_pk_add_f32 v[76:77], v[76:77], v[12:13]
    v_pk_add_f32 v[78:79], v[78:79], v[14:15]
    v_pk_add_f32 v[76:77], v[76:77], v[16:17]
    v_pk_add_f32 v[78:79], v[78:79], v[18:19]
    v_pk_fma_f32 v[204:205], v[76:77], v[108:109], v[204:205]
    v_pk_fma_f32 v[206:207], v[78:79], v[110:111], v[206:207]
    v_cvt_pk_bf16_f32 v204, v204, v205
    v_cvt_pk_bf16_f32 v205, v206, v207
    buffer_store_dwordx2 v[204:205], v43, s[24:27], 0 offen offset:96
    v_lshlrev_b32 v8, 16, v120
    v_and_b32 v9, 0xffff0000, v120
    v_lshlrev_b32 v10, 16, v121
    v_and_b32 v11, 0xffff0000, v121
    v_lshlrev_b32 v12, 16, v152
    v_and_b32 v13, 0xffff0000, v152
    v_lshlrev_b32 v14, 16, v153
    v_and_b32 v15, 0xffff0000, v153
    v_lshlrev_b32 v16, 16, v184
    v_and_b32 v17, 0xffff0000, v184
    v_lshlrev_b32 v18, 16, v185
    v_and_b32 v19, 0xffff0000, v185
    v_pk_add_f32 v[80:81], v[80:81], v[8:9]
    v_pk_add_f32 v[82:83], v[82:83], v[10:11]
    v_pk_add_f32 v[80:81], v[80:81], v[12:13]
    v_pk_add_f32 v[82:83], v[82:83], v[14:15]
    v_pk_add_f32 v[80:81], v[80:81], v[16:17]
    v_pk_add_f32 v[82:83], v[82:83], v[18:19]
    v_pk_fma_f32 v[208:209], v[80:81], v[128:129], v[208:209]
    v_pk_fma_f32 v[210:211], v[82:83], v[130:131], v[210:211]
    v_cvt_pk_bf16_f32 v208, v208, v209
    v_cvt_pk_bf16_f32 v209, v210, v211
    buffer_store_dwordx2 v[208:209], v43, s[24:27], 0 offen offset:128
    v_lshlrev_b32 v8, 16, v122
    v_and_b32 v9, 0xffff0000, v122
    v_lshlrev_b32 v10, 16, v123
    v_and_b32 v11, 0xffff0000, v123
    v_lshlrev_b32 v12, 16, v154
    v_and_b32 v13, 0xffff0000, v154
    v_lshlrev_b32 v14, 16, v155
    v_and_b32 v15, 0xffff0000, v155
    v_lshlrev_b32 v16, 16, v186
    v_and_b32 v17, 0xffff0000, v186
    v_lshlrev_b32 v18, 16, v187
    v_and_b32 v19, 0xffff0000, v187
    v_pk_add_f32 v[84:85], v[84:85], v[8:9]
    v_pk_add_f32 v[86:87], v[86:87], v[10:11]
    v_pk_add_f32 v[84:85], v[84:85], v[12:13]
    v_pk_add_f32 v[86:87], v[86:87], v[14:15]
    v_pk_add_f32 v[84:85], v[84:85], v[16:17]
    v_pk_add_f32 v[86:87], v[86:87], v[18:19]
    v_pk_fma_f32 v[212:213], v[84:85], v[132:133], v[212:213]
    v_pk_fma_f32 v[214:215], v[86:87], v[134:135], v[214:215]
    v_cvt_pk_bf16_f32 v212, v212, v213
    v_cvt_pk_bf16_f32 v213, v214, v215
    buffer_store_dwordx2 v[212:213], v43, s[24:27], 0 offen offset:160
    v_lshlrev_b32 v8, 16, v124
    v_and_b32 v9, 0xffff0000, v124
    v_lshlrev_b32 v10, 16, v125
    v_and_b32 v11, 0xffff0000, v125
    v_lshlrev_b32 v12, 16, v156
    v_and_b32 v13, 0xffff0000, v156
    v_lshlrev_b32 v14, 16, v157
    v_and_b32 v15, 0xffff0000, v157
    v_lshlrev_b32 v16, 16, v188
    v_and_b32 v17, 0xffff0000, v188
    v_lshlrev_b32 v18, 16, v189
    v_and_b32 v19, 0xffff0000, v189
    v_pk_add_f32 v[88:89], v[88:89], v[8:9]
    v_pk_add_f32 v[90:91], v[90:91], v[10:11]
    v_pk_add_f32 v[88:89], v[88:89], v[12:13]
    v_pk_add_f32 v[90:91], v[90:91], v[14:15]
    v_pk_add_f32 v[88:89], v[88:89], v[16:17]
    v_pk_add_f32 v[90:91], v[90:91], v[18:19]
    v_pk_fma_f32 v[216:217], v[88:89], v[136:137], v[216:217]
    v_pk_fma_f32 v[218:219], v[90:91], v[138:139], v[218:219]
    v_cvt_pk_bf16_f32 v216, v216, v217
    v_cvt_pk_bf16_f32 v217, v218, v219
    buffer_store_dwordx2 v[216:217], v43, s[24:27], 0 offen offset:192
    v_lshlrev_b32 v8, 16, v126
    v_and_b32 v9, 0xffff0000, v126
    v_lshlrev_b32 v10, 16, v127
    v_and_b32 v11, 0xffff0000, v127
    v_lshlrev_b32 v12, 16, v158
    v_and_b32 v13, 0xffff0000, v158
    v_lshlrev_b32 v14, 16, v159
    v_and_b32 v15, 0xffff0000, v159
    v_lshlrev_b32 v16, 16, v190
    v_and_b32 v17, 0xffff0000, v190
    v_lshlrev_b32 v18, 16, v191
    v_and_b32 v19, 0xffff0000, v191
    v_pk_add_f32 v[92:93], v[92:93], v[8:9]
    v_pk_add_f32 v[94:95], v[94:95], v[10:11]
    v_pk_add_f32 v[92:93], v[92:93], v[12:13]
    v_pk_add_f32 v[94:95], v[94:95], v[14:15]
    v_pk_add_f32 v[92:93], v[92:93], v[16:17]
    v_pk_add_f32 v[94:95], v[94:95], v[18:19]
    v_pk_fma_f32 v[220:221], v[92:93], v[140:141], v[220:221]
    v_pk_fma_f32 v[222:223], v[94:95], v[142:143], v[222:223]
    v_cvt_pk_bf16_f32 v220, v220, v221
    v_cvt_pk_bf16_f32 v221, v222, v223
    buffer_store_dwordx2 v[220:221], v43, s[24:27], 0 offen offset:224
    s_endpgm
DN_go:
    s_cmp_eq_u32 s41, 3
    s_cbranch_scc1 DN_idle
    s_waitcnt vmcnt(39) lgkmcnt(14)
    v_mfma_f32_16x16x32_bf16 v[96:99], a[192:195], a[132:135], 0
    s_bfe_u32 s61, s40, 0x40004
    v_xor_b32 v16, 0, v41
    v_xor_b32 v17, 32, v41
    s_waitcnt lgkmcnt(12)
    v_mfma_f32_16x16x32_bf16 v[100:103], a[196:199], a[132:135], 0
    s_lshl_b32 s61, s61, 12
    ds_read_b64_tr_b16 a[224:225], v8 offset:8192
    ds_read_b64_tr_b16 a[226:227], v8 offset:12288
    s_waitcnt lgkmcnt(12)
    v_mfma_f32_16x16x32_bf16 v[104:107], a[200:203], a[132:135], 0
    s_waitcnt lgkmcnt(10)
    v_xor_b32 v18, 64, v41
    v_xor_b32 v19, 96, v41
    v_mfma_f32_16x16x32_bf16 v[108:111], a[204:207], a[132:135], 0
    s_waitcnt lgkmcnt(8)
    ds_read_b64_tr_b16 a[228:229], v9 offset:8192
    ds_read_b64_tr_b16 a[230:231], v9 offset:12288
    v_mfma_f32_16x16x32_bf16 v[112:115], a[208:211], a[132:135], 0
    s_waitcnt lgkmcnt(8)
    v_xor_b32 v20, 128, v41
    v_xor_b32 v21, 160, v41
    v_mfma_f32_16x16x32_bf16 v[116:119], a[212:215], a[132:135], 0
    s_waitcnt lgkmcnt(6)
    ds_read_b64_tr_b16 a[232:233], v10 offset:8192
    ds_read_b64_tr_b16 a[234:235], v10 offset:12288
    v_mfma_f32_16x16x32_bf16 v[120:123], a[216:219], a[132:135], 0
    s_waitcnt lgkmcnt(6)
    v_xor_b32 v22, 192, v41
    v_xor_b32 v23, 224, v41
    v_mfma_f32_16x16x32_bf16 v[124:127], a[220:223], a[132:135], 0
    s_waitcnt vmcnt(37)
    ds_read_b64_tr_b16 a[236:237], v11 offset:8192
    ds_read_b64_tr_b16 a[238:239], v11 offset:12288
    v_mfma_f32_16x16x32_bf16 v[156:159], a[220:223], a[136:139], 0
    v_xor_b32 v44, 65536, v41
    v_xor_b32 v45, 65568, v41
    v_mfma_f32_16x16x32_bf16 v[152:155], a[216:219], a[136:139], 0
    ds_read_b64_tr_b16 a[240:241], v12 offset:8192
    ds_read_b64_tr_b16 a[242:243], v12 offset:12288
    v_mfma_f32_16x16x32_bf16 v[148:151], a[212:215], a[136:139], 0
    v_xor_b32 v46, 65600, v41
    v_xor_b32 v47, 65632, v41
    v_mfma_f32_16x16x32_bf16 v[144:147], a[208:211], a[136:139], 0
    ds_read_b64_tr_b16 a[244:245], v13 offset:8192
    ds_read_b64_tr_b16 a[246:247], v13 offset:12288
    v_mfma_f32_16x16x32_bf16 v[140:143], a[204:207], a[136:139], 0
    v_xor_b32 v48, 65664, v41
    v_xor_b32 v49, 65696, v41
    v_mfma_f32_16x16x32_bf16 v[136:139], a[200:203], a[136:139], 0
    ds_read_b64_tr_b16 a[248:249], v14 offset:8192
    ds_read_b64_tr_b16 a[250:251], v14 offset:12288
    v_mfma_f32_16x16x32_bf16 v[132:135], a[196:199], a[136:139], 0
    s_waitcnt vmcnt(35)
    v_xor_b32 v50, 65728, v41
    v_xor_b32 v51, 65760, v41
    v_mfma_f32_16x16x32_bf16 v[128:131], a[192:195], a[136:139], 0
    s_sub_u32 s34, s57, s56
    ds_read_b64_tr_b16 a[252:253], v15 offset:8192
    ds_read_b64_tr_b16 a[254:255], v15 offset:12288
    v_mfma_f32_16x16x32_bf16 v[160:163], a[192:195], a[140:143], 0
    v_lshrrev_b32 v52, 5, v1
    v_and_b32 v53, 31, v1
    v_mfma_f32_16x16x32_bf16 v[164:167], a[196:199], a[140:143], 0
    v_mul_u32_u24 v52, s34, v52
    v_lshl_add_u32 v52, v53, 7, v52
    v_mfma_f32_16x16x32_bf16 v[168:171], a[200:203], a[140:143], 0
    buffer_load_dwordx4 v[196:199], v37, s[20:23], s61 offen offset:0 sc1
    v_mfma_f32_16x16x32_bf16 v[172:175], a[204:207], a[140:143], 0
    v_mfma_f32_16x16x32_bf16 v[176:179], a[208:211], a[140:143], 0
    v_mfma_f32_16x16x32_bf16 v[180:183], a[212:215], a[140:143], 0
    buffer_load_dwordx4 v[200:203], v38, s[20:23], s61 offen offset:0 sc1
    v_mfma_f32_16x16x32_bf16 v[184:187], a[216:219], a[140:143], 0
    v_mfma_f32_16x16x32_bf16 v[188:191], a[220:223], a[140:143], 0
    s_waitcnt vmcnt(35)
    v_mfma_f32_16x16x32_bf16 v[92:95], a[220:223], a[128:131], 0
    buffer_load_dwordx4 v[204:207], v39, s[20:23], s61 offen offset:0 sc1
    v_mfma_f32_16x16x32_bf16 v[88:91], a[216:219], a[128:131], 0
    v_mfma_f32_16x16x32_bf16 v[84:87], a[212:215], a[128:131], 0
    v_mfma_f32_16x16x32_bf16 v[80:83], a[208:211], a[128:131], 0
    buffer_load_dwordx4 v[192:195], v36, s[20:23], s61 offen offset:0 sc1
    v_mfma_f32_16x16x32_bf16 v[76:79], a[204:207], a[128:131], 0
    v_mfma_f32_16x16x32_bf16 v[72:75], a[200:203], a[128:131], 0
    v_mfma_f32_16x16x32_bf16 v[68:71], a[196:199], a[128:131], 0
    buffer_load_dwordx4 v[212:215], v37, s[20:23], s61 offen offset:1024 sc1
    v_mfma_f32_16x16x32_bf16 v[64:67], a[192:195], a[128:131], 0
    s_waitcnt lgkmcnt(0) vmcnt(36)
    v_mfma_f32_16x16x32_bf16 v[96:99], a[224:227], a[148:151], v[96:99]
    v_mfma_f32_16x16x32_bf16 v[100:103], a[228:231], a[148:151], v[100:103]
    ds_read_b64_tr_b16 a[192:193], v8 offset:16384
    ds_read_b64_tr_b16 a[194:195], v8 offset:20480
    v_mfma_f32_16x16x32_bf16 v[104:107], a[232:235], a[148:151], v[104:107]
    buffer_load_dwordx4 v[216:219], v38, s[20:23], s61 offen offset:1024 sc1
    v_mfma_f32_16x16x32_bf16 v[108:111], a[236:239], a[148:151], v[108:111]
    ds_read_b64_tr_b16 a[196:197], v9 offset:16384
    ds_read_b64_tr_b16 a[198:199], v9 offset:20480
    v_mfma_f32_16x16x32_bf16 v[112:115], a[240:243], a[148:151], v[112:115]
    v_mfma_f32_16x16x32_bf16 v[116:119], a[244:247], a[148:151], v[116:119]
    ds_read_b64_tr_b16 a[200:201], v10 offset:16384
    ds_read_b64_tr_b16 a[202:203], v10 offset:20480
    v_mfma_f32_16x16x32_bf16 v[120:123], a[248:251], a[148:151], v[120:123]
    buffer_load_dwordx4 v[220:223], v39, s[20:23], s61 offen offset:1024 sc1
    v_mfma_f32_16x16x32_bf16 v[124:127], a[252:255], a[148:151], v[124:127]
    s_waitcnt vmcnt(36)
    ds_read_b64_tr_b16 a[204:205], v11 offset:16384
    ds_read_b64_tr_b16 a[206:207], v11 offset:20480
    v_mfma_f32_16x16x32_bf16 v[156:159], a[252:255], a[152:155], v[156:159]
    v_mfma_f32_16x16x32_bf16 v[152:155], a[248:251], a[152:155], v[152:155]
    ds_read_b64_tr_b16 a[208:209], v12 offset:16384
    ds_read_b64_tr_b16 a[210:211], v12 offset:20480
    v_mfma_f32_16x16x32_bf16 v[148:151], a[244:247], a[152:155], v[148:151]
    buffer_load_dwordx4 v[208:211], v36, s[20:23], s61 offen offset:1024 sc1
    v_mfma_f32_16x16x32_bf16 v[144:147], a[240:243], a[152:155], v[144:147]
    ds_read_b64_tr_b16 a[212:213], v13 offset:16384
    ds_read_b64_tr_b16 a[214:215], v13 offset:20480
    v_mfma_f32_16x16x32_bf16 v[140:143], a[236:239], a[152:155], v[140:143]
    v_mfma_f32_16x16x32_bf16 v[136:139], a[232:235], a[152:155], v[136:139]
    ds_read_b64_tr_b16 a[216:217], v14 offset:16384
    ds_read_b64_tr_b16 a[218:219], v14 offset:20480
    v_mfma_f32_16x16x32_bf16 v[132:135], a[228:231], a[152:155], v[132:135]
    v_mfma_f32_16x16x32_bf16 v[128:131], a[224:227], a[152:155], v[128:131]
    s_waitcnt vmcnt(35)
    ds_read_b64_tr_b16 a[220:221], v15 offset:16384
    ds_read_b64_tr_b16 a[222:223], v15 offset:20480
    v_mfma_f32_16x16x32_bf16 v[160:163], a[224:227], a[156:159], v[160:163]
    v_mfma_f32_16x16x32_bf16 v[164:167], a[228:231], a[156:159], v[164:167]
    v_mfma_f32_16x16x32_bf16 v[168:171], a[232:235], a[156:159], v[168:171]
    v_mfma_f32_16x16x32_bf16 v[172:175], a[236:239], a[156:159], v[172:175]
    v_mfma_f32_16x16x32_bf16 v[176:179], a[240:243], a[156:159], v[176:179]
    v_mfma_f32_16x16x32_bf16 v[180:183], a[244:247], a[156:159], v[180:183]
    v_mfma_f32_16x16x32_bf16 v[184:187], a[248:251], a[156:159], v[184:187]
    v_mfma_f32_16x16x32_bf16 v[188:191], a[252:255], a[156:159], v[188:191]
    s_waitcnt vmcnt(33)
    v_mfma_f32_16x16x32_bf16 v[92:95], a[252:255], a[144:147], v[92:95]
    v_mfma_f32_16x16x32_bf16 v[88:91], a[248:251], a[144:147], v[88:91]
    v_mfma_f32_16x16x32_bf16 v[84:87], a[244:247], a[144:147], v[84:87]
    v_mfma_f32_16x16x32_bf16 v[80:83], a[240:243], a[144:147], v[80:83]
    v_mfma_f32_16x16x32_bf16 v[76:79], a[236:239], a[144:147], v[76:79]
    v_mfma_f32_16x16x32_bf16 v[72:75], a[232:235], a[144:147], v[72:75]
    v_mov_b32 v5, 4
    v_mfma_f32_16x16x32_bf16 v[68:71], a[228:231], a[144:147], v[68:71]
    v_mfma_f32_16x16x32_bf16 v[64:67], a[224:227], a[144:147], v[64:67]
    s_waitcnt lgkmcnt(0) vmcnt(31)
    v_mfma_f32_16x16x32_bf16 v[96:99], a[192:195], a[164:167], v[96:99]
    s_waitcnt vmcnt(8) lgkmcnt(0)
    v_mfma_f32_16x16x32_bf16 v[100:103], a[196:199], a[164:167], v[100:103]
    s_barrier
    buffer_store_dword v5, v0, s[76:79], 0 offen sc1
    v_mfma_f32_16x16x32_bf16 v[104:107], a[200:203], a[164:167], v[104:107]
    ds_read_b64_tr_b16 a[224:225], v8 offset:24576
    ds_read_b64_tr_b16 a[226:227], v8 offset:28672
    v_mfma_f32_16x16x32_bf16 v[108:111], a[204:207], a[164:167], v[108:111]
    buffer_load_dwordx4 v[228:231], v37, s[20:23], s61 offen offset:2048 sc1
    v_mfma_f32_16x16x32_bf16 v[112:115], a[208:211], a[164:167], v[112:115]
    ds_read_b64_tr_b16 a[228:229], v9 offset:24576
    ds_read_b64_tr_b16 a[230:231], v9 offset:28672
    v_mfma_f32_16x16x32_bf16 v[116:119], a[212:215], a[164:167], v[116:119]
    buffer_load_dwordx4 v[232:235], v38, s[20:23], s61 offen offset:2048 sc1
    v_mfma_f32_16x16x32_bf16 v[120:123], a[216:219], a[164:167], v[120:123]
    ds_read_b64_tr_b16 a[232:233], v10 offset:24576
    ds_read_b64_tr_b16 a[234:235], v10 offset:28672
    v_mfma_f32_16x16x32_bf16 v[124:127], a[220:223], a[164:167], v[124:127]
    s_waitcnt vmcnt(33)
    buffer_load_dwordx4 v[236:239], v39, s[20:23], s61 offen offset:2048 sc1
    v_mfma_f32_16x16x32_bf16 v[156:159], a[220:223], a[168:171], v[156:159]
    ds_read_b64_tr_b16 a[236:237], v11 offset:24576
    ds_read_b64_tr_b16 a[238:239], v11 offset:28672
    v_mfma_f32_16x16x32_bf16 v[152:155], a[216:219], a[168:171], v[152:155]
    buffer_load_dwordx4 v[224:227], v36, s[20:23], s61 offen offset:2048 sc1
    v_mfma_f32_16x16x32_bf16 v[148:151], a[212:215], a[168:171], v[148:151]
    ds_read_b64_tr_b16 a[240:241], v12 offset:24576
    ds_read_b64_tr_b16 a[242:243], v12 offset:28672
    v_mfma_f32_16x16x32_bf16 v[144:147], a[208:211], a[168:171], v[144:147]
    v_mfma_f32_16x16x32_bf16 v[140:143], a[204:207], a[168:171], v[140:143]
    ds_read_b64_tr_b16 a[244:245], v13 offset:24576
    ds_read_b64_tr_b16 a[246:247], v13 offset:28672
    v_mfma_f32_16x16x32_bf16 v[136:139], a[200:203], a[168:171], v[136:139]
    buffer_load_dwordx4 v[244:247], v37, s[20:23], s61 offen offset:3072 sc1
    v_mfma_f32_16x16x32_bf16 v[132:135], a[196:199], a[168:171], v[132:135]
    ds_read_b64_tr_b16 a[248:249], v14 offset:24576
    ds_read_b64_tr_b16 a[250:251], v14 offset:28672
    v_mfma_f32_16x16x32_bf16 v[128:131], a[192:195], a[168:171], v[128:131]
    s_waitcnt vmcnt(35)
    buffer_load_dwordx4 v[248:251], v38, s[20:23], s61 offen offset:3072 sc1
    v_mfma_f32_16x16x32_bf16 v[160:163], a[192:195], a[172:175], v[160:163]
    ds_read_b64_tr_b16 a[252:253], v15 offset:24576
    ds_read_b64_tr_b16 a[254:255], v15 offset:28672
    v_mfma_f32_16x16x32_bf16 v[164:167], a[196:199], a[172:175], v[164:167]
    buffer_load_dwordx4 v[252:255], v39, s[20:23], s61 offen offset:3072 sc1
    v_mfma_f32_16x16x32_bf16 v[168:171], a[200:203], a[172:175], v[168:171]
    v_mfma_f32_16x16x32_bf16 v[172:175], a[204:207], a[172:175], v[172:175]
    buffer_load_dwordx4 v[240:243], v36, s[20:23], s61 offen offset:3072 sc1
    v_mfma_f32_16x16x32_bf16 v[176:179], a[208:211], a[172:175], v[176:179]
    v_mfma_f32_16x16x32_bf16 v[180:183], a[212:215], a[172:175], v[180:183]
    s_waitcnt vmcnt(37)
    v_mfma_f32_16x16x32_bf16 v[184:187], a[216:219], a[172:175], v[184:187]
    s_bfe_u32 s61, s40, 0x40008
    v_mfma_f32_16x16x32_bf16 v[188:191], a[220:223], a[172:175], v[188:191]
    s_lshl_b32 s61, s61, 12
    buffer_load_dwordx4 a[132:135], v37, s[20:23], s61 offen offset:0 sc1
    v_mfma_f32_16x16x32_bf16 v[92:95], a[220:223], a[160:163], v[92:95]
    v_mfma_f32_16x16x32_bf16 v[88:91], a[216:219], a[160:163], v[88:91]
    buffer_load_dwordx4 a[136:139], v38, s[20:23], s61 offen offset:0 sc1
    v_mfma_f32_16x16x32_bf16 v[84:87], a[212:215], a[160:163], v[84:87]
    v_mfma_f32_16x16x32_bf16 v[80:83], a[208:211], a[160:163], v[80:83]
    buffer_load_dwordx4 a[140:143], v39, s[20:23], s61 offen offset:0 sc1
    v_mfma_f32_16x16x32_bf16 v[76:79], a[204:207], a[160:163], v[76:79]
    v_mfma_f32_16x16x32_bf16 v[72:75], a[200:203], a[160:163], v[72:75]
    buffer_load_dwordx4 a[128:131], v36, s[20:23], s61 offen offset:0 sc1
    v_mfma_f32_16x16x32_bf16 v[68:71], a[196:199], a[160:163], v[68:71]
    v_mfma_f32_16x16x32_bf16 v[64:67], a[192:195], a[160:163], v[64:67]
    s_waitcnt lgkmcnt(0) vmcnt(40)
    v_mfma_f32_16x16x32_bf16 v[96:99], a[224:227], a[180:183], v[96:99]
    buffer_load_dwordx4 a[148:151], v37, s[20:23], s61 offen offset:1024 sc1
    v_mfma_f32_16x16x32_bf16 v[100:103], a[228:231], a[180:183], v[100:103]
    ds_read_b64_tr_b16 a[192:193], v16 offset:32768
    ds_read_b64_tr_b16 a[194:195], v16 offset:36864
    v_mfma_f32_16x16x32_bf16 v[104:107], a[232:235], a[180:183], v[104:107]
    buffer_load_dwordx4 a[152:155], v38, s[20:23], s61 offen offset:1024 sc1
    v_mfma_f32_16x16x32_bf16 v[108:111], a[236:239], a[180:183], v[108:111]
    ds_read_b64_tr_b16 a[196:197], v17 offset:32768
    ds_read_b64_tr_b16 a[198:199], v17 offset:36864
    v_mfma_f32_16x16x32_bf16 v[112:115], a[240:243], a[180:183], v[112:115]
    buffer_load_dwordx4 a[156:159], v39, s[20:23], s61 offen offset:1024 sc1
    v_mfma_f32_16x16x32_bf16 v[116:119], a[244:247], a[180:183], v[116:119]
    ds_read_b64_tr_b16 a[200:201], v18 offset:32768
    ds_read_b64_tr_b16 a[202:203], v18 offset:36864
    v_mfma_f32_16x16x32_bf16 v[120:123], a[248:251], a[180:183], v[120:123]
    buffer_load_dwordx4 a[144:147], v36, s[20:23], s61 offen offset:1024 sc1
    v_mfma_f32_16x16x32_bf16 v[124:127], a[252:255], a[180:183], v[124:127]
    s_waitcnt vmcnt(43)
    ds_read_b64_tr_b16 a[204:205], v19 offset:32768
    ds_read_b64_tr_b16 a[206:207], v19 offset:36864
    v_mfma_f32_16x16x32_bf16 v[156:159], a[252:255], a[184:187], v[156:159]
    v_mfma_f32_16x16x32_bf16 v[152:155], a[248:251], a[184:187], v[152:155]
    ds_read_b64_tr_b16 a[208:209], v20 offset:32768
    ds_read_b64_tr_b16 a[210:211], v20 offset:36864
    v_mfma_f32_16x16x32_bf16 v[148:151], a[244:247], a[184:187], v[148:151]
    buffer_load_dwordx4 a[164:167], v37, s[20:23], s61 offen offset:2048 sc1
    v_mfma_f32_16x16x32_bf16 v[144:147], a[240:243], a[184:187], v[144:147]
    ds_read_b64_tr_b16 a[212:213], v21 offset:32768
    ds_read_b64_tr_b16 a[214:215], v21 offset:36864
    v_mfma_f32_16x16x32_bf16 v[140:143], a[236:239], a[184:187], v[140:143]
    buffer_load_dwordx4 a[168:171], v38, s[20:23], s61 offen offset:2048 sc1
    v_mfma_f32_16x16x32_bf16 v[136:139], a[232:235], a[184:187], v[136:139]
    ds_read_b64_tr_b16 a[216:217], v22 offset:32768
    ds_read_b64_tr_b16 a[218:219], v22 offset:36864
    v_mfma_f32_16x16x32_bf16 v[132:135], a[228:231], a[184:187], v[132:135]
    buffer_load_dwordx4 a[172:175], v39, s[20:23], s61 offen offset:2048 sc1
    v_mfma_f32_16x16x32_bf16 v[128:131], a[224:227], a[184:187], v[128:131]
    s_waitcnt vmcnt(45)
    ds_read_b64_tr_b16 a[220:221], v23 offset:32768
    ds_read_b64_tr_b16 a[222:223], v23 offset:36864
    v_mfma_f32_16x16x32_bf16 v[160:163], a[224:227], a[188:191], v[160:163]
    buffer_load_dwordx4 a[160:163], v36, s[20:23], s61 offen offset:2048 sc1
    v_mfma_f32_16x16x32_bf16 v[164:167], a[228:231], a[188:191], v[164:167]
    v_mfma_f32_16x16x32_bf16 v[168:171], a[232:235], a[188:191], v[168:171]
    v_mfma_f32_16x16x32_bf16 v[172:175], a[236:239], a[188:191], v[172:175]
    v_mfma_f32_16x16x32_bf16 v[176:179], a[240:243], a[188:191], v[176:179]
    v_mfma_f32_16x16x32_bf16 v[180:183], a[244:247], a[188:191], v[180:183]
    v_mfma_f32_16x16x32_bf16 v[184:187], a[248:251], a[188:191], v[184:187]
    v_mfma_f32_16x16x32_bf16 v[188:191], a[252:255], a[188:191], v[188:191]
    s_waitcnt vmcnt(45)
    v_mfma_f32_16x16x32_bf16 v[92:95], a[252:255], a[176:179], v[92:95]
    v_mfma_f32_16x16x32_bf16 v[88:91], a[248:251], a[176:179], v[88:91]
    v_mfma_f32_16x16x32_bf16 v[84:87], a[244:247], a[176:179], v[84:87]
    v_mfma_f32_16x16x32_bf16 v[80:83], a[240:243], a[176:179], v[80:83]
    v_mfma_f32_16x16x32_bf16 v[76:79], a[236:239], a[176:179], v[76:79]
    v_mfma_f32_16x16x32_bf16 v[72:75], a[232:235], a[176:179], v[72:75]
    v_mfma_f32_16x16x32_bf16 v[68:71], a[228:231], a[176:179], v[68:71]
    v_mfma_f32_16x16x32_bf16 v[64:67], a[224:227], a[176:179], v[64:67]
    s_waitcnt lgkmcnt(0) vmcnt(28)
    v_mfma_f32_16x16x32_bf16 v[96:99], a[192:195], v[196:199], v[96:99]
    buffer_load_dwordx4 a[180:183], v37, s[20:23], s61 offen offset:3072 sc1
    v_mfma_f32_16x16x32_bf16 v[100:103], a[196:199], v[196:199], v[100:103]
    ds_read_b64_tr_b16 a[224:225], v16 offset:40960
    ds_read_b64_tr_b16 a[226:227], v16 offset:45056
    v_mfma_f32_16x16x32_bf16 v[104:107], a[200:203], v[196:199], v[104:107]
    v_mfma_f32_16x16x32_bf16 v[108:111], a[204:207], v[196:199], v[108:111]
    ds_read_b64_tr_b16 a[228:229], v17 offset:40960
    ds_read_b64_tr_b16 a[230:231], v17 offset:45056
    v_mfma_f32_16x16x32_bf16 v[112:115], a[208:211], v[196:199], v[112:115]
    buffer_load_dwordx4 a[184:187], v38, s[20:23], s61 offen offset:3072 sc1
    v_mfma_f32_16x16x32_bf16 v[116:119], a[212:215], v[196:199], v[116:119]
    ds_read_b64_tr_b16 a[232:233], v18 offset:40960
    ds_read_b64_tr_b16 a[234:235], v18 offset:45056
    v_mfma_f32_16x16x32_bf16 v[120:123], a[216:219], v[196:199], v[120:123]
    v_mfma_f32_16x16x32_bf16 v[124:127], a[220:223], v[196:199], v[124:127]
    s_waitcnt vmcnt(29)
    ds_read_b64_tr_b16 a[236:237], v19 offset:40960
    ds_read_b64_tr_b16 a[238:239], v19 offset:45056
    v_mfma_f32_16x16x32_bf16 v[156:159], a[220:223], v[200:203], v[156:159]
    buffer_load_dwordx4 a[188:191], v39, s[20:23], s61 offen offset:3072 sc1
    v_mfma_f32_16x16x32_bf16 v[152:155], a[216:219], v[200:203], v[152:155]
    ds_read_b64_tr_b16 a[240:241], v20 offset:40960
    ds_read_b64_tr_b16 a[242:243], v20 offset:45056
    v_mfma_f32_16x16x32_bf16 v[148:151], a[212:215], v[200:203], v[148:151]
    v_mfma_f32_16x16x32_bf16 v[144:147], a[208:211], v[200:203], v[144:147]
    ds_read_b64_tr_b16 a[244:245], v21 offset:40960
    ds_read_b64_tr_b16 a[246:247], v21 offset:45056
    v_mfma_f32_16x16x32_bf16 v[140:143], a[204:207], v[200:203], v[140:143]
    buffer_load_dwordx4 a[176:179], v36, s[20:23], s61 offen offset:3072 sc1
    v_mfma_f32_16x16x32_bf16 v[136:139], a[200:203], v[200:203], v[136:139]
    ds_read_b64_tr_b16 a[248:249], v22 offset:40960
    ds_read_b64_tr_b16 a[250:251], v22 offset:45056
    v_mfma_f32_16x16x32_bf16 v[132:135], a[196:199], v[200:203], v[132:135]
    v_mfma_f32_16x16x32_bf16 v[128:131], a[192:195], v[200:203], v[128:131]
    s_waitcnt vmcnt(30)
    ds_read_b64_tr_b16 a[252:253], v23 offset:40960
    ds_read_b64_tr_b16 a[254:255], v23 offset:45056
    v_mfma_f32_16x16x32_bf16 v[160:163], a[192:195], v[204:207], v[160:163]
    v_mfma_f32_16x16x32_bf16 v[164:167], a[196:199], v[204:207], v[164:167]
    v_mfma_f32_16x16x32_bf16 v[168:171], a[200:203], v[204:207], v[168:171]
    v_mfma_f32_16x16x32_bf16 v[172:175], a[204:207], v[204:207], v[172:175]
    v_mfma_f32_16x16x32_bf16 v[176:179], a[208:211], v[204:207], v[176:179]
    v_mfma_f32_16x16x32_bf16 v[180:183], a[212:215], v[204:207], v[180:183]
    v_mfma_f32_16x16x32_bf16 v[184:187], a[216:219], v[204:207], v[184:187]
    v_mfma_f32_16x16x32_bf16 v[188:191], a[220:223], v[204:207], v[188:191]
    s_waitcnt vmcnt(29)
    v_mfma_f32_16x16x32_bf16 v[92:95], a[220:223], v[192:195], v[92:95]
    v_mfma_f32_16x16x32_bf16 v[88:91], a[216:219], v[192:195], v[88:91]
    v_mfma_f32_16x16x32_bf16 v[84:87], a[212:215], v[192:195], v[84:87]
    v_mfma_f32_16x16x32_bf16 v[80:83], a[208:211], v[192:195], v[80:83]
    v_mfma_f32_16x16x32_bf16 v[76:79], a[204:207], v[192:195], v[76:79]
    v_mfma_f32_16x16x32_bf16 v[72:75], a[200:203], v[192:195], v[72:75]
    v_mfma_f32_16x16x32_bf16 v[68:71], a[196:199], v[192:195], v[68:71]
    v_mfma_f32_16x16x32_bf16 v[64:67], a[192:195], v[192:195], v[64:67]
    s_waitcnt lgkmcnt(0) vmcnt(28)
    v_mfma_f32_16x16x32_bf16 v[96:99], a[224:227], v[212:215], v[96:99]
    s_bfe_u32 s61, s40, 0x4000c
    v_mfma_f32_16x16x32_bf16 v[100:103], a[228:231], v[212:215], v[100:103]
    s_lshl_b32 s61, s61, 12
    ds_read_b64_tr_b16 a[192:193], v16 offset:49152
    ds_read_b64_tr_b16 a[194:195], v16 offset:53248
    v_mfma_f32_16x16x32_bf16 v[104:107], a[232:235], v[212:215], v[104:107]
    s_add_u32 m0, s85, 32768
    buffer_load_dwordx4 v[196:199], v37, s[20:23], s61 offen offset:0 sc1
    v_mfma_f32_16x16x32_bf16 v[108:111], a[236:239], v[212:215], v[108:111]
    ds_read_b64_tr_b16 a[196:197], v17 offset:49152
    ds_read_b64_tr_b16 a[198:199], v17 offset:53248
    v_mfma_f32_16x16x32_bf16 v[112:115], a[240:243], v[212:215], v[112:115]
    buffer_load_dwordx4 v28, s[8:11], s47 offen offset:0 lds
    v_mfma_f32_16x16x32_bf16 v[116:119], a[244:247], v[212:215], v[116:119]
    ds_read_b64_tr_b16 a[200:201], v18 offset:49152
    ds_read_b64_tr_b16 a[202:203], v18 offset:53248
    v_mfma_f32_16x16x32_bf16 v[120:123], a[248:251], v[212:215], v[120:123]
    buffer_load_dwordx4 v[200:203], v38, s[20:23], s61 offen offset:0 sc1
    v_mfma_f32_16x16x32_bf16 v[124:127], a[252:255], v[212:215], v[124:127]
    s_waitcnt vmcnt(30)
    ds_read_b64_tr_b16 a[204:205], v19 offset:49152
    ds_read_b64_tr_b16 a[206:207], v19 offset:53248
    v_mfma_f32_16x16x32_bf16 v[156:159], a[252:255], v[216:219], v[156:159]
    v_mfma_f32_16x16x32_bf16 v[152:155], a[248:251], v[216:219], v[152:155]
    ds_read_b64_tr_b16 a[208:209], v20 offset:49152
    ds_read_b64_tr_b16 a[210:211], v20 offset:53248
    v_mfma_f32_16x16x32_bf16 v[148:151], a[244:247], v[216:219], v[148:151]
    buffer_load_dwordx4 v[204:207], v39, s[20:23], s61 offen offset:0 sc1
    v_mfma_f32_16x16x32_bf16 v[144:147], a[240:243], v[216:219], v[144:147]
    ds_read_b64_tr_b16 a[212:213], v21 offset:49152
    ds_read_b64_tr_b16 a[214:215], v21 offset:53248
    v_mfma_f32_16x16x32_bf16 v[140:143], a[236:239], v[216:219], v[140:143]
    buffer_load_dwordx4 v29, s[8:11], s47 offen offset:1024 lds
    v_mfma_f32_16x16x32_bf16 v[136:139], a[232:235], v[216:219], v[136:139]
    ds_read_b64_tr_b16 a[216:217], v22 offset:49152
    ds_read_b64_tr_b16 a[218:219], v22 offset:53248
    v_mfma_f32_16x16x32_bf16 v[132:135], a[228:231], v[216:219], v[132:135]
    buffer_load_dwordx4 v[192:195], v36, s[20:23], s61 offen offset:0 sc1
    v_mfma_f32_16x16x32_bf16 v[128:131], a[224:227], v[216:219], v[128:131]
    s_waitcnt vmcnt(32)
    ds_read_b64_tr_b16 a[220:221], v23 offset:49152
    ds_read_b64_tr_b16 a[222:223], v23 offset:53248
    v_mfma_f32_16x16x32_bf16 v[160:163], a[224:227], v[220:223], v[160:163]
    v_mfma_f32_16x16x32_bf16 v[164:167], a[228:231], v[220:223], v[164:167]
    v_mfma_f32_16x16x32_bf16 v[168:171], a[232:235], v[220:223], v[168:171]
    buffer_load_dwordx4 v30, s[8:11], s47 offen offset:2048 lds
    v_mfma_f32_16x16x32_bf16 v[172:175], a[236:239], v[220:223], v[172:175]
    v_mfma_f32_16x16x32_bf16 v[176:179], a[240:243], v[220:223], v[176:179]
    v_mfma_f32_16x16x32_bf16 v[180:183], a[244:247], v[220:223], v[180:183]
    v_mfma_f32_16x16x32_bf16 v[184:187], a[248:251], v[220:223], v[184:187]
    v_mfma_f32_16x16x32_bf16 v[188:191], a[252:255], v[220:223], v[188:191]
    s_waitcnt vmcnt(32)
    v_mfma_f32_16x16x32_bf16 v[92:95], a[252:255], v[208:211], v[92:95]
    buffer_load_dwordx4 v31, s[8:11], s47 offen offset:3072 lds
    v_mfma_f32_16x16x32_bf16 v[88:91], a[248:251], v[208:211], v[88:91]
    s_add_u32 m0, s85, 36864
    v_mfma_f32_16x16x32_bf16 v[84:87], a[244:247], v[208:211], v[84:87]
    s_add_u32 s47, s47, 20480
    v_mfma_f32_16x16x32_bf16 v[80:83], a[240:243], v[208:211], v[80:83]
    v_mfma_f32_16x16x32_bf16 v[76:79], a[236:239], v[208:211], v[76:79]
    v_mfma_f32_16x16x32_bf16 v[72:75], a[232:235], v[208:211], v[72:75]
    v_mfma_f32_16x16x32_bf16 v[68:71], a[228:231], v[208:211], v[68:71]
    buffer_load_dwordx4 v28, s[8:11], s47 offen offset:0 lds
    v_mfma_f32_16x16x32_bf16 v[64:67], a[224:227], v[208:211], v[64:67]
    s_waitcnt lgkmcnt(0) vmcnt(32)
    v_mfma_f32_16x16x32_bf16 v[96:99], a[192:195], v[228:231], v[96:99]
    buffer_load_dwordx4 v[212:215], v37, s[20:23], s61 offen offset:1024 sc1
    v_mfma_f32_16x16x32_bf16 v[100:103], a[196:199], v[228:231], v[100:103]
    ds_read_b64_tr_b16 a[224:225], v16 offset:57344
    ds_read_b64_tr_b16 a[226:227], v16 offset:61440
    v_mfma_f32_16x16x32_bf16 v[104:107], a[200:203], v[228:231], v[104:107]
    v_mfma_f32_16x16x32_bf16 v[108:111], a[204:207], v[228:231], v[108:111]
    ds_read_b64_tr_b16 a[228:229], v17 offset:57344
    ds_read_b64_tr_b16 a[230:231], v17 offset:61440
    v_mfma_f32_16x16x32_bf16 v[112:115], a[208:211], v[228:231], v[112:115]
    buffer_load_dwordx4 v[216:219], v38, s[20:23], s61 offen offset:1024 sc1
    v_mfma_f32_16x16x32_bf16 v[116:119], a[212:215], v[228:231], v[116:119]
    ds_read_b64_tr_b16 a[232:233], v18 offset:57344
    ds_read_b64_tr_b16 a[234:235], v18 offset:61440
    v_mfma_f32_16x16x32_bf16 v[120:123], a[216:219], v[228:231], v[120:123]
    buffer_load_dwordx4 v29, s[8:11], s47 offen offset:1024 lds
    v_mfma_f32_16x16x32_bf16 v[124:127], a[220:223], v[228:231], v[124:127]
    s_waitcnt vmcnt(34)
    ds_read_b64_tr_b16 a[236:237], v19 offset:57344
    ds_read_b64_tr_b16 a[238:239], v19 offset:61440
    v_mfma_f32_16x16x32_bf16 v[156:159], a[220:223], v[232:235], v[156:159]
    buffer_load_dwordx4 v[220:223], v39, s[20:23], s61 offen offset:1024 sc1
    v_mfma_f32_16x16x32_bf16 v[152:155], a[216:219], v[232:235], v[152:155]
    ds_read_b64_tr_b16 a[240:241], v20 offset:57344
    ds_read_b64_tr_b16 a[242:243], v20 offset:61440
    v_mfma_f32_16x16x32_bf16 v[148:151], a[212:215], v[232:235], v[148:151]
    v_mfma_f32_16x16x32_bf16 v[144:147], a[208:211], v[232:235], v[144:147]
    ds_read_b64_tr_b16 a[244:245], v21 offset:57344
    ds_read_b64_tr_b16 a[246:247], v21 offset:61440
    v_mfma_f32_16x16x32_bf16 v[140:143], a[204:207], v[232:235], v[140:143]
    buffer_load_dwordx4 v[208:211], v36, s[20:23], s61 offen offset:1024 sc1
    v_mfma_f32_16x16x32_bf16 v[136:139], a[200:203], v[232:235], v[136:139]
    ds_read_b64_tr_b16 a[248:249], v22 offset:57344
    ds_read_b64_tr_b16 a[250:251], v22 offset:61440
    v_mfma_f32_16x16x32_bf16 v[132:135], a[196:199], v[232:235], v[132:135]
    buffer_load_dwordx4 v30, s[8:11], s47 offen offset:2048 lds
    v_mfma_f32_16x16x32_bf16 v[128:131], a[192:195], v[232:235], v[128:131]
    s_waitcnt vmcnt(36)
    ds_read_b64_tr_b16 a[252:253], v23 offset:57344
    ds_read_b64_tr_b16 a[254:255], v23 offset:61440
    v_mfma_f32_16x16x32_bf16 v[160:163], a[192:195], v[236:239], v[160:163]
    v_mfma_f32_16x16x32_bf16 v[164:167], a[196:199], v[236:239], v[164:167]
    v_mfma_f32_16x16x32_bf16 v[168:171], a[200:203], v[236:239], v[168:171]
    v_mfma_f32_16x16x32_bf16 v[172:175], a[204:207], v[236:239], v[172:175]
    v_mfma_f32_16x16x32_bf16 v[176:179], a[208:211], v[236:239], v[176:179]
    buffer_load_dwordx4 v31, s[8:11], s47 offen offset:3072 lds
    v_mfma_f32_16x16x32_bf16 v[180:183], a[212:215], v[236:239], v[180:183]
    s_add_u32 m0, s84, 0
    v_mfma_f32_16x16x32_bf16 v[184:187], a[216:219], v[236:239], v[184:187]
    v_mfma_f32_16x16x32_bf16 v[188:191], a[220:223], v[236:239], v[188:191]
    s_waitcnt vmcnt(36)
    v_mfma_f32_16x16x32_bf16 v[92:95], a[220:223], v[224:227], v[92:95]
    v_mfma_f32_16x16x32_bf16 v[88:91], a[216:219], v[224:227], v[88:91]
    v_mfma_f32_16x16x32_bf16 v[84:87], a[212:215], v[224:227], v[84:87]
    buffer_load_dwordx4 v28, s[8:11], s48 offen offset:0 lds
    v_mfma_f32_16x16x32_bf16 v[80:83], a[208:211], v[224:227], v[80:83]
    v_mfma_f32_16x16x32_bf16 v[76:79], a[204:207], v[224:227], v[76:79]
    v_mfma_f32_16x16x32_bf16 v[72:75], a[200:203], v[224:227], v[72:75]
    v_mfma_f32_16x16x32_bf16 v[68:71], a[196:199], v[224:227], v[68:71]
    v_mfma_f32_16x16x32_bf16 v[64:67], a[192:195], v[224:227], v[64:67]
    s_waitcnt lgkmcnt(0) vmcnt(36)
    v_mfma_f32_16x16x32_bf16 v[96:99], a[224:227], v[244:247], v[96:99]
    buffer_load_dwordx4 v[228:231], v37, s[20:23], s61 offen offset:2048 sc1
    v_mfma_f32_16x16x32_bf16 v[100:103], a[228:231], v[244:247], v[100:103]
    ds_read_b64_tr_b16 a[192:193], v44 offset:0
    ds_read_b64_tr_b16 a[194:195], v44 offset:4096
    v_mfma_f32_16x16x32_bf16 v[104:107], a[232:235], v[244:247], v[104:107]
    buffer_load_dwordx4 v29, s[8:11], s48 offen offset:1024 lds
    v_mfma_f32_16x16x32_bf16 v[108:111], a[236:239], v[244:247], v[108:111]
    ds_read_b64_tr_b16 a[196:197], v45 offset:0
    ds_read_b64_tr_b16 a[198:199], v45 offset:4096
    v_mfma_f32_16x16x32_bf16 v[112:115], a[240:243], v[244:247], v[112:115]
    buffer_load_dwordx4 v[232:235], v38, s[20:23], s61 offen offset:2048 sc1
    v_mfma_f32_16x16x32_bf16 v[116:119], a[244:247], v[244:247], v[116:119]
    ds_read_b64_tr_b16 a[200:201], v46 offset:0
    ds_read_b64_tr_b16 a[202:203], v46 offset:4096
    v_mfma_f32_16x16x32_bf16 v[120:123], a[248:251], v[244:247], v[120:123]
    v_mfma_f32_16x16x32_bf16 v[124:127], a[252:255], v[244:247], v[124:127]
    s_waitcnt vmcnt(38)
    ds_read_b64_tr_b16 a[204:205], v47 offset:0
    ds_read_b64_tr_b16 a[206:207], v47 offset:4096
    v_mfma_f32_16x16x32_bf16 v[156:159], a[252:255], v[248:251], v[156:159]
    buffer_load_dwordx4 v[236:239], v39, s[20:23], s61 offen offset:2048 sc1
    v_mfma_f32_16x16x32_bf16 v[152:155], a[248:251], v[248:251], v[152:155]
    ds_read_b64_tr_b16 a[208:209], v48 offset:0
    ds_read_b64_tr_b16 a[210:211], v48 offset:4096
    v_mfma_f32_16x16x32_bf16 v[148:151], a[244:247], v[248:251], v[148:151]
    buffer_load_dwordx4 v30, s[8:11], s48 offen offset:2048 lds
    v_mfma_f32_16x16x32_bf16 v[144:147], a[240:243], v[248:251], v[144:147]
    ds_read_b64_tr_b16 a[212:213], v49 offset:0
    ds_read_b64_tr_b16 a[214:215], v49 offset:4096
    v_mfma_f32_16x16x32_bf16 v[140:143], a[236:239], v[248:251], v[140:143]
    buffer_load_dwordx4 v[224:227], v36, s[20:23], s61 offen offset:2048 sc1
    v_mfma_f32_16x16x32_bf16 v[136:139], a[232:235], v[248:251], v[136:139]
    ds_read_b64_tr_b16 a[216:217], v50 offset:0
    ds_read_b64_tr_b16 a[218:219], v50 offset:4096
    v_mfma_f32_16x16x32_bf16 v[132:135], a[228:231], v[248:251], v[132:135]
    v_mfma_f32_16x16x32_bf16 v[128:131], a[224:227], v[248:251], v[128:131]
    s_waitcnt vmcnt(40)
    ds_read_b64_tr_b16 a[220:221], v51 offset:0
    ds_read_b64_tr_b16 a[222:223], v51 offset:4096
    v_mfma_f32_16x16x32_bf16 v[160:163], a[224:227], v[252:255], v[160:163]
    buffer_load_dwordx4 v31, s[8:11], s48 offen offset:3072 lds
    v_mfma_f32_16x16x32_bf16 v[164:167], a[228:231], v[252:255], v[164:167]
    s_add_u32 m0, s84, 4096
    v_mfma_f32_16x16x32_bf16 v[168:171], a[232:235], v[252:255], v[168:171]
    s_add_u32 s48, s48, 20480
    v_mfma_f32_16x16x32_bf16 v[172:175], a[236:239], v[252:255], v[172:175]
    v_mfma_f32_16x16x32_bf16 v[176:179], a[240:243], v[252:255], v[176:179]
    v_mfma_f32_16x16x32_bf16 v[180:183], a[244:247], v[252:255], v[180:183]
    v_mfma_f32_16x16x32_bf16 v[184:187], a[248:251], v[252:255], v[184:187]
    buffer_load_dwordx4 v28, s[8:11], s48 offen offset:0 lds
    v_mfma_f32_16x16x32_bf16 v[188:191], a[252:255], v[252:255], v[188:191]
    s_waitcnt vmcnt(41)
    v_mfma_f32_16x16x32_bf16 v[92:95], a[252:255], v[240:243], v[92:95]
    v_mfma_f32_16x16x32_bf16 v[88:91], a[248:251], v[240:243], v[88:91]
    v_mfma_f32_16x16x32_bf16 v[84:87], a[244:247], v[240:243], v[84:87]
    v_mfma_f32_16x16x32_bf16 v[80:83], a[240:243], v[240:243], v[80:83]
    v_mfma_f32_16x16x32_bf16 v[76:79], a[236:239], v[240:243], v[76:79]
    buffer_load_dwordx4 v29, s[8:11], s48 offen offset:1024 lds
    v_mfma_f32_16x16x32_bf16 v[72:75], a[232:235], v[240:243], v[72:75]
    v_mfma_f32_16x16x32_bf16 v[68:71], a[228:231], v[240:243], v[68:71]
    v_mfma_f32_16x16x32_bf16 v[64:67], a[224:227], v[240:243], v[64:67]
    s_waitcnt lgkmcnt(0) vmcnt(41)
    v_mfma_f32_16x16x32_bf16 v[96:99], a[192:195], a[132:135], v[96:99]
    buffer_load_dwordx4 v[244:247], v37, s[20:23], s61 offen offset:3072 sc1
    v_mfma_f32_16x16x32_bf16 v[100:103], a[196:199], a[132:135], v[100:103]
    ds_read_b64_tr_b16 a[224:225], v44 offset:8192
    ds_read_b64_tr_b16 a[226:227], v44 offset:12288
    v_mfma_f32_16x16x32_bf16 v[104:107], a[200:203], a[132:135], v[104:107]
    buffer_load_dwordx4 v30, s[8:11], s48 offen offset:2048 lds
    v_mfma_f32_16x16x32_bf16 v[108:111], a[204:207], a[132:135], v[108:111]
    ds_read_b64_tr_b16 a[228:229], v45 offset:8192
    ds_read_b64_tr_b16 a[230:231], v45 offset:12288
    v_mfma_f32_16x16x32_bf16 v[112:115], a[208:211], a[132:135], v[112:115]
    buffer_load_dwordx4 v[248:251], v38, s[20:23], s61 offen offset:3072 sc1
    v_mfma_f32_16x16x32_bf16 v[116:119], a[212:215], a[132:135], v[116:119]
    ds_read_b64_tr_b16 a[232:233], v46 offset:8192
    ds_read_b64_tr_b16 a[234:235], v46 offset:12288
    v_mfma_f32_16x16x32_bf16 v[120:123], a[216:219], a[132:135], v[120:123]
    v_mfma_f32_16x16x32_bf16 v[124:127], a[220:223], a[132:135], v[124:127]
    s_waitcnt vmcnt(43)
    ds_read_b64_tr_b16 a[236:237], v47 offset:8192
    ds_read_b64_tr_b16 a[238:239], v47 offset:12288
    v_mfma_f32_16x16x32_bf16 v[156:159], a[220:223], a[136:139], v[156:159]
    buffer_load_dwordx4 v[252:255], v39, s[20:23], s61 offen offset:3072 sc1
    v_mfma_f32_16x16x32_bf16 v[152:155], a[216:219], a[136:139], v[152:155]
    ds_read_b64_tr_b16 a[240:241], v48 offset:8192
    ds_read_b64_tr_b16 a[242:243], v48 offset:12288
    v_mfma_f32_16x16x32_bf16 v[148:151], a[212:215], a[136:139], v[148:151]
    buffer_load_dwordx4 v31, s[8:11], s48 offen offset:3072 lds
    v_mfma_f32_16x16x32_bf16 v[144:147], a[208:211], a[136:139], v[144:147]
    ds_read_b64_tr_b16 a[244:245], v49 offset:8192
    ds_read_b64_tr_b16 a[246:247], v49 offset:12288
    v_mfma_f32_16x16x32_bf16 v[140:143], a[204:207], a[136:139], v[140:143]
    buffer_load_dwordx4 v[240:243], v36, s[20:23], s61 offen offset:3072 sc1
    v_mfma_f32_16x16x32_bf16 v[136:139], a[200:203], a[136:139], v[136:139]
    ds_read_b64_tr_b16 a[248:249], v50 offset:8192
    ds_read_b64_tr_b16 a[250:251], v50 offset:12288
    v_mfma_f32_16x16x32_bf16 v[132:135], a[196:199], a[136:139], v[132:135]
    v_mfma_f32_16x16x32_bf16 v[128:131], a[192:195], a[136:139], v[128:131]
    s_waitcnt vmcnt(45)
    ds_read_b64_tr_b16 a[252:253], v51 offset:8192
    ds_read_b64_tr_b16 a[254:255], v51 offset:12288
    v_mfma_f32_16x16x32_bf16 v[160:163], a[192:195], a[140:143], v[160:163]
    v_mfma_f32_16x16x32_bf16 v[164:167], a[196:199], a[140:143], v[164:167]
    v_mfma_f32_16x16x32_bf16 v[168:171], a[200:203], a[140:143], v[168:171]
    v_mfma_f32_16x16x32_bf16 v[172:175], a[204:207], a[140:143], v[172:175]
    v_mfma_f32_16x16x32_bf16 v[176:179], a[208:211], a[140:143], v[176:179]
    v_mfma_f32_16x16x32_bf16 v[180:183], a[212:215], a[140:143], v[180:183]
    v_mfma_f32_16x16x32_bf16 v[184:187], a[216:219], a[140:143], v[184:187]
    v_mfma_f32_16x16x32_bf16 v[188:191], a[220:223], a[140:143], v[188:191]
    s_waitcnt vmcnt(44)
    v_mfma_f32_16x16x32_bf16 v[92:95], a[220:223], a[128:131], v[92:95]
    v_mfma_f32_16x16x32_bf16 v[88:91], a[216:219], a[128:131], v[88:91]
    v_mfma_f32_16x16x32_bf16 v[84:87], a[212:215], a[128:131], v[84:87]
    v_mfma_f32_16x16x32_bf16 v[80:83], a[208:211], a[128:131], v[80:83]
    v_mfma_f32_16x16x32_bf16 v[76:79], a[204:207], a[128:131], v[76:79]
    v_mfma_f32_16x16x32_bf16 v[72:75], a[200:203], a[128:131], v[72:75]
    v_mfma_f32_16x16x32_bf16 v[68:71], a[196:199], a[128:131], v[68:71]
    v_mfma_f32_16x16x32_bf16 v[64:67], a[192:195], a[128:131], v[64:67]
    s_waitcnt lgkmcnt(0) vmcnt(43)
    v_mfma_f32_16x16x32_bf16 v[96:99], a[224:227], a[148:151], v[96:99]
    s_bfe_u32 s61, s40, 0x40010
    v_mfma_f32_16x16x32_bf16 v[100:103], a[228:231], a[148:151], v[100:103]
    s_lshl_b32 s61, s61, 12
    ds_read_b64_tr_b16 a[192:193], v44 offset:16384
    ds_read_b64_tr_b16 a[194:195], v44 offset:20480
    v_mfma_f32_16x16x32_bf16 v[104:107], a[232:235], a[148:151], v[104:107]
    buffer_load_dwordx4 a[132:135], v37, s[20:23], s61 offen offset:0 sc1
    v_mfma_f32_16x16x32_bf16 v[108:111], a[236:239], a[148:151], v[108:111]
    ds_read_b64_tr_b16 a[196:197], v45 offset:16384
    ds_read_b64_tr_b16 a[198:199], v45 offset:20480
    v_mfma_f32_16x16x32_bf16 v[112:115], a[240:243], a[148:151], v[112:115]
    v_mfma_f32_16x16x32_bf16 v[116:119], a[244:247], a[148:151], v[116:119]
    ds_read_b64_tr_b16 a[200:201], v46 offset:16384
    ds_read_b64_tr_b16 a[202:203], v46 offset:20480
    v_mfma_f32_16x16x32_bf16 v[120:123], a[248:251], a[148:151], v[120:123]
    buffer_load_dwordx4 a[136:139], v38, s[20:23], s61 offen offset:0 sc1
    v_mfma_f32_16x16x32_bf16 v[124:127], a[252:255], a[148:151], v[124:127]
    s_waitcnt vmcnt(44)
    ds_read_b64_tr_b16 a[204:205], v47 offset:16384
    ds_read_b64_tr_b16 a[206:207], v47 offset:20480
    v_mfma_f32_16x16x32_bf16 v[156:159], a[252:255], a[152:155], v[156:159]
    v_mfma_f32_16x16x32_bf16 v[152:155], a[248:251], a[152:155], v[152:155]
    ds_read_b64_tr_b16 a[208:209], v48 offset:16384
    ds_read_b64_tr_b16 a[210:211], v48 offset:20480
    v_mfma_f32_16x16x32_bf16 v[148:151], a[244:247], a[152:155], v[148:151]
    buffer_load_dwordx4 a[140:143], v39, s[20:23], s61 offen offset:0 sc1
    v_mfma_f32_16x16x32_bf16 v[144:147], a[240:243], a[152:155], v[144:147]
    ds_read_b64_tr_b16 a[212:213], v49 offset:16384
    ds_read_b64_tr_b16 a[214:215], v49 offset:20480
    v_mfma_f32_16x16x32_bf16 v[140:143], a[236:239], a[152:155], v[140:143]
    v_mfma_f32_16x16x32_bf16 v[136:139], a[232:235], a[152:155], v[136:139]
    ds_read_b64_tr_b16 a[216:217], v50 offset:16384
    ds_read_b64_tr_b16 a[218:219], v50 offset:20480
    v_mfma_f32_16x16x32_bf16 v[132:135], a[228:231], a[152:155], v[132:135]
    buffer_load_dwordx4 a[128:131], v36, s[20:23], s61 offen offset:0 sc1
    v_mfma_f32_16x16x32_bf16 v[128:131], a[224:227], a[152:155], v[128:131]
    s_waitcnt vmcnt(45)
    ds_read_b64_tr_b16 a[220:221], v51 offset:16384
    ds_read_b64_tr_b16 a[222:223], v51 offset:20480
    v_mfma_f32_16x16x32_bf16 v[160:163], a[224:227], a[156:159], v[160:163]
    v_mfma_f32_16x16x32_bf16 v[164:167], a[228:231], a[156:159], v[164:167]
    v_mfma_f32_16x16x32_bf16 v[168:171], a[232:235], a[156:159], v[168:171]
    v_mfma_f32_16x16x32_bf16 v[172:175], a[236:239], a[156:159], v[172:175]
    v_mfma_f32_16x16x32_bf16 v[176:179], a[240:243], a[156:159], v[176:179]
    v_mfma_f32_16x16x32_bf16 v[180:183], a[244:247], a[156:159], v[180:183]
    v_mfma_f32_16x16x32_bf16 v[184:187], a[248:251], a[156:159], v[184:187]
    v_mfma_f32_16x16x32_bf16 v[188:191], a[252:255], a[156:159], v[188:191]
    s_waitcnt vmcnt(44)
    v_mfma_f32_16x16x32_bf16 v[92:95], a[252:255], a[144:147], v[92:95]
    v_mfma_f32_16x16x32_bf16 v[88:91], a[248:251], a[144:147], v[88:91]
    v_mfma_f32_16x16x32_bf16 v[84:87], a[244:247], a[144:147], v[84:87]
    v_mfma_f32_16x16x32_bf16 v[80:83], a[240:243], a[144:147], v[80:83]
    v_mfma_f32_16x16x32_bf16 v[76:79], a[236:239], a[144:147], v[76:79]
    v_mfma_f32_16x16x32_bf16 v[72:75], a[232:235], a[144:147], v[72:75]
    v_mfma_f32_16x16x32_bf16 v[68:71], a[228:231], a[144:147], v[68:71]
    v_mfma_f32_16x16x32_bf16 v[64:67], a[224:227], a[144:147], v[64:67]
    s_waitcnt lgkmcnt(0) vmcnt(43)
    v_mfma_f32_16x16x32_bf16 v[96:99], a[192:195], a[164:167], v[96:99]
    buffer_load_dwordx4 a[148:151], v37, s[20:23], s61 offen offset:1024 sc1
    v_mfma_f32_16x16x32_bf16 v[100:103], a[196:199], a[164:167], v[100:103]
    ds_read_b64_tr_b16 a[224:225], v44 offset:24576
    ds_read_b64_tr_b16 a[226:227], v44 offset:28672
    v_mfma_f32_16x16x32_bf16 v[104:107], a[200:203], a[164:167], v[104:107]
    v_mfma_f32_16x16x32_bf16 v[108:111], a[204:207], a[164:167], v[108:111]
    ds_read_b64_tr_b16 a[228:229], v45 offset:24576
    ds_read_b64_tr_b16 a[230:231], v45 offset:28672
    v_mfma_f32_16x16x32_bf16 v[112:115], a[208:211], a[164:167], v[112:115]
    buffer_load_dwordx4 a[152:155], v38, s[20:23], s61 offen offset:1024 sc1
    v_mfma_f32_16x16x32_bf16 v[116:119], a[212:215], a[164:167], v[116:119]
    ds_read_b64_tr_b16 a[232:233], v46 offset:24576
    ds_read_b64_tr_b16 a[234:235], v46 offset:28672
    v_mfma_f32_16x16x32_bf16 v[120:123], a[216:219], a[164:167], v[120:123]
    v_mfma_f32_16x16x32_bf16 v[124:127], a[220:223], a[164:167], v[124:127]
    s_waitcnt vmcnt(44)
    ds_read_b64_tr_b16 a[236:237], v47 offset:24576
    ds_read_b64_tr_b16 a[238:239], v47 offset:28672
    v_mfma_f32_16x16x32_bf16 v[156:159], a[220:223], a[168:171], v[156:159]
    buffer_load_dwordx4 a[156:159], v39, s[20:23], s61 offen offset:1024 sc1
    v_mfma_f32_16x16x32_bf16 v[152:155], a[216:219], a[168:171], v[152:155]
    ds_read_b64_tr_b16 a[240:241], v48 offset:24576
    ds_read_b64_tr_b16 a[242:243], v48 offset:28672
    v_mfma_f32_16x16x32_bf16 v[148:151], a[212:215], a[168:171], v[148:151]
    v_mfma_f32_16x16x32_bf16 v[144:147], a[208:211], a[168:171], v[144:147]
    ds_read_b64_tr_b16 a[244:245], v49 offset:24576
    ds_read_b64_tr_b16 a[246:247], v49 offset:28672
    v_mfma_f32_16x16x32_bf16 v[140:143], a[204:207], a[168:171], v[140:143]
    buffer_load_dwordx4 a[144:147], v36, s[20:23], s61 offen offset:1024 sc1
    v_mfma_f32_16x16x32_bf16 v[136:139], a[200:203], a[168:171], v[136:139]
    ds_read_b64_tr_b16 a[248:249], v50 offset:24576
    ds_read_b64_tr_b16 a[250:251], v50 offset:28672
    v_mfma_f32_16x16x32_bf16 v[132:135], a[196:199], a[168:171], v[132:135]
    v_mfma_f32_16x16x32_bf16 v[128:131], a[192:195], a[168:171], v[128:131]
    s_waitcnt vmcnt(45)
    ds_read_b64_tr_b16 a[252:253], v51 offset:24576
    ds_read_b64_tr_b16 a[254:255], v51 offset:28672
    v_mfma_f32_16x16x32_bf16 v[160:163], a[192:195], a[172:175], v[160:163]
    v_mfma_f32_16x16x32_bf16 v[164:167], a[196:199], a[172:175], v[164:167]
    v_mfma_f32_16x16x32_bf16 v[168:171], a[200:203], a[172:175], v[168:171]
    v_mfma_f32_16x16x32_bf16 v[172:175], a[204:207], a[172:175], v[172:175]
    v_mfma_f32_16x16x32_bf16 v[176:179], a[208:211], a[172:175], v[176:179]
    v_mfma_f32_16x16x32_bf16 v[180:183], a[212:215], a[172:175], v[180:183]
    v_mfma_f32_16x16x32_bf16 v[184:187], a[216:219], a[172:175], v[184:187]
    v_mfma_f32_16x16x32_bf16 v[188:191], a[220:223], a[172:175], v[188:191]
    s_waitcnt vmcnt(44)
    v_mfma_f32_16x16x32_bf16 v[92:95], a[220:223], a[160:163], v[92:95]
    v_mfma_f32_16x16x32_bf16 v[88:91], a[216:219], a[160:163], v[88:91]
    v_mfma_f32_16x16x32_bf16 v[84:87], a[212:215], a[160:163], v[84:87]
    v_mfma_f32_16x16x32_bf16 v[80:83], a[208:211], a[160:163], v[80:83]
    v_mfma_f32_16x16x32_bf16 v[76:79], a[204:207], a[160:163], v[76:79]
    v_mfma_f32_16x16x32_bf16 v[72:75], a[200:203], a[160:163], v[72:75]
    v_mfma_f32_16x16x32_bf16 v[68:71], a[196:199], a[160:163], v[68:71]
    v_mfma_f32_16x16x32_bf16 v[64:67], a[192:195], a[160:163], v[64:67]
    s_waitcnt lgkmcnt(0) vmcnt(43)
    v_mfma_f32_16x16x32_bf16 v[96:99], a[224:227], a[180:183], v[96:99]
    s_waitcnt vmcnt(9) lgkmcnt(0)
    buffer_load_dwordx4 a[164:167], v37, s[20:23], s61 offen offset:2048 sc1
    v_mfma_f32_16x16x32_bf16 v[100:103], a[228:231], a[180:183], v[100:103]
    s_barrier
    v_mfma_f32_16x16x32_bf16 v[104:107], a[232:235], a[180:183], v[104:107]
    s_add_u32 m0, s86, 0
    ds_read_b64_tr_b16 a[192:193], v44 offset:32768
    ds_read_b64_tr_b16 a[194:195], v44 offset:36864
    v_mfma_f32_16x16x32_bf16 v[108:111], a[236:239], a[180:183], v[108:111]
    buffer_load_dwordx4 v28, s[8:11], s49 offen offset:0 lds
    v_mfma_f32_16x16x32_bf16 v[112:115], a[240:243], a[180:183], v[112:115]
    ds_read_b64_tr_b16 a[196:197], v45 offset:32768
    ds_read_b64_tr_b16 a[198:199], v45 offset:36864
    v_mfma_f32_16x16x32_bf16 v[116:119], a[244:247], a[180:183], v[116:119]
    buffer_load_dwordx4 a[168:171], v38, s[20:23], s61 offen offset:2048 sc1
    v_mfma_f32_16x16x32_bf16 v[120:123], a[248:251], a[180:183], v[120:123]
    ds_read_b64_tr_b16 a[200:201], v46 offset:32768
    ds_read_b64_tr_b16 a[202:203], v46 offset:36864
    v_mfma_f32_16x16x32_bf16 v[124:127], a[252:255], a[180:183], v[124:127]
    s_waitcnt vmcnt(45)
    v_mfma_f32_16x16x32_bf16 v[156:159], a[252:255], a[184:187], v[156:159]
    ds_read_b64_tr_b16 a[204:205], v47 offset:32768
    ds_read_b64_tr_b16 a[206:207], v47 offset:36864
    v_mfma_f32_16x16x32_bf16 v[152:155], a[248:251], a[184:187], v[152:155]
    buffer_load_dwordx4 a[172:175], v39, s[20:23], s61 offen offset:2048 sc1
    v_mfma_f32_16x16x32_bf16 v[148:151], a[244:247], a[184:187], v[148:151]
    ds_read_b64_tr_b16 a[208:209], v48 offset:32768
    ds_read_b64_tr_b16 a[210:211], v48 offset:36864
    v_mfma_f32_16x16x32_bf16 v[144:147], a[240:243], a[184:187], v[144:147]
    buffer_load_dwordx4 v29, s[8:11], s49 offen offset:1024 lds
    v_mfma_f32_16x16x32_bf16 v[140:143], a[236:239], a[184:187], v[140:143]
    ds_read_b64_tr_b16 a[212:213], v49 offset:32768
    ds_read_b64_tr_b16 a[214:215], v49 offset:36864
    v_mfma_f32_16x16x32_bf16 v[136:139], a[232:235], a[184:187], v[136:139]
    buffer_load_dwordx4 a[160:163], v36, s[20:23], s61 offen offset:2048 sc1
    v_mfma_f32_16x16x32_bf16 v[132:135], a[228:231], a[184:187], v[132:135]
    ds_read_b64_tr_b16 a[216:217], v50 offset:32768
    ds_read_b64_tr_b16 a[218:219], v50 offset:36864
    v_mfma_f32_16x16x32_bf16 v[128:131], a[224:227], a[184:187], v[128:131]
    s_waitcnt vmcnt(47)
    v_mfma_f32_16x16x32_bf16 v[160:163], a[224:227], a[188:191], v[160:163]
    ds_read_b64_tr_b16 a[220:221], v51 offset:32768
    ds_read_b64_tr_b16 a[222:223], v51 offset:36864
    v_mfma_f32_16x16x32_bf16 v[164:167], a[228:231], a[188:191], v[164:167]
    v_mfma_f32_16x16x32_bf16 v[168:171], a[232:235], a[188:191], v[168:171]
    v_mfma_f32_16x16x32_bf16 v[172:175], a[236:239], a[188:191], v[172:175]
    buffer_load_dwordx4 v30, s[8:11], s49 offen offset:2048 lds
    v_mfma_f32_16x16x32_bf16 v[176:179], a[240:243], a[188:191], v[176:179]
    v_mfma_f32_16x16x32_bf16 v[180:183], a[244:247], a[188:191], v[180:183]
    v_mfma_f32_16x16x32_bf16 v[184:187], a[248:251], a[188:191], v[184:187]
    v_mfma_f32_16x16x32_bf16 v[188:191], a[252:255], a[188:191], v[188:191]
    s_waitcnt vmcnt(47)
    v_mfma_f32_16x16x32_bf16 v[92:95], a[252:255], a[176:179], v[92:95]
    v_mfma_f32_16x16x32_bf16 v[88:91], a[248:251], a[176:179], v[88:91]
    v_mfma_f32_16x16x32_bf16 v[84:87], a[244:247], a[176:179], v[84:87]
    v_mfma_f32_16x16x32_bf16 v[80:83], a[240:243], a[176:179], v[80:83]
    buffer_load_dwordx4 v31, s[8:11], s49 offen offset:3072 lds
    v_mfma_f32_16x16x32_bf16 v[76:79], a[236:239], a[176:179], v[76:79]
    s_add_u32 m0, s86, 4096
    v_mfma_f32_16x16x32_bf16 v[72:75], a[232:235], a[176:179], v[72:75]
    s_add_u32 s49, s49, 20480
    v_mfma_f32_16x16x32_bf16 v[68:71], a[228:231], a[176:179], v[68:71]
    v_mfma_f32_16x16x32_bf16 v[64:67], a[224:227], a[176:179], v[64:67]
    s_waitcnt lgkmcnt(0) vmcnt(47)
    v_mfma_f32_16x16x32_bf16 v[96:99], a[192:195], v[196:199], v[96:99]
    buffer_load_dwordx4 a[180:183], v37, s[20:23], s61 offen offset:3072 sc1
    v_mfma_f32_16x16x32_bf16 v[100:103], a[196:199], v[196:199], v[100:103]
    ds_read_b64_tr_b16 a[224:225], v44 offset:40960
    ds_read_b64_tr_b16 a[226:227], v44 offset:45056
    v_mfma_f32_16x16x32_bf16 v[104:107], a[200:203], v[196:199], v[104:107]
    v_mfma_f32_16x16x32_bf16 v[108:111], a[204:207], v[196:199], v[108:111]
    ds_read_b64_tr_b16 a[228:229], v45 offset:40960
    ds_read_b64_tr_b16 a[230:231], v45 offset:45056
    v_mfma_f32_16x16x32_bf16 v[112:115], a[208:211], v[196:199], v[112:115]
    buffer_load_dwordx4 a[184:187], v38, s[20:23], s61 offen offset:3072 sc1
    v_mfma_f32_16x16x32_bf16 v[116:119], a[212:215], v[196:199], v[116:119]
    ds_read_b64_tr_b16 a[232:233], v46 offset:40960
    ds_read_b64_tr_b16 a[234:235], v46 offset:45056
    v_mfma_f32_16x16x32_bf16 v[120:123], a[216:219], v[196:199], v[120:123]
    buffer_load_dwordx4 v28, s[8:11], s49 offen offset:0 lds
    v_mfma_f32_16x16x32_bf16 v[124:127], a[220:223], v[196:199], v[124:127]
    s_waitcnt vmcnt(48)
    ds_read_b64_tr_b16 a[236:237], v47 offset:40960
    ds_read_b64_tr_b16 a[238:239], v47 offset:45056
    v_mfma_f32_16x16x32_bf16 v[156:159], a[220:223], v[200:203], v[156:159]
    buffer_load_dwordx4 a[188:191], v39, s[20:23], s61 offen offset:3072 sc1
    v_mfma_f32_16x16x32_bf16 v[152:155], a[216:219], v[200:203], v[152:155]
    ds_read_b64_tr_b16 a[240:241], v48 offset:40960
    ds_read_b64_tr_b16 a[242:243], v48 offset:45056
    v_mfma_f32_16x16x32_bf16 v[148:151], a[212:215], v[200:203], v[148:151]
    v_mfma_f32_16x16x32_bf16 v[144:147], a[208:211], v[200:203], v[144:147]
    ds_read_b64_tr_b16 a[244:245], v49 offset:40960
    ds_read_b64_tr_b16 a[246:247], v49 offset:45056
    v_mfma_f32_16x16x32_bf16 v[140:143], a[204:207], v[200:203], v[140:143]
    buffer_load_dwordx4 a[176:179], v36, s[20:23], s61 offen offset:3072 sc1
    v_mfma_f32_16x16x32_bf16 v[136:139], a[200:203], v[200:203], v[136:139]
    ds_read_b64_tr_b16 a[248:249], v50 offset:40960
    ds_read_b64_tr_b16 a[250:251], v50 offset:45056
    v_mfma_f32_16x16x32_bf16 v[132:135], a[196:199], v[200:203], v[132:135]
    buffer_load_dwordx4 v29, s[8:11], s49 offen offset:1024 lds
    v_mfma_f32_16x16x32_bf16 v[128:131], a[192:195], v[200:203], v[128:131]
    s_waitcnt vmcnt(50)
    ds_read_b64_tr_b16 a[252:253], v51 offset:40960
    ds_read_b64_tr_b16 a[254:255], v51 offset:45056
    v_mfma_f32_16x16x32_bf16 v[160:163], a[192:195], v[204:207], v[160:163]
    v_mfma_f32_16x16x32_bf16 v[164:167], a[196:199], v[204:207], v[164:167]
    v_mfma_f32_16x16x32_bf16 v[168:171], a[200:203], v[204:207], v[168:171]
    v_mfma_f32_16x16x32_bf16 v[172:175], a[204:207], v[204:207], v[172:175]
    v_mfma_f32_16x16x32_bf16 v[176:179], a[208:211], v[204:207], v[176:179]
    v_mfma_f32_16x16x32_bf16 v[180:183], a[212:215], v[204:207], v[180:183]
    v_mfma_f32_16x16x32_bf16 v[184:187], a[216:219], v[204:207], v[184:187]
    buffer_load_dwordx4 v30, s[8:11], s49 offen offset:2048 lds
    v_mfma_f32_16x16x32_bf16 v[188:191], a[220:223], v[204:207], v[188:191]
    s_waitcnt vmcnt(49)
    v_mfma_f32_16x16x32_bf16 v[92:95], a[220:223], v[192:195], v[92:95]
    v_mfma_f32_16x16x32_bf16 v[88:91], a[216:219], v[192:195], v[88:91]
    v_mfma_f32_16x16x32_bf16 v[84:87], a[212:215], v[192:195], v[84:87]
    v_mfma_f32_16x16x32_bf16 v[80:83], a[208:211], v[192:195], v[80:83]
    v_mfma_f32_16x16x32_bf16 v[76:79], a[204:207], v[192:195], v[76:79]
    v_mfma_f32_16x16x32_bf16 v[72:75], a[200:203], v[192:195], v[72:75]
    v_mfma_f32_16x16x32_bf16 v[68:71], a[196:199], v[192:195], v[68:71]
    s_waitcnt lgkmcnt(0) vmcnt(45)
    buffer_load_dwordx4 v31, s[8:11], s49 offen offset:3072 lds
    v_mfma_f32_16x16x32_bf16 v[64:67], a[192:195], v[192:195], v[64:67]
    s_add_u32 m0, s84, 32768
    v_mfma_f32_16x16x32_bf16 v[96:99], a[224:227], v[212:215], v[96:99]
    s_bfe_u32 s61, s40, 0x40014
    v_mfma_f32_16x16x32_bf16 v[100:103], a[228:231], v[212:215], v[100:103]
    s_lshl_b32 s61, s61, 12
    ds_read_b64_tr_b16 a[192:193], v44 offset:49152
    ds_read_b64_tr_b16 a[194:195], v44 offset:53248
    v_mfma_f32_16x16x32_bf16 v[104:107], a[232:235], v[212:215], v[104:107]
    buffer_load_dwordx4 v[196:199], v37, s[20:23], s61 offen offset:0 sc1
    v_mfma_f32_16x16x32_bf16 v[108:111], a[236:239], v[212:215], v[108:111]
    ds_read_b64_tr_b16 a[196:197], v45 offset:49152
    ds_read_b64_tr_b16 a[198:199], v45 offset:53248
    v_mfma_f32_16x16x32_bf16 v[112:115], a[240:243], v[212:215], v[112:115]
    v_mfma_f32_16x16x32_bf16 v[116:119], a[244:247], v[212:215], v[116:119]
    ds_read_b64_tr_b16 a[200:201], v46 offset:49152
    ds_read_b64_tr_b16 a[202:203], v46 offset:53248
    v_mfma_f32_16x16x32_bf16 v[120:123], a[248:251], v[212:215], v[120:123]
    buffer_load_dwordx4 v[200:203], v38, s[20:23], s61 offen offset:0 sc1
    v_mfma_f32_16x16x32_bf16 v[124:127], a[252:255], v[212:215], v[124:127]
    s_waitcnt vmcnt(47)
    ds_read_b64_tr_b16 a[204:205], v47 offset:49152
    ds_read_b64_tr_b16 a[206:207], v47 offset:53248
    v_mfma_f32_16x16x32_bf16 v[156:159], a[252:255], v[216:219], v[156:159]
    buffer_load_dwordx4 v28, s[8:11], s50 offen offset:0 lds
    v_mfma_f32_16x16x32_bf16 v[152:155], a[248:251], v[216:219], v[152:155]
    ds_read_b64_tr_b16 a[208:209], v48 offset:49152
    ds_read_b64_tr_b16 a[210:211], v48 offset:53248
    v_mfma_f32_16x16x32_bf16 v[148:151], a[244:247], v[216:219], v[148:151]
    buffer_load_dwordx4 v[204:207], v39, s[20:23], s61 offen offset:0 sc1
    v_mfma_f32_16x16x32_bf16 v[144:147], a[240:243], v[216:219], v[144:147]
    ds_read_b64_tr_b16 a[212:213], v49 offset:49152
    ds_read_b64_tr_b16 a[214:215], v49 offset:53248
    v_mfma_f32_16x16x32_bf16 v[140:143], a[236:239], v[216:219], v[140:143]
    v_mfma_f32_16x16x32_bf16 v[136:139], a[232:235], v[216:219], v[136:139]
    ds_read_b64_tr_b16 a[216:217], v50 offset:49152
    ds_read_b64_tr_b16 a[218:219], v50 offset:53248
    v_mfma_f32_16x16x32_bf16 v[132:135], a[228:231], v[216:219], v[132:135]
    buffer_load_dwordx4 v[192:195], v36, s[20:23], s61 offen offset:0 sc1
    v_mfma_f32_16x16x32_bf16 v[128:131], a[224:227], v[216:219], v[128:131]
    s_waitcnt vmcnt(48)
    ds_read_b64_tr_b16 a[220:221], v51 offset:49152
    ds_read_b64_tr_b16 a[222:223], v51 offset:53248
    v_mfma_f32_16x16x32_bf16 v[160:163], a[224:227], v[220:223], v[160:163]
    buffer_load_dwordx4 v29, s[8:11], s50 offen offset:1024 lds
    v_mfma_f32_16x16x32_bf16 v[164:167], a[228:231], v[220:223], v[164:167]
    v_mfma_f32_16x16x32_bf16 v[168:171], a[232:235], v[220:223], v[168:171]
    v_mfma_f32_16x16x32_bf16 v[172:175], a[236:239], v[220:223], v[172:175]
    v_mfma_f32_16x16x32_bf16 v[176:179], a[240:243], v[220:223], v[176:179]
    v_mfma_f32_16x16x32_bf16 v[180:183], a[244:247], v[220:223], v[180:183]
    v_mfma_f32_16x16x32_bf16 v[184:187], a[248:251], v[220:223], v[184:187]
    v_mfma_f32_16x16x32_bf16 v[188:191], a[252:255], v[220:223], v[188:191]
    s_waitcnt vmcnt(48)
    v_mfma_f32_16x16x32_bf16 v[92:95], a[252:255], v[208:211], v[92:95]
    buffer_load_dwordx4 v30, s[8:11], s50 offen offset:2048 lds
    v_mfma_f32_16x16x32_bf16 v[88:91], a[248:251], v[208:211], v[88:91]
    v_mfma_f32_16x16x32_bf16 v[84:87], a[244:247], v[208:211], v[84:87]
    v_mfma_f32_16x16x32_bf16 v[80:83], a[240:243], v[208:211], v[80:83]
    v_mfma_f32_16x16x32_bf16 v[76:79], a[236:239], v[208:211], v[76:79]
    v_mfma_f32_16x16x32_bf16 v[72:75], a[232:235], v[208:211], v[72:75]
    v_mfma_f32_16x16x32_bf16 v[68:71], a[228:231], v[208:211], v[68:71]
    v_mfma_f32_16x16x32_bf16 v[64:67], a[224:227], v[208:211], v[64:67]
    s_waitcnt lgkmcnt(0) vmcnt(45)
    v_mfma_f32_16x16x32_bf16 v[96:99], a[192:195], v[228:231], v[96:99]
    buffer_load_dwordx4 v[212:215], v37, s[20:23], s61 offen offset:1024 sc1
    v_mfma_f32_16x16x32_bf16 v[100:103], a[196:199], v[228:231], v[100:103]
    ds_read_b64_tr_b16 a[224:225], v44 offset:57344
    ds_read_b64_tr_b16 a[226:227], v44 offset:61440
    v_mfma_f32_16x16x32_bf16 v[104:107], a[200:203], v[228:231], v[104:107]
    buffer_load_dwordx4 v31, s[8:11], s50 offen offset:3072 lds
    v_mfma_f32_16x16x32_bf16 v[108:111], a[204:207], v[228:231], v[108:111]
    s_add_u32 m0, s84, 36864
    ds_read_b64_tr_b16 a[228:229], v45 offset:57344
    ds_read_b64_tr_b16 a[230:231], v45 offset:61440
    v_mfma_f32_16x16x32_bf16 v[112:115], a[208:211], v[228:231], v[112:115]
    s_add_u32 s50, s50, 20480
    buffer_load_dwordx4 v[216:219], v38, s[20:23], s61 offen offset:1024 sc1
    v_mfma_f32_16x16x32_bf16 v[116:119], a[212:215], v[228:231], v[116:119]
    ds_read_b64_tr_b16 a[232:233], v46 offset:57344
    ds_read_b64_tr_b16 a[234:235], v46 offset:61440
    v_mfma_f32_16x16x32_bf16 v[120:123], a[216:219], v[228:231], v[120:123]
    v_mfma_f32_16x16x32_bf16 v[124:127], a[220:223], v[228:231], v[124:127]
    s_waitcnt vmcnt(46)
    ds_read_b64_tr_b16 a[236:237], v47 offset:57344
    ds_read_b64_tr_b16 a[238:239], v47 offset:61440
    v_mfma_f32_16x16x32_bf16 v[156:159], a[220:223], v[232:235], v[156:159]
    buffer_load_dwordx4 v[220:223], v39, s[20:23], s61 offen offset:1024 sc1
    v_mfma_f32_16x16x32_bf16 v[152:155], a[216:219], v[232:235], v[152:155]
    ds_read_b64_tr_b16 a[240:241], v48 offset:57344
    ds_read_b64_tr_b16 a[242:243], v48 offset:61440
    v_mfma_f32_16x16x32_bf16 v[148:151], a[212:215], v[232:235], v[148:151]
    buffer_load_dwordx4 v28, s[8:11], s50 offen offset:0 lds
    v_mfma_f32_16x16x32_bf16 v[144:147], a[208:211], v[232:235], v[144:147]
    ds_read_b64_tr_b16 a[244:245], v49 offset:57344
    ds_read_b64_tr_b16 a[246:247], v49 offset:61440
    v_mfma_f32_16x16x32_bf16 v[140:143], a[204:207], v[232:235], v[140:143]
    buffer_load_dwordx4 v[208:211], v36, s[20:23], s61 offen offset:1024 sc1
    v_mfma_f32_16x16x32_bf16 v[136:139], a[200:203], v[232:235], v[136:139]
    ds_read_b64_tr_b16 a[248:249], v50 offset:57344
    ds_read_b64_tr_b16 a[250:251], v50 offset:61440
    v_mfma_f32_16x16x32_bf16 v[132:135], a[196:199], v[232:235], v[132:135]
    v_mfma_f32_16x16x32_bf16 v[128:131], a[192:195], v[232:235], v[128:131]
    s_waitcnt vmcnt(48)
    ds_read_b64_tr_b16 a[252:253], v51 offset:57344
    ds_read_b64_tr_b16 a[254:255], v51 offset:61440
    v_mfma_f32_16x16x32_bf16 v[160:163], a[192:195], v[236:239], v[160:163]
    v_mfma_f32_16x16x32_bf16 v[164:167], a[196:199], v[236:239], v[164:167]
    v_mfma_f32_16x16x32_bf16 v[168:171], a[200:203], v[236:239], v[168:171]
    buffer_load_dwordx4 v29, s[8:11], s50 offen offset:1024 lds
    v_mfma_f32_16x16x32_bf16 v[172:175], a[204:207], v[236:239], v[172:175]
    v_mfma_f32_16x16x32_bf16 v[176:179], a[208:211], v[236:239], v[176:179]
    v_mfma_f32_16x16x32_bf16 v[180:183], a[212:215], v[236:239], v[180:183]
    v_mfma_f32_16x16x32_bf16 v[184:187], a[216:219], v[236:239], v[184:187]
    v_mfma_f32_16x16x32_bf16 v[188:191], a[220:223], v[236:239], v[188:191]
    s_waitcnt vmcnt(47)
    v_mfma_f32_16x16x32_bf16 v[92:95], a[220:223], v[224:227], v[92:95]
    v_mfma_f32_16x16x32_bf16 v[88:91], a[216:219], v[224:227], v[88:91]
    v_mfma_f32_16x16x32_bf16 v[84:87], a[212:215], v[224:227], v[84:87]
    buffer_load_dwordx4 v30, s[8:11], s50 offen offset:2048 lds
    v_mfma_f32_16x16x32_bf16 v[80:83], a[208:211], v[224:227], v[80:83]
    v_mfma_f32_16x16x32_bf16 v[76:79], a[204:207], v[224:227], v[76:79]
    v_mfma_f32_16x16x32_bf16 v[72:75], a[200:203], v[224:227], v[72:75]
    v_mfma_f32_16x16x32_bf16 v[68:71], a[196:199], v[224:227], v[68:71]
    v_mfma_f32_16x16x32_bf16 v[64:67], a[192:195], v[224:227], v[64:67]
    s_waitcnt lgkmcnt(0) vmcnt(44)
    v_mfma_f32_16x16x32_bf16 v[96:99], a[224:227], v[244:247], v[96:99]
    buffer_load_dwordx4 v[228:231], v37, s[20:23], s61 offen offset:2048 sc1
    v_mfma_f32_16x16x32_bf16 v[100:103], a[228:231], v[244:247], v[100:103]
    ds_read_b64_tr_b16 a[192:193], v16 offset:0
    ds_read_b64_tr_b16 a[194:195], v16 offset:4096
    v_mfma_f32_16x16x32_bf16 v[104:107], a[232:235], v[244:247], v[104:107]
    buffer_load_dwordx4 v31, s[8:11], s50 offen offset:3072 lds
    v_mfma_f32_16x16x32_bf16 v[108:111], a[236:239], v[244:247], v[108:111]
    ds_read_b64_tr_b16 a[196:197], v17 offset:0
    ds_read_b64_tr_b16 a[198:199], v17 offset:4096
    v_mfma_f32_16x16x32_bf16 v[112:115], a[240:243], v[244:247], v[112:115]
    buffer_load_dwordx4 v[232:235], v38, s[20:23], s61 offen offset:2048 sc1
    v_mfma_f32_16x16x32_bf16 v[116:119], a[244:247], v[244:247], v[116:119]
    ds_read_b64_tr_b16 a[200:201], v18 offset:0
    ds_read_b64_tr_b16 a[202:203], v18 offset:4096
    v_mfma_f32_16x16x32_bf16 v[120:123], a[248:251], v[244:247], v[120:123]
    v_mfma_f32_16x16x32_bf16 v[124:127], a[252:255], v[244:247], v[124:127]
    s_waitcnt vmcnt(45)
    ds_read_b64_tr_b16 a[204:205], v19 offset:0
    ds_read_b64_tr_b16 a[206:207], v19 offset:4096
    v_mfma_f32_16x16x32_bf16 v[156:159], a[252:255], v[248:251], v[156:159]
    buffer_load_dwordx4 v[236:239], v39, s[20:23], s61 offen offset:2048 sc1
    v_mfma_f32_16x16x32_bf16 v[152:155], a[248:251], v[248:251], v[152:155]
    ds_read_b64_tr_b16 a[208:209], v20 offset:0
    ds_read_b64_tr_b16 a[210:211], v20 offset:4096
    v_mfma_f32_16x16x32_bf16 v[148:151], a[244:247], v[248:251], v[148:151]
    v_mfma_f32_16x16x32_bf16 v[144:147], a[240:243], v[248:251], v[144:147]
    ds_read_b64_tr_b16 a[212:213], v21 offset:0
    ds_read_b64_tr_b16 a[214:215], v21 offset:4096
    v_mfma_f32_16x16x32_bf16 v[140:143], a[236:239], v[248:251], v[140:143]
    buffer_load_dwordx4 v[224:227], v36, s[20:23], s61 offen offset:2048 sc1
    v_mfma_f32_16x16x32_bf16 v[136:139], a[232:235], v[248:251], v[136:139]
    ds_read_b64_tr_b16 a[216:217], v22 offset:0
    ds_read_b64_tr_b16 a[218:219], v22 offset:4096
    v_mfma_f32_16x16x32_bf16 v[132:135], a[228:231], v[248:251], v[132:135]
    v_mfma_f32_16x16x32_bf16 v[128:131], a[224:227], v[248:251], v[128:131]
    s_waitcnt vmcnt(46)
    ds_read_b64_tr_b16 a[220:221], v23 offset:0
    ds_read_b64_tr_b16 a[222:223], v23 offset:4096
    v_mfma_f32_16x16x32_bf16 v[160:163], a[224:227], v[252:255], v[160:163]
    v_mfma_f32_16x16x32_bf16 v[164:167], a[228:231], v[252:255], v[164:167]
    v_mfma_f32_16x16x32_bf16 v[168:171], a[232:235], v[252:255], v[168:171]
    v_mfma_f32_16x16x32_bf16 v[172:175], a[236:239], v[252:255], v[172:175]
    v_mfma_f32_16x16x32_bf16 v[176:179], a[240:243], v[252:255], v[176:179]
    v_mfma_f32_16x16x32_bf16 v[180:183], a[244:247], v[252:255], v[180:183]
    v_mfma_f32_16x16x32_bf16 v[184:187], a[248:251], v[252:255], v[184:187]
    v_mfma_f32_16x16x32_bf16 v[188:191], a[252:255], v[252:255], v[188:191]
    s_waitcnt vmcnt(44)
    v_mfma_f32_16x16x32_bf16 v[92:95], a[252:255], v[240:243], v[92:95]
    v_mfma_f32_16x16x32_bf16 v[88:91], a[248:251], v[240:243], v[88:91]
    v_mfma_f32_16x16x32_bf16 v[84:87], a[244:247], v[240:243], v[84:87]
    v_mfma_f32_16x16x32_bf16 v[80:83], a[240:243], v[240:243], v[80:83]
    v_mfma_f32_16x16x32_bf16 v[76:79], a[236:239], v[240:243], v[76:79]
    v_mfma_f32_16x16x32_bf16 v[72:75], a[232:235], v[240:243], v[72:75]
    v_mfma_f32_16x16x32_bf16 v[68:71], a[228:231], v[240:243], v[68:71]
    v_mfma_f32_16x16x32_bf16 v[64:67], a[224:227], v[240:243], v[64:67]
    s_waitcnt lgkmcnt(0) vmcnt(43)
    v_mfma_f32_16x16x32_bf16 v[96:99], a[192:195], a[132:135], v[96:99]
    buffer_load_dwordx4 v[244:247], v37, s[20:23], s61 offen offset:3072 sc1
    v_mfma_f32_16x16x32_bf16 v[100:103], a[196:199], a[132:135], v[100:103]
    ds_read_b64_tr_b16 a[224:225], v16 offset:8192
    ds_read_b64_tr_b16 a[226:227], v16 offset:12288
    v_mfma_f32_16x16x32_bf16 v[104:107], a[200:203], a[132:135], v[104:107]
    v_mfma_f32_16x16x32_bf16 v[108:111], a[204:207], a[132:135], v[108:111]
    ds_read_b64_tr_b16 a[228:229], v17 offset:8192
    ds_read_b64_tr_b16 a[230:231], v17 offset:12288
    v_mfma_f32_16x16x32_bf16 v[112:115], a[208:211], a[132:135], v[112:115]
    buffer_load_dwordx4 v[248:251], v38, s[20:23], s61 offen offset:3072 sc1
    v_mfma_f32_16x16x32_bf16 v[116:119], a[212:215], a[132:135], v[116:119]
    ds_read_b64_tr_b16 a[232:233], v18 offset:8192
    ds_read_b64_tr_b16 a[234:235], v18 offset:12288
    v_mfma_f32_16x16x32_bf16 v[120:123], a[216:219], a[132:135], v[120:123]
    v_mfma_f32_16x16x32_bf16 v[124:127], a[220:223], a[132:135], v[124:127]
    s_waitcnt vmcnt(44)
    ds_read_b64_tr_b16 a[236:237], v19 offset:8192
    ds_read_b64_tr_b16 a[238:239], v19 offset:12288
    v_mfma_f32_16x16x32_bf16 v[156:159], a[220:223], a[136:139], v[156:159]
    buffer_load_dwordx4 v[252:255], v39, s[20:23], s61 offen offset:3072 sc1
    v_mfma_f32_16x16x32_bf16 v[152:155], a[216:219], a[136:139], v[152:155]
    ds_read_b64_tr_b16 a[240:241], v20 offset:8192
    ds_read_b64_tr_b16 a[242:243], v20 offset:12288
    v_mfma_f32_16x16x32_bf16 v[148:151], a[212:215], a[136:139], v[148:151]
    v_mfma_f32_16x16x32_bf16 v[144:147], a[208:211], a[136:139], v[144:147]
    ds_read_b64_tr_b16 a[244:245], v21 offset:8192
    ds_read_b64_tr_b16 a[246:247], v21 offset:12288
    v_mfma_f32_16x16x32_bf16 v[140:143], a[204:207], a[136:139], v[140:143]
    buffer_load_dwordx4 v[240:243], v36, s[20:23], s61 offen offset:3072 sc1
    v_mfma_f32_16x16x32_bf16 v[136:139], a[200:203], a[136:139], v[136:139]
    ds_read_b64_tr_b16 a[248:249], v22 offset:8192
    ds_read_b64_tr_b16 a[250:251], v22 offset:12288
    v_mfma_f32_16x16x32_bf16 v[132:135], a[196:199], a[136:139], v[132:135]
    v_mfma_f32_16x16x32_bf16 v[128:131], a[192:195], a[136:139], v[128:131]
    s_waitcnt vmcnt(45)
    ds_read_b64_tr_b16 a[252:253], v23 offset:8192
    ds_read_b64_tr_b16 a[254:255], v23 offset:12288
    v_mfma_f32_16x16x32_bf16 v[160:163], a[192:195], a[140:143], v[160:163]
    v_mfma_f32_16x16x32_bf16 v[164:167], a[196:199], a[140:143], v[164:167]
    v_mfma_f32_16x16x32_bf16 v[168:171], a[200:203], a[140:143], v[168:171]
    v_mfma_f32_16x16x32_bf16 v[172:175], a[204:207], a[140:143], v[172:175]
    v_mfma_f32_16x16x32_bf16 v[176:179], a[208:211], a[140:143], v[176:179]
    v_mfma_f32_16x16x32_bf16 v[180:183], a[212:215], a[140:143], v[180:183]
    v_mfma_f32_16x16x32_bf16 v[184:187], a[216:219], a[140:143], v[184:187]
    v_mfma_f32_16x16x32_bf16 v[188:191], a[220:223], a[140:143], v[188:191]
    s_waitcnt vmcnt(44)
    v_mfma_f32_16x16x32_bf16 v[92:95], a[220:223], a[128:131], v[92:95]
    v_mfma_f32_16x16x32_bf16 v[88:91], a[216:219], a[128:131], v[88:91]
    v_mfma_f32_16x16x32_bf16 v[84:87], a[212:215], a[128:131], v[84:87]
    v_mfma_f32_16x16x32_bf16 v[80:83], a[208:211], a[128:131], v[80:83]
    v_mfma_f32_16x16x32_bf16 v[76:79], a[204:207], a[128:131], v[76:79]
    v_mfma_f32_16x16x32_bf16 v[72:75], a[200:203], a[128:131], v[72:75]
    v_mfma_f32_16x16x32_bf16 v[68:71], a[196:199], a[128:131], v[68:71]
    v_mfma_f32_16x16x32_bf16 v[64:67], a[192:195], a[128:131], v[64:67]
    s_waitcnt lgkmcnt(0) vmcnt(43)
    v_mfma_f32_16x16x32_bf16 v[96:99], a[224:227], a[148:151], v[96:99]
    s_bfe_u32 s61, s40, 0x40018
    v_mfma_f32_16x16x32_bf16 v[100:103], a[228:231], a[148:151], v[100:103]
    s_lshl_b32 s61, s61, 12
    ds_read_b64_tr_b16 a[192:193], v16 offset:16384
    ds_read_b64_tr_b16 a[194:195], v16 offset:20480
    v_mfma_f32_16x16x32_bf16 v[104:107], a[232:235], a[148:151], v[104:107]
    buffer_load_dwordx4 a[132:135], v37, s[20:23], s61 offen offset:0 sc1
    v_mfma_f32_16x16x32_bf16 v[108:111], a[236:239], a[148:151], v[108:111]
    ds_read_b64_tr_b16 a[196:197], v17 offset:16384
    ds_read_b64_tr_b16 a[198:199], v17 offset:20480
    v_mfma_f32_16x16x32_bf16 v[112:115], a[240:243], a[148:151], v[112:115]
    v_mfma_f32_16x16x32_bf16 v[116:119], a[244:247], a[148:151], v[116:119]
    ds_read_b64_tr_b16 a[200:201], v18 offset:16384
    ds_read_b64_tr_b16 a[202:203], v18 offset:20480
    v_mfma_f32_16x16x32_bf16 v[120:123], a[248:251], a[148:151], v[120:123]
    buffer_load_dwordx4 a[136:139], v38, s[20:23], s61 offen offset:0 sc1
    v_mfma_f32_16x16x32_bf16 v[124:127], a[252:255], a[148:151], v[124:127]
    s_waitcnt vmcnt(44)
    ds_read_b64_tr_b16 a[204:205], v19 offset:16384
    ds_read_b64_tr_b16 a[206:207], v19 offset:20480
    v_mfma_f32_16x16x32_bf16 v[156:159], a[252:255], a[152:155], v[156:159]
    v_mfma_f32_16x16x32_bf16 v[152:155], a[248:251], a[152:155], v[152:155]
    ds_read_b64_tr_b16 a[208:209], v20 offset:16384
    ds_read_b64_tr_b16 a[210:211], v20 offset:20480
    v_mfma_f32_16x16x32_bf16 v[148:151], a[244:247], a[152:155], v[148:151]
    buffer_load_dwordx4 a[140:143], v39, s[20:23], s61 offen offset:0 sc1
    v_mfma_f32_16x16x32_bf16 v[144:147], a[240:243], a[152:155], v[144:147]
    ds_read_b64_tr_b16 a[212:213], v21 offset:16384
    ds_read_b64_tr_b16 a[214:215], v21 offset:20480
    v_mfma_f32_16x16x32_bf16 v[140:143], a[236:239], a[152:155], v[140:143]
    v_mfma_f32_16x16x32_bf16 v[136:139], a[232:235], a[152:155], v[136:139]
    ds_read_b64_tr_b16 a[216:217], v22 offset:16384
    ds_read_b64_tr_b16 a[218:219], v22 offset:20480
    v_mfma_f32_16x16x32_bf16 v[132:135], a[228:231], a[152:155], v[132:135]
    buffer_load_dwordx4 a[128:131], v36, s[20:23], s61 offen offset:0 sc1
    v_mfma_f32_16x16x32_bf16 v[128:131], a[224:227], a[152:155], v[128:131]
    s_waitcnt vmcnt(45)
    ds_read_b64_tr_b16 a[220:221], v23 offset:16384
    ds_read_b64_tr_b16 a[222:223], v23 offset:20480
    v_mfma_f32_16x16x32_bf16 v[160:163], a[224:227], a[156:159], v[160:163]
    v_mfma_f32_16x16x32_bf16 v[164:167], a[228:231], a[156:159], v[164:167]
    v_mfma_f32_16x16x32_bf16 v[168:171], a[232:235], a[156:159], v[168:171]
    v_mfma_f32_16x16x32_bf16 v[172:175], a[236:239], a[156:159], v[172:175]
    v_mfma_f32_16x16x32_bf16 v[176:179], a[240:243], a[156:159], v[176:179]
    v_mfma_f32_16x16x32_bf16 v[180:183], a[244:247], a[156:159], v[180:183]
    v_mfma_f32_16x16x32_bf16 v[184:187], a[248:251], a[156:159], v[184:187]
    v_mfma_f32_16x16x32_bf16 v[188:191], a[252:255], a[156:159], v[188:191]
    s_waitcnt vmcnt(44)
    v_mfma_f32_16x16x32_bf16 v[92:95], a[252:255], a[144:147], v[92:95]
    v_mfma_f32_16x16x32_bf16 v[88:91], a[248:251], a[144:147], v[88:91]
    v_mfma_f32_16x16x32_bf16 v[84:87], a[244:247], a[144:147], v[84:87]
    v_mfma_f32_16x16x32_bf16 v[80:83], a[240:243], a[144:147], v[80:83]
    v_mfma_f32_16x16x32_bf16 v[76:79], a[236:239], a[144:147], v[76:79]
    v_mfma_f32_16x16x32_bf16 v[72:75], a[232:235], a[144:147], v[72:75]
    v_mfma_f32_16x16x32_bf16 v[68:71], a[228:231], a[144:147], v[68:71]
    v_mfma_f32_16x16x32_bf16 v[64:67], a[224:227], a[144:147], v[64:67]
    s_waitcnt lgkmcnt(0) vmcnt(43)
    v_mfma_f32_16x16x32_bf16 v[96:99], a[192:195], a[164:167], v[96:99]
    buffer_load_dwordx4 a[148:151], v37, s[20:23], s61 offen offset:1024 sc1
    v_mfma_f32_16x16x32_bf16 v[100:103], a[196:199], a[164:167], v[100:103]
    ds_read_b64_tr_b16 a[224:225], v16 offset:24576
    ds_read_b64_tr_b16 a[226:227], v16 offset:28672
    v_mfma_f32_16x16x32_bf16 v[104:107], a[200:203], a[164:167], v[104:107]
    v_mfma_f32_16x16x32_bf16 v[108:111], a[204:207], a[164:167], v[108:111]
    ds_read_b64_tr_b16 a[228:229], v17 offset:24576
    ds_read_b64_tr_b16 a[230:231], v17 offset:28672
    v_mfma_f32_16x16x32_bf16 v[112:115], a[208:211], a[164:167], v[112:115]
    buffer_load_dwordx4 a[152:155], v38, s[20:23], s61 offen offset:1024 sc1
    v_mfma_f32_16x16x32_bf16 v[116:119], a[212:215], a[164:167], v[116:119]
    ds_read_b64_tr_b16 a[232:233], v18 offset:24576
    ds_read_b64_tr_b16 a[234:235], v18 offset:28672
    v_mfma_f32_16x16x32_bf16 v[120:123], a[216:219], a[164:167], v[120:123]
    v_mfma_f32_16x16x32_bf16 v[124:127], a[220:223], a[164:167], v[124:127]
    s_waitcnt vmcnt(43)
    ds_read_b64_tr_b16 a[236:237], v19 offset:24576
    ds_read_b64_tr_b16 a[238:239], v19 offset:28672
    v_mfma_f32_16x16x32_bf16 v[156:159], a[220:223], a[168:171], v[156:159]
    buffer_load_dwordx4 a[156:159], v39, s[20:23], s61 offen offset:1024 sc1
    v_mfma_f32_16x16x32_bf16 v[152:155], a[216:219], a[168:171], v[152:155]
    ds_read_b64_tr_b16 a[240:241], v20 offset:24576
    ds_read_b64_tr_b16 a[242:243], v20 offset:28672
    v_mfma_f32_16x16x32_bf16 v[148:151], a[212:215], a[168:171], v[148:151]
    v_mfma_f32_16x16x32_bf16 v[144:147], a[208:211], a[168:171], v[144:147]
    ds_read_b64_tr_b16 a[244:245], v21 offset:24576
    ds_read_b64_tr_b16 a[246:247], v21 offset:28672
    v_mfma_f32_16x16x32_bf16 v[140:143], a[204:207], a[168:171], v[140:143]
    buffer_load_dwordx4 a[144:147], v36, s[20:23], s61 offen offset:1024 sc1
    v_mfma_f32_16x16x32_bf16 v[136:139], a[200:203], a[168:171], v[136:139]
    ds_read_b64_tr_b16 a[248:249], v22 offset:24576
    ds_read_b64_tr_b16 a[250:251], v22 offset:28672
    v_mfma_f32_16x16x32_bf16 v[132:135], a[196:199], a[168:171], v[132:135]
    v_mfma_f32_16x16x32_bf16 v[128:131], a[192:195], a[168:171], v[128:131]
    s_waitcnt vmcnt(44)
    ds_read_b64_tr_b16 a[252:253], v23 offset:24576
    ds_read_b64_tr_b16 a[254:255], v23 offset:28672
    v_mfma_f32_16x16x32_bf16 v[160:163], a[192:195], a[172:175], v[160:163]
    v_mfma_f32_16x16x32_bf16 v[164:167], a[196:199], a[172:175], v[164:167]
    v_mfma_f32_16x16x32_bf16 v[168:171], a[200:203], a[172:175], v[168:171]
    v_mfma_f32_16x16x32_bf16 v[172:175], a[204:207], a[172:175], v[172:175]
    v_mfma_f32_16x16x32_bf16 v[176:179], a[208:211], a[172:175], v[176:179]
    v_mfma_f32_16x16x32_bf16 v[180:183], a[212:215], a[172:175], v[180:183]
    v_mfma_f32_16x16x32_bf16 v[184:187], a[216:219], a[172:175], v[184:187]
    v_mfma_f32_16x16x32_bf16 v[188:191], a[220:223], a[172:175], v[188:191]
    s_waitcnt vmcnt(42)
    v_mfma_f32_16x16x32_bf16 v[92:95], a[220:223], a[160:163], v[92:95]
    v_mfma_f32_16x16x32_bf16 v[88:91], a[216:219], a[160:163], v[88:91]
    v_mfma_f32_16x16x32_bf16 v[84:87], a[212:215], a[160:163], v[84:87]
    v_mfma_f32_16x16x32_bf16 v[80:83], a[208:211], a[160:163], v[80:83]
    v_mfma_f32_16x16x32_bf16 v[76:79], a[204:207], a[160:163], v[76:79]
    v_mfma_f32_16x16x32_bf16 v[72:75], a[200:203], a[160:163], v[72:75]
    v_mfma_f32_16x16x32_bf16 v[68:71], a[196:199], a[160:163], v[68:71]
    v_mfma_f32_16x16x32_bf16 v[64:67], a[192:195], a[160:163], v[64:67]
    s_waitcnt lgkmcnt(0) vmcnt(39)
    v_mfma_f32_16x16x32_bf16 v[96:99], a[224:227], a[180:183], v[96:99]
    s_waitcnt vmcnt(15) lgkmcnt(0)
    buffer_load_dwordx4 a[164:167], v37, s[20:23], s61 offen offset:2048 sc1
    v_mfma_f32_16x16x32_bf16 v[100:103], a[228:231], a[180:183], v[100:103]
    s_barrier
    v_mfma_f32_16x16x32_bf16 v[104:107], a[232:235], a[180:183], v[104:107]
    ds_read_b64_tr_b16 a[192:193], v8 offset:0
    ds_read_b64_tr_b16 a[194:195], v8 offset:4096
    v_mfma_f32_16x16x32_bf16 v[108:111], a[236:239], a[180:183], v[108:111]
    v_mfma_f32_16x16x32_bf16 v[112:115], a[240:243], a[180:183], v[112:115]
    ds_read_b64_tr_b16 a[196:197], v9 offset:0
    ds_read_b64_tr_b16 a[198:199], v9 offset:4096
    v_mfma_f32_16x16x32_bf16 v[116:119], a[244:247], a[180:183], v[116:119]
    buffer_load_dwordx4 a[168:171], v38, s[20:23], s61 offen offset:2048 sc1
    v_mfma_f32_16x16x32_bf16 v[120:123], a[248:251], a[180:183], v[120:123]
    ds_read_b64_tr_b16 a[200:201], v10 offset:0
    ds_read_b64_tr_b16 a[202:203], v10 offset:4096
    v_mfma_f32_16x16x32_bf16 v[124:127], a[252:255], a[180:183], v[124:127]
    s_waitcnt vmcnt(40)
    v_mfma_f32_16x16x32_bf16 v[156:159], a[252:255], a[184:187], v[156:159]
    ds_read_b64_tr_b16 a[204:205], v11 offset:0
    ds_read_b64_tr_b16 a[206:207], v11 offset:4096
    v_mfma_f32_16x16x32_bf16 v[152:155], a[248:251], a[184:187], v[152:155]
    buffer_load_dwordx4 a[172:175], v39, s[20:23], s61 offen offset:2048 sc1
    v_mfma_f32_16x16x32_bf16 v[148:151], a[244:247], a[184:187], v[148:151]
    ds_read_b64_tr_b16 a[208:209], v12 offset:0
    ds_read_b64_tr_b16 a[210:211], v12 offset:4096
    v_mfma_f32_16x16x32_bf16 v[144:147], a[240:243], a[184:187], v[144:147]
    v_mfma_f32_16x16x32_bf16 v[140:143], a[236:239], a[184:187], v[140:143]
    ds_read_b64_tr_b16 a[212:213], v13 offset:0
    ds_read_b64_tr_b16 a[214:215], v13 offset:4096
    v_mfma_f32_16x16x32_bf16 v[136:139], a[232:235], a[184:187], v[136:139]
    buffer_load_dwordx4 a[160:163], v36, s[20:23], s61 offen offset:2048 sc1
    v_mfma_f32_16x16x32_bf16 v[132:135], a[228:231], a[184:187], v[132:135]
    ds_read_b64_tr_b16 a[216:217], v14 offset:0
    ds_read_b64_tr_b16 a[218:219], v14 offset:4096
    v_mfma_f32_16x16x32_bf16 v[128:131], a[224:227], a[184:187], v[128:131]
    s_waitcnt vmcnt(40)
    v_mfma_f32_16x16x32_bf16 v[160:163], a[224:227], a[188:191], v[160:163]
    ds_read_b64_tr_b16 a[220:221], v15 offset:0
    ds_read_b64_tr_b16 a[222:223], v15 offset:4096
    v_mfma_f32_16x16x32_bf16 v[164:167], a[228:231], a[188:191], v[164:167]
    v_mfma_f32_16x16x32_bf16 v[168:171], a[232:235], a[188:191], v[168:171]
    v_mfma_f32_16x16x32_bf16 v[172:175], a[236:239], a[188:191], v[172:175]
    v_mfma_f32_16x16x32_bf16 v[176:179], a[240:243], a[188:191], v[176:179]
    v_mfma_f32_16x16x32_bf16 v[180:183], a[244:247], a[188:191], v[180:183]
    v_mfma_f32_16x16x32_bf16 v[184:187], a[248:251], a[188:191], v[184:187]
    v_mfma_f32_16x16x32_bf16 v[188:191], a[252:255], a[188:191], v[188:191]
    s_waitcnt vmcnt(39)
    v_mfma_f32_16x16x32_bf16 v[92:95], a[252:255], a[176:179], v[92:95]
    v_mfma_f32_16x16x32_bf16 v[88:91], a[248:251], a[176:179], v[88:91]
    v_mfma_f32_16x16x32_bf16 v[84:87], a[244:247], a[176:179], v[84:87]
    v_mfma_f32_16x16x32_bf16 v[80:83], a[240:243], a[176:179], v[80:83]
    v_mfma_f32_16x16x32_bf16 v[76:79], a[236:239], a[176:179], v[76:79]
    v_mfma_f32_16x16x32_bf16 v[72:75], a[232:235], a[176:179], v[72:75]
    v_mfma_f32_16x16x32_bf16 v[68:71], a[228:231], a[176:179], v[68:71]
    v_mfma_f32_16x16x32_bf16 v[64:67], a[224:227], a[176:179], v[64:67]
    s_waitcnt lgkmcnt(0) vmcnt(35)
    v_mfma_f32_16x16x32_bf16 v[96:99], a[192:195], v[196:199], v[96:99]
    buffer_load_dwordx4 a[180:183], v37, s[20:23], s61 offen offset:3072 sc1
    v_mfma_f32_16x16x32_bf16 v[100:103], a[196:199], v[196:199], v[100:103]
    ds_read_b64_tr_b16 a[224:225], v8 offset:8192
    ds_read_b64_tr_b16 a[226:227], v8 offset:12288
    v_mfma_f32_16x16x32_bf16 v[104:107], a[200:203], v[196:199], v[104:107]
    v_mfma_f32_16x16x32_bf16 v[108:111], a[204:207], v[196:199], v[108:111]
    ds_read_b64_tr_b16 a[228:229], v9 offset:8192
    ds_read_b64_tr_b16 a[230:231], v9 offset:12288
    v_mfma_f32_16x16x32_bf16 v[112:115], a[208:211], v[196:199], v[112:115]
    buffer_load_dwordx4 a[184:187], v38, s[20:23], s61 offen offset:3072 sc1
    v_mfma_f32_16x16x32_bf16 v[116:119], a[212:215], v[196:199], v[116:119]
    ds_read_b64_tr_b16 a[232:233], v10 offset:8192
    ds_read_b64_tr_b16 a[234:235], v10 offset:12288
    v_mfma_f32_16x16x32_bf16 v[120:123], a[216:219], v[196:199], v[120:123]
    v_mfma_f32_16x16x32_bf16 v[124:127], a[220:223], v[196:199], v[124:127]
    s_waitcnt vmcnt(36)
    ds_read_b64_tr_b16 a[236:237], v11 offset:8192
    ds_read_b64_tr_b16 a[238:239], v11 offset:12288
    v_mfma_f32_16x16x32_bf16 v[156:159], a[220:223], v[200:203], v[156:159]
    buffer_load_dwordx4 a[188:191], v39, s[20:23], s61 offen offset:3072 sc1
    v_mfma_f32_16x16x32_bf16 v[152:155], a[216:219], v[200:203], v[152:155]
    ds_read_b64_tr_b16 a[240:241], v12 offset:8192
    ds_read_b64_tr_b16 a[242:243], v12 offset:12288
    v_mfma_f32_16x16x32_bf16 v[148:151], a[212:215], v[200:203], v[148:151]
    v_mfma_f32_16x16x32_bf16 v[144:147], a[208:211], v[200:203], v[144:147]
    ds_read_b64_tr_b16 a[244:245], v13 offset:8192
    ds_read_b64_tr_b16 a[246:247], v13 offset:12288
    v_mfma_f32_16x16x32_bf16 v[140:143], a[204:207], v[200:203], v[140:143]
    buffer_load_dwordx4 a[176:179], v36, s[20:23], s61 offen offset:3072 sc1
    v_mfma_f32_16x16x32_bf16 v[136:139], a[200:203], v[200:203], v[136:139]
    ds_read_b64_tr_b16 a[248:249], v14 offset:8192
    ds_read_b64_tr_b16 a[250:251], v14 offset:12288
    v_mfma_f32_16x16x32_bf16 v[132:135], a[196:199], v[200:203], v[132:135]
    v_mfma_f32_16x16x32_bf16 v[128:131], a[192:195], v[200:203], v[128:131]
    s_waitcnt vmcnt(36)
    ds_read_b64_tr_b16 a[252:253], v15 offset:8192
    ds_read_b64_tr_b16 a[254:255], v15 offset:12288
    v_mfma_f32_16x16x32_bf16 v[160:163], a[192:195], v[204:207], v[160:163]
    v_mfma_f32_16x16x32_bf16 v[164:167], a[196:199], v[204:207], v[164:167]
    v_mfma_f32_16x16x32_bf16 v[168:171], a[200:203], v[204:207], v[168:171]
    v_mfma_f32_16x16x32_bf16 v[172:175], a[204:207], v[204:207], v[172:175]
    v_mfma_f32_16x16x32_bf16 v[176:179], a[208:211], v[204:207], v[176:179]
    v_mfma_f32_16x16x32_bf16 v[180:183], a[212:215], v[204:207], v[180:183]
    v_mfma_f32_16x16x32_bf16 v[184:187], a[216:219], v[204:207], v[184:187]
    v_mfma_f32_16x16x32_bf16 v[188:191], a[220:223], v[204:207], v[188:191]
    s_waitcnt vmcnt(35)
    v_mfma_f32_16x16x32_bf16 v[92:95], a[220:223], v[192:195], v[92:95]
    v_mfma_f32_16x16x32_bf16 v[88:91], a[216:219], v[192:195], v[88:91]
    v_mfma_f32_16x16x32_bf16 v[84:87], a[212:215], v[192:195], v[84:87]
    v_mfma_f32_16x16x32_bf16 v[80:83], a[208:211], v[192:195], v[80:83]
    v_mfma_f32_16x16x32_bf16 v[76:79], a[204:207], v[192:195], v[76:79]
    v_mfma_f32_16x16x32_bf16 v[72:75], a[200:203], v[192:195], v[72:75]
    v_mfma_f32_16x16x32_bf16 v[68:71], a[196:199], v[192:195], v[68:71]
    v_mfma_f32_16x16x32_bf16 v[64:67], a[192:195], v[192:195], v[64:67]
    s_waitcnt lgkmcnt(0) vmcnt(32)
    v_mfma_f32_16x16x32_bf16 v[96:99], a[224:227], v[212:215], v[96:99]
    v_mfma_f32_16x16x32_bf16 v[100:103], a[228:231], v[212:215], v[100:103]
    ds_read_b64_tr_b16 a[192:193], v8 offset:16384
    ds_read_b64_tr_b16 a[194:195], v8 offset:20480
    v_mfma_f32_16x16x32_bf16 v[104:107], a[232:235], v[212:215], v[104:107]
    v_mfma_f32_16x16x32_bf16 v[108:111], a[236:239], v[212:215], v[108:111]
    ds_read_b64_tr_b16 a[196:197], v9 offset:16384
    ds_read_b64_tr_b16 a[198:199], v9 offset:20480
    v_mfma_f32_16x16x32_bf16 v[112:115], a[240:243], v[212:215], v[112:115]
    v_mfma_f32_16x16x32_bf16 v[116:119], a[244:247], v[212:215], v[116:119]
    ds_read_b64_tr_b16 a[200:201], v10 offset:16384
    ds_read_b64_tr_b16 a[202:203], v10 offset:20480
    v_mfma_f32_16x16x32_bf16 v[120:123], a[248:251], v[212:215], v[120:123]
    v_mfma_f32_16x16x32_bf16 v[124:127], a[252:255], v[212:215], v[124:127]
    s_waitcnt vmcnt(30)
    ds_read_b64_tr_b16 a[204:205], v11 offset:16384
    ds_read_b64_tr_b16 a[206:207], v11 offset:20480
    v_mfma_f32_16x16x32_bf16 v[156:159], a[252:255], v[216:219], v[156:159]
    v_mfma_f32_16x16x32_bf16 v[152:155], a[248:251], v[216:219], v[152:155]
    ds_read_b64_tr_b16 a[208:209], v12 offset:16384
    ds_read_b64_tr_b16 a[210:211], v12 offset:20480
    v_mfma_f32_16x16x32_bf16 v[148:151], a[244:247], v[216:219], v[148:151]
    v_mfma_f32_16x16x32_bf16 v[144:147], a[240:243], v[216:219], v[144:147]
    ds_read_b64_tr_b16 a[212:213], v13 offset:16384
    ds_read_b64_tr_b16 a[214:215], v13 offset:20480
    v_mfma_f32_16x16x32_bf16 v[140:143], a[236:239], v[216:219], v[140:143]
    v_mfma_f32_16x16x32_bf16 v[136:139], a[232:235], v[216:219], v[136:139]
    ds_read_b64_tr_b16 a[216:217], v14 offset:16384
    ds_read_b64_tr_b16 a[218:219], v14 offset:20480
    v_mfma_f32_16x16x32_bf16 v[132:135], a[228:231], v[216:219], v[132:135]
    v_mfma_f32_16x16x32_bf16 v[128:131], a[224:227], v[216:219], v[128:131]
    s_waitcnt vmcnt(29)
    ds_read_b64_tr_b16 a[220:221], v15 offset:16384
    ds_read_b64_tr_b16 a[222:223], v15 offset:20480
    v_mfma_f32_16x16x32_bf16 v[160:163], a[224:227], v[220:223], v[160:163]
    v_mfma_f32_16x16x32_bf16 v[164:167], a[228:231], v[220:223], v[164:167]
    v_mfma_f32_16x16x32_bf16 v[168:171], a[232:235], v[220:223], v[168:171]
    v_mfma_f32_16x16x32_bf16 v[172:175], a[236:239], v[220:223], v[172:175]
    v_mfma_f32_16x16x32_bf16 v[176:179], a[240:243], v[220:223], v[176:179]
    v_mfma_f32_16x16x32_bf16 v[180:183], a[244:247], v[220:223], v[180:183]
    v_mfma_f32_16x16x32_bf16 v[184:187], a[248:251], v[220:223], v[184:187]
    v_mfma_f32_16x16x32_bf16 v[188:191], a[252:255], v[220:223], v[188:191]
    s_waitcnt vmcnt(27)
    v_mfma_f32_16x16x32_bf16 v[92:95], a[252:255], v[208:211], v[92:95]
    v_mfma_f32_16x16x32_bf16 v[88:91], a[248:251], v[208:211], v[88:91]
    v_mfma_f32_16x16x32_bf16 v[84:87], a[244:247], v[208:211], v[84:87]
    v_mfma_f32_16x16x32_bf16 v[80:83], a[240:243], v[208:211], v[80:83]
    v_mfma_f32_16x16x32_bf16 v[76:79], a[236:239], v[208:211], v[76:79]
    v_mfma_f32_16x16x32_bf16 v[72:75], a[232:235], v[208:211], v[72:75]
    v_mfma_f32_16x16x32_bf16 v[68:71], a[228:231], v[208:211], v[68:71]
    v_mfma_f32_16x16x32_bf16 v[64:67], a[224:227], v[208:211], v[64:67]
    s_waitcnt lgkmcnt(0) vmcnt(24)
    v_mfma_f32_16x16x32_bf16 v[96:99], a[192:195], v[228:231], v[96:99]
    v_mfma_f32_16x16x32_bf16 v[100:103], a[196:199], v[228:231], v[100:103]
    ds_read_b64_tr_b16 a[224:225], v8 offset:24576
    ds_read_b64_tr_b16 a[226:227], v8 offset:28672
    v_mfma_f32_16x16x32_bf16 v[104:107], a[200:203], v[228:231], v[104:107]
    v_mfma_f32_16x16x32_bf16 v[108:111], a[204:207], v[228:231], v[108:111]
    ds_read_b64_tr_b16 a[228:229], v9 offset:24576
    ds_read_b64_tr_b16 a[230:231], v9 offset:28672
    v_mfma_f32_16x16x32_bf16 v[112:115], a[208:211], v[228:231], v[112:115]
    v_mfma_f32_16x16x32_bf16 v[116:119], a[212:215], v[228:231], v[116:119]
    ds_read_b64_tr_b16 a[232:233], v10 offset:24576
    ds_read_b64_tr_b16 a[234:235], v10 offset:28672
    v_mfma_f32_16x16x32_bf16 v[120:123], a[216:219], v[228:231], v[120:123]
    v_mfma_f32_16x16x32_bf16 v[124:127], a[220:223], v[228:231], v[124:127]
    s_waitcnt vmcnt(22)
    ds_read_b64_tr_b16 a[236:237], v11 offset:24576
    ds_read_b64_tr_b16 a[238:239], v11 offset:28672
    v_mfma_f32_16x16x32_bf16 v[156:159], a[220:223], v[232:235], v[156:159]
    v_mfma_f32_16x16x32_bf16 v[152:155], a[216:219], v[232:235], v[152:155]
    ds_read_b64_tr_b16 a[240:241], v12 offset:24576
    ds_read_b64_tr_b16 a[242:243], v12 offset:28672
    v_mfma_f32_16x16x32_bf16 v[148:151], a[212:215], v[232:235], v[148:151]
    v_mfma_f32_16x16x32_bf16 v[144:147], a[208:211], v[232:235], v[144:147]
    ds_read_b64_tr_b16 a[244:245], v13 offset:24576
    ds_read_b64_tr_b16 a[246:247], v13 offset:28672
    v_mfma_f32_16x16x32_bf16 v[140:143], a[204:207], v[232:235], v[140:143]
    v_mfma_f32_16x16x32_bf16 v[136:139], a[200:203], v[232:235], v[136:139]
    ds_read_b64_tr_b16 a[248:249], v14 offset:24576
    ds_read_b64_tr_b16 a[250:251], v14 offset:28672
    v_mfma_f32_16x16x32_bf16 v[132:135], a[196:199], v[232:235], v[132:135]
    v_mfma_f32_16x16x32_bf16 v[128:131], a[192:195], v[232:235], v[128:131]
    s_waitcnt vmcnt(21)
    ds_read_b64_tr_b16 a[252:253], v15 offset:24576
    ds_read_b64_tr_b16 a[254:255], v15 offset:28672
    v_mfma_f32_16x16x32_bf16 v[160:163], a[192:195], v[236:239], v[160:163]
    v_mfma_f32_16x16x32_bf16 v[164:167], a[196:199], v[236:239], v[164:167]
    v_mfma_f32_16x16x32_bf16 v[168:171], a[200:203], v[236:239], v[168:171]
    v_mfma_f32_16x16x32_bf16 v[172:175], a[204:207], v[236:239], v[172:175]
    v_mfma_f32_16x16x32_bf16 v[176:179], a[208:211], v[236:239], v[176:179]
    v_mfma_f32_16x16x32_bf16 v[180:183], a[212:215], v[236:239], v[180:183]
    v_mfma_f32_16x16x32_bf16 v[184:187], a[216:219], v[236:239], v[184:187]
    v_mfma_f32_16x16x32_bf16 v[188:191], a[220:223], v[236:239], v[188:191]
    s_waitcnt vmcnt(20)
    v_mfma_f32_16x16x32_bf16 v[92:95], a[220:223], v[224:227], v[92:95]
    v_mfma_f32_16x16x32_bf16 v[88:91], a[216:219], v[224:227], v[88:91]
    v_mfma_f32_16x16x32_bf16 v[84:87], a[212:215], v[224:227], v[84:87]
    v_mfma_f32_16x16x32_bf16 v[80:83], a[208:211], v[224:227], v[80:83]
    v_mfma_f32_16x16x32_bf16 v[76:79], a[204:207], v[224:227], v[76:79]
    v_mfma_f32_16x16x32_bf16 v[72:75], a[200:203], v[224:227], v[72:75]
    v_mfma_f32_16x16x32_bf16 v[68:71], a[196:199], v[224:227], v[68:71]
    v_mfma_f32_16x16x32_bf16 v[64:67], a[192:195], v[224:227], v[64:67]
    s_waitcnt lgkmcnt(0) vmcnt(19)
    v_mfma_f32_16x16x32_bf16 v[96:99], a[224:227], v[244:247], v[96:99]
    v_mfma_f32_16x16x32_bf16 v[100:103], a[228:231], v[244:247], v[100:103]
    ds_read_b64_tr_b16 a[192:193], v16 offset:32768
    ds_read_b64_tr_b16 a[194:195], v16 offset:36864
    v_mfma_f32_16x16x32_bf16 v[104:107], a[232:235], v[244:247], v[104:107]
    v_mfma_f32_16x16x32_bf16 v[108:111], a[236:239], v[244:247], v[108:111]
    ds_read_b64_tr_b16 a[196:197], v17 offset:32768
    ds_read_b64_tr_b16 a[198:199], v17 offset:36864
    v_mfma_f32_16x16x32_bf16 v[112:115], a[240:243], v[244:247], v[112:115]
    v_mfma_f32_16x16x32_bf16 v[116:119], a[244:247], v[244:247], v[116:119]
    ds_read_b64_tr_b16 a[200:201], v18 offset:32768
    ds_read_b64_tr_b16 a[202:203], v18 offset:36864
    v_mfma_f32_16x16x32_bf16 v[120:123], a[248:251], v[244:247], v[120:123]
    v_mfma_f32_16x16x32_bf16 v[124:127], a[252:255], v[244:247], v[124:127]
    s_waitcnt vmcnt(18)
    ds_read_b64_tr_b16 a[204:205], v19 offset:32768
    ds_read_b64_tr_b16 a[206:207], v19 offset:36864
    v_mfma_f32_16x16x32_bf16 v[156:159], a[252:255], v[248:251], v[156:159]
    v_mfma_f32_16x16x32_bf16 v[152:155], a[248:251], v[248:251], v[152:155]
    ds_read_b64_tr_b16 a[208:209], v20 offset:32768
    ds_read_b64_tr_b16 a[210:211], v20 offset:36864
    v_mfma_f32_16x16x32_bf16 v[148:151], a[244:247], v[248:251], v[148:151]
    v_mfma_f32_16x16x32_bf16 v[144:147], a[240:243], v[248:251], v[144:147]
    ds_read_b64_tr_b16 a[212:213], v21 offset:32768
    ds_read_b64_tr_b16 a[214:215], v21 offset:36864
    v_mfma_f32_16x16x32_bf16 v[140:143], a[236:239], v[248:251], v[140:143]
    v_mfma_f32_16x16x32_bf16 v[136:139], a[232:235], v[248:251], v[136:139]
    ds_read_b64_tr_b16 a[216:217], v22 offset:32768
    ds_read_b64_tr_b16 a[218:219], v22 offset:36864
    v_mfma_f32_16x16x32_bf16 v[132:135], a[228:231], v[248:251], v[132:135]
    v_mfma_f32_16x16x32_bf16 v[128:131], a[224:227], v[248:251], v[128:131]
    s_waitcnt vmcnt(17)
    ds_read_b64_tr_b16 a[220:221], v23 offset:32768
    ds_read_b64_tr_b16 a[222:223], v23 offset:36864
    v_mfma_f32_16x16x32_bf16 v[160:163], a[224:227], v[252:255], v[160:163]
    v_mfma_f32_16x16x32_bf16 v[164:167], a[228:231], v[252:255], v[164:167]
    v_mfma_f32_16x16x32_bf16 v[168:171], a[232:235], v[252:255], v[168:171]
    v_mfma_f32_16x16x32_bf16 v[172:175], a[236:239], v[252:255], v[172:175]
    v_mfma_f32_16x16x32_bf16 v[176:179], a[240:243], v[252:255], v[176:179]
    v_mfma_f32_16x16x32_bf16 v[180:183], a[244:247], v[252:255], v[180:183]
    v_mfma_f32_16x16x32_bf16 v[184:187], a[248:251], v[252:255], v[184:187]
    v_mfma_f32_16x16x32_bf16 v[188:191], a[252:255], v[252:255], v[188:191]
    s_waitcnt vmcnt(16)
    v_mfma_f32_16x16x32_bf16 v[92:95], a[252:255], v[240:243], v[92:95]
    v_mfma_f32_16x16x32_bf16 v[88:91], a[248:251], v[240:243], v[88:91]
    v_mfma_f32_16x16x32_bf16 v[84:87], a[244:247], v[240:243], v[84:87]
    v_mfma_f32_16x16x32_bf16 v[80:83], a[240:243], v[240:243], v[80:83]
    v_mfma_f32_16x16x32_bf16 v[76:79], a[236:239], v[240:243], v[76:79]
    v_mfma_f32_16x16x32_bf16 v[72:75], a[232:235], v[240:243], v[72:75]
    v_mfma_f32_16x16x32_bf16 v[68:71], a[228:231], v[240:243], v[68:71]
    v_mfma_f32_16x16x32_bf16 v[64:67], a[224:227], v[240:243], v[64:67]
    s_waitcnt lgkmcnt(0) vmcnt(15)
    v_mfma_f32_16x16x32_bf16 v[96:99], a[192:195], a[132:135], v[96:99]
    v_mfma_f32_16x16x32_bf16 v[100:103], a[196:199], a[132:135], v[100:103]
    ds_read_b64_tr_b16 a[224:225], v16 offset:40960
    ds_read_b64_tr_b16 a[226:227], v16 offset:45056
    v_mfma_f32_16x16x32_bf16 v[104:107], a[200:203], a[132:135], v[104:107]
    v_mfma_f32_16x16x32_bf16 v[108:111], a[204:207], a[132:135], v[108:111]
    ds_read_b64_tr_b16 a[228:229], v17 offset:40960
    ds_read_b64_tr_b16 a[230:231], v17 offset:45056
    v_mfma_f32_16x16x32_bf16 v[112:115], a[208:211], a[132:135], v[112:115]
    v_mfma_f32_16x16x32_bf16 v[116:119], a[212:215], a[132:135], v[116:119]
    ds_read_b64_tr_b16 a[232:233], v18 offset:40960
    ds_read_b64_tr_b16 a[234:235], v18 offset:45056
    v_mfma_f32_16x16x32_bf16 v[120:123], a[216:219], a[132:135], v[120:123]
    v_mfma_f32_16x16x32_bf16 v[124:127], a[220:223], a[132:135], v[124:127]
    s_waitcnt vmcnt(14)
    ds_read_b64_tr_b16 a[236:237], v19 offset:40960
    ds_read_b64_tr_b16 a[238:239], v19 offset:45056
    v_mfma_f32_16x16x32_bf16 v[156:159], a[220:223], a[136:139], v[156:159]
    v_mfma_f32_16x16x32_bf16 v[152:155], a[216:219], a[136:139], v[152:155]
    ds_read_b64_tr_b16 a[240:241], v20 offset:40960
    ds_read_b64_tr_b16 a[242:243], v20 offset:45056
    v_mfma_f32_16x16x32_bf16 v[148:151], a[212:215], a[136:139], v[148:151]
    v_mfma_f32_16x16x32_bf16 v[144:147], a[208:211], a[136:139], v[144:147]
    ds_read_b64_tr_b16 a[244:245], v21 offset:40960
    ds_read_b64_tr_b16 a[246:247], v21 offset:45056
    v_mfma_f32_16x16x32_bf16 v[140:143], a[204:207], a[136:139], v[140:143]
    v_mfma_f32_16x16x32_bf16 v[136:139], a[200:203], a[136:139], v[136:139]
    ds_read_b64_tr_b16 a[248:249], v22 offset:40960
    ds_read_b64_tr_b16 a[250:251], v22 offset:45056
    v_mfma_f32_16x16x32_bf16 v[132:135], a[196:199], a[136:139], v[132:135]
    v_mfma_f32_16x16x32_bf16 v[128:131], a[192:195], a[136:139], v[128:131]
    s_waitcnt vmcnt(13)
    ds_read_b64_tr_b16 a[252:253], v23 offset:40960
    ds_read_b64_tr_b16 a[254:255], v23 offset:45056
    v_mfma_f32_16x16x32_bf16 v[160:163], a[192:195], a[140:143], v[160:163]
    v_mfma_f32_16x16x32_bf16 v[164:167], a[196:199], a[140:143], v[164:167]
    v_mfma_f32_16x16x32_bf16 v[168:171], a[200:203], a[140:143], v[168:171]
    v_mfma_f32_16x16x32_bf16 v[172:175], a[204:207], a[140:143], v[172:175]
    v_mfma_f32_16x16x32_bf16 v[176:179], a[208:211], a[140:143], v[176:179]
    v_mfma_f32_16x16x32_bf16 v[180:183], a[212:215], a[140:143], v[180:183]
    v_mfma_f32_16x16x32_bf16 v[184:187], a[216:219], a[140:143], v[184:187]
    v_mfma_f32_16x16x32_bf16 v[188:191], a[220:223], a[140:143], v[188:191]
    s_waitcnt vmcnt(12)
    v_mfma_f32_16x16x32_bf16 v[92:95], a[220:223], a[128:131], v[92:95]
    v_mfma_f32_16x16x32_bf16 v[88:91], a[216:219], a[128:131], v[88:91]
    v_mfma_f32_16x16x32_bf16 v[84:87], a[212:215], a[128:131], v[84:87]
    v_mfma_f32_16x16x32_bf16 v[80:83], a[208:211], a[128:131], v[80:83]
    v_mfma_f32_16x16x32_bf16 v[76:79], a[204:207], a[128:131], v[76:79]
    v_mfma_f32_16x16x32_bf16 v[72:75], a[200:203], a[128:131], v[72:75]
    v_mfma_f32_16x16x32_bf16 v[68:71], a[196:199], a[128:131], v[68:71]
    v_mfma_f32_16x16x32_bf16 v[64:67], a[192:195], a[128:131], v[64:67]
    s_waitcnt lgkmcnt(0) vmcnt(11)
    v_mfma_f32_16x16x32_bf16 v[96:99], a[224:227], a[148:151], v[96:99]
    v_mfma_f32_16x16x32_bf16 v[100:103], a[228:231], a[148:151], v[100:103]
    ds_read_b64_tr_b16 a[192:193], v16 offset:49152
    ds_read_b64_tr_b16 a[194:195], v16 offset:53248
    v_mfma_f32_16x16x32_bf16 v[104:107], a[232:235], a[148:151], v[104:107]
    v_mfma_f32_16x16x32_bf16 v[108:111], a[236:239], a[148:151], v[108:111]
    ds_read_b64_tr_b16 a[196:197], v17 offset:49152
    ds_read_b64_tr_b16 a[198:199], v17 offset:53248
    v_mfma_f32_16x16x32_bf16 v[112:115], a[240:243], a[148:151], v[112:115]
    v_mfma_f32_16x16x32_bf16 v[116:119], a[244:247], a[148:151], v[116:119]
    ds_read_b64_tr_b16 a[200:201], v18 offset:49152
    ds_read_b64_tr_b16 a[202:203], v18 offset:53248
    v_mfma_f32_16x16x32_bf16 v[120:123], a[248:251], a[148:151], v[120:123]
    v_mfma_f32_16x16x32_bf16 v[124:127], a[252:255], a[148:151], v[124:127]
    s_waitcnt vmcnt(10)
    ds_read_b64_tr_b16 a[204:205], v19 offset:49152
    ds_read_b64_tr_b16 a[206:207], v19 offset:53248
    v_mfma_f32_16x16x32_bf16 v[156:159], a[252:255], a[152:155], v[156:159]
    v_mfma_f32_16x16x32_bf16 v[152:155], a[248:251], a[152:155], v[152:155]
    ds_read_b64_tr_b16 a[208:209], v20 offset:49152
    ds_read_b64_tr_b16 a[210:211], v20 offset:53248
    v_mfma_f32_16x16x32_bf16 v[148:151], a[244:247], a[152:155], v[148:151]
    v_mfma_f32_16x16x32_bf16 v[144:147], a[240:243], a[152:155], v[144:147]
    ds_read_b64_tr_b16 a[212:213], v21 offset:49152
    ds_read_b64_tr_b16 a[214:215], v21 offset:53248
    v_mfma_f32_16x16x32_bf16 v[140:143], a[236:239], a[152:155], v[140:143]
    v_mfma_f32_16x16x32_bf16 v[136:139], a[232:235], a[152:155], v[136:139]
    ds_read_b64_tr_b16 a[216:217], v22 offset:49152
    ds_read_b64_tr_b16 a[218:219], v22 offset:53248
    v_mfma_f32_16x16x32_bf16 v[132:135], a[228:231], a[152:155], v[132:135]
    v_mfma_f32_16x16x32_bf16 v[128:131], a[224:227], a[152:155], v[128:131]
    s_waitcnt vmcnt(9)
    ds_read_b64_tr_b16 a[220:221], v23 offset:49152
    ds_read_b64_tr_b16 a[222:223], v23 offset:53248
    v_mfma_f32_16x16x32_bf16 v[160:163], a[224:227], a[156:159], v[160:163]
    v_mfma_f32_16x16x32_bf16 v[164:167], a[228:231], a[156:159], v[164:167]
    v_mfma_f32_16x16x32_bf16 v[168:171], a[232:235], a[156:159], v[168:171]
    v_mfma_f32_16x16x32_bf16 v[172:175], a[236:239], a[156:159], v[172:175]
    v_mfma_f32_16x16x32_bf16 v[176:179], a[240:243], a[156:159], v[176:179]
    v_mfma_f32_16x16x32_bf16 v[180:183], a[244:247], a[156:159], v[180:183]
    v_mfma_f32_16x16x32_bf16 v[184:187], a[248:251], a[156:159], v[184:187]
    v_mfma_f32_16x16x32_bf16 v[188:191], a[252:255], a[156:159], v[188:191]
    s_waitcnt vmcnt(8)
    v_mfma_f32_16x16x32_bf16 v[92:95], a[252:255], a[144:147], v[92:95]
    v_mfma_f32_16x16x32_bf16 v[88:91], a[248:251], a[144:147], v[88:91]
    v_mfma_f32_16x16x32_bf16 v[84:87], a[244:247], a[144:147], v[84:87]
    v_mfma_f32_16x16x32_bf16 v[80:83], a[240:243], a[144:147], v[80:83]
    v_mfma_f32_16x16x32_bf16 v[76:79], a[236:239], a[144:147], v[76:79]
    v_mfma_f32_16x16x32_bf16 v[72:75], a[232:235], a[144:147], v[72:75]
    v_mfma_f32_16x16x32_bf16 v[68:71], a[228:231], a[144:147], v[68:71]
    v_mfma_f32_16x16x32_bf16 v[64:67], a[224:227], a[144:147], v[64:67]
    s_waitcnt lgkmcnt(0) vmcnt(7)
    v_mfma_f32_16x16x32_bf16 v[96:99], a[192:195], a[164:167], v[96:99]
    v_mfma_f32_16x16x32_bf16 v[100:103], a[196:199], a[164:167], v[100:103]
    ds_read_b64_tr_b16 a[224:225], v16 offset:57344
    ds_read_b64_tr_b16 a[226:227], v16 offset:61440
    v_mfma_f32_16x16x32_bf16 v[104:107], a[200:203], a[164:167], v[104:107]
    v_mfma_f32_16x16x32_bf16 v[108:111], a[204:207], a[164:167], v[108:111]
    ds_read_b64_tr_b16 a[228:229], v17 offset:57344
    ds_read_b64_tr_b16 a[230:231], v17 offset:61440
    v_mfma_f32_16x16x32_bf16 v[112:115], a[208:211], a[164:167], v[112:115]
    v_mfma_f32_16x16x32_bf16 v[116:119], a[212:215], a[164:167], v[116:119]
    ds_read_b64_tr_b16 a[232:233], v18 offset:57344
    ds_read_b64_tr_b16 a[234:235], v18 offset:61440
    v_mfma_f32_16x16x32_bf16 v[120:123], a[216:219], a[164:167], v[120:123]
    v_mfma_f32_16x16x32_bf16 v[124:127], a[220:223], a[164:167], v[124:127]
    s_waitcnt vmcnt(6)
    ds_read_b64_tr_b16 a[236:237], v19 offset:57344
    ds_read_b64_tr_b16 a[238:239], v19 offset:61440
    v_mfma_f32_16x16x32_bf16 v[156:159], a[220:223], a[168:171], v[156:159]
    v_mfma_f32_16x16x32_bf16 v[152:155], a[216:219], a[168:171], v[152:155]
    ds_read_b64_tr_b16 a[240:241], v20 offset:57344
    ds_read_b64_tr_b16 a[242:243], v20 offset:61440
    v_mfma_f32_16x16x32_bf16 v[148:151], a[212:215], a[168:171], v[148:151]
    v_mfma_f32_16x16x32_bf16 v[144:147], a[208:211], a[168:171], v[144:147]
    ds_read_b64_tr_b16 a[244:245], v21 offset:57344
    ds_read_b64_tr_b16 a[246:247], v21 offset:61440
    v_mfma_f32_16x16x32_bf16 v[140:143], a[204:207], a[168:171], v[140:143]
    v_mfma_f32_16x16x32_bf16 v[136:139], a[200:203], a[168:171], v[136:139]
    ds_read_b64_tr_b16 a[248:249], v22 offset:57344
    ds_read_b64_tr_b16 a[250:251], v22 offset:61440
    v_mfma_f32_16x16x32_bf16 v[132:135], a[196:199], a[168:171], v[132:135]
    v_mfma_f32_16x16x32_bf16 v[128:131], a[192:195], a[168:171], v[128:131]
    s_waitcnt vmcnt(5)
    ds_read_b64_tr_b16 a[252:253], v23 offset:57344
    ds_read_b64_tr_b16 a[254:255], v23 offset:61440
    v_mfma_f32_16x16x32_bf16 v[160:163], a[192:195], a[172:175], v[160:163]
    v_mfma_f32_16x16x32_bf16 v[164:167], a[196:199], a[172:175], v[164:167]
    v_mfma_f32_16x16x32_bf16 v[168:171], a[200:203], a[172:175], v[168:171]
    v_mfma_f32_16x16x32_bf16 v[172:175], a[204:207], a[172:175], v[172:175]
    v_mfma_f32_16x16x32_bf16 v[176:179], a[208:211], a[172:175], v[176:179]
    v_mfma_f32_16x16x32_bf16 v[180:183], a[212:215], a[172:175], v[180:183]
    v_mfma_f32_16x16x32_bf16 v[184:187], a[216:219], a[172:175], v[184:187]
    v_mfma_f32_16x16x32_bf16 v[188:191], a[220:223], a[172:175], v[188:191]
    s_waitcnt vmcnt(4)
    v_mfma_f32_16x16x32_bf16 v[92:95], a[220:223], a[160:163], v[92:95]
    v_mfma_f32_16x16x32_bf16 v[88:91], a[216:219], a[160:163], v[88:91]
    v_mfma_f32_16x16x32_bf16 v[84:87], a[212:215], a[160:163], v[84:87]
    v_mfma_f32_16x16x32_bf16 v[80:83], a[208:211], a[160:163], v[80:83]
    v_mfma_f32_16x16x32_bf16 v[76:79], a[204:207], a[160:163], v[76:79]
    v_mfma_f32_16x16x32_bf16 v[72:75], a[200:203], a[160:163], v[72:75]
    v_mfma_f32_16x16x32_bf16 v[68:71], a[196:199], a[160:163], v[68:71]
    v_mfma_f32_16x16x32_bf16 v[64:67], a[192:195], a[160:163], v[64:67]
    s_waitcnt lgkmcnt(0) vmcnt(3)
    v_mfma_f32_16x16x32_bf16 v[96:99], a[224:227], a[180:183], v[96:99]
    v_mfma_f32_16x16x32_bf16 v[100:103], a[228:231], a[180:183], v[100:103]
    v_mfma_f32_16x16x32_bf16 v[104:107], a[232:235], a[180:183], v[104:107]
    v_mfma_f32_16x16x32_bf16 v[108:111], a[236:239], a[180:183], v[108:111]
    v_mfma_f32_16x16x32_bf16 v[112:115], a[240:243], a[180:183], v[112:115]
    v_mfma_f32_16x16x32_bf16 v[116:119], a[244:247], a[180:183], v[116:119]
    v_mfma_f32_16x16x32_bf16 v[120:123], a[248:251], a[180:183], v[120:123]
    v_mfma_f32_16x16x32_bf16 v[124:127], a[252:255], a[180:183], v[124:127]
    s_waitcnt vmcnt(2)
    v_mfma_f32_16x16x32_bf16 v[156:159], a[252:255], a[184:187], v[156:159]
    v_mfma_f32_16x16x32_bf16 v[152:155], a[248:251], a[184:187], v[152:155]
    v_mfma_f32_16x16x32_bf16 v[148:151], a[244:247], a[184:187], v[148:151]
    v_mfma_f32_16x16x32_bf16 v[144:147], a[240:243], a[184:187], v[144:147]
    v_mfma_f32_16x16x32_bf16 v[140:143], a[236:239], a[184:187], v[140:143]
    v_mfma_f32_16x16x32_bf16 v[136:139], a[232:235], a[184:187], v[136:139]
    v_mfma_f32_16x16x32_bf16 v[132:135], a[228:231], a[184:187], v[132:135]
    v_mfma_f32_16x16x32_bf16 v[128:131], a[224:227], a[184:187], v[128:131]
    s_waitcnt vmcnt(1)
    v_mfma_f32_16x16x32_bf16 v[160:163], a[224:227], a[188:191], v[160:163]
    v_mfma_f32_16x16x32_bf16 v[164:167], a[228:231], a[188:191], v[164:167]
    v_mfma_f32_16x16x32_bf16 v[168:171], a[232:235], a[188:191], v[168:171]
    v_mfma_f32_16x16x32_bf16 v[172:175], a[236:239], a[188:191], v[172:175]
    v_mfma_f32_16x16x32_bf16 v[176:179], a[240:243], a[188:191], v[176:179]
    v_mfma_f32_16x16x32_bf16 v[180:183], a[244:247], a[188:191], v[180:183]
    v_mfma_f32_16x16x32_bf16 v[184:187], a[248:251], a[188:191], v[184:187]
    v_mfma_f32_16x16x32_bf16 v[188:191], a[252:255], a[188:191], v[188:191]
    s_waitcnt vmcnt(0)
    v_mfma_f32_16x16x32_bf16 v[92:95], a[252:255], a[176:179], v[92:95]
    v_mfma_f32_16x16x32_bf16 v[88:91], a[248:251], a[176:179], v[88:91]
    v_mfma_f32_16x16x32_bf16 v[84:87], a[244:247], a[176:179], v[84:87]
    v_mfma_f32_16x16x32_bf16 v[80:83], a[240:243], a[176:179], v[80:83]
    v_mfma_f32_16x16x32_bf16 v[76:79], a[236:239], a[176:179], v[76:79]
    v_mfma_f32_16x16x32_bf16 v[72:75], a[232:235], a[176:179], v[72:75]
    v_mfma_f32_16x16x32_bf16 v[68:71], a[228:231], a[176:179], v[68:71]
    v_mfma_f32_16x16x32_bf16 v[64:67], a[224:227], a[176:179], v[64:67]
    s_add_u32 s65, s63, 4096
    v_cvt_pk_bf16_f32 v96, v96, v97
    v_cvt_pk_bf16_f32 v97, v98, v99
    v_cvt_pk_bf16_f32 v98, v100, v101
    v_cvt_pk_bf16_f32 v99, v102, v103
    v_cvt_pk_bf16_f32 v100, v104, v105
    v_cvt_pk_bf16_f32 v101, v106, v107
    v_cvt_pk_bf16_f32 v102, v108, v109
    v_cvt_pk_bf16_f32 v103, v110, v111
    buffer_store_dwordx4 v[96:99], v2, s[12:15], s65 offen offset:0 sc1
    v_cvt_pk_bf16_f32 v104, v112, v113
    v_cvt_pk_bf16_f32 v105, v114, v115
    v_cvt_pk_bf16_f32 v106, v116, v117
    v_cvt_pk_bf16_f32 v107, v118, v119
    buffer_store_dwordx4 v[100:103], v2, s[12:15], s65 offen offset:1024 sc1
    v_cvt_pk_bf16_f32 v108, v120, v121
    v_cvt_pk_bf16_f32 v109, v122, v123
    v_cvt_pk_bf16_f32 v110, v124, v125
    v_cvt_pk_bf16_f32 v111, v126, v127
    buffer_store_dwordx4 v[104:107], v2, s[12:15], s65 offen offset:2048 sc1
    buffer_store_dwordx4 v[108:111], v2, s[12:15], s65 offen offset:3072 sc1
    s_add_u32 s65, s63, 8192
    v_cvt_pk_bf16_f32 v128, v128, v129
    v_cvt_pk_bf16_f32 v129, v130, v131
    v_cvt_pk_bf16_f32 v130, v132, v133
    v_cvt_pk_bf16_f32 v131, v134, v135
    v_cvt_pk_bf16_f32 v132, v136, v137
    v_cvt_pk_bf16_f32 v133, v138, v139
    v_cvt_pk_bf16_f32 v134, v140, v141
    v_cvt_pk_bf16_f32 v135, v142, v143
    buffer_store_dwordx4 v[128:131], v2, s[12:15], s65 offen offset:0 sc1
    v_cvt_pk_bf16_f32 v136, v144, v145
    v_cvt_pk_bf16_f32 v137, v146, v147
    v_cvt_pk_bf16_f32 v138, v148, v149
    v_cvt_pk_bf16_f32 v139, v150, v151
    buffer_store_dwordx4 v[132:135], v2, s[12:15], s65 offen offset:1024 sc1
    v_cvt_pk_bf16_f32 v140, v152, v153
    v_cvt_pk_bf16_f32 v141, v154, v155
    v_cvt_pk_bf16_f32 v142, v156, v157
    v_cvt_pk_bf16_f32 v143, v158, v159
    buffer_store_dwordx4 v[136:139], v2, s[12:15], s65 offen offset:2048 sc1
    buffer_store_dwordx4 v[140:143], v2, s[12:15], s65 offen offset:3072 sc1
    s_add_u32 s65, s63, 12288
    v_cvt_pk_bf16_f32 v160, v160, v161
    v_cvt_pk_bf16_f32 v161, v162, v163
    v_cvt_pk_bf16_f32 v162, v164, v165
    v_cvt_pk_bf16_f32 v163, v166, v167
    v_cvt_pk_bf16_f32 v164, v168, v169
    v_cvt_pk_bf16_f32 v165, v170, v171
    v_cvt_pk_bf16_f32 v166, v172, v173
    v_cvt_pk_bf16_f32 v167, v174, v175
    buffer_store_dwordx4 v[160:163], v2, s[12:15], s65 offen offset:0 sc1
    v_cvt_pk_bf16_f32 v168, v176, v177
    v_cvt_pk_bf16_f32 v169, v178, v179
    v_cvt_pk_bf16_f32 v170, v180, v181
    v_cvt_pk_bf16_f32 v171, v182, v183
    buffer_store_dwordx4 v[164:167], v2, s[12:15], s65 offen offset:1024 sc1
    v_cvt_pk_bf16_f32 v172, v184, v185
    v_cvt_pk_bf16_f32 v173, v186, v187
    v_cvt_pk_bf16_f32 v174, v188, v189
    v_cvt_pk_bf16_f32 v175, v190, v191
    buffer_store_dwordx4 v[168:171], v2, s[12:15], s65 offen offset:2048 sc1
    buffer_store_dwordx4 v[172:175], v2, s[12:15], s65 offen offset:3072 sc1
    s_add_u32 s65, s63, 0
    v_cvt_pk_bf16_f32 v64, v64, v65
    v_cvt_pk_bf16_f32 v65, v66, v67
    v_cvt_pk_bf16_f32 v66, v68, v69
    v_cvt_pk_bf16_f32 v67, v70, v71
    v_cvt_pk_bf16_f32 v68, v72, v73
    v_cvt_pk_bf16_f32 v69, v74, v75
    v_cvt_pk_bf16_f32 v70, v76, v77
    v_cvt_pk_bf16_f32 v71, v78, v79
    buffer_store_dwordx4 v[64:67], v2, s[12:15], s65 offen offset:0 sc1
    v_cvt_pk_bf16_f32 v72, v80, v81
    v_cvt_pk_bf16_f32 v73, v82, v83
    v_cvt_pk_bf16_f32 v74, v84, v85
    v_cvt_pk_bf16_f32 v75, v86, v87
    buffer_store_dwordx4 v[68:71], v2, s[12:15], s65 offen offset:1024 sc1
    v_cvt_pk_bf16_f32 v76, v88, v89
    v_cvt_pk_bf16_f32 v77, v90, v91
    v_cvt_pk_bf16_f32 v78, v92, v93
    v_cvt_pk_bf16_f32 v79, v94, v95
    buffer_store_dwordx4 v[72:75], v2, s[12:15], s65 offen offset:2048 sc1
    buffer_store_dwordx4 v[76:79], v2, s[12:15], s65 offen offset:3072 sc1
    s_waitcnt vmcnt(0)
    s_barrier
    v_mov_b32 v5, 5
    buffer_store_dword v5, v0, s[76:79], 0 offen sc1
    s_endpgm
DN_idle:
    s_sub_u32 s34, s57, s56
    v_lshrrev_b32 v52, 5, v1
    v_and_b32 v53, 31, v1
    v_mul_u32_u24 v52, s34, v52
    v_lshl_add_u32 v52, v53, 7, v52
    s_waitcnt vmcnt(0) lgkmcnt(0)
    s_barrier
    v_mov_b32 v5, 4
    buffer_store_dword v5, v0, s[76:79], 0 offen sc1
    s_waitcnt vmcnt(0)
    s_endpgm
CE_23:
    s_bitcmp1_b32 s31, 3
    s_cbranch_scc1 CE_3
CE_2:
    v_accvgpr_read_b32 v44, a0
    v_accvgpr_read_b32 v45, a1
    v_accvgpr_read_b32 v46, a2
    v_accvgpr_read_b32 v47, a3
    v_accvgpr_read_b32 v48, a4
    v_accvgpr_read_b32 v49, a5
    v_accvgpr_read_b32 v50, a6
    v_accvgpr_read_b32 v51, a7
    v_pk_mul_f32 v[44:45], v[44:45], v[8:9]
    v_pk_mul_f32 v[46:47], v[46:47], v[8:9]
    v_pk_mul_f32 v[48:49], v[48:49], v[8:9]
    v_pk_mul_f32 v[50:51], v[50:51], v[8:9]
    v_cvt_pk_bf16_f32 v200, v44, v45
    v_cvt_pk_bf16_f32 v201, v46, v47
    v_cvt_pk_bf16_f32 v202, v48, v49
    v_cvt_pk_bf16_f32 v203, v50, v51
    buffer_store_dwordx4 v[200:203], v2, s[52:55], s56 offen offset:0 sc1
    v_accvgpr_read_b32 v52, a8
    v_accvgpr_read_b32 v53, a9
    v_accvgpr_read_b32 v54, a10
    v_accvgpr_read_b32 v55, a11
    v_accvgpr_read_b32 v56, a12
    v_accvgpr_read_b32 v57, a13
    v_accvgpr_read_b32 v58, a14
    v_accvgpr_read_b32 v59, a15
    v_pk_mul_f32 v[52:53], v[52:53], v[8:9]
    v_pk_mul_f32 v[54:55], v[54:55], v[8:9]
    v_pk_mul_f32 v[56:57], v[56:57], v[8:9]
    v_pk_mul_f32 v[58:59], v[58:59], v[8:9]
    v_cvt_pk_bf16_f32 v216, v52, v53
    v_cvt_pk_bf16_f32 v217, v54, v55
    v_cvt_pk_bf16_f32 v218, v56, v57
    v_cvt_pk_bf16_f32 v219, v58, v59
    buffer_store_dwordx4 v[216:219], v2, s[52:55], s56 offen offset:1024 sc1
    v_accvgpr_read_b32 v44, a16
    v_accvgpr_read_b32 v45, a17
    v_accvgpr_read_b32 v46, a18
    v_accvgpr_read_b32 v47, a19
    v_accvgpr_read_b32 v48, a20
    v_accvgpr_read_b32 v49, a21
    v_accvgpr_read_b32 v50, a22
    v_accvgpr_read_b32 v51, a23
    v_pk_mul_f32 v[44:45], v[44:45], v[8:9]
    v_pk_mul_f32 v[46:47], v[46:47], v[8:9]
    v_pk_mul_f32 v[48:49], v[48:49], v[8:9]
    v_pk_mul_f32 v[50:51], v[50:51], v[8:9]
    v_cvt_pk_bf16_f32 v232, v44, v45
    v_cvt_pk_bf16_f32 v233, v46, v47
    v_cvt_pk_bf16_f32 v234, v48, v49
    v_cvt_pk_bf16_f32 v235, v50, v51
    buffer_store_dwordx4 v[232:235], v2, s[52:55], s56 offen offset:2048 sc1
    v_accvgpr_read_b32 v52, a24
    v_accvgpr_read_b32 v53, a25
    v_accvgpr_read_b32 v54, a26
    v_accvgpr_read_b32 v55, a27
    v_accvgpr_read_b32 v56, a28
    v_accvgpr_read_b32 v57, a29
    v_accvgpr_read_b32 v58, a30
    v_accvgpr_read_b32 v59, a31
    v_pk_mul_f32 v[52:53], v[52:53], v[8:9]
    v_pk_mul_f32 v[54:55], v[54:55], v[8:9]
    v_pk_mul_f32 v[56:57], v[56:57], v[8:9]
    v_pk_mul_f32 v[58:59], v[58:59], v[8:9]
    v_cvt_pk_bf16_f32 v248, v52, v53
    v_cvt_pk_bf16_f32 v249, v54, v55
    v_cvt_pk_bf16_f32 v250, v56, v57
    v_cvt_pk_bf16_f32 v251, v58, v59
    buffer_store_dwordx4 v[248:251], v2, s[52:55], s56 offen offset:3072 sc1
    v_accvgpr_read_b32 v44, a32
    v_accvgpr_read_b32 v45, a33
    v_accvgpr_read_b32 v46, a34
    v_accvgpr_read_b32 v47, a35
    v_accvgpr_read_b32 v48, a36
    v_accvgpr_read_b32 v49, a37
    v_accvgpr_read_b32 v50, a38
    v_accvgpr_read_b32 v51, a39
    v_pk_mul_f32 v[44:45], v[44:45], v[12:13]
    v_pk_mul_f32 v[46:47], v[46:47], v[12:13]
    v_pk_mul_f32 v[48:49], v[48:49], v[12:13]
    v_pk_mul_f32 v[50:51], v[50:51], v[12:13]
    v_cvt_pk_bf16_f32 v204, v44, v45
    v_cvt_pk_bf16_f32 v205, v46, v47
    v_cvt_pk_bf16_f32 v206, v48, v49
    v_cvt_pk_bf16_f32 v207, v50, v51
    buffer_store_dwordx4 v[204:207], v2, s[52:55], s57 offen offset:0 sc1
    v_accvgpr_read_b32 v52, a40
    v_accvgpr_read_b32 v53, a41
    v_accvgpr_read_b32 v54, a42
    v_accvgpr_read_b32 v55, a43
    v_accvgpr_read_b32 v56, a44
    v_accvgpr_read_b32 v57, a45
    v_accvgpr_read_b32 v58, a46
    v_accvgpr_read_b32 v59, a47
    v_pk_mul_f32 v[52:53], v[52:53], v[12:13]
    v_pk_mul_f32 v[54:55], v[54:55], v[12:13]
    v_pk_mul_f32 v[56:57], v[56:57], v[12:13]
    v_pk_mul_f32 v[58:59], v[58:59], v[12:13]
    v_cvt_pk_bf16_f32 v220, v52, v53
    v_cvt_pk_bf16_f32 v221, v54, v55
    v_cvt_pk_bf16_f32 v222, v56, v57
    v_cvt_pk_bf16_f32 v223, v58, v59
    buffer_store_dwordx4 v[220:223], v2, s[52:55], s57 offen offset:1024 sc1
    v_accvgpr_read_b32 v44, a48
    v_accvgpr_read_b32 v45, a49
    v_accvgpr_read_b32 v46, a50
    v_accvgpr_read_b32 v47, a51
    v_accvgpr_read_b32 v48, a52
    v_accvgpr_read_b32 v49, a53
    v_accvgpr_read_b32 v50, a54
    v_accvgpr_read_b32 v51, a55
    v_pk_mul_f32 v[44:45], v[44:45], v[12:13]
    v_pk_mul_f32 v[46:47], v[46:47], v[12:13]
    v_pk_mul_f32 v[48:49], v[48:49], v[12:13]
    v_pk_mul_f32 v[50:51], v[50:51], v[12:13]
    v_cvt_pk_bf16_f32 v236, v44, v45
    v_cvt_pk_bf16_f32 v237, v46, v47
    v_cvt_pk_bf16_f32 v238, v48, v49
    v_cvt_pk_bf16_f32 v239, v50, v51
    buffer_store_dwordx4 v[236:239], v2, s[52:55], s57 offen offset:2048 sc1
    v_accvgpr_read_b32 v52, a56
    v_accvgpr_read_b32 v53, a57
    v_accvgpr_read_b32 v54, a58
    v_accvgpr_read_b32 v55, a59
    v_accvgpr_read_b32 v56, a60
    v_accvgpr_read_b32 v57, a61
    v_accvgpr_read_b32 v58, a62
    v_accvgpr_read_b32 v59, a63
    v_pk_mul_f32 v[52:53], v[52:53], v[12:13]
    v_pk_mul_f32 v[54:55], v[54:55], v[12:13]
    v_pk_mul_f32 v[56:57], v[56:57], v[12:13]
    v_pk_mul_f32 v[58:59], v[58:59], v[12:13]
    v_cvt_pk_bf16_f32 v252, v52, v53
    v_cvt_pk_bf16_f32 v253, v54, v55
    v_cvt_pk_bf16_f32 v254, v56, v57
    v_cvt_pk_bf16_f32 v255, v58, v59
    buffer_store_dwordx4 v[252:255], v2, s[52:55], s57 offen offset:3072 sc1
    v_accvgpr_read_b32 v44, a64
    v_accvgpr_read_b32 v45, a65
    v_accvgpr_read_b32 v46, a66
    v_accvgpr_read_b32 v47, a67
    v_accvgpr_read_b32 v48, a68
    v_accvgpr_read_b32 v49, a69
    v_accvgpr_read_b32 v50, a70
    v_accvgpr_read_b32 v51, a71
    v_pk_mul_f32 v[44:45], v[44:45], v[16:17]
    v_pk_mul_f32 v[46:47], v[46:47], v[16:17]
    v_pk_mul_f32 v[48:49], v[48:49], v[16:17]
    v_pk_mul_f32 v[50:51], v[50:51], v[16:17]
    v_cvt_pk_bf16_f32 v192, v44, v45
    v_cvt_pk_bf16_f32 v193, v46, v47
    v_cvt_pk_bf16_f32 v194, v48, v49
    v_cvt_pk_bf16_f32 v195, v50, v51
    buffer_store_dwordx4 v[192:195], v2, s[52:55], s58 offen offset:0 sc1
    v_accvgpr_read_b32 v52, a72
    v_accvgpr_read_b32 v53, a73
    v_accvgpr_read_b32 v54, a74
    v_accvgpr_read_b32 v55, a75
    v_accvgpr_read_b32 v56, a76
    v_accvgpr_read_b32 v57, a77
    v_accvgpr_read_b32 v58, a78
    v_accvgpr_read_b32 v59, a79
    v_pk_mul_f32 v[52:53], v[52:53], v[16:17]
    v_pk_mul_f32 v[54:55], v[54:55], v[16:17]
    v_pk_mul_f32 v[56:57], v[56:57], v[16:17]
    v_pk_mul_f32 v[58:59], v[58:59], v[16:17]
    v_cvt_pk_bf16_f32 v208, v52, v53
    v_cvt_pk_bf16_f32 v209, v54, v55
    v_cvt_pk_bf16_f32 v210, v56, v57
    v_cvt_pk_bf16_f32 v211, v58, v59
    buffer_store_dwordx4 v[208:211], v2, s[52:55], s58 offen offset:1024 sc1
    v_accvgpr_read_b32 v44, a80
    v_accvgpr_read_b32 v45, a81
    v_accvgpr_read_b32 v46, a82
    v_accvgpr_read_b32 v47, a83
    v_accvgpr_read_b32 v48, a84
    v_accvgpr_read_b32 v49, a85
    v_accvgpr_read_b32 v50, a86
    v_accvgpr_read_b32 v51, a87
    v_pk_mul_f32 v[44:45], v[44:45], v[16:17]
    v_pk_mul_f32 v[46:47], v[46:47], v[16:17]
    v_pk_mul_f32 v[48:49], v[48:49], v[16:17]
    v_pk_mul_f32 v[50:51], v[50:51], v[16:17]
    v_cvt_pk_bf16_f32 v224, v44, v45
    v_cvt_pk_bf16_f32 v225, v46, v47
    v_cvt_pk_bf16_f32 v226, v48, v49
    v_cvt_pk_bf16_f32 v227, v50, v51
    buffer_store_dwordx4 v[224:227], v2, s[52:55], s58 offen offset:2048 sc1
    v_accvgpr_read_b32 v52, a88
    v_accvgpr_read_b32 v53, a89
    v_accvgpr_read_b32 v54, a90
    v_accvgpr_read_b32 v55, a91
    v_accvgpr_read_b32 v56, a92
    v_accvgpr_read_b32 v57, a93
    v_accvgpr_read_b32 v58, a94
    v_accvgpr_read_b32 v59, a95
    v_pk_mul_f32 v[52:53], v[52:53], v[16:17]
    v_pk_mul_f32 v[54:55], v[54:55], v[16:17]
    v_pk_mul_f32 v[56:57], v[56:57], v[16:17]
    v_pk_mul_f32 v[58:59], v[58:59], v[16:17]
    v_cvt_pk_bf16_f32 v240, v52, v53
    v_cvt_pk_bf16_f32 v241, v54, v55
    v_cvt_pk_bf16_f32 v242, v56, v57
    v_cvt_pk_bf16_f32 v243, v58, v59
    buffer_store_dwordx4 v[240:243], v2, s[52:55], s58 offen offset:3072 sc1
    v_accvgpr_read_b32 v44, a96
    v_accvgpr_read_b32 v45, a97
    v_accvgpr_read_b32 v46, a98
    v_accvgpr_read_b32 v47, a99
    v_accvgpr_read_b32 v48, a100
    v_accvgpr_read_b32 v49, a101
    v_accvgpr_read_b32 v50, a102
    v_accvgpr_read_b32 v51, a103
    v_pk_mul_f32 v[44:45], v[44:45], v[20:21]
    v_pk_mul_f32 v[46:47], v[46:47], v[20:21]
    v_pk_mul_f32 v[48:49], v[48:49], v[20:21]
    v_pk_mul_f32 v[50:51], v[50:51], v[20:21]
    v_cvt_pk_bf16_f32 v196, v44, v45
    v_cvt_pk_bf16_f32 v197, v46, v47
    v_cvt_pk_bf16_f32 v198, v48, v49
    v_cvt_pk_bf16_f32 v199, v50, v51
    buffer_store_dwordx4 v[196:199], v2, s[52:55], s59 offen offset:0 sc1
    v_accvgpr_read_b32 v52, a104
    v_accvgpr_read_b32 v53, a105
    v_accvgpr_read_b32 v54, a106
    v_accvgpr_read_b32 v55, a107
    v_accvgpr_read_b32 v56, a108
    v_accvgpr_read_b32 v57, a109
    v_accvgpr_read_b32 v58, a110
    v_accvgpr_read_b32 v59, a111
    v_pk_mul_f32 v[52:53], v[52:53], v[20:21]
    v_pk_mul_f32 v[54:55], v[54:55], v[20:21]
    v_pk_mul_f32 v[56:57], v[56:57], v[20:21]
    v_pk_mul_f32 v[58:59], v[58:59], v[20:21]
    v_cvt_pk_bf16_f32 v212, v52, v53
    v_cvt_pk_bf16_f32 v213, v54, v55
    v_cvt_pk_bf16_f32 v214, v56, v57
    v_cvt_pk_bf16_f32 v215, v58, v59
    buffer_store_dwordx4 v[212:215], v2, s[52:55], s59 offen offset:1024 sc1
    v_accvgpr_read_b32 v44, a112
    v_accvgpr_read_b32 v45, a113
    v_accvgpr_read_b32 v46, a114
    v_accvgpr_read_b32 v47, a115
    v_accvgpr_read_b32 v48, a116
    v_accvgpr_read_b32 v49, a117
    v_accvgpr_read_b32 v50, a118
    v_accvgpr_read_b32 v51, a119
    v_pk_mul_f32 v[44:45], v[44:45], v[20:21]
    v_pk_mul_f32 v[46:47], v[46:47], v[20:21]
    v_pk_mul_f32 v[48:49], v[48:49], v[20:21]
    v_pk_mul_f32 v[50:51], v[50:51], v[20:21]
    v_cvt_pk_bf16_f32 v228, v44, v45
    v_cvt_pk_bf16_f32 v229, v46, v47
    v_cvt_pk_bf16_f32 v230, v48, v49
    v_cvt_pk_bf16_f32 v231, v50, v51
    buffer_store_dwordx4 v[228:231], v2, s[52:55], s59 offen offset:2048 sc1
    v_accvgpr_read_b32 v52, a120
    v_accvgpr_read_b32 v53, a121
    v_accvgpr_read_b32 v54, a122
    v_accvgpr_read_b32 v55, a123
    v_accvgpr_read_b32 v56, a124
    v_accvgpr_read_b32 v57, a125
    v_accvgpr_read_b32 v58, a126
    v_accvgpr_read_b32 v59, a127
    v_pk_mul_f32 v[52:53], v[52:53], v[20:21]
    v_pk_mul_f32 v[54:55], v[54:55], v[20:21]
    v_pk_mul_f32 v[56:57], v[56:57], v[20:21]
    v_pk_mul_f32 v[58:59], v[58:59], v[20:21]
    v_cvt_pk_bf16_f32 v244, v52, v53
    v_cvt_pk_bf16_f32 v245, v54, v55
    v_cvt_pk_bf16_f32 v246, v56, v57
    v_cvt_pk_bf16_f32 v247, v58, v59
    buffer_store_dwordx4 v[244:247], v2, s[52:55], s59 offen offset:3072 sc1
    s_branch CE_end
CE_1:
    v_accvgpr_read_b32 v44, a0
    v_accvgpr_read_b32 v45, a1
    v_accvgpr_read_b32 v46, a2
    v_accvgpr_read_b32 v47, a3
    v_accvgpr_read_b32 v48, a4
    v_accvgpr_read_b32 v49, a5
    v_accvgpr_read_b32 v50, a6
    v_accvgpr_read_b32 v51, a7
    v_pk_mul_f32 v[44:45], v[44:45], v[8:9]
    v_pk_mul_f32 v[46:47], v[46:47], v[8:9]
    v_pk_mul_f32 v[48:49], v[48:49], v[8:9]
    v_pk_mul_f32 v[50:51], v[50:51], v[8:9]
    v_cvt_pk_bf16_f32 v196, v44, v45
    v_cvt_pk_bf16_f32 v197, v46, v47
    v_cvt_pk_bf16_f32 v198, v48, v49
    v_cvt_pk_bf16_f32 v199, v50, v51
    buffer_store_dwordx4 v[196:199], v2, s[52:55], s56 offen offset:0 sc1
    v_accvgpr_read_b32 v52, a8
    v_accvgpr_read_b32 v53, a9
    v_accvgpr_read_b32 v54, a10
    v_accvgpr_read_b32 v55, a11
    v_accvgpr_read_b32 v56, a12
    v_accvgpr_read_b32 v57, a13
    v_accvgpr_read_b32 v58, a14
    v_accvgpr_read_b32 v59, a15
    v_pk_mul_f32 v[52:53], v[52:53], v[8:9]
    v_pk_mul_f32 v[54:55], v[54:55], v[8:9]
    v_pk_mul_f32 v[56:57], v[56:57], v[8:9]
    v_pk_mul_f32 v[58:59], v[58:59], v[8:9]
    v_cvt_pk_bf16_f32 v212, v52, v53
    v_cvt_pk_bf16_f32 v213, v54, v55
    v_cvt_pk_bf16_f32 v214, v56, v57
    v_cvt_pk_bf16_f32 v215, v58, v59
    buffer_store_dwordx4 v[212:215], v2, s[52:55], s56 offen offset:1024 sc1
    v_accvgpr_read_b32 v44, a16
    v_accvgpr_read_b32 v45, a17
    v_accvgpr_read_b32 v46, a18
    v_accvgpr_read_b32 v47, a19
    v_accvgpr_read_b32 v48, a20
    v_accvgpr_read_b32 v49, a21
    v_accvgpr_read_b32 v50, a22
    v_accvgpr_read_b32 v51, a23
    v_pk_mul_f32 v[44:45], v[44:45], v[8:9]
    v_pk_mul_f32 v[46:47], v[46:47], v[8:9]
    v_pk_mul_f32 v[48:49], v[48:49], v[8:9]
    v_pk_mul_f32 v[50:51], v[50:51], v[8:9]
    v_cvt_pk_bf16_f32 v228, v44, v45
    v_cvt_pk_bf16_f32 v229, v46, v47
    v_cvt_pk_bf16_f32 v230, v48, v49
    v_cvt_pk_bf16_f32 v231, v50, v51
    buffer_store_dwordx4 v[228:231], v2, s[52:55], s56 offen offset:2048 sc1
    v_accvgpr_read_b32 v52, a24
    v_accvgpr_read_b32 v53, a25
    v_accvgpr_read_b32 v54, a26
    v_accvgpr_read_b32 v55, a27
    v_accvgpr_read_b32 v56, a28
    v_accvgpr_read_b32 v57, a29
    v_accvgpr_read_b32 v58, a30
    v_accvgpr_read_b32 v59, a31
    v_pk_mul_f32 v[52:53], v[52:53], v[8:9]
    v_pk_mul_f32 v[54:55], v[54:55], v[8:9]
    v_pk_mul_f32 v[56:57], v[56:57], v[8:9]
    v_pk_mul_f32 v[58:59], v[58:59], v[8:9]
    v_cvt_pk_bf16_f32 v244, v52, v53
    v_cvt_pk_bf16_f32 v245, v54, v55
    v_cvt_pk_bf16_f32 v246, v56, v57
    v_cvt_pk_bf16_f32 v247, v58, v59
    buffer_store_dwordx4 v[244:247], v2, s[52:55], s56 offen offset:3072 sc1
    v_accvgpr_read_b32 v44, a32
    v_accvgpr_read_b32 v45, a33
    v_accvgpr_read_b32 v46, a34
    v_accvgpr_read_b32 v47, a35
    v_accvgpr_read_b32 v48, a36
    v_accvgpr_read_b32 v49, a37
    v_accvgpr_read_b32 v50, a38
    v_accvgpr_read_b32 v51, a39
    v_pk_mul_f32 v[44:45], v[44:45], v[12:13]
    v_pk_mul_f32 v[46:47], v[46:47], v[12:13]
    v_pk_mul_f32 v[48:49], v[48:49], v[12:13]
    v_pk_mul_f32 v[50:51], v[50:51], v[12:13]
    v_cvt_pk_bf16_f32 v192, v44, v45
    v_cvt_pk_bf16_f32 v193, v46, v47
    v_cvt_pk_bf16_f32 v194, v48, v49
    v_cvt_pk_bf16_f32 v195, v50, v51
    buffer_store_dwordx4 v[192:195], v2, s[52:55], s57 offen offset:0 sc1
    v_accvgpr_read_b32 v52, a40
    v_accvgpr_read_b32 v53, a41
    v_accvgpr_read_b32 v54, a42
    v_accvgpr_read_b32 v55, a43
    v_accvgpr_read_b32 v56, a44
    v_accvgpr_read_b32 v57, a45
    v_accvgpr_read_b32 v58, a46
    v_accvgpr_read_b32 v59, a47
    v_pk_mul_f32 v[52:53], v[52:53], v[12:13]
    v_pk_mul_f32 v[54:55], v[54:55], v[12:13]
    v_pk_mul_f32 v[56:57], v[56:57], v[12:13]
    v_pk_mul_f32 v[58:59], v[58:59], v[12:13]
    v_cvt_pk_bf16_f32 v208, v52, v53
    v_cvt_pk_bf16_f32 v209, v54, v55
    v_cvt_pk_bf16_f32 v210, v56, v57
    v_cvt_pk_bf16_f32 v211, v58, v59
    buffer_store_dwordx4 v[208:211], v2, s[52:55], s57 offen offset:1024 sc1
    v_accvgpr_read_b32 v44, a48
    v_accvgpr_read_b32 v45, a49
    v_accvgpr_read_b32 v46, a50
    v_accvgpr_read_b32 v47, a51
    v_accvgpr_read_b32 v48, a52
    v_accvgpr_read_b32 v49, a53
    v_accvgpr_read_b32 v50, a54
    v_accvgpr_read_b32 v51, a55
    v_pk_mul_f32 v[44:45], v[44:45], v[12:13]
    v_pk_mul_f32 v[46:47], v[46:47], v[12:13]
    v_pk_mul_f32 v[48:49], v[48:49], v[12:13]
    v_pk_mul_f32 v[50:51], v[50:51], v[12:13]
    v_cvt_pk_bf16_f32 v224, v44, v45
    v_cvt_pk_bf16_f32 v225, v46, v47
    v_cvt_pk_bf16_f32 v226, v48, v49
    v_cvt_pk_bf16_f32 v227, v50, v51
    buffer_store_dwordx4 v[224:227], v2, s[52:55], s57 offen offset:2048 sc1
    v_accvgpr_read_b32 v52, a56
    v_accvgpr_read_b32 v53, a57
    v_accvgpr_read_b32 v54, a58
    v_accvgpr_read_b32 v55, a59
    v_accvgpr_read_b32 v56, a60
    v_accvgpr_read_b32 v57, a61
    v_accvgpr_read_b32 v58, a62
    v_accvgpr_read_b32 v59, a63
    v_pk_mul_f32 v[52:53], v[52:53], v[12:13]
    v_pk_mul_f32 v[54:55], v[54:55], v[12:13]
    v_pk_mul_f32 v[56:57], v[56:57], v[12:13]
    v_pk_mul_f32 v[58:59], v[58:59], v[12:13]
    v_cvt_pk_bf16_f32 v240, v52, v53
    v_cvt_pk_bf16_f32 v241, v54, v55
    v_cvt_pk_bf16_f32 v242, v56, v57
    v_cvt_pk_bf16_f32 v243, v58, v59
    buffer_store_dwordx4 v[240:243], v2, s[52:55], s57 offen offset:3072 sc1
    v_accvgpr_read_b32 v44, a64
    v_accvgpr_read_b32 v45, a65
    v_accvgpr_read_b32 v46, a66
    v_accvgpr_read_b32 v47, a67
    v_accvgpr_read_b32 v48, a68
    v_accvgpr_read_b32 v49, a69
    v_accvgpr_read_b32 v50, a70
    v_accvgpr_read_b32 v51, a71
    v_pk_mul_f32 v[44:45], v[44:45], v[16:17]
    v_pk_mul_f32 v[46:47], v[46:47], v[16:17]
    v_pk_mul_f32 v[48:49], v[48:49], v[16:17]
    v_pk_mul_f32 v[50:51], v[50:51], v[16:17]
    v_cvt_pk_bf16_f32 v204, v44, v45
    v_cvt_pk_bf16_f32 v205, v46, v47
    v_cvt_pk_bf16_f32 v206, v48, v49
    v_cvt_pk_bf16_f32 v207, v50, v51
    buffer_store_dwordx4 v[204:207], v2, s[52:55], s58 offen offset:0 sc1
    v_accvgpr_read_b32 v52, a72
    v_accvgpr_read_b32 v53, a73
    v_accvgpr_read_b32 v54, a74
    v_accvgpr_read_b32 v55, a75
    v_accvgpr_read_b32 v56, a76
    v_accvgpr_read_b32 v57, a77
    v_accvgpr_read_b32 v58, a78
    v_accvgpr_read_b32 v59, a79
    v_pk_mul_f32 v[52:53], v[52:53], v[16:17]
    v_pk_mul_f32 v[54:55], v[54:55], v[16:17]
    v_pk_mul_f32 v[56:57], v[56:57], v[16:17]
    v_pk_mul_f32 v[58:59], v[58:59], v[16:17]
    v_cvt_pk_bf16_f32 v220, v52, v53
    v_cvt_pk_bf16_f32 v221, v54, v55
    v_cvt_pk_bf16_f32 v222, v56, v57
    v_cvt_pk_bf16_f32 v223, v58, v59
    buffer_store_dwordx4 v[220:223], v2, s[52:55], s58 offen offset:1024 sc1
    v_accvgpr_read_b32 v44, a80
    v_accvgpr_read_b32 v45, a81
    v_accvgpr_read_b32 v46, a82
    v_accvgpr_read_b32 v47, a83
    v_accvgpr_read_b32 v48, a84
    v_accvgpr_read_b32 v49, a85
    v_accvgpr_read_b32 v50, a86
    v_accvgpr_read_b32 v51, a87
    v_pk_mul_f32 v[44:45], v[44:45], v[16:17]
    v_pk_mul_f32 v[46:47], v[46:47], v[16:17]
    v_pk_mul_f32 v[48:49], v[48:49], v[16:17]
    v_pk_mul_f32 v[50:51], v[50:51], v[16:17]
    v_cvt_pk_bf16_f32 v236, v44, v45
    v_cvt_pk_bf16_f32 v237, v46, v47
    v_cvt_pk_bf16_f32 v238, v48, v49
    v_cvt_pk_bf16_f32 v239, v50, v51
    buffer_store_dwordx4 v[236:239], v2, s[52:55], s58 offen offset:2048 sc1
    v_accvgpr_read_b32 v52, a88
    v_accvgpr_read_b32 v53, a89
    v_accvgpr_read_b32 v54, a90
    v_accvgpr_read_b32 v55, a91
    v_accvgpr_read_b32 v56, a92
    v_accvgpr_read_b32 v57, a93
    v_accvgpr_read_b32 v58, a94
    v_accvgpr_read_b32 v59, a95
    v_pk_mul_f32 v[52:53], v[52:53], v[16:17]
    v_pk_mul_f32 v[54:55], v[54:55], v[16:17]
    v_pk_mul_f32 v[56:57], v[56:57], v[16:17]
    v_pk_mul_f32 v[58:59], v[58:59], v[16:17]
    v_cvt_pk_bf16_f32 v252, v52, v53
    v_cvt_pk_bf16_f32 v253, v54, v55
    v_cvt_pk_bf16_f32 v254, v56, v57
    v_cvt_pk_bf16_f32 v255, v58, v59
    buffer_store_dwordx4 v[252:255], v2, s[52:55], s58 offen offset:3072 sc1
    v_accvgpr_read_b32 v44, a96
    v_accvgpr_read_b32 v45, a97
    v_accvgpr_read_b32 v46, a98
    v_accvgpr_read_b32 v47, a99
    v_accvgpr_read_b32 v48, a100
    v_accvgpr_read_b32 v49, a101
    v_accvgpr_read_b32 v50, a102
    v_accvgpr_read_b32 v51, a103
    v_pk_mul_f32 v[44:45], v[44:45], v[20:21]
    v_pk_mul_f32 v[46:47], v[46:47], v[20:21]
    v_pk_mul_f32 v[48:49], v[48:49], v[20:21]
    v_pk_mul_f32 v[50:51], v[50:51], v[20:21]
    v_cvt_pk_bf16_f32 v200, v44, v45
    v_cvt_pk_bf16_f32 v201, v46, v47
    v_cvt_pk_bf16_f32 v202, v48, v49
    v_cvt_pk_bf16_f32 v203, v50, v51
    buffer_store_dwordx4 v[200:203], v2, s[52:55], s59 offen offset:0 sc1
    v_accvgpr_read_b32 v52, a104
    v_accvgpr_read_b32 v53, a105
    v_accvgpr_read_b32 v54, a106
    v_accvgpr_read_b32 v55, a107
    v_accvgpr_read_b32 v56, a108
    v_accvgpr_read_b32 v57, a109
    v_accvgpr_read_b32 v58, a110
    v_accvgpr_read_b32 v59, a111
    v_pk_mul_f32 v[52:53], v[52:53], v[20:21]
    v_pk_mul_f32 v[54:55], v[54:55], v[20:21]
    v_pk_mul_f32 v[56:57], v[56:57], v[20:21]
    v_pk_mul_f32 v[58:59], v[58:59], v[20:21]
    v_cvt_pk_bf16_f32 v216, v52, v53
    v_cvt_pk_bf16_f32 v217, v54, v55
    v_cvt_pk_bf16_f32 v218, v56, v57
    v_cvt_pk_bf16_f32 v219, v58, v59
    buffer_store_dwordx4 v[216:219], v2, s[52:55], s59 offen offset:1024 sc1
    v_accvgpr_read_b32 v44, a112
    v_accvgpr_read_b32 v45, a113
    v_accvgpr_read_b32 v46, a114
    v_accvgpr_read_b32 v47, a115
    v_accvgpr_read_b32 v48, a116
    v_accvgpr_read_b32 v49, a117
    v_accvgpr_read_b32 v50, a118
    v_accvgpr_read_b32 v51, a119
    v_pk_mul_f32 v[44:45], v[44:45], v[20:21]
    v_pk_mul_f32 v[46:47], v[46:47], v[20:21]
    v_pk_mul_f32 v[48:49], v[48:49], v[20:21]
    v_pk_mul_f32 v[50:51], v[50:51], v[20:21]
    v_cvt_pk_bf16_f32 v232, v44, v45
    v_cvt_pk_bf16_f32 v233, v46, v47
    v_cvt_pk_bf16_f32 v234, v48, v49
    v_cvt_pk_bf16_f32 v235, v50, v51
    buffer_store_dwordx4 v[232:235], v2, s[52:55], s59 offen offset:2048 sc1
    v_accvgpr_read_b32 v52, a120
    v_accvgpr_read_b32 v53, a121
    v_accvgpr_read_b32 v54, a122
    v_accvgpr_read_b32 v55, a123
    v_accvgpr_read_b32 v56, a124
    v_accvgpr_read_b32 v57, a125
    v_accvgpr_read_b32 v58, a126
    v_accvgpr_read_b32 v59, a127
    v_pk_mul_f32 v[52:53], v[52:53], v[20:21]
    v_pk_mul_f32 v[54:55], v[54:55], v[20:21]
    v_pk_mul_f32 v[56:57], v[56:57], v[20:21]
    v_pk_mul_f32 v[58:59], v[58:59], v[20:21]
    v_cvt_pk_bf16_f32 v248, v52, v53
    v_cvt_pk_bf16_f32 v249, v54, v55
    v_cvt_pk_bf16_f32 v250, v56, v57
    v_cvt_pk_bf16_f32 v251, v58, v59
    buffer_store_dwordx4 v[248:251], v2, s[52:55], s59 offen offset:3072 sc1
    s_branch CE_end
CE_3:
    v_accvgpr_read_b32 v44, a0
    v_accvgpr_read_b32 v45, a1
    v_accvgpr_read_b32 v46, a2
    v_accvgpr_read_b32 v47, a3
    v_accvgpr_read_b32 v48, a4
    v_accvgpr_read_b32 v49, a5
    v_accvgpr_read_b32 v50, a6
    v_accvgpr_read_b32 v51, a7
    v_pk_mul_f32 v[44:45], v[44:45], v[8:9]
    v_pk_mul_f32 v[46:47], v[46:47], v[8:9]
    v_pk_mul_f32 v[48:49], v[48:49], v[8:9]
    v_pk_mul_f32 v[50:51], v[50:51], v[8:9]
    v_cvt_pk_bf16_f32 v204, v44, v45
    v_cvt_pk_bf16_f32 v205, v46, v47
    v_cvt_pk_bf16_f32 v206, v48, v49
    v_cvt_pk_bf16_f32 v207, v50, v51
    buffer_store_dwordx4 v[204:207], v2, s[52:55], s56 offen offset:0 sc1
    v_accvgpr_read_b32 v52, a8
    v_accvgpr_read_b32 v53, a9
    v_accvgpr_read_b32 v54, a10
    v_accvgpr_read_b32 v55, a11
    v_accvgpr_read_b32 v56, a12
    v_accvgpr_read_b32 v57, a13
    v_accvgpr_read_b32 v58, a14
    v_accvgpr_read_b32 v59, a15
    v_pk_mul_f32 v[52:53], v[52:53], v[8:9]
    v_pk_mul_f32 v[54:55], v[54:55], v[8:9]
    v_pk_mul_f32 v[56:57], v[56:57], v[8:9]
    v_pk_mul_f32 v[58:59], v[58:59], v[8:9]
    v_cvt_pk_bf16_f32 v220, v52, v53
    v_cvt_pk_bf16_f32 v221, v54, v55
    v_cvt_pk_bf16_f32 v222, v56, v57
    v_cvt_pk_bf16_f32 v223, v58, v59
    buffer_store_dwordx4 v[220:223], v2, s[52:55], s56 offen offset:1024 sc1
    v_accvgpr_read_b32 v44, a16
    v_accvgpr_read_b32 v45, a17
    v_accvgpr_read_b32 v46, a18
    v_accvgpr_read_b32 v47, a19
    v_accvgpr_read_b32 v48, a20
    v_accvgpr_read_b32 v49, a21
    v_accvgpr_read_b32 v50, a22
    v_accvgpr_read_b32 v51, a23
    v_pk_mul_f32 v[44:45], v[44:45], v[8:9]
    v_pk_mul_f32 v[46:47], v[46:47], v[8:9]
    v_pk_mul_f32 v[48:49], v[48:49], v[8:9]
    v_pk_mul_f32 v[50:51], v[50:51], v[8:9]
    v_cvt_pk_bf16_f32 v236, v44, v45
    v_cvt_pk_bf16_f32 v237, v46, v47
    v_cvt_pk_bf16_f32 v238, v48, v49
    v_cvt_pk_bf16_f32 v239, v50, v51
    buffer_store_dwordx4 v[236:239], v2, s[52:55], s56 offen offset:2048 sc1
    v_accvgpr_read_b32 v52, a24
    v_accvgpr_read_b32 v53, a25
    v_accvgpr_read_b32 v54, a26
    v_accvgpr_read_b32 v55, a27
    v_accvgpr_read_b32 v56, a28
    v_accvgpr_read_b32 v57, a29
    v_accvgpr_read_b32 v58, a30
    v_accvgpr_read_b32 v59, a31
    v_pk_mul_f32 v[52:53], v[52:53], v[8:9]
    v_pk_mul_f32 v[54:55], v[54:55], v[8:9]
    v_pk_mul_f32 v[56:57], v[56:57], v[8:9]
    v_pk_mul_f32 v[58:59], v[58:59], v[8:9]
    v_cvt_pk_bf16_f32 v252, v52, v53
    v_cvt_pk_bf16_f32 v253, v54, v55
    v_cvt_pk_bf16_f32 v254, v56, v57
    v_cvt_pk_bf16_f32 v255, v58, v59
    buffer_store_dwordx4 v[252:255], v2, s[52:55], s56 offen offset:3072 sc1
    v_accvgpr_read_b32 v44, a32
    v_accvgpr_read_b32 v45, a33
    v_accvgpr_read_b32 v46, a34
    v_accvgpr_read_b32 v47, a35
    v_accvgpr_read_b32 v48, a36
    v_accvgpr_read_b32 v49, a37
    v_accvgpr_read_b32 v50, a38
    v_accvgpr_read_b32 v51, a39
    v_pk_mul_f32 v[44:45], v[44:45], v[12:13]
    v_pk_mul_f32 v[46:47], v[46:47], v[12:13]
    v_pk_mul_f32 v[48:49], v[48:49], v[12:13]
    v_pk_mul_f32 v[50:51], v[50:51], v[12:13]
    v_cvt_pk_bf16_f32 v200, v44, v45
    v_cvt_pk_bf16_f32 v201, v46, v47
    v_cvt_pk_bf16_f32 v202, v48, v49
    v_cvt_pk_bf16_f32 v203, v50, v51
    buffer_store_dwordx4 v[200:203], v2, s[52:55], s57 offen offset:0 sc1
    v_accvgpr_read_b32 v52, a40
    v_accvgpr_read_b32 v53, a41
    v_accvgpr_read_b32 v54, a42
    v_accvgpr_read_b32 v55, a43
    v_accvgpr_read_b32 v56, a44
    v_accvgpr_read_b32 v57, a45
    v_accvgpr_read_b32 v58, a46
    v_accvgpr_read_b32 v59, a47
    v_pk_mul_f32 v[52:53], v[52:53], v[12:13]
    v_pk_mul_f32 v[54:55], v[54:55], v[12:13]
    v_pk_mul_f32 v[56:57], v[56:57], v[12:13]
    v_pk_mul_f32 v[58:59], v[58:59], v[12:13]
    v_cvt_pk_bf16_f32 v216, v52, v53
    v_cvt_pk_bf16_f32 v217, v54, v55
    v_cvt_pk_bf16_f32 v218, v56, v57
    v_cvt_pk_bf16_f32 v219, v58, v59
    buffer_store_dwordx4 v[216:219], v2, s[52:55], s57 offen offset:1024 sc1
    v_accvgpr_read_b32 v44, a48
    v_accvgpr_read_b32 v45, a49
    v_accvgpr_read_b32 v46, a50
    v_accvgpr_read_b32 v47, a51
    v_accvgpr_read_b32 v48, a52
    v_accvgpr_read_b32 v49, a53
    v_accvgpr_read_b32 v50, a54
    v_accvgpr_read_b32 v51, a55
    v_pk_mul_f32 v[44:45], v[44:45], v[12:13]
    v_pk_mul_f32 v[46:47], v[46:47], v[12:13]
    v_pk_mul_f32 v[48:49], v[48:49], v[12:13]
    v_pk_mul_f32 v[50:51], v[50:51], v[12:13]
    v_cvt_pk_bf16_f32 v232, v44, v45
    v_cvt_pk_bf16_f32 v233, v46, v47
    v_cvt_pk_bf16_f32 v234, v48, v49
    v_cvt_pk_bf16_f32 v235, v50, v51
    buffer_store_dwordx4 v[232:235], v2, s[52:55], s57 offen offset:2048 sc1
    v_accvgpr_read_b32 v52, a56
    v_accvgpr_read_b32 v53, a57
    v_accvgpr_read_b32 v54, a58
    v_accvgpr_read_b32 v55, a59
    v_accvgpr_read_b32 v56, a60
    v_accvgpr_read_b32 v57, a61
    v_accvgpr_read_b32 v58, a62
    v_accvgpr_read_b32 v59, a63
    v_pk_mul_f32 v[52:53], v[52:53], v[12:13]
    v_pk_mul_f32 v[54:55], v[54:55], v[12:13]
    v_pk_mul_f32 v[56:57], v[56:57], v[12:13]
    v_pk_mul_f32 v[58:59], v[58:59], v[12:13]
    v_cvt_pk_bf16_f32 v248, v52, v53
    v_cvt_pk_bf16_f32 v249, v54, v55
    v_cvt_pk_bf16_f32 v250, v56, v57
    v_cvt_pk_bf16_f32 v251, v58, v59
    buffer_store_dwordx4 v[248:251], v2, s[52:55], s57 offen offset:3072 sc1
    v_accvgpr_read_b32 v44, a64
    v_accvgpr_read_b32 v45, a65
    v_accvgpr_read_b32 v46, a66
    v_accvgpr_read_b32 v47, a67
    v_accvgpr_read_b32 v48, a68
    v_accvgpr_read_b32 v49, a69
    v_accvgpr_read_b32 v50, a70
    v_accvgpr_read_b32 v51, a71
    v_pk_mul_f32 v[44:45], v[44:45], v[16:17]
    v_pk_mul_f32 v[46:47], v[46:47], v[16:17]
    v_pk_mul_f32 v[48:49], v[48:49], v[16:17]
    v_pk_mul_f32 v[50:51], v[50:51], v[16:17]
    v_cvt_pk_bf16_f32 v196, v44, v45
    v_cvt_pk_bf16_f32 v197, v46, v47
    v_cvt_pk_bf16_f32 v198, v48, v49
    v_cvt_pk_bf16_f32 v199, v50, v51
    buffer_store_dwordx4 v[196:199], v2, s[52:55], s58 offen offset:0 sc1
    v_accvgpr_read_b32 v52, a72
    v_accvgpr_read_b32 v53, a73
    v_accvgpr_read_b32 v54, a74
    v_accvgpr_read_b32 v55, a75
    v_accvgpr_read_b32 v56, a76
    v_accvgpr_read_b32 v57, a77
    v_accvgpr_read_b32 v58, a78
    v_accvgpr_read_b32 v59, a79
    v_pk_mul_f32 v[52:53], v[52:53], v[16:17]
    v_pk_mul_f32 v[54:55], v[54:55], v[16:17]
    v_pk_mul_f32 v[56:57], v[56:57], v[16:17]
    v_pk_mul_f32 v[58:59], v[58:59], v[16:17]
    v_cvt_pk_bf16_f32 v212, v52, v53
    v_cvt_pk_bf16_f32 v213, v54, v55
    v_cvt_pk_bf16_f32 v214, v56, v57
    v_cvt_pk_bf16_f32 v215, v58, v59
    buffer_store_dwordx4 v[212:215], v2, s[52:55], s58 offen offset:1024 sc1
    v_accvgpr_read_b32 v44, a80
    v_accvgpr_read_b32 v45, a81
    v_accvgpr_read_b32 v46, a82
    v_accvgpr_read_b32 v47, a83
    v_accvgpr_read_b32 v48, a84
    v_accvgpr_read_b32 v49, a85
    v_accvgpr_read_b32 v50, a86
    v_accvgpr_read_b32 v51, a87
    v_pk_mul_f32 v[44:45], v[44:45], v[16:17]
    v_pk_mul_f32 v[46:47], v[46:47], v[16:17]
    v_pk_mul_f32 v[48:49], v[48:49], v[16:17]
    v_pk_mul_f32 v[50:51], v[50:51], v[16:17]
    v_cvt_pk_bf16_f32 v228, v44, v45
    v_cvt_pk_bf16_f32 v229, v46, v47
    v_cvt_pk_bf16_f32 v230, v48, v49
    v_cvt_pk_bf16_f32 v231, v50, v51
    buffer_store_dwordx4 v[228:231], v2, s[52:55], s58 offen offset:2048 sc1
    v_accvgpr_read_b32 v52, a88
    v_accvgpr_read_b32 v53, a89
    v_accvgpr_read_b32 v54, a90
    v_accvgpr_read_b32 v55, a91
    v_accvgpr_read_b32 v56, a92
    v_accvgpr_read_b32 v57, a93
    v_accvgpr_read_b32 v58, a94
    v_accvgpr_read_b32 v59, a95
    v_pk_mul_f32 v[52:53], v[52:53], v[16:17]
    v_pk_mul_f32 v[54:55], v[54:55], v[16:17]
    v_pk_mul_f32 v[56:57], v[56:57], v[16:17]
    v_pk_mul_f32 v[58:59], v[58:59], v[16:17]
    v_cvt_pk_bf16_f32 v244, v52, v53
    v_cvt_pk_bf16_f32 v245, v54, v55
    v_cvt_pk_bf16_f32 v246, v56, v57
    v_cvt_pk_bf16_f32 v247, v58, v59
    buffer_store_dwordx4 v[244:247], v2, s[52:55], s58 offen offset:3072 sc1
    v_accvgpr_read_b32 v44, a96
    v_accvgpr_read_b32 v45, a97
    v_accvgpr_read_b32 v46, a98
    v_accvgpr_read_b32 v47, a99
    v_accvgpr_read_b32 v48, a100
    v_accvgpr_read_b32 v49, a101
    v_accvgpr_read_b32 v50, a102
    v_accvgpr_read_b32 v51, a103
    v_pk_mul_f32 v[44:45], v[44:45], v[20:21]
    v_pk_mul_f32 v[46:47], v[46:47], v[20:21]
    v_pk_mul_f32 v[48:49], v[48:49], v[20:21]
    v_pk_mul_f32 v[50:51], v[50:51], v[20:21]
    v_cvt_pk_bf16_f32 v192, v44, v45
    v_cvt_pk_bf16_f32 v193, v46, v47
    v_cvt_pk_bf16_f32 v194, v48, v49
    v_cvt_pk_bf16_f32 v195, v50, v51
    buffer_store_dwordx4 v[192:195], v2, s[52:55], s59 offen offset:0 sc1
    v_accvgpr_read_b32 v52, a104
    v_accvgpr_read_b32 v53, a105
    v_accvgpr_read_b32 v54, a106
    v_accvgpr_read_b32 v55, a107
    v_accvgpr_read_b32 v56, a108
    v_accvgpr_read_b32 v57, a109
    v_accvgpr_read_b32 v58, a110
    v_accvgpr_read_b32 v59, a111
    v_pk_mul_f32 v[52:53], v[52:53], v[20:21]
    v_pk_mul_f32 v[54:55], v[54:55], v[20:21]
    v_pk_mul_f32 v[56:57], v[56:57], v[20:21]
    v_pk_mul_f32 v[58:59], v[58:59], v[20:21]
    v_cvt_pk_bf16_f32 v208, v52, v53
    v_cvt_pk_bf16_f32 v209, v54, v55
    v_cvt_pk_bf16_f32 v210, v56, v57
    v_cvt_pk_bf16_f32 v211, v58, v59
    buffer_store_dwordx4 v[208:211], v2, s[52:55], s59 offen offset:1024 sc1
    v_accvgpr_read_b32 v44, a112
    v_accvgpr_read_b32 v45, a113
    v_accvgpr_read_b32 v46, a114
    v_accvgpr_read_b32 v47, a115
    v_accvgpr_read_b32 v48, a116
    v_accvgpr_read_b32 v49, a117
    v_accvgpr_read_b32 v50, a118
    v_accvgpr_read_b32 v51, a119
    v_pk_mul_f32 v[44:45], v[44:45], v[20:21]
    v_pk_mul_f32 v[46:47], v[46:47], v[20:21]
    v_pk_mul_f32 v[48:49], v[48:49], v[20:21]
    v_pk_mul_f32 v[50:51], v[50:51], v[20:21]
    v_cvt_pk_bf16_f32 v224, v44, v45
    v_cvt_pk_bf16_f32 v225, v46, v47
    v_cvt_pk_bf16_f32 v226, v48, v49
    v_cvt_pk_bf16_f32 v227, v50, v51
    buffer_store_dwordx4 v[224:227], v2, s[52:55], s59 offen offset:2048 sc1
    v_accvgpr_read_b32 v52, a120
    v_accvgpr_read_b32 v53, a121
    v_accvgpr_read_b32 v54, a122
    v_accvgpr_read_b32 v55, a123
    v_accvgpr_read_b32 v56, a124
    v_accvgpr_read_b32 v57, a125
    v_accvgpr_read_b32 v58, a126
    v_accvgpr_read_b32 v59, a127
    v_pk_mul_f32 v[52:53], v[52:53], v[20:21]
    v_pk_mul_f32 v[54:55], v[54:55], v[20:21]
    v_pk_mul_f32 v[56:57], v[56:57], v[20:21]
    v_pk_mul_f32 v[58:59], v[58:59], v[20:21]
    v_cvt_pk_bf16_f32 v240, v52, v53
    v_cvt_pk_bf16_f32 v241, v54, v55
    v_cvt_pk_bf16_f32 v242, v56, v57
    v_cvt_pk_bf16_f32 v243, v58, v59
    buffer_store_dwordx4 v[240:243], v2, s[52:55], s59 offen offset:3072 sc1
    s_branch CE_end
QG_light:
    s_waitcnt vmcnt(19) lgkmcnt(10)
    v_mfma_f32_16x16x32_bf16 a[0:3], a[224:227], a[160:163], 0
    s_waitcnt lgkmcnt(8)
    ds_read_b64_tr_b16 a[248:249], v58 offset:0
    ds_read_b64_tr_b16 a[250:251], v58 offset:1024
    v_mfma_f32_16x16x32_bf16 a[16:19], a[228:231], a[160:163], 0
    s_waitcnt vmcnt(18)
    ds_read_b64_tr_b16 a[252:253], v59 offset:0
    ds_read_b64_tr_b16 a[254:255], v59 offset:1024
    v_mfma_f32_16x16x32_bf16 a[20:23], a[228:231], a[164:167], 0
    s_add_u32 m0, s93, 98304
    v_cvt_pk_bf16_f32 v80, v80, v81
    v_cvt_pk_bf16_f32 v81, v82, v83
    v_mfma_f32_16x16x32_bf16 a[4:7], a[224:227], a[164:167], 0
    s_mov_b32 s94, 1048576
    buffer_load_dwordx4 a[208:211], v32, s[72:75], s84 offen offset:3072 sc1
    s_waitcnt vmcnt(18)
    v_mfma_f32_16x16x32_bf16 a[8:11], a[224:227], a[168:171], 0
    buffer_load_dwordx4 v34, s[60:63], s94 offen offset:0 lds
    v_mfma_f32_16x16x32_bf16 a[24:27], a[228:231], a[168:171], 0
    s_waitcnt vmcnt(18)
    buffer_load_dwordx4 a[212:215], v32, s[72:75], s85 offen offset:3072 sc1
    v_mfma_f32_16x16x32_bf16 a[28:31], a[228:231], a[172:175], 0
    v_cvt_pk_bf16_f32 v82, v176, v177
    v_cvt_pk_bf16_f32 v83, v178, v179
    v_mfma_f32_16x16x32_bf16 a[12:15], a[224:227], a[172:175], 0
    s_waitcnt lgkmcnt(2)
    buffer_load_dwordx4 a[216:219], v32, s[72:75], s86 offen offset:3072 sc1
    v_mfma_f32_16x16x32_bf16 a[44:47], a[232:235], a[172:175], 0
    ds_read_b64_tr_b16 a[224:225], v52 offset:8192
    ds_read_b64_tr_b16 a[226:227], v52 offset:9216
    v_mfma_f32_16x16x32_bf16 a[60:63], a[236:239], a[172:175], 0
    ds_read_b64_tr_b16 a[228:229], v53 offset:8192
    ds_read_b64_tr_b16 a[230:231], v53 offset:9216
    v_mfma_f32_16x16x32_bf16 a[56:59], a[236:239], a[168:171], 0
    buffer_load_dwordx4 a[220:223], v32, s[72:75], s87 offen offset:3072 sc1
    v_mfma_f32_16x16x32_bf16 a[40:43], a[232:235], a[168:171], 0
    buffer_load_dwordx4 v35, s[60:63], s94 offen offset:1024 lds
    v_mfma_f32_16x16x32_bf16 a[36:39], a[232:235], a[164:167], 0
    v_cvt_pk_bf16_f32 v64, v64, v65
    v_cvt_pk_bf16_f32 v65, v66, v67
    v_mfma_f32_16x16x32_bf16 a[52:55], a[236:239], a[164:167], 0
    v_cvt_pk_bf16_f32 v66, v160, v161
    v_cvt_pk_bf16_f32 v67, v162, v163
    v_mfma_f32_16x16x32_bf16 a[48:51], a[236:239], a[160:163], 0
    v_cvt_pk_bf16_f32 v124, v124, v125
    v_cvt_pk_bf16_f32 v125, v126, v127
    v_mfma_f32_16x16x32_bf16 a[32:35], a[232:235], a[160:163], 0
    v_cvt_pk_bf16_f32 v126, v220, v221
    v_cvt_pk_bf16_f32 v127, v222, v223
    v_mfma_f32_16x16x32_bf16 a[64:67], a[240:243], a[160:163], 0
    ds_read_b64_tr_b16 a[232:233], v54 offset:8192
    ds_read_b64_tr_b16 a[234:235], v54 offset:9216
    v_mfma_f32_16x16x32_bf16 a[80:83], a[244:247], a[160:163], 0
    ds_read_b64_tr_b16 a[236:237], v55 offset:8192
    ds_read_b64_tr_b16 a[238:239], v55 offset:9216
    v_mfma_f32_16x16x32_bf16 a[84:87], a[244:247], a[164:167], 0
    buffer_load_dwordx4 v36, s[60:63], s94 offen offset:2048 lds
    v_mfma_f32_16x16x32_bf16 a[68:71], a[240:243], a[164:167], 0
    v_cvt_pk_bf16_f32 v120, v120, v121
    v_cvt_pk_bf16_f32 v121, v122, v123
    v_mfma_f32_16x16x32_bf16 a[72:75], a[240:243], a[168:171], 0
    v_cvt_pk_bf16_f32 v122, v216, v217
    v_cvt_pk_bf16_f32 v123, v218, v219
    v_mfma_f32_16x16x32_bf16 a[88:91], a[244:247], a[168:171], 0
    v_cvt_pk_bf16_f32 v116, v116, v117
    v_cvt_pk_bf16_f32 v117, v118, v119
    v_mfma_f32_16x16x32_bf16 a[92:95], a[244:247], a[172:175], 0
    v_cvt_pk_bf16_f32 v118, v212, v213
    v_cvt_pk_bf16_f32 v119, v214, v215
    v_mfma_f32_16x16x32_bf16 a[76:79], a[240:243], a[172:175], 0
    buffer_load_dwordx4 v37, s[60:63], s94 offen offset:3072 lds
    v_mfma_f32_16x16x32_bf16 a[108:111], a[248:251], a[172:175], 0
    s_waitcnt lgkmcnt(0)
    ds_read_b64_tr_b16 a[240:241], v56 offset:8192
    ds_read_b64_tr_b16 a[242:243], v56 offset:9216
    v_mfma_f32_16x16x32_bf16 a[124:127], a[252:255], a[172:175], 0
    ds_read_b64_tr_b16 a[244:245], v57 offset:8192
    ds_read_b64_tr_b16 a[246:247], v57 offset:9216
    v_mfma_f32_16x16x32_bf16 a[120:123], a[252:255], a[168:171], 0
    v_cvt_pk_bf16_f32 v112, v112, v113
    v_cvt_pk_bf16_f32 v113, v114, v115
    v_mfma_f32_16x16x32_bf16 a[104:107], a[248:251], a[168:171], 0
    v_cvt_pk_bf16_f32 v114, v208, v209
    v_cvt_pk_bf16_f32 v115, v210, v211
    v_mfma_f32_16x16x32_bf16 a[100:103], a[248:251], a[164:167], 0
    v_cvt_pk_bf16_f32 v108, v108, v109
    v_cvt_pk_bf16_f32 v109, v110, v111
    v_mfma_f32_16x16x32_bf16 a[116:119], a[252:255], a[164:167], 0
    v_cvt_pk_bf16_f32 v110, v204, v205
    v_cvt_pk_bf16_f32 v111, v206, v207
    v_mfma_f32_16x16x32_bf16 a[112:115], a[252:255], a[160:163], 0
    v_cvt_pk_bf16_f32 v104, v104, v105
    v_cvt_pk_bf16_f32 v105, v106, v107
    v_mfma_f32_16x16x32_bf16 a[96:99], a[248:251], a[160:163], 0
    s_waitcnt vmcnt(23)
    v_cvt_pk_bf16_f32 v106, v200, v201
    v_cvt_pk_bf16_f32 v107, v202, v203
    v_mfma_f32_16x16x32_bf16 a[0:3], a[224:227], a[176:179], a[0:3]
    ds_read_b64_tr_b16 a[248:249], v58 offset:8192
    ds_read_b64_tr_b16 a[250:251], v58 offset:9216
    v_mfma_f32_16x16x32_bf16 a[16:19], a[228:231], a[176:179], a[16:19]
    s_waitcnt vmcnt(22)
    ds_read_b64_tr_b16 a[252:253], v59 offset:8192
    ds_read_b64_tr_b16 a[254:255], v59 offset:9216
    v_mfma_f32_16x16x32_bf16 a[20:23], a[228:231], a[180:183], a[20:23]
    v_add_u32 v32, 4096, v32
    v_mfma_f32_16x16x32_bf16 a[4:7], a[224:227], a[180:183], a[4:7]
    s_waitcnt vmcnt(21)
    buffer_load_dwordx4 a[160:163], v32, s[72:75], s84 offen offset:0 sc1
    v_mfma_f32_16x16x32_bf16 a[8:11], a[224:227], a[184:187], a[8:11]
    v_cvt_pk_bf16_f32 v100, v100, v101
    v_cvt_pk_bf16_f32 v101, v102, v103
    v_mfma_f32_16x16x32_bf16 a[24:27], a[228:231], a[184:187], a[24:27]
    s_waitcnt vmcnt(21)
    v_cvt_pk_bf16_f32 v102, v196, v197
    v_cvt_pk_bf16_f32 v103, v198, v199
    v_mfma_f32_16x16x32_bf16 a[28:31], a[228:231], a[188:191], a[28:31]
    v_cvt_pk_bf16_f32 v96, v96, v97
    v_cvt_pk_bf16_f32 v97, v98, v99
    v_mfma_f32_16x16x32_bf16 a[12:15], a[224:227], a[188:191], a[12:15]
    s_waitcnt vmcnt(29) lgkmcnt(0)
    buffer_load_dwordx4 a[164:167], v32, s[72:75], s85 offen offset:0 sc1
    v_mfma_f32_16x16x32_bf16 a[44:47], a[232:235], a[188:191], a[44:47]
    s_barrier
    ds_read_b64_tr_b16 a[224:225], v40 offset:0
    ds_read_b64_tr_b16 a[226:227], v40 offset:1024
    v_mfma_f32_16x16x32_bf16 a[60:63], a[236:239], a[188:191], a[60:63]
    s_add_u32 m0, s93, 131072
    ds_read_b64_tr_b16 a[228:229], v41 offset:0
    ds_read_b64_tr_b16 a[230:231], v41 offset:1024
    v_mfma_f32_16x16x32_bf16 a[56:59], a[236:239], a[184:187], a[56:59]
    s_mov_b32 s94, 1572864
    v_cvt_pk_bf16_f32 v98, v192, v193
    v_cvt_pk_bf16_f32 v99, v194, v195
    v_mfma_f32_16x16x32_bf16 a[40:43], a[232:235], a[184:187], a[40:43]
    buffer_load_dwordx4 a[168:171], v32, s[72:75], s86 offen offset:0 sc1
    v_mfma_f32_16x16x32_bf16 a[36:39], a[232:235], a[180:183], a[36:39]
    buffer_load_dwordx4 v34, s[60:63], s94 offen offset:0 lds
    v_mfma_f32_16x16x32_bf16 a[52:55], a[236:239], a[180:183], a[52:55]
    v_cvt_pk_bf16_f32 v156, v156, v157
    v_cvt_pk_bf16_f32 v157, v158, v159
    v_mfma_f32_16x16x32_bf16 a[48:51], a[236:239], a[176:179], a[48:51]
    v_cvt_pk_bf16_f32 v158, v252, v253
    v_cvt_pk_bf16_f32 v159, v254, v255
    v_mfma_f32_16x16x32_bf16 a[32:35], a[232:235], a[176:179], a[32:35]
    buffer_load_dwordx4 a[172:175], v32, s[72:75], s87 offen offset:0 sc1
    v_mfma_f32_16x16x32_bf16 a[64:67], a[240:243], a[176:179], a[64:67]
    ds_read_b64_tr_b16 a[232:233], v42 offset:0
    ds_read_b64_tr_b16 a[234:235], v42 offset:1024
    v_mfma_f32_16x16x32_bf16 a[80:83], a[244:247], a[176:179], a[80:83]
    ds_read_b64_tr_b16 a[236:237], v43 offset:0
    ds_read_b64_tr_b16 a[238:239], v43 offset:1024
    v_mfma_f32_16x16x32_bf16 a[84:87], a[244:247], a[180:183], a[84:87]
    buffer_load_dwordx4 v35, s[60:63], s94 offen offset:1024 lds
    v_mfma_f32_16x16x32_bf16 a[68:71], a[240:243], a[180:183], a[68:71]
    v_cvt_pk_bf16_f32 v152, v152, v153
    v_cvt_pk_bf16_f32 v153, v154, v155
    v_mfma_f32_16x16x32_bf16 a[72:75], a[240:243], a[184:187], a[72:75]
    v_cvt_pk_bf16_f32 v154, v248, v249
    v_cvt_pk_bf16_f32 v155, v250, v251
    v_mfma_f32_16x16x32_bf16 a[88:91], a[244:247], a[184:187], a[88:91]
    v_cvt_pk_bf16_f32 v148, v148, v149
    v_cvt_pk_bf16_f32 v149, v150, v151
    v_mfma_f32_16x16x32_bf16 a[92:95], a[244:247], a[188:191], a[92:95]
    buffer_load_dwordx4 v36, s[60:63], s94 offen offset:2048 lds
    v_mfma_f32_16x16x32_bf16 a[76:79], a[240:243], a[188:191], a[76:79]
    v_cvt_pk_bf16_f32 v150, v244, v245
    v_cvt_pk_bf16_f32 v151, v246, v247
    v_mfma_f32_16x16x32_bf16 a[108:111], a[248:251], a[188:191], a[108:111]
    ds_read_b64_tr_b16 a[240:241], v44 offset:0
    ds_read_b64_tr_b16 a[242:243], v44 offset:1024
    v_mfma_f32_16x16x32_bf16 a[124:127], a[252:255], a[188:191], a[124:127]
    ds_read_b64_tr_b16 a[244:245], v45 offset:0
    ds_read_b64_tr_b16 a[246:247], v45 offset:1024
    v_mfma_f32_16x16x32_bf16 a[120:123], a[252:255], a[184:187], a[120:123]
    buffer_load_dwordx4 v37, s[60:63], s94 offen offset:3072 lds
    v_mfma_f32_16x16x32_bf16 a[104:107], a[248:251], a[184:187], a[104:107]
    v_cvt_pk_bf16_f32 v144, v144, v145
    v_cvt_pk_bf16_f32 v145, v146, v147
    v_mfma_f32_16x16x32_bf16 a[100:103], a[248:251], a[180:183], a[100:103]
    v_cvt_pk_bf16_f32 v146, v240, v241
    v_cvt_pk_bf16_f32 v147, v242, v243
    v_mfma_f32_16x16x32_bf16 a[116:119], a[252:255], a[180:183], a[116:119]
    v_cvt_pk_bf16_f32 v140, v140, v141
    v_cvt_pk_bf16_f32 v141, v142, v143
    v_mfma_f32_16x16x32_bf16 a[112:115], a[252:255], a[176:179], a[112:115]
    v_cvt_pk_bf16_f32 v142, v236, v237
    v_cvt_pk_bf16_f32 v143, v238, v239
    v_mfma_f32_16x16x32_bf16 a[96:99], a[248:251], a[176:179], a[96:99]
    s_waitcnt lgkmcnt(2) vmcnt(27)
    v_cvt_pk_bf16_f32 v136, v136, v137
    v_cvt_pk_bf16_f32 v137, v138, v139
    v_mfma_f32_16x16x32_bf16 a[0:3], a[224:227], a[192:195], a[0:3]
    ds_read_b64_tr_b16 a[248:249], v46 offset:0
    ds_read_b64_tr_b16 a[250:251], v46 offset:1024
    v_mfma_f32_16x16x32_bf16 a[16:19], a[228:231], a[192:195], a[16:19]
    s_waitcnt vmcnt(26)
    ds_read_b64_tr_b16 a[252:253], v47 offset:0
    ds_read_b64_tr_b16 a[254:255], v47 offset:1024
    v_mfma_f32_16x16x32_bf16 a[20:23], a[228:231], a[196:199], a[20:23]
    v_cvt_pk_bf16_f32 v138, v232, v233
    v_cvt_pk_bf16_f32 v139, v234, v235
    v_mfma_f32_16x16x32_bf16 a[4:7], a[224:227], a[196:199], a[4:7]
    s_waitcnt vmcnt(24)
    buffer_load_dwordx4 a[176:179], v32, s[72:75], s84 offen offset:1024 sc1
    v_mfma_f32_16x16x32_bf16 a[8:11], a[224:227], a[200:203], a[8:11]
    v_cvt_pk_bf16_f32 v132, v132, v133
    v_cvt_pk_bf16_f32 v133, v134, v135
    v_mfma_f32_16x16x32_bf16 a[24:27], a[228:231], a[200:203], a[24:27]
    s_waitcnt vmcnt(24)
    v_cvt_pk_bf16_f32 v134, v228, v229
    v_cvt_pk_bf16_f32 v135, v230, v231
    v_mfma_f32_16x16x32_bf16 a[28:31], a[228:231], a[204:207], a[28:31]
    v_cvt_pk_bf16_f32 v128, v128, v129
    v_cvt_pk_bf16_f32 v129, v130, v131
    v_mfma_f32_16x16x32_bf16 a[12:15], a[224:227], a[204:207], a[12:15]
    buffer_load_dwordx4 a[180:183], v32, s[72:75], s85 offen offset:1024 sc1
    v_mfma_f32_16x16x32_bf16 a[44:47], a[232:235], a[204:207], a[44:47]
    ds_read_b64_tr_b16 a[224:225], v40 offset:8192
    ds_read_b64_tr_b16 a[226:227], v40 offset:9216
    v_mfma_f32_16x16x32_bf16 a[60:63], a[236:239], a[204:207], a[60:63]
    ds_read_b64_tr_b16 a[228:229], v41 offset:8192
    ds_read_b64_tr_b16 a[230:231], v41 offset:9216
    v_mfma_f32_16x16x32_bf16 a[56:59], a[236:239], a[200:203], a[56:59]
    v_cvt_pk_bf16_f32 v130, v224, v225
    v_cvt_pk_bf16_f32 v131, v226, v227
    v_mfma_f32_16x16x32_bf16 a[40:43], a[232:235], a[200:203], a[40:43]
    buffer_load_dwordx4 a[184:187], v32, s[72:75], s86 offen offset:1024 sc1
    v_mfma_f32_16x16x32_bf16 a[36:39], a[232:235], a[196:199], a[36:39]
    v_mfma_f32_16x16x32_bf16 a[52:55], a[236:239], a[196:199], a[52:55]
    v_mfma_f32_16x16x32_bf16 a[48:51], a[236:239], a[192:195], a[48:51]
    v_mfma_f32_16x16x32_bf16 a[32:35], a[232:235], a[192:195], a[32:35]
    buffer_load_dwordx4 a[188:191], v32, s[72:75], s87 offen offset:1024 sc1
    v_mfma_f32_16x16x32_bf16 a[64:67], a[240:243], a[192:195], a[64:67]
    s_waitcnt lgkmcnt(0)
    ds_read_b64_tr_b16 a[232:233], v42 offset:8192
    ds_read_b64_tr_b16 a[234:235], v42 offset:9216
    v_mfma_f32_16x16x32_bf16 a[80:83], a[244:247], a[192:195], a[80:83]
    ds_read_b64_tr_b16 a[236:237], v43 offset:8192
    ds_read_b64_tr_b16 a[238:239], v43 offset:9216
    v_mfma_f32_16x16x32_bf16 a[84:87], a[244:247], a[196:199], a[84:87]
    v_mfma_f32_16x16x32_bf16 a[68:71], a[240:243], a[196:199], a[68:71]
    v_mfma_f32_16x16x32_bf16 a[72:75], a[240:243], a[200:203], a[72:75]
    v_mfma_f32_16x16x32_bf16 a[88:91], a[244:247], a[200:203], a[88:91]
    v_mfma_f32_16x16x32_bf16 a[92:95], a[244:247], a[204:207], a[92:95]
    v_mfma_f32_16x16x32_bf16 a[76:79], a[240:243], a[204:207], a[76:79]
    v_mfma_f32_16x16x32_bf16 a[108:111], a[248:251], a[204:207], a[108:111]
    ds_read_b64_tr_b16 a[240:241], v44 offset:8192
    ds_read_b64_tr_b16 a[242:243], v44 offset:9216
    v_mfma_f32_16x16x32_bf16 a[124:127], a[252:255], a[204:207], a[124:127]
    ds_read_b64_tr_b16 a[244:245], v45 offset:8192
    ds_read_b64_tr_b16 a[246:247], v45 offset:9216
    v_mfma_f32_16x16x32_bf16 a[120:123], a[252:255], a[200:203], a[120:123]
    v_mfma_f32_16x16x32_bf16 a[104:107], a[248:251], a[200:203], a[104:107]
    v_mfma_f32_16x16x32_bf16 a[100:103], a[248:251], a[196:199], a[100:103]
    v_mfma_f32_16x16x32_bf16 a[116:119], a[252:255], a[196:199], a[116:119]
    v_mfma_f32_16x16x32_bf16 a[112:115], a[252:255], a[192:195], a[112:115]
    v_mfma_f32_16x16x32_bf16 a[96:99], a[248:251], a[192:195], a[96:99]
    s_waitcnt vmcnt(19)
    v_mfma_f32_16x16x32_bf16 a[0:3], a[224:227], a[208:211], a[0:3]
    ds_read_b64_tr_b16 a[248:249], v46 offset:8192
    ds_read_b64_tr_b16 a[250:251], v46 offset:9216
    v_mfma_f32_16x16x32_bf16 a[16:19], a[228:231], a[208:211], a[16:19]
    s_waitcnt vmcnt(17)
    ds_read_b64_tr_b16 a[252:253], v47 offset:8192
    ds_read_b64_tr_b16 a[254:255], v47 offset:9216
    v_mfma_f32_16x16x32_bf16 a[20:23], a[228:231], a[212:215], a[20:23]
    v_mfma_f32_16x16x32_bf16 a[4:7], a[224:227], a[212:215], a[4:7]
    s_waitcnt vmcnt(16)
    buffer_load_dwordx4 a[192:195], v32, s[72:75], s84 offen offset:2048 sc1
    v_mfma_f32_16x16x32_bf16 a[8:11], a[224:227], a[216:219], a[8:11]
    v_mfma_f32_16x16x32_bf16 a[24:27], a[228:231], a[216:219], a[24:27]
    s_waitcnt vmcnt(16)
    v_mfma_f32_16x16x32_bf16 a[28:31], a[228:231], a[220:223], a[28:31]
    v_mfma_f32_16x16x32_bf16 a[12:15], a[224:227], a[220:223], a[12:15]
    s_waitcnt vmcnt(13) lgkmcnt(0)
    buffer_load_dwordx4 a[196:199], v32, s[72:75], s85 offen offset:2048 sc1
    v_mfma_f32_16x16x32_bf16 a[44:47], a[232:235], a[220:223], a[44:47]
    s_barrier
    ds_read_b64_tr_b16 a[224:225], v40 offset:32768
    ds_read_b64_tr_b16 a[226:227], v40 offset:33792
    v_mfma_f32_16x16x32_bf16 a[60:63], a[236:239], a[220:223], a[60:63]
    s_add_u32 m0, s93, 65536
    ds_read_b64_tr_b16 a[228:229], v41 offset:32768
    ds_read_b64_tr_b16 a[230:231], v41 offset:33792
    v_mfma_f32_16x16x32_bf16 a[56:59], a[236:239], a[216:219], a[56:59]
    s_mov_b32 s94, 2097152
    v_mfma_f32_16x16x32_bf16 a[40:43], a[232:235], a[216:219], a[40:43]
    buffer_load_dwordx4 a[200:203], v32, s[72:75], s86 offen offset:2048 sc1
    v_mfma_f32_16x16x32_bf16 a[36:39], a[232:235], a[212:215], a[36:39]
    buffer_load_dwordx4 v34, s[60:63], s94 offen offset:0 lds
    v_mfma_f32_16x16x32_bf16 a[52:55], a[236:239], a[212:215], a[52:55]
    v_mfma_f32_16x16x32_bf16 a[48:51], a[236:239], a[208:211], a[48:51]
    v_mfma_f32_16x16x32_bf16 a[32:35], a[232:235], a[208:211], a[32:35]
    buffer_load_dwordx4 a[204:207], v32, s[72:75], s87 offen offset:2048 sc1
    v_mfma_f32_16x16x32_bf16 a[64:67], a[240:243], a[208:211], a[64:67]
    ds_read_b64_tr_b16 a[232:233], v42 offset:32768
    ds_read_b64_tr_b16 a[234:235], v42 offset:33792
    v_mfma_f32_16x16x32_bf16 a[80:83], a[244:247], a[208:211], a[80:83]
    ds_read_b64_tr_b16 a[236:237], v43 offset:32768
    ds_read_b64_tr_b16 a[238:239], v43 offset:33792
    v_mfma_f32_16x16x32_bf16 a[84:87], a[244:247], a[212:215], a[84:87]
    buffer_load_dwordx4 v35, s[60:63], s94 offen offset:1024 lds
    v_mfma_f32_16x16x32_bf16 a[68:71], a[240:243], a[212:215], a[68:71]
    v_mfma_f32_16x16x32_bf16 a[72:75], a[240:243], a[216:219], a[72:75]
    v_mfma_f32_16x16x32_bf16 a[88:91], a[244:247], a[216:219], a[88:91]
    v_mfma_f32_16x16x32_bf16 a[92:95], a[244:247], a[220:223], a[92:95]
    buffer_load_dwordx4 v36, s[60:63], s94 offen offset:2048 lds
    v_mfma_f32_16x16x32_bf16 a[76:79], a[240:243], a[220:223], a[76:79]
    v_mfma_f32_16x16x32_bf16 a[108:111], a[248:251], a[220:223], a[108:111]
    ds_read_b64_tr_b16 a[240:241], v44 offset:32768
    ds_read_b64_tr_b16 a[242:243], v44 offset:33792
    v_mfma_f32_16x16x32_bf16 a[124:127], a[252:255], a[220:223], a[124:127]
    ds_read_b64_tr_b16 a[244:245], v45 offset:32768
    ds_read_b64_tr_b16 a[246:247], v45 offset:33792
    v_mfma_f32_16x16x32_bf16 a[120:123], a[252:255], a[216:219], a[120:123]
    buffer_load_dwordx4 v37, s[60:63], s94 offen offset:3072 lds
    v_mfma_f32_16x16x32_bf16 a[104:107], a[248:251], a[216:219], a[104:107]
    v_mfma_f32_16x16x32_bf16 a[100:103], a[248:251], a[212:215], a[100:103]
    v_mfma_f32_16x16x32_bf16 a[116:119], a[252:255], a[212:215], a[116:119]
    v_mfma_f32_16x16x32_bf16 a[112:115], a[252:255], a[208:211], a[112:115]
    v_mfma_f32_16x16x32_bf16 a[96:99], a[248:251], a[208:211], a[96:99]
    s_waitcnt lgkmcnt(2) vmcnt(19)
    v_mfma_f32_16x16x32_bf16 a[0:3], a[224:227], a[160:163], a[0:3]
    ds_read_b64_tr_b16 a[248:249], v46 offset:32768
    ds_read_b64_tr_b16 a[250:251], v46 offset:33792
    v_mfma_f32_16x16x32_bf16 a[16:19], a[228:231], a[160:163], a[16:19]
    s_waitcnt vmcnt(18)
    ds_read_b64_tr_b16 a[252:253], v47 offset:32768
    ds_read_b64_tr_b16 a[254:255], v47 offset:33792
    v_mfma_f32_16x16x32_bf16 a[20:23], a[228:231], a[164:167], a[20:23]
    v_mfma_f32_16x16x32_bf16 a[4:7], a[224:227], a[164:167], a[4:7]
    s_waitcnt vmcnt(17)
    buffer_load_dwordx4 a[208:211], v32, s[72:75], s84 offen offset:3072 sc1
    v_mfma_f32_16x16x32_bf16 a[8:11], a[224:227], a[168:171], a[8:11]
    v_mfma_f32_16x16x32_bf16 a[24:27], a[228:231], a[168:171], a[24:27]
    s_waitcnt vmcnt(16)
    v_mfma_f32_16x16x32_bf16 a[28:31], a[228:231], a[172:175], a[28:31]
    v_mfma_f32_16x16x32_bf16 a[12:15], a[224:227], a[172:175], a[12:15]
    buffer_load_dwordx4 a[212:215], v32, s[72:75], s85 offen offset:3072 sc1
    v_mfma_f32_16x16x32_bf16 a[44:47], a[232:235], a[172:175], a[44:47]
    ds_read_b64_tr_b16 a[224:225], v40 offset:40960
    ds_read_b64_tr_b16 a[226:227], v40 offset:41984
    v_mfma_f32_16x16x32_bf16 a[60:63], a[236:239], a[172:175], a[60:63]
    ds_read_b64_tr_b16 a[228:229], v41 offset:40960
    ds_read_b64_tr_b16 a[230:231], v41 offset:41984
    v_mfma_f32_16x16x32_bf16 a[56:59], a[236:239], a[168:171], a[56:59]
    v_mfma_f32_16x16x32_bf16 a[40:43], a[232:235], a[168:171], a[40:43]
    buffer_load_dwordx4 a[216:219], v32, s[72:75], s86 offen offset:3072 sc1
    v_mfma_f32_16x16x32_bf16 a[36:39], a[232:235], a[164:167], a[36:39]
    v_mfma_f32_16x16x32_bf16 a[52:55], a[236:239], a[164:167], a[52:55]
    v_mfma_f32_16x16x32_bf16 a[48:51], a[236:239], a[160:163], a[48:51]
    v_mfma_f32_16x16x32_bf16 a[32:35], a[232:235], a[160:163], a[32:35]
    buffer_load_dwordx4 a[220:223], v32, s[72:75], s87 offen offset:3072 sc1
    v_mfma_f32_16x16x32_bf16 a[64:67], a[240:243], a[160:163], a[64:67]
    s_waitcnt lgkmcnt(0)
    ds_read_b64_tr_b16 a[232:233], v42 offset:40960
    ds_read_b64_tr_b16 a[234:235], v42 offset:41984
    v_mfma_f32_16x16x32_bf16 a[80:83], a[244:247], a[160:163], a[80:83]
    ds_read_b64_tr_b16 a[236:237], v43 offset:40960
    ds_read_b64_tr_b16 a[238:239], v43 offset:41984
    v_mfma_f32_16x16x32_bf16 a[84:87], a[244:247], a[164:167], a[84:87]
    v_mfma_f32_16x16x32_bf16 a[68:71], a[240:243], a[164:167], a[68:71]
    v_mfma_f32_16x16x32_bf16 a[72:75], a[240:243], a[168:171], a[72:75]
    v_mfma_f32_16x16x32_bf16 a[88:91], a[244:247], a[168:171], a[88:91]
    v_mfma_f32_16x16x32_bf16 a[92:95], a[244:247], a[172:175], a[92:95]
    s_mov_b32 s96, 0
    buffer_store_dwordx4 v[64:67], v31, s[44:47], s96 offen offset:2048 sc1
    v_mfma_f32_16x16x32_bf16 a[76:79], a[240:243], a[172:175], a[76:79]
    v_mfma_f32_16x16x32_bf16 a[108:111], a[248:251], a[172:175], a[108:111]
    ds_read_b64_tr_b16 a[240:241], v44 offset:40960
    ds_read_b64_tr_b16 a[242:243], v44 offset:41984
    v_mfma_f32_16x16x32_bf16 a[124:127], a[252:255], a[172:175], a[124:127]
    ds_read_b64_tr_b16 a[244:245], v45 offset:40960
    ds_read_b64_tr_b16 a[246:247], v45 offset:41984
    v_mfma_f32_16x16x32_bf16 a[120:123], a[252:255], a[168:171], a[120:123]
    v_mfma_f32_16x16x32_bf16 a[104:107], a[248:251], a[168:171], a[104:107]
    v_mfma_f32_16x16x32_bf16 a[100:103], a[248:251], a[164:167], a[100:103]
    v_mfma_f32_16x16x32_bf16 a[116:119], a[252:255], a[164:167], a[116:119]
    v_mfma_f32_16x16x32_bf16 a[112:115], a[252:255], a[160:163], a[112:115]
    v_mfma_f32_16x16x32_bf16 a[96:99], a[248:251], a[160:163], a[96:99]
    s_waitcnt vmcnt(16)
    v_mfma_f32_16x16x32_bf16 a[0:3], a[224:227], a[176:179], a[0:3]
    ds_read_b64_tr_b16 a[248:249], v46 offset:40960
    ds_read_b64_tr_b16 a[250:251], v46 offset:41984
    v_mfma_f32_16x16x32_bf16 a[16:19], a[228:231], a[176:179], a[16:19]
    s_waitcnt vmcnt(15)
    ds_read_b64_tr_b16 a[252:253], v47 offset:40960
    ds_read_b64_tr_b16 a[254:255], v47 offset:41984
    v_mfma_f32_16x16x32_bf16 a[20:23], a[228:231], a[180:183], a[20:23]
    v_add_u32 v32, 4096, v32
    v_mfma_f32_16x16x32_bf16 a[4:7], a[224:227], a[180:183], a[4:7]
    s_waitcnt vmcnt(14)
    buffer_load_dwordx4 a[160:163], v32, s[72:75], s84 offen offset:0 sc1
    v_mfma_f32_16x16x32_bf16 a[8:11], a[224:227], a[184:187], a[8:11]
    s_waitcnt vmcnt(14)
    v_mfma_f32_16x16x32_bf16 a[24:27], a[228:231], a[184:187], a[24:27]
    s_mov_b32 s96, 8192
    buffer_store_dwordx4 v[68:71], v31, s[44:47], s96 offen offset:2048 sc1
    v_mfma_f32_16x16x32_bf16 a[28:31], a[228:231], a[188:191], a[28:31]
    v_mfma_f32_16x16x32_bf16 a[12:15], a[224:227], a[188:191], a[12:15]
    s_waitcnt vmcnt(19) lgkmcnt(0)
    buffer_load_dwordx4 a[164:167], v32, s[72:75], s85 offen offset:0 sc1
    v_mfma_f32_16x16x32_bf16 a[44:47], a[232:235], a[188:191], a[44:47]
    s_barrier
    ds_read_b64_tr_b16 a[224:225], v52 offset:0
    ds_read_b64_tr_b16 a[226:227], v52 offset:1024
    v_mfma_f32_16x16x32_bf16 a[60:63], a[236:239], a[188:191], a[60:63]
    s_add_u32 m0, s93, 98304
    ds_read_b64_tr_b16 a[228:229], v53 offset:0
    ds_read_b64_tr_b16 a[230:231], v53 offset:1024
    v_mfma_f32_16x16x32_bf16 a[56:59], a[236:239], a[184:187], a[56:59]
    s_mov_b32 s94, 2621440
    v_mfma_f32_16x16x32_bf16 a[40:43], a[232:235], a[184:187], a[40:43]
    buffer_load_dwordx4 a[168:171], v32, s[72:75], s86 offen offset:0 sc1
    v_mfma_f32_16x16x32_bf16 a[36:39], a[232:235], a[180:183], a[36:39]
    buffer_load_dwordx4 v34, s[60:63], s94 offen offset:0 lds
    v_mfma_f32_16x16x32_bf16 a[52:55], a[236:239], a[180:183], a[52:55]
    v_mfma_f32_16x16x32_bf16 a[48:51], a[236:239], a[176:179], a[48:51]
    v_mfma_f32_16x16x32_bf16 a[32:35], a[232:235], a[176:179], a[32:35]
    buffer_load_dwordx4 a[172:175], v32, s[72:75], s87 offen offset:0 sc1
    v_mfma_f32_16x16x32_bf16 a[64:67], a[240:243], a[176:179], a[64:67]
    ds_read_b64_tr_b16 a[232:233], v54 offset:0
    ds_read_b64_tr_b16 a[234:235], v54 offset:1024
    v_mfma_f32_16x16x32_bf16 a[80:83], a[244:247], a[176:179], a[80:83]
    ds_read_b64_tr_b16 a[236:237], v55 offset:0
    ds_read_b64_tr_b16 a[238:239], v55 offset:1024
    v_mfma_f32_16x16x32_bf16 a[84:87], a[244:247], a[180:183], a[84:87]
    buffer_load_dwordx4 v35, s[60:63], s94 offen offset:1024 lds
    v_mfma_f32_16x16x32_bf16 a[68:71], a[240:243], a[180:183], a[68:71]
    v_mfma_f32_16x16x32_bf16 a[72:75], a[240:243], a[184:187], a[72:75]
    v_mfma_f32_16x16x32_bf16 a[88:91], a[244:247], a[184:187], a[88:91]
    s_mov_b32 s96, 33792
    buffer_store_dwordx4 v[72:75], v31, s[44:47], s96 offen offset:2048 sc1
    v_mfma_f32_16x16x32_bf16 a[92:95], a[244:247], a[188:191], a[92:95]
    buffer_load_dwordx4 v36, s[60:63], s94 offen offset:2048 lds
    v_mfma_f32_16x16x32_bf16 a[76:79], a[240:243], a[188:191], a[76:79]
    v_mfma_f32_16x16x32_bf16 a[108:111], a[248:251], a[188:191], a[108:111]
    ds_read_b64_tr_b16 a[240:241], v56 offset:0
    ds_read_b64_tr_b16 a[242:243], v56 offset:1024
    v_mfma_f32_16x16x32_bf16 a[124:127], a[252:255], a[188:191], a[124:127]
    ds_read_b64_tr_b16 a[244:245], v57 offset:0
    ds_read_b64_tr_b16 a[246:247], v57 offset:1024
    v_mfma_f32_16x16x32_bf16 a[120:123], a[252:255], a[184:187], a[120:123]
    buffer_load_dwordx4 v37, s[60:63], s94 offen offset:3072 lds
    v_mfma_f32_16x16x32_bf16 a[104:107], a[248:251], a[184:187], a[104:107]
    v_mfma_f32_16x16x32_bf16 a[100:103], a[248:251], a[180:183], a[100:103]
    v_mfma_f32_16x16x32_bf16 a[116:119], a[252:255], a[180:183], a[116:119]
    v_mfma_f32_16x16x32_bf16 a[112:115], a[252:255], a[176:179], a[112:115]
    v_mfma_f32_16x16x32_bf16 a[96:99], a[248:251], a[176:179], a[96:99]
    s_waitcnt lgkmcnt(2) vmcnt(22)
    v_mfma_f32_16x16x32_bf16 a[0:3], a[224:227], a[192:195], a[0:3]
    ds_read_b64_tr_b16 a[248:249], v58 offset:0
    ds_read_b64_tr_b16 a[250:251], v58 offset:1024
    v_mfma_f32_16x16x32_bf16 a[16:19], a[228:231], a[192:195], a[16:19]
    s_waitcnt vmcnt(21)
    ds_read_b64_tr_b16 a[252:253], v59 offset:0
    ds_read_b64_tr_b16 a[254:255], v59 offset:1024
    v_mfma_f32_16x16x32_bf16 a[20:23], a[228:231], a[196:199], a[20:23]
    v_mfma_f32_16x16x32_bf16 a[4:7], a[224:227], a[196:199], a[4:7]
    s_waitcnt vmcnt(20)
    buffer_load_dwordx4 a[176:179], v32, s[72:75], s84 offen offset:1024 sc1
    v_mfma_f32_16x16x32_bf16 a[8:11], a[224:227], a[200:203], a[8:11]
    s_mov_b32 s96, 41984
    buffer_store_dwordx4 v[76:79], v31, s[44:47], s96 offen offset:2048 sc1
    v_mfma_f32_16x16x32_bf16 a[24:27], a[228:231], a[200:203], a[24:27]
    s_waitcnt vmcnt(20)
    v_mfma_f32_16x16x32_bf16 a[28:31], a[228:231], a[204:207], a[28:31]
    v_mfma_f32_16x16x32_bf16 a[12:15], a[224:227], a[204:207], a[12:15]
    buffer_load_dwordx4 a[180:183], v32, s[72:75], s85 offen offset:1024 sc1
    v_mfma_f32_16x16x32_bf16 a[44:47], a[232:235], a[204:207], a[44:47]
    ds_read_b64_tr_b16 a[224:225], v52 offset:8192
    ds_read_b64_tr_b16 a[226:227], v52 offset:9216
    v_mfma_f32_16x16x32_bf16 a[60:63], a[236:239], a[204:207], a[60:63]
    ds_read_b64_tr_b16 a[228:229], v53 offset:8192
    ds_read_b64_tr_b16 a[230:231], v53 offset:9216
    v_mfma_f32_16x16x32_bf16 a[56:59], a[236:239], a[200:203], a[56:59]
    v_mfma_f32_16x16x32_bf16 a[40:43], a[232:235], a[200:203], a[40:43]
    buffer_load_dwordx4 a[184:187], v32, s[72:75], s86 offen offset:1024 sc1
    v_mfma_f32_16x16x32_bf16 a[36:39], a[232:235], a[196:199], a[36:39]
    v_mfma_f32_16x16x32_bf16 a[52:55], a[236:239], a[196:199], a[52:55]
    v_mfma_f32_16x16x32_bf16 a[48:51], a[236:239], a[192:195], a[48:51]
    v_mfma_f32_16x16x32_bf16 a[32:35], a[232:235], a[192:195], a[32:35]
    buffer_load_dwordx4 a[188:191], v32, s[72:75], s87 offen offset:1024 sc1
    v_mfma_f32_16x16x32_bf16 a[64:67], a[240:243], a[192:195], a[64:67]
    s_waitcnt lgkmcnt(0)
    ds_read_b64_tr_b16 a[232:233], v54 offset:8192
    ds_read_b64_tr_b16 a[234:235], v54 offset:9216
    v_mfma_f32_16x16x32_bf16 a[80:83], a[244:247], a[192:195], a[80:83]
    ds_read_b64_tr_b16 a[236:237], v55 offset:8192
    ds_read_b64_tr_b16 a[238:239], v55 offset:9216
    v_mfma_f32_16x16x32_bf16 a[84:87], a[244:247], a[196:199], a[84:87]
    v_mfma_f32_16x16x32_bf16 a[68:71], a[240:243], a[196:199], a[68:71]
    v_mfma_f32_16x16x32_bf16 a[72:75], a[240:243], a[200:203], a[72:75]
    s_mov_b32 s96, 0
    buffer_store_dwordx4 v[80:83], v31, s[44:47], s96 offen offset:3072 sc1
    v_mfma_f32_16x16x32_bf16 a[88:91], a[244:247], a[200:203], a[88:91]
    v_mfma_f32_16x16x32_bf16 a[92:95], a[244:247], a[204:207], a[92:95]
    v_mfma_f32_16x16x32_bf16 a[76:79], a[240:243], a[204:207], a[76:79]
    v_mfma_f32_16x16x32_bf16 a[108:111], a[248:251], a[204:207], a[108:111]
    ds_read_b64_tr_b16 a[240:241], v56 offset:8192
    ds_read_b64_tr_b16 a[242:243], v56 offset:9216
    v_mfma_f32_16x16x32_bf16 a[124:127], a[252:255], a[204:207], a[124:127]
    ds_read_b64_tr_b16 a[244:245], v57 offset:8192
    ds_read_b64_tr_b16 a[246:247], v57 offset:9216
    v_mfma_f32_16x16x32_bf16 a[120:123], a[252:255], a[200:203], a[120:123]
    v_mfma_f32_16x16x32_bf16 a[104:107], a[248:251], a[200:203], a[104:107]
    v_mfma_f32_16x16x32_bf16 a[100:103], a[248:251], a[196:199], a[100:103]
    v_mfma_f32_16x16x32_bf16 a[116:119], a[252:255], a[196:199], a[116:119]
    v_mfma_f32_16x16x32_bf16 a[112:115], a[252:255], a[192:195], a[112:115]
    v_mfma_f32_16x16x32_bf16 a[96:99], a[248:251], a[192:195], a[96:99]
    s_waitcnt vmcnt(20)
    v_mfma_f32_16x16x32_bf16 a[0:3], a[224:227], a[208:211], a[0:3]
    ds_read_b64_tr_b16 a[248:249], v58 offset:8192
    ds_read_b64_tr_b16 a[250:251], v58 offset:9216
    v_mfma_f32_16x16x32_bf16 a[16:19], a[228:231], a[208:211], a[16:19]
    s_waitcnt vmcnt(19)
    ds_read_b64_tr_b16 a[252:253], v59 offset:8192
    ds_read_b64_tr_b16 a[254:255], v59 offset:9216
    v_mfma_f32_16x16x32_bf16 a[20:23], a[228:231], a[212:215], a[20:23]
    s_waitcnt vmcnt(18)
    v_mfma_f32_16x16x32_bf16 a[4:7], a[224:227], a[212:215], a[4:7]
    s_mov_b32 s96, 8192
    buffer_load_dwordx4 a[192:195], v32, s[72:75], s84 offen offset:2048 sc1
    v_mfma_f32_16x16x32_bf16 a[8:11], a[224:227], a[216:219], a[8:11]
    buffer_store_dwordx4 v[84:87], v31, s[44:47], s96 offen offset:3072 sc1
    v_mfma_f32_16x16x32_bf16 a[24:27], a[228:231], a[216:219], a[24:27]
    s_waitcnt vmcnt(19)
    v_mfma_f32_16x16x32_bf16 a[28:31], a[228:231], a[220:223], a[28:31]
    v_mfma_f32_16x16x32_bf16 a[12:15], a[224:227], a[220:223], a[12:15]
    s_waitcnt vmcnt(23) lgkmcnt(0)
    buffer_load_dwordx4 a[196:199], v32, s[72:75], s85 offen offset:2048 sc1
    v_mfma_f32_16x16x32_bf16 a[44:47], a[232:235], a[220:223], a[44:47]
    s_barrier
    ds_read_b64_tr_b16 a[224:225], v40 offset:0
    ds_read_b64_tr_b16 a[226:227], v40 offset:1024
    v_mfma_f32_16x16x32_bf16 a[60:63], a[236:239], a[220:223], a[60:63]
    s_add_u32 m0, s93, 131072
    ds_read_b64_tr_b16 a[228:229], v41 offset:0
    ds_read_b64_tr_b16 a[230:231], v41 offset:1024
    v_mfma_f32_16x16x32_bf16 a[56:59], a[236:239], a[216:219], a[56:59]
    s_mov_b32 s94, 3145728
    v_mfma_f32_16x16x32_bf16 a[40:43], a[232:235], a[216:219], a[40:43]
    buffer_load_dwordx4 a[200:203], v32, s[72:75], s86 offen offset:2048 sc1
    v_mfma_f32_16x16x32_bf16 a[36:39], a[232:235], a[212:215], a[36:39]
    buffer_load_dwordx4 v34, s[60:63], s94 offen offset:0 lds
    v_mfma_f32_16x16x32_bf16 a[52:55], a[236:239], a[212:215], a[52:55]
    v_mfma_f32_16x16x32_bf16 a[48:51], a[236:239], a[208:211], a[48:51]
    v_mfma_f32_16x16x32_bf16 a[32:35], a[232:235], a[208:211], a[32:35]
    buffer_load_dwordx4 a[204:207], v32, s[72:75], s87 offen offset:2048 sc1
    v_mfma_f32_16x16x32_bf16 a[64:67], a[240:243], a[208:211], a[64:67]
    ds_read_b64_tr_b16 a[232:233], v42 offset:0
    ds_read_b64_tr_b16 a[234:235], v42 offset:1024
    v_mfma_f32_16x16x32_bf16 a[80:83], a[244:247], a[208:211], a[80:83]
    ds_read_b64_tr_b16 a[236:237], v43 offset:0
    ds_read_b64_tr_b16 a[238:239], v43 offset:1024
    v_mfma_f32_16x16x32_bf16 a[84:87], a[244:247], a[212:215], a[84:87]
    buffer_load_dwordx4 v35, s[60:63], s94 offen offset:1024 lds
    v_mfma_f32_16x16x32_bf16 a[68:71], a[240:243], a[212:215], a[68:71]
    s_mov_b32 s96, 33792
    buffer_store_dwordx4 v[88:91], v31, s[44:47], s96 offen offset:3072 sc1
    v_mfma_f32_16x16x32_bf16 a[72:75], a[240:243], a[216:219], a[72:75]
    v_mfma_f32_16x16x32_bf16 a[88:91], a[244:247], a[216:219], a[88:91]
    v_mfma_f32_16x16x32_bf16 a[92:95], a[244:247], a[220:223], a[92:95]
    buffer_load_dwordx4 v36, s[60:63], s94 offen offset:2048 lds
    v_mfma_f32_16x16x32_bf16 a[76:79], a[240:243], a[220:223], a[76:79]
    v_mfma_f32_16x16x32_bf16 a[108:111], a[248:251], a[220:223], a[108:111]
    ds_read_b64_tr_b16 a[240:241], v44 offset:0
    ds_read_b64_tr_b16 a[242:243], v44 offset:1024
    v_mfma_f32_16x16x32_bf16 a[124:127], a[252:255], a[220:223], a[124:127]
    ds_read_b64_tr_b16 a[244:245], v45 offset:0
    ds_read_b64_tr_b16 a[246:247], v45 offset:1024
    v_mfma_f32_16x16x32_bf16 a[120:123], a[252:255], a[216:219], a[120:123]
    buffer_load_dwordx4 v37, s[60:63], s94 offen offset:3072 lds
    v_mfma_f32_16x16x32_bf16 a[104:107], a[248:251], a[216:219], a[104:107]
    v_mfma_f32_16x16x32_bf16 a[100:103], a[248:251], a[212:215], a[100:103]
    v_mfma_f32_16x16x32_bf16 a[116:119], a[252:255], a[212:215], a[116:119]
    v_mfma_f32_16x16x32_bf16 a[112:115], a[252:255], a[208:211], a[112:115]
    v_mfma_f32_16x16x32_bf16 a[96:99], a[248:251], a[208:211], a[96:99]
    s_waitcnt lgkmcnt(2) vmcnt(25)
    v_mfma_f32_16x16x32_bf16 a[0:3], a[224:227], a[160:163], a[0:3]
    ds_read_b64_tr_b16 a[248:249], v46 offset:0
    ds_read_b64_tr_b16 a[250:251], v46 offset:1024
    v_mfma_f32_16x16x32_bf16 a[16:19], a[228:231], a[160:163], a[16:19]
    s_waitcnt vmcnt(23)
    ds_read_b64_tr_b16 a[252:253], v47 offset:0
    ds_read_b64_tr_b16 a[254:255], v47 offset:1024
    v_mfma_f32_16x16x32_bf16 a[20:23], a[228:231], a[164:167], a[20:23]
    s_mov_b32 s96, 41984
    buffer_store_dwordx4 v[92:95], v31, s[44:47], s96 offen offset:3072 sc1
    v_mfma_f32_16x16x32_bf16 a[4:7], a[224:227], a[164:167], a[4:7]
    s_waitcnt vmcnt(23)
    buffer_load_dwordx4 a[208:211], v32, s[72:75], s84 offen offset:3072 sc1
    v_mfma_f32_16x16x32_bf16 a[8:11], a[224:227], a[168:171], a[8:11]
    v_mfma_f32_16x16x32_bf16 a[24:27], a[228:231], a[168:171], a[24:27]
    s_waitcnt vmcnt(22)
    v_mfma_f32_16x16x32_bf16 a[28:31], a[228:231], a[172:175], a[28:31]
    v_mfma_f32_16x16x32_bf16 a[12:15], a[224:227], a[172:175], a[12:15]
    buffer_load_dwordx4 a[212:215], v32, s[72:75], s85 offen offset:3072 sc1
    v_mfma_f32_16x16x32_bf16 a[44:47], a[232:235], a[172:175], a[44:47]
    ds_read_b64_tr_b16 a[224:225], v40 offset:8192
    ds_read_b64_tr_b16 a[226:227], v40 offset:9216
    v_mfma_f32_16x16x32_bf16 a[60:63], a[236:239], a[172:175], a[60:63]
    ds_read_b64_tr_b16 a[228:229], v41 offset:8192
    ds_read_b64_tr_b16 a[230:231], v41 offset:9216
    v_mfma_f32_16x16x32_bf16 a[56:59], a[236:239], a[168:171], a[56:59]
    v_mfma_f32_16x16x32_bf16 a[40:43], a[232:235], a[168:171], a[40:43]
    buffer_load_dwordx4 a[216:219], v32, s[72:75], s86 offen offset:3072 sc1
    v_mfma_f32_16x16x32_bf16 a[36:39], a[232:235], a[164:167], a[36:39]
    v_mfma_f32_16x16x32_bf16 a[52:55], a[236:239], a[164:167], a[52:55]
    v_mfma_f32_16x16x32_bf16 a[48:51], a[236:239], a[160:163], a[48:51]
    v_mfma_f32_16x16x32_bf16 a[32:35], a[232:235], a[160:163], a[32:35]
    buffer_load_dwordx4 a[220:223], v32, s[72:75], s87 offen offset:3072 sc1
    v_mfma_f32_16x16x32_bf16 a[64:67], a[240:243], a[160:163], a[64:67]
    s_waitcnt lgkmcnt(0)
    ds_read_b64_tr_b16 a[232:233], v42 offset:8192
    ds_read_b64_tr_b16 a[234:235], v42 offset:9216
    v_mfma_f32_16x16x32_bf16 a[80:83], a[244:247], a[160:163], a[80:83]
    ds_read_b64_tr_b16 a[236:237], v43 offset:8192
    ds_read_b64_tr_b16 a[238:239], v43 offset:9216
    v_mfma_f32_16x16x32_bf16 a[84:87], a[244:247], a[164:167], a[84:87]
    s_mov_b32 s96, 0
    buffer_store_dwordx4 v[96:99], v30, s[44:47], s96 offen offset:0 sc1
    v_mfma_f32_16x16x32_bf16 a[68:71], a[240:243], a[164:167], a[68:71]
    v_mfma_f32_16x16x32_bf16 a[72:75], a[240:243], a[168:171], a[72:75]
    v_mfma_f32_16x16x32_bf16 a[88:91], a[244:247], a[168:171], a[88:91]
    v_mfma_f32_16x16x32_bf16 a[92:95], a[244:247], a[172:175], a[92:95]
    v_mfma_f32_16x16x32_bf16 a[76:79], a[240:243], a[172:175], a[76:79]
    v_mfma_f32_16x16x32_bf16 a[108:111], a[248:251], a[172:175], a[108:111]
    ds_read_b64_tr_b16 a[240:241], v44 offset:8192
    ds_read_b64_tr_b16 a[242:243], v44 offset:9216
    v_mfma_f32_16x16x32_bf16 a[124:127], a[252:255], a[172:175], a[124:127]
    ds_read_b64_tr_b16 a[244:245], v45 offset:8192
    ds_read_b64_tr_b16 a[246:247], v45 offset:9216
    v_mfma_f32_16x16x32_bf16 a[120:123], a[252:255], a[168:171], a[120:123]
    v_mfma_f32_16x16x32_bf16 a[104:107], a[248:251], a[168:171], a[104:107]
    v_mfma_f32_16x16x32_bf16 a[100:103], a[248:251], a[164:167], a[100:103]
    v_mfma_f32_16x16x32_bf16 a[116:119], a[252:255], a[164:167], a[116:119]
    v_mfma_f32_16x16x32_bf16 a[112:115], a[252:255], a[160:163], a[112:115]
    v_mfma_f32_16x16x32_bf16 a[96:99], a[248:251], a[160:163], a[96:99]
    s_waitcnt vmcnt(21)
    v_mfma_f32_16x16x32_bf16 a[0:3], a[224:227], a[176:179], a[0:3]
    ds_read_b64_tr_b16 a[248:249], v46 offset:8192
    ds_read_b64_tr_b16 a[250:251], v46 offset:9216
    v_mfma_f32_16x16x32_bf16 a[16:19], a[228:231], a[176:179], a[16:19]
    s_waitcnt vmcnt(19)
    ds_read_b64_tr_b16 a[252:253], v47 offset:8192
    ds_read_b64_tr_b16 a[254:255], v47 offset:9216
    v_mfma_f32_16x16x32_bf16 a[20:23], a[228:231], a[180:183], a[20:23]
    s_mov_b32 s96, 4096
    v_add_u32 v32, 4096, v32
    v_mfma_f32_16x16x32_bf16 a[4:7], a[224:227], a[180:183], a[4:7]
    s_waitcnt vmcnt(18)
    buffer_load_dwordx4 a[160:163], v32, s[72:75], s84 offen offset:0 sc1
    v_mfma_f32_16x16x32_bf16 a[8:11], a[224:227], a[184:187], a[8:11]
    buffer_store_dwordx4 v[100:103], v30, s[44:47], s96 offen offset:0 sc1
    v_mfma_f32_16x16x32_bf16 a[24:27], a[228:231], a[184:187], a[24:27]
    s_waitcnt vmcnt(19)
    v_mfma_f32_16x16x32_bf16 a[28:31], a[228:231], a[188:191], a[28:31]
    v_mfma_f32_16x16x32_bf16 a[12:15], a[224:227], a[188:191], a[12:15]
    s_waitcnt vmcnt(24) lgkmcnt(0)
    buffer_load_dwordx4 a[164:167], v32, s[72:75], s85 offen offset:0 sc1
    v_mfma_f32_16x16x32_bf16 a[44:47], a[232:235], a[188:191], a[44:47]
    s_barrier
    ds_read_b64_tr_b16 a[224:225], v40 offset:32768
    ds_read_b64_tr_b16 a[226:227], v40 offset:33792
    v_mfma_f32_16x16x32_bf16 a[60:63], a[236:239], a[188:191], a[60:63]
    s_add_u32 m0, s93, 65536
    ds_read_b64_tr_b16 a[228:229], v41 offset:32768
    ds_read_b64_tr_b16 a[230:231], v41 offset:33792
    v_mfma_f32_16x16x32_bf16 a[56:59], a[236:239], a[184:187], a[56:59]
    s_mov_b32 s94, 3670016
    v_mfma_f32_16x16x32_bf16 a[40:43], a[232:235], a[184:187], a[40:43]
    buffer_load_dwordx4 a[168:171], v32, s[72:75], s86 offen offset:0 sc1
    v_mfma_f32_16x16x32_bf16 a[36:39], a[232:235], a[180:183], a[36:39]
    buffer_load_dwordx4 v34, s[60:63], s94 offen offset:0 lds
    v_mfma_f32_16x16x32_bf16 a[52:55], a[236:239], a[180:183], a[52:55]
    v_mfma_f32_16x16x32_bf16 a[48:51], a[236:239], a[176:179], a[48:51]
    v_mfma_f32_16x16x32_bf16 a[32:35], a[232:235], a[176:179], a[32:35]
    buffer_load_dwordx4 a[172:175], v32, s[72:75], s87 offen offset:0 sc1
    v_mfma_f32_16x16x32_bf16 a[64:67], a[240:243], a[176:179], a[64:67]
    ds_read_b64_tr_b16 a[232:233], v42 offset:32768
    ds_read_b64_tr_b16 a[234:235], v42 offset:33792
    v_mfma_f32_16x16x32_bf16 a[80:83], a[244:247], a[176:179], a[80:83]
    s_mov_b32 s96, 8192
    ds_read_b64_tr_b16 a[236:237], v43 offset:32768
    ds_read_b64_tr_b16 a[238:239], v43 offset:33792
    v_mfma_f32_16x16x32_bf16 a[84:87], a[244:247], a[180:183], a[84:87]
    buffer_load_dwordx4 v35, s[60:63], s94 offen offset:1024 lds
    v_mfma_f32_16x16x32_bf16 a[68:71], a[240:243], a[180:183], a[68:71]
    buffer_store_dwordx4 v[104:107], v30, s[44:47], s96 offen offset:0 sc1
    v_mfma_f32_16x16x32_bf16 a[72:75], a[240:243], a[184:187], a[72:75]
    v_mfma_f32_16x16x32_bf16 a[88:91], a[244:247], a[184:187], a[88:91]
    v_mfma_f32_16x16x32_bf16 a[92:95], a[244:247], a[188:191], a[92:95]
    buffer_load_dwordx4 v36, s[60:63], s94 offen offset:2048 lds
    v_mfma_f32_16x16x32_bf16 a[76:79], a[240:243], a[188:191], a[76:79]
    v_mfma_f32_16x16x32_bf16 a[108:111], a[248:251], a[188:191], a[108:111]
    ds_read_b64_tr_b16 a[240:241], v44 offset:32768
    ds_read_b64_tr_b16 a[242:243], v44 offset:33792
    v_mfma_f32_16x16x32_bf16 a[124:127], a[252:255], a[188:191], a[124:127]
    ds_read_b64_tr_b16 a[244:245], v45 offset:32768
    ds_read_b64_tr_b16 a[246:247], v45 offset:33792
    v_mfma_f32_16x16x32_bf16 a[120:123], a[252:255], a[184:187], a[120:123]
    buffer_load_dwordx4 v37, s[60:63], s94 offen offset:3072 lds
    v_mfma_f32_16x16x32_bf16 a[104:107], a[248:251], a[184:187], a[104:107]
    v_mfma_f32_16x16x32_bf16 a[100:103], a[248:251], a[180:183], a[100:103]
    v_mfma_f32_16x16x32_bf16 a[116:119], a[252:255], a[180:183], a[116:119]
    v_mfma_f32_16x16x32_bf16 a[112:115], a[252:255], a[176:179], a[112:115]
    v_mfma_f32_16x16x32_bf16 a[96:99], a[248:251], a[176:179], a[96:99]
    s_waitcnt lgkmcnt(2) vmcnt(25)
    v_mfma_f32_16x16x32_bf16 a[0:3], a[224:227], a[192:195], a[0:3]
    s_waitcnt vmcnt(23)
    ds_read_b64_tr_b16 a[248:249], v46 offset:32768
    ds_read_b64_tr_b16 a[250:251], v46 offset:33792
    v_mfma_f32_16x16x32_bf16 a[16:19], a[228:231], a[192:195], a[16:19]
    s_mov_b32 s96, 12288
    ds_read_b64_tr_b16 a[252:253], v47 offset:32768
    ds_read_b64_tr_b16 a[254:255], v47 offset:33792
    v_mfma_f32_16x16x32_bf16 a[20:23], a[228:231], a[196:199], a[20:23]
    buffer_store_dwordx4 v[108:111], v30, s[44:47], s96 offen offset:0 sc1
    v_mfma_f32_16x16x32_bf16 a[4:7], a[224:227], a[196:199], a[4:7]
    s_waitcnt vmcnt(23)
    buffer_load_dwordx4 a[176:179], v32, s[72:75], s84 offen offset:1024 sc1
    v_mfma_f32_16x16x32_bf16 a[8:11], a[224:227], a[200:203], a[8:11]
    v_mfma_f32_16x16x32_bf16 a[24:27], a[228:231], a[200:203], a[24:27]
    s_waitcnt vmcnt(22)
    v_mfma_f32_16x16x32_bf16 a[28:31], a[228:231], a[204:207], a[28:31]
    v_mfma_f32_16x16x32_bf16 a[12:15], a[224:227], a[204:207], a[12:15]
    buffer_load_dwordx4 a[180:183], v32, s[72:75], s85 offen offset:1024 sc1
    v_mfma_f32_16x16x32_bf16 a[44:47], a[232:235], a[204:207], a[44:47]
    ds_read_b64_tr_b16 a[224:225], v40 offset:40960
    ds_read_b64_tr_b16 a[226:227], v40 offset:41984
    v_mfma_f32_16x16x32_bf16 a[60:63], a[236:239], a[204:207], a[60:63]
    ds_read_b64_tr_b16 a[228:229], v41 offset:40960
    ds_read_b64_tr_b16 a[230:231], v41 offset:41984
    v_mfma_f32_16x16x32_bf16 a[56:59], a[236:239], a[200:203], a[56:59]
    v_mfma_f32_16x16x32_bf16 a[40:43], a[232:235], a[200:203], a[40:43]
    buffer_load_dwordx4 a[184:187], v32, s[72:75], s86 offen offset:1024 sc1
    v_mfma_f32_16x16x32_bf16 a[36:39], a[232:235], a[196:199], a[36:39]
    v_mfma_f32_16x16x32_bf16 a[52:55], a[236:239], a[196:199], a[52:55]
    v_mfma_f32_16x16x32_bf16 a[48:51], a[236:239], a[192:195], a[48:51]
    v_mfma_f32_16x16x32_bf16 a[32:35], a[232:235], a[192:195], a[32:35]
    s_waitcnt lgkmcnt(2)
    buffer_load_dwordx4 a[188:191], v32, s[72:75], s87 offen offset:1024 sc1
    v_mfma_f32_16x16x32_bf16 a[64:67], a[240:243], a[192:195], a[64:67]
    s_mov_b32 s96, 33792
    ds_read_b64_tr_b16 a[232:233], v42 offset:40960
    ds_read_b64_tr_b16 a[234:235], v42 offset:41984
    v_mfma_f32_16x16x32_bf16 a[80:83], a[244:247], a[192:195], a[80:83]
    ds_read_b64_tr_b16 a[236:237], v43 offset:40960
    ds_read_b64_tr_b16 a[238:239], v43 offset:41984
    v_mfma_f32_16x16x32_bf16 a[84:87], a[244:247], a[196:199], a[84:87]
    buffer_store_dwordx4 v[112:115], v30, s[44:47], s96 offen offset:0 sc1
    v_mfma_f32_16x16x32_bf16 a[68:71], a[240:243], a[196:199], a[68:71]
    v_mfma_f32_16x16x32_bf16 a[72:75], a[240:243], a[200:203], a[72:75]
    v_mfma_f32_16x16x32_bf16 a[88:91], a[244:247], a[200:203], a[88:91]
    v_mfma_f32_16x16x32_bf16 a[92:95], a[244:247], a[204:207], a[92:95]
    v_mfma_f32_16x16x32_bf16 a[76:79], a[240:243], a[204:207], a[76:79]
    v_mfma_f32_16x16x32_bf16 a[108:111], a[248:251], a[204:207], a[108:111]
    ds_read_b64_tr_b16 a[240:241], v44 offset:40960
    ds_read_b64_tr_b16 a[242:243], v44 offset:41984
    v_mfma_f32_16x16x32_bf16 a[124:127], a[252:255], a[204:207], a[124:127]
    ds_read_b64_tr_b16 a[244:245], v45 offset:40960
    ds_read_b64_tr_b16 a[246:247], v45 offset:41984
    v_mfma_f32_16x16x32_bf16 a[120:123], a[252:255], a[200:203], a[120:123]
    v_mfma_f32_16x16x32_bf16 a[104:107], a[248:251], a[200:203], a[104:107]
    v_mfma_f32_16x16x32_bf16 a[100:103], a[248:251], a[196:199], a[100:103]
    v_mfma_f32_16x16x32_bf16 a[116:119], a[252:255], a[196:199], a[116:119]
    v_mfma_f32_16x16x32_bf16 a[112:115], a[252:255], a[192:195], a[112:115]
    v_mfma_f32_16x16x32_bf16 a[96:99], a[248:251], a[192:195], a[96:99]
    s_waitcnt vmcnt(20) lgkmcnt(2)
    v_mfma_f32_16x16x32_bf16 a[0:3], a[224:227], a[208:211], a[0:3]
    s_mov_b32 s96, 37888
    ds_read_b64_tr_b16 a[248:249], v46 offset:40960
    ds_read_b64_tr_b16 a[250:251], v46 offset:41984
    v_mfma_f32_16x16x32_bf16 a[16:19], a[228:231], a[208:211], a[16:19]
    s_waitcnt vmcnt(19)
    ds_read_b64_tr_b16 a[252:253], v47 offset:40960
    ds_read_b64_tr_b16 a[254:255], v47 offset:41984
    v_mfma_f32_16x16x32_bf16 a[20:23], a[228:231], a[212:215], a[20:23]
    buffer_store_dwordx4 v[116:119], v30, s[44:47], s96 offen offset:0 sc1
    v_mfma_f32_16x16x32_bf16 a[4:7], a[224:227], a[212:215], a[4:7]
    s_waitcnt vmcnt(19)
    buffer_load_dwordx4 a[192:195], v32, s[72:75], s84 offen offset:2048 sc1
    v_mfma_f32_16x16x32_bf16 a[8:11], a[224:227], a[216:219], a[8:11]
    v_mfma_f32_16x16x32_bf16 a[24:27], a[228:231], a[216:219], a[24:27]
    s_waitcnt vmcnt(19)
    v_mfma_f32_16x16x32_bf16 a[28:31], a[228:231], a[220:223], a[28:31]
    v_mfma_f32_16x16x32_bf16 a[12:15], a[224:227], a[220:223], a[12:15]
    s_waitcnt vmcnt(24) lgkmcnt(0)
    buffer_load_dwordx4 a[196:199], v32, s[72:75], s85 offen offset:2048 sc1
    v_mfma_f32_16x16x32_bf16 a[44:47], a[232:235], a[220:223], a[44:47]
    s_barrier
    ds_read_b64_tr_b16 a[224:225], v52 offset:0
    ds_read_b64_tr_b16 a[226:227], v52 offset:1024
    v_mfma_f32_16x16x32_bf16 a[60:63], a[236:239], a[220:223], a[60:63]
    s_add_u32 m0, s93, 98304
    ds_read_b64_tr_b16 a[228:229], v53 offset:0
    ds_read_b64_tr_b16 a[230:231], v53 offset:1024
    v_mfma_f32_16x16x32_bf16 a[56:59], a[236:239], a[216:219], a[56:59]
    s_mov_b32 s94, 4194304
    v_mfma_f32_16x16x32_bf16 a[40:43], a[232:235], a[216:219], a[40:43]
    buffer_load_dwordx4 a[200:203], v32, s[72:75], s86 offen offset:2048 sc1
    v_mfma_f32_16x16x32_bf16 a[36:39], a[232:235], a[212:215], a[36:39]
    buffer_load_dwordx4 v34, s[60:63], s94 offen offset:0 lds
    v_mfma_f32_16x16x32_bf16 a[52:55], a[236:239], a[212:215], a[52:55]
    v_mfma_f32_16x16x32_bf16 a[48:51], a[236:239], a[208:211], a[48:51]
    v_mfma_f32_16x16x32_bf16 a[32:35], a[232:235], a[208:211], a[32:35]
    s_mov_b32 s96, 41984
    buffer_load_dwordx4 a[204:207], v32, s[72:75], s87 offen offset:2048 sc1
    v_mfma_f32_16x16x32_bf16 a[64:67], a[240:243], a[208:211], a[64:67]
    ds_read_b64_tr_b16 a[232:233], v54 offset:0
    ds_read_b64_tr_b16 a[234:235], v54 offset:1024
    v_mfma_f32_16x16x32_bf16 a[80:83], a[244:247], a[208:211], a[80:83]
    ds_read_b64_tr_b16 a[236:237], v55 offset:0
    ds_read_b64_tr_b16 a[238:239], v55 offset:1024
    v_mfma_f32_16x16x32_bf16 a[84:87], a[244:247], a[212:215], a[84:87]
    buffer_load_dwordx4 v35, s[60:63], s94 offen offset:1024 lds
    v_mfma_f32_16x16x32_bf16 a[68:71], a[240:243], a[212:215], a[68:71]
    buffer_store_dwordx4 v[120:123], v30, s[44:47], s96 offen offset:0 sc1
    v_mfma_f32_16x16x32_bf16 a[72:75], a[240:243], a[216:219], a[72:75]
    v_mfma_f32_16x16x32_bf16 a[88:91], a[244:247], a[216:219], a[88:91]
    v_mfma_f32_16x16x32_bf16 a[92:95], a[244:247], a[220:223], a[92:95]
    buffer_load_dwordx4 v36, s[60:63], s94 offen offset:2048 lds
    v_mfma_f32_16x16x32_bf16 a[76:79], a[240:243], a[220:223], a[76:79]
    v_mfma_f32_16x16x32_bf16 a[108:111], a[248:251], a[220:223], a[108:111]
    ds_read_b64_tr_b16 a[240:241], v56 offset:0
    ds_read_b64_tr_b16 a[242:243], v56 offset:1024
    v_mfma_f32_16x16x32_bf16 a[124:127], a[252:255], a[220:223], a[124:127]
    ds_read_b64_tr_b16 a[244:245], v57 offset:0
    ds_read_b64_tr_b16 a[246:247], v57 offset:1024
    v_mfma_f32_16x16x32_bf16 a[120:123], a[252:255], a[216:219], a[120:123]
    buffer_load_dwordx4 v37, s[60:63], s94 offen offset:3072 lds
    v_mfma_f32_16x16x32_bf16 a[104:107], a[248:251], a[216:219], a[104:107]
    v_mfma_f32_16x16x32_bf16 a[100:103], a[248:251], a[212:215], a[100:103]
    v_mfma_f32_16x16x32_bf16 a[116:119], a[252:255], a[212:215], a[116:119]
    v_mfma_f32_16x16x32_bf16 a[112:115], a[252:255], a[208:211], a[112:115]
    s_waitcnt lgkmcnt(4) vmcnt(25)
    v_mfma_f32_16x16x32_bf16 a[96:99], a[248:251], a[208:211], a[96:99]
    s_mov_b32 s96, 46080
    buffer_store_dwordx4 v[124:127], v30, s[44:47], s96 offen offset:0 sc1
    v_mfma_f32_16x16x32_bf16 a[0:3], a[224:227], a[160:163], a[0:3]
    ds_read_b64_tr_b16 a[248:249], v58 offset:0
    ds_read_b64_tr_b16 a[250:251], v58 offset:1024
    v_mfma_f32_16x16x32_bf16 a[16:19], a[228:231], a[160:163], a[16:19]
    s_waitcnt vmcnt(24)
    ds_read_b64_tr_b16 a[252:253], v59 offset:0
    ds_read_b64_tr_b16 a[254:255], v59 offset:1024
    v_mfma_f32_16x16x32_bf16 a[20:23], a[228:231], a[164:167], a[20:23]
    v_mfma_f32_16x16x32_bf16 a[4:7], a[224:227], a[164:167], a[4:7]
    s_waitcnt vmcnt(23)
    buffer_load_dwordx4 a[208:211], v32, s[72:75], s84 offen offset:3072 sc1
    v_mfma_f32_16x16x32_bf16 a[8:11], a[224:227], a[168:171], a[8:11]
    v_mfma_f32_16x16x32_bf16 a[24:27], a[228:231], a[168:171], a[24:27]
    s_waitcnt vmcnt(22)
    v_mfma_f32_16x16x32_bf16 a[28:31], a[228:231], a[172:175], a[28:31]
    v_mfma_f32_16x16x32_bf16 a[12:15], a[224:227], a[172:175], a[12:15]
    buffer_load_dwordx4 a[212:215], v32, s[72:75], s85 offen offset:3072 sc1
    v_mfma_f32_16x16x32_bf16 a[44:47], a[232:235], a[172:175], a[44:47]
    ds_read_b64_tr_b16 a[224:225], v52 offset:8192
    ds_read_b64_tr_b16 a[226:227], v52 offset:9216
    v_mfma_f32_16x16x32_bf16 a[60:63], a[236:239], a[172:175], a[60:63]
    ds_read_b64_tr_b16 a[228:229], v53 offset:8192
    ds_read_b64_tr_b16 a[230:231], v53 offset:9216
    v_mfma_f32_16x16x32_bf16 a[56:59], a[236:239], a[168:171], a[56:59]
    v_mfma_f32_16x16x32_bf16 a[40:43], a[232:235], a[168:171], a[40:43]
    buffer_load_dwordx4 a[216:219], v32, s[72:75], s86 offen offset:3072 sc1
    v_mfma_f32_16x16x32_bf16 a[36:39], a[232:235], a[164:167], a[36:39]
    v_mfma_f32_16x16x32_bf16 a[52:55], a[236:239], a[164:167], a[52:55]
    v_mfma_f32_16x16x32_bf16 a[48:51], a[236:239], a[160:163], a[48:51]
    s_waitcnt lgkmcnt(4)
    v_mfma_f32_16x16x32_bf16 a[32:35], a[232:235], a[160:163], a[32:35]
    s_mov_b32 s96, 0
    buffer_load_dwordx4 a[220:223], v32, s[72:75], s87 offen offset:3072 sc1
    v_mfma_f32_16x16x32_bf16 a[64:67], a[240:243], a[160:163], a[64:67]
    ds_read_b64_tr_b16 a[232:233], v54 offset:8192
    ds_read_b64_tr_b16 a[234:235], v54 offset:9216
    v_mfma_f32_16x16x32_bf16 a[80:83], a[244:247], a[160:163], a[80:83]
    ds_read_b64_tr_b16 a[236:237], v55 offset:8192
    ds_read_b64_tr_b16 a[238:239], v55 offset:9216
    v_mfma_f32_16x16x32_bf16 a[84:87], a[244:247], a[164:167], a[84:87]
    buffer_store_dwordx4 v[128:131], v30, s[44:47], s96 offen offset:1024 sc1
    v_mfma_f32_16x16x32_bf16 a[68:71], a[240:243], a[164:167], a[68:71]
    v_mfma_f32_16x16x32_bf16 a[72:75], a[240:243], a[168:171], a[72:75]
    v_mfma_f32_16x16x32_bf16 a[88:91], a[244:247], a[168:171], a[88:91]
    v_mfma_f32_16x16x32_bf16 a[92:95], a[244:247], a[172:175], a[92:95]
    v_mfma_f32_16x16x32_bf16 a[76:79], a[240:243], a[172:175], a[76:79]
    v_mfma_f32_16x16x32_bf16 a[108:111], a[248:251], a[172:175], a[108:111]
    ds_read_b64_tr_b16 a[240:241], v56 offset:8192
    ds_read_b64_tr_b16 a[242:243], v56 offset:9216
    v_mfma_f32_16x16x32_bf16 a[124:127], a[252:255], a[172:175], a[124:127]
    ds_read_b64_tr_b16 a[244:245], v57 offset:8192
    ds_read_b64_tr_b16 a[246:247], v57 offset:9216
    v_mfma_f32_16x16x32_bf16 a[120:123], a[252:255], a[168:171], a[120:123]
    v_mfma_f32_16x16x32_bf16 a[104:107], a[248:251], a[168:171], a[104:107]
    v_mfma_f32_16x16x32_bf16 a[100:103], a[248:251], a[164:167], a[100:103]
    v_mfma_f32_16x16x32_bf16 a[116:119], a[252:255], a[164:167], a[116:119]
    v_mfma_f32_16x16x32_bf16 a[112:115], a[252:255], a[160:163], a[112:115]
    s_mov_b32 s96, 4096
    buffer_store_dwordx4 v[132:135], v30, s[44:47], s96 offen offset:1024 sc1
    v_mfma_f32_16x16x32_bf16 a[96:99], a[248:251], a[160:163], a[96:99]
    s_waitcnt lgkmcnt(2) vmcnt(21)
    v_mfma_f32_16x16x32_bf16 a[0:3], a[224:227], a[176:179], a[0:3]
    ds_read_b64_tr_b16 a[248:249], v58 offset:8192
    ds_read_b64_tr_b16 a[250:251], v58 offset:9216
    v_mfma_f32_16x16x32_bf16 a[16:19], a[228:231], a[176:179], a[16:19]
    s_waitcnt vmcnt(20)
    ds_read_b64_tr_b16 a[252:253], v59 offset:8192
    ds_read_b64_tr_b16 a[254:255], v59 offset:9216
    v_mfma_f32_16x16x32_bf16 a[20:23], a[228:231], a[180:183], a[20:23]
    v_add_u32 v32, 4096, v32
    v_mfma_f32_16x16x32_bf16 a[4:7], a[224:227], a[180:183], a[4:7]
    s_waitcnt vmcnt(19)
    buffer_load_dwordx4 a[160:163], v32, s[72:75], s84 offen offset:0 sc1
    v_mfma_f32_16x16x32_bf16 a[8:11], a[224:227], a[184:187], a[8:11]
    v_mfma_f32_16x16x32_bf16 a[24:27], a[228:231], a[184:187], a[24:27]
    s_waitcnt vmcnt(19)
    v_mfma_f32_16x16x32_bf16 a[28:31], a[228:231], a[188:191], a[28:31]
    v_mfma_f32_16x16x32_bf16 a[12:15], a[224:227], a[188:191], a[12:15]
    s_waitcnt vmcnt(24) lgkmcnt(0)
    buffer_load_dwordx4 a[164:167], v32, s[72:75], s85 offen offset:0 sc1
    v_mfma_f32_16x16x32_bf16 a[44:47], a[232:235], a[188:191], a[44:47]
    s_barrier
    ds_read_b64_tr_b16 a[224:225], v40 offset:0
    ds_read_b64_tr_b16 a[226:227], v40 offset:1024
    v_mfma_f32_16x16x32_bf16 a[60:63], a[236:239], a[188:191], a[60:63]
    s_add_u32 m0, s93, 131072
    ds_read_b64_tr_b16 a[228:229], v41 offset:0
    ds_read_b64_tr_b16 a[230:231], v41 offset:1024
    v_mfma_f32_16x16x32_bf16 a[56:59], a[236:239], a[184:187], a[56:59]
    s_mov_b32 s94, 4718592
    v_mfma_f32_16x16x32_bf16 a[40:43], a[232:235], a[184:187], a[40:43]
    buffer_load_dwordx4 a[168:171], v32, s[72:75], s86 offen offset:0 sc1
    v_mfma_f32_16x16x32_bf16 a[36:39], a[232:235], a[180:183], a[36:39]
    buffer_load_dwordx4 v34, s[60:63], s94 offen offset:0 lds
    v_mfma_f32_16x16x32_bf16 a[52:55], a[236:239], a[180:183], a[52:55]
    v_mfma_f32_16x16x32_bf16 a[48:51], a[236:239], a[176:179], a[48:51]
    s_mov_b32 s96, 8192
    buffer_store_dwordx4 v[136:139], v30, s[44:47], s96 offen offset:1024 sc1
    v_mfma_f32_16x16x32_bf16 a[32:35], a[232:235], a[176:179], a[32:35]
    buffer_load_dwordx4 a[172:175], v32, s[72:75], s87 offen offset:0 sc1
    v_mfma_f32_16x16x32_bf16 a[64:67], a[240:243], a[176:179], a[64:67]
    ds_read_b64_tr_b16 a[232:233], v42 offset:0
    ds_read_b64_tr_b16 a[234:235], v42 offset:1024
    v_mfma_f32_16x16x32_bf16 a[80:83], a[244:247], a[176:179], a[80:83]
    ds_read_b64_tr_b16 a[236:237], v43 offset:0
    ds_read_b64_tr_b16 a[238:239], v43 offset:1024
    v_mfma_f32_16x16x32_bf16 a[84:87], a[244:247], a[180:183], a[84:87]
    buffer_load_dwordx4 v35, s[60:63], s94 offen offset:1024 lds
    v_mfma_f32_16x16x32_bf16 a[68:71], a[240:243], a[180:183], a[68:71]
    v_mfma_f32_16x16x32_bf16 a[72:75], a[240:243], a[184:187], a[72:75]
    v_mfma_f32_16x16x32_bf16 a[88:91], a[244:247], a[184:187], a[88:91]
    v_mfma_f32_16x16x32_bf16 a[92:95], a[244:247], a[188:191], a[92:95]
    buffer_load_dwordx4 v36, s[60:63], s94 offen offset:2048 lds
    v_mfma_f32_16x16x32_bf16 a[76:79], a[240:243], a[188:191], a[76:79]
    v_mfma_f32_16x16x32_bf16 a[108:111], a[248:251], a[188:191], a[108:111]
    ds_read_b64_tr_b16 a[240:241], v44 offset:0
    ds_read_b64_tr_b16 a[242:243], v44 offset:1024
    v_mfma_f32_16x16x32_bf16 a[124:127], a[252:255], a[188:191], a[124:127]
    ds_read_b64_tr_b16 a[244:245], v45 offset:0
    ds_read_b64_tr_b16 a[246:247], v45 offset:1024
    v_mfma_f32_16x16x32_bf16 a[120:123], a[252:255], a[184:187], a[120:123]
    buffer_load_dwordx4 v37, s[60:63], s94 offen offset:3072 lds
    v_mfma_f32_16x16x32_bf16 a[104:107], a[248:251], a[184:187], a[104:107]
    v_mfma_f32_16x16x32_bf16 a[100:103], a[248:251], a[180:183], a[100:103]
    v_mfma_f32_16x16x32_bf16 a[116:119], a[252:255], a[180:183], a[116:119]
    s_mov_b32 s96, 12288
    buffer_store_dwordx4 v[140:143], v30, s[44:47], s96 offen offset:1024 sc1
    v_mfma_f32_16x16x32_bf16 a[112:115], a[252:255], a[176:179], a[112:115]
    v_mfma_f32_16x16x32_bf16 a[96:99], a[248:251], a[176:179], a[96:99]
    s_waitcnt lgkmcnt(2) vmcnt(25)
    v_mfma_f32_16x16x32_bf16 a[0:3], a[224:227], a[192:195], a[0:3]
    ds_read_b64_tr_b16 a[248:249], v46 offset:0
    ds_read_b64_tr_b16 a[250:251], v46 offset:1024
    v_mfma_f32_16x16x32_bf16 a[16:19], a[228:231], a[192:195], a[16:19]
    s_waitcnt vmcnt(24)
    ds_read_b64_tr_b16 a[252:253], v47 offset:0
    ds_read_b64_tr_b16 a[254:255], v47 offset:1024
    v_mfma_f32_16x16x32_bf16 a[20:23], a[228:231], a[196:199], a[20:23]
    v_mfma_f32_16x16x32_bf16 a[4:7], a[224:227], a[196:199], a[4:7]
    s_waitcnt vmcnt(23)
    buffer_load_dwordx4 a[176:179], v32, s[72:75], s84 offen offset:1024 sc1
    v_mfma_f32_16x16x32_bf16 a[8:11], a[224:227], a[200:203], a[8:11]
    v_mfma_f32_16x16x32_bf16 a[24:27], a[228:231], a[200:203], a[24:27]
    s_waitcnt vmcnt(22)
    v_mfma_f32_16x16x32_bf16 a[28:31], a[228:231], a[204:207], a[28:31]
    v_mfma_f32_16x16x32_bf16 a[12:15], a[224:227], a[204:207], a[12:15]
    buffer_load_dwordx4 a[180:183], v32, s[72:75], s85 offen offset:1024 sc1
    v_mfma_f32_16x16x32_bf16 a[44:47], a[232:235], a[204:207], a[44:47]
    ds_read_b64_tr_b16 a[224:225], v40 offset:8192
    ds_read_b64_tr_b16 a[226:227], v40 offset:9216
    v_mfma_f32_16x16x32_bf16 a[60:63], a[236:239], a[204:207], a[60:63]
    ds_read_b64_tr_b16 a[228:229], v41 offset:8192
    ds_read_b64_tr_b16 a[230:231], v41 offset:9216
    v_mfma_f32_16x16x32_bf16 a[56:59], a[236:239], a[200:203], a[56:59]
    v_mfma_f32_16x16x32_bf16 a[40:43], a[232:235], a[200:203], a[40:43]
    buffer_load_dwordx4 a[184:187], v32, s[72:75], s86 offen offset:1024 sc1
    v_mfma_f32_16x16x32_bf16 a[36:39], a[232:235], a[196:199], a[36:39]
    v_mfma_f32_16x16x32_bf16 a[52:55], a[236:239], a[196:199], a[52:55]
    s_mov_b32 s96, 33792
    buffer_store_dwordx4 v[144:147], v30, s[44:47], s96 offen offset:1024 sc1
    v_mfma_f32_16x16x32_bf16 a[48:51], a[236:239], a[192:195], a[48:51]
    v_mfma_f32_16x16x32_bf16 a[32:35], a[232:235], a[192:195], a[32:35]
    buffer_load_dwordx4 a[188:191], v32, s[72:75], s87 offen offset:1024 sc1
    v_mfma_f32_16x16x32_bf16 a[64:67], a[240:243], a[192:195], a[64:67]
    s_waitcnt lgkmcnt(0)
    ds_read_b64_tr_b16 a[232:233], v42 offset:8192
    ds_read_b64_tr_b16 a[234:235], v42 offset:9216
    v_mfma_f32_16x16x32_bf16 a[80:83], a[244:247], a[192:195], a[80:83]
    ds_read_b64_tr_b16 a[236:237], v43 offset:8192
    ds_read_b64_tr_b16 a[238:239], v43 offset:9216
    v_mfma_f32_16x16x32_bf16 a[84:87], a[244:247], a[196:199], a[84:87]
    v_mfma_f32_16x16x32_bf16 a[68:71], a[240:243], a[196:199], a[68:71]
    v_mfma_f32_16x16x32_bf16 a[72:75], a[240:243], a[200:203], a[72:75]
    v_mfma_f32_16x16x32_bf16 a[88:91], a[244:247], a[200:203], a[88:91]
    v_mfma_f32_16x16x32_bf16 a[92:95], a[244:247], a[204:207], a[92:95]
    v_mfma_f32_16x16x32_bf16 a[76:79], a[240:243], a[204:207], a[76:79]
    v_mfma_f32_16x16x32_bf16 a[108:111], a[248:251], a[204:207], a[108:111]
    ds_read_b64_tr_b16 a[240:241], v44 offset:8192
    ds_read_b64_tr_b16 a[242:243], v44 offset:9216
    v_mfma_f32_16x16x32_bf16 a[124:127], a[252:255], a[204:207], a[124:127]
    ds_read_b64_tr_b16 a[244:245], v45 offset:8192
    ds_read_b64_tr_b16 a[246:247], v45 offset:9216
    v_mfma_f32_16x16x32_bf16 a[120:123], a[252:255], a[200:203], a[120:123]
    v_mfma_f32_16x16x32_bf16 a[104:107], a[248:251], a[200:203], a[104:107]
    v_mfma_f32_16x16x32_bf16 a[100:103], a[248:251], a[196:199], a[100:103]
    s_mov_b32 s96, 37888
    buffer_store_dwordx4 v[148:151], v30, s[44:47], s96 offen offset:1024 sc1
    v_mfma_f32_16x16x32_bf16 a[116:119], a[252:255], a[196:199], a[116:119]
    v_mfma_f32_16x16x32_bf16 a[112:115], a[252:255], a[192:195], a[112:115]
    v_mfma_f32_16x16x32_bf16 a[96:99], a[248:251], a[192:195], a[96:99]
    s_waitcnt vmcnt(21)
    v_mfma_f32_16x16x32_bf16 a[0:3], a[224:227], a[208:211], a[0:3]
    ds_read_b64_tr_b16 a[248:249], v46 offset:8192
    ds_read_b64_tr_b16 a[250:251], v46 offset:9216
    v_mfma_f32_16x16x32_bf16 a[16:19], a[228:231], a[208:211], a[16:19]
    s_waitcnt vmcnt(20)
    ds_read_b64_tr_b16 a[252:253], v47 offset:8192
    ds_read_b64_tr_b16 a[254:255], v47 offset:9216
    v_mfma_f32_16x16x32_bf16 a[20:23], a[228:231], a[212:215], a[20:23]
    v_mfma_f32_16x16x32_bf16 a[4:7], a[224:227], a[212:215], a[4:7]
    s_waitcnt vmcnt(19)
    buffer_load_dwordx4 a[192:195], v32, s[72:75], s84 offen offset:2048 sc1
    v_mfma_f32_16x16x32_bf16 a[8:11], a[224:227], a[216:219], a[8:11]
    v_mfma_f32_16x16x32_bf16 a[24:27], a[228:231], a[216:219], a[24:27]
    s_waitcnt vmcnt(19)
    v_mfma_f32_16x16x32_bf16 a[28:31], a[228:231], a[220:223], a[28:31]
    v_mfma_f32_16x16x32_bf16 a[12:15], a[224:227], a[220:223], a[12:15]
    s_waitcnt vmcnt(24) lgkmcnt(0)
    buffer_load_dwordx4 a[196:199], v32, s[72:75], s85 offen offset:2048 sc1
    v_mfma_f32_16x16x32_bf16 a[44:47], a[232:235], a[220:223], a[44:47]
    s_barrier
    ds_read_b64_tr_b16 a[224:225], v40 offset:32768
    ds_read_b64_tr_b16 a[226:227], v40 offset:33792
    v_mfma_f32_16x16x32_bf16 a[60:63], a[236:239], a[220:223], a[60:63]
    ds_read_b64_tr_b16 a[228:229], v41 offset:32768
    ds_read_b64_tr_b16 a[230:231], v41 offset:33792
    v_mfma_f32_16x16x32_bf16 a[56:59], a[236:239], a[216:219], a[56:59]
    v_mfma_f32_16x16x32_bf16 a[40:43], a[232:235], a[216:219], a[40:43]
    buffer_load_dwordx4 a[200:203], v32, s[72:75], s86 offen offset:2048 sc1
    v_mfma_f32_16x16x32_bf16 a[36:39], a[232:235], a[212:215], a[36:39]
    s_mov_b32 s96, 41984
    buffer_store_dwordx4 v[152:155], v30, s[44:47], s96 offen offset:1024 sc1
    v_mfma_f32_16x16x32_bf16 a[52:55], a[236:239], a[212:215], a[52:55]
    v_mfma_f32_16x16x32_bf16 a[48:51], a[236:239], a[208:211], a[48:51]
    v_mfma_f32_16x16x32_bf16 a[32:35], a[232:235], a[208:211], a[32:35]
    buffer_load_dwordx4 a[204:207], v32, s[72:75], s87 offen offset:2048 sc1
    v_mfma_f32_16x16x32_bf16 a[64:67], a[240:243], a[208:211], a[64:67]
    ds_read_b64_tr_b16 a[232:233], v42 offset:32768
    ds_read_b64_tr_b16 a[234:235], v42 offset:33792
    v_mfma_f32_16x16x32_bf16 a[80:83], a[244:247], a[208:211], a[80:83]
    ds_read_b64_tr_b16 a[236:237], v43 offset:32768
    ds_read_b64_tr_b16 a[238:239], v43 offset:33792
    v_mfma_f32_16x16x32_bf16 a[84:87], a[244:247], a[212:215], a[84:87]
    v_mfma_f32_16x16x32_bf16 a[68:71], a[240:243], a[212:215], a[68:71]
    v_mfma_f32_16x16x32_bf16 a[72:75], a[240:243], a[216:219], a[72:75]
    v_mfma_f32_16x16x32_bf16 a[88:91], a[244:247], a[216:219], a[88:91]
    v_mfma_f32_16x16x32_bf16 a[92:95], a[244:247], a[220:223], a[92:95]
    v_mfma_f32_16x16x32_bf16 a[76:79], a[240:243], a[220:223], a[76:79]
    v_mfma_f32_16x16x32_bf16 a[108:111], a[248:251], a[220:223], a[108:111]
    ds_read_b64_tr_b16 a[240:241], v44 offset:32768
    ds_read_b64_tr_b16 a[242:243], v44 offset:33792
    v_mfma_f32_16x16x32_bf16 a[124:127], a[252:255], a[220:223], a[124:127]
    ds_read_b64_tr_b16 a[244:245], v45 offset:32768
    ds_read_b64_tr_b16 a[246:247], v45 offset:33792
    v_mfma_f32_16x16x32_bf16 a[120:123], a[252:255], a[216:219], a[120:123]
    v_mfma_f32_16x16x32_bf16 a[104:107], a[248:251], a[216:219], a[104:107]
    v_mfma_f32_16x16x32_bf16 a[100:103], a[248:251], a[212:215], a[100:103]
    s_mov_b32 s96, 46080
    buffer_store_dwordx4 v[156:159], v30, s[44:47], s96 offen offset:1024 sc1
    v_mfma_f32_16x16x32_bf16 a[116:119], a[252:255], a[212:215], a[116:119]
    v_mfma_f32_16x16x32_bf16 a[112:115], a[252:255], a[208:211], a[112:115]
    v_mfma_f32_16x16x32_bf16 a[96:99], a[248:251], a[208:211], a[96:99]
    s_waitcnt lgkmcnt(2) vmcnt(21)
    v_mfma_f32_16x16x32_bf16 a[0:3], a[224:227], a[160:163], a[0:3]
    ds_read_b64_tr_b16 a[248:249], v46 offset:32768
    ds_read_b64_tr_b16 a[250:251], v46 offset:33792
    v_mfma_f32_16x16x32_bf16 a[16:19], a[228:231], a[160:163], a[16:19]
    s_waitcnt vmcnt(20)
    ds_read_b64_tr_b16 a[252:253], v47 offset:32768
    ds_read_b64_tr_b16 a[254:255], v47 offset:33792
    v_mfma_f32_16x16x32_bf16 a[20:23], a[228:231], a[164:167], a[20:23]
    v_mfma_f32_16x16x32_bf16 a[4:7], a[224:227], a[164:167], a[4:7]
    s_waitcnt vmcnt(19)
    buffer_load_dwordx4 a[208:211], v32, s[72:75], s84 offen offset:3072 sc1
    v_mfma_f32_16x16x32_bf16 a[8:11], a[224:227], a[168:171], a[8:11]
    v_mfma_f32_16x16x32_bf16 a[24:27], a[228:231], a[168:171], a[24:27]
    s_waitcnt vmcnt(17)
    v_mfma_f32_16x16x32_bf16 a[28:31], a[228:231], a[172:175], a[28:31]
    v_mfma_f32_16x16x32_bf16 a[12:15], a[224:227], a[172:175], a[12:15]
    buffer_load_dwordx4 a[212:215], v32, s[72:75], s85 offen offset:3072 sc1
    v_mfma_f32_16x16x32_bf16 a[44:47], a[232:235], a[172:175], a[44:47]
    ds_read_b64_tr_b16 a[224:225], v40 offset:40960
    ds_read_b64_tr_b16 a[226:227], v40 offset:41984
    v_mfma_f32_16x16x32_bf16 a[60:63], a[236:239], a[172:175], a[60:63]
    ds_read_b64_tr_b16 a[228:229], v41 offset:40960
    ds_read_b64_tr_b16 a[230:231], v41 offset:41984
    v_mfma_f32_16x16x32_bf16 a[56:59], a[236:239], a[168:171], a[56:59]
    v_mfma_f32_16x16x32_bf16 a[40:43], a[232:235], a[168:171], a[40:43]
    buffer_load_dwordx4 a[216:219], v32, s[72:75], s86 offen offset:3072 sc1
    v_mfma_f32_16x16x32_bf16 a[36:39], a[232:235], a[164:167], a[36:39]
    v_mfma_f32_16x16x32_bf16 a[52:55], a[236:239], a[164:167], a[52:55]
    v_mfma_f32_16x16x32_bf16 a[48:51], a[236:239], a[160:163], a[48:51]
    v_mfma_f32_16x16x32_bf16 a[32:35], a[232:235], a[160:163], a[32:35]
    buffer_load_dwordx4 a[220:223], v32, s[72:75], s87 offen offset:3072 sc1
    v_mfma_f32_16x16x32_bf16 a[64:67], a[240:243], a[160:163], a[64:67]
    s_waitcnt lgkmcnt(0)
    ds_read_b64_tr_b16 a[232:233], v42 offset:40960
    ds_read_b64_tr_b16 a[234:235], v42 offset:41984
    v_mfma_f32_16x16x32_bf16 a[80:83], a[244:247], a[160:163], a[80:83]
    ds_read_b64_tr_b16 a[236:237], v43 offset:40960
    ds_read_b64_tr_b16 a[238:239], v43 offset:41984
    v_mfma_f32_16x16x32_bf16 a[84:87], a[244:247], a[164:167], a[84:87]
    v_mfma_f32_16x16x32_bf16 a[68:71], a[240:243], a[164:167], a[68:71]
    v_mfma_f32_16x16x32_bf16 a[72:75], a[240:243], a[168:171], a[72:75]
    v_mfma_f32_16x16x32_bf16 a[88:91], a[244:247], a[168:171], a[88:91]
    v_mfma_f32_16x16x32_bf16 a[92:95], a[244:247], a[172:175], a[92:95]
    v_mfma_f32_16x16x32_bf16 a[76:79], a[240:243], a[172:175], a[76:79]
    v_mfma_f32_16x16x32_bf16 a[108:111], a[248:251], a[172:175], a[108:111]
    ds_read_b64_tr_b16 a[240:241], v44 offset:40960
    ds_read_b64_tr_b16 a[242:243], v44 offset:41984
    v_mfma_f32_16x16x32_bf16 a[124:127], a[252:255], a[172:175], a[124:127]
    ds_read_b64_tr_b16 a[244:245], v45 offset:40960
    ds_read_b64_tr_b16 a[246:247], v45 offset:41984
    v_mfma_f32_16x16x32_bf16 a[120:123], a[252:255], a[168:171], a[120:123]
    v_mfma_f32_16x16x32_bf16 a[104:107], a[248:251], a[168:171], a[104:107]
    v_mfma_f32_16x16x32_bf16 a[100:103], a[248:251], a[164:167], a[100:103]
    v_mfma_f32_16x16x32_bf16 a[116:119], a[252:255], a[164:167], a[116:119]
    v_mfma_f32_16x16x32_bf16 a[112:115], a[252:255], a[160:163], a[112:115]
    v_mfma_f32_16x16x32_bf16 a[96:99], a[248:251], a[160:163], a[96:99]
    s_waitcnt vmcnt(15)
    v_mfma_f32_16x16x32_bf16 a[0:3], a[224:227], a[176:179], a[0:3]
    ds_read_b64_tr_b16 a[248:249], v46 offset:40960
    ds_read_b64_tr_b16 a[250:251], v46 offset:41984
    v_mfma_f32_16x16x32_bf16 a[16:19], a[228:231], a[176:179], a[16:19]
    s_waitcnt vmcnt(14)
    ds_read_b64_tr_b16 a[252:253], v47 offset:40960
    ds_read_b64_tr_b16 a[254:255], v47 offset:41984
    v_mfma_f32_16x16x32_bf16 a[20:23], a[228:231], a[180:183], a[20:23]
    v_mfma_f32_16x16x32_bf16 a[4:7], a[224:227], a[180:183], a[4:7]
    s_waitcnt vmcnt(13)
    v_mfma_f32_16x16x32_bf16 a[8:11], a[224:227], a[184:187], a[8:11]
    v_mfma_f32_16x16x32_bf16 a[24:27], a[228:231], a[184:187], a[24:27]
    s_waitcnt vmcnt(11)
    v_mfma_f32_16x16x32_bf16 a[28:31], a[228:231], a[188:191], a[28:31]
    v_mfma_f32_16x16x32_bf16 a[12:15], a[224:227], a[188:191], a[12:15]
    s_waitcnt vmcnt(17) lgkmcnt(0)
    v_mfma_f32_16x16x32_bf16 a[44:47], a[232:235], a[188:191], a[44:47]
    s_barrier
    ds_read_b64_tr_b16 a[224:225], v52 offset:0
    ds_read_b64_tr_b16 a[226:227], v52 offset:1024
    v_mfma_f32_16x16x32_bf16 a[60:63], a[236:239], a[188:191], a[60:63]
    ds_read_b64_tr_b16 a[228:229], v53 offset:0
    ds_read_b64_tr_b16 a[230:231], v53 offset:1024
    v_mfma_f32_16x16x32_bf16 a[56:59], a[236:239], a[184:187], a[56:59]
    v_mfma_f32_16x16x32_bf16 a[40:43], a[232:235], a[184:187], a[40:43]
    v_mfma_f32_16x16x32_bf16 a[36:39], a[232:235], a[180:183], a[36:39]
    v_mfma_f32_16x16x32_bf16 a[52:55], a[236:239], a[180:183], a[52:55]
    v_mfma_f32_16x16x32_bf16 a[48:51], a[236:239], a[176:179], a[48:51]
    v_mfma_f32_16x16x32_bf16 a[32:35], a[232:235], a[176:179], a[32:35]
    v_mfma_f32_16x16x32_bf16 a[64:67], a[240:243], a[176:179], a[64:67]
    ds_read_b64_tr_b16 a[232:233], v54 offset:0
    ds_read_b64_tr_b16 a[234:235], v54 offset:1024
    v_mfma_f32_16x16x32_bf16 a[80:83], a[244:247], a[176:179], a[80:83]
    ds_read_b64_tr_b16 a[236:237], v55 offset:0
    ds_read_b64_tr_b16 a[238:239], v55 offset:1024
    v_mfma_f32_16x16x32_bf16 a[84:87], a[244:247], a[180:183], a[84:87]
    v_mfma_f32_16x16x32_bf16 a[68:71], a[240:243], a[180:183], a[68:71]
    v_mfma_f32_16x16x32_bf16 a[72:75], a[240:243], a[184:187], a[72:75]
    v_mfma_f32_16x16x32_bf16 a[88:91], a[244:247], a[184:187], a[88:91]
    v_mfma_f32_16x16x32_bf16 a[92:95], a[244:247], a[188:191], a[92:95]
    v_mfma_f32_16x16x32_bf16 a[76:79], a[240:243], a[188:191], a[76:79]
    v_mfma_f32_16x16x32_bf16 a[108:111], a[248:251], a[188:191], a[108:111]
    ds_read_b64_tr_b16 a[240:241], v56 offset:0
    ds_read_b64_tr_b16 a[242:243], v56 offset:1024
    v_mfma_f32_16x16x32_bf16 a[124:127], a[252:255], a[188:191], a[124:127]
    ds_read_b64_tr_b16 a[244:245], v57 offset:0
    ds_read_b64_tr_b16 a[246:247], v57 offset:1024
    v_mfma_f32_16x16x32_bf16 a[120:123], a[252:255], a[184:187], a[120:123]
    v_mfma_f32_16x16x32_bf16 a[104:107], a[248:251], a[184:187], a[104:107]
    v_mfma_f32_16x16x32_bf16 a[100:103], a[248:251], a[180:183], a[100:103]
    v_mfma_f32_16x16x32_bf16 a[116:119], a[252:255], a[180:183], a[116:119]
    v_mfma_f32_16x16x32_bf16 a[112:115], a[252:255], a[176:179], a[112:115]
    v_mfma_f32_16x16x32_bf16 a[96:99], a[248:251], a[176:179], a[96:99]
    s_waitcnt lgkmcnt(2) vmcnt(9)
    v_mfma_f32_16x16x32_bf16 a[0:3], a[224:227], a[192:195], a[0:3]
    ds_read_b64_tr_b16 a[248:249], v58 offset:0
    ds_read_b64_tr_b16 a[250:251], v58 offset:1024
    v_mfma_f32_16x16x32_bf16 a[16:19], a[228:231], a[192:195], a[16:19]
    s_waitcnt vmcnt(8)
    ds_read_b64_tr_b16 a[252:253], v59 offset:0
    ds_read_b64_tr_b16 a[254:255], v59 offset:1024
    v_mfma_f32_16x16x32_bf16 a[20:23], a[228:231], a[196:199], a[20:23]
    v_mfma_f32_16x16x32_bf16 a[4:7], a[224:227], a[196:199], a[4:7]
    s_waitcnt vmcnt(7)
    v_mfma_f32_16x16x32_bf16 a[8:11], a[224:227], a[200:203], a[8:11]
    v_mfma_f32_16x16x32_bf16 a[24:27], a[228:231], a[200:203], a[24:27]
    s_waitcnt vmcnt(5)
    v_mfma_f32_16x16x32_bf16 a[28:31], a[228:231], a[204:207], a[28:31]
    v_mfma_f32_16x16x32_bf16 a[12:15], a[224:227], a[204:207], a[12:15]
    v_mfma_f32_16x16x32_bf16 a[44:47], a[232:235], a[204:207], a[44:47]
    ds_read_b64_tr_b16 a[224:225], v52 offset:8192
    ds_read_b64_tr_b16 a[226:227], v52 offset:9216
    v_mfma_f32_16x16x32_bf16 a[60:63], a[236:239], a[204:207], a[60:63]
    ds_read_b64_tr_b16 a[228:229], v53 offset:8192
    ds_read_b64_tr_b16 a[230:231], v53 offset:9216
    v_mfma_f32_16x16x32_bf16 a[56:59], a[236:239], a[200:203], a[56:59]
    v_mfma_f32_16x16x32_bf16 a[40:43], a[232:235], a[200:203], a[40:43]
    v_mfma_f32_16x16x32_bf16 a[36:39], a[232:235], a[196:199], a[36:39]
    v_mfma_f32_16x16x32_bf16 a[52:55], a[236:239], a[196:199], a[52:55]
    v_mfma_f32_16x16x32_bf16 a[48:51], a[236:239], a[192:195], a[48:51]
    v_mfma_f32_16x16x32_bf16 a[32:35], a[232:235], a[192:195], a[32:35]
    v_mfma_f32_16x16x32_bf16 a[64:67], a[240:243], a[192:195], a[64:67]
    s_waitcnt lgkmcnt(0)
    ds_read_b64_tr_b16 a[232:233], v54 offset:8192
    ds_read_b64_tr_b16 a[234:235], v54 offset:9216
    v_mfma_f32_16x16x32_bf16 a[80:83], a[244:247], a[192:195], a[80:83]
    ds_read_b64_tr_b16 a[236:237], v55 offset:8192
    ds_read_b64_tr_b16 a[238:239], v55 offset:9216
    v_mfma_f32_16x16x32_bf16 a[84:87], a[244:247], a[196:199], a[84:87]
    v_mfma_f32_16x16x32_bf16 a[68:71], a[240:243], a[196:199], a[68:71]
    v_mfma_f32_16x16x32_bf16 a[72:75], a[240:243], a[200:203], a[72:75]
    v_mfma_f32_16x16x32_bf16 a[88:91], a[244:247], a[200:203], a[88:91]
    v_mfma_f32_16x16x32_bf16 a[92:95], a[244:247], a[204:207], a[92:95]
    v_mfma_f32_16x16x32_bf16 a[76:79], a[240:243], a[204:207], a[76:79]
    v_mfma_f32_16x16x32_bf16 a[108:111], a[248:251], a[204:207], a[108:111]
    ds_read_b64_tr_b16 a[240:241], v56 offset:8192
    ds_read_b64_tr_b16 a[242:243], v56 offset:9216
    v_mfma_f32_16x16x32_bf16 a[124:127], a[252:255], a[204:207], a[124:127]
    ds_read_b64_tr_b16 a[244:245], v57 offset:8192
    ds_read_b64_tr_b16 a[246:247], v57 offset:9216
    v_mfma_f32_16x16x32_bf16 a[120:123], a[252:255], a[200:203], a[120:123]
    v_mfma_f32_16x16x32_bf16 a[104:107], a[248:251], a[200:203], a[104:107]
    v_mfma_f32_16x16x32_bf16 a[100:103], a[248:251], a[196:199], a[100:103]
    v_mfma_f32_16x16x32_bf16 a[116:119], a[252:255], a[196:199], a[116:119]
    v_mfma_f32_16x16x32_bf16 a[112:115], a[252:255], a[192:195], a[112:115]
    v_mfma_f32_16x16x32_bf16 a[96:99], a[248:251], a[192:195], a[96:99]
    s_waitcnt vmcnt(3)
    v_mfma_f32_16x16x32_bf16 a[0:3], a[224:227], a[208:211], a[0:3]
    ds_read_b64_tr_b16 a[248:249], v58 offset:8192
    ds_read_b64_tr_b16 a[250:251], v58 offset:9216
    v_mfma_f32_16x16x32_bf16 a[16:19], a[228:231], a[208:211], a[16:19]
    s_waitcnt vmcnt(2)
    ds_read_b64_tr_b16 a[252:253], v59 offset:8192
    ds_read_b64_tr_b16 a[254:255], v59 offset:9216
    v_mfma_f32_16x16x32_bf16 a[20:23], a[228:231], a[212:215], a[20:23]
    v_mfma_f32_16x16x32_bf16 a[4:7], a[224:227], a[212:215], a[4:7]
    s_waitcnt vmcnt(1)
    v_mfma_f32_16x16x32_bf16 a[8:11], a[224:227], a[216:219], a[8:11]
    v_mfma_f32_16x16x32_bf16 a[24:27], a[228:231], a[216:219], a[24:27]
    s_waitcnt vmcnt(0)
    v_mfma_f32_16x16x32_bf16 a[28:31], a[228:231], a[220:223], a[28:31]
    v_mfma_f32_16x16x32_bf16 a[12:15], a[224:227], a[220:223], a[12:15]
    s_waitcnt lgkmcnt(2)
    v_mfma_f32_16x16x32_bf16 a[44:47], a[232:235], a[220:223], a[44:47]
    v_mfma_f32_16x16x32_bf16 a[60:63], a[236:239], a[220:223], a[60:63]
    v_mfma_f32_16x16x32_bf16 a[56:59], a[236:239], a[216:219], a[56:59]
    v_mfma_f32_16x16x32_bf16 a[40:43], a[232:235], a[216:219], a[40:43]
    v_mfma_f32_16x16x32_bf16 a[36:39], a[232:235], a[212:215], a[36:39]
    v_mfma_f32_16x16x32_bf16 a[52:55], a[236:239], a[212:215], a[52:55]
    v_mfma_f32_16x16x32_bf16 a[48:51], a[236:239], a[208:211], a[48:51]
    v_mfma_f32_16x16x32_bf16 a[32:35], a[232:235], a[208:211], a[32:35]
    v_mfma_f32_16x16x32_bf16 a[64:67], a[240:243], a[208:211], a[64:67]
    v_mfma_f32_16x16x32_bf16 a[80:83], a[244:247], a[208:211], a[80:83]
    v_mfma_f32_16x16x32_bf16 a[84:87], a[244:247], a[212:215], a[84:87]
    v_mfma_f32_16x16x32_bf16 a[68:71], a[240:243], a[212:215], a[68:71]
    v_mfma_f32_16x16x32_bf16 a[72:75], a[240:243], a[216:219], a[72:75]
    v_mfma_f32_16x16x32_bf16 a[88:91], a[244:247], a[216:219], a[88:91]
    v_mfma_f32_16x16x32_bf16 a[92:95], a[244:247], a[220:223], a[92:95]
    v_mfma_f32_16x16x32_bf16 a[76:79], a[240:243], a[220:223], a[76:79]
    v_mfma_f32_16x16x32_bf16 a[108:111], a[248:251], a[220:223], a[108:111]
    s_waitcnt lgkmcnt(0)
    v_mfma_f32_16x16x32_bf16 a[124:127], a[252:255], a[220:223], a[124:127]
    v_mfma_f32_16x16x32_bf16 a[120:123], a[252:255], a[216:219], a[120:123]
    v_mfma_f32_16x16x32_bf16 a[104:107], a[248:251], a[216:219], a[104:107]
    v_mfma_f32_16x16x32_bf16 a[100:103], a[248:251], a[212:215], a[100:103]
    v_mfma_f32_16x16x32_bf16 a[116:119], a[252:255], a[212:215], a[116:119]
    v_mfma_f32_16x16x32_bf16 a[112:115], a[252:255], a[208:211], a[112:115]
    v_mfma_f32_16x16x32_bf16 a[96:99], a[248:251], a[208:211], a[96:99]
    s_waitcnt vmcnt(0) lgkmcnt(0)
    s_barrier
    v_mov_b32 v5, 2
    buffer_store_dword v5, v0, s[76:79], 0 offen sc1
    v_lshrrev_b32 v28, 4, v1
    v_lshlrev_b32 v28, 2, v28
    v_and_b32 v29, 15, v1
    v_sub_u32 v28, v29, v28
    v_lshlrev_b32_e64 v29, 4, s30
    v_sub_u32 v30, v28, v29
    v_add_u32 v30, 48, v30
    v_add_u32 v29, v28, v29
    v_subrev_u32 v128, 0, v29
    v_and_b32 v128, 0xff000000, v128
    v_subrev_u32 v129, 1, v29
    v_and_b32 v129, 0xff000000, v129
    v_subrev_u32 v130, 2, v29
    v_and_b32 v130, 0xff000000, v130
    v_subrev_u32 v131, 3, v29
    v_and_b32 v131, 0xff000000, v131
    v_subrev_u32 v132, 16, v29
    v_and_b32 v132, 0xff000000, v132
    v_subrev_u32 v133, 17, v29
    v_and_b32 v133, 0xff000000, v133
    v_subrev_u32 v134, 18, v29
    v_and_b32 v134, 0xff000000, v134
    v_subrev_u32 v135, 19, v29
    v_and_b32 v135, 0xff000000, v135
    v_subrev_u32 v136, 32, v29
    v_and_b32 v136, 0xff000000, v136
    v_subrev_u32 v137, 33, v29
    v_and_b32 v137, 0xff000000, v137
    v_subrev_u32 v138, 34, v29
    v_and_b32 v138, 0xff000000, v138
    v_subrev_u32 v139, 35, v29
    v_and_b32 v139, 0xff000000, v139
    v_subrev_u32 v140, 48, v29
    v_and_b32 v140, 0xff000000, v140
    v_subrev_u32 v141, 49, v29
    v_and_b32 v141, 0xff000000, v141
    v_subrev_u32 v142, 50, v29
    v_and_b32 v142, 0xff000000, v142
    v_subrev_u32 v143, 51, v29
    v_and_b32 v143, 0xff000000, v143
    v_subrev_u32 v144, 0, v30
    v_and_b32 v144, 0xff000000, v144
    v_subrev_u32 v145, 1, v30
    v_and_b32 v145, 0xff000000, v145
    v_subrev_u32 v146, 2, v30
    v_and_b32 v146, 0xff000000, v146
    v_subrev_u32 v147, 3, v30
    v_and_b32 v147, 0xff000000, v147
    v_subrev_u32 v148, 16, v30
    v_and_b32 v148, 0xff000000, v148
    v_subrev_u32 v149, 17, v30
    v_and_b32 v149, 0xff000000, v149
    v_subrev_u32 v150, 18, v30
    v_and_b32 v150, 0xff000000, v150
    v_subrev_u32 v151, 19, v30
    v_and_b32 v151, 0xff000000, v151
    v_subrev_u32 v152, 32, v30
    v_and_b32 v152, 0xff000000, v152
    v_subrev_u32 v153, 33, v30
    v_and_b32 v153, 0xff000000, v153
    v_subrev_u32 v154, 34, v30
    v_and_b32 v154, 0xff000000, v154
    v_subrev_u32 v155, 35, v30
    v_and_b32 v155, 0xff000000, v155
    v_subrev_u32 v156, 48, v30
    v_and_b32 v156, 0xff000000, v156
    v_subrev_u32 v157, 49, v30
    v_and_b32 v157, 0xff000000, v157
    v_subrev_u32 v158, 50, v30
    v_and_b32 v158, 0xff000000, v158
    v_subrev_u32 v159, 51, v30
    v_and_b32 v159, 0xff000000, v159
    v_mov_b32 v24, 0x3f803f80
    v_mov_b32 v25, 0x3f803f80
    v_mov_b32 v26, 0x3f803f80
    v_mov_b32 v27, 0x3f803f80
    v_mov_b32 v8, 0
    v_mov_b32 v9, 0
    v_mov_b32 v10, 0
    v_mov_b32 v11, 0
    v_mov_b32 v12, 0
    v_mov_b32 v13, 0
    v_mov_b32 v14, 0
    v_mov_b32 v15, 0
    v_mov_b32 v16, 0
    v_mov_b32 v17, 0
    v_mov_b32 v18, 0
    v_mov_b32 v19, 0
    v_mov_b32 v20, 0
    v_mov_b32 v21, 0
    v_mov_b32 v22, 0
    v_mov_b32 v23, 0
    v_and_b32 v28, 7, v1
    s_and_b32 s33, s2, 31
    v_lshl_add_u32 v28, v28, 5, s33
    v_lshlrev_b32 v3, 7, v28
    s_lshl_b32 s33, s3, 11
    s_add_u32 s33, s33, 42074112
    s_add_u32 s48, s28, s33
    s_addc_u32 s49, s29, 0
    s_mov_b32 s50, 23930880
    s_mov_b32 s51, 0x00020000
    s_cmp_eq_u32 s3, 27
    s_cselect_b32 s50, s50, 0
    buffer_store_dwordx4 v[8:11], v2, s[48:51], s56 offen offset:0 sc1
    buffer_store_dwordx4 v[8:11], v2, s[48:51], s56 offen offset:1024 sc1
    buffer_store_dwordx4 v[8:11], v2, s[48:51], s57 offen offset:0 sc1
    buffer_store_dwordx4 v[8:11], v2, s[48:51], s57 offen offset:1024 sc1
    buffer_store_dwordx4 v[8:11], v2, s[48:51], s58 offen offset:0 sc1
    buffer_store_dwordx4 v[8:11], v2, s[48:51], s58 offen offset:1024 sc1
    buffer_store_dwordx4 v[8:11], v2, s[48:51], s59 offen offset:0 sc1
    buffer_store_dwordx4 v[8:11], v2, s[48:51], s59 offen offset:1024 sc1
    s_mov_b32 s50, 0
    v_lshlrev_b32 v34, 7, v1
    buffer_load_dword v36, v34, s[16:19], s0 offen
    s_add_u32 s0, s0, 8192
    buffer_load_dword v35, v34, s[16:19], s0 offen
    s_waitcnt vmcnt(0)
    buffer_load_dword v35, v34, s[8:11], s1 offen
    s_add_u32 s1, s1, 8192
    buffer_load_dword v36, v34, s[8:11], s1 offen
    s_add_u32 s1, s1, 8192
    buffer_load_dword v37, v34, s[8:11], s1 offen
    s_add_u32 s1, s1, 8192
    buffer_load_dword v38, v34, s[8:11], s1 offen
    buffer_load_dword v6, v3, s[88:91], 0 offen sc1
    s_waitcnt vmcnt(0)
    v_cmp_gt_u32 vcc, 2, v6
    s_nop 0
    s_cbranch_vccnz SP_kvl
SR_kvl:
    s_and_b32 s67, s31, 7
    s_bitcmp1_b32 s32, 1
    s_cselect_b32 s33, 9, 4
    s_add_u32 s33, s33, s67
    s_and_b32 s34, s33, 3
    s_lshl_b32 s34, s34, 6
    s_and_b32 s33, s33, 12
    s_lshl1_add_u32 s33, s33, s34
    s_and_b32 s34, s2, 32
    s_add_u32 s33, s33, s34
    s_lshr_b32 s34, s32, 2
    s_lshl1_add_u32 s33, s34, s33
    s_add_u32 s0, s33, 1
    s_add_u32 s1, s33, 5
    s_lshr_b32 s33, s32, 1
    s_lshl2_add_u32 s72, s67, s33
    s_cmp_ge_u32 s72, 25
    s_cselect_b32 s33, 25, 20
    s_cselect_b32 s34, 2, 0
    s_cselect_b32 s35, 16, 0
    s_sub_u32 s68, s72, s33
    s_bfe_u32 s33, s31, 0x10003
    s_lshl2_add_u32 s34, s33, s34
    s_and_b32 s33, s32, 1
    s_add_u32 s69, s33, s34
    s_mul_i32 s33, s68, 11
    s_lshr_b32 s33, s33, 3
    s_lshl2_add_u32 s33, s33, s35
    s_mov_b32 s74, 0x6543210
    s_mov_b32 s75, 0x10654321
    s_lshr_b64 s[74:75], s[74:75], s33
    s_cmp_ge_u32 s72, 30
    s_cselect_b32 s41, 3, 1
    s_bitcmp1_b32 s31, 4
    s_cselect_b32 s72, 7, 0
    s_add_u32 s73, s72, 32
    s_mov_b32 s34, 0x76543210
    s_bitcmp1_b32 s32, 1
    s_cmov_b32 s34, 0x32147650
    s_mul_i32 s33, s67, 0x11111111
    s_xor_b32 s33, s33, s34
    s_and_b32 s34, s31, 24
    s_cmp_lt_u32 s67, 5
    s_cselect_b32 s41, 0, s41
    s_cselect_b32 s68, s67, s68
    s_cselect_b32 s69, s32, s69
    s_cselect_b32 s40, s33, s74
    s_cselect_b32 s72, s34, s72
    s_cselect_b32 s73, s34, s73
    s_cselect_b32 s67, s31, 0
    s_cselect_b32 s8, s8, s16
    s_cselect_b32 s9, s9, s17
    s_cselect_b32 s10, s10, s18
    s_lshl2_add_u32 s72, s72, s30
    s_mul_i32 s72, s72, 160
    s_add_u32 s72, s72, s68
    s_lshl_b32 s72, s72, 8
    s_sub_u32 s10, s10, s72
    s_add_u32 s8, s8, s72
    s_addc_u32 s9, s9, 0
    s_cmp_eq_u32 s41, 3
    s_cselect_b32 s10, 0, s10
    s_and_b32 s42, s40, 15
    s_lshl_b32 s42, s42, 12
    s_cmp_eq_u32 s41, 1
    s_cselect_b32 s42, s42, 0x40000000
    s_lshl_b32 s33, s69, 5
    v_and_b32 v33, 31, v1
    v_add_lshl_u32 v33, v33, s33, 7
    s_sub_u32 s33, s69, s32
    s_mul_i32 s33, s33, 1507328
    s_lshl_b32 s73, s73, 12
    s_sub_u32 s34, s73, s33
    s_add_u32 s33, s73, s33
    s_mov_b32 s35, s67
    s_add_u32 s72, s56, s33
    s_add_u32 s73, s57, s33
    s_add_u32 s74, s58, s34
    s_add_u32 s75, s59, s34
    s_bitcmp1_b32 s35, 3
    s_cselect_b32 s66, s73, s72
    s_cselect_b32 s67, s72, s73
    s_cselect_b32 s68, s75, s74
    s_cselect_b32 s69, s74, s75
    s_bitcmp1_b32 s35, 4
    s_cselect_b32 s72, s68, s66
    s_cselect_b32 s73, s69, s67
    s_cselect_b32 s74, s66, s68
    s_cselect_b32 s75, s67, s69
    v_lshrrev_b32 v29, 4, v1
    v_lshlrev_b32 v28, 5, v29
    v_xor_b32 v28, v28, v2
    v_lshl_add_u32 v28, v29, 10, v28
    v_xor_b32 v29, 128, v28
    v_add_u32 v29, 4096, v29
    v_add_u32 v30, 8192, v28
    v_add_u32 v31, 8192, v29
    v_lshrrev_b32 v40, 2, v1
    v_and_b32 v41, 31, v1
    v_lshlrev_b32 v41, 3, v41
    v_lshl_add_u32 v40, v40, 8, v41
    s_and_b32 s33, s32, 1
    s_lshl_b32 s62, s33, 16
    v_add_u32 v41, s62, v40
    v_mov_b32 v44, -1
    v_mov_b32 v45, -1
    v_mov_b32 v46, -1
    v_mov_b32 v47, -1
    s_lshl2_add_u32 s63, s2, s30
    s_mul_i32 s63, s63, 16384
    s_mul_i32 s33, s31, 1082368
    s_add_u32 s36, s28, s33
    s_addc_u32 s37, s29, 0
    s_mov_b32 s38, 1081344
    s_mov_b32 s39, 0x00020000
    s_lshl_b32 s33, s30, 12
    s_add_u32 m0, s33, 16384
    s_lshl_b32 s92, s30, 13
    buffer_load_dwordx4 v2, s[36:39], s33 offen offset:0 sc1 lds
    buffer_load_dwordx4 v2, s[36:39], s33 offen offset:1024 sc1 lds
    buffer_load_dwordx4 v2, s[36:39], s33 offen offset:2048 sc1 lds
    buffer_load_dwordx4 v2, s[36:39], s33 offen offset:3072 sc1 lds
    s_add_u32 s93, s92, 32768
    s_add_u32 s92, s92, 17408
    s_add_u32 m0, s93, 0
    s_nop 0
    buffer_load_dwordx4 v2, s[36:39], s92 offen offset:0 sc1 lds
    buffer_load_dwordx4 v2, s[36:39], s92 offen offset:1024 sc1 lds
    buffer_load_dwordx4 v2, s[36:39], s92 offen offset:2048 sc1 lds
    buffer_load_dwordx4 v2, s[36:39], s92 offen offset:3072 sc1 lds
    s_add_u32 m0, s93, 4096
    s_nop 0
    buffer_load_dwordx4 v4, s[36:39], s92 offen offset:0 sc1 lds
    buffer_load_dwordx4 v4, s[36:39], s92 offen offset:1024 sc1 lds
    buffer_load_dwordx4 v4, s[36:39], s92 offen offset:2048 sc1 lds
    buffer_load_dwordx4 v4, s[36:39], s92 offen offset:3072 sc1 lds
    s_add_u32 s92, s92, 33792
    s_add_u32 s93, s93, 32768
    s_and_b32 s93, s93, 0x1ffff
    s_add_u32 m0, s93, 0
    s_nop 0
    buffer_load_dwordx4 v2, s[36:39], s92 offen offset:0 sc1 lds
    buffer_load_dwordx4 v2, s[36:39], s92 offen offset:1024 sc1 lds
    buffer_load_dwordx4 v2, s[36:39], s92 offen offset:2048 sc1 lds
    buffer_load_dwordx4 v2, s[36:39], s92 offen offset:3072 sc1 lds
    s_add_u32 m0, s93, 4096
    s_nop 0
    buffer_load_dwordx4 v4, s[36:39], s92 offen offset:0 sc1 lds
    buffer_load_dwordx4 v4, s[36:39], s92 offen offset:1024 sc1 lds
    buffer_load_dwordx4 v4, s[36:39], s92 offen offset:2048 sc1 lds
    buffer_load_dwordx4 v4, s[36:39], s92 offen offset:3072 sc1 lds
    s_add_u32 s92, s92, 33792
    s_add_u32 s93, s93, 32768
    s_and_b32 s93, s93, 0x1ffff
    s_branch QG_epi
AT_p0:
    v_mfma_f32_16x16x32_bf16 v[160:163], a[128:131], v[64:67], v[128:131]
    v_accvgpr_write_b32 a32, 0
    v_accvgpr_write_b32 a33, 0
    v_mfma_f32_16x16x32_bf16 v[164:167], a[128:131], v[68:71], 0
    v_accvgpr_write_b32 a34, 0
    v_accvgpr_write_b32 a35, 0
    v_mfma_f32_16x16x32_bf16 v[160:163], a[132:135], v[80:83], v[160:163]
    v_accvgpr_write_b32 a36, 0
    v_accvgpr_write_b32 a37, 0
    v_mfma_f32_16x16x32_bf16 v[164:167], a[132:135], v[84:87], v[164:167]
    v_accvgpr_write_b32 a38, 0
    v_accvgpr_write_b32 a39, 0
    v_mfma_f32_16x16x32_bf16 v[160:163], a[136:139], v[96:99], v[160:163]
    v_accvgpr_write_b32 a40, 0
    v_accvgpr_write_b32 a41, 0
    v_mfma_f32_16x16x32_bf16 v[164:167], a[136:139], v[100:103], v[164:167]
    v_accvgpr_write_b32 a42, 0
    v_accvgpr_write_b32 a43, 0
    v_mfma_f32_16x16x32_bf16 v[160:163], a[140:143], v[112:115], v[160:163]
    v_accvgpr_write_b32 a44, 0
    v_accvgpr_write_b32 a45, 0
    v_mfma_f32_16x16x32_bf16 v[164:167], a[140:143], v[116:119], v[164:167]
    v_accvgpr_write_b32 a46, 0
    v_accvgpr_write_b32 a47, 0
    v_mfma_f32_16x16x32_bf16 v[168:171], a[144:147], v[64:67], v[132:135]
    v_accvgpr_write_b32 a48, 0
    v_accvgpr_write_b32 a49, 0
    v_mfma_f32_16x16x32_bf16 v[172:175], a[144:147], v[68:71], 0
    v_accvgpr_write_b32 a50, 0
    v_accvgpr_write_b32 a51, 0
    v_mfma_f32_16x16x32_bf16 v[168:171], a[148:151], v[80:83], v[168:171]
    v_accvgpr_write_b32 a52, 0
    v_accvgpr_write_b32 a53, 0
    v_mfma_f32_16x16x32_bf16 v[172:175], a[148:151], v[84:87], v[172:175]
    v_accvgpr_write_b32 a54, 0
    v_accvgpr_write_b32 a55, 0
    v_mfma_f32_16x16x32_bf16 v[168:171], a[152:155], v[96:99], v[168:171]
    v_accvgpr_write_b32 a56, 0
    v_accvgpr_write_b32 a57, 0
    v_mfma_f32_16x16x32_bf16 v[172:175], a[152:155], v[100:103], v[172:175]
    v_accvgpr_write_b32 a58, 0
    v_accvgpr_write_b32 a59, 0
    v_mfma_f32_16x16x32_bf16 v[168:171], a[156:159], v[112:115], v[168:171]
    v_accvgpr_write_b32 a60, 0
    v_accvgpr_write_b32 a61, 0
    v_mfma_f32_16x16x32_bf16 v[172:175], a[156:159], v[116:119], v[172:175]
    v_accvgpr_write_b32 a62, 0
    v_accvgpr_write_b32 a63, 0
    v_mfma_f32_16x16x32_bf16 v[176:179], a[128:131], v[72:75], 0
    v_accvgpr_write_b32 a64, 0
    v_accvgpr_write_b32 a65, 0
    v_mfma_f32_16x16x32_bf16 v[180:183], a[128:131], v[76:79], 0
    v_accvgpr_write_b32 a66, 0
    v_accvgpr_write_b32 a67, 0
    v_mfma_f32_16x16x32_bf16 v[176:179], a[132:135], v[88:91], v[176:179]
    v_accvgpr_write_b32 a68, 0
    v_accvgpr_write_b32 a69, 0
    v_mfma_f32_16x16x32_bf16 v[180:183], a[132:135], v[92:95], v[180:183]
    v_accvgpr_write_b32 a70, 0
    v_accvgpr_write_b32 a71, 0
    v_mfma_f32_16x16x32_bf16 v[176:179], a[136:139], v[104:107], v[176:179]
    v_accvgpr_write_b32 a72, 0
    v_accvgpr_write_b32 a73, 0
    v_mfma_f32_16x16x32_bf16 v[180:183], a[136:139], v[108:111], v[180:183]
    v_accvgpr_write_b32 a74, 0
    v_accvgpr_write_b32 a75, 0
    v_mfma_f32_16x16x32_bf16 v[176:179], a[140:143], v[120:123], v[176:179]
    v_accvgpr_write_b32 a76, 0
    v_accvgpr_write_b32 a77, 0
    v_mfma_f32_16x16x32_bf16 v[180:183], a[140:143], v[124:127], v[180:183]
    v_accvgpr_write_b32 a78, 0
    v_accvgpr_write_b32 a79, 0
    v_mfma_f32_16x16x32_bf16 v[184:187], a[144:147], v[72:75], 0
    v_accvgpr_write_b32 a80, 0
    v_accvgpr_write_b32 a81, 0
    v_mfma_f32_16x16x32_bf16 v[188:191], a[144:147], v[76:79], 0
    v_accvgpr_write_b32 a82, 0
    v_accvgpr_write_b32 a83, 0
    v_mfma_f32_16x16x32_bf16 v[184:187], a[148:151], v[88:91], v[184:187]
    v_accvgpr_write_b32 a84, 0
    v_accvgpr_write_b32 a85, 0
    v_mfma_f32_16x16x32_bf16 v[188:191], a[148:151], v[92:95], v[188:191]
    v_accvgpr_write_b32 a86, 0
    v_accvgpr_write_b32 a87, 0
    v_mfma_f32_16x16x32_bf16 v[184:187], a[152:155], v[104:107], v[184:187]
    v_accvgpr_write_b32 a88, 0
    v_accvgpr_write_b32 a89, 0
    v_mfma_f32_16x16x32_bf16 v[188:191], a[152:155], v[108:111], v[188:191]
    v_accvgpr_write_b32 a90, 0
    v_accvgpr_write_b32 a91, 0
    v_mfma_f32_16x16x32_bf16 v[184:187], a[156:159], v[120:123], v[184:187]
    v_accvgpr_write_b32 a92, 0
    v_accvgpr_write_b32 a93, 0
    v_mfma_f32_16x16x32_bf16 v[188:191], a[156:159], v[124:127], v[188:191]
    s_waitcnt vmcnt(21) lgkmcnt(0)
    v_accvgpr_write_b32 a94, 0
    v_accvgpr_write_b32 a95, 0
    v_mfma_f32_16x16x32_bf16 v[192:195], a[160:163], v[64:67], v[136:139]
    s_barrier
    v_add_u32 v3, s94, v2
    ds_read_b128 a[192:195], v3 offset:0
    ds_read_b128 a[196:199], v3 offset:1024
    ds_read_b128 a[200:203], v3 offset:2048
    ds_read_b128 a[204:207], v3 offset:3072
    v_mfma_f32_16x16x32_bf16 v[196:199], a[160:163], v[68:71], 0
    s_add_u32 s94, s94, 32768
    ds_read_b128 a[208:211], v3 offset:4096
    ds_read_b128 a[212:215], v3 offset:5120
    v_exp_f32 v160, v160
    v_mfma_f32_16x16x32_bf16 v[192:195], a[164:167], v[80:83], v[192:195]
    s_and_b32 s94, s94, 0x18000
    v_exp_f32 v161, v161
    ds_read_b128 a[216:219], v3 offset:6144
    ds_read_b128 a[220:223], v3 offset:7168
    v_mfma_f32_16x16x32_bf16 v[196:199], a[164:167], v[84:87], v[196:199]
    v_exp_f32 v162, v162
    v_exp_f32 v163, v163
    v_mfma_f32_16x16x32_bf16 v[192:195], a[168:171], v[96:99], v[192:195]
    v_cvt_pk_bf16_f32 v224, v160, v161
    v_cvt_pk_bf16_f32 v225, v162, v163
    ds_read_b128 a[128:131], v3 offset:16384
    ds_read_b128 a[132:135], v3 offset:17408
    v_mfma_f32_16x16x32_bf16 v[196:199], a[168:171], v[100:103], v[196:199]
    ds_read_b128 a[136:139], v3 offset:18432
    ds_read_b128 a[140:143], v3 offset:19456
    v_exp_f32 v164, v164
    v_mfma_f32_16x16x32_bf16 v[192:195], a[172:175], v[112:115], v[192:195]
    s_add_u32 m0, s93, 0
    v_exp_f32 v165, v165
    ds_read_b128 a[144:147], v3 offset:20480
    ds_read_b128 a[148:151], v3 offset:21504
    v_exp_f32 v166, v166
    v_mfma_f32_16x16x32_bf16 v[196:199], a[172:175], v[116:119], v[196:199]
    buffer_load_dwordx4 v2, s[36:39], s92 offen offset:0 sc1 lds
    v_exp_f32 v167, v167
    v_mfma_f32_16x16x32_bf16 v[200:203], a[176:179], v[64:67], v[140:143]
    v_cvt_pk_bf16_f32 v228, v164, v165
    v_cvt_pk_bf16_f32 v229, v166, v167
    ds_read_b128 a[152:155], v3 offset:22528
    ds_read_b128 a[156:159], v3 offset:23552
    v_mfma_f32_16x16x32_bf16 v[204:207], a[176:179], v[68:71], 0
    v_accvgpr_write_b32 a96, 0
    v_accvgpr_write_b32 a97, 0
    v_exp_f32 v168, v168
    v_mfma_f32_16x16x32_bf16 v[200:203], a[180:183], v[80:83], v[200:203]
    v_exp_f32 v169, v169
    v_accvgpr_write_b32 a98, 0
    v_accvgpr_write_b32 a99, 0
    v_mfma_f32_16x16x32_bf16 v[204:207], a[180:183], v[84:87], v[204:207]
    v_exp_f32 v170, v170
    v_exp_f32 v171, v171
    v_mfma_f32_16x16x32_bf16 v[200:203], a[184:187], v[96:99], v[200:203]
    v_cvt_pk_bf16_f32 v226, v168, v169
    v_cvt_pk_bf16_f32 v227, v170, v171
    v_accvgpr_write_b32 a100, 0
    v_accvgpr_write_b32 a101, 0
    v_accvgpr_write_b32 a102, 0
    v_accvgpr_write_b32 a103, 0
    v_mfma_f32_16x16x32_bf16 v[204:207], a[184:187], v[100:103], v[204:207]
    v_exp_f32 v172, v172
    v_exp_f32 v173, v173
    v_mfma_f32_16x16x32_bf16 v[200:203], a[188:191], v[112:115], v[200:203]
    v_accvgpr_write_b32 a104, 0
    v_accvgpr_write_b32 a105, 0
    v_exp_f32 v174, v174
    v_mfma_f32_16x16x32_bf16 v[204:207], a[188:191], v[116:119], v[204:207]
    buffer_load_dwordx4 v2, s[36:39], s92 offen offset:1024 sc1 lds
    v_exp_f32 v175, v175
    v_mfma_f32_16x16x32_bf16 v[208:211], a[160:163], v[72:75], 0
    v_cvt_pk_bf16_f32 v230, v172, v173
    v_cvt_pk_bf16_f32 v231, v174, v175
    v_accvgpr_write_b32 a106, 0
    v_accvgpr_write_b32 a107, 0
    v_mfma_f32_16x16x32_bf16 v[212:215], a[160:163], v[76:79], 0
    v_accvgpr_write_b32 a108, 0
    v_accvgpr_write_b32 a109, 0
    v_exp_f32 v176, v176
    v_mfma_f32_16x16x32_bf16 v[208:211], a[164:167], v[88:91], v[208:211]
    v_exp_f32 v177, v177
    v_accvgpr_write_b32 a110, 0
    v_accvgpr_write_b32 a111, 0
    v_mfma_f32_16x16x32_bf16 v[212:215], a[164:167], v[92:95], v[212:215]
    v_exp_f32 v178, v178
    v_exp_f32 v179, v179
    v_cvt_pk_bf16_f32 v232, v176, v177
    v_cvt_pk_bf16_f32 v233, v178, v179
    v_mfma_f32_16x16x32_bf16 v[208:211], a[168:171], v[104:107], v[208:211]
    v_accvgpr_write_b32 a112, 0
    v_accvgpr_write_b32 a113, 0
    v_accvgpr_write_b32 a114, 0
    v_accvgpr_write_b32 a115, 0
    v_mfma_f32_16x16x32_bf16 v[212:215], a[168:171], v[108:111], v[212:215]
    v_exp_f32 v180, v180
    v_exp_f32 v181, v181
    v_mfma_f32_16x16x32_bf16 v[208:211], a[172:175], v[120:123], v[208:211]
    v_accvgpr_write_b32 a116, 0
    v_accvgpr_write_b32 a117, 0
    v_exp_f32 v182, v182
    v_mfma_f32_16x16x32_bf16 v[212:215], a[172:175], v[124:127], v[212:215]
    buffer_load_dwordx4 v2, s[36:39], s92 offen offset:2048 sc1 lds
    v_exp_f32 v183, v183
    v_mfma_f32_16x16x32_bf16 v[216:219], a[176:179], v[72:75], 0
    v_cvt_pk_bf16_f32 v236, v180, v181
    v_cvt_pk_bf16_f32 v237, v182, v183
    v_accvgpr_write_b32 a118, 0
    v_accvgpr_write_b32 a119, 0
    v_mfma_f32_16x16x32_bf16 v[220:223], a[176:179], v[76:79], 0
    v_accvgpr_write_b32 a120, 0
    v_accvgpr_write_b32 a121, 0
    v_exp_f32 v184, v184
    v_exp_f32 v185, v185
    v_mfma_f32_16x16x32_bf16 v[216:219], a[180:183], v[88:91], v[216:219]
    v_accvgpr_write_b32 a122, 0
    v_accvgpr_write_b32 a123, 0
    v_exp_f32 v186, v186
    v_mfma_f32_16x16x32_bf16 v[220:223], a[180:183], v[92:95], v[220:223]
    v_exp_f32 v187, v187
    v_cvt_pk_bf16_f32 v234, v184, v185
    v_cvt_pk_bf16_f32 v235, v186, v187
    v_mfma_f32_16x16x32_bf16 v[216:219], a[184:187], v[104:107], v[216:219]
    v_accvgpr_write_b32 a124, 0
    v_accvgpr_write_b32 a125, 0
    v_exp_f32 v188, v188
    v_mfma_f32_16x16x32_bf16 v[220:223], a[184:187], v[108:111], v[220:223]
    v_exp_f32 v189, v189
    v_accvgpr_write_b32 a126, 0
    v_accvgpr_write_b32 a127, 0
    v_mfma_f32_16x16x32_bf16 v[216:219], a[188:191], v[120:123], v[216:219]
    v_exp_f32 v190, v190
    v_exp_f32 v191, v191
    v_mfma_f32_16x16x32_bf16 v[220:223], a[188:191], v[124:127], v[220:223]
    buffer_load_dwordx4 v2, s[36:39], s92 offen offset:3072 sc1 lds
    v_cvt_pk_bf16_f32 v238, v188, v189
    v_cvt_pk_bf16_f32 v239, v190, v191
    s_waitcnt lgkmcnt(0)
    s_branch AT_d1
AT_p7:
    v_mfma_f32_16x16x32_bf16 a[32:35], a[192:195], v[228:231], a[32:35]
    ds_read_b128 a[160:163], v3 offset:24576
    ds_read_b128 a[164:167], v3 offset:25600
    v_mfma_f32_16x16x32_bf16 a[36:39], a[196:199], v[228:231], a[36:39]
    v_exp_f32 v196, v196
    v_mfma_f32_16x16x32_bf16 a[40:43], a[200:203], v[228:231], a[40:43]
    v_exp_f32 v197, v197
    v_mfma_f32_16x16x32_bf16 a[44:47], a[204:207], v[228:231], a[44:47]
    ds_read_b128 a[168:171], v3 offset:26624
    ds_read_b128 a[172:175], v3 offset:27648
    v_mfma_f32_16x16x32_bf16 a[48:51], a[208:211], v[228:231], a[48:51]
    v_exp_f32 v198, v198
    v_mfma_f32_16x16x32_bf16 a[52:55], a[212:215], v[228:231], a[52:55]
    v_mfma_f32_16x16x32_bf16 a[56:59], a[216:219], v[228:231], a[56:59]
    v_exp_f32 v199, v199
    v_mfma_f32_16x16x32_bf16 a[60:63], a[220:223], v[228:231], a[60:63]
    buffer_load_dword v34, v33, s[88:91], 0 offen sc1
    v_mfma_f32_16x16x32_bf16 v[12:15], v[24:27], v[228:231], v[12:15]
    v_cvt_pk_bf16_f32 v244, v196, v197
    v_cvt_pk_bf16_f32 v245, v198, v199
    v_mfma_f32_16x16x32_bf16 a[64:67], a[192:195], v[232:235], a[64:67]
    ds_read_b128 a[176:179], v3 offset:28672
    ds_read_b128 a[180:183], v3 offset:29696
    v_mfma_f32_16x16x32_bf16 a[96:99], a[192:195], v[236:239], a[96:99]
    v_mfma_f32_16x16x32_bf16 a[100:103], a[196:199], v[236:239], a[100:103]
    v_exp_f32 v204, v204
    v_mfma_f32_16x16x32_bf16 a[68:71], a[196:199], v[232:235], a[68:71]
    v_exp_f32 v205, v205
    v_mfma_f32_16x16x32_bf16 a[72:75], a[200:203], v[232:235], a[72:75]
    v_exp_f32 v206, v206
    v_mfma_f32_16x16x32_bf16 a[104:107], a[200:203], v[236:239], a[104:107]
    v_exp_f32 v207, v207
    v_mfma_f32_16x16x32_bf16 a[108:111], a[204:207], v[236:239], a[108:111]
    s_add_u32 m0, s84, 32768
    v_mfma_f32_16x16x32_bf16 a[76:79], a[204:207], v[232:235], a[76:79]
    buffer_load_dwordx4 v28, s[8:11], s45 offen offset:0 lds
    v_mfma_f32_16x16x32_bf16 a[80:83], a[208:211], v[232:235], a[80:83]
    buffer_load_dwordx4 v29, s[8:11], s45 offen offset:1024 lds
    v_mfma_f32_16x16x32_bf16 a[112:115], a[208:211], v[236:239], a[112:115]
    v_cvt_pk_bf16_f32 v246, v204, v205
    v_cvt_pk_bf16_f32 v247, v206, v207
    v_mfma_f32_16x16x32_bf16 a[116:119], a[212:215], v[236:239], a[116:119]
    ds_read_b128 a[184:187], v3 offset:30720
    ds_read_b128 a[188:191], v3 offset:31744
    v_mfma_f32_16x16x32_bf16 a[84:87], a[212:215], v[232:235], a[84:87]
    v_exp_f32 v208, v208
    v_mfma_f32_16x16x32_bf16 a[88:91], a[216:219], v[232:235], a[88:91]
    v_mfma_f32_16x16x32_bf16 a[120:123], a[216:219], v[236:239], a[120:123]
    v_exp_f32 v209, v209
    v_mfma_f32_16x16x32_bf16 a[124:127], a[220:223], v[236:239], a[124:127]
    v_exp_f32 v210, v210
    v_mfma_f32_16x16x32_bf16 a[92:95], a[220:223], v[232:235], a[92:95]
    v_exp_f32 v211, v211
    v_mfma_f32_16x16x32_bf16 v[16:19], v[24:27], v[232:235], v[16:19]
    buffer_load_dwordx4 v30, s[8:11], s45 offen offset:2048 lds
    v_mfma_f32_16x16x32_bf16 v[20:23], v[24:27], v[236:239], v[20:23]
    v_mfma_f32_16x16x32_bf16 v[160:163], a[128:131], v[72:75], v[128:131]
    v_cvt_pk_bf16_f32 v248, v208, v209
    v_cvt_pk_bf16_f32 v249, v210, v211
    v_mfma_f32_16x16x32_bf16 v[164:167], a[128:131], v[76:79], 0
    ds_read_b128 a[224:227], v3 offset:8192
    ds_read_b128 a[228:231], v3 offset:9216
    v_mfma_f32_16x16x32_bf16 v[160:163], a[132:135], v[88:91], v[160:163]
    v_exp_f32 v212, v212
    v_mfma_f32_16x16x32_bf16 v[164:167], a[132:135], v[92:95], v[164:167]
    v_exp_f32 v213, v213
    v_mfma_f32_16x16x32_bf16 v[160:163], a[136:139], v[104:107], v[160:163]
    v_mfma_f32_16x16x32_bf16 v[164:167], a[136:139], v[108:111], v[164:167]
    ds_read_b128 a[232:235], v3 offset:10240
    ds_read_b128 a[236:239], v3 offset:11264
    v_mfma_f32_16x16x32_bf16 v[160:163], a[140:143], v[120:123], v[160:163]
    v_exp_f32 v214, v214
    v_mfma_f32_16x16x32_bf16 v[164:167], a[140:143], v[124:127], v[164:167]
    v_exp_f32 v215, v215
    v_mfma_f32_16x16x32_bf16 v[168:171], a[144:147], v[72:75], v[132:135]
    buffer_load_dwordx4 v31, s[8:11], s45 offen offset:3072 lds
    v_mfma_f32_16x16x32_bf16 v[172:175], a[144:147], v[76:79], 0
    s_add_u32 m0, s84, 36864
    v_mfma_f32_16x16x32_bf16 v[168:171], a[148:151], v[88:91], v[168:171]
    s_add_u32 s45, s45, 20480
    buffer_load_dwordx4 v28, s[8:11], s45 offen offset:0 lds
    v_mfma_f32_16x16x32_bf16 v[172:175], a[148:151], v[92:95], v[172:175]
    v_cvt_pk_bf16_f32 v252, v212, v213
    v_cvt_pk_bf16_f32 v253, v214, v215
    v_mfma_f32_16x16x32_bf16 v[168:171], a[152:155], v[104:107], v[168:171]
    ds_read_b128 a[240:243], v3 offset:12288
    ds_read_b128 a[244:247], v3 offset:13312
    v_mfma_f32_16x16x32_bf16 v[172:175], a[152:155], v[108:111], v[172:175]
    v_exp_f32 v216, v216
    v_mfma_f32_16x16x32_bf16 v[168:171], a[156:159], v[120:123], v[168:171]
    v_exp_f32 v217, v217
    v_mfma_f32_16x16x32_bf16 v[172:175], a[156:159], v[124:127], v[172:175]
    s_waitcnt lgkmcnt(2)
    v_mfma_f32_16x16x32_bf16 v[176:179], a[160:163], v[72:75], v[136:139]
    v_exp_f32 v218, v218
    v_mfma_f32_16x16x32_bf16 v[180:183], a[160:163], v[76:79], 0
    v_exp_f32 v219, v219
    v_mfma_f32_16x16x32_bf16 v[176:179], a[164:167], v[88:91], v[176:179]
    buffer_load_dwordx4 v29, s[8:11], s45 offen offset:1024 lds
    v_mfma_f32_16x16x32_bf16 v[180:183], a[164:167], v[92:95], v[180:183]
    v_cvt_pk_bf16_f32 v250, v216, v217
    v_cvt_pk_bf16_f32 v251, v218, v219
    v_mfma_f32_16x16x32_bf16 v[176:179], a[168:171], v[104:107], v[176:179]
    v_mfma_f32_16x16x32_bf16 v[180:183], a[168:171], v[108:111], v[180:183]
    ds_read_b128 a[248:251], v3 offset:14336
    ds_read_b128 a[252:255], v3 offset:15360
    v_mfma_f32_16x16x32_bf16 v[176:179], a[172:175], v[120:123], v[176:179]
    v_exp_f32 v220, v220
    v_mfma_f32_16x16x32_bf16 v[180:183], a[172:175], v[124:127], v[180:183]
    v_exp_f32 v221, v221
    v_mfma_f32_16x16x32_bf16 v[184:187], a[176:179], v[72:75], v[140:143]
    v_exp_f32 v222, v222
    v_mfma_f32_16x16x32_bf16 v[188:191], a[176:179], v[76:79], 0
    v_mfma_f32_16x16x32_bf16 v[184:187], a[180:183], v[88:91], v[184:187]
    v_exp_f32 v223, v223
    v_mfma_f32_16x16x32_bf16 v[188:191], a[180:183], v[92:95], v[188:191]
    buffer_load_dwordx4 v30, s[8:11], s45 offen offset:2048 lds
    v_mfma_f32_16x16x32_bf16 v[184:187], a[184:187], v[104:107], v[184:187]
    buffer_load_dwordx4 v31, s[8:11], s45 offen offset:3072 lds
    v_mfma_f32_16x16x32_bf16 v[188:191], a[184:187], v[108:111], v[188:191]
    v_cvt_pk_bf16_f32 v254, v220, v221
    v_cvt_pk_bf16_f32 v255, v222, v223
    v_mfma_f32_16x16x32_bf16 v[184:187], a[188:191], v[120:123], v[184:187]
    v_mfma_f32_16x16x32_bf16 v[188:191], a[188:191], v[124:127], v[188:191]
    s_waitcnt vmcnt(43) lgkmcnt(0)
    v_mfma_f32_16x16x32_bf16 a[32:35], a[224:227], v[244:247], a[32:35]
    s_barrier
    v_add_u32 v3, s94, v2
    ds_read_b128 a[128:131], v3 offset:16384
    ds_read_b128 a[132:135], v3 offset:17408
    v_mfma_f32_16x16x32_bf16 a[36:39], a[228:231], v[244:247], a[36:39]
    s_add_u32 s94, s94, 32768
    ds_read_b128 a[136:139], v3 offset:18432
    ds_read_b128 a[140:143], v3 offset:19456
    v_exp_f32 v160, v160
    v_mfma_f32_16x16x32_bf16 a[40:43], a[232:235], v[244:247], a[40:43]
    s_and_b32 s94, s94, 0x18000
    v_exp_f32 v161, v161
    v_mfma_f32_16x16x32_bf16 a[44:47], a[236:239], v[244:247], a[44:47]
    ds_read_b128 a[144:147], v3 offset:20480
    ds_read_b128 a[148:151], v3 offset:21504
    v_exp_f32 v162, v162
    v_mfma_f32_16x16x32_bf16 a[48:51], a[240:243], v[244:247], a[48:51]
    s_add_u32 m0, s85, 0
    v_exp_f32 v163, v163
    v_mfma_f32_16x16x32_bf16 a[52:55], a[244:247], v[244:247], a[52:55]
    buffer_load_dwordx4 v28, s[8:11], s46 offen offset:0 lds
    v_cvt_pk_bf16_f32 v224, v160, v161
    v_cvt_pk_bf16_f32 v225, v162, v163
    v_mfma_f32_16x16x32_bf16 a[56:59], a[248:251], v[244:247], a[56:59]
    ds_read_b128 a[152:155], v3 offset:22528
    ds_read_b128 a[156:159], v3 offset:23552
    v_mfma_f32_16x16x32_bf16 a[60:63], a[252:255], v[244:247], a[60:63]
    v_exp_f32 v164, v164
    v_exp_f32 v165, v165
    v_mfma_f32_16x16x32_bf16 v[12:15], v[24:27], v[244:247], v[12:15]
    ds_read_b128 a[160:163], v3 offset:24576
    ds_read_b128 a[164:167], v3 offset:25600
    v_mfma_f32_16x16x32_bf16 a[64:67], a[224:227], v[248:251], a[64:67]
    v_exp_f32 v166, v166
    v_exp_f32 v167, v167
    v_mfma_f32_16x16x32_bf16 a[96:99], a[224:227], v[252:255], a[96:99]
    buffer_load_dwordx4 v29, s[8:11], s46 offen offset:1024 lds
    v_mfma_f32_16x16x32_bf16 a[100:103], a[228:231], v[252:255], a[100:103]
    v_cvt_pk_bf16_f32 v228, v164, v165
    v_cvt_pk_bf16_f32 v229, v166, v167
    ds_read_b128 a[168:171], v3 offset:26624
    ds_read_b128 a[172:175], v3 offset:27648
    v_mfma_f32_16x16x32_bf16 a[68:71], a[228:231], v[248:251], a[68:71]
    v_exp_f32 v168, v168
    v_mfma_f32_16x16x32_bf16 a[72:75], a[232:235], v[248:251], a[72:75]
    v_exp_f32 v169, v169
    ds_read_b128 a[176:179], v3 offset:28672
    ds_read_b128 a[180:183], v3 offset:29696
    v_mfma_f32_16x16x32_bf16 a[104:107], a[232:235], v[252:255], a[104:107]
    v_exp_f32 v170, v170
    v_mfma_f32_16x16x32_bf16 a[108:111], a[236:239], v[252:255], a[108:111]
    buffer_load_dwordx4 v30, s[8:11], s46 offen offset:2048 lds
    v_exp_f32 v171, v171
    v_mfma_f32_16x16x32_bf16 a[76:79], a[236:239], v[248:251], a[76:79]
    v_cvt_pk_bf16_f32 v226, v168, v169
    v_cvt_pk_bf16_f32 v227, v170, v171
    v_mfma_f32_16x16x32_bf16 a[80:83], a[240:243], v[248:251], a[80:83]
    ds_read_b128 a[184:187], v3 offset:30720
    ds_read_b128 a[188:191], v3 offset:31744
    v_exp_f32 v172, v172
    v_mfma_f32_16x16x32_bf16 a[112:115], a[240:243], v[252:255], a[112:115]
    v_exp_f32 v173, v173
    v_mfma_f32_16x16x32_bf16 a[116:119], a[244:247], v[252:255], a[116:119]
    ds_read_b128 a[192:195], v3 offset:0
    ds_read_b128 a[196:199], v3 offset:1024
    v_exp_f32 v174, v174
    v_mfma_f32_16x16x32_bf16 a[84:87], a[244:247], v[248:251], a[84:87]
    v_exp_f32 v175, v175
    v_mfma_f32_16x16x32_bf16 a[88:91], a[248:251], v[248:251], a[88:91]
    buffer_load_dwordx4 v31, s[8:11], s46 offen offset:3072 lds
    v_cvt_pk_bf16_f32 v230, v172, v173
    v_cvt_pk_bf16_f32 v231, v174, v175
    v_mfma_f32_16x16x32_bf16 a[120:123], a[248:251], v[252:255], a[120:123]
    ds_read_b128 a[200:203], v3 offset:2048
    ds_read_b128 a[204:207], v3 offset:3072
    v_mfma_f32_16x16x32_bf16 a[124:127], a[252:255], v[252:255], a[124:127]
    v_exp_f32 v176, v176
    v_exp_f32 v177, v177
    v_mfma_f32_16x16x32_bf16 a[92:95], a[252:255], v[248:251], a[92:95]
    s_waitcnt lgkmcnt(4)
    ds_read_b128 a[208:211], v3 offset:4096
    ds_read_b128 a[212:215], v3 offset:5120
    v_mfma_f32_16x16x32_bf16 v[16:19], v[24:27], v[248:251], v[16:19]
    s_add_u32 m0, s85, 4096
    v_exp_f32 v178, v178
    v_exp_f32 v179, v179
    v_mfma_f32_16x16x32_bf16 v[20:23], v[24:27], v[252:255], v[20:23]
    s_add_u32 s46, s46, 20480
    buffer_load_dwordx4 v28, s[8:11], s46 offen offset:0 lds
    v_mfma_f32_16x16x32_bf16 v[196:199], a[128:131], v[76:79], v[144:147]
    v_cvt_pk_bf16_f32 v232, v176, v177
    v_cvt_pk_bf16_f32 v233, v178, v179
    ds_read_b128 a[216:219], v3 offset:6144
    ds_read_b128 a[220:223], v3 offset:7168
    v_mfma_f32_16x16x32_bf16 v[204:207], a[144:147], v[76:79], v[148:151]
    v_exp_f32 v180, v180
    v_mfma_f32_16x16x32_bf16 v[196:199], a[132:135], v[92:95], v[196:199]
    v_exp_f32 v181, v181
    ds_read_b128 a[224:227], v3 offset:8192
    ds_read_b128 a[228:231], v3 offset:9216
    v_mfma_f32_16x16x32_bf16 v[204:207], a[148:151], v[92:95], v[204:207]
    v_exp_f32 v182, v182
    v_mfma_f32_16x16x32_bf16 v[196:199], a[136:139], v[108:111], v[196:199]
    buffer_load_dwordx4 v29, s[8:11], s46 offen offset:1024 lds
    v_exp_f32 v183, v183
    v_mfma_f32_16x16x32_bf16 v[204:207], a[152:155], v[108:111], v[204:207]
    v_cvt_pk_bf16_f32 v236, v180, v181
    v_cvt_pk_bf16_f32 v237, v182, v183
    v_mfma_f32_16x16x32_bf16 v[196:199], a[140:143], v[124:127], v[196:199]
    ds_read_b128 a[232:235], v3 offset:10240
    ds_read_b128 a[236:239], v3 offset:11264
    v_exp_f32 v184, v184
    v_mfma_f32_16x16x32_bf16 v[204:207], a[156:159], v[124:127], v[204:207]
    v_exp_f32 v185, v185
    v_mfma_f32_16x16x32_bf16 v[212:215], a[160:163], v[76:79], v[152:155]
    ds_read_b128 a[240:243], v3 offset:12288
    ds_read_b128 a[244:247], v3 offset:13312
    v_exp_f32 v186, v186
    v_mfma_f32_16x16x32_bf16 v[220:223], a[176:179], v[76:79], v[156:159]
    v_exp_f32 v187, v187
    v_mfma_f32_16x16x32_bf16 v[212:215], a[164:167], v[92:95], v[212:215]
    buffer_load_dwordx4 v30, s[8:11], s46 offen offset:2048 lds
    v_cvt_pk_bf16_f32 v234, v184, v185
    v_cvt_pk_bf16_f32 v235, v186, v187
    v_mfma_f32_16x16x32_bf16 v[220:223], a[180:183], v[92:95], v[220:223]
    ds_read_b128 a[248:251], v3 offset:14336
    ds_read_b128 a[252:255], v3 offset:15360
    v_mfma_f32_16x16x32_bf16 v[212:215], a[168:171], v[108:111], v[212:215]
    v_exp_f32 v188, v188
    v_exp_f32 v189, v189
    v_mfma_f32_16x16x32_bf16 v[220:223], a[184:187], v[108:111], v[220:223]
    v_exp_f32 v190, v190
    v_mfma_f32_16x16x32_bf16 v[212:215], a[172:175], v[124:127], v[212:215]
    buffer_load_dwordx4 v31, s[8:11], s46 offen offset:3072 lds
    v_exp_f32 v191, v191
    v_mfma_f32_16x16x32_bf16 v[220:223], a[188:191], v[124:127], v[220:223]
    s_waitcnt vmcnt(8) lgkmcnt(0)
    v_cvt_pk_bf16_f32 v238, v188, v189
    v_cvt_pk_bf16_f32 v239, v190, v191
    s_branch AT_f3
AT_slow:
    s_waitcnt vmcnt(0) lgkmcnt(0)
    s_nop 7
    s_nop 7
    v_lshrrev_b32 v56, 4, v1
    v_lshlrev_b32 v56, 2, v56
    v_and_b32 v57, 15, v1
    v_sub_u32 v56, v57, v56
    s_lshl_b32 s33, s32, 7
    s_lshl_b32 s34, s30, 4
    s_add_u32 s35, s33, s34
    v_add_u32 v44, s35, v56
    s_sub_u32 s35, 2032, s35
    v_add_u32 v47, s35, v56
    s_sub_u32 s35, s33, s34
    s_add_u32 s35, s35, 112
    v_add_u32 v45, s35, v56
    s_sub_u32 s35, 2032, s35
    v_add_u32 v46, s35, v56
    v_mov_b32 v60, 0xff7fffff
    v_mov_b32 v48, 0xff7fffff
    v_mov_b32 v49, 0xff7fffff
    v_mov_b32 v50, 0xff7fffff
    v_mov_b32 v51, 0xff7fffff
    v_mov_b32 v8, 0
    v_mov_b32 v9, 0
    v_mov_b32 v10, 0
    v_mov_b32 v11, 0
    v_mov_b32 v12, 0
    v_mov_b32 v13, 0
    v_mov_b32 v14, 0
    v_mov_b32 v15, 0
    v_mov_b32 v16, 0
    v_mov_b32 v17, 0
    v_mov_b32 v18, 0
    v_mov_b32 v19, 0
    v_mov_b32 v20, 0
    v_mov_b32 v21, 0
    v_mov_b32 v22, 0
    v_mov_b32 v23, 0
    v_accvgpr_write_b32 a0, 0
    v_accvgpr_write_b32 a1, 0
    v_accvgpr_write_b32 a2, 0
    v_accvgpr_write_b32 a3, 0
    v_accvgpr_write_b32 a4, 0
    v_accvgpr_write_b32 a5, 0
    v_accvgpr_write_b32 a6, 0
    v_accvgpr_write_b32 a7, 0
    v_accvgpr_write_b32 a8, 0
    v_accvgpr_write_b32 a9, 0
    v_accvgpr_write_b32 a10, 0
    v_accvgpr_write_b32 a11, 0
    v_accvgpr_write_b32 a12, 0
    v_accvgpr_write_b32 a13, 0
    v_accvgpr_write_b32 a14, 0
    v_accvgpr_write_b32 a15, 0
    v_accvgpr_write_b32 a16, 0
    v_accvgpr_write_b32 a17, 0
    v_accvgpr_write_b32 a18, 0
    v_accvgpr_write_b32 a19, 0
    v_accvgpr_write_b32 a20, 0
    v_accvgpr_write_b32 a21, 0
    v_accvgpr_write_b32 a22, 0
    v_accvgpr_write_b32 a23, 0
    v_accvgpr_write_b32 a24, 0
    v_accvgpr_write_b32 a25, 0
    v_accvgpr_write_b32 a26, 0
    v_accvgpr_write_b32 a27, 0
    v_accvgpr_write_b32 a28, 0
    v_accvgpr_write_b32 a29, 0
    v_accvgpr_write_b32 a30, 0
    v_accvgpr_write_b32 a31, 0
    v_accvgpr_write_b32 a32, 0
    v_accvgpr_write_b32 a33, 0
    v_accvgpr_write_b32 a34, 0
    v_accvgpr_write_b32 a35, 0
    v_accvgpr_write_b32 a36, 0
    v_accvgpr_write_b32 a37, 0
    v_accvgpr_write_b32 a38, 0
    v_accvgpr_write_b32 a39, 0
    v_accvgpr_write_b32 a40, 0
    v_accvgpr_write_b32 a41, 0
    v_accvgpr_write_b32 a42, 0
    v_accvgpr_write_b32 a43, 0
    v_accvgpr_write_b32 a44, 0
    v_accvgpr_write_b32 a45, 0
    v_accvgpr_write_b32 a46, 0
    v_accvgpr_write_b32 a47, 0
    v_accvgpr_write_b32 a48, 0
    v_accvgpr_write_b32 a49, 0
    v_accvgpr_write_b32 a50, 0
    v_accvgpr_write_b32 a51, 0
    v_accvgpr_write_b32 a52, 0
    v_accvgpr_write_b32 a53, 0
    v_accvgpr_write_b32 a54, 0
    v_accvgpr_write_b32 a55, 0
    v_accvgpr_write_b32 a56, 0
    v_accvgpr_write_b32 a57, 0
    v_accvgpr_write_b32 a58, 0
    v_accvgpr_write_b32 a59, 0
    v_accvgpr_write_b32 a60, 0
    v_accvgpr_write_b32 a61, 0
    v_accvgpr_write_b32 a62, 0
    v_accvgpr_write_b32 a63, 0
    v_accvgpr_write_b32 a64, 0
    v_accvgpr_write_b32 a65, 0
    v_accvgpr_write_b32 a66, 0
    v_accvgpr_write_b32 a67, 0
    v_accvgpr_write_b32 a68, 0
    v_accvgpr_write_b32 a69, 0
    v_accvgpr_write_b32 a70, 0
    v_accvgpr_write_b32 a71, 0
    v_accvgpr_write_b32 a72, 0
    v_accvgpr_write_b32 a73, 0
    v_accvgpr_write_b32 a74, 0
    v_accvgpr_write_b32 a75, 0
    v_accvgpr_write_b32 a76, 0
    v_accvgpr_write_b32 a77, 0
    v_accvgpr_write_b32 a78, 0
    v_accvgpr_write_b32 a79, 0
    v_accvgpr_write_b32 a80, 0
    v_accvgpr_write_b32 a81, 0
    v_accvgpr_write_b32 a82, 0
    v_accvgpr_write_b32 a83, 0
    v_accvgpr_write_b32 a84, 0
    v_accvgpr_write_b32 a85, 0
    v_accvgpr_write_b32 a86, 0
    v_accvgpr_write_b32 a87, 0
    v_accvgpr_write_b32 a88, 0
    v_accvgpr_write_b32 a89, 0
    v_accvgpr_write_b32 a90, 0
    v_accvgpr_write_b32 a91, 0
    v_accvgpr_write_b32 a92, 0
    v_accvgpr_write_b32 a93, 0
    v_accvgpr_write_b32 a94, 0
    v_accvgpr_write_b32 a95, 0
    v_accvgpr_write_b32 a96, 0
    v_accvgpr_write_b32 a97, 0
    v_accvgpr_write_b32 a98, 0
    v_accvgpr_write_b32 a99, 0
    v_accvgpr_write_b32 a100, 0
    v_accvgpr_write_b32 a101, 0
    v_accvgpr_write_b32 a102, 0
    v_accvgpr_write_b32 a103, 0
    v_accvgpr_write_b32 a104, 0
    v_accvgpr_write_b32 a105, 0
    v_accvgpr_write_b32 a106, 0
    v_accvgpr_write_b32 a107, 0
    v_accvgpr_write_b32 a108, 0
    v_accvgpr_write_b32 a109, 0
    v_accvgpr_write_b32 a110, 0
    v_accvgpr_write_b32 a111, 0
    v_accvgpr_write_b32 a112, 0
    v_accvgpr_write_b32 a113, 0
    v_accvgpr_write_b32 a114, 0
    v_accvgpr_write_b32 a115, 0
    v_accvgpr_write_b32 a116, 0
    v_accvgpr_write_b32 a117, 0
    v_accvgpr_write_b32 a118, 0
    v_accvgpr_write_b32 a119, 0
    v_accvgpr_write_b32 a120, 0
    v_accvgpr_write_b32 a121, 0
    v_accvgpr_write_b32 a122, 0
    v_accvgpr_write_b32 a123, 0
    v_accvgpr_write_b32 a124, 0
    v_accvgpr_write_b32 a125, 0
    v_accvgpr_write_b32 a126, 0
    v_accvgpr_write_b32 a127, 0
    s_lshl_b32 s95, s32, 2
    s_sub_u32 s95, 64, s95
    s_mov_b32 s92, 0
AT_sl:
    s_lshr_b32 s33, s92, 1
    s_mul_i32 s33, s33, 33792
    s_and_b32 s34, s92, 1
    s_lshl_b32 s34, s34, 13
    s_add_u32 s33, s33, s34
    s_add_u32 s34, s33, 17408
    buffer_load_dwordx4 a[128:131], v2, s[36:39], s33 offen offset:0 sc1
    buffer_load_dwordx4 a[132:135], v2, s[36:39], s33 offen offset:1024 sc1
    buffer_load_dwordx4 a[136:139], v2, s[36:39], s33 offen offset:2048 sc1
    buffer_load_dwordx4 a[140:143], v2, s[36:39], s33 offen offset:3072 sc1
    buffer_load_dwordx4 a[144:147], v4, s[36:39], s33 offen offset:0 sc1
    buffer_load_dwordx4 a[148:151], v4, s[36:39], s33 offen offset:1024 sc1
    buffer_load_dwordx4 a[152:155], v4, s[36:39], s33 offen offset:2048 sc1
    buffer_load_dwordx4 a[156:159], v4, s[36:39], s33 offen offset:3072 sc1
    buffer_load_dwordx4 a[192:195], v2, s[36:39], s34 offen offset:0 sc1
    buffer_load_dwordx4 a[196:199], v2, s[36:39], s34 offen offset:1024 sc1
    buffer_load_dwordx4 a[200:203], v2, s[36:39], s34 offen offset:2048 sc1
    buffer_load_dwordx4 a[204:207], v2, s[36:39], s34 offen offset:3072 sc1
    buffer_load_dwordx4 a[208:211], v4, s[36:39], s34 offen offset:0 sc1
    buffer_load_dwordx4 a[212:215], v4, s[36:39], s34 offen offset:1024 sc1
    buffer_load_dwordx4 a[216:219], v4, s[36:39], s34 offen offset:2048 sc1
    buffer_load_dwordx4 a[220:223], v4, s[36:39], s34 offen offset:3072 sc1
    s_waitcnt vmcnt(15)
    v_mfma_f32_16x16x32_bf16 v[160:163], a[128:131], v[64:67], 0
    v_mfma_f32_16x16x32_bf16 v[164:167], a[128:131], v[68:71], 0
    s_waitcnt vmcnt(14)
    v_mfma_f32_16x16x32_bf16 v[160:163], a[132:135], v[80:83], v[160:163]
    v_mfma_f32_16x16x32_bf16 v[164:167], a[132:135], v[84:87], v[164:167]
    s_waitcnt vmcnt(13)
    v_mfma_f32_16x16x32_bf16 v[160:163], a[136:139], v[96:99], v[160:163]
    v_mfma_f32_16x16x32_bf16 v[164:167], a[136:139], v[100:103], v[164:167]
    s_waitcnt vmcnt(12)
    v_mfma_f32_16x16x32_bf16 v[160:163], a[140:143], v[112:115], v[160:163]
    v_mfma_f32_16x16x32_bf16 v[164:167], a[140:143], v[116:119], v[164:167]
    s_waitcnt vmcnt(11)
    v_mfma_f32_16x16x32_bf16 v[168:171], a[144:147], v[64:67], 0
    v_mfma_f32_16x16x32_bf16 v[172:175], a[144:147], v[68:71], 0
    s_waitcnt vmcnt(10)
    v_mfma_f32_16x16x32_bf16 v[168:171], a[148:151], v[80:83], v[168:171]
    v_mfma_f32_16x16x32_bf16 v[172:175], a[148:151], v[84:87], v[172:175]
    s_waitcnt vmcnt(9)
    v_mfma_f32_16x16x32_bf16 v[168:171], a[152:155], v[96:99], v[168:171]
    v_mfma_f32_16x16x32_bf16 v[172:175], a[152:155], v[100:103], v[172:175]
    s_waitcnt vmcnt(8)
    v_mfma_f32_16x16x32_bf16 v[168:171], a[156:159], v[112:115], v[168:171]
    v_mfma_f32_16x16x32_bf16 v[172:175], a[156:159], v[116:119], v[172:175]
    v_mfma_f32_16x16x32_bf16 v[176:179], a[128:131], v[72:75], 0
    v_mfma_f32_16x16x32_bf16 v[180:183], a[128:131], v[76:79], 0
    v_mfma_f32_16x16x32_bf16 v[176:179], a[132:135], v[88:91], v[176:179]
    v_mfma_f32_16x16x32_bf16 v[180:183], a[132:135], v[92:95], v[180:183]
    v_mfma_f32_16x16x32_bf16 v[176:179], a[136:139], v[104:107], v[176:179]
    v_mfma_f32_16x16x32_bf16 v[180:183], a[136:139], v[108:111], v[180:183]
    v_mfma_f32_16x16x32_bf16 v[176:179], a[140:143], v[120:123], v[176:179]
    v_mfma_f32_16x16x32_bf16 v[180:183], a[140:143], v[124:127], v[180:183]
    v_mfma_f32_16x16x32_bf16 v[184:187], a[144:147], v[72:75], 0
    v_mfma_f32_16x16x32_bf16 v[188:191], a[144:147], v[76:79], 0
    v_mfma_f32_16x16x32_bf16 v[184:187], a[148:151], v[88:91], v[184:187]
    v_mfma_f32_16x16x32_bf16 v[188:191], a[148:151], v[92:95], v[188:191]
    v_mfma_f32_16x16x32_bf16 v[184:187], a[152:155], v[104:107], v[184:187]
    v_mfma_f32_16x16x32_bf16 v[188:191], a[152:155], v[108:111], v[188:191]
    v_mfma_f32_16x16x32_bf16 v[184:187], a[156:159], v[120:123], v[184:187]
    v_mfma_f32_16x16x32_bf16 v[188:191], a[156:159], v[124:127], v[188:191]
    v_cmp_gt_i32 vcc, 0, v44
    s_nop 1
    v_cndmask_b32 v160, v160, v60, vcc
    v_cmp_gt_i32 vcc, 1, v44
    s_nop 1
    v_cndmask_b32 v161, v161, v60, vcc
    v_cmp_gt_i32 vcc, 2, v44
    s_nop 1
    v_cndmask_b32 v162, v162, v60, vcc
    v_cmp_gt_i32 vcc, 3, v44
    s_nop 1
    v_cndmask_b32 v163, v163, v60, vcc
    v_cmp_gt_i32 vcc, 0, v45
    s_nop 1
    v_cndmask_b32 v164, v164, v60, vcc
    v_cmp_gt_i32 vcc, 1, v45
    s_nop 1
    v_cndmask_b32 v165, v165, v60, vcc
    v_cmp_gt_i32 vcc, 2, v45
    s_nop 1
    v_cndmask_b32 v166, v166, v60, vcc
    v_cmp_gt_i32 vcc, 3, v45
    s_nop 1
    v_cndmask_b32 v167, v167, v60, vcc
    v_cmp_gt_i32 vcc, 16, v44
    s_nop 1
    v_cndmask_b32 v168, v168, v60, vcc
    v_cmp_gt_i32 vcc, 17, v44
    s_nop 1
    v_cndmask_b32 v169, v169, v60, vcc
    v_cmp_gt_i32 vcc, 18, v44
    s_nop 1
    v_cndmask_b32 v170, v170, v60, vcc
    v_cmp_gt_i32 vcc, 19, v44
    s_nop 1
    v_cndmask_b32 v171, v171, v60, vcc
    v_cmp_gt_i32 vcc, 16, v45
    s_nop 1
    v_cndmask_b32 v172, v172, v60, vcc
    v_cmp_gt_i32 vcc, 17, v45
    s_nop 1
    v_cndmask_b32 v173, v173, v60, vcc
    v_cmp_gt_i32 vcc, 18, v45
    s_nop 1
    v_cndmask_b32 v174, v174, v60, vcc
    v_cmp_gt_i32 vcc, 19, v45
    s_nop 1
    v_cndmask_b32 v175, v175, v60, vcc
    v_cmp_gt_i32 vcc, 0, v46
    s_nop 1
    v_cndmask_b32 v176, v176, v60, vcc
    v_cmp_gt_i32 vcc, 1, v46
    s_nop 1
    v_cndmask_b32 v177, v177, v60, vcc
    v_cmp_gt_i32 vcc, 2, v46
    s_nop 1
    v_cndmask_b32 v178, v178, v60, vcc
    v_cmp_gt_i32 vcc, 3, v46
    s_nop 1
    v_cndmask_b32 v179, v179, v60, vcc
    v_cmp_gt_i32 vcc, 0, v47
    s_nop 1
    v_cndmask_b32 v180, v180, v60, vcc
    v_cmp_gt_i32 vcc, 1, v47
    s_nop 1
    v_cndmask_b32 v181, v181, v60, vcc
    v_cmp_gt_i32 vcc, 2, v47
    s_nop 1
    v_cndmask_b32 v182, v182, v60, vcc
    v_cmp_gt_i32 vcc, 3, v47
    s_nop 1
    v_cndmask_b32 v183, v183, v60, vcc
    v_cmp_gt_i32 vcc, 16, v46
    s_nop 1
    v_cndmask_b32 v184, v184, v60, vcc
    v_cmp_gt_i32 vcc, 17, v46
    s_nop 1
    v_cndmask_b32 v185, v185, v60, vcc
    v_cmp_gt_i32 vcc, 18, v46
    s_nop 1
    v_cndmask_b32 v186, v186, v60, vcc
    v_cmp_gt_i32 vcc, 19, v46
    s_nop 1
    v_cndmask_b32 v187, v187, v60, vcc
    v_cmp_gt_i32 vcc, 16, v47
    s_nop 1
    v_cndmask_b32 v188, v188, v60, vcc
    v_cmp_gt_i32 vcc, 17, v47
    s_nop 1
    v_cndmask_b32 v189, v189, v60, vcc
    v_cmp_gt_i32 vcc, 18, v47
    s_nop 1
    v_cndmask_b32 v190, v190, v60, vcc
    v_cmp_gt_i32 vcc, 19, v47
    s_nop 1
    v_cndmask_b32 v191, v191, v60, vcc
    v_max3_f32 v52, v48, v160, v161
    v_max3_f32 v52, v52, v162, v163
    v_max3_f32 v52, v52, v168, v169
    v_max3_f32 v52, v52, v170, v171
    v_max3_f32 v53, v49, v164, v165
    v_max3_f32 v53, v53, v166, v167
    v_max3_f32 v53, v53, v172, v173
    v_max3_f32 v53, v53, v174, v175
    v_max3_f32 v54, v50, v176, v177
    v_max3_f32 v54, v54, v178, v179
    v_max3_f32 v54, v54, v184, v185
    v_max3_f32 v54, v54, v186, v187
    v_max3_f32 v55, v51, v180, v181
    v_max3_f32 v55, v55, v182, v183
    v_max3_f32 v55, v55, v188, v189
    v_max3_f32 v55, v55, v190, v191
    v_mov_b32 v56, v52
    v_mov_b32 v57, v53
    v_mov_b32 v58, v54
    v_mov_b32 v59, v55
    v_permlane16_swap_b32 v56, v52
    v_permlane16_swap_b32 v57, v53
    v_permlane16_swap_b32 v58, v54
    v_permlane16_swap_b32 v59, v55
    v_max_f32 v52, v52, v56
    v_max_f32 v53, v53, v57
    v_max_f32 v54, v54, v58
    v_max_f32 v55, v55, v59
    v_mov_b32 v56, v52
    v_mov_b32 v57, v53
    v_mov_b32 v58, v54
    v_mov_b32 v59, v55
    v_permlane32_swap_b32 v56, v52
    v_permlane32_swap_b32 v57, v53
    v_permlane32_swap_b32 v58, v54
    v_permlane32_swap_b32 v59, v55
    v_max_f32 v52, v52, v56
    v_max_f32 v53, v53, v57
    v_max_f32 v54, v54, v58
    v_max_f32 v55, v55, v59
    v_sub_f32 v56, v48, v52
    v_exp_f32 v56, v56
    v_mov_b32 v48, v52
    v_subrev_u32 v44, 32, v44
    v_sub_f32 v57, v49, v53
    v_exp_f32 v57, v57
    v_mov_b32 v49, v53
    v_subrev_u32 v45, 32, v45
    v_sub_f32 v58, v50, v54
    v_exp_f32 v58, v58
    v_mov_b32 v50, v54
    v_subrev_u32 v46, 32, v46
    v_sub_f32 v59, v51, v55
    v_exp_f32 v59, v59
    v_mov_b32 v51, v55
    v_subrev_u32 v47, 32, v47
    v_sub_f32 v160, v160, v48
    v_sub_f32 v161, v161, v48
    v_sub_f32 v162, v162, v48
    v_sub_f32 v163, v163, v48
    v_exp_f32 v160, v160
    v_exp_f32 v161, v161
    v_exp_f32 v162, v162
    v_exp_f32 v163, v163
    v_cvt_pk_bf16_f32 v224, v160, v161
    v_cvt_pk_bf16_f32 v225, v162, v163
    v_sub_f32 v164, v164, v49
    v_sub_f32 v165, v165, v49
    v_sub_f32 v166, v166, v49
    v_sub_f32 v167, v167, v49
    v_exp_f32 v164, v164
    v_exp_f32 v165, v165
    v_exp_f32 v166, v166
    v_exp_f32 v167, v167
    v_cvt_pk_bf16_f32 v228, v164, v165
    v_cvt_pk_bf16_f32 v229, v166, v167
    v_sub_f32 v168, v168, v48
    v_sub_f32 v169, v169, v48
    v_sub_f32 v170, v170, v48
    v_sub_f32 v171, v171, v48
    v_exp_f32 v168, v168
    v_exp_f32 v169, v169
    v_exp_f32 v170, v170
    v_exp_f32 v171, v171
    v_cvt_pk_bf16_f32 v226, v168, v169
    v_cvt_pk_bf16_f32 v227, v170, v171
    v_sub_f32 v172, v172, v49
    v_sub_f32 v173, v173, v49
    v_sub_f32 v174, v174, v49
    v_sub_f32 v175, v175, v49
    v_exp_f32 v172, v172
    v_exp_f32 v173, v173
    v_exp_f32 v174, v174
    v_exp_f32 v175, v175
    v_cvt_pk_bf16_f32 v230, v172, v173
    v_cvt_pk_bf16_f32 v231, v174, v175
    v_sub_f32 v176, v176, v50
    v_sub_f32 v177, v177, v50
    v_sub_f32 v178, v178, v50
    v_sub_f32 v179, v179, v50
    v_exp_f32 v176, v176
    v_exp_f32 v177, v177
    v_exp_f32 v178, v178
    v_exp_f32 v179, v179
    v_cvt_pk_bf16_f32 v232, v176, v177
    v_cvt_pk_bf16_f32 v233, v178, v179
    v_sub_f32 v180, v180, v51
    v_sub_f32 v181, v181, v51
    v_sub_f32 v182, v182, v51
    v_sub_f32 v183, v183, v51
    v_exp_f32 v180, v180
    v_exp_f32 v181, v181
    v_exp_f32 v182, v182
    v_exp_f32 v183, v183
    v_cvt_pk_bf16_f32 v236, v180, v181
    v_cvt_pk_bf16_f32 v237, v182, v183
    v_sub_f32 v184, v184, v50
    v_sub_f32 v185, v185, v50
    v_sub_f32 v186, v186, v50
    v_sub_f32 v187, v187, v50
    v_exp_f32 v184, v184
    v_exp_f32 v185, v185
    v_exp_f32 v186, v186
    v_exp_f32 v187, v187
    v_cvt_pk_bf16_f32 v234, v184, v185
    v_cvt_pk_bf16_f32 v235, v186, v187
    v_sub_f32 v188, v188, v51
    v_sub_f32 v189, v189, v51
    v_sub_f32 v190, v190, v51
    v_sub_f32 v191, v191, v51
    v_exp_f32 v188, v188
    v_exp_f32 v189, v189
    v_exp_f32 v190, v190
    v_exp_f32 v191, v191
    v_cvt_pk_bf16_f32 v238, v188, v189
    v_cvt_pk_bf16_f32 v239, v190, v191
    v_mul_f32 v8, v8, v56
    v_mul_f32 v9, v9, v56
    v_mul_f32 v10, v10, v56
    v_mul_f32 v11, v11, v56
    v_accvgpr_read_b32 v192, a0
    v_accvgpr_read_b32 v193, a1
    v_accvgpr_read_b32 v194, a2
    v_accvgpr_read_b32 v195, a3
    v_accvgpr_read_b32 v196, a4
    v_accvgpr_read_b32 v197, a5
    v_accvgpr_read_b32 v198, a6
    v_accvgpr_read_b32 v199, a7
    v_accvgpr_read_b32 v200, a8
    v_accvgpr_read_b32 v201, a9
    v_accvgpr_read_b32 v202, a10
    v_accvgpr_read_b32 v203, a11
    v_accvgpr_read_b32 v204, a12
    v_accvgpr_read_b32 v205, a13
    v_accvgpr_read_b32 v206, a14
    v_accvgpr_read_b32 v207, a15
    v_accvgpr_read_b32 v208, a16
    v_accvgpr_read_b32 v209, a17
    v_accvgpr_read_b32 v210, a18
    v_accvgpr_read_b32 v211, a19
    v_accvgpr_read_b32 v212, a20
    v_accvgpr_read_b32 v213, a21
    v_accvgpr_read_b32 v214, a22
    v_accvgpr_read_b32 v215, a23
    v_accvgpr_read_b32 v216, a24
    v_accvgpr_read_b32 v217, a25
    v_accvgpr_read_b32 v218, a26
    v_accvgpr_read_b32 v219, a27
    v_accvgpr_read_b32 v220, a28
    v_accvgpr_read_b32 v221, a29
    v_accvgpr_read_b32 v222, a30
    v_accvgpr_read_b32 v223, a31
    v_mul_f32 v192, v192, v56
    v_mul_f32 v193, v193, v56
    v_mul_f32 v194, v194, v56
    v_mul_f32 v195, v195, v56
    v_mul_f32 v196, v196, v56
    v_mul_f32 v197, v197, v56
    v_mul_f32 v198, v198, v56
    v_mul_f32 v199, v199, v56
    v_mul_f32 v200, v200, v56
    v_mul_f32 v201, v201, v56
    v_mul_f32 v202, v202, v56
    v_mul_f32 v203, v203, v56
    v_mul_f32 v204, v204, v56
    v_mul_f32 v205, v205, v56
    v_mul_f32 v206, v206, v56
    v_mul_f32 v207, v207, v56
    v_mul_f32 v208, v208, v56
    v_mul_f32 v209, v209, v56
    v_mul_f32 v210, v210, v56
    v_mul_f32 v211, v211, v56
    v_mul_f32 v212, v212, v56
    v_mul_f32 v213, v213, v56
    v_mul_f32 v214, v214, v56
    v_mul_f32 v215, v215, v56
    v_mul_f32 v216, v216, v56
    v_mul_f32 v217, v217, v56
    v_mul_f32 v218, v218, v56
    v_mul_f32 v219, v219, v56
    v_mul_f32 v220, v220, v56
    v_mul_f32 v221, v221, v56
    v_mul_f32 v222, v222, v56
    v_mul_f32 v223, v223, v56
    v_accvgpr_write_b32 a0, v192
    v_accvgpr_write_b32 a1, v193
    v_accvgpr_write_b32 a2, v194
    v_accvgpr_write_b32 a3, v195
    v_accvgpr_write_b32 a4, v196
    v_accvgpr_write_b32 a5, v197
    v_accvgpr_write_b32 a6, v198
    v_accvgpr_write_b32 a7, v199
    v_accvgpr_write_b32 a8, v200
    v_accvgpr_write_b32 a9, v201
    v_accvgpr_write_b32 a10, v202
    v_accvgpr_write_b32 a11, v203
    v_accvgpr_write_b32 a12, v204
    v_accvgpr_write_b32 a13, v205
    v_accvgpr_write_b32 a14, v206
    v_accvgpr_write_b32 a15, v207
    v_accvgpr_write_b32 a16, v208
    v_accvgpr_write_b32 a17, v209
    v_accvgpr_write_b32 a18, v210
    v_accvgpr_write_b32 a19, v211
    v_accvgpr_write_b32 a20, v212
    v_accvgpr_write_b32 a21, v213
    v_accvgpr_write_b32 a22, v214
    v_accvgpr_write_b32 a23, v215
    v_accvgpr_write_b32 a24, v216
    v_accvgpr_write_b32 a25, v217
    v_accvgpr_write_b32 a26, v218
    v_accvgpr_write_b32 a27, v219
    v_accvgpr_write_b32 a28, v220
    v_accvgpr_write_b32 a29, v221
    v_accvgpr_write_b32 a30, v222
    v_accvgpr_write_b32 a31, v223
    v_mul_f32 v12, v12, v57
    v_mul_f32 v13, v13, v57
    v_mul_f32 v14, v14, v57
    v_mul_f32 v15, v15, v57
    v_accvgpr_read_b32 v192, a32
    v_accvgpr_read_b32 v193, a33
    v_accvgpr_read_b32 v194, a34
    v_accvgpr_read_b32 v195, a35
    v_accvgpr_read_b32 v196, a36
    v_accvgpr_read_b32 v197, a37
    v_accvgpr_read_b32 v198, a38
    v_accvgpr_read_b32 v199, a39
    v_accvgpr_read_b32 v200, a40
    v_accvgpr_read_b32 v201, a41
    v_accvgpr_read_b32 v202, a42
    v_accvgpr_read_b32 v203, a43
    v_accvgpr_read_b32 v204, a44
    v_accvgpr_read_b32 v205, a45
    v_accvgpr_read_b32 v206, a46
    v_accvgpr_read_b32 v207, a47
    v_accvgpr_read_b32 v208, a48
    v_accvgpr_read_b32 v209, a49
    v_accvgpr_read_b32 v210, a50
    v_accvgpr_read_b32 v211, a51
    v_accvgpr_read_b32 v212, a52
    v_accvgpr_read_b32 v213, a53
    v_accvgpr_read_b32 v214, a54
    v_accvgpr_read_b32 v215, a55
    v_accvgpr_read_b32 v216, a56
    v_accvgpr_read_b32 v217, a57
    v_accvgpr_read_b32 v218, a58
    v_accvgpr_read_b32 v219, a59
    v_accvgpr_read_b32 v220, a60
    v_accvgpr_read_b32 v221, a61
    v_accvgpr_read_b32 v222, a62
    v_accvgpr_read_b32 v223, a63
    v_mul_f32 v192, v192, v57
    v_mul_f32 v193, v193, v57
    v_mul_f32 v194, v194, v57
    v_mul_f32 v195, v195, v57
    v_mul_f32 v196, v196, v57
    v_mul_f32 v197, v197, v57
    v_mul_f32 v198, v198, v57
    v_mul_f32 v199, v199, v57
    v_mul_f32 v200, v200, v57
    v_mul_f32 v201, v201, v57
    v_mul_f32 v202, v202, v57
    v_mul_f32 v203, v203, v57
    v_mul_f32 v204, v204, v57
    v_mul_f32 v205, v205, v57
    v_mul_f32 v206, v206, v57
    v_mul_f32 v207, v207, v57
    v_mul_f32 v208, v208, v57
    v_mul_f32 v209, v209, v57
    v_mul_f32 v210, v210, v57
    v_mul_f32 v211, v211, v57
    v_mul_f32 v212, v212, v57
    v_mul_f32 v213, v213, v57
    v_mul_f32 v214, v214, v57
    v_mul_f32 v215, v215, v57
    v_mul_f32 v216, v216, v57
    v_mul_f32 v217, v217, v57
    v_mul_f32 v218, v218, v57
    v_mul_f32 v219, v219, v57
    v_mul_f32 v220, v220, v57
    v_mul_f32 v221, v221, v57
    v_mul_f32 v222, v222, v57
    v_mul_f32 v223, v223, v57
    v_accvgpr_write_b32 a32, v192
    v_accvgpr_write_b32 a33, v193
    v_accvgpr_write_b32 a34, v194
    v_accvgpr_write_b32 a35, v195
    v_accvgpr_write_b32 a36, v196
    v_accvgpr_write_b32 a37, v197
    v_accvgpr_write_b32 a38, v198
    v_accvgpr_write_b32 a39, v199
    v_accvgpr_write_b32 a40, v200
    v_accvgpr_write_b32 a41, v201
    v_accvgpr_write_b32 a42, v202
    v_accvgpr_write_b32 a43, v203
    v_accvgpr_write_b32 a44, v204
    v_accvgpr_write_b32 a45, v205
    v_accvgpr_write_b32 a46, v206
    v_accvgpr_write_b32 a47, v207
    v_accvgpr_write_b32 a48, v208
    v_accvgpr_write_b32 a49, v209
    v_accvgpr_write_b32 a50, v210
    v_accvgpr_write_b32 a51, v211
    v_accvgpr_write_b32 a52, v212
    v_accvgpr_write_b32 a53, v213
    v_accvgpr_write_b32 a54, v214
    v_accvgpr_write_b32 a55, v215
    v_accvgpr_write_b32 a56, v216
    v_accvgpr_write_b32 a57, v217
    v_accvgpr_write_b32 a58, v218
    v_accvgpr_write_b32 a59, v219
    v_accvgpr_write_b32 a60, v220
    v_accvgpr_write_b32 a61, v221
    v_accvgpr_write_b32 a62, v222
    v_accvgpr_write_b32 a63, v223
    v_mul_f32 v16, v16, v58
    v_mul_f32 v17, v17, v58
    v_mul_f32 v18, v18, v58
    v_mul_f32 v19, v19, v58
    v_accvgpr_read_b32 v192, a64
    v_accvgpr_read_b32 v193, a65
    v_accvgpr_read_b32 v194, a66
    v_accvgpr_read_b32 v195, a67
    v_accvgpr_read_b32 v196, a68
    v_accvgpr_read_b32 v197, a69
    v_accvgpr_read_b32 v198, a70
    v_accvgpr_read_b32 v199, a71
    v_accvgpr_read_b32 v200, a72
    v_accvgpr_read_b32 v201, a73
    v_accvgpr_read_b32 v202, a74
    v_accvgpr_read_b32 v203, a75
    v_accvgpr_read_b32 v204, a76
    v_accvgpr_read_b32 v205, a77
    v_accvgpr_read_b32 v206, a78
    v_accvgpr_read_b32 v207, a79
    v_accvgpr_read_b32 v208, a80
    v_accvgpr_read_b32 v209, a81
    v_accvgpr_read_b32 v210, a82
    v_accvgpr_read_b32 v211, a83
    v_accvgpr_read_b32 v212, a84
    v_accvgpr_read_b32 v213, a85
    v_accvgpr_read_b32 v214, a86
    v_accvgpr_read_b32 v215, a87
    v_accvgpr_read_b32 v216, a88
    v_accvgpr_read_b32 v217, a89
    v_accvgpr_read_b32 v218, a90
    v_accvgpr_read_b32 v219, a91
    v_accvgpr_read_b32 v220, a92
    v_accvgpr_read_b32 v221, a93
    v_accvgpr_read_b32 v222, a94
    v_accvgpr_read_b32 v223, a95
    v_mul_f32 v192, v192, v58
    v_mul_f32 v193, v193, v58
    v_mul_f32 v194, v194, v58
    v_mul_f32 v195, v195, v58
    v_mul_f32 v196, v196, v58
    v_mul_f32 v197, v197, v58
    v_mul_f32 v198, v198, v58
    v_mul_f32 v199, v199, v58
    v_mul_f32 v200, v200, v58
    v_mul_f32 v201, v201, v58
    v_mul_f32 v202, v202, v58
    v_mul_f32 v203, v203, v58
    v_mul_f32 v204, v204, v58
    v_mul_f32 v205, v205, v58
    v_mul_f32 v206, v206, v58
    v_mul_f32 v207, v207, v58
    v_mul_f32 v208, v208, v58
    v_mul_f32 v209, v209, v58
    v_mul_f32 v210, v210, v58
    v_mul_f32 v211, v211, v58
    v_mul_f32 v212, v212, v58
    v_mul_f32 v213, v213, v58
    v_mul_f32 v214, v214, v58
    v_mul_f32 v215, v215, v58
    v_mul_f32 v216, v216, v58
    v_mul_f32 v217, v217, v58
    v_mul_f32 v218, v218, v58
    v_mul_f32 v219, v219, v58
    v_mul_f32 v220, v220, v58
    v_mul_f32 v221, v221, v58
    v_mul_f32 v222, v222, v58
    v_mul_f32 v223, v223, v58
    v_accvgpr_write_b32 a64, v192
    v_accvgpr_write_b32 a65, v193
    v_accvgpr_write_b32 a66, v194
    v_accvgpr_write_b32 a67, v195
    v_accvgpr_write_b32 a68, v196
    v_accvgpr_write_b32 a69, v197
    v_accvgpr_write_b32 a70, v198
    v_accvgpr_write_b32 a71, v199
    v_accvgpr_write_b32 a72, v200
    v_accvgpr_write_b32 a73, v201
    v_accvgpr_write_b32 a74, v202
    v_accvgpr_write_b32 a75, v203
    v_accvgpr_write_b32 a76, v204
    v_accvgpr_write_b32 a77, v205
    v_accvgpr_write_b32 a78, v206
    v_accvgpr_write_b32 a79, v207
    v_accvgpr_write_b32 a80, v208
    v_accvgpr_write_b32 a81, v209
    v_accvgpr_write_b32 a82, v210
    v_accvgpr_write_b32 a83, v211
    v_accvgpr_write_b32 a84, v212
    v_accvgpr_write_b32 a85, v213
    v_accvgpr_write_b32 a86, v214
    v_accvgpr_write_b32 a87, v215
    v_accvgpr_write_b32 a88, v216
    v_accvgpr_write_b32 a89, v217
    v_accvgpr_write_b32 a90, v218
    v_accvgpr_write_b32 a91, v219
    v_accvgpr_write_b32 a92, v220
    v_accvgpr_write_b32 a93, v221
    v_accvgpr_write_b32 a94, v222
    v_accvgpr_write_b32 a95, v223
    v_mul_f32 v20, v20, v59
    v_mul_f32 v21, v21, v59
    v_mul_f32 v22, v22, v59
    v_mul_f32 v23, v23, v59
    v_accvgpr_read_b32 v192, a96
    v_accvgpr_read_b32 v193, a97
    v_accvgpr_read_b32 v194, a98
    v_accvgpr_read_b32 v195, a99
    v_accvgpr_read_b32 v196, a100
    v_accvgpr_read_b32 v197, a101
    v_accvgpr_read_b32 v198, a102
    v_accvgpr_read_b32 v199, a103
    v_accvgpr_read_b32 v200, a104
    v_accvgpr_read_b32 v201, a105
    v_accvgpr_read_b32 v202, a106
    v_accvgpr_read_b32 v203, a107
    v_accvgpr_read_b32 v204, a108
    v_accvgpr_read_b32 v205, a109
    v_accvgpr_read_b32 v206, a110
    v_accvgpr_read_b32 v207, a111
    v_accvgpr_read_b32 v208, a112
    v_accvgpr_read_b32 v209, a113
    v_accvgpr_read_b32 v210, a114
    v_accvgpr_read_b32 v211, a115
    v_accvgpr_read_b32 v212, a116
    v_accvgpr_read_b32 v213, a117
    v_accvgpr_read_b32 v214, a118
    v_accvgpr_read_b32 v215, a119
    v_accvgpr_read_b32 v216, a120
    v_accvgpr_read_b32 v217, a121
    v_accvgpr_read_b32 v218, a122
    v_accvgpr_read_b32 v219, a123
    v_accvgpr_read_b32 v220, a124
    v_accvgpr_read_b32 v221, a125
    v_accvgpr_read_b32 v222, a126
    v_accvgpr_read_b32 v223, a127
    v_mul_f32 v192, v192, v59
    v_mul_f32 v193, v193, v59
    v_mul_f32 v194, v194, v59
    v_mul_f32 v195, v195, v59
    v_mul_f32 v196, v196, v59
    v_mul_f32 v197, v197, v59
    v_mul_f32 v198, v198, v59
    v_mul_f32 v199, v199, v59
    v_mul_f32 v200, v200, v59
    v_mul_f32 v201, v201, v59
    v_mul_f32 v202, v202, v59
    v_mul_f32 v203, v203, v59
    v_mul_f32 v204, v204, v59
    v_mul_f32 v205, v205, v59
    v_mul_f32 v206, v206, v59
    v_mul_f32 v207, v207, v59
    v_mul_f32 v208, v208, v59
    v_mul_f32 v209, v209, v59
    v_mul_f32 v210, v210, v59
    v_mul_f32 v211, v211, v59
    v_mul_f32 v212, v212, v59
    v_mul_f32 v213, v213, v59
    v_mul_f32 v214, v214, v59
    v_mul_f32 v215, v215, v59
    v_mul_f32 v216, v216, v59
    v_mul_f32 v217, v217, v59
    v_mul_f32 v218, v218, v59
    v_mul_f32 v219, v219, v59
    v_mul_f32 v220, v220, v59
    v_mul_f32 v221, v221, v59
    v_mul_f32 v222, v222, v59
    v_mul_f32 v223, v223, v59
    v_accvgpr_write_b32 a96, v192
    v_accvgpr_write_b32 a97, v193
    v_accvgpr_write_b32 a98, v194
    v_accvgpr_write_b32 a99, v195
    v_accvgpr_write_b32 a100, v196
    v_accvgpr_write_b32 a101, v197
    v_accvgpr_write_b32 a102, v198
    v_accvgpr_write_b32 a103, v199
    v_accvgpr_write_b32 a104, v200
    v_accvgpr_write_b32 a105, v201
    v_accvgpr_write_b32 a106, v202
    v_accvgpr_write_b32 a107, v203
    v_accvgpr_write_b32 a108, v204
    v_accvgpr_write_b32 a109, v205
    v_accvgpr_write_b32 a110, v206
    v_accvgpr_write_b32 a111, v207
    v_accvgpr_write_b32 a112, v208
    v_accvgpr_write_b32 a113, v209
    v_accvgpr_write_b32 a114, v210
    v_accvgpr_write_b32 a115, v211
    v_accvgpr_write_b32 a116, v212
    v_accvgpr_write_b32 a117, v213
    v_accvgpr_write_b32 a118, v214
    v_accvgpr_write_b32 a119, v215
    v_accvgpr_write_b32 a120, v216
    v_accvgpr_write_b32 a121, v217
    v_accvgpr_write_b32 a122, v218
    v_accvgpr_write_b32 a123, v219
    v_accvgpr_write_b32 a124, v220
    v_accvgpr_write_b32 a125, v221
    v_accvgpr_write_b32 a126, v222
    v_accvgpr_write_b32 a127, v223
    s_waitcnt vmcnt(7)
    v_mfma_f32_16x16x32_bf16 a[0:3], a[192:195], v[224:227], a[0:3]
    v_mfma_f32_16x16x32_bf16 a[32:35], a[192:195], v[228:231], a[32:35]
    s_waitcnt vmcnt(6)
    v_mfma_f32_16x16x32_bf16 a[36:39], a[196:199], v[228:231], a[36:39]
    v_mfma_f32_16x16x32_bf16 a[4:7], a[196:199], v[224:227], a[4:7]
    s_waitcnt vmcnt(5)
    v_mfma_f32_16x16x32_bf16 a[8:11], a[200:203], v[224:227], a[8:11]
    v_mfma_f32_16x16x32_bf16 a[40:43], a[200:203], v[228:231], a[40:43]
    s_waitcnt vmcnt(4)
    v_mfma_f32_16x16x32_bf16 a[44:47], a[204:207], v[228:231], a[44:47]
    v_mfma_f32_16x16x32_bf16 a[12:15], a[204:207], v[224:227], a[12:15]
    s_waitcnt vmcnt(3)
    v_mfma_f32_16x16x32_bf16 a[16:19], a[208:211], v[224:227], a[16:19]
    v_mfma_f32_16x16x32_bf16 a[48:51], a[208:211], v[228:231], a[48:51]
    s_waitcnt vmcnt(2)
    v_mfma_f32_16x16x32_bf16 a[52:55], a[212:215], v[228:231], a[52:55]
    v_mfma_f32_16x16x32_bf16 a[20:23], a[212:215], v[224:227], a[20:23]
    s_waitcnt vmcnt(1)
    v_mfma_f32_16x16x32_bf16 a[24:27], a[216:219], v[224:227], a[24:27]
    v_mfma_f32_16x16x32_bf16 a[56:59], a[216:219], v[228:231], a[56:59]
    s_waitcnt vmcnt(0)
    v_mfma_f32_16x16x32_bf16 a[60:63], a[220:223], v[228:231], a[60:63]
    v_mfma_f32_16x16x32_bf16 a[28:31], a[220:223], v[224:227], a[28:31]
    v_mfma_f32_16x16x32_bf16 v[8:11], v[24:27], v[224:227], v[8:11]
    v_mfma_f32_16x16x32_bf16 v[12:15], v[24:27], v[228:231], v[12:15]
    v_mfma_f32_16x16x32_bf16 a[64:67], a[192:195], v[232:235], a[64:67]
    v_mfma_f32_16x16x32_bf16 a[96:99], a[192:195], v[236:239], a[96:99]
    v_mfma_f32_16x16x32_bf16 a[100:103], a[196:199], v[236:239], a[100:103]
    v_mfma_f32_16x16x32_bf16 a[68:71], a[196:199], v[232:235], a[68:71]
    v_mfma_f32_16x16x32_bf16 a[72:75], a[200:203], v[232:235], a[72:75]
    v_mfma_f32_16x16x32_bf16 a[104:107], a[200:203], v[236:239], a[104:107]
    v_mfma_f32_16x16x32_bf16 a[108:111], a[204:207], v[236:239], a[108:111]
    v_mfma_f32_16x16x32_bf16 a[76:79], a[204:207], v[232:235], a[76:79]
    v_mfma_f32_16x16x32_bf16 a[80:83], a[208:211], v[232:235], a[80:83]
    v_mfma_f32_16x16x32_bf16 a[112:115], a[208:211], v[236:239], a[112:115]
    v_mfma_f32_16x16x32_bf16 a[116:119], a[212:215], v[236:239], a[116:119]
    v_mfma_f32_16x16x32_bf16 a[84:87], a[212:215], v[232:235], a[84:87]
    v_mfma_f32_16x16x32_bf16 a[88:91], a[216:219], v[232:235], a[88:91]
    v_mfma_f32_16x16x32_bf16 a[120:123], a[216:219], v[236:239], a[120:123]
    v_mfma_f32_16x16x32_bf16 a[124:127], a[220:223], v[236:239], a[124:127]
    v_mfma_f32_16x16x32_bf16 a[92:95], a[220:223], v[232:235], a[92:95]
    v_mfma_f32_16x16x32_bf16 v[16:19], v[24:27], v[232:235], v[16:19]
    v_mfma_f32_16x16x32_bf16 v[20:23], v[24:27], v[236:239], v[20:23]
    s_add_u32 s92, s92, 1
    s_cmp_lt_u32 s92, s95
    s_cbranch_scc1 AT_sl
    s_nop 7
    s_nop 7
    buffer_load_dwordx4 a[132:135], v37, s[20:23], s42 offen offset:0 sc1
    buffer_load_dwordx4 a[136:139], v38, s[20:23], s42 offen offset:0 sc1
    buffer_load_dwordx4 a[140:143], v39, s[20:23], s42 offen offset:0 sc1
    buffer_load_dwordx4 a[128:131], v36, s[20:23], s42 offen offset:0 sc1
    buffer_load_dwordx4 a[148:151], v37, s[20:23], s42 offen offset:1024 sc1
    buffer_load_dwordx4 a[152:155], v38, s[20:23], s42 offen offset:1024 sc1
    buffer_load_dwordx4 a[156:159], v39, s[20:23], s42 offen offset:1024 sc1
    buffer_load_dwordx4 a[144:147], v36, s[20:23], s42 offen offset:1024 sc1
    buffer_load_dwordx4 a[164:167], v37, s[20:23], s42 offen offset:2048 sc1
    buffer_load_dwordx4 a[168:171], v38, s[20:23], s42 offen offset:2048 sc1
    buffer_load_dwordx4 a[172:175], v39, s[20:23], s42 offen offset:2048 sc1
    buffer_load_dwordx4 a[160:163], v36, s[20:23], s42 offen offset:2048 sc1
    buffer_load_dwordx4 a[180:183], v37, s[20:23], s42 offen offset:3072 sc1
    buffer_load_dwordx4 a[184:187], v38, s[20:23], s42 offen offset:3072 sc1
    buffer_load_dwordx4 a[188:191], v39, s[20:23], s42 offen offset:3072 sc1
    buffer_load_dwordx4 a[176:179], v36, s[20:23], s42 offen offset:3072 sc1
    s_waitcnt vmcnt(0)
    s_branch AT_fin
SP_cnt:
    s_mov_b32 s97, 40000
SQ_cnt:
    buffer_load_dword v6, v0, s[80:83], 0 offen sc1
    s_waitcnt vmcnt(0)
    v_cmp_eq_u32 vcc, v0, v6
    s_nop 0
    s_cbranch_vccz SR_cnt
    s_sub_u32 s97, s97, 1
    s_cmp_lg_u32 s97, 0
    s_cbranch_scc1 SQ_cnt
    s_branch SR_cnt
SP_xn:
    s_mov_b32 s97, 40000
SQ_xn:
    buffer_load_dword v6, v3, s[88:91], 0 offen sc1
    s_waitcnt vmcnt(0)
    v_cmp_gt_u32 vcc, 1, v6
    s_nop 0
    s_cbranch_vccz SR_xn
    s_sub_u32 s97, s97, 1
    s_cmp_lg_u32 s97, 0
    s_cbranch_scc1 SQ_xn
    s_branch SR_xn
SP_kv:
    s_mov_b32 s97, 40000
SQ_kv:
    buffer_load_dword v6, v3, s[88:91], 0 offen sc1
    s_waitcnt vmcnt(0)
    v_cmp_gt_u32 vcc, 2, v6
    s_nop 0
    s_cbranch_vccz SR_kv
    s_sub_u32 s97, s97, 1
    s_cmp_lg_u32 s97, 0
    s_cbranch_scc1 SQ_kv
    s_branch SR_kv
SP_hw:
    s_mov_b32 s97, 40000
SQ_hw:
    buffer_load_dword v34, v33, s[88:91], 0 offen sc1
    s_waitcnt vmcnt(0)
    v_cmp_gt_u32 vcc, 3, v34
    s_nop 0
    s_cbranch_vccz SR_hw
    s_sub_u32 s97, s97, 1
    s_cmp_lg_u32 s97, 0
    s_cbranch_scc1 SQ_hw
    s_branch SR_hw
SP_ctx:
    s_mov_b32 s97, 40000
SQ_ctx:
    buffer_load_dword v34, v3, s[88:91], 0 offen sc1
    s_waitcnt vmcnt(0)
    v_cmp_gt_u32 vcc, 4, v34
    s_nop 0
    s_cbranch_vccz SR_ctx
    s_sub_u32 s97, s97, 1
    s_cmp_lg_u32 s97, 0
    s_cbranch_scc1 SQ_ctx
    s_branch SR_ctx
SP_pp:
    s_mov_b32 s97, 40000
SQ_pp:
    buffer_load_dword v34, v33, s[88:91], 0 offen sc1
    s_waitcnt vmcnt(0)
    v_cmp_gt_u32 vcc, v32, v34
    s_nop 0
    s_cbranch_vccz SR_pp
    s_sub_u32 s97, s97, 1
    s_cmp_lg_u32 s97, 0
    s_cbranch_scc1 SQ_pp
    s_branch SR_pp
SP_ps:
    s_mov_b32 s97, 40000
SQ_ps:
    buffer_load_dwordx4 v[112:115], v2, s[12:15], s72 offen offset:0 sc1
    buffer_load_dwordx4 v[116:119], v2, s[12:15], s72 offen offset:1024 sc1
    buffer_load_dwordx4 v[120:123], v2, s[12:15], s72 offen offset:2048 sc1
    buffer_load_dwordx4 v[124:127], v2, s[12:15], s72 offen offset:3072 sc1
    buffer_load_dwordx4 v[144:147], v2, s[12:15], s73 offen offset:0 sc1
    buffer_load_dwordx4 v[148:151], v2, s[12:15], s73 offen offset:1024 sc1
    buffer_load_dwordx4 v[152:155], v2, s[12:15], s73 offen offset:2048 sc1
    buffer_load_dwordx4 v[156:159], v2, s[12:15], s73 offen offset:3072 sc1
    buffer_load_dwordx4 v[176:179], v2, s[12:15], s74 offen offset:0 sc1
    buffer_load_dwordx4 v[180:183], v2, s[12:15], s74 offen offset:1024 sc1
    buffer_load_dwordx4 v[184:187], v2, s[12:15], s74 offen offset:2048 sc1
    buffer_load_dwordx4 v[188:191], v2, s[12:15], s74 offen offset:3072 sc1
    s_waitcnt vmcnt(0)
    v_max3_u32 v34, v112, v113, v114
    v_max3_u32 v35, v152, v153, v154
    v_max3_u32 v34, v34, v115, v116
    v_max3_u32 v35, v35, v155, v156
    v_max3_u32 v34, v34, v117, v118
    v_max3_u32 v35, v35, v157, v158
    v_max3_u32 v34, v34, v119, v120
    v_max3_u32 v35, v35, v159, v176
    v_max3_u32 v34, v34, v121, v122
    v_max3_u32 v35, v35, v177, v178
    v_max3_u32 v34, v34, v123, v124
    v_max3_u32 v35, v35, v179, v180
    v_max3_u32 v34, v34, v125, v126
    v_max3_u32 v35, v35, v181, v182
    v_max3_u32 v34, v34, v127, v144
    v_max3_u32 v35, v35, v183, v184
    v_max3_u32 v34, v34, v145, v146
    v_max3_u32 v35, v35, v185, v186
    v_max3_u32 v34, v34, v147, v148
    v_max3_u32 v35, v35, v187, v188
    v_max3_u32 v34, v34, v149, v150
    v_max3_u32 v35, v35, v189, v190
    v_max3_u32 v34, v34, v151, v191
    v_max_u32 v34, v34, v35
    v_cmp_eq_u32 vcc, -1, v34
    s_nop 0
    s_cbranch_vccz SR_ps
    s_sub_u32 s97, s97, 1
    s_cmp_lg_u32 s97, 0
    s_cbranch_scc1 SQ_ps
    s_branch SR_ps
SP_kvl:
    s_mov_b32 s97, 40000
SQ_kvl:
    buffer_load_dword v6, v3, s[88:91], 0 offen sc1
    s_waitcnt vmcnt(0)
    v_cmp_gt_u32 vcc, 2, v6
    s_nop 0
    s_cbranch_vccz SR_kvl
    s_sub_u32 s97, s97, 1
    s_cmp_lg_u32 s97, 0
    s_cbranch_scc1 SQ_kvl
    s_branch SR_kvl
K_end:
    s_endpgm
.section .rodata,"a"
.p2align 6
.amdhsa_kernel recurrent_scan__compressed_kv_cla__geglu_ffn__prompt_kernel
  .amdhsa_next_free_vgpr 512
  .amdhsa_next_free_sgpr 102
  .amdhsa_accum_offset 256
  .amdhsa_group_segment_fixed_size 0
  .amdhsa_kernarg_size 104
  .amdhsa_user_sgpr_count 2
  .amdhsa_user_sgpr_kernarg_segment_ptr 1
  .amdhsa_system_sgpr_workgroup_id_x 1
.end_amdhsa_kernel
```
